```python
import torch

def _softmax(x, axis=-1):
    return torch.softmax(x, dim=axis)

def _gelu(x):
    return torch.nn.functional.gelu(x, approximate='tanh')

def _silu(x):
    return torch.nn.functional.silu(x)

def _sigmoid(x):
    return torch.sigmoid(x)

def _layernorm(x, axis=-1, eps=1e-05):
    m = x.mean(dim=axis, keepdim=True)
    v = x.var(dim=axis, keepdim=True, unbiased=False)
    return (x - m) / torch.sqrt(v + eps)

def _scatter_add(tgt, idx, src, axis=0):
    return tgt.clone().index_add_(axis, idx, src)

def _segment_sum(src, seg, n):
    out = torch.zeros((n,) + src.shape[1:], dtype=src.dtype)
    return out.index_add_(0, seg, src)

def _pad(x, pw):
    flat = tuple((v for pair in reversed(pw) for v in pair))
    return torch.nn.functional.pad(x, flat)
kernel_name = 'standalone__molecular_angular_painn__graph'

def setup_inputs():

    _w = lambda a: (lambda t: t.to(torch.bfloat16) if t.is_floating_point() else t)(torch.as_tensor(a))
    N, deg, D = (50000, 16, 64)
    n_rbf = max(16, 4)
    E = N * deg
    cutoff = 5.0
    freqs = (torch.arange(1, n_rbf + 1) * torch.pi / cutoff).to(float)
    return {'sv': _w((lambda *s: torch.randn(*s, dtype=torch.bfloat16) * 0.4)(N, 4, D) * 0.3), 'pos': _w((lambda *s: torch.randn(*s, dtype=torch.bfloat16) * 3.2)(N, 3) * 1.2), 'src': _w((lambda lo, hi, *s: torch.randint(lo, hi, s))(0, N, E).to(torch.int64)), 'dst': _w((lambda lo, hi, *s: torch.randint(lo, hi, s))(0, N, E).to(torch.int64)), 'freqs': _w(freqs), 'w_phi1': _w((lambda *s: torch.randn(*s, dtype=torch.bfloat16) * 3.2)(D, D) / D ** 0.5), 'w_phi2': _w((lambda *s: torch.randn(*s, dtype=torch.bfloat16) * 3.2)(D, 3 * D) / D ** 0.5), 'w_rbf': _w((lambda *s: torch.randn(*s, dtype=torch.bfloat16) * 3.2)(n_rbf, 3 * D) / n_rbf ** 0.5)}

def reference(sv, pos, src, dst, freqs, w_phi1, w_phi2, w_rbf):
    N, _, D = sv.shape
    E = src.shape[0]
    PI, cutoff = (3.141592653589793, 5.0)
    s, v = (sv[:, 0, :].clone(), sv[:, 1:, :].clone())
    r_vec = pos[src] - pos[dst]
    d = torch.sqrt((r_vec * r_vec).sum(-1) + 1e-08)
    r_hat = r_vec / d[:, None]
    rbf = torch.sin(d[:, None] * freqs[None, :]) / d[:, None]
    fcut = 0.5 * (torch.cos(PI * d / cutoff) + 1.0)
    fcut = torch.where(d < cutoff, fcut, 0.0 * d)
    Wf = rbf @ w_rbf * fcut[:, None]
    phi = (_silu(s @ w_phi1) @ w_phi2)[src]
    m = phi * Wf
    m_s, m_vv, m_vr = (m[:, :D].clone(), m[:, D:2 * D].clone(), m[:, 2 * D:].clone())
    ds = _segment_sum(m_s, dst, N)
    dv_e = m_vv[:, None, :] * v[src] + m_vr[:, None, :] * r_hat[:, :, None]
    dv = _segment_sum(dv_e.reshape(E, 3 * D), dst, N).reshape(N, 3, D)
    return sv + torch.concatenate([ds[:, None, :], dv], axis=1)
```

```asm
; @launch kernel=prep_kernel grid=(250,1,1) block=(1024,1,1) lds=163424
; @launch kernel=main_kernel grid=(250,1,1) block=(512,1,1) lds=163840
.amdgcn_target "amdgcn-amd-amdhsa--gfx950"
.text
.globl prep_kernel
.p2align 8
.type prep_kernel,@function
prep_kernel:
    s_cmp_ge_u32 s2, 250
    s_cbranch_scc1 P_end
    s_load_dwordx8 s[4:11], s[0:1], 0
    s_load_dwordx8 s[12:19], s[0:1], 32
    s_load_dwordx2 s[24:25], s[0:1], 80
    v_and_b32 v1, 63, v0
    v_lshrrev_b32 v2, 6, v0
    v_lshlrev_b32 v3, 3, v0
    v_mov_b32 v4, 0
    v_mov_b32 v5, 0
    v_readfirstlane_b32 s26, v2
    v_add_u32 v3, 155152, v3
    ds_write_b64 v3, v[4:5]
    v_mov_b32 v3, 133120
    ds_write_b64 v3, v[4:5]
    v_mov_b32 v3, 163408
    ds_write_b64 v3, v[4:5]
    ds_write_b64 v3, v[4:5] offset:8
    v_lshrrev_b32 v2, 5, v1
    v_and_b32 v3, 31, v1
    s_mov_b32 s56, 0x05040100
    s_mov_b32 s57, 0x07060302
    s_mov_b32 s58, 0xffff0000
    v_lshlrev_b32 v13, 4, v1
    s_waitcnt lgkmcnt(0)
    s_mov_b32 s28, s8
    s_mov_b32 s29, s9
    s_mov_b32 s30, 0x30d400
    s_mov_b32 s31, 0x00020000
    s_mov_b32 s32, s10
    s_mov_b32 s33, s11
    s_mov_b32 s34, 0x30d400
    s_mov_b32 s35, 0x00020000
    s_mov_b32 s36, s6
    s_mov_b32 s37, s7
    s_mov_b32 s38, 0x493e0
    s_mov_b32 s39, 0x00020000
    s_mov_b32 s48, s24
    s_mov_b32 s49, s25
    s_mov_b32 s50, 0x241b000
    s_mov_b32 s51, 0x00020000
    s_mov_b32 s40, s4
    s_mov_b32 s41, s5
    s_mov_b32 s42, 0x186a000
    s_mov_b32 s43, 0x00020000
    s_add_u32 s44, s24, 0x1e00000
    s_addc_u32 s45, s25, 0
    s_mov_b32 s46, 0x61b000
    s_mov_b32 s47, 0x00020000
    s_mov_b32 s52, s14
    s_mov_b32 s53, s15
    s_mov_b32 s54, 0x2000
    s_mov_b32 s55, 0x00020000
    s_mov_b32 s4, s16
    s_mov_b32 s5, s17
    s_mov_b32 s6, 0x6000
    s_mov_b32 s7, 0x00020000
    s_mov_b32 s8, s18
    s_mov_b32 s9, s19
    s_mov_b32 s10, 0x1800
    s_mov_b32 s11, 0x00020000
    s_cmp_ge_u32 s26, 13
    s_cbranch_scc1 P_noedge1
    v_lshlrev_b32 v12, 4, v0
    s_mul_i32 s27, s2, 12800
    v_cmp_gt_u32 vcc, 800, v0
    s_and_saveexec_b64 s[70:71], vcc
    buffer_load_dwordx4 v[4:7], v12, s[28:31], s27 offen nt
    buffer_load_dwordx4 v[8:11], v12, s[32:35], s27 offen nt
    s_mov_b64 exec, s[70:71]
    s_nop 0
    s_branch P_noedge2
P_noedge1:
    s_lshr_b32 s27, s2, 3
    s_mul_i32 s27, s27, 3
    s_add_u32 s27, s27, s26
    s_sub_u32 s27, s27, 13
    s_mul_i32 s27, s27, 1536
    v_lshlrev_b32 v59, 7, v1
    s_mov_b64 exec, 0xfff
    buffer_load_dword v59, v59, s[36:39], s27 offen
    s_mov_b64 exec, -1
P_noedge2:
    s_barrier
    s_cmp_ge_u32 s26, 13
    s_cbranch_scc1 P_h
    s_setprio 2
    s_mul_i32 s27, s2, 37
    s_mul_hi_u32 s59, s27, 33038210
    s_mul_i32 s59, s59, 130
    s_sub_u32 s27, s27, s59
    s_add_u32 s27, s27, s26
    s_lshl_b32 s27, s27, 10
    s_sub_u32 s59, s27, 133120
    s_cmp_ge_u32 s27, 133120
    s_cselect_b32 s27, s59, s27
    s_add_u32 m0, s27, 0
    s_nop 0
    buffer_load_dwordx4 v13, s[36:39], s27 offen lds
    s_add_u32 s27, s27, 13312
    s_sub_u32 s59, s27, 133120
    s_cmp_ge_u32 s27, 133120
    s_cselect_b32 s27, s59, s27
    s_add_u32 m0, s27, 0
    s_nop 0
    buffer_load_dwordx4 v13, s[36:39], s27 offen lds
    s_add_u32 s27, s27, 13312
    s_sub_u32 s59, s27, 133120
    s_cmp_ge_u32 s27, 133120
    s_cselect_b32 s27, s59, s27
    s_add_u32 m0, s27, 0
    s_nop 0
    buffer_load_dwordx4 v13, s[36:39], s27 offen lds
    s_add_u32 s27, s27, 13312
    s_sub_u32 s59, s27, 133120
    s_cmp_ge_u32 s27, 133120
    s_cselect_b32 s27, s59, s27
    s_add_u32 m0, s27, 0
    s_nop 0
    buffer_load_dwordx4 v13, s[36:39], s27 offen lds
    s_add_u32 s27, s27, 13312
    s_sub_u32 s59, s27, 133120
    s_cmp_ge_u32 s27, 133120
    s_cselect_b32 s27, s59, s27
    s_add_u32 m0, s27, 0
    s_nop 0
    buffer_load_dwordx4 v13, s[36:39], s27 offen lds
    s_add_u32 s27, s27, 13312
    s_sub_u32 s59, s27, 133120
    s_cmp_ge_u32 s27, 133120
    s_cselect_b32 s27, s59, s27
    s_add_u32 m0, s27, 0
    s_nop 0
    buffer_load_dwordx4 v13, s[36:39], s27 offen lds
    s_add_u32 s27, s27, 13312
    s_sub_u32 s59, s27, 133120
    s_cmp_ge_u32 s27, 133120
    s_cselect_b32 s27, s59, s27
    s_add_u32 m0, s27, 0
    s_nop 0
    buffer_load_dwordx4 v13, s[36:39], s27 offen lds
    s_add_u32 s27, s27, 13312
    s_sub_u32 s59, s27, 133120
    s_cmp_ge_u32 s27, 133120
    s_cselect_b32 s27, s59, s27
    s_add_u32 m0, s27, 0
    s_nop 0
    buffer_load_dwordx4 v13, s[36:39], s27 offen lds
    s_add_u32 s27, s27, 13312
    s_sub_u32 s59, s27, 133120
    s_cmp_ge_u32 s27, 133120
    s_cselect_b32 s27, s59, s27
    s_add_u32 m0, s27, 0
    s_nop 0
    buffer_load_dwordx4 v13, s[36:39], s27 offen lds
    s_add_u32 s27, s27, 13312
    s_sub_u32 s59, s27, 133120
    s_cmp_ge_u32 s27, 133120
    s_cselect_b32 s27, s59, s27
    s_add_u32 m0, s27, 0
    s_nop 0
    buffer_load_dwordx4 v13, s[36:39], s27 offen lds
    s_setprio 0
    s_waitcnt vmcnt(10)
    v_cmp_gt_u32 vcc, 800, v0
    s_mov_b64 s[68:69], vcc
    s_nop 0
    v_cndmask_b32 v4, 0, v4, vcc
    v_cndmask_b32 v5, 0, v5, vcc
    v_cndmask_b32 v6, 0, v6, vcc
    v_cndmask_b32 v7, 0, v7, vcc
    v_cndmask_b32 v8, 0, v8, vcc
    v_cndmask_b32 v9, 0, v9, vcc
    v_cndmask_b32 v10, 0, v10, vcc
    v_cndmask_b32 v11, 0, v11, vcc
    s_mov_b32 s62, 0x207f8
    v_bfrev_b32 v14, 2
    v_mov_b32 v15, 133120
    v_mov_b32 v57, 0x01000c0c
    s_mov_b32 s63, 0x02020000
    v_mul_u32_u24 v56, 6, v4
    v_and_b32 v56, -4, v56
    v_cmp_gt_u32 vcc, s62, v56
    s_nop 1
    v_cndmask_b32 v32, v15, v56, vcc
    v_cndmask_b32 v108, v56, v14, vcc
    v_bfe_i32 v58, v4, 0, 1
    v_and_or_b32 v88, v58, s63, v57
    v_add_u32 v96, s63, v88
    v_add_u32 v116, s63, v96
    v_mul_u32_u24 v56, 6, v8
    v_and_b32 v56, -4, v56
    v_cmp_gt_u32 vcc, s62, v56
    s_nop 1
    v_cndmask_b32 v36, v15, v56, vcc
    v_cndmask_b32 v112, v56, v14, vcc
    v_bfe_i32 v58, v8, 0, 1
    v_and_or_b32 v92, v58, s63, v57
    v_add_u32 v100, s63, v92
    v_add_u32 v120, s63, v100
    buffer_load_dwordx2 v[16:17], v108, s[36:39], 0 offen
    buffer_load_dwordx2 v[24:25], v112, s[36:39], 0 offen
    v_mul_u32_u24 v56, 6, v5
    v_and_b32 v56, -4, v56
    v_cmp_gt_u32 vcc, s62, v56
    s_nop 1
    v_cndmask_b32 v33, v15, v56, vcc
    v_cndmask_b32 v109, v56, v14, vcc
    v_bfe_i32 v58, v5, 0, 1
    v_and_or_b32 v89, v58, s63, v57
    v_add_u32 v97, s63, v89
    v_add_u32 v117, s63, v97
    v_mul_u32_u24 v56, 6, v9
    v_and_b32 v56, -4, v56
    v_cmp_gt_u32 vcc, s62, v56
    s_nop 1
    v_cndmask_b32 v37, v15, v56, vcc
    v_cndmask_b32 v113, v56, v14, vcc
    v_bfe_i32 v58, v9, 0, 1
    v_and_or_b32 v93, v58, s63, v57
    v_add_u32 v101, s63, v93
    v_add_u32 v121, s63, v101
    v_mul_u32_u24 v56, 6, v6
    v_and_b32 v56, -4, v56
    v_cmp_gt_u32 vcc, s62, v56
    s_nop 1
    v_cndmask_b32 v34, v15, v56, vcc
    v_cndmask_b32 v110, v56, v14, vcc
    v_bfe_i32 v58, v6, 0, 1
    v_and_or_b32 v90, v58, s63, v57
    v_add_u32 v98, s63, v90
    v_add_u32 v118, s63, v98
    v_mul_u32_u24 v56, 6, v10
    v_and_b32 v56, -4, v56
    v_cmp_gt_u32 vcc, s62, v56
    s_nop 1
    v_cndmask_b32 v38, v15, v56, vcc
    v_cndmask_b32 v114, v56, v14, vcc
    v_bfe_i32 v58, v10, 0, 1
    v_and_or_b32 v94, v58, s63, v57
    v_add_u32 v102, s63, v94
    v_add_u32 v122, s63, v102
    v_mul_u32_u24 v56, 6, v7
    v_and_b32 v56, -4, v56
    v_cmp_gt_u32 vcc, s62, v56
    s_nop 1
    v_cndmask_b32 v35, v15, v56, vcc
    v_cndmask_b32 v111, v56, v14, vcc
    v_bfe_i32 v58, v7, 0, 1
    v_and_or_b32 v91, v58, s63, v57
    v_add_u32 v99, s63, v91
    v_add_u32 v119, s63, v99
    v_mul_u32_u24 v56, 6, v11
    v_and_b32 v56, -4, v56
    v_cmp_gt_u32 vcc, s62, v56
    s_nop 1
    v_cndmask_b32 v39, v15, v56, vcc
    v_cndmask_b32 v115, v56, v14, vcc
    v_bfe_i32 v58, v11, 0, 1
    v_and_or_b32 v95, v58, s63, v57
    v_add_u32 v103, s63, v95
    v_add_u32 v123, s63, v103
    s_mov_b64 s[60:61], exec
    v_mov_b32 v59, 163408
    v_mov_b32 v86, 1
    s_waitcnt vmcnt(2) lgkmcnt(0)
    s_mov_b64 exec, 1
    ds_add_u32 v59, v86 offset:0
    s_mov_b64 exec, s[60:61]
P_w1:
    ds_read_b32 v58, v59 offset:0
    s_waitcnt lgkmcnt(0)
    v_readfirstlane_b32 s59, v58
    s_cmp_ge_u32 s59, 13
    s_nop 3
    s_cbranch_scc1 P_w1_d
    s_sleep 1
    s_branch P_w1
P_w1_d:
    ds_read2_b32 v[40:41], v32 offset1:1
    ds_read2_b32 v[48:49], v36 offset1:1
    ds_read2_b32 v[42:43], v33 offset1:1
    ds_read2_b32 v[50:51], v37 offset1:1
    ds_read2_b32 v[44:45], v34 offset1:1
    ds_read2_b32 v[52:53], v38 offset1:1
    ds_read2_b32 v[46:47], v35 offset1:1
    ds_read2_b32 v[54:55], v39 offset1:1
    s_mov_b32 s64, 0x41c40000
    s_lshl_b32 s65, s26, 12
    s_add_u32 s65, s65, 0
    s_mov_b32 s66, s65
    s_waitcnt lgkmcnt(0)
    s_mov_b64 exec, 1
    ds_add_u32 v59, v86 offset:4
    s_mov_b64 exec, s[60:61]
    buffer_load_dwordx2 v[18:19], v109, s[36:39], 0 offen
    buffer_load_dwordx2 v[26:27], v113, s[36:39], 0 offen
    buffer_load_dwordx2 v[20:21], v110, s[36:39], 0 offen
    buffer_load_dwordx2 v[28:29], v114, s[36:39], 0 offen
    s_waitcnt vmcnt(4)
    v_or_b32 v16, v16, v40
    v_or_b32 v17, v17, v41
    v_perm_b32 v70, v17, v16, v88
    v_perm_b32 v71, v17, v16, v96
    v_perm_b32 v72, v17, v16, v116
    v_or_b32 v24, v24, v48
    v_or_b32 v25, v25, v49
    v_perm_b32 v74, v25, v24, v92
    v_perm_b32 v75, v25, v24, v100
    v_perm_b32 v76, v25, v24, v120
    v_sub_f32 v70, v70, v74
    v_sub_f32 v71, v71, v75
    v_sub_f32 v72, v72, v76
    v_mul_f32 v73, v70, v70
    v_fmac_f32 v73, v71, v71
    v_fmac_f32 v73, v72, v72
    v_cmp_gt_f32 vcc, s64, v73
    s_and_b64 s[62:63], vcc, s[68:69]
    v_cvt_pk_bf16_f32 v74, v70, v71
    v_cvt_pk_bf16_f32 v75, v72, 0
    v_mbcnt_lo_u32_b32 v76, s62, 0
    v_mbcnt_hi_u32_b32 v76, s63, v76
    v_lshl_add_u32 v76, v76, 4, s66
    s_nop 1
P_w2:
    ds_read_b32 v58, v59 offset:4
    s_waitcnt lgkmcnt(0)
    v_readfirstlane_b32 s59, v58
    s_cmp_ge_u32 s59, 13
    s_nop 3
    s_cbranch_scc1 P_w2_d
    s_sleep 1
    s_branch P_w2
P_w2_d:
    s_mov_b64 exec, s[62:63]
    s_cbranch_execz P_skipc0
    ds_write2_b32 v76, v4, v8 offset1:3
    ds_write2_b32 v76, v74, v75 offset0:1 offset1:2
P_skipc0:
    s_mov_b64 exec, s[60:61]
    s_bcnt1_i32_b64 s67, s[62:63]
    s_lshl_b32 s67, s67, 4
    s_add_u32 s66, s66, s67
    buffer_load_dwordx2 v[22:23], v111, s[36:39], 0 offen
    buffer_load_dwordx2 v[30:31], v115, s[36:39], 0 offen
    s_waitcnt vmcnt(4)
    v_or_b32 v18, v18, v42
    v_or_b32 v19, v19, v43
    v_perm_b32 v70, v19, v18, v89
    v_perm_b32 v71, v19, v18, v97
    v_perm_b32 v72, v19, v18, v117
    v_or_b32 v26, v26, v50
    v_or_b32 v27, v27, v51
    v_perm_b32 v74, v27, v26, v93
    v_perm_b32 v75, v27, v26, v101
    v_perm_b32 v76, v27, v26, v121
    v_sub_f32 v70, v70, v74
    v_sub_f32 v71, v71, v75
    v_sub_f32 v72, v72, v76
    v_mul_f32 v73, v70, v70
    v_fmac_f32 v73, v71, v71
    v_fmac_f32 v73, v72, v72
    v_cmp_gt_f32 vcc, s64, v73
    s_and_b64 s[62:63], vcc, s[68:69]
    v_cvt_pk_bf16_f32 v74, v70, v71
    v_cvt_pk_bf16_f32 v75, v72, 0
    v_mbcnt_lo_u32_b32 v76, s62, 0
    v_mbcnt_hi_u32_b32 v76, s63, v76
    v_lshl_add_u32 v76, v76, 4, s66
    s_mov_b64 exec, s[62:63]
    s_nop 0
    s_cbranch_execz P_skipc1
    ds_write2_b32 v76, v5, v9 offset1:3
    ds_write2_b32 v76, v74, v75 offset0:1 offset1:2
P_skipc1:
    s_mov_b64 exec, s[60:61]
    s_bcnt1_i32_b64 s67, s[62:63]
    s_lshl_b32 s67, s67, 4
    s_add_u32 s66, s66, s67
    s_waitcnt vmcnt(2)
    v_or_b32 v20, v20, v44
    v_or_b32 v21, v21, v45
    v_perm_b32 v70, v21, v20, v90
    v_perm_b32 v71, v21, v20, v98
    v_perm_b32 v72, v21, v20, v118
    v_or_b32 v28, v28, v52
    v_or_b32 v29, v29, v53
    v_perm_b32 v74, v29, v28, v94
    v_perm_b32 v75, v29, v28, v102
    v_perm_b32 v76, v29, v28, v122
    v_sub_f32 v70, v70, v74
    v_sub_f32 v71, v71, v75
    v_sub_f32 v72, v72, v76
    v_mul_f32 v73, v70, v70
    v_fmac_f32 v73, v71, v71
    v_fmac_f32 v73, v72, v72
    v_cmp_gt_f32 vcc, s64, v73
    s_and_b64 s[62:63], vcc, s[68:69]
    v_cvt_pk_bf16_f32 v74, v70, v71
    v_cvt_pk_bf16_f32 v75, v72, 0
    v_mbcnt_lo_u32_b32 v76, s62, 0
    v_mbcnt_hi_u32_b32 v76, s63, v76
    v_lshl_add_u32 v76, v76, 4, s66
    s_mov_b64 exec, s[62:63]
    s_nop 0
    s_cbranch_execz P_skipc2
    ds_write2_b32 v76, v6, v10 offset1:3
    ds_write2_b32 v76, v74, v75 offset0:1 offset1:2
P_skipc2:
    s_mov_b64 exec, s[60:61]
    s_bcnt1_i32_b64 s67, s[62:63]
    s_lshl_b32 s67, s67, 4
    s_add_u32 s66, s66, s67
    s_waitcnt vmcnt(0)
    v_or_b32 v22, v22, v46
    v_or_b32 v23, v23, v47
    v_perm_b32 v70, v23, v22, v91
    v_perm_b32 v71, v23, v22, v99
    v_perm_b32 v72, v23, v22, v119
    v_or_b32 v30, v30, v54
    v_or_b32 v31, v31, v55
    v_perm_b32 v74, v31, v30, v95
    v_perm_b32 v75, v31, v30, v103
    v_perm_b32 v76, v31, v30, v123
    v_sub_f32 v70, v70, v74
    v_sub_f32 v71, v71, v75
    v_sub_f32 v72, v72, v76
    v_mul_f32 v73, v70, v70
    v_fmac_f32 v73, v71, v71
    v_fmac_f32 v73, v72, v72
    v_cmp_gt_f32 vcc, s64, v73
    s_and_b64 s[62:63], vcc, s[68:69]
    v_cvt_pk_bf16_f32 v74, v70, v71
    v_cvt_pk_bf16_f32 v75, v72, 0
    v_mbcnt_lo_u32_b32 v76, s62, 0
    v_mbcnt_hi_u32_b32 v76, s63, v76
    v_lshl_add_u32 v76, v76, 4, s66
    s_mov_b64 exec, s[62:63]
    s_nop 0
    s_cbranch_execz P_skipc3
    ds_write2_b32 v76, v7, v11 offset1:3
    ds_write2_b32 v76, v74, v75 offset0:1 offset1:2
P_skipc3:
    s_mov_b64 exec, s[60:61]
    s_bcnt1_i32_b64 s67, s[62:63]
    s_lshl_b32 s67, s67, 4
    s_add_u32 s66, s66, s67
    s_sub_u32 s66, s66, s65
    s_lshr_b32 s66, s66, 4
    s_mov_b32 s64, 0x322bcc77
    s_mov_b32 s62, 0x409d0000
    s_mov_b32 s63, 0x147AE15
    s_movk_i32 s67, -200
    s_mov_b64 s[70:71], 0
    s_mov_b64 s[72:73], 0
    s_mov_b64 s[74:75], 0
    s_mov_b64 s[76:77], 0
    v_add_u32 v12, s65, v13
    s_waitcnt lgkmcnt(0)
    s_cmp_le_u32 s66, 0
    s_cbranch_scc1 P_edgew
    ds_read_b128 v[88:91], v12 offset:0
    s_sub_u32 s59, s66, 0
    v_cmp_gt_u32 s[68:69], s59, v1
    s_waitcnt lgkmcnt(0)
    v_lshlrev_b32 v74, 16, v89
    v_and_b32 v75, s58, v89
    v_lshlrev_b32 v72, 16, v90
    v_mul_f32 v74, v74, v74
    v_mul_f32 v75, v75, v75
    v_mul_f32 v76, v72, v72
    v_cvt_pk_bf16_f32 v74, 0, v74
    v_cvt_pk_bf16_f32 v75, 0, v75
    v_cvt_pk_bf16_f32 v76, 0, v76
    v_add_f32 v74, v74, v75
    v_add_f32 v74, v74, v76
    v_cvt_pk_bf16_f32 v74, 0, v74
    v_add_f32 v74, s64, v74
    v_cvt_pk_bf16_f32 v74, 0, v74
    v_sqrt_f32 v74, v74
    v_mul_hi_u32 v60, v91, s63
    v_cvt_pk_bf16_f32 v90, v72, v74
    v_mad_i32_i24 v91, v60, s67, v91
    v_lshl_or_b32 v88, v91, 16, v88
    v_cmp_gt_u32 vcc, s62, v90
    s_and_b64 s[70:71], vcc, s[68:69]
    v_lshlrev_b32 v104, 2, v60
    v_add_u32 v104, 155152, v104
    s_mov_b64 exec, s[70:71]
    s_nop 0
    s_cbranch_execz P_skiph0
    ds_add_rtn_u32 v64, v104, v86
P_skiph0:
    s_mov_b64 exec, s[60:61]
    s_cmp_le_u32 s66, 64
    s_cbranch_scc1 P_edgew
    ds_read_b128 v[92:95], v12 offset:1024
    s_sub_u32 s59, s66, 64
    v_cmp_gt_u32 s[68:69], s59, v1
    s_waitcnt lgkmcnt(0)
    v_lshlrev_b32 v74, 16, v93
    v_and_b32 v75, s58, v93
    v_lshlrev_b32 v72, 16, v94
    v_mul_f32 v74, v74, v74
    v_mul_f32 v75, v75, v75
    v_mul_f32 v76, v72, v72
    v_cvt_pk_bf16_f32 v74, 0, v74
    v_cvt_pk_bf16_f32 v75, 0, v75
    v_cvt_pk_bf16_f32 v76, 0, v76
    v_add_f32 v74, v74, v75
    v_add_f32 v74, v74, v76
    v_cvt_pk_bf16_f32 v74, 0, v74
    v_add_f32 v74, s64, v74
    v_cvt_pk_bf16_f32 v74, 0, v74
    v_sqrt_f32 v74, v74
    v_mul_hi_u32 v61, v95, s63
    v_cvt_pk_bf16_f32 v94, v72, v74
    v_mad_i32_i24 v95, v61, s67, v95
    v_lshl_or_b32 v92, v95, 16, v92
    v_cmp_gt_u32 vcc, s62, v94
    s_and_b64 s[72:73], vcc, s[68:69]
    v_lshlrev_b32 v105, 2, v61
    v_add_u32 v105, 155152, v105
    s_mov_b64 exec, s[72:73]
    s_nop 0
    s_cbranch_execz P_skiph1
    ds_add_rtn_u32 v65, v105, v86
P_skiph1:
    s_mov_b64 exec, s[60:61]
    s_cmp_le_u32 s66, 128
    s_cbranch_scc1 P_edgew
    ds_read_b128 v[96:99], v12 offset:2048
    s_sub_u32 s59, s66, 128
    v_cmp_gt_u32 s[68:69], s59, v1
    s_waitcnt lgkmcnt(0)
    v_lshlrev_b32 v74, 16, v97
    v_and_b32 v75, s58, v97
    v_lshlrev_b32 v72, 16, v98
    v_mul_f32 v74, v74, v74
    v_mul_f32 v75, v75, v75
    v_mul_f32 v76, v72, v72
    v_cvt_pk_bf16_f32 v74, 0, v74
    v_cvt_pk_bf16_f32 v75, 0, v75
    v_cvt_pk_bf16_f32 v76, 0, v76
    v_add_f32 v74, v74, v75
    v_add_f32 v74, v74, v76
    v_cvt_pk_bf16_f32 v74, 0, v74
    v_add_f32 v74, s64, v74
    v_cvt_pk_bf16_f32 v74, 0, v74
    v_sqrt_f32 v74, v74
    v_mul_hi_u32 v62, v99, s63
    v_cvt_pk_bf16_f32 v98, v72, v74
    v_mad_i32_i24 v99, v62, s67, v99
    v_lshl_or_b32 v96, v99, 16, v96
    v_cmp_gt_u32 vcc, s62, v98
    s_and_b64 s[74:75], vcc, s[68:69]
    v_lshlrev_b32 v106, 2, v62
    v_add_u32 v106, 155152, v106
    s_mov_b64 exec, s[74:75]
    s_nop 0
    s_cbranch_execz P_skiph2
    ds_add_rtn_u32 v66, v106, v86
P_skiph2:
    s_mov_b64 exec, s[60:61]
    s_cmp_le_u32 s66, 192
    s_cbranch_scc1 P_edgew
    ds_read_b128 v[100:103], v12 offset:3072
    s_sub_u32 s59, s66, 192
    v_cmp_gt_u32 s[68:69], s59, v1
    s_waitcnt lgkmcnt(0)
    v_lshlrev_b32 v74, 16, v101
    v_and_b32 v75, s58, v101
    v_lshlrev_b32 v72, 16, v102
    v_mul_f32 v74, v74, v74
    v_mul_f32 v75, v75, v75
    v_mul_f32 v76, v72, v72
    v_cvt_pk_bf16_f32 v74, 0, v74
    v_cvt_pk_bf16_f32 v75, 0, v75
    v_cvt_pk_bf16_f32 v76, 0, v76
    v_add_f32 v74, v74, v75
    v_add_f32 v74, v74, v76
    v_cvt_pk_bf16_f32 v74, 0, v74
    v_add_f32 v74, s64, v74
    v_cvt_pk_bf16_f32 v74, 0, v74
    v_sqrt_f32 v74, v74
    v_mul_hi_u32 v63, v103, s63
    v_cvt_pk_bf16_f32 v102, v72, v74
    v_mad_i32_i24 v103, v63, s67, v103
    v_lshl_or_b32 v100, v103, 16, v100
    v_cmp_gt_u32 vcc, s62, v102
    s_and_b64 s[76:77], vcc, s[68:69]
    v_lshlrev_b32 v107, 2, v63
    v_add_u32 v107, 155152, v107
    s_mov_b64 exec, s[76:77]
    s_nop 0
    s_cbranch_execz P_skiph3
    ds_add_rtn_u32 v67, v107, v86
P_skiph3:
    s_mov_b64 exec, s[60:61]
P_edgew:
    v_mov_b32 v87, 156152
    s_mul_i32 s27, s2, 51200
    s_add_u32 s27, s27, 0x1100000
    v_lshlrev_b32 v104, 8, v60
    v_add_u32 v104, 53248, v104
    v_lshlrev_b32 v105, 8, v61
    v_add_u32 v105, 53248, v105
    v_lshlrev_b32 v106, 8, v62
    v_add_u32 v106, 53248, v106
    v_lshlrev_b32 v107, 8, v63
    v_add_u32 v107, 53248, v107
    s_waitcnt lgkmcnt(0)
    s_cmp_eq_u64 s[70:71], 0
    s_cbranch_scc1 P_img0
    v_mad_u32_u24 v70, v64, 12, v104
    v_add_u32 v71, 6, v64
    v_lshrrev_b32 v71, 4, v71
    v_lshl_add_u32 v70, v71, 3, v70
    v_cmp_gt_u32 vcc, 20, v64
    s_and_b64 exec, vcc, s[70:71]
    s_nop 3
    s_cbranch_execz P_imo0
    ds_write2_b32 v70, v88, v89 offset1:1
    ds_write_b32 v70, v90 offset:8
P_imo0:
    s_andn2_b64 exec, s[70:71], vcc
    s_cbranch_execz P_imx0
    ds_add_rtn_u32 v71, v87, v86
    v_mov_b32 v91, v60
    s_waitcnt lgkmcnt(0)
    v_lshlrev_b32 v71, 4, v71
    buffer_store_dwordx4 v[88:91], v71, s[48:51], s27 offen
    s_nop 1
P_imx0:
    s_mov_b64 exec, s[60:61]
P_img0:
    s_cmp_eq_u64 s[72:73], 0
    s_cbranch_scc1 P_img1
    v_mad_u32_u24 v70, v65, 12, v105
    v_add_u32 v71, 6, v65
    v_lshrrev_b32 v71, 4, v71
    v_lshl_add_u32 v70, v71, 3, v70
    v_cmp_gt_u32 vcc, 20, v65
    s_and_b64 exec, vcc, s[72:73]
    s_nop 3
    s_cbranch_execz P_imo1
    ds_write2_b32 v70, v92, v93 offset1:1
    ds_write_b32 v70, v94 offset:8
P_imo1:
    s_andn2_b64 exec, s[72:73], vcc
    s_cbranch_execz P_imx1
    ds_add_rtn_u32 v71, v87, v86
    v_mov_b32 v95, v61
    s_waitcnt lgkmcnt(0)
    v_lshlrev_b32 v71, 4, v71
    buffer_store_dwordx4 v[92:95], v71, s[48:51], s27 offen
    s_nop 1
P_imx1:
    s_mov_b64 exec, s[60:61]
P_img1:
    s_cmp_eq_u64 s[74:75], 0
    s_cbranch_scc1 P_img2
    v_mad_u32_u24 v70, v66, 12, v106
    v_add_u32 v71, 6, v66
    v_lshrrev_b32 v71, 4, v71
    v_lshl_add_u32 v70, v71, 3, v70
    v_cmp_gt_u32 vcc, 20, v66
    s_and_b64 exec, vcc, s[74:75]
    s_nop 3
    s_cbranch_execz P_imo2
    ds_write2_b32 v70, v96, v97 offset1:1
    ds_write_b32 v70, v98 offset:8
P_imo2:
    s_andn2_b64 exec, s[74:75], vcc
    s_cbranch_execz P_imx2
    ds_add_rtn_u32 v71, v87, v86
    v_mov_b32 v99, v62
    s_waitcnt lgkmcnt(0)
    v_lshlrev_b32 v71, 4, v71
    buffer_store_dwordx4 v[96:99], v71, s[48:51], s27 offen
    s_nop 1
P_imx2:
    s_mov_b64 exec, s[60:61]
P_img2:
    s_cmp_eq_u64 s[76:77], 0
    s_cbranch_scc1 P_img3
    v_mad_u32_u24 v70, v67, 12, v107
    v_add_u32 v71, 6, v67
    v_lshrrev_b32 v71, 4, v71
    v_lshl_add_u32 v70, v71, 3, v70
    v_cmp_gt_u32 vcc, 20, v67
    s_and_b64 exec, vcc, s[76:77]
    s_nop 3
    s_cbranch_execz P_imo3
    ds_write2_b32 v70, v100, v101 offset1:1
    ds_write_b32 v70, v102 offset:8
P_imo3:
    s_andn2_b64 exec, s[76:77], vcc
    s_cbranch_execz P_imx3
    ds_add_rtn_u32 v71, v87, v86
    v_mov_b32 v103, v63
    s_waitcnt lgkmcnt(0)
    v_lshlrev_b32 v71, 4, v71
    buffer_store_dwordx4 v[100:103], v71, s[48:51], s27 offen
    s_nop 1
P_imx3:
    s_mov_b64 exec, s[60:61]
P_img3:
    s_branch P_noedge3
P_h:
    s_setprio 1
    s_mov_b32 s77, 0
    s_cmp_lg_u32 s26, 15
    s_cbranch_scc1 P_hl
    s_cmp_ge_u32 s2, 15
    s_cbranch_scc1 P_hl
    s_mov_b32 s77, 1
    v_mul_u32_u24 v14, 1536, v2
    v_lshl_add_u32 v14, v3, 2, v14
    s_cmp_ge_u32 s2, 12
    s_nop 0
    s_cbranch_scc1 P_imgrbf
    s_lshr_b32 s64, s2, 2
    s_and_b32 s65, s2, 3
    s_mul_i32 s66, s65, 6144
    s_lshl_b32 s67, s64, 7
    s_add_u32 s66, s66, s67
    v_add_u32 v15, 3072, v14
    buffer_load_dword v4, v14, s[4:7], s66 offen offset:0
    buffer_load_dword v5, v14, s[4:7], s66 offen offset:384
    buffer_load_dword v6, v14, s[4:7], s66 offen offset:768
    buffer_load_dword v7, v14, s[4:7], s66 offen offset:1152
    buffer_load_dword v8, v15, s[4:7], s66 offen offset:0
    buffer_load_dword v9, v15, s[4:7], s66 offen offset:384
    buffer_load_dword v10, v15, s[4:7], s66 offen offset:768
    buffer_load_dword v11, v15, s[4:7], s66 offen offset:1152
    s_lshl_b32 s75, s64, 3
    s_add_u32 s75, s75, s65
    s_lshl_b32 s75, s75, 10
    s_add_u32 s75, s75, 0x800000
    s_movk_i32 s76, 4096
    s_branch P_hl
P_imgrbf:
    v_mul_u32_u24 v14, 3072, v2
    v_lshl_add_u32 v14, v3, 2, v14
    s_sub_u32 s64, s2, 12
    s_lshl_b32 s66, s64, 7
    buffer_load_dword v4, v14, s[8:11], s66 offen offset:0
    buffer_load_dword v5, v14, s[8:11], s66 offen offset:384
    buffer_load_dword v6, v14, s[8:11], s66 offen offset:768
    buffer_load_dword v7, v14, s[8:11], s66 offen offset:1152
    buffer_load_dword v8, v14, s[8:11], s66 offen offset:1536
    buffer_load_dword v9, v14, s[8:11], s66 offen offset:1920
    buffer_load_dword v10, v14, s[8:11], s66 offen offset:2304
    buffer_load_dword v11, v14, s[8:11], s66 offen offset:2688
    s_lshl_b32 s75, s64, 11
    s_add_u32 s75, s75, 0x806000
    s_movk_i32 s76, 1024
P_hl:
    s_sub_u32 s61, s26, 13
    s_mul_i32 s62, s61, 250
    s_add_u32 s62, s62, s2
    s_add_u32 s63, s62, 750
    s_add_u32 s68, s62, 1500
    v_lshlrev_b32 v14, 9, v3
    v_lshl_add_u32 v14, v2, 4, v14
    s_lshl_b32 s70, s62, 14
    s_lshl_b32 s71, s63, 14
    buffer_load_dwordx4 v[16:19], v14, s[40:43], s70 offen offset:0
    buffer_load_dwordx4 v[20:23], v14, s[40:43], s70 offen offset:32
    buffer_load_dwordx4 v[24:27], v14, s[40:43], s70 offen offset:64
    buffer_load_dwordx4 v[28:31], v14, s[40:43], s70 offen offset:96
    s_sub_u32 s61, s26, 13
    s_lshl_b32 s61, s61, 10
    s_add_u32 m0, s61, 133136
    s_nop 0
    buffer_load_dwordx4 v13, s[52:55], s61 offen lds
    s_add_u32 s61, s61, 3072
    s_add_u32 m0, s61, 133136
    s_nop 0
    buffer_load_dwordx4 v13, s[52:55], s61 offen lds
    s_add_u32 s61, s61, 3072
    s_cmp_eq_u32 s26, 15
    s_cbranch_scc1 P_w1s
    s_add_u32 m0, s61, 133136
    s_nop 0
    buffer_load_dwordx4 v13, s[52:55], s61 offen lds
P_w1s:
    buffer_load_dwordx4 v[32:35], v14, s[40:43], s71 offen offset:0
    buffer_load_dwordx4 v[36:39], v14, s[40:43], s71 offen offset:32
    buffer_load_dwordx4 v[40:43], v14, s[40:43], s71 offen offset:64
    buffer_load_dwordx4 v[44:47], v14, s[40:43], s71 offen offset:96
    s_lshr_b32 s27, s2, 3
    s_mul_i32 s27, s27, 3
    s_add_u32 s27, s27, s26
    s_sub_u32 s27, s27, 13
    s_mul_i32 s27, s27, 2048
    s_add_u32 s27, s27, 133120
    v_add_u32 v56, s27, v13
    buffer_load_dwordx4 v[48:51], v56, s[36:39], 0 offen offset:0
    buffer_load_dwordx4 v[52:55], v56, s[36:39], 0 offen offset:1024
    s_setprio 0
    s_mov_b32 s60, 0xbfb8aa3b
    s_sub_u32 s59, s26, 13
    s_mul_i32 s59, s59, 4608
    s_add_u32 s59, s59, 141328
    v_mul_u32_u24 v12, 144, v3
    v_lshl_add_u32 v12, v2, 6, v12
    v_add_u32 v12, s59, v12
    v_lshrrev_b32 v3, 3, v1
    v_mul_u32_u24 v3, 144, v3
    v_and_b32 v56, 7, v1
    v_lshl_add_u32 v3, v56, 4, v3
    v_add_u32 v3, s59, v3
    v_bfe_u32 v15, v1, 2, 2
    v_lshl_add_u32 v15, v2, 3, v15
    v_lshlrev_b32 v15, 7, v15
    v_bfe_u32 v56, v1, 4, 1
    v_lshl_add_u32 v15, v56, 5, v15
    v_and_b32 v56, 3, v1
    v_lshl_add_u32 v15, v56, 3, v15
    v_add_u32 v15, 133136, v15
    s_lshl_b32 s64, s68, 14
    s_cmp_lt_u32 s68, 1563
    s_cselect_b32 s64, s64, 0x40000000
    s_waitcnt vmcnt(6)
    s_mov_b64 s[60:61], exec
    v_mov_b32 v59, 163408
    v_mov_b32 v86, 1
    s_mov_b64 exec, 1
    ds_add_u32 v59, v86 offset:8
    s_mov_b64 exec, s[60:61]
P_w3:
    ds_read_b32 v58, v59 offset:8
    s_waitcnt lgkmcnt(0)
    v_readfirstlane_b32 s59, v58
    s_cmp_ge_u32 s59, 3
    s_nop 3
    s_cbranch_scc1 P_w3_d
    s_sleep 1
    s_branch P_w3
P_w3_d:
    s_mov_b32 s60, 0xbfb8aa3b
    ds_read_b64_tr_b16 v[96:97], v15 offset:0
    ds_read_b64_tr_b16 v[98:99], v15 offset:512
    ds_read_b64_tr_b16 v[100:101], v15 offset:2048
    ds_read_b64_tr_b16 v[102:103], v15 offset:2560
    ds_read_b64_tr_b16 v[104:105], v15 offset:4096
    ds_read_b64_tr_b16 v[106:107], v15 offset:4608
    ds_read_b64_tr_b16 v[108:109], v15 offset:6144
    ds_read_b64_tr_b16 v[110:111], v15 offset:6656
    ds_read_b64_tr_b16 v[112:113], v15 offset:64
    ds_read_b64_tr_b16 v[114:115], v15 offset:576
    ds_read_b64_tr_b16 v[116:117], v15 offset:2112
    ds_read_b64_tr_b16 v[118:119], v15 offset:2624
    ds_read_b64_tr_b16 v[120:121], v15 offset:4160
    ds_read_b64_tr_b16 v[122:123], v15 offset:4672
    ds_read_b64_tr_b16 v[124:125], v15 offset:6208
    ds_read_b64_tr_b16 v[126:127], v15 offset:6720
    s_waitcnt lgkmcnt(0)
    v_mfma_f32_32x32x16_bf16 v[64:79], v[96:99], v[16:19], 0
    v_mfma_f32_32x32x16_bf16 v[64:79], v[100:103], v[20:23], v[64:79]
    v_mfma_f32_32x32x16_bf16 v[64:79], v[104:107], v[24:27], v[64:79]
    v_mfma_f32_32x32x16_bf16 v[64:79], v[108:111], v[28:31], v[64:79]
    v_mfma_f32_32x32x16_bf16 v[80:95], v[112:115], v[16:19], 0
    v_mfma_f32_32x32x16_bf16 v[80:95], v[116:119], v[20:23], v[80:95]
    v_mfma_f32_32x32x16_bf16 v[80:95], v[120:123], v[24:27], v[80:95]
    v_mfma_f32_32x32x16_bf16 v[80:95], v[124:127], v[28:31], v[80:95]
    v_add_u32 v14, s64, v14
    buffer_load_dwordx4 v[16:19], v14, s[40:43], 0 offen offset:0
    buffer_load_dwordx4 v[20:23], v14, s[40:43], 0 offen offset:32
    buffer_load_dwordx4 v[24:27], v14, s[40:43], 0 offen offset:64
    buffer_load_dwordx4 v[28:31], v14, s[40:43], 0 offen offset:96
    s_waitcnt vmcnt(4)
    s_nop 1
    v_cvt_pk_bf16_f32 v64, 0, v64
    v_cvt_pk_bf16_f32 v65, 0, v65
    v_cvt_pk_bf16_f32 v66, 0, v66
    v_cvt_pk_bf16_f32 v67, 0, v67
    v_cvt_pk_bf16_f32 v68, 0, v68
    v_cvt_pk_bf16_f32 v69, 0, v69
    v_cvt_pk_bf16_f32 v70, 0, v70
    v_cvt_pk_bf16_f32 v71, 0, v71
    v_cvt_pk_bf16_f32 v72, 0, v72
    v_cvt_pk_bf16_f32 v73, 0, v73
    v_cvt_pk_bf16_f32 v74, 0, v74
    v_cvt_pk_bf16_f32 v75, 0, v75
    v_cvt_pk_bf16_f32 v76, 0, v76
    v_cvt_pk_bf16_f32 v77, 0, v77
    v_cvt_pk_bf16_f32 v78, 0, v78
    v_cvt_pk_bf16_f32 v79, 0, v79
    v_mul_f32 v48, s60, v64
    v_mul_f32 v49, s60, v65
    v_mul_f32 v50, s60, v66
    v_mul_f32 v51, s60, v67
    v_mul_f32 v52, s60, v68
    v_mul_f32 v53, s60, v69
    v_mul_f32 v54, s60, v70
    v_mul_f32 v55, s60, v71
    v_mul_f32 v56, s60, v72
    v_mul_f32 v57, s60, v73
    v_mul_f32 v58, s60, v74
    v_mul_f32 v59, s60, v75
    v_mul_f32 v60, s60, v76
    v_mul_f32 v61, s60, v77
    v_mul_f32 v62, s60, v78
    v_mul_f32 v63, s60, v79
    v_exp_f32 v48, v48
    v_exp_f32 v49, v49
    v_exp_f32 v50, v50
    v_exp_f32 v51, v51
    v_exp_f32 v52, v52
    v_exp_f32 v53, v53
    v_exp_f32 v54, v54
    v_exp_f32 v55, v55
    v_exp_f32 v56, v56
    v_exp_f32 v57, v57
    v_exp_f32 v58, v58
    v_exp_f32 v59, v59
    v_exp_f32 v60, v60
    v_exp_f32 v61, v61
    v_exp_f32 v62, v62
    v_exp_f32 v63, v63
    v_add_f32 v48, 1.0, v48
    v_add_f32 v49, 1.0, v49
    v_add_f32 v50, 1.0, v50
    v_add_f32 v51, 1.0, v51
    v_add_f32 v52, 1.0, v52
    v_add_f32 v53, 1.0, v53
    v_add_f32 v54, 1.0, v54
    v_add_f32 v55, 1.0, v55
    v_add_f32 v56, 1.0, v56
    v_add_f32 v57, 1.0, v57
    v_add_f32 v58, 1.0, v58
    v_add_f32 v59, 1.0, v59
    v_add_f32 v60, 1.0, v60
    v_add_f32 v61, 1.0, v61
    v_add_f32 v62, 1.0, v62
    v_add_f32 v63, 1.0, v63
    v_rcp_f32 v48, v48
    v_rcp_f32 v49, v49
    v_rcp_f32 v50, v50
    v_rcp_f32 v51, v51
    v_rcp_f32 v52, v52
    v_rcp_f32 v53, v53
    v_rcp_f32 v54, v54
    v_rcp_f32 v55, v55
    v_rcp_f32 v56, v56
    v_rcp_f32 v57, v57
    v_rcp_f32 v58, v58
    v_rcp_f32 v59, v59
    v_rcp_f32 v60, v60
    v_rcp_f32 v61, v61
    v_rcp_f32 v62, v62
    v_rcp_f32 v63, v63
    v_mul_f32 v48, v64, v48
    v_mul_f32 v49, v65, v49
    v_mul_f32 v50, v66, v50
    v_mul_f32 v51, v67, v51
    v_mul_f32 v52, v68, v52
    v_mul_f32 v53, v69, v53
    v_mul_f32 v54, v70, v54
    v_mul_f32 v55, v71, v55
    v_mul_f32 v56, v72, v56
    v_mul_f32 v57, v73, v57
    v_mul_f32 v58, v74, v58
    v_mul_f32 v59, v75, v59
    v_mul_f32 v60, v76, v60
    v_mul_f32 v61, v77, v61
    v_mul_f32 v62, v78, v62
    v_mul_f32 v63, v79, v63
    v_cvt_pk_bf16_f32 v64, v48, v49
    v_cvt_pk_bf16_f32 v65, v50, v51
    v_cvt_pk_bf16_f32 v66, v52, v53
    v_cvt_pk_bf16_f32 v67, v54, v55
    v_cvt_pk_bf16_f32 v68, v56, v57
    v_cvt_pk_bf16_f32 v69, v58, v59
    v_cvt_pk_bf16_f32 v70, v60, v61
    v_cvt_pk_bf16_f32 v71, v62, v63
    v_cvt_pk_bf16_f32 v80, 0, v80
    v_cvt_pk_bf16_f32 v81, 0, v81
    v_cvt_pk_bf16_f32 v82, 0, v82
    v_cvt_pk_bf16_f32 v83, 0, v83
    v_cvt_pk_bf16_f32 v84, 0, v84
    v_cvt_pk_bf16_f32 v85, 0, v85
    v_cvt_pk_bf16_f32 v86, 0, v86
    v_cvt_pk_bf16_f32 v87, 0, v87
    v_cvt_pk_bf16_f32 v88, 0, v88
    v_cvt_pk_bf16_f32 v89, 0, v89
    v_cvt_pk_bf16_f32 v90, 0, v90
    v_cvt_pk_bf16_f32 v91, 0, v91
    v_cvt_pk_bf16_f32 v92, 0, v92
    v_cvt_pk_bf16_f32 v93, 0, v93
    v_cvt_pk_bf16_f32 v94, 0, v94
    v_cvt_pk_bf16_f32 v95, 0, v95
    v_mul_f32 v48, s60, v80
    v_mul_f32 v49, s60, v81
    v_mul_f32 v50, s60, v82
    v_mul_f32 v51, s60, v83
    v_mul_f32 v52, s60, v84
    v_mul_f32 v53, s60, v85
    v_mul_f32 v54, s60, v86
    v_mul_f32 v55, s60, v87
    v_mul_f32 v56, s60, v88
    v_mul_f32 v57, s60, v89
    v_mul_f32 v58, s60, v90
    v_mul_f32 v59, s60, v91
    v_mul_f32 v60, s60, v92
    v_mul_f32 v61, s60, v93
    v_mul_f32 v62, s60, v94
    v_mul_f32 v63, s60, v95
    v_exp_f32 v48, v48
    v_exp_f32 v49, v49
    v_exp_f32 v50, v50
    v_exp_f32 v51, v51
    v_exp_f32 v52, v52
    v_exp_f32 v53, v53
    v_exp_f32 v54, v54
    v_exp_f32 v55, v55
    v_exp_f32 v56, v56
    v_exp_f32 v57, v57
    v_exp_f32 v58, v58
    v_exp_f32 v59, v59
    v_exp_f32 v60, v60
    v_exp_f32 v61, v61
    v_exp_f32 v62, v62
    v_exp_f32 v63, v63
    v_add_f32 v48, 1.0, v48
    v_add_f32 v49, 1.0, v49
    v_add_f32 v50, 1.0, v50
    v_add_f32 v51, 1.0, v51
    v_add_f32 v52, 1.0, v52
    v_add_f32 v53, 1.0, v53
    v_add_f32 v54, 1.0, v54
    v_add_f32 v55, 1.0, v55
    v_add_f32 v56, 1.0, v56
    v_add_f32 v57, 1.0, v57
    v_add_f32 v58, 1.0, v58
    v_add_f32 v59, 1.0, v59
    v_add_f32 v60, 1.0, v60
    v_add_f32 v61, 1.0, v61
    v_add_f32 v62, 1.0, v62
    v_add_f32 v63, 1.0, v63
    v_rcp_f32 v48, v48
    v_rcp_f32 v49, v49
    v_rcp_f32 v50, v50
    v_rcp_f32 v51, v51
    v_rcp_f32 v52, v52
    v_rcp_f32 v53, v53
    v_rcp_f32 v54, v54
    v_rcp_f32 v55, v55
    v_rcp_f32 v56, v56
    v_rcp_f32 v57, v57
    v_rcp_f32 v58, v58
    v_rcp_f32 v59, v59
    v_rcp_f32 v60, v60
    v_rcp_f32 v61, v61
    v_rcp_f32 v62, v62
    v_rcp_f32 v63, v63
    v_mul_f32 v48, v80, v48
    v_mul_f32 v49, v81, v49
    v_mul_f32 v50, v82, v50
    v_mul_f32 v51, v83, v51
    v_mul_f32 v52, v84, v52
    v_mul_f32 v53, v85, v53
    v_mul_f32 v54, v86, v54
    v_mul_f32 v55, v87, v55
    v_mul_f32 v56, v88, v56
    v_mul_f32 v57, v89, v57
    v_mul_f32 v58, v90, v58
    v_mul_f32 v59, v91, v59
    v_mul_f32 v60, v92, v60
    v_mul_f32 v61, v93, v61
    v_mul_f32 v62, v94, v62
    v_mul_f32 v63, v95, v63
    v_cvt_pk_bf16_f32 v80, v48, v49
    v_cvt_pk_bf16_f32 v81, v50, v51
    v_cvt_pk_bf16_f32 v82, v52, v53
    v_cvt_pk_bf16_f32 v83, v54, v55
    v_cvt_pk_bf16_f32 v84, v56, v57
    v_cvt_pk_bf16_f32 v85, v58, v59
    v_cvt_pk_bf16_f32 v86, v60, v61
    v_cvt_pk_bf16_f32 v87, v62, v63
    ds_write_b128 v12, v[64:67] offset:0
    ds_write_b128 v12, v[68:71] offset:16
    ds_write_b128 v12, v[80:83] offset:32
    ds_write_b128 v12, v[84:87] offset:48
    s_lshl_b32 s27, s62, 12
    s_waitcnt lgkmcnt(0)
    ds_read_b128 v[48:51], v3 offset:0
    ds_read_b128 v[52:55], v3 offset:1152
    ds_read_b128 v[56:59], v3 offset:2304
    ds_read_b128 v[60:63], v3 offset:3456
    s_waitcnt lgkmcnt(3)
    buffer_store_dwordx4 v[48:51], v13, s[44:47], s27 offen offset:0 sc1
    s_waitcnt lgkmcnt(2)
    buffer_store_dwordx4 v[52:55], v13, s[44:47], s27 offen offset:1024 sc1
    s_waitcnt lgkmcnt(1)
    buffer_store_dwordx4 v[56:59], v13, s[44:47], s27 offen offset:2048 sc1
    s_waitcnt lgkmcnt(0)
    buffer_store_dwordx4 v[60:63], v13, s[44:47], s27 offen offset:3072 sc1
    v_mfma_f32_32x32x16_bf16 v[64:79], v[96:99], v[32:35], 0
    v_mfma_f32_32x32x16_bf16 v[64:79], v[100:103], v[36:39], v[64:79]
    v_mfma_f32_32x32x16_bf16 v[64:79], v[104:107], v[40:43], v[64:79]
    v_mfma_f32_32x32x16_bf16 v[64:79], v[108:111], v[44:47], v[64:79]
    v_mfma_f32_32x32x16_bf16 v[80:95], v[112:115], v[32:35], 0
    v_mfma_f32_32x32x16_bf16 v[80:95], v[116:119], v[36:39], v[80:95]
    v_mfma_f32_32x32x16_bf16 v[80:95], v[120:123], v[40:43], v[80:95]
    v_mfma_f32_32x32x16_bf16 v[80:95], v[124:127], v[44:47], v[80:95]
    s_nop 7
    v_cvt_pk_bf16_f32 v64, 0, v64
    v_cvt_pk_bf16_f32 v65, 0, v65
    v_cvt_pk_bf16_f32 v66, 0, v66
    v_cvt_pk_bf16_f32 v67, 0, v67
    v_cvt_pk_bf16_f32 v68, 0, v68
    v_cvt_pk_bf16_f32 v69, 0, v69
    v_cvt_pk_bf16_f32 v70, 0, v70
    v_cvt_pk_bf16_f32 v71, 0, v71
    v_cvt_pk_bf16_f32 v72, 0, v72
    v_cvt_pk_bf16_f32 v73, 0, v73
    v_cvt_pk_bf16_f32 v74, 0, v74
    v_cvt_pk_bf16_f32 v75, 0, v75
    v_cvt_pk_bf16_f32 v76, 0, v76
    v_cvt_pk_bf16_f32 v77, 0, v77
    v_cvt_pk_bf16_f32 v78, 0, v78
    v_cvt_pk_bf16_f32 v79, 0, v79
    v_mul_f32 v48, s60, v64
    v_mul_f32 v49, s60, v65
    v_mul_f32 v50, s60, v66
    v_mul_f32 v51, s60, v67
    v_mul_f32 v52, s60, v68
    v_mul_f32 v53, s60, v69
    v_mul_f32 v54, s60, v70
    v_mul_f32 v55, s60, v71
    v_mul_f32 v56, s60, v72
    v_mul_f32 v57, s60, v73
    v_mul_f32 v58, s60, v74
    v_mul_f32 v59, s60, v75
    v_mul_f32 v60, s60, v76
    v_mul_f32 v61, s60, v77
    v_mul_f32 v62, s60, v78
    v_mul_f32 v63, s60, v79
    v_exp_f32 v48, v48
    v_exp_f32 v49, v49
    v_exp_f32 v50, v50
    v_exp_f32 v51, v51
    v_exp_f32 v52, v52
    v_exp_f32 v53, v53
    v_exp_f32 v54, v54
    v_exp_f32 v55, v55
    v_exp_f32 v56, v56
    v_exp_f32 v57, v57
    v_exp_f32 v58, v58
    v_exp_f32 v59, v59
    v_exp_f32 v60, v60
    v_exp_f32 v61, v61
    v_exp_f32 v62, v62
    v_exp_f32 v63, v63
    v_add_f32 v48, 1.0, v48
    v_add_f32 v49, 1.0, v49
    v_add_f32 v50, 1.0, v50
    v_add_f32 v51, 1.0, v51
    v_add_f32 v52, 1.0, v52
    v_add_f32 v53, 1.0, v53
    v_add_f32 v54, 1.0, v54
    v_add_f32 v55, 1.0, v55
    v_add_f32 v56, 1.0, v56
    v_add_f32 v57, 1.0, v57
    v_add_f32 v58, 1.0, v58
    v_add_f32 v59, 1.0, v59
    v_add_f32 v60, 1.0, v60
    v_add_f32 v61, 1.0, v61
    v_add_f32 v62, 1.0, v62
    v_add_f32 v63, 1.0, v63
    v_rcp_f32 v48, v48
    v_rcp_f32 v49, v49
    v_rcp_f32 v50, v50
    v_rcp_f32 v51, v51
    v_rcp_f32 v52, v52
    v_rcp_f32 v53, v53
    v_rcp_f32 v54, v54
    v_rcp_f32 v55, v55
    v_rcp_f32 v56, v56
    v_rcp_f32 v57, v57
    v_rcp_f32 v58, v58
    v_rcp_f32 v59, v59
    v_rcp_f32 v60, v60
    v_rcp_f32 v61, v61
    v_rcp_f32 v62, v62
    v_rcp_f32 v63, v63
    v_mul_f32 v48, v64, v48
    v_mul_f32 v49, v65, v49
    v_mul_f32 v50, v66, v50
    v_mul_f32 v51, v67, v51
    v_mul_f32 v52, v68, v52
    v_mul_f32 v53, v69, v53
    v_mul_f32 v54, v70, v54
    v_mul_f32 v55, v71, v55
    v_mul_f32 v56, v72, v56
    v_mul_f32 v57, v73, v57
    v_mul_f32 v58, v74, v58
    v_mul_f32 v59, v75, v59
    v_mul_f32 v60, v76, v60
    v_mul_f32 v61, v77, v61
    v_mul_f32 v62, v78, v62
    v_mul_f32 v63, v79, v63
    v_cvt_pk_bf16_f32 v64, v48, v49
    v_cvt_pk_bf16_f32 v65, v50, v51
    v_cvt_pk_bf16_f32 v66, v52, v53
    v_cvt_pk_bf16_f32 v67, v54, v55
    v_cvt_pk_bf16_f32 v68, v56, v57
    v_cvt_pk_bf16_f32 v69, v58, v59
    v_cvt_pk_bf16_f32 v70, v60, v61
    v_cvt_pk_bf16_f32 v71, v62, v63
    v_cvt_pk_bf16_f32 v80, 0, v80
    v_cvt_pk_bf16_f32 v81, 0, v81
    v_cvt_pk_bf16_f32 v82, 0, v82
    v_cvt_pk_bf16_f32 v83, 0, v83
    v_cvt_pk_bf16_f32 v84, 0, v84
    v_cvt_pk_bf16_f32 v85, 0, v85
    v_cvt_pk_bf16_f32 v86, 0, v86
    v_cvt_pk_bf16_f32 v87, 0, v87
    v_cvt_pk_bf16_f32 v88, 0, v88
    v_cvt_pk_bf16_f32 v89, 0, v89
    v_cvt_pk_bf16_f32 v90, 0, v90
    v_cvt_pk_bf16_f32 v91, 0, v91
    v_cvt_pk_bf16_f32 v92, 0, v92
    v_cvt_pk_bf16_f32 v93, 0, v93
    v_cvt_pk_bf16_f32 v94, 0, v94
    v_cvt_pk_bf16_f32 v95, 0, v95
    v_mul_f32 v48, s60, v80
    v_mul_f32 v49, s60, v81
    v_mul_f32 v50, s60, v82
    v_mul_f32 v51, s60, v83
    v_mul_f32 v52, s60, v84
    v_mul_f32 v53, s60, v85
    v_mul_f32 v54, s60, v86
    v_mul_f32 v55, s60, v87
    v_mul_f32 v56, s60, v88
    v_mul_f32 v57, s60, v89
    v_mul_f32 v58, s60, v90
    v_mul_f32 v59, s60, v91
    v_mul_f32 v60, s60, v92
    v_mul_f32 v61, s60, v93
    v_mul_f32 v62, s60, v94
    v_mul_f32 v63, s60, v95
    v_exp_f32 v48, v48
    v_exp_f32 v49, v49
    v_exp_f32 v50, v50
    v_exp_f32 v51, v51
    v_exp_f32 v52, v52
    v_exp_f32 v53, v53
    v_exp_f32 v54, v54
    v_exp_f32 v55, v55
    v_exp_f32 v56, v56
    v_exp_f32 v57, v57
    v_exp_f32 v58, v58
    v_exp_f32 v59, v59
    v_exp_f32 v60, v60
    v_exp_f32 v61, v61
    v_exp_f32 v62, v62
    v_exp_f32 v63, v63
    v_add_f32 v48, 1.0, v48
    v_add_f32 v49, 1.0, v49
    v_add_f32 v50, 1.0, v50
    v_add_f32 v51, 1.0, v51
    v_add_f32 v52, 1.0, v52
    v_add_f32 v53, 1.0, v53
    v_add_f32 v54, 1.0, v54
    v_add_f32 v55, 1.0, v55
    v_add_f32 v56, 1.0, v56
    v_add_f32 v57, 1.0, v57
    v_add_f32 v58, 1.0, v58
    v_add_f32 v59, 1.0, v59
    v_add_f32 v60, 1.0, v60
    v_add_f32 v61, 1.0, v61
    v_add_f32 v62, 1.0, v62
    v_add_f32 v63, 1.0, v63
    v_rcp_f32 v48, v48
    v_rcp_f32 v49, v49
    v_rcp_f32 v50, v50
    v_rcp_f32 v51, v51
    v_rcp_f32 v52, v52
    v_rcp_f32 v53, v53
    v_rcp_f32 v54, v54
    v_rcp_f32 v55, v55
    v_rcp_f32 v56, v56
    v_rcp_f32 v57, v57
    v_rcp_f32 v58, v58
    v_rcp_f32 v59, v59
    v_rcp_f32 v60, v60
    v_rcp_f32 v61, v61
    v_rcp_f32 v62, v62
    v_rcp_f32 v63, v63
    v_mul_f32 v48, v80, v48
    v_mul_f32 v49, v81, v49
    v_mul_f32 v50, v82, v50
    v_mul_f32 v51, v83, v51
    v_mul_f32 v52, v84, v52
    v_mul_f32 v53, v85, v53
    v_mul_f32 v54, v86, v54
    v_mul_f32 v55, v87, v55
    v_mul_f32 v56, v88, v56
    v_mul_f32 v57, v89, v57
    v_mul_f32 v58, v90, v58
    v_mul_f32 v59, v91, v59
    v_mul_f32 v60, v92, v60
    v_mul_f32 v61, v93, v61
    v_mul_f32 v62, v94, v62
    v_mul_f32 v63, v95, v63
    v_cvt_pk_bf16_f32 v80, v48, v49
    v_cvt_pk_bf16_f32 v81, v50, v51
    v_cvt_pk_bf16_f32 v82, v52, v53
    v_cvt_pk_bf16_f32 v83, v54, v55
    v_cvt_pk_bf16_f32 v84, v56, v57
    v_cvt_pk_bf16_f32 v85, v58, v59
    v_cvt_pk_bf16_f32 v86, v60, v61
    v_cvt_pk_bf16_f32 v87, v62, v63
    ds_write_b128 v12, v[64:67] offset:0
    ds_write_b128 v12, v[68:71] offset:16
    ds_write_b128 v12, v[80:83] offset:32
    ds_write_b128 v12, v[84:87] offset:48
    s_lshl_b32 s27, s63, 12
    s_waitcnt lgkmcnt(0)
    ds_read_b128 v[48:51], v3 offset:0
    ds_read_b128 v[52:55], v3 offset:1152
    ds_read_b128 v[56:59], v3 offset:2304
    ds_read_b128 v[60:63], v3 offset:3456
    s_waitcnt lgkmcnt(3)
    buffer_store_dwordx4 v[48:51], v13, s[44:47], s27 offen offset:0 sc1
    s_waitcnt lgkmcnt(2)
    buffer_store_dwordx4 v[52:55], v13, s[44:47], s27 offen offset:1024 sc1
    s_waitcnt lgkmcnt(1)
    buffer_store_dwordx4 v[56:59], v13, s[44:47], s27 offen offset:2048 sc1
    s_waitcnt lgkmcnt(0)
    buffer_store_dwordx4 v[60:63], v13, s[44:47], s27 offen offset:3072 sc1
    s_cmp_ge_u32 s68, 1563
    s_nop 0
    s_cbranch_scc1 P_h2
    s_waitcnt vmcnt(8)
    v_mfma_f32_32x32x16_bf16 v[64:79], v[96:99], v[16:19], 0
    v_mfma_f32_32x32x16_bf16 v[64:79], v[100:103], v[20:23], v[64:79]
    v_mfma_f32_32x32x16_bf16 v[64:79], v[104:107], v[24:27], v[64:79]
    v_mfma_f32_32x32x16_bf16 v[64:79], v[108:111], v[28:31], v[64:79]
    v_mfma_f32_32x32x16_bf16 v[80:95], v[112:115], v[16:19], 0
    v_mfma_f32_32x32x16_bf16 v[80:95], v[116:119], v[20:23], v[80:95]
    v_mfma_f32_32x32x16_bf16 v[80:95], v[120:123], v[24:27], v[80:95]
    v_mfma_f32_32x32x16_bf16 v[80:95], v[124:127], v[28:31], v[80:95]
    s_nop 7
    v_cvt_pk_bf16_f32 v64, 0, v64
    v_cvt_pk_bf16_f32 v65, 0, v65
    v_cvt_pk_bf16_f32 v66, 0, v66
    v_cvt_pk_bf16_f32 v67, 0, v67
    v_cvt_pk_bf16_f32 v68, 0, v68
    v_cvt_pk_bf16_f32 v69, 0, v69
    v_cvt_pk_bf16_f32 v70, 0, v70
    v_cvt_pk_bf16_f32 v71, 0, v71
    v_cvt_pk_bf16_f32 v72, 0, v72
    v_cvt_pk_bf16_f32 v73, 0, v73
    v_cvt_pk_bf16_f32 v74, 0, v74
    v_cvt_pk_bf16_f32 v75, 0, v75
    v_cvt_pk_bf16_f32 v76, 0, v76
    v_cvt_pk_bf16_f32 v77, 0, v77
    v_cvt_pk_bf16_f32 v78, 0, v78
    v_cvt_pk_bf16_f32 v79, 0, v79
    v_mul_f32 v48, s60, v64
    v_mul_f32 v49, s60, v65
    v_mul_f32 v50, s60, v66
    v_mul_f32 v51, s60, v67
    v_mul_f32 v52, s60, v68
    v_mul_f32 v53, s60, v69
    v_mul_f32 v54, s60, v70
    v_mul_f32 v55, s60, v71
    v_mul_f32 v56, s60, v72
    v_mul_f32 v57, s60, v73
    v_mul_f32 v58, s60, v74
    v_mul_f32 v59, s60, v75
    v_mul_f32 v60, s60, v76
    v_mul_f32 v61, s60, v77
    v_mul_f32 v62, s60, v78
    v_mul_f32 v63, s60, v79
    v_exp_f32 v48, v48
    v_exp_f32 v49, v49
    v_exp_f32 v50, v50
    v_exp_f32 v51, v51
    v_exp_f32 v52, v52
    v_exp_f32 v53, v53
    v_exp_f32 v54, v54
    v_exp_f32 v55, v55
    v_exp_f32 v56, v56
    v_exp_f32 v57, v57
    v_exp_f32 v58, v58
    v_exp_f32 v59, v59
    v_exp_f32 v60, v60
    v_exp_f32 v61, v61
    v_exp_f32 v62, v62
    v_exp_f32 v63, v63
    v_add_f32 v48, 1.0, v48
    v_add_f32 v49, 1.0, v49
    v_add_f32 v50, 1.0, v50
    v_add_f32 v51, 1.0, v51
    v_add_f32 v52, 1.0, v52
    v_add_f32 v53, 1.0, v53
    v_add_f32 v54, 1.0, v54
    v_add_f32 v55, 1.0, v55
    v_add_f32 v56, 1.0, v56
    v_add_f32 v57, 1.0, v57
    v_add_f32 v58, 1.0, v58
    v_add_f32 v59, 1.0, v59
    v_add_f32 v60, 1.0, v60
    v_add_f32 v61, 1.0, v61
    v_add_f32 v62, 1.0, v62
    v_add_f32 v63, 1.0, v63
    v_rcp_f32 v48, v48
    v_rcp_f32 v49, v49
    v_rcp_f32 v50, v50
    v_rcp_f32 v51, v51
    v_rcp_f32 v52, v52
    v_rcp_f32 v53, v53
    v_rcp_f32 v54, v54
    v_rcp_f32 v55, v55
    v_rcp_f32 v56, v56
    v_rcp_f32 v57, v57
    v_rcp_f32 v58, v58
    v_rcp_f32 v59, v59
    v_rcp_f32 v60, v60
    v_rcp_f32 v61, v61
    v_rcp_f32 v62, v62
    v_rcp_f32 v63, v63
    v_mul_f32 v48, v64, v48
    v_mul_f32 v49, v65, v49
    v_mul_f32 v50, v66, v50
    v_mul_f32 v51, v67, v51
    v_mul_f32 v52, v68, v52
    v_mul_f32 v53, v69, v53
    v_mul_f32 v54, v70, v54
    v_mul_f32 v55, v71, v55
    v_mul_f32 v56, v72, v56
    v_mul_f32 v57, v73, v57
    v_mul_f32 v58, v74, v58
    v_mul_f32 v59, v75, v59
    v_mul_f32 v60, v76, v60
    v_mul_f32 v61, v77, v61
    v_mul_f32 v62, v78, v62
    v_mul_f32 v63, v79, v63
    v_cvt_pk_bf16_f32 v64, v48, v49
    v_cvt_pk_bf16_f32 v65, v50, v51
    v_cvt_pk_bf16_f32 v66, v52, v53
    v_cvt_pk_bf16_f32 v67, v54, v55
    v_cvt_pk_bf16_f32 v68, v56, v57
    v_cvt_pk_bf16_f32 v69, v58, v59
    v_cvt_pk_bf16_f32 v70, v60, v61
    v_cvt_pk_bf16_f32 v71, v62, v63
    v_cvt_pk_bf16_f32 v80, 0, v80
    v_cvt_pk_bf16_f32 v81, 0, v81
    v_cvt_pk_bf16_f32 v82, 0, v82
    v_cvt_pk_bf16_f32 v83, 0, v83
    v_cvt_pk_bf16_f32 v84, 0, v84
    v_cvt_pk_bf16_f32 v85, 0, v85
    v_cvt_pk_bf16_f32 v86, 0, v86
    v_cvt_pk_bf16_f32 v87, 0, v87
    v_cvt_pk_bf16_f32 v88, 0, v88
    v_cvt_pk_bf16_f32 v89, 0, v89
    v_cvt_pk_bf16_f32 v90, 0, v90
    v_cvt_pk_bf16_f32 v91, 0, v91
    v_cvt_pk_bf16_f32 v92, 0, v92
    v_cvt_pk_bf16_f32 v93, 0, v93
    v_cvt_pk_bf16_f32 v94, 0, v94
    v_cvt_pk_bf16_f32 v95, 0, v95
    v_mul_f32 v48, s60, v80
    v_mul_f32 v49, s60, v81
    v_mul_f32 v50, s60, v82
    v_mul_f32 v51, s60, v83
    v_mul_f32 v52, s60, v84
    v_mul_f32 v53, s60, v85
    v_mul_f32 v54, s60, v86
    v_mul_f32 v55, s60, v87
    v_mul_f32 v56, s60, v88
    v_mul_f32 v57, s60, v89
    v_mul_f32 v58, s60, v90
    v_mul_f32 v59, s60, v91
    v_mul_f32 v60, s60, v92
    v_mul_f32 v61, s60, v93
    v_mul_f32 v62, s60, v94
    v_mul_f32 v63, s60, v95
    v_exp_f32 v48, v48
    v_exp_f32 v49, v49
    v_exp_f32 v50, v50
    v_exp_f32 v51, v51
    v_exp_f32 v52, v52
    v_exp_f32 v53, v53
    v_exp_f32 v54, v54
    v_exp_f32 v55, v55
    v_exp_f32 v56, v56
    v_exp_f32 v57, v57
    v_exp_f32 v58, v58
    v_exp_f32 v59, v59
    v_exp_f32 v60, v60
    v_exp_f32 v61, v61
    v_exp_f32 v62, v62
    v_exp_f32 v63, v63
    v_add_f32 v48, 1.0, v48
    v_add_f32 v49, 1.0, v49
    v_add_f32 v50, 1.0, v50
    v_add_f32 v51, 1.0, v51
    v_add_f32 v52, 1.0, v52
    v_add_f32 v53, 1.0, v53
    v_add_f32 v54, 1.0, v54
    v_add_f32 v55, 1.0, v55
    v_add_f32 v56, 1.0, v56
    v_add_f32 v57, 1.0, v57
    v_add_f32 v58, 1.0, v58
    v_add_f32 v59, 1.0, v59
    v_add_f32 v60, 1.0, v60
    v_add_f32 v61, 1.0, v61
    v_add_f32 v62, 1.0, v62
    v_add_f32 v63, 1.0, v63
    v_rcp_f32 v48, v48
    v_rcp_f32 v49, v49
    v_rcp_f32 v50, v50
    v_rcp_f32 v51, v51
    v_rcp_f32 v52, v52
    v_rcp_f32 v53, v53
    v_rcp_f32 v54, v54
    v_rcp_f32 v55, v55
    v_rcp_f32 v56, v56
    v_rcp_f32 v57, v57
    v_rcp_f32 v58, v58
    v_rcp_f32 v59, v59
    v_rcp_f32 v60, v60
    v_rcp_f32 v61, v61
    v_rcp_f32 v62, v62
    v_rcp_f32 v63, v63
    v_mul_f32 v48, v80, v48
    v_mul_f32 v49, v81, v49
    v_mul_f32 v50, v82, v50
    v_mul_f32 v51, v83, v51
    v_mul_f32 v52, v84, v52
    v_mul_f32 v53, v85, v53
    v_mul_f32 v54, v86, v54
    v_mul_f32 v55, v87, v55
    v_mul_f32 v56, v88, v56
    v_mul_f32 v57, v89, v57
    v_mul_f32 v58, v90, v58
    v_mul_f32 v59, v91, v59
    v_mul_f32 v60, v92, v60
    v_mul_f32 v61, v93, v61
    v_mul_f32 v62, v94, v62
    v_mul_f32 v63, v95, v63
    v_cvt_pk_bf16_f32 v80, v48, v49
    v_cvt_pk_bf16_f32 v81, v50, v51
    v_cvt_pk_bf16_f32 v82, v52, v53
    v_cvt_pk_bf16_f32 v83, v54, v55
    v_cvt_pk_bf16_f32 v84, v56, v57
    v_cvt_pk_bf16_f32 v85, v58, v59
    v_cvt_pk_bf16_f32 v86, v60, v61
    v_cvt_pk_bf16_f32 v87, v62, v63
    ds_write_b128 v12, v[64:67] offset:0
    ds_write_b128 v12, v[68:71] offset:16
    ds_write_b128 v12, v[80:83] offset:32
    ds_write_b128 v12, v[84:87] offset:48
    s_lshl_b32 s27, s68, 12
    s_waitcnt lgkmcnt(0)
    ds_read_b128 v[48:51], v3 offset:0
    ds_read_b128 v[52:55], v3 offset:1152
    ds_read_b128 v[56:59], v3 offset:2304
    ds_read_b128 v[60:63], v3 offset:3456
    s_waitcnt lgkmcnt(3)
    buffer_store_dwordx4 v[48:51], v13, s[44:47], s27 offen offset:0 sc1
    s_waitcnt lgkmcnt(2)
    buffer_store_dwordx4 v[52:55], v13, s[44:47], s27 offen offset:1024 sc1
    s_waitcnt lgkmcnt(1)
    buffer_store_dwordx4 v[56:59], v13, s[44:47], s27 offen offset:2048 sc1
    s_waitcnt lgkmcnt(0)
    buffer_store_dwordx4 v[60:63], v13, s[44:47], s27 offen offset:3072 sc1
    s_nop 1
P_h2:
    s_cmp_eq_u32 s77, 0
    s_cbranch_scc1 P_h3
    v_perm_b32 v48, v5, v4, s56
    v_perm_b32 v52, v5, v4, s57
    v_perm_b32 v49, v7, v6, s56
    v_perm_b32 v53, v7, v6, s57
    v_perm_b32 v50, v9, v8, s56
    v_perm_b32 v54, v9, v8, s57
    v_perm_b32 v51, v11, v10, s56
    v_perm_b32 v55, v11, v10, s57
    buffer_store_dwordx4 v[48:51], v13, s[48:51], s75 offen sc1
    s_add_u32 s75, s75, s76
    buffer_store_dwordx4 v[52:55], v13, s[48:51], s75 offen sc1
    s_nop 1
P_h3:
    s_setprio 0
P_noedge3:
    v_lshrrev_b32 v70, 3, v0
    v_and_b32 v71, 7, v0
    v_lshlrev_b32 v72, 8, v70
    v_lshl_add_u32 v72, v71, 4, v72
    v_add_u32 v72, 53248, v72
    v_lshlrev_b32 v73, 2, v70
    v_add_u32 v73, 155152, v73
    v_mul_u32_u24 v84, 11, v71
    v_lshrrev_b32 v84, 5, v84
    v_mul_u32_u24 v84, 3, v84
    v_sub_u32 v84, v71, v84
    v_mov_b32 v85, -1
    v_mov_b32 v86, 0x00ffffff
    v_cmp_eq_u32 vcc, 0, v84
    s_nop 1
    v_cndmask_b32 v96, v85, v86, vcc
    v_cndmask_b32 v99, v85, v86, vcc
    v_cmp_eq_u32 vcc, 2, v84
    s_nop 1
    v_cndmask_b32 v97, v85, v86, vcc
    v_cmp_eq_u32 vcc, 1, v84
    s_nop 1
    v_cndmask_b32 v98, v85, v86, vcc
    v_cmp_eq_u32 s[68:69], 7, v71
    s_nop 1
    v_cndmask_b32 v98, v98, v85, s[68:69]
    v_cndmask_b32 v99, v99, 0, s[68:69]
    v_lshlrev_b32 v85, 4, v0
    s_lshl_b32 s27, s2, 15
    s_add_u32 s59, s27, 16384
    v_cmp_gt_u32 vcc, 984, v0
    s_mov_b64 s[70:71], vcc
    s_waitcnt lgkmcnt(0)
    s_barrier
    ds_read_b32 v74, v73
    ds_read_b128 v[76:79], v72
    ds_read_b32 v75, v73 offset:512
    ds_read_b128 v[80:83], v72 offset:32768
    s_mov_b64 s[60:61], exec
    s_waitcnt lgkmcnt(3)
    v_min_u32 v88, 0xff, v74
    v_lshlrev_b32 v88, 24, v88
    v_cndmask_b32 v89, v88, v74, s[68:69]
    s_waitcnt lgkmcnt(2)
    v_bfi_b32 v76, v96, v76, v88
    v_bfi_b32 v77, v97, v77, v88
    v_bfi_b32 v78, v98, v78, v88
    v_bfi_b32 v79, v99, v79, v89
    buffer_store_dwordx4 v[76:79], v85, s[48:51], s27 offen sc1
    s_waitcnt lgkmcnt(1)
    v_min_u32 v92, 0xff, v75
    v_lshlrev_b32 v92, 24, v92
    v_cndmask_b32 v93, v92, v75, s[68:69]
    s_waitcnt lgkmcnt(0)
    v_bfi_b32 v80, v96, v80, v92
    v_bfi_b32 v81, v97, v81, v92
    v_bfi_b32 v82, v98, v82, v92
    v_bfi_b32 v83, v99, v83, v93
    s_mov_b64 exec, s[70:71]
    s_nop 0
    s_cbranch_execz P_c1
    buffer_store_dwordx4 v[80:83], v85, s[48:51], s59 offen sc1
    s_nop 1
P_c1:
    s_mov_b64 exec, s[60:61]
    v_cmp_lt_u32 s[62:63], 10, v74
    v_cmp_lt_u32 s[64:65], 10, v75
    v_cmp_gt_u32 vcc, 976, v0
    s_and_b64 s[64:65], s[64:65], vcc
    s_or_b64 s[66:67], s[62:63], s[64:65]
    s_cmp_eq_u64 s[66:67], 0
    s_nop 1
    s_cbranch_scc1 P_fin
    ds_read_b128 v[76:79], v72 offset:128
    ds_read_b128 v[80:83], v72 offset:32896
    s_add_u32 s27, s27, 0x900000
    s_add_u32 s59, s59, 0x900000
    s_waitcnt lgkmcnt(0)
    s_mov_b64 exec, s[62:63]
    s_cbranch_execz P_c2
    buffer_store_dwordx4 v[76:79], v85, s[48:51], s27 offen
    s_nop 1
P_c2:
    s_mov_b64 exec, s[64:65]
    s_cbranch_execz P_c3
    buffer_store_dwordx4 v[80:83], v85, s[48:51], s59 offen
    s_nop 1
P_c3:
    s_mov_b64 exec, s[60:61]
P_fin:
P_end:
    s_endpgm
.globl main_kernel
.p2align 8
.type main_kernel,@function
main_kernel:
    s_cmp_ge_u32 s2, 250
    s_cbranch_scc1 M_end
    s_load_dwordx2 s[4:5], s[0:1], 0
    s_load_dwordx2 s[12:13], s[0:1], 32
    s_load_dwordx2 s[20:21], s[0:1], 64
    s_load_dwordx2 s[24:25], s[0:1], 80
    v_and_b32 v8, 63, v0
    v_lshrrev_b32 v9, 6, v0
    v_lshlrev_b32 v1, 4, v8
    v_readfirstlane_b32 s26, v9
    v_lshrrev_b32 v10, 5, v8
    v_and_b32 v11, 31, v8
    s_mov_b32 s58, 0xffff0000
    s_mov_b32 s61, 0x3e22f983
    s_movk_i32 s63, 0x70
    s_movk_i32 s64, 128
    s_movk_i32 s65, 256
    s_movk_i32 s66, 384
    s_mul_i32 s44, s2, 102400
    s_mul_i32 s51, s26, 12800
    s_add_u32 s51, s51, 30720
    s_mul_i32 s52, s26, 3840
    s_add_u32 s52, s52, 133120
    s_mov_b32 s67, 120320
    v_mul_u32_u24 v12, 205, v8
    v_lshrrev_b32 v12, 11, v12
    v_mul_u32_u24 v13, 10, v12
    v_sub_u32 v24, v8, v13
    s_mul_i32 s27, s26, 6
    v_add_u32 v13, s27, v12
    v_bfrev_b32 v14, 2
    v_mul_u32_u24 v15, 12, v24
    v_lshl_add_u32 v25, v13, 15, v15
    v_cmp_gt_u32 vcc, 60, v8
    s_nop 1
    v_cndmask_b32 v25, v14, v25, vcc
    v_cmp_gt_u32 vcc, 10, v13
    s_nop 1
    v_cndmask_b32 v26, v14, v25, vcc
    s_lshl_b32 s27, s2, 7
    v_lshlrev_b32 v15, 1, v8
    v_mov_b32 v19, 0
    v_lshlrev_b32 v20, 2, v8
    v_add_u32 v30, 132864, v20
    v_mov_b32 v9, 132672
    ds_write_b32 v30, v19
    ds_write_b32 v9, v19
    s_mov_b32 s3, 132864
    v_mov_b32 v18, 0xfc
    s_waitcnt lgkmcnt(0)
    s_mov_b32 s36, s24
    s_mov_b32 s37, s25
    s_mov_b32 s38, 0x241b000
    s_mov_b32 s39, 0x00020000
    buffer_load_dwordx3 v[64:66], v25, s[36:39], s27 offen
    s_add_u32 s27, s27, 1572864
    buffer_load_dwordx3 v[68:70], v25, s[36:39], s27 offen
    s_add_u32 s27, s27, 1572864
    buffer_load_dwordx3 v[72:74], v25, s[36:39], s27 offen
    s_add_u32 s27, s27, 1572864
    buffer_load_dwordx3 v[76:78], v25, s[36:39], s27 offen
    s_add_u32 s27, s27, 1572864
    buffer_load_dwordx3 v[80:82], v25, s[36:39], s27 offen
    s_add_u32 s27, s27, 1572864
    buffer_load_dwordx3 v[84:86], v26, s[36:39], s27 offen
    s_mov_b32 s68, s12
    s_mov_b32 s69, s13
    s_mov_b32 s70, 0x20
    s_mov_b32 s71, 0x00020000
    buffer_load_ushort v21, v15, s[68:71], 0 offen
    s_mov_b32 s28, s4
    s_mov_b32 s29, s5
    s_mov_b32 s30, 0x186a000
    s_mov_b32 s31, 0x00020000
    s_mov_b32 s32, s20
    s_mov_b32 s33, s21
    s_mov_b32 s34, 0x186a000
    s_mov_b32 s35, 0x00020000
    s_add_u32 s72, s24, 0x1e00000
    s_addc_u32 s73, s25, 0
    s_mov_b32 s74, 0x61b000
    s_mov_b32 s75, 0x00020000
    s_mov_b32 s6, 25600000
    s_mov_b32 s7, 0x00020000
    s_barrier
    v_lshrrev_b32 v17, 4, v8
    v_lshlrev_b32 v17, 9, v17
    v_and_b32 v16, 15, v8
    v_lshl_or_b32 v17, v16, 4, v17
    s_lshl_b32 s45, s26, 10
    s_add_u32 s45, s45, 30720
    s_lshl_b32 s46, s26, 11
    s_add_u32 s46, s46, s44
    s_lshl_b32 s27, s26, 10
    s_mov_b32 m0, s27
    s_add_u32 s53, s27, 0x800000
    buffer_load_dwordx4 v1, s[36:39], s53 offen lds
    s_lshl_b32 s27, s26, 10
    s_add_u32 s27, s27, 8192
    s_mov_b32 m0, s27
    s_add_u32 s53, s27, 0x800000
    buffer_load_dwordx4 v1, s[36:39], s53 offen lds
    s_lshl_b32 s27, s26, 10
    s_add_u32 s27, s27, 16384
    s_mov_b32 m0, s27
    s_add_u32 s53, s27, 0x800000
    buffer_load_dwordx4 v1, s[36:39], s53 offen lds
    s_lshl_b32 s27, s26, 10
    s_add_u32 s27, s27, 24576
    s_min_u32 s27, s27, 29696
    s_mov_b32 m0, s27
    s_add_u32 s53, s27, 0x800000
    buffer_load_dwordx4 v1, s[36:39], s53 offen lds
    s_add_u32 m0, s45, 0
    s_add_u32 s53, s46, 0
    buffer_load_dwordx4 v17, s[28:31], s53 offen  lds
    s_add_u32 m0, s45, 8192
    s_add_u32 s53, s46, 16384
    buffer_load_dwordx4 v17, s[28:31], s53 offen  lds
    s_add_u32 m0, s45, 16384
    s_add_u32 s53, s46, 32768
    buffer_load_dwordx4 v17, s[28:31], s53 offen  lds
    s_add_u32 m0, s45, 24576
    s_add_u32 s53, s46, 49152
    buffer_load_dwordx4 v17, s[28:31], s53 offen  lds
    s_add_u32 m0, s45, 32768
    s_add_u32 s53, s46, 65536
    buffer_load_dwordx4 v17, s[28:31], s53 offen  lds
    s_add_u32 m0, s45, 40960
    s_add_u32 s53, s46, 81920
    buffer_load_dwordx4 v17, s[28:31], s53 offen  lds
    s_cmp_ge_u32 s26, 2
    s_cbranch_scc1 M_rs7
    s_add_u32 m0, s45, 49152
    s_add_u32 s53, s46, 98304
    buffer_load_dwordx4 v17, s[28:31], s53 offen  lds
M_rs7:
    s_lshl_b32 s27, s26, 6
    v_add_u32 v12, s27, v8
    v_lshrrev_b32 v13, 1, v12
    v_and_b32 v12, 1, v12
    v_lshlrev_b32 v13, 9, v13
    v_lshl_add_u32 v13, v12, 7, v13
    v_cmp_gt_u32 vcc, 102400, v13
    s_nop 1
    v_cndmask_b32 v171, v14, v13, vcc
    v_mov_b32 v192, 0
    v_mov_b32 v193, 0
    v_mov_b32 v194, 0
    v_mov_b32 v195, 0
    v_mov_b32 v196, 0
    v_mov_b32 v197, 0
    v_mov_b32 v198, 0
    v_mov_b32 v199, 0
    v_mov_b32 v200, 0
    v_mov_b32 v201, 0
    v_mov_b32 v202, 0
    v_mov_b32 v203, 0
    v_mov_b32 v204, 0
    v_mov_b32 v205, 0
    v_mov_b32 v206, 0
    v_mov_b32 v207, 0
    v_mov_b32 v208, 0
    v_mov_b32 v209, 0
    v_mov_b32 v210, 0
    v_mov_b32 v211, 0
    v_mov_b32 v212, 0
    v_mov_b32 v213, 0
    v_mov_b32 v214, 0
    v_mov_b32 v215, 0
    v_mov_b32 v216, 0
    v_mov_b32 v217, 0
    v_mov_b32 v218, 0
    v_mov_b32 v219, 0
    v_mov_b32 v220, 0
    v_mov_b32 v221, 0
    v_mov_b32 v222, 0
    v_mov_b32 v223, 0
    v_mov_b32 v224, 0
    v_mov_b32 v225, 0
    v_mov_b32 v226, 0
    v_mov_b32 v227, 0
    v_mov_b32 v228, 0
    v_mov_b32 v229, 0
    v_mov_b32 v230, 0
    v_mov_b32 v231, 0
    v_mov_b32 v232, 0
    v_mov_b32 v233, 0
    v_mov_b32 v234, 0
    v_mov_b32 v235, 0
    v_mov_b32 v236, 0
    v_mov_b32 v237, 0
    v_mov_b32 v238, 0
    v_mov_b32 v239, 0
    v_mov_b32 v240, 0
    v_mov_b32 v241, 0
    v_mov_b32 v242, 0
    v_mov_b32 v243, 0
    v_mov_b32 v244, 0
    v_mov_b32 v245, 0
    v_mov_b32 v246, 0
    v_mov_b32 v247, 0
    v_mov_b32 v248, 0
    v_mov_b32 v249, 0
    v_mov_b32 v250, 0
    v_mov_b32 v251, 0
    v_mov_b32 v252, 0
    v_mov_b32 v253, 0
    v_mov_b32 v254, 0
    v_mov_b32 v255, 0
    v_lshrrev_b32 v8, 4, v1
    v_lshrrev_b32 v10, 5, v8
    v_and_b32 v11, 31, v8
    v_lshlrev_b32 v3, 4, v11
    v_add_u32 v3, s52, v3
    v_mul_u32_u24 v0, 56, v10
    v_add_u32 v0, s52, v0
    v_lshrrev_b32 v13, 3, v11
    v_lshl_add_u32 v4, v13, 3, v0
    v_lshrrev_b32 v13, 3, v8
    v_and_b32 v14, 1, v13
    v_lshrrev_b32 v13, 1, v13
    v_lshl_add_u32 v13, v14, 2, v13
    v_lshlrev_b32 v5, 4, v13
    v_add_u32 v5, s52, v5
    v_add_u32 v16, s52, v1
    v_lshrrev_b32 v17, 2, v8
    v_mul_u32_u24 v17, 56, v17
    v_and_b32 v13, 3, v8
    v_lshl_add_u32 v17, v13, 1, v17
    v_add_u32 v17, s52, v17
    v_lshlrev_b32 v2, 7, v10
    v_lshl_add_u32 v2, v11, 2, v2
    v_add_u32 v2, s51, v2
    v_and_b32 v13, 7, v11
    v_lshlrev_b32 v13, 1, v13
    v_sub_u32 v13, 14, v13
    v_lshl_or_b32 v6, v13, 16, v13
    v_lshlrev_b32 v7, 5, v10
    v_add_u32 v7, 132608, v7
    v_add_u32 v27, 132608, v20
    s_waitcnt vmcnt(10)
    buffer_load_dword v170, v171, s[28:31], s44 offen offset:256
    v_lshlrev_b32 v31, 16, v21
    v_mov_b32 v19, 1
    s_mov_b64 exec, 0xffff
    ds_write_b32 v27, v31
    s_mov_b64 exec, -1
    v_lshrrev_b32 v67, 24, v64
    v_cmp_gt_u32 s[8:9], v67, v24
    v_lshrrev_b32 v96, 16, v64
    v_lshrrev_b32 v120, 13, v64
    v_and_b32 v120, 16, v120
    v_lshlrev_b32 v112, v120, v19
    v_and_or_b32 v96, v96, v18, s3
    s_mov_b64 exec, s[8:9]
    s_nop 0
    s_cbranch_execz M_sa8
    ds_add_rtn_u32 v112, v96, v112
M_sa8:
    s_mov_b64 exec, -1
    v_lshrrev_b32 v71, 24, v68
    v_cmp_gt_u32 s[10:11], v71, v24
    v_lshrrev_b32 v97, 16, v68
    v_lshrrev_b32 v121, 13, v68
    v_and_b32 v121, 16, v121
    v_lshlrev_b32 v113, v121, v19
    v_and_or_b32 v97, v97, v18, s3
    s_mov_b64 exec, s[10:11]
    s_nop 0
    s_cbranch_execz M_sa9
    ds_add_rtn_u32 v113, v97, v113
M_sa9:
    s_mov_b64 exec, -1
    v_lshrrev_b32 v75, 24, v72
    v_cmp_gt_u32 s[14:15], v75, v24
    v_lshrrev_b32 v98, 16, v72
    v_lshrrev_b32 v122, 13, v72
    v_and_b32 v122, 16, v122
    v_lshlrev_b32 v114, v122, v19
    v_and_or_b32 v98, v98, v18, s3
    s_mov_b64 exec, s[14:15]
    s_nop 0
    s_cbranch_execz M_sa10
    ds_add_rtn_u32 v114, v98, v114
M_sa10:
    s_mov_b64 exec, -1
    v_lshrrev_b32 v79, 24, v76
    v_cmp_gt_u32 s[16:17], v79, v24
    v_lshrrev_b32 v99, 16, v76
    v_lshrrev_b32 v123, 13, v76
    v_and_b32 v123, 16, v123
    v_lshlrev_b32 v115, v123, v19
    v_and_or_b32 v99, v99, v18, s3
    s_mov_b64 exec, s[16:17]
    s_nop 0
    s_cbranch_execz M_sa11
    ds_add_rtn_u32 v115, v99, v115
M_sa11:
    s_mov_b64 exec, -1
    v_lshrrev_b32 v83, 24, v80
    v_cmp_gt_u32 s[18:19], v83, v24
    v_lshrrev_b32 v100, 16, v80
    v_lshrrev_b32 v124, 13, v80
    v_and_b32 v124, 16, v124
    v_lshlrev_b32 v116, v124, v19
    v_and_or_b32 v100, v100, v18, s3
    s_mov_b64 exec, s[18:19]
    s_nop 0
    s_cbranch_execz M_sa12
    ds_add_rtn_u32 v116, v100, v116
M_sa12:
    s_mov_b64 exec, -1
    v_lshrrev_b32 v87, 24, v84
    v_cmp_gt_u32 s[22:23], v87, v24
    v_lshrrev_b32 v101, 16, v84
    v_lshrrev_b32 v125, 13, v84
    v_and_b32 v125, 16, v125
    v_lshlrev_b32 v117, v125, v19
    v_and_or_b32 v101, v101, v18, s3
    s_mov_b64 exec, s[22:23]
    s_nop 0
    s_cbranch_execz M_sa13
    ds_add_rtn_u32 v117, v101, v117
M_sa13:
    s_mov_b64 exec, -1
    v_max3_u32 v22, v67, v71, v75
    v_max3_u32 v23, v79, v83, v87
    v_max_u32 v22, v22, v23
    v_cmp_lt_u32 s[54:55], 10, v22
    v_add_u32 v23, 10, v24
    s_cmp_lg_u64 s[54:55], 0
    s_cselect_b32 s60, 1, 0
    s_nop 1
    s_cbranch_scc0 M_nomed
    s_lshl_b32 s27, s2, 7
    s_add_u32 s27, s27, 0x900000
    buffer_load_dwordx3 v[128:130], v25, s[36:39], s27 offen
    s_add_u32 s27, s27, 1572864
    buffer_load_dwordx3 v[132:134], v25, s[36:39], s27 offen
    s_add_u32 s27, s27, 1572864
    buffer_load_dwordx3 v[136:138], v25, s[36:39], s27 offen
    s_add_u32 s27, s27, 1572864
    buffer_load_dwordx3 v[140:142], v25, s[36:39], s27 offen
    s_add_u32 s27, s27, 1572864
    buffer_load_dwordx3 v[144:146], v25, s[36:39], s27 offen
    s_add_u32 s27, s27, 1572864
    buffer_load_dwordx3 v[148:150], v26, s[36:39], s27 offen
    s_waitcnt vmcnt(0)
    v_cmp_gt_u32 s[56:57], v67, v23
    v_cmp_gt_u32 vcc, 60, v8
    s_and_b64 s[56:57], s[56:57], vcc
    v_lshrrev_b32 v152, 16, v128
    v_lshrrev_b32 v160, 13, v128
    v_and_b32 v160, 16, v160
    v_lshlrev_b32 v131, v160, v19
    v_and_or_b32 v152, v152, v18, s3
    s_mov_b64 exec, s[56:57]
    s_nop 0
    s_cbranch_execz M_sa14
    ds_add_rtn_u32 v131, v152, v131
M_sa14:
    s_mov_b64 exec, -1
    v_cmp_gt_u32 s[56:57], v71, v23
    v_cmp_gt_u32 vcc, 60, v8
    s_and_b64 s[56:57], s[56:57], vcc
    v_lshrrev_b32 v153, 16, v132
    v_lshrrev_b32 v161, 13, v132
    v_and_b32 v161, 16, v161
    v_lshlrev_b32 v135, v161, v19
    v_and_or_b32 v153, v153, v18, s3
    s_mov_b64 exec, s[56:57]
    s_nop 0
    s_cbranch_execz M_sa15
    ds_add_rtn_u32 v135, v153, v135
M_sa15:
    s_mov_b64 exec, -1
    v_cmp_gt_u32 s[56:57], v75, v23
    v_cmp_gt_u32 vcc, 60, v8
    s_and_b64 s[56:57], s[56:57], vcc
    v_lshrrev_b32 v154, 16, v136
    v_lshrrev_b32 v162, 13, v136
    v_and_b32 v162, 16, v162
    v_lshlrev_b32 v139, v162, v19
    v_and_or_b32 v154, v154, v18, s3
    s_mov_b64 exec, s[56:57]
    s_nop 0
    s_cbranch_execz M_sa16
    ds_add_rtn_u32 v139, v154, v139
M_sa16:
    s_mov_b64 exec, -1
    v_cmp_gt_u32 s[56:57], v79, v23
    v_cmp_gt_u32 vcc, 60, v8
    s_and_b64 s[56:57], s[56:57], vcc
    v_lshrrev_b32 v155, 16, v140
    v_lshrrev_b32 v163, 13, v140
    v_and_b32 v163, 16, v163
    v_lshlrev_b32 v143, v163, v19
    v_and_or_b32 v155, v155, v18, s3
    s_mov_b64 exec, s[56:57]
    s_nop 0
    s_cbranch_execz M_sa17
    ds_add_rtn_u32 v143, v155, v143
M_sa17:
    s_mov_b64 exec, -1
    v_cmp_gt_u32 s[56:57], v83, v23
    v_cmp_gt_u32 vcc, 60, v8
    s_and_b64 s[56:57], s[56:57], vcc
    v_lshrrev_b32 v156, 16, v144
    v_lshrrev_b32 v164, 13, v144
    v_and_b32 v164, 16, v164
    v_lshlrev_b32 v147, v164, v19
    v_and_or_b32 v156, v156, v18, s3
    s_mov_b64 exec, s[56:57]
    s_nop 0
    s_cbranch_execz M_sa18
    ds_add_rtn_u32 v147, v156, v147
M_sa18:
    s_mov_b64 exec, -1
    v_cmp_gt_u32 s[56:57], v87, v23
    v_cmp_gt_u32 vcc, 60, v8
    s_and_b64 s[56:57], s[56:57], vcc
    v_lshrrev_b32 v157, 16, v148
    v_lshrrev_b32 v165, 13, v148
    v_and_b32 v165, 16, v165
    v_lshlrev_b32 v151, v165, v19
    v_and_or_b32 v157, v157, v18, s3
    s_mov_b64 exec, s[56:57]
    s_nop 0
    s_cbranch_execz M_sa19
    ds_add_rtn_u32 v151, v157, v151
M_sa19:
    s_mov_b64 exec, -1
    v_cmp_lt_u32 vcc, 20, v22
    s_mov_b64 exec, vcc
    s_nop 3
    s_cbranch_execz M_md7
    ds_write_b32 v9, v19
M_md7:
    s_mov_b64 exec, -1
M_nomed:
    s_waitcnt lgkmcnt(0)
    s_barrier
    ds_read_b32 v28, v30
    ds_read_b32 v13, v9
    s_waitcnt lgkmcnt(1)
    v_and_b32 v31, 0xffff, v28
    v_lshrrev_b32 v28, 16, v28
    v_add_u32 v28, v28, v31
    v_mov_b32 v29, v28
    s_nop 1
    v_add_u32_dpp v29, v29, v29 row_shr:1 row_mask:0xf bank_mask:0xf bound_ctrl:0
    s_nop 1
    v_add_u32_dpp v29, v29, v29 row_shr:2 row_mask:0xf bank_mask:0xf bound_ctrl:0
    s_nop 1
    v_add_u32_dpp v29, v29, v29 row_shr:4 row_mask:0xf bank_mask:0xf bound_ctrl:0
    s_nop 1
    v_add_u32_dpp v29, v29, v29 row_shr:8 row_mask:0xf bank_mask:0xf bound_ctrl:0
    s_nop 1
    v_add_u32_dpp v29, v29, v29 row_bcast:15 row_mask:0xa bank_mask:0xf
    s_nop 1
    v_add_u32_dpp v29, v29, v29 row_bcast:31 row_mask:0xc bank_mask:0xf
    v_sub_u32 v28, v29, v28
    v_add_u32 v31, v28, v31
    v_lshl_or_b32 v28, v31, 16, v28
    ds_bpermute_b32 v104, v96, v28
    ds_bpermute_b32 v105, v97, v28
    ds_bpermute_b32 v106, v98, v28
    ds_bpermute_b32 v107, v99, v28
    ds_bpermute_b32 v108, v100, v28
    ds_bpermute_b32 v109, v101, v28
    v_readlane_b32 s62, v29, 63
    s_mov_b32 s54, 0
    s_mov_b32 s55, 0
    s_xor_b32 s12, s26, 4
    s_cmp_gt_u32 s62, 480
    s_cselect_b32 s27, 96, 64
    v_cmp_ge_u32 vcc, s27, v29
    v_cmp_ge_u32 s[70:71], s27, v31
    s_bcnt1_i32_b64 s56, vcc
    s_bcnt1_i32_b64 s57, s[70:71]
    s_add_u32 s56, s56, s57
    s_min_u32 s56, s56, 16
    s_lshr_b32 s27, s56, 1
    s_and_b32 s69, s56, 1
    v_readlane_b32 s57, v28, s27
    s_lshl4_add_u32 s69, s69, 0x100000
    s_bfe_u32 s57, s57, s69
    s_waitcnt lgkmcnt(0)
    v_readfirstlane_b32 s46, v13
    v_add_u32 v104, v104, v112
    v_bfe_u32 v104, v104, v120, 16
    v_cmp_gt_u32 vcc, 768, v104
    v_lshl_add_u32 v104, v104, 4, s67
    s_and_b64 exec, vcc, s[8:9]
    s_nop 2
    s_cbranch_execz M_sb20
    ds_write_b96 v104, v[64:66]
M_sb20:
    s_mov_b64 exec, -1
    v_add_u32 v105, v105, v113
    v_bfe_u32 v105, v105, v121, 16
    v_cmp_gt_u32 vcc, 768, v105
    v_lshl_add_u32 v105, v105, 4, s67
    s_and_b64 exec, vcc, s[10:11]
    s_nop 2
    s_cbranch_execz M_sb21
    ds_write_b96 v105, v[68:70]
M_sb21:
    s_mov_b64 exec, -1
    v_add_u32 v106, v106, v114
    v_bfe_u32 v106, v106, v122, 16
    v_cmp_gt_u32 vcc, 768, v106
    v_lshl_add_u32 v106, v106, 4, s67
    s_and_b64 exec, vcc, s[14:15]
    s_nop 2
    s_cbranch_execz M_sb22
    ds_write_b96 v106, v[72:74]
M_sb22:
    s_mov_b64 exec, -1
    v_add_u32 v107, v107, v115
    v_bfe_u32 v107, v107, v123, 16
    v_cmp_gt_u32 vcc, 768, v107
    v_lshl_add_u32 v107, v107, 4, s67
    s_and_b64 exec, vcc, s[16:17]
    s_nop 2
    s_cbranch_execz M_sb23
    ds_write_b96 v107, v[76:78]
M_sb23:
    s_mov_b64 exec, -1
    v_add_u32 v108, v108, v116
    v_bfe_u32 v108, v108, v124, 16
    v_cmp_gt_u32 vcc, 768, v108
    v_lshl_add_u32 v108, v108, 4, s67
    s_and_b64 exec, vcc, s[18:19]
    s_nop 2
    s_cbranch_execz M_sb24
    ds_write_b96 v108, v[80:82]
M_sb24:
    s_mov_b64 exec, -1
    v_add_u32 v109, v109, v117
    v_bfe_u32 v109, v109, v125, 16
    v_cmp_gt_u32 vcc, 768, v109
    v_lshl_add_u32 v109, v109, 4, s67
    s_and_b64 exec, vcc, s[22:23]
    s_nop 2
    s_cbranch_execz M_sb25
    ds_write_b96 v109, v[84:86]
M_sb25:
    s_mov_b64 exec, -1
    s_cmp_eq_u32 s60, 0
    s_cbranch_scc1 M_nomed2
    ds_bpermute_b32 v152, v152, v28
    ds_bpermute_b32 v153, v153, v28
    ds_bpermute_b32 v154, v154, v28
    ds_bpermute_b32 v155, v155, v28
    ds_bpermute_b32 v156, v156, v28
    ds_bpermute_b32 v157, v157, v28
    s_waitcnt lgkmcnt(0)
    v_cmp_gt_u32 s[8:9], v67, v23
    v_cmp_gt_u32 vcc, 60, v8
    s_and_b64 s[8:9], s[8:9], vcc
    v_add_u32 v152, v152, v131
    v_bfe_u32 v152, v152, v160, 16
    v_cmp_gt_u32 vcc, 768, v152
    v_lshl_add_u32 v152, v152, 4, s67
    s_and_b64 exec, vcc, s[8:9]
    s_nop 2
    s_cbranch_execz M_sb26
    ds_write_b96 v152, v[128:130]
M_sb26:
    s_mov_b64 exec, -1
    v_cmp_gt_u32 s[8:9], v71, v23
    v_cmp_gt_u32 vcc, 60, v8
    s_and_b64 s[8:9], s[8:9], vcc
    v_add_u32 v153, v153, v135
    v_bfe_u32 v153, v153, v161, 16
    v_cmp_gt_u32 vcc, 768, v153
    v_lshl_add_u32 v153, v153, 4, s67
    s_and_b64 exec, vcc, s[8:9]
    s_nop 2
    s_cbranch_execz M_sb27
    ds_write_b96 v153, v[132:134]
M_sb27:
    s_mov_b64 exec, -1
    v_cmp_gt_u32 s[8:9], v75, v23
    v_cmp_gt_u32 vcc, 60, v8
    s_and_b64 s[8:9], s[8:9], vcc
    v_add_u32 v154, v154, v139
    v_bfe_u32 v154, v154, v162, 16
    v_cmp_gt_u32 vcc, 768, v154
    v_lshl_add_u32 v154, v154, 4, s67
    s_and_b64 exec, vcc, s[8:9]
    s_nop 2
    s_cbranch_execz M_sb28
    ds_write_b96 v154, v[136:138]
M_sb28:
    s_mov_b64 exec, -1
    v_cmp_gt_u32 s[8:9], v79, v23
    v_cmp_gt_u32 vcc, 60, v8
    s_and_b64 s[8:9], s[8:9], vcc
    v_add_u32 v155, v155, v143
    v_bfe_u32 v155, v155, v163, 16
    v_cmp_gt_u32 vcc, 768, v155
    v_lshl_add_u32 v155, v155, 4, s67
    s_and_b64 exec, vcc, s[8:9]
    s_nop 2
    s_cbranch_execz M_sb29
    ds_write_b96 v155, v[140:142]
M_sb29:
    s_mov_b64 exec, -1
    v_cmp_gt_u32 s[8:9], v83, v23
    v_cmp_gt_u32 vcc, 60, v8
    s_and_b64 s[8:9], s[8:9], vcc
    v_add_u32 v156, v156, v147
    v_bfe_u32 v156, v156, v164, 16
    v_cmp_gt_u32 vcc, 768, v156
    v_lshl_add_u32 v156, v156, 4, s67
    s_and_b64 exec, vcc, s[8:9]
    s_nop 2
    s_cbranch_execz M_sb30
    ds_write_b96 v156, v[144:146]
M_sb30:
    s_mov_b64 exec, -1
    v_cmp_gt_u32 s[8:9], v87, v23
    v_cmp_gt_u32 vcc, 60, v8
    s_and_b64 s[8:9], s[8:9], vcc
    v_add_u32 v157, v157, v151
    v_bfe_u32 v157, v157, v165, 16
    v_cmp_gt_u32 vcc, 768, v157
    v_lshl_add_u32 v157, v157, 4, s67
    s_and_b64 exec, vcc, s[8:9]
    s_nop 2
    s_cbranch_execz M_sb31
    ds_write_b96 v157, v[148:150]
M_sb31:
    s_mov_b64 exec, -1
M_nomed2:
    s_waitcnt lgkmcnt(0)
    s_barrier
    s_cmp_eq_u32 s12, 0
    s_cbranch_scc1 M_cut
    s_sub_u32 s27, s57, s55
    s_cmp_gt_u32 s27, 64
    s_cselect_b32 s14, 64, 96
    s_mov_b32 s54, s56
    s_mov_b32 s55, s57
    s_sub_u32 s27, s62, s55
    s_cmp_gt_u32 s27, 420
    s_cselect_b32 s27, 96, 64
    s_add_u32 s27, s27, s55
    v_cmp_ge_u32 vcc, s27, v29
    v_cmp_ge_u32 s[70:71], s27, v31
    s_bcnt1_i32_b64 s56, vcc
    s_bcnt1_i32_b64 s57, s[70:71]
    s_add_u32 s27, s54, 16
    s_add_u32 s56, s56, s57
    s_min_u32 s56, s56, s27
    s_min_u32 s56, s56, 100
    s_max_u32 s56, s56, 4
    s_lshr_b32 s27, s56, 1
    s_and_b32 s69, s56, 1
    v_readlane_b32 s57, v28, s27
    s_lshl4_add_u32 s69, s69, 0x100000
    s_bfe_u32 s57, s57, s69
    s_cmp_eq_u32 s12, 1
    s_cbranch_scc1 M_cut
    s_sub_u32 s27, s57, s55
    s_cmp_gt_u32 s27, 64
    s_cselect_b32 s15, 64, 96
    s_mov_b32 s54, s56
    s_mov_b32 s55, s57
    s_sub_u32 s27, s62, s55
    s_cmp_gt_u32 s27, 360
    s_cselect_b32 s27, 96, 64
    s_add_u32 s27, s27, s55
    v_cmp_ge_u32 vcc, s27, v29
    v_cmp_ge_u32 s[70:71], s27, v31
    s_bcnt1_i32_b64 s56, vcc
    s_bcnt1_i32_b64 s57, s[70:71]
    s_add_u32 s27, s54, 16
    s_add_u32 s56, s56, s57
    s_min_u32 s56, s56, s27
    s_min_u32 s56, s56, 100
    s_max_u32 s56, s56, 20
    s_lshr_b32 s27, s56, 1
    s_and_b32 s69, s56, 1
    v_readlane_b32 s57, v28, s27
    s_lshl4_add_u32 s69, s69, 0x100000
    s_bfe_u32 s57, s57, s69
    s_cmp_eq_u32 s12, 2
    s_cbranch_scc1 M_cut
    s_sub_u32 s27, s57, s55
    s_cmp_gt_u32 s27, 64
    s_cselect_b32 s16, 64, 96
    s_mov_b32 s54, s56
    s_mov_b32 s55, s57
    s_sub_u32 s27, s62, s55
    s_cmp_gt_u32 s27, 300
    s_cselect_b32 s27, 96, 64
    s_add_u32 s27, s27, s55
    v_cmp_ge_u32 vcc, s27, v29
    v_cmp_ge_u32 s[70:71], s27, v31
    s_bcnt1_i32_b64 s56, vcc
    s_bcnt1_i32_b64 s57, s[70:71]
    s_add_u32 s27, s54, 16
    s_add_u32 s56, s56, s57
    s_min_u32 s56, s56, s27
    s_min_u32 s56, s56, 100
    s_max_u32 s56, s56, 36
    s_lshr_b32 s27, s56, 1
    s_and_b32 s69, s56, 1
    v_readlane_b32 s57, v28, s27
    s_lshl4_add_u32 s69, s69, 0x100000
    s_bfe_u32 s57, s57, s69
    s_cmp_eq_u32 s12, 3
    s_cbranch_scc1 M_cut
    s_mov_b32 s54, s56
    s_mov_b32 s55, s57
    s_sub_u32 s27, s62, s55
    s_cmp_gt_u32 s27, 248
    s_cselect_b32 s27, s14, 64
    s_add_u32 s27, s27, s55
    v_cmp_ge_u32 vcc, s27, v29
    v_cmp_ge_u32 s[70:71], s27, v31
    s_bcnt1_i32_b64 s56, vcc
    s_bcnt1_i32_b64 s57, s[70:71]
    s_add_u32 s27, s54, 16
    s_add_u32 s56, s56, s57
    s_min_u32 s56, s56, s27
    s_min_u32 s56, s56, 100
    s_max_u32 s56, s56, 52
    s_lshr_b32 s27, s56, 1
    s_and_b32 s69, s56, 1
    v_readlane_b32 s57, v28, s27
    s_lshl4_add_u32 s69, s69, 0x100000
    s_bfe_u32 s57, s57, s69
    s_cmp_eq_u32 s12, 4
    s_cbranch_scc1 M_cut
    s_mov_b32 s54, s56
    s_mov_b32 s55, s57
    s_sub_u32 s27, s62, s55
    s_cmp_gt_u32 s27, 186
    s_cselect_b32 s27, s15, 64
    s_add_u32 s27, s27, s55
    v_cmp_ge_u32 vcc, s27, v29
    v_cmp_ge_u32 s[70:71], s27, v31
    s_bcnt1_i32_b64 s56, vcc
    s_bcnt1_i32_b64 s57, s[70:71]
    s_add_u32 s27, s54, 16
    s_add_u32 s56, s56, s57
    s_min_u32 s56, s56, s27
    s_min_u32 s56, s56, 100
    s_max_u32 s56, s56, 68
    s_lshr_b32 s27, s56, 1
    s_and_b32 s69, s56, 1
    v_readlane_b32 s57, v28, s27
    s_lshl4_add_u32 s69, s69, 0x100000
    s_bfe_u32 s57, s57, s69
    s_cmp_eq_u32 s12, 5
    s_cbranch_scc1 M_cut
    s_mov_b32 s54, s56
    s_mov_b32 s55, s57
    s_sub_u32 s27, s62, s55
    s_cmp_gt_u32 s27, 124
    s_cselect_b32 s27, s16, 64
    s_add_u32 s27, s27, s55
    v_cmp_ge_u32 vcc, s27, v29
    v_cmp_ge_u32 s[70:71], s27, v31
    s_bcnt1_i32_b64 s56, vcc
    s_bcnt1_i32_b64 s57, s[70:71]
    s_add_u32 s27, s54, 16
    s_add_u32 s56, s56, s57
    s_min_u32 s56, s56, s27
    s_min_u32 s56, s56, 100
    s_max_u32 s56, s56, 84
    s_lshr_b32 s27, s56, 1
    s_and_b32 s69, s56, 1
    v_readlane_b32 s57, v28, s27
    s_lshl4_add_u32 s69, s69, 0x100000
    s_bfe_u32 s57, s57, s69
    s_cmp_eq_u32 s12, 6
    s_cbranch_scc1 M_cut
    s_mov_b32 s54, s56
    s_mov_b32 s55, s57
    s_movk_i32 s56, 100
    s_mov_b32 s57, s62
M_cut:
    s_lshl_b32 s27, s55, 4
    s_add_u32 s27, s27, s67
    v_add_u32 v14, s27, v1
    v_lshlrev_b32 v15, 4, v11
    v_add_u32 v15, s27, v15
    ds_read_b32 v15, v15
    ds_read_b96 v[88:90], v14
    ds_read_b96 v[92:94], v14 offset:1024
    s_lshl_b32 s59, s54, 1
    s_sub_u32 s45, s56, s54
    s_lshl_b32 s45, s45, 1
    s_lshl_b32 s40, s54, 10
    s_add_u32 s40, s40, s44
    s_add_u32 s41, s40, 4096
    s_add_u32 s42, s40, 8192
    s_add_u32 s43, s40, 12288
    s_lshl_b32 s6, s56, 10
    s_add_u32 s6, s6, s44
    s_mov_b32 s34, s6
    s_sub_u32 s47, s57, s55
    v_add_u32 v86, 64, v8
    s_mov_b32 s50, 1
    s_cmp_gt_u32 s47, 128
    s_cselect_b32 s27, 1, s46
    s_cmp_gt_u32 s57, 768
    s_cselect_b32 s27, 1, s27
    s_cmp_eq_u32 s27, 0
    s_cselect_b32 s47, s47, 0
    s_cselect_b32 s76, 1, 0
    s_mov_b32 s14, 0
    s_mov_b32 s15, 0
    s_mov_b32 s16, 0
    s_mov_b32 s17, 0
    v_cmp_gt_u32 s[8:9], s47, v8
    v_cmp_gt_u32 s[10:11], s47, v86
    s_add_u32 s48, s47, 31
    s_lshr_b32 s48, s48, 5
    v_bfrev_b32 v14, 2
    v_cmp_gt_u32 vcc, s47, v11
    s_waitcnt lgkmcnt(2)
    v_and_b32 v15, 0xffff, v15
    v_lshlrev_b32 v15, 7, v15
    v_lshl_add_u32 v15, v10, 6, v15
    v_cndmask_b32 v15, v14, v15, vcc
    buffer_load_dwordx4 v[32:35], v15, s[72:75], 0 offen offset:0
    buffer_load_dwordx4 v[36:39], v15, s[72:75], 0 offen offset:16
    buffer_load_dwordx4 v[40:43], v15, s[72:75], 0 offen offset:32
    buffer_load_dwordx4 v[44:47], v15, s[72:75], 0 offen offset:48
    s_waitcnt lgkmcnt(0)
M_win:
    v_lshrrev_b32 v8, 4, v1
    s_mov_b32 s53, 0x40490fdb
    s_mov_b32 s70, 0
    s_mov_b32 s54, 0x3e4ccccd
    v_mov_b32 v87, 1
    v_bfrev_b32 v14, 2
    v_and_b32 v96, s58, v90
    v_cndmask_b32 v96, 1.0, v96, s[8:9]
    v_rcp_f32 v98, v96
    v_mul_f32 v97, s53, v96
    v_cvt_pk_bf16_f32 v97, 0, v97
    v_mul_f32 v97, s54, v97
    v_cvt_pk_bf16_f32 v97, 0, v97
    v_mul_f32 v97, s61, v97
    v_cos_f32 v97, v97
    v_lshlrev_b32 v100, 16, v89
    v_and_b32 v101, s58, v89
    v_lshlrev_b32 v102, 16, v90
    v_cvt_pk_bf16_f32 v97, 0, v97
    v_add_f32 v97, 1.0, v97
    v_cvt_pk_bf16_f32 v97, 0, v97
    v_cndmask_b32 v97, 0, v97, s[8:9]
    v_mul_f32 v97, v97, v98
    v_add_f32 v103, v98, v98
    v_mul_f32 v97, 0x3e800000, v97
    v_mul_f32 v100, v100, v103
    v_mul_f32 v101, v101, v103
    v_mul_f32 v102, v102, v103
    v_bfe_u32 v99, v88, 0, 16
    v_lshlrev_b32 v99, 9, v99
    v_cndmask_b32 v99, v14, v99, s[8:9]
    v_cvt_pk_bf16_f32 v100, v100, v101
    v_cvt_pk_bf16_f32 v102, 0, v102
    v_cndmask_b32 v104, 0, v87, s[8:9]
    v_mov_b32 v105, 0
    v_bfe_u32 v108, v88, 16, 8
    v_subrev_u32 v108, s59, v108
    v_lshlrev_b32 v108, 1, v108
    v_lshlrev_b64 v[106:107], v108, v[104:105]
    ds_write_b128 v16, v[96:99] offset:0
    ds_write_b16 v17, v106 offset:2048
    ds_write_b16_d16_hi v17, v106 offset:2056
    ds_write_b16 v17, v107 offset:2064
    ds_write_b16_d16_hi v17, v107 offset:2072
    ds_write_b16 v17, v100 offset:2080
    ds_write_b16_d16_hi v17, v100 offset:2088
    ds_write_b16_d16_hi v17, v102 offset:2096
    s_cmp_eq_u64 s[10:11], 0
    s_cbranch_scc1 M_g1
    v_and_b32 v112, s58, v94
    v_cndmask_b32 v112, 1.0, v112, s[10:11]
    v_rcp_f32 v114, v112
    v_mul_f32 v113, s53, v112
    v_cvt_pk_bf16_f32 v113, 0, v113
    v_mul_f32 v113, s54, v113
    v_cvt_pk_bf16_f32 v113, 0, v113
    v_mul_f32 v113, s61, v113
    v_cos_f32 v113, v113
    v_lshlrev_b32 v116, 16, v93
    v_and_b32 v117, s58, v93
    v_lshlrev_b32 v118, 16, v94
    v_cvt_pk_bf16_f32 v113, 0, v113
    v_add_f32 v113, 1.0, v113
    v_cvt_pk_bf16_f32 v113, 0, v113
    v_cndmask_b32 v113, 0, v113, s[10:11]
    v_mul_f32 v113, v113, v114
    v_add_f32 v119, v114, v114
    v_mul_f32 v113, 0x3e800000, v113
    v_mul_f32 v116, v116, v119
    v_mul_f32 v117, v117, v119
    v_mul_f32 v118, v118, v119
    v_bfe_u32 v115, v92, 0, 16
    v_lshlrev_b32 v115, 9, v115
    v_cndmask_b32 v115, v14, v115, s[10:11]
    v_cvt_pk_bf16_f32 v116, v116, v117
    v_cvt_pk_bf16_f32 v118, 0, v118
    v_cndmask_b32 v120, 0, v87, s[10:11]
    v_mov_b32 v121, 0
    v_bfe_u32 v124, v92, 16, 8
    v_subrev_u32 v124, s59, v124
    v_lshlrev_b32 v124, 1, v124
    v_lshlrev_b64 v[122:123], v124, v[120:121]
    ds_write_b128 v16, v[112:115] offset:1024
    ds_write_b16 v17, v122 offset:2944
    ds_write_b16_d16_hi v17, v122 offset:2952
    ds_write_b16 v17, v123 offset:2960
    ds_write_b16_d16_hi v17, v123 offset:2968
    ds_write_b16 v17, v116 offset:2976
    ds_write_b16_d16_hi v17, v116 offset:2984
    ds_write_b16_d16_hi v17, v118 offset:2992
M_g1:
    s_waitcnt lgkmcnt(0)
    s_cmp_lg_u32 s50, 0
    s_cbranch_scc1 M_first
    s_cmp_eq_u32 s48, 0
    s_cselect_b32 s77, 0x40000000, 0
    ds_read_b32 v47, v3 offset:12
    v_bfe_u32 v46, v1, 9, 1
    s_waitcnt lgkmcnt(0)
    v_lshrrev_b32 v47, 2, v47
    v_lshl_add_u32 v47, v46, 6, v47
    buffer_load_dwordx4 v[32:35], v47, s[72:75], s77 offen offset:0
    buffer_load_dwordx4 v[36:39], v47, s[72:75], s77 offen offset:16
    buffer_load_dwordx4 v[40:43], v47, s[72:75], s77 offen offset:32
    buffer_load_dwordx4 v[44:47], v47, s[72:75], s77 offen offset:48
    s_branch M_noacc
M_first:
    s_mov_b32 s50, 2
    s_sub_u32 s27, s26, 4
    s_cmp_ge_u32 s27, 3
    s_cbranch_scc1 M_late
    s_cmp_eq_u32 s48, 0
    s_cbranch_scc1 M_late
    ds_read_b32 v64, v5 offset:12
    ds_read_b32 v65, v5 offset:140
    ds_read_b32 v66, v5 offset:268
    ds_read_b32 v67, v5 offset:396
    s_waitcnt lgkmcnt(3)
    v_and_or_b32 v64, v1, s63, v64
    s_waitcnt lgkmcnt(2)
    v_and_or_b32 v65, v1, s63, v65
    s_waitcnt lgkmcnt(1)
    v_and_or_b32 v66, v1, s63, v66
    s_waitcnt lgkmcnt(0)
    v_and_or_b32 v67, v1, s63, v67
    s_add_u32 m0, s51, 0
    s_nop 0
    buffer_load_dwordx4 v64, s[28:31], s64 offen lds
    s_add_u32 m0, s51, 1024
    s_nop 0
    buffer_load_dwordx4 v64, s[28:31], s65 offen lds
    s_add_u32 m0, s51, 2048
    s_nop 0
    buffer_load_dwordx4 v64, s[28:31], s66 offen lds
    s_add_u32 m0, s51, 3072
    s_nop 0
    buffer_load_dwordx4 v65, s[28:31], s64 offen lds
    s_add_u32 m0, s51, 4096
    s_nop 0
    buffer_load_dwordx4 v65, s[28:31], s65 offen lds
    s_add_u32 m0, s51, 5120
    s_nop 0
    buffer_load_dwordx4 v65, s[28:31], s66 offen lds
    s_add_u32 m0, s51, 6144
    s_nop 0
    buffer_load_dwordx4 v66, s[28:31], s64 offen lds
    s_add_u32 m0, s51, 7168
    s_nop 0
    buffer_load_dwordx4 v66, s[28:31], s65 offen lds
    s_add_u32 m0, s51, 8192
    s_nop 0
    buffer_load_dwordx4 v66, s[28:31], s66 offen lds
    s_add_u32 m0, s51, 9216
    s_nop 0
    buffer_load_dwordx4 v67, s[28:31], s64 offen lds
    s_add_u32 m0, s51, 10240
    s_nop 0
    buffer_load_dwordx4 v67, s[28:31], s65 offen lds
    s_add_u32 m0, s51, 11264
    s_nop 0
    buffer_load_dwordx4 v67, s[28:31], s66 offen lds
    s_mov_b32 s50, 3
    s_waitcnt vmcnt(16)
    s_branch M_late2
M_late:
    s_waitcnt vmcnt(4)
M_late2:
    s_lshl_b32 s27, s59, 8
    s_add_u32 s27, s27, 30720
    v_lshlrev_b32 v12, 10, v10
    v_lshl_add_u32 v12, v11, 2, v12
    v_add_u32 v12, s27, v12
    s_barrier
    ds_read_u16_d16_hi v128, v12 offset:0
    ds_read_u16_d16_hi v144, v12 offset:2
    ds_read_u16_d16_hi v129, v12 offset:256
    ds_read_u16_d16_hi v145, v12 offset:258
    ds_read_u16_d16_hi v130, v12 offset:512
    ds_read_u16_d16_hi v146, v12 offset:514
    ds_read_u16_d16_hi v131, v12 offset:768
    ds_read_u16_d16_hi v147, v12 offset:770
    ds_read_u16_d16_hi v132, v12 offset:2048
    ds_read_u16_d16_hi v148, v12 offset:2050
    ds_read_u16_d16_hi v133, v12 offset:2304
    ds_read_u16_d16_hi v149, v12 offset:2306
    ds_read_u16_d16_hi v134, v12 offset:2560
    ds_read_u16_d16_hi v150, v12 offset:2562
    ds_read_u16_d16_hi v135, v12 offset:2816
    ds_read_u16_d16_hi v151, v12 offset:2818
    ds_read_u16_d16_hi v136, v12 offset:4096
    ds_read_u16_d16_hi v152, v12 offset:4098
    ds_read_u16_d16_hi v137, v12 offset:4352
    ds_read_u16_d16_hi v153, v12 offset:4354
    ds_read_u16_d16_hi v138, v12 offset:4608
    ds_read_u16_d16_hi v154, v12 offset:4610
    ds_read_u16_d16_hi v139, v12 offset:4864
    ds_read_u16_d16_hi v155, v12 offset:4866
    ds_read_u16_d16_hi v140, v12 offset:6144
    ds_read_u16_d16_hi v156, v12 offset:6146
    ds_read_u16_d16_hi v141, v12 offset:6400
    ds_read_u16_d16_hi v157, v12 offset:6402
    ds_read_u16_d16_hi v142, v12 offset:6656
    ds_read_u16_d16_hi v158, v12 offset:6658
    ds_read_u16_d16_hi v143, v12 offset:6912
    ds_read_u16_d16_hi v159, v12 offset:6914
    ds_read_u16_d16_hi v160, v12 offset:128
    ds_read_u16_d16_hi v176, v12 offset:130
    ds_read_u16_d16_hi v161, v12 offset:384
    ds_read_u16_d16_hi v177, v12 offset:386
    ds_read_u16_d16_hi v162, v12 offset:640
    ds_read_u16_d16_hi v178, v12 offset:642
    ds_read_u16_d16_hi v163, v12 offset:896
    ds_read_u16_d16_hi v179, v12 offset:898
    ds_read_u16_d16_hi v164, v12 offset:2176
    ds_read_u16_d16_hi v180, v12 offset:2178
    ds_read_u16_d16_hi v165, v12 offset:2432
    ds_read_u16_d16_hi v181, v12 offset:2434
    ds_read_u16_d16_hi v166, v12 offset:2688
    ds_read_u16_d16_hi v182, v12 offset:2690
    ds_read_u16_d16_hi v167, v12 offset:2944
    ds_read_u16_d16_hi v183, v12 offset:2946
    ds_read_u16_d16_hi v168, v12 offset:4224
    ds_read_u16_d16_hi v184, v12 offset:4226
    ds_read_u16_d16_hi v169, v12 offset:4480
    ds_read_u16_d16_hi v185, v12 offset:4482
    ds_read_u16_d16_hi v170, v12 offset:4736
    ds_read_u16_d16_hi v186, v12 offset:4738
    ds_read_u16_d16_hi v171, v12 offset:4992
    ds_read_u16_d16_hi v187, v12 offset:4994
    ds_read_u16_d16_hi v172, v12 offset:6272
    ds_read_u16_d16_hi v188, v12 offset:6274
    ds_read_u16_d16_hi v173, v12 offset:6528
    ds_read_u16_d16_hi v189, v12 offset:6530
    ds_read_u16_d16_hi v174, v12 offset:6784
    ds_read_u16_d16_hi v190, v12 offset:6786
    ds_read_u16_d16_hi v175, v12 offset:7040
    ds_read_u16_d16_hi v191, v12 offset:7042
    s_waitcnt lgkmcnt(0)
    s_cmp_eq_u32 s50, 3
    s_cbranch_scc1 M_noinit
    s_cmp_ge_u32 s26, 4
    s_cbranch_scc1 M_noacc
    s_barrier
    s_mov_b32 s50, 0
    s_cmp_eq_u32 s48, 0
    s_cbranch_scc1 M_noacc
    s_mov_b32 s70, 1
    s_waitcnt vmcnt(0)
    s_branch M_noinit
M_noacc:
    s_cmp_eq_u32 s48, 0
    s_cbranch_scc1 M_nob
    ds_read_b32 v64, v5 offset:12
    ds_read_b32 v65, v5 offset:140
    ds_read_b32 v66, v5 offset:268
    ds_read_b32 v67, v5 offset:396
    s_waitcnt lgkmcnt(3)
    v_and_or_b32 v64, v1, s63, v64
    s_waitcnt lgkmcnt(2)
    v_and_or_b32 v65, v1, s63, v65
    s_waitcnt lgkmcnt(1)
    v_and_or_b32 v66, v1, s63, v66
    s_waitcnt lgkmcnt(0)
    v_and_or_b32 v67, v1, s63, v67
    s_add_u32 m0, s51, 0
    s_nop 0
    buffer_load_dwordx4 v64, s[28:31], s64 offen lds
    s_add_u32 m0, s51, 1024
    s_nop 0
    buffer_load_dwordx4 v64, s[28:31], s65 offen lds
    s_add_u32 m0, s51, 2048
    s_nop 0
    buffer_load_dwordx4 v64, s[28:31], s66 offen lds
    s_add_u32 m0, s51, 3072
    s_nop 0
    buffer_load_dwordx4 v65, s[28:31], s64 offen lds
    s_add_u32 m0, s51, 4096
    s_nop 0
    buffer_load_dwordx4 v65, s[28:31], s65 offen lds
    s_add_u32 m0, s51, 5120
    s_nop 0
    buffer_load_dwordx4 v65, s[28:31], s66 offen lds
    s_add_u32 m0, s51, 6144
    s_nop 0
    buffer_load_dwordx4 v66, s[28:31], s64 offen lds
    s_add_u32 m0, s51, 7168
    s_nop 0
    buffer_load_dwordx4 v66, s[28:31], s65 offen lds
    s_add_u32 m0, s51, 8192
    s_nop 0
    buffer_load_dwordx4 v66, s[28:31], s66 offen lds
    s_add_u32 m0, s51, 9216
    s_nop 0
    buffer_load_dwordx4 v67, s[28:31], s64 offen lds
    s_add_u32 m0, s51, 10240
    s_nop 0
    buffer_load_dwordx4 v67, s[28:31], s65 offen lds
    s_add_u32 m0, s51, 11264
    s_nop 0
    buffer_load_dwordx4 v67, s[28:31], s66 offen lds
    s_branch M_noinit
M_nob:
    s_cmp_eq_u32 s76, 0
    s_cbranch_scc1 M_noinit
    v_lshrrev_b32 v64, 7, v1
    v_and_b32 v65, 1, v64
    v_lshrrev_b32 v64, 1, v64
    v_lshl_add_u32 v64, v65, 2, v64
    v_lshlrev_b32 v64, 9, v64
    v_and_or_b32 v64, v1, s63, v64
    s_add_u32 m0, s51, 1024
    s_add_u32 s53, s40, 256
    buffer_load_dwordx4 v64, s[4:7], s53 offen  lds
    s_add_u32 m0, s51, 2048
    s_add_u32 s53, s40, 384
    buffer_load_dwordx4 v64, s[4:7], s53 offen  lds
    s_add_u32 m0, s51, 4096
    s_add_u32 s53, s41, 256
    buffer_load_dwordx4 v64, s[4:7], s53 offen  lds
    s_add_u32 m0, s51, 5120
    s_add_u32 s53, s41, 384
    buffer_load_dwordx4 v64, s[4:7], s53 offen  lds
    s_add_u32 m0, s51, 7168
    s_add_u32 s53, s42, 256
    buffer_load_dwordx4 v64, s[4:7], s53 offen  lds
    s_add_u32 m0, s51, 8192
    s_add_u32 s53, s42, 384
    buffer_load_dwordx4 v64, s[4:7], s53 offen  lds
    s_add_u32 m0, s51, 10240
    s_add_u32 s53, s43, 256
    buffer_load_dwordx4 v64, s[4:7], s53 offen  lds
    s_add_u32 m0, s51, 11264
    s_add_u32 s53, s43, 384
    buffer_load_dwordx4 v64, s[4:7], s53 offen  lds
M_noinit:
    s_cmp_eq_u32 s50, 0
    s_cbranch_scc1 M_nod
    s_barrier
    s_mov_b32 s50, 0
M_nod:
    s_cmp_eq_u32 s48, 0
    s_cbranch_scc1 M_wend
    s_mov_b32 s49, 0
    s_cmp_lt_u32 s26, 4
    s_cbranch_scc1 M_yp
    s_setprio 1
M_yp:
    ds_read_b128 v[104:107], v3 offset:0
    ds_read_b128 v[72:75], v7
    ds_read_b128 v[76:79], v7 offset:16
    ds_read_b64 v[12:13], v4 offset:2048
    ds_read_b64 v[14:15], v4 offset:2160
    ds_read_b64 v[16:17], v4 offset:2272
    ds_read_b64 v[18:19], v4 offset:2384
    ds_read_b128 v[20:23], v1 offset:24576
    ds_read_b128 v[24:27], v1 offset:0
    ds_read_b128 v[28:31], v1 offset:1024
    s_waitcnt lgkmcnt(7)
    v_mul_f32 v72, v104, v72
    v_mul_f32 v73, v104, v73
    v_mul_f32 v74, v104, v74
    v_mul_f32 v75, v104, v75
    v_mul_f32 v76, v104, v76
    v_mul_f32 v77, v104, v77
    v_mul_f32 v78, v104, v78
    v_mul_f32 v79, v104, v79
    v_cvt_pk_bf16_f32 v72, 0, v72
    v_cvt_pk_bf16_f32 v73, 0, v73
    v_cvt_pk_bf16_f32 v74, 0, v74
    v_cvt_pk_bf16_f32 v75, 0, v75
    v_cvt_pk_bf16_f32 v76, 0, v76
    v_cvt_pk_bf16_f32 v77, 0, v77
    v_cvt_pk_bf16_f32 v78, 0, v78
    v_cvt_pk_bf16_f32 v79, 0, v79
    v_mul_f32 v72, s61, v72
    v_mul_f32 v73, s61, v73
    v_mul_f32 v74, s61, v74
    v_mul_f32 v75, s61, v75
    v_mul_f32 v76, s61, v76
    v_mul_f32 v77, s61, v77
    v_mul_f32 v78, s61, v78
    v_mul_f32 v79, s61, v79
    v_sin_f32 v72, v72
    v_sin_f32 v73, v73
    v_sin_f32 v74, v74
    v_sin_f32 v75, v75
    v_sin_f32 v76, v76
    v_sin_f32 v77, v77
    v_sin_f32 v78, v78
    v_sin_f32 v79, v79
    v_mul_f32 v72, v72, v105
    v_mul_f32 v73, v73, v105
    v_mul_f32 v74, v74, v105
    v_mul_f32 v75, v75, v105
    v_mul_f32 v76, v76, v105
    v_mul_f32 v77, v77, v105
    v_mul_f32 v78, v78, v105
    v_mul_f32 v79, v79, v105
    v_cvt_pk_bf16_f32 v8, v72, v73
    v_cvt_pk_bf16_f32 v9, v74, v75
    v_cvt_pk_bf16_f32 v10, v76, v77
    v_cvt_pk_bf16_f32 v11, v78, v79
    s_waitcnt lgkmcnt(3)
    v_pk_lshlrev_b16 v12, v6, v12
    v_pk_lshlrev_b16 v13, v6, v13
    v_pk_lshlrev_b16 v14, v6, v14
    v_pk_lshlrev_b16 v15, v6, v15
    v_pk_lshlrev_b16 v16, v6, v16
    v_pk_lshlrev_b16 v17, v6, v17
    v_pk_lshlrev_b16 v18, v6, v18
    v_pk_lshlrev_b16 v19, v6, v19
    s_waitcnt lgkmcnt(0)
    s_nop 0
M_batch:
    s_waitcnt vmcnt(12)
    v_mfma_f32_32x32x16_bf16 v[80:95], v[8:11], v[20:23], 0
    ds_read_b128 v[20:23], v1 offset:2048
    s_add_u32 s77, s49, 1
    s_cmp_lt_u32 s77, s48
    s_cselect_b32 s77, 0, 0x40000000
    ds_read_b32 v63, v3 offset:524
    v_bfe_u32 v62, v1, 9, 1
    s_waitcnt lgkmcnt(0)
    v_lshrrev_b32 v63, 2, v63
    v_lshl_add_u32 v63, v62, 6, v63
    buffer_load_dwordx4 v[48:51], v63, s[72:75], s77 offen offset:0
    buffer_load_dwordx4 v[52:55], v63, s[72:75], s77 offen offset:16
    buffer_load_dwordx4 v[56:59], v63, s[72:75], s77 offen offset:32
    buffer_load_dwordx4 v[60:63], v63, s[72:75], s77 offen offset:48
    s_cmp_eq_u32 s70, 0
    s_cbranch_scc1 M_vb32
    ds_read_b32 v112, v5 offset:12
    ds_read_b32 v113, v5 offset:140
    s_waitcnt lgkmcnt(1)
    v_and_or_b32 v112, v1, s63, v112
    s_add_u32 m0, s51, 0
    s_nop 0
    buffer_load_dwordx4 v112, s[28:31], s64 offen lds
    s_add_u32 m0, s51, 1024
    s_nop 0
    buffer_load_dwordx4 v112, s[28:31], s65 offen lds
    s_add_u32 m0, s51, 2048
    s_nop 0
    buffer_load_dwordx4 v112, s[28:31], s66 offen lds
    s_waitcnt lgkmcnt(0)
    v_and_or_b32 v113, v1, s63, v113
    s_add_u32 m0, s51, 3072
    s_nop 0
    buffer_load_dwordx4 v113, s[28:31], s64 offen lds
    s_add_u32 m0, s51, 4096
    s_nop 0
    buffer_load_dwordx4 v113, s[28:31], s65 offen lds
    s_add_u32 m0, s51, 5120
    s_nop 0
    buffer_load_dwordx4 v113, s[28:31], s66 offen lds
M_vb32:
    v_mfma_f32_32x32x16_bf16 v[64:79], v[32:35], v[24:27], 0
    ds_read_b128 v[24:27], v1 offset:3072
    v_mfma_f32_32x32x16_bf16 v[64:79], v[36:39], v[28:31], v[64:79]
    ds_read_b128 v[28:31], v1 offset:25600
    v_mfma_f32_32x32x16_bf16 v[64:79], v[40:43], v[20:23], v[64:79]
    ds_read_b128 v[20:23], v1 offset:4096
    s_waitcnt lgkmcnt(2)
    v_mfma_f32_32x32x16_bf16 v[64:79], v[44:47], v[24:27], v[64:79]
    ds_read_b128 v[24:27], v1 offset:5120
    s_cmp_eq_u32 s70, 0
    s_nop 9
    s_cbranch_scc1 M_vb33
    ds_read_b32 v114, v5 offset:268
    s_waitcnt lgkmcnt(0)
    v_and_or_b32 v114, v1, s63, v114
    s_add_u32 m0, s51, 6144
    s_nop 0
    buffer_load_dwordx4 v114, s[28:31], s64 offen lds
    s_add_u32 m0, s51, 7168
    s_nop 0
    buffer_load_dwordx4 v114, s[28:31], s65 offen lds
    s_add_u32 m0, s51, 8192
    s_nop 0
    buffer_load_dwordx4 v114, s[28:31], s66 offen lds
M_vb33:
    s_waitcnt lgkmcnt(2)
    v_mfma_f32_32x32x16_bf16 v[112:127], v[8:11], v[28:31], 0
    ds_read_b128 v[28:31], v1 offset:6144
    s_waitcnt lgkmcnt(2)
    v_mfma_f32_32x32x16_bf16 v[96:111], v[32:35], v[20:23], 0
    ds_read_b128 v[20:23], v1 offset:7168
    v_mul_f32 v64, v64, v80
    v_mul_f32 v65, v65, v81
    v_mul_f32 v66, v66, v82
    v_mul_f32 v67, v67, v83
    v_mul_f32 v68, v68, v84
    v_mul_f32 v69, v69, v85
    s_waitcnt lgkmcnt(2)
    v_mfma_f32_32x32x16_bf16 v[96:111], v[36:39], v[24:27], v[96:111]
    ds_read_b128 v[24:27], v1 offset:26624
    v_mul_f32 v70, v70, v86
    v_mul_f32 v71, v71, v87
    v_mul_f32 v72, v72, v88
    v_mul_f32 v73, v73, v89
    v_mul_f32 v74, v74, v90
    v_mul_f32 v75, v75, v91
    v_mul_f32 v76, v76, v92
    s_waitcnt lgkmcnt(2)
    v_mfma_f32_32x32x16_bf16 v[96:111], v[40:43], v[28:31], v[96:111]
    ds_read_b128 v[28:31], v1 offset:8192
    v_mul_f32 v77, v77, v93
    v_mul_f32 v78, v78, v94
    v_mul_f32 v79, v79, v95
    v_cvt_pk_bf16_f32 v64, v64, v65
    v_cvt_pk_bf16_f32 v65, v66, v67
    v_cvt_pk_bf16_f32 v66, v68, v69
    s_waitcnt lgkmcnt(2)
    v_mfma_f32_32x32x16_bf16 v[96:111], v[44:47], v[20:23], v[96:111]
    ds_read_b128 v[20:23], v1 offset:9216
    v_cvt_pk_bf16_f32 v67, v70, v71
    v_cvt_pk_bf16_f32 v68, v72, v73
    v_cvt_pk_bf16_f32 v69, v74, v75
    v_cvt_pk_bf16_f32 v70, v76, v77
    v_cvt_pk_bf16_f32 v71, v78, v79
    v_mfma_f32_32x32x16_bf16 v[128:143], v[12:15], v[64:67], v[128:143]
    s_nop 0
    v_mfma_f32_32x32x16_bf16 v[128:143], v[16:19], v[68:71], v[128:143]
    s_cmp_eq_u32 s70, 0
    s_nop 10
    s_cbranch_scc1 M_vb34
    ds_read_b32 v72, v5 offset:396
    s_waitcnt lgkmcnt(0)
    v_and_or_b32 v72, v1, s63, v72
    s_add_u32 m0, s51, 9216
    s_nop 0
    buffer_load_dwordx4 v72, s[28:31], s64 offen lds
    s_add_u32 m0, s51, 10240
    s_nop 0
    buffer_load_dwordx4 v72, s[28:31], s65 offen lds
    s_add_u32 m0, s51, 11264
    s_nop 0
    buffer_load_dwordx4 v72, s[28:31], s66 offen lds
M_vb34:
    s_waitcnt lgkmcnt(2)
    v_mfma_f32_32x32x16_bf16 v[80:95], v[8:11], v[24:27], 0
    ds_read_b128 v[24:27], v1 offset:10240
    s_waitcnt lgkmcnt(2)
    v_mfma_f32_32x32x16_bf16 v[64:79], v[32:35], v[28:31], 0
    ds_read_b128 v[28:31], v1 offset:11264
    v_mul_f32 v96, v96, v112
    v_mul_f32 v97, v97, v113
    v_mul_f32 v98, v98, v114
    v_mul_f32 v99, v99, v115
    v_mul_f32 v100, v100, v116
    v_mul_f32 v101, v101, v117
    s_waitcnt lgkmcnt(2)
    v_mfma_f32_32x32x16_bf16 v[64:79], v[36:39], v[20:23], v[64:79]
    ds_read_b128 v[20:23], v1 offset:27648
    v_mul_f32 v102, v102, v118
    v_mul_f32 v103, v103, v119
    v_mul_f32 v104, v104, v120
    v_mul_f32 v105, v105, v121
    v_mul_f32 v106, v106, v122
    v_mul_f32 v107, v107, v123
    v_mul_f32 v108, v108, v124
    s_waitcnt lgkmcnt(2)
    v_mfma_f32_32x32x16_bf16 v[64:79], v[40:43], v[24:27], v[64:79]
    ds_read_b128 v[24:27], v1 offset:12288
    v_mul_f32 v109, v109, v125
    v_mul_f32 v110, v110, v126
    v_mul_f32 v111, v111, v127
    v_cvt_pk_bf16_f32 v96, v96, v97
    v_cvt_pk_bf16_f32 v97, v98, v99
    v_cvt_pk_bf16_f32 v98, v100, v101
    s_waitcnt lgkmcnt(2)
    v_mfma_f32_32x32x16_bf16 v[64:79], v[44:47], v[28:31], v[64:79]
    ds_read_b128 v[28:31], v1 offset:13312
    v_cvt_pk_bf16_f32 v99, v102, v103
    v_cvt_pk_bf16_f32 v100, v104, v105
    v_cvt_pk_bf16_f32 v101, v106, v107
    v_cvt_pk_bf16_f32 v102, v108, v109
    v_cvt_pk_bf16_f32 v103, v110, v111
    v_mfma_f32_32x32x16_bf16 v[144:159], v[12:15], v[96:99], v[144:159]
    s_nop 0
    v_mfma_f32_32x32x16_bf16 v[144:159], v[16:19], v[100:103], v[144:159]
    s_waitcnt lgkmcnt(2)
    v_mfma_f32_32x32x16_bf16 v[112:127], v[8:11], v[20:23], 0
    ds_read_b128 v[20:23], v1 offset:14336
    s_waitcnt lgkmcnt(2)
    v_mfma_f32_32x32x16_bf16 v[96:111], v[32:35], v[24:27], 0
    ds_read_b128 v[24:27], v1 offset:15360
    v_mul_f32 v64, v64, v80
    v_mul_f32 v65, v65, v81
    v_mul_f32 v66, v66, v82
    v_mul_f32 v67, v67, v83
    v_mul_f32 v68, v68, v84
    v_mul_f32 v69, v69, v85
    v_mul_f32 v70, v70, v86
    v_mul_f32 v71, v71, v87
    v_mul_f32 v72, v72, v88
    v_mul_f32 v73, v73, v89
    v_mul_f32 v74, v74, v90
    v_mul_f32 v75, v75, v91
    v_mul_f32 v76, v76, v92
    v_mul_f32 v77, v77, v93
    v_mul_f32 v78, v78, v94
    v_mul_f32 v79, v79, v95
    s_cmp_eq_u32 s70, 0
    s_nop 0
    s_cbranch_scc1 M_vw35
    s_waitcnt vmcnt(0)
    s_mov_b32 s70, 0
M_vw35:
    s_waitcnt vmcnt(4)
    ds_read_u16_d16_hi v80, v2 offset:0
    ds_read_u16_d16_hi v81, v2 offset:256
    ds_read_u16_d16_hi v82, v2 offset:512
    ds_read_u16_d16_hi v83, v2 offset:768
    ds_read_u16_d16_hi v84, v2 offset:3072
    ds_read_u16_d16_hi v85, v2 offset:3328
    ds_read_u16_d16_hi v86, v2 offset:3584
    ds_read_u16_d16_hi v87, v2 offset:3840
    ds_read_u16_d16_hi v88, v2 offset:6144
    ds_read_u16_d16_hi v89, v2 offset:6400
    ds_read_u16_d16_hi v90, v2 offset:6656
    ds_read_u16_d16_hi v91, v2 offset:6912
    ds_read_u16_d16_hi v92, v2 offset:9216
    ds_read_u16_d16_hi v93, v2 offset:9472
    ds_read_u16_d16_hi v94, v2 offset:9728
    ds_read_u16_d16_hi v95, v2 offset:9984
    s_waitcnt lgkmcnt(12)
    v_mul_f32 v80, v80, v64
    v_mul_f32 v81, v81, v65
    v_mul_f32 v82, v82, v66
    v_mul_f32 v83, v83, v67
    s_waitcnt lgkmcnt(8)
    v_mul_f32 v84, v84, v68
    v_mul_f32 v85, v85, v69
    v_mfma_f32_32x32x16_bf16 v[96:111], v[36:39], v[28:31], v[96:111]
    ds_read_b128 v[28:31], v1 offset:28672
    v_mul_f32 v86, v86, v70
    v_mul_f32 v87, v87, v71
    v_cvt_pk_bf16_f32 v80, v80, v81
    v_cvt_pk_bf16_f32 v81, v82, v83
    v_cvt_pk_bf16_f32 v82, v84, v85
    v_cvt_pk_bf16_f32 v83, v86, v87
    s_nop 1
    v_mfma_f32_32x32x16_bf16 v[160:175], v[12:15], v[80:83], v[160:175]
    ds_read_u16_d16_hi v80, v2 offset:1024
    ds_read_u16_d16_hi v81, v2 offset:1280
    ds_read_u16_d16_hi v82, v2 offset:1536
    ds_read_u16_d16_hi v83, v2 offset:1792
    ds_read_u16_d16_hi v84, v2 offset:4096
    ds_read_u16_d16_hi v85, v2 offset:4352
    ds_read_u16_d16_hi v86, v2 offset:4608
    ds_read_u16_d16_hi v87, v2 offset:4864
    s_waitcnt lgkmcnt(13)
    v_mul_f32 v88, v88, v72
    v_mul_f32 v89, v89, v73
    v_mul_f32 v90, v90, v74
    v_mul_f32 v91, v91, v75
    s_waitcnt lgkmcnt(9)
    v_mul_f32 v92, v92, v76
    v_mul_f32 v93, v93, v77
    v_mul_f32 v94, v94, v78
    v_mul_f32 v95, v95, v79
    v_cvt_pk_bf16_f32 v88, v88, v89
    v_cvt_pk_bf16_f32 v89, v90, v91
    v_cvt_pk_bf16_f32 v90, v92, v93
    v_cvt_pk_bf16_f32 v91, v94, v95
    s_nop 1
    v_mfma_f32_32x32x16_bf16 v[160:175], v[16:19], v[88:91], v[160:175]
    ds_read_u16_d16_hi v88, v2 offset:7168
    ds_read_u16_d16_hi v89, v2 offset:7424
    ds_read_u16_d16_hi v90, v2 offset:7680
    ds_read_u16_d16_hi v91, v2 offset:7936
    ds_read_u16_d16_hi v92, v2 offset:10240
    ds_read_u16_d16_hi v93, v2 offset:10496
    ds_read_u16_d16_hi v94, v2 offset:10752
    ds_read_u16_d16_hi v95, v2 offset:11008
    s_waitcnt lgkmcnt(12)
    v_mul_f32 v80, v80, v64
    v_mul_f32 v81, v81, v65
    v_mul_f32 v82, v82, v66
    v_mfma_f32_32x32x16_bf16 v[96:111], v[40:43], v[20:23], v[96:111]
    ds_read_b128 v[20:23], v1 offset:16384
    v_mul_f32 v83, v83, v67
    s_waitcnt lgkmcnt(9)
    v_mul_f32 v84, v84, v68
    v_mul_f32 v85, v85, v69
    v_mul_f32 v86, v86, v70
    v_mul_f32 v87, v87, v71
    v_cvt_pk_bf16_f32 v80, v80, v81
    v_cvt_pk_bf16_f32 v81, v82, v83
    v_cvt_pk_bf16_f32 v82, v84, v85
    v_cvt_pk_bf16_f32 v83, v86, v87
    s_nop 1
    v_mfma_f32_32x32x16_bf16 v[192:207], v[12:15], v[80:83], v[192:207]
    ds_read_u16_d16_hi v80, v2 offset:2048
    ds_read_u16_d16_hi v81, v2 offset:2304
    ds_read_u16_d16_hi v82, v2 offset:2560
    ds_read_u16_d16_hi v83, v2 offset:2816
    ds_read_u16_d16_hi v84, v2 offset:5120
    ds_read_u16_d16_hi v85, v2 offset:5376
    ds_read_u16_d16_hi v86, v2 offset:5632
    ds_read_u16_d16_hi v87, v2 offset:5888
    s_waitcnt lgkmcnt(13)
    v_mul_f32 v88, v88, v72
    v_mul_f32 v89, v89, v73
    v_mul_f32 v90, v90, v74
    v_mul_f32 v91, v91, v75
    s_waitcnt lgkmcnt(9)
    v_mul_f32 v92, v92, v76
    v_mul_f32 v93, v93, v77
    v_mul_f32 v94, v94, v78
    v_mul_f32 v95, v95, v79
    v_cvt_pk_bf16_f32 v88, v88, v89
    v_cvt_pk_bf16_f32 v89, v90, v91
    v_cvt_pk_bf16_f32 v90, v92, v93
    v_cvt_pk_bf16_f32 v91, v94, v95
    s_nop 1
    v_mfma_f32_32x32x16_bf16 v[192:207], v[16:19], v[88:91], v[192:207]
    ds_read_u16_d16_hi v88, v2 offset:8192
    ds_read_u16_d16_hi v89, v2 offset:8448
    ds_read_u16_d16_hi v90, v2 offset:8704
    ds_read_u16_d16_hi v91, v2 offset:8960
    ds_read_u16_d16_hi v92, v2 offset:11264
    ds_read_u16_d16_hi v93, v2 offset:11520
    ds_read_u16_d16_hi v94, v2 offset:11776
    ds_read_u16_d16_hi v95, v2 offset:12032
    v_mfma_f32_32x32x16_bf16 v[96:111], v[44:47], v[24:27], v[96:111]
    ds_read_b128 v[24:27], v1 offset:17408
    s_waitcnt lgkmcnt(13)
    v_mul_f32 v80, v80, v64
    v_mul_f32 v81, v81, v65
    v_mul_f32 v82, v82, v66
    v_mul_f32 v83, v83, v67
    s_waitcnt lgkmcnt(9)
    v_mul_f32 v84, v84, v68
    v_mul_f32 v85, v85, v69
    v_mul_f32 v86, v86, v70
    v_mul_f32 v87, v87, v71
    v_cvt_pk_bf16_f32 v80, v80, v81
    v_cvt_pk_bf16_f32 v81, v82, v83
    v_cvt_pk_bf16_f32 v82, v84, v85
    v_cvt_pk_bf16_f32 v83, v86, v87
    s_nop 1
    v_mfma_f32_32x32x16_bf16 v[224:239], v[12:15], v[80:83], v[224:239]
    s_waitcnt lgkmcnt(5)
    v_mul_f32 v88, v88, v72
    v_mul_f32 v89, v89, v73
    v_mul_f32 v90, v90, v74
    v_mul_f32 v91, v91, v75
    s_waitcnt lgkmcnt(1)
    v_mul_f32 v92, v92, v76
    v_mul_f32 v93, v93, v77
    v_mul_f32 v94, v94, v78
    v_mul_f32 v95, v95, v79
    v_cvt_pk_bf16_f32 v88, v88, v89
    v_cvt_pk_bf16_f32 v89, v90, v91
    v_cvt_pk_bf16_f32 v90, v92, v93
    v_cvt_pk_bf16_f32 v91, v94, v95
    s_nop 1
    v_mfma_f32_32x32x16_bf16 v[224:239], v[16:19], v[88:91], v[224:239]
    v_mfma_f32_32x32x16_bf16 v[80:95], v[8:11], v[28:31], 0
    ds_read_b128 v[28:31], v1 offset:18432
    v_mfma_f32_32x32x16_bf16 v[64:79], v[32:35], v[20:23], 0
    ds_read_b128 v[20:23], v1 offset:19456
    v_mul_f32 v96, v96, v112
    v_mul_f32 v97, v97, v113
    v_mul_f32 v98, v98, v114
    v_mul_f32 v99, v99, v115
    v_mul_f32 v100, v100, v116
    v_mul_f32 v101, v101, v117
    v_mul_f32 v102, v102, v118
    v_mul_f32 v103, v103, v119
    v_mul_f32 v104, v104, v120
    v_mul_f32 v105, v105, v121
    v_mul_f32 v106, v106, v122
    v_mul_f32 v107, v107, v123
    v_mul_f32 v108, v108, v124
    v_mul_f32 v109, v109, v125
    v_mul_f32 v110, v110, v126
    v_mul_f32 v111, v111, v127
    ds_read_u16_d16_hi v112, v2 offset:2
    ds_read_u16_d16_hi v113, v2 offset:258
    ds_read_u16_d16_hi v114, v2 offset:514
    ds_read_u16_d16_hi v115, v2 offset:770
    ds_read_u16_d16_hi v116, v2 offset:3074
    ds_read_u16_d16_hi v117, v2 offset:3330
    ds_read_u16_d16_hi v118, v2 offset:3586
    ds_read_u16_d16_hi v119, v2 offset:3842
    ds_read_u16_d16_hi v120, v2 offset:6146
    ds_read_u16_d16_hi v121, v2 offset:6402
    ds_read_u16_d16_hi v122, v2 offset:6658
    ds_read_u16_d16_hi v123, v2 offset:6914
    ds_read_u16_d16_hi v124, v2 offset:9218
    ds_read_u16_d16_hi v125, v2 offset:9474
    ds_read_u16_d16_hi v126, v2 offset:9730
    ds_read_u16_d16_hi v127, v2 offset:9986
    s_waitcnt lgkmcnt(12)
    v_mul_f32 v112, v112, v96
    v_mul_f32 v113, v113, v97
    v_mul_f32 v114, v114, v98
    v_mul_f32 v115, v115, v99
    s_waitcnt lgkmcnt(8)
    v_mul_f32 v116, v116, v100
    v_mul_f32 v117, v117, v101
    v_mul_f32 v118, v118, v102
    v_mfma_f32_32x32x16_bf16 v[64:79], v[36:39], v[24:27], v[64:79]
    ds_read_b128 v[24:27], v1 offset:29696
    v_mul_f32 v119, v119, v103
    v_cvt_pk_bf16_f32 v112, v112, v113
    v_cvt_pk_bf16_f32 v113, v114, v115
    v_cvt_pk_bf16_f32 v114, v116, v117
    v_cvt_pk_bf16_f32 v115, v118, v119
    s_nop 1
    v_mfma_f32_32x32x16_bf16 v[176:191], v[12:15], v[112:115], v[176:191]
    ds_read_u16_d16_hi v112, v2 offset:1026
    ds_read_u16_d16_hi v113, v2 offset:1282
    ds_read_u16_d16_hi v114, v2 offset:1538
    ds_read_u16_d16_hi v115, v2 offset:1794
    ds_read_u16_d16_hi v116, v2 offset:4098
    ds_read_u16_d16_hi v117, v2 offset:4354
    ds_read_u16_d16_hi v118, v2 offset:4610
    ds_read_u16_d16_hi v119, v2 offset:4866
    s_waitcnt lgkmcnt(13)
    v_mul_f32 v120, v120, v104
    v_mul_f32 v121, v121, v105
    v_mul_f32 v122, v122, v106
    v_mul_f32 v123, v123, v107
    s_waitcnt lgkmcnt(9)
    v_mul_f32 v124, v124, v108
    v_mul_f32 v125, v125, v109
    v_mul_f32 v126, v126, v110
    v_mul_f32 v127, v127, v111
    v_cvt_pk_bf16_f32 v120, v120, v121
    v_cvt_pk_bf16_f32 v121, v122, v123
    v_cvt_pk_bf16_f32 v122, v124, v125
    v_cvt_pk_bf16_f32 v123, v126, v127
    s_nop 1
    v_mfma_f32_32x32x16_bf16 v[176:191], v[16:19], v[120:123], v[176:191]
    ds_read_u16_d16_hi v120, v2 offset:7170
    ds_read_u16_d16_hi v121, v2 offset:7426
    ds_read_u16_d16_hi v122, v2 offset:7682
    ds_read_u16_d16_hi v123, v2 offset:7938
    ds_read_u16_d16_hi v124, v2 offset:10242
    ds_read_u16_d16_hi v125, v2 offset:10498
    ds_read_u16_d16_hi v126, v2 offset:10754
    ds_read_u16_d16_hi v127, v2 offset:11010
    s_waitcnt lgkmcnt(12)
    v_mul_f32 v112, v112, v96
    v_mul_f32 v113, v113, v97
    v_mul_f32 v114, v114, v98
    v_mul_f32 v115, v115, v99
    v_mfma_f32_32x32x16_bf16 v[64:79], v[40:43], v[28:31], v[64:79]
    ds_read_b128 v[28:31], v1 offset:20480
    s_waitcnt lgkmcnt(9)
    v_mul_f32 v116, v116, v100
    v_mul_f32 v117, v117, v101
    v_mul_f32 v118, v118, v102
    v_mul_f32 v119, v119, v103
    v_cvt_pk_bf16_f32 v112, v112, v113
    v_cvt_pk_bf16_f32 v113, v114, v115
    v_cvt_pk_bf16_f32 v114, v116, v117
    v_cvt_pk_bf16_f32 v115, v118, v119
    s_nop 1
    v_mfma_f32_32x32x16_bf16 v[208:223], v[12:15], v[112:115], v[208:223]
    ds_read_u16_d16_hi v112, v2 offset:2050
    ds_read_u16_d16_hi v113, v2 offset:2306
    ds_read_u16_d16_hi v114, v2 offset:2562
    ds_read_u16_d16_hi v115, v2 offset:2818
    ds_read_u16_d16_hi v116, v2 offset:5122
    ds_read_u16_d16_hi v117, v2 offset:5378
    ds_read_u16_d16_hi v118, v2 offset:5634
    ds_read_u16_d16_hi v119, v2 offset:5890
    s_waitcnt lgkmcnt(13)
    v_mul_f32 v120, v120, v104
    v_mul_f32 v121, v121, v105
    v_mul_f32 v122, v122, v106
    v_mul_f32 v123, v123, v107
    s_waitcnt lgkmcnt(9)
    v_mul_f32 v124, v124, v108
    v_mul_f32 v125, v125, v109
    v_mul_f32 v126, v126, v110
    v_mul_f32 v127, v127, v111
    v_cvt_pk_bf16_f32 v120, v120, v121
    v_cvt_pk_bf16_f32 v121, v122, v123
    v_cvt_pk_bf16_f32 v122, v124, v125
    v_cvt_pk_bf16_f32 v123, v126, v127
    s_nop 1
    v_mfma_f32_32x32x16_bf16 v[208:223], v[16:19], v[120:123], v[208:223]
    ds_read_u16_d16_hi v120, v2 offset:8194
    ds_read_u16_d16_hi v121, v2 offset:8450
    ds_read_u16_d16_hi v122, v2 offset:8706
    ds_read_u16_d16_hi v123, v2 offset:8962
    ds_read_u16_d16_hi v124, v2 offset:11266
    ds_read_u16_d16_hi v125, v2 offset:11522
    ds_read_u16_d16_hi v126, v2 offset:11778
    ds_read_u16_d16_hi v127, v2 offset:12034
    s_waitcnt lgkmcnt(12)
    v_mul_f32 v112, v112, v96
    v_mfma_f32_32x32x16_bf16 v[64:79], v[44:47], v[20:23], v[64:79]
    ds_read_b128 v[20:23], v1 offset:21504
    v_mul_f32 v113, v113, v97
    v_mul_f32 v114, v114, v98
    v_mul_f32 v115, v115, v99
    s_waitcnt lgkmcnt(9)
    v_mul_f32 v116, v116, v100
    v_mul_f32 v117, v117, v101
    v_mul_f32 v118, v118, v102
    v_mul_f32 v119, v119, v103
    v_cvt_pk_bf16_f32 v112, v112, v113
    v_cvt_pk_bf16_f32 v113, v114, v115
    v_cvt_pk_bf16_f32 v114, v116, v117
    v_cvt_pk_bf16_f32 v115, v118, v119
    s_nop 1
    v_mfma_f32_32x32x16_bf16 v[240:255], v[12:15], v[112:115], v[240:255]
    s_waitcnt lgkmcnt(5)
    v_mul_f32 v120, v120, v104
    v_mul_f32 v121, v121, v105
    v_mul_f32 v122, v122, v106
    v_mul_f32 v123, v123, v107
    s_waitcnt lgkmcnt(1)
    v_mul_f32 v124, v124, v108
    v_mul_f32 v125, v125, v109
    v_mul_f32 v126, v126, v110
    v_mul_f32 v127, v127, v111
    v_cvt_pk_bf16_f32 v120, v120, v121
    v_cvt_pk_bf16_f32 v121, v122, v123
    v_cvt_pk_bf16_f32 v122, v124, v125
    v_cvt_pk_bf16_f32 v123, v126, v127
    s_nop 1
    v_mfma_f32_32x32x16_bf16 v[240:255], v[16:19], v[120:123], v[240:255]
    s_cmp_lg_u32 s77, 0
    s_nop 10
    s_cbranch_scc1 M_nv36
    ds_read_b32 v112, v5 offset:524
    ds_read_b32 v113, v5 offset:652
    ds_read_b32 v114, v5 offset:780
    ds_read_b32 v115, v5 offset:908
    s_waitcnt lgkmcnt(3)
    v_and_or_b32 v112, v1, s63, v112
    s_waitcnt lgkmcnt(2)
    v_and_or_b32 v113, v1, s63, v113
    s_waitcnt lgkmcnt(1)
    v_and_or_b32 v114, v1, s63, v114
    s_waitcnt lgkmcnt(0)
    v_and_or_b32 v115, v1, s63, v115
    s_add_u32 m0, s51, 0
    s_nop 0
    buffer_load_dwordx4 v112, s[28:31], s64 offen lds
    s_add_u32 m0, s51, 1024
    s_nop 0
    buffer_load_dwordx4 v112, s[28:31], s65 offen lds
    s_add_u32 m0, s51, 2048
    s_nop 0
    buffer_load_dwordx4 v112, s[28:31], s66 offen lds
    s_add_u32 m0, s51, 3072
    s_nop 0
    buffer_load_dwordx4 v113, s[28:31], s64 offen lds
    s_add_u32 m0, s51, 4096
    s_nop 0
    buffer_load_dwordx4 v113, s[28:31], s65 offen lds
    s_add_u32 m0, s51, 5120
    s_nop 0
    buffer_load_dwordx4 v113, s[28:31], s66 offen lds
    s_add_u32 m0, s51, 6144
    s_nop 0
    buffer_load_dwordx4 v114, s[28:31], s64 offen lds
    s_add_u32 m0, s51, 7168
    s_nop 0
    buffer_load_dwordx4 v114, s[28:31], s65 offen lds
    s_add_u32 m0, s51, 8192
    s_nop 0
    buffer_load_dwordx4 v114, s[28:31], s66 offen lds
    s_add_u32 m0, s51, 9216
    s_nop 0
    buffer_load_dwordx4 v115, s[28:31], s64 offen lds
    s_add_u32 m0, s51, 10240
    s_nop 0
    buffer_load_dwordx4 v115, s[28:31], s65 offen lds
    s_add_u32 m0, s51, 11264
    s_nop 0
    buffer_load_dwordx4 v115, s[28:31], s66 offen lds
    s_branch M_nj36
M_nv36:
    s_cmp_eq_u32 s76, 0
    s_cbranch_scc1 M_nj36
    v_lshrrev_b32 v112, 7, v1
    v_and_b32 v113, 1, v112
    v_lshrrev_b32 v112, 1, v112
    v_lshl_add_u32 v112, v113, 2, v112
    v_lshlrev_b32 v112, 9, v112
    v_and_or_b32 v112, v1, s63, v112
    s_add_u32 m0, s51, 1024
    s_add_u32 s53, s40, 256
    buffer_load_dwordx4 v112, s[4:7], s53 offen  lds
    s_add_u32 m0, s51, 2048
    s_add_u32 s53, s40, 384
    buffer_load_dwordx4 v112, s[4:7], s53 offen  lds
    s_add_u32 m0, s51, 4096
    s_add_u32 s53, s41, 256
    buffer_load_dwordx4 v112, s[4:7], s53 offen  lds
    s_add_u32 m0, s51, 5120
    s_add_u32 s53, s41, 384
    buffer_load_dwordx4 v112, s[4:7], s53 offen  lds
    s_add_u32 m0, s51, 7168
    s_add_u32 s53, s42, 256
    buffer_load_dwordx4 v112, s[4:7], s53 offen  lds
    s_add_u32 m0, s51, 8192
    s_add_u32 s53, s42, 384
    buffer_load_dwordx4 v112, s[4:7], s53 offen  lds
    s_add_u32 m0, s51, 10240
    s_add_u32 s53, s43, 256
    buffer_load_dwordx4 v112, s[4:7], s53 offen  lds
    s_add_u32 m0, s51, 11264
    s_add_u32 s53, s43, 384
    buffer_load_dwordx4 v112, s[4:7], s53 offen  lds
M_nj36:
    v_mfma_f32_32x32x16_bf16 v[112:127], v[8:11], v[24:27], 0
    ds_read_b128 v[24:27], v1 offset:22528
    v_mfma_f32_32x32x16_bf16 v[96:111], v[32:35], v[28:31], 0
    ds_read_b128 v[28:31], v1 offset:23552
    v_mul_f32 v64, v64, v80
    v_mul_f32 v65, v65, v81
    v_mul_f32 v66, v66, v82
    v_mul_f32 v67, v67, v83
    v_mul_f32 v68, v68, v84
    v_mul_f32 v69, v69, v85
    v_mul_f32 v70, v70, v86
    v_mul_f32 v71, v71, v87
    v_mul_f32 v72, v72, v88
    v_mul_f32 v73, v73, v89
    v_mul_f32 v74, v74, v90
    v_mul_f32 v75, v75, v91
    s_waitcnt lgkmcnt(2)
    v_mfma_f32_32x32x16_bf16 v[96:111], v[36:39], v[20:23], v[96:111]
    v_mul_f32 v76, v76, v92
    v_mul_f32 v77, v77, v93
    v_mul_f32 v78, v78, v94
    v_mul_f32 v79, v79, v95
    ds_read_b64 v[80:81], v0 offset:2080
    ds_read_b64 v[88:89], v0 offset:2088
    ds_read_b64 v[82:83], v0 offset:2192
    ds_read_b64 v[90:91], v0 offset:2200
    ds_read_b64 v[84:85], v0 offset:2304
    ds_read_b64 v[92:93], v0 offset:2312
    ds_read_b64 v[86:87], v0 offset:2416
    ds_read_b64 v[94:95], v0 offset:2424
    v_cvt_pk_bf16_f32 v64, v64, v65
    v_cvt_pk_bf16_f32 v65, v66, v67
    v_cvt_pk_bf16_f32 v66, v68, v69
    v_cvt_pk_bf16_f32 v67, v70, v71
    v_cvt_pk_bf16_f32 v68, v72, v73
    v_cvt_pk_bf16_f32 v69, v74, v75
    v_cvt_pk_bf16_f32 v70, v76, v77
    s_waitcnt lgkmcnt(9)
    v_mfma_f32_32x32x16_bf16 v[96:111], v[40:43], v[24:27], v[96:111]
    v_cvt_pk_bf16_f32 v71, v78, v79
    v_pk_lshrrev_b16 v72, 14, v12 op_sel_hi:[0,1]
    v_pk_lshrrev_b16 v73, 14, v13 op_sel_hi:[0,1]
    v_pk_lshrrev_b16 v74, 14, v14 op_sel_hi:[0,1]
    v_pk_lshrrev_b16 v75, 14, v15 op_sel_hi:[0,1]
    v_pk_lshrrev_b16 v76, 14, v16 op_sel_hi:[0,1]
    v_pk_lshrrev_b16 v77, 14, v17 op_sel_hi:[0,1]
    v_pk_lshrrev_b16 v78, 14, v18 op_sel_hi:[0,1]
    v_pk_lshrrev_b16 v79, 14, v19 op_sel_hi:[0,1]
    s_waitcnt lgkmcnt(0)
    v_pk_mul_lo_u16 v80, v72, v80
    v_pk_mul_lo_u16 v81, v73, v81
    v_pk_mul_lo_u16 v82, v74, v82
    v_mfma_f32_32x32x16_bf16 v[96:111], v[44:47], v[28:31], v[96:111]
    v_pk_mul_lo_u16 v83, v75, v83
    v_pk_mul_lo_u16 v84, v76, v84
    v_pk_mul_lo_u16 v85, v77, v85
    v_pk_mul_lo_u16 v86, v78, v86
    v_pk_mul_lo_u16 v87, v79, v87
    v_pk_mul_lo_u16 v88, v72, v88
    v_pk_mul_lo_u16 v89, v73, v89
    v_pk_mul_lo_u16 v90, v74, v90
    v_pk_mul_lo_u16 v91, v75, v91
    v_pk_mul_lo_u16 v92, v76, v92
    v_pk_mul_lo_u16 v93, v77, v93
    v_pk_mul_lo_u16 v94, v78, v94
    v_pk_mul_lo_u16 v95, v79, v95
    v_mfma_f32_32x32x16_bf16 v[160:175], v[80:83], v[64:67], v[160:175]
    v_mul_f32 v96, v96, v112
    v_mul_f32 v97, v97, v113
    v_mul_f32 v98, v98, v114
    v_mul_f32 v99, v99, v115
    v_mul_f32 v100, v100, v116
    v_mul_f32 v101, v101, v117
    v_mfma_f32_32x32x16_bf16 v[160:175], v[84:87], v[68:71], v[160:175]
    v_mul_f32 v102, v102, v118
    v_mul_f32 v103, v103, v119
    v_mul_f32 v104, v104, v120
    v_mul_f32 v105, v105, v121
    v_mul_f32 v106, v106, v122
    v_mul_f32 v107, v107, v123
    v_mfma_f32_32x32x16_bf16 v[192:207], v[88:91], v[64:67], v[192:207]
    v_mul_f32 v108, v108, v124
    v_mul_f32 v109, v109, v125
    v_mul_f32 v110, v110, v126
    v_mul_f32 v111, v111, v127
    ds_read_b64 v[112:113], v0 offset:2096
    ds_read_b64 v[114:115], v0 offset:2208
    ds_read_b64 v[116:117], v0 offset:2320
    ds_read_b64 v[118:119], v0 offset:2432
    v_cvt_pk_bf16_f32 v96, v96, v97
    v_mfma_f32_32x32x16_bf16 v[192:207], v[92:95], v[68:71], v[192:207]
    v_cvt_pk_bf16_f32 v97, v98, v99
    v_cvt_pk_bf16_f32 v98, v100, v101
    v_cvt_pk_bf16_f32 v99, v102, v103
    v_cvt_pk_bf16_f32 v100, v104, v105
    v_cvt_pk_bf16_f32 v101, v106, v107
    v_cvt_pk_bf16_f32 v102, v108, v109
    v_cvt_pk_bf16_f32 v103, v110, v111
    s_waitcnt lgkmcnt(0)
    v_pk_mul_lo_u16 v112, v72, v112
    v_pk_mul_lo_u16 v113, v73, v113
    v_pk_mul_lo_u16 v114, v74, v114
    v_pk_mul_lo_u16 v115, v75, v115
    v_pk_mul_lo_u16 v116, v76, v116
    v_pk_mul_lo_u16 v117, v77, v117
    v_pk_mul_lo_u16 v118, v78, v118
    v_pk_mul_lo_u16 v119, v79, v119
    v_mfma_f32_32x32x16_bf16 v[176:191], v[80:83], v[96:99], v[176:191]
    ds_read_b128 v[104:107], v3 offset:512
    ds_read_b128 v[72:75], v7
    ds_read_b128 v[76:79], v7 offset:16
    ds_read_b64 v[12:13], v4 offset:2496
    ds_read_b64 v[14:15], v4 offset:2608
    ds_read_b64 v[16:17], v4 offset:2720
    ds_read_b64 v[18:19], v4 offset:2832
    ds_read_b128 v[20:23], v1 offset:24576
    ds_read_b128 v[24:27], v1 offset:0
    ds_read_b128 v[28:31], v1 offset:1024
    s_waitcnt lgkmcnt(7)
    v_mul_f32 v72, v104, v72
    v_mul_f32 v73, v104, v73
    v_mul_f32 v74, v104, v74
    v_mul_f32 v75, v104, v75
    v_mul_f32 v76, v104, v76
    v_mfma_f32_32x32x16_bf16 v[176:191], v[84:87], v[100:103], v[176:191]
    v_mul_f32 v77, v104, v77
    v_mul_f32 v78, v104, v78
    v_mul_f32 v79, v104, v79
    v_cvt_pk_bf16_f32 v72, 0, v72
    v_cvt_pk_bf16_f32 v73, 0, v73
    v_cvt_pk_bf16_f32 v74, 0, v74
    v_cvt_pk_bf16_f32 v75, 0, v75
    v_mfma_f32_32x32x16_bf16 v[208:223], v[88:91], v[96:99], v[208:223]
    v_cvt_pk_bf16_f32 v76, 0, v76
    v_cvt_pk_bf16_f32 v77, 0, v77
    v_cvt_pk_bf16_f32 v78, 0, v78
    v_cvt_pk_bf16_f32 v79, 0, v79
    v_mul_f32 v72, s61, v72
    v_mul_f32 v73, s61, v73
    v_mfma_f32_32x32x16_bf16 v[208:223], v[92:95], v[100:103], v[208:223]
    v_mul_f32 v74, s61, v74
    v_mul_f32 v75, s61, v75
    v_mul_f32 v76, s61, v76
    v_mul_f32 v77, s61, v77
    v_mul_f32 v78, s61, v78
    v_mul_f32 v79, s61, v79
    v_sin_f32 v72, v72
    v_mfma_f32_32x32x16_bf16 v[224:239], v[112:115], v[64:67], v[224:239]
    v_sin_f32 v73, v73
    v_sin_f32 v74, v74
    v_sin_f32 v75, v75
    v_sin_f32 v76, v76
    v_sin_f32 v77, v77
    v_sin_f32 v78, v78
    v_sin_f32 v79, v79
    v_mfma_f32_32x32x16_bf16 v[240:255], v[112:115], v[96:99], v[240:255]
    v_mul_f32 v72, v72, v105
    v_mul_f32 v73, v73, v105
    v_mul_f32 v74, v74, v105
    v_mul_f32 v75, v75, v105
    v_mul_f32 v76, v76, v105
    v_mul_f32 v77, v77, v105
    v_mfma_f32_32x32x16_bf16 v[224:239], v[116:119], v[68:71], v[224:239]
    v_mul_f32 v78, v78, v105
    v_mul_f32 v79, v79, v105
    v_cvt_pk_bf16_f32 v8, v72, v73
    v_cvt_pk_bf16_f32 v9, v74, v75
    v_cvt_pk_bf16_f32 v10, v76, v77
    v_cvt_pk_bf16_f32 v11, v78, v79
    s_waitcnt lgkmcnt(3)
    v_pk_lshlrev_b16 v12, v6, v12
    v_mfma_f32_32x32x16_bf16 v[240:255], v[116:119], v[100:103], v[240:255]
    v_pk_lshlrev_b16 v13, v6, v13
    v_pk_lshlrev_b16 v14, v6, v14
    v_pk_lshlrev_b16 v15, v6, v15
    v_pk_lshlrev_b16 v16, v6, v16
    v_pk_lshlrev_b16 v17, v6, v17
    v_pk_lshlrev_b16 v18, v6, v18
    v_pk_lshlrev_b16 v19, v6, v19
    v_add_u32 v3, 512, v3
    v_add_u32 v4, 448, v4
    v_add_u32 v0, 448, v0
    v_add_u32 v5, 512, v5
    s_waitcnt lgkmcnt(0)
    s_add_u32 s49, s49, 1
    s_cmp_lt_u32 s49, s48
    s_cbranch_scc0 M_wend
    s_waitcnt vmcnt(12)
    v_mfma_f32_32x32x16_bf16 v[80:95], v[8:11], v[20:23], 0
    ds_read_b128 v[20:23], v1 offset:2048
    s_add_u32 s77, s49, 1
    s_cmp_lt_u32 s77, s48
    s_cselect_b32 s77, 0, 0x40000000
    ds_read_b32 v47, v3 offset:524
    v_bfe_u32 v46, v1, 9, 1
    s_waitcnt lgkmcnt(0)
    v_lshrrev_b32 v47, 2, v47
    v_lshl_add_u32 v47, v46, 6, v47
    buffer_load_dwordx4 v[32:35], v47, s[72:75], s77 offen offset:0
    buffer_load_dwordx4 v[36:39], v47, s[72:75], s77 offen offset:16
    buffer_load_dwordx4 v[40:43], v47, s[72:75], s77 offen offset:32
    buffer_load_dwordx4 v[44:47], v47, s[72:75], s77 offen offset:48
    v_mfma_f32_32x32x16_bf16 v[64:79], v[48:51], v[24:27], 0
    ds_read_b128 v[24:27], v1 offset:3072
    v_mfma_f32_32x32x16_bf16 v[64:79], v[52:55], v[28:31], v[64:79]
    ds_read_b128 v[28:31], v1 offset:25600
    v_mfma_f32_32x32x16_bf16 v[64:79], v[56:59], v[20:23], v[64:79]
    ds_read_b128 v[20:23], v1 offset:4096
    s_waitcnt lgkmcnt(2)
    v_mfma_f32_32x32x16_bf16 v[64:79], v[60:63], v[24:27], v[64:79]
    ds_read_b128 v[24:27], v1 offset:5120
    s_waitcnt lgkmcnt(2)
    v_mfma_f32_32x32x16_bf16 v[112:127], v[8:11], v[28:31], 0
    ds_read_b128 v[28:31], v1 offset:6144
    s_waitcnt lgkmcnt(2)
    v_mfma_f32_32x32x16_bf16 v[96:111], v[48:51], v[20:23], 0
    ds_read_b128 v[20:23], v1 offset:7168
    s_nop 4
    v_mul_f32 v64, v64, v80
    v_mul_f32 v65, v65, v81
    v_mul_f32 v66, v66, v82
    v_mul_f32 v67, v67, v83
    v_mul_f32 v68, v68, v84
    v_mul_f32 v69, v69, v85
    s_waitcnt lgkmcnt(2)
    v_mfma_f32_32x32x16_bf16 v[96:111], v[52:55], v[24:27], v[96:111]
    ds_read_b128 v[24:27], v1 offset:26624
    v_mul_f32 v70, v70, v86
    v_mul_f32 v71, v71, v87
    v_mul_f32 v72, v72, v88
    v_mul_f32 v73, v73, v89
    v_mul_f32 v74, v74, v90
    v_mul_f32 v75, v75, v91
    v_mul_f32 v76, v76, v92
    s_waitcnt lgkmcnt(2)
    v_mfma_f32_32x32x16_bf16 v[96:111], v[56:59], v[28:31], v[96:111]
    ds_read_b128 v[28:31], v1 offset:8192
    v_mul_f32 v77, v77, v93
    v_mul_f32 v78, v78, v94
    v_mul_f32 v79, v79, v95
    v_cvt_pk_bf16_f32 v64, v64, v65
    v_cvt_pk_bf16_f32 v65, v66, v67
    v_cvt_pk_bf16_f32 v66, v68, v69
    s_waitcnt lgkmcnt(2)
    v_mfma_f32_32x32x16_bf16 v[96:111], v[60:63], v[20:23], v[96:111]
    ds_read_b128 v[20:23], v1 offset:9216
    v_cvt_pk_bf16_f32 v67, v70, v71
    v_cvt_pk_bf16_f32 v68, v72, v73
    v_cvt_pk_bf16_f32 v69, v74, v75
    v_cvt_pk_bf16_f32 v70, v76, v77
    v_cvt_pk_bf16_f32 v71, v78, v79
    v_mfma_f32_32x32x16_bf16 v[128:143], v[12:15], v[64:67], v[128:143]
    s_nop 0
    v_mfma_f32_32x32x16_bf16 v[128:143], v[16:19], v[68:71], v[128:143]
    s_waitcnt lgkmcnt(2)
    v_mfma_f32_32x32x16_bf16 v[80:95], v[8:11], v[24:27], 0
    ds_read_b128 v[24:27], v1 offset:10240
    s_waitcnt lgkmcnt(2)
    v_mfma_f32_32x32x16_bf16 v[64:79], v[48:51], v[28:31], 0
    ds_read_b128 v[28:31], v1 offset:11264
    v_mul_f32 v96, v96, v112
    v_mul_f32 v97, v97, v113
    v_mul_f32 v98, v98, v114
    v_mul_f32 v99, v99, v115
    v_mul_f32 v100, v100, v116
    v_mul_f32 v101, v101, v117
    s_waitcnt lgkmcnt(2)
    v_mfma_f32_32x32x16_bf16 v[64:79], v[52:55], v[20:23], v[64:79]
    ds_read_b128 v[20:23], v1 offset:27648
    v_mul_f32 v102, v102, v118
    v_mul_f32 v103, v103, v119
    v_mul_f32 v104, v104, v120
    v_mul_f32 v105, v105, v121
    v_mul_f32 v106, v106, v122
    v_mul_f32 v107, v107, v123
    v_mul_f32 v108, v108, v124
    s_waitcnt lgkmcnt(2)
    v_mfma_f32_32x32x16_bf16 v[64:79], v[56:59], v[24:27], v[64:79]
    ds_read_b128 v[24:27], v1 offset:12288
    v_mul_f32 v109, v109, v125
    v_mul_f32 v110, v110, v126
    v_mul_f32 v111, v111, v127
    v_cvt_pk_bf16_f32 v96, v96, v97
    v_cvt_pk_bf16_f32 v97, v98, v99
    v_cvt_pk_bf16_f32 v98, v100, v101
    s_waitcnt lgkmcnt(2)
    v_mfma_f32_32x32x16_bf16 v[64:79], v[60:63], v[28:31], v[64:79]
    ds_read_b128 v[28:31], v1 offset:13312
    v_cvt_pk_bf16_f32 v99, v102, v103
    v_cvt_pk_bf16_f32 v100, v104, v105
    v_cvt_pk_bf16_f32 v101, v106, v107
    v_cvt_pk_bf16_f32 v102, v108, v109
    v_cvt_pk_bf16_f32 v103, v110, v111
    v_mfma_f32_32x32x16_bf16 v[144:159], v[12:15], v[96:99], v[144:159]
    s_nop 0
    v_mfma_f32_32x32x16_bf16 v[144:159], v[16:19], v[100:103], v[144:159]
    s_waitcnt lgkmcnt(2)
    v_mfma_f32_32x32x16_bf16 v[112:127], v[8:11], v[20:23], 0
    ds_read_b128 v[20:23], v1 offset:14336
    s_waitcnt lgkmcnt(2)
    v_mfma_f32_32x32x16_bf16 v[96:111], v[48:51], v[24:27], 0
    ds_read_b128 v[24:27], v1 offset:15360
    v_mul_f32 v64, v64, v80
    v_mul_f32 v65, v65, v81
    v_mul_f32 v66, v66, v82
    v_mul_f32 v67, v67, v83
    v_mul_f32 v68, v68, v84
    v_mul_f32 v69, v69, v85
    v_mul_f32 v70, v70, v86
    v_mul_f32 v71, v71, v87
    v_mul_f32 v72, v72, v88
    v_mul_f32 v73, v73, v89
    v_mul_f32 v74, v74, v90
    v_mul_f32 v75, v75, v91
    v_mul_f32 v76, v76, v92
    v_mul_f32 v77, v77, v93
    v_mul_f32 v78, v78, v94
    v_mul_f32 v79, v79, v95
    s_waitcnt vmcnt(4)
    ds_read_u16_d16_hi v80, v2 offset:0
    ds_read_u16_d16_hi v81, v2 offset:256
    ds_read_u16_d16_hi v82, v2 offset:512
    ds_read_u16_d16_hi v83, v2 offset:768
    ds_read_u16_d16_hi v84, v2 offset:3072
    ds_read_u16_d16_hi v85, v2 offset:3328
    ds_read_u16_d16_hi v86, v2 offset:3584
    ds_read_u16_d16_hi v87, v2 offset:3840
    ds_read_u16_d16_hi v88, v2 offset:6144
    ds_read_u16_d16_hi v89, v2 offset:6400
    ds_read_u16_d16_hi v90, v2 offset:6656
    ds_read_u16_d16_hi v91, v2 offset:6912
    ds_read_u16_d16_hi v92, v2 offset:9216
    ds_read_u16_d16_hi v93, v2 offset:9472
    ds_read_u16_d16_hi v94, v2 offset:9728
    ds_read_u16_d16_hi v95, v2 offset:9984
    s_waitcnt lgkmcnt(12)
    v_mul_f32 v80, v80, v64
    v_mul_f32 v81, v81, v65
    v_mul_f32 v82, v82, v66
    v_mul_f32 v83, v83, v67
    s_waitcnt lgkmcnt(8)
    v_mul_f32 v84, v84, v68
    v_mul_f32 v85, v85, v69
    v_mfma_f32_32x32x16_bf16 v[96:111], v[52:55], v[28:31], v[96:111]
    ds_read_b128 v[28:31], v1 offset:28672
    v_mul_f32 v86, v86, v70
    v_mul_f32 v87, v87, v71
    v_cvt_pk_bf16_f32 v80, v80, v81
    v_cvt_pk_bf16_f32 v81, v82, v83
    v_cvt_pk_bf16_f32 v82, v84, v85
    v_cvt_pk_bf16_f32 v83, v86, v87
    s_nop 1
    v_mfma_f32_32x32x16_bf16 v[160:175], v[12:15], v[80:83], v[160:175]
    ds_read_u16_d16_hi v80, v2 offset:1024
    ds_read_u16_d16_hi v81, v2 offset:1280
    ds_read_u16_d16_hi v82, v2 offset:1536
    ds_read_u16_d16_hi v83, v2 offset:1792
    ds_read_u16_d16_hi v84, v2 offset:4096
    ds_read_u16_d16_hi v85, v2 offset:4352
    ds_read_u16_d16_hi v86, v2 offset:4608
    ds_read_u16_d16_hi v87, v2 offset:4864
    s_waitcnt lgkmcnt(13)
    v_mul_f32 v88, v88, v72
    v_mul_f32 v89, v89, v73
    v_mul_f32 v90, v90, v74
    v_mul_f32 v91, v91, v75
    s_waitcnt lgkmcnt(9)
    v_mul_f32 v92, v92, v76
    v_mul_f32 v93, v93, v77
    v_mul_f32 v94, v94, v78
    v_mul_f32 v95, v95, v79
    v_cvt_pk_bf16_f32 v88, v88, v89
    v_cvt_pk_bf16_f32 v89, v90, v91
    v_cvt_pk_bf16_f32 v90, v92, v93
    v_cvt_pk_bf16_f32 v91, v94, v95
    s_nop 1
    v_mfma_f32_32x32x16_bf16 v[160:175], v[16:19], v[88:91], v[160:175]
    ds_read_u16_d16_hi v88, v2 offset:7168
    ds_read_u16_d16_hi v89, v2 offset:7424
    ds_read_u16_d16_hi v90, v2 offset:7680
    ds_read_u16_d16_hi v91, v2 offset:7936
    ds_read_u16_d16_hi v92, v2 offset:10240
    ds_read_u16_d16_hi v93, v2 offset:10496
    ds_read_u16_d16_hi v94, v2 offset:10752
    ds_read_u16_d16_hi v95, v2 offset:11008
    s_waitcnt lgkmcnt(12)
    v_mul_f32 v80, v80, v64
    v_mul_f32 v81, v81, v65
    v_mul_f32 v82, v82, v66
    v_mfma_f32_32x32x16_bf16 v[96:111], v[56:59], v[20:23], v[96:111]
    ds_read_b128 v[20:23], v1 offset:16384
    v_mul_f32 v83, v83, v67
    s_waitcnt lgkmcnt(9)
    v_mul_f32 v84, v84, v68
    v_mul_f32 v85, v85, v69
    v_mul_f32 v86, v86, v70
    v_mul_f32 v87, v87, v71
    v_cvt_pk_bf16_f32 v80, v80, v81
    v_cvt_pk_bf16_f32 v81, v82, v83
    v_cvt_pk_bf16_f32 v82, v84, v85
    v_cvt_pk_bf16_f32 v83, v86, v87
    s_nop 1
    v_mfma_f32_32x32x16_bf16 v[192:207], v[12:15], v[80:83], v[192:207]
    ds_read_u16_d16_hi v80, v2 offset:2048
    ds_read_u16_d16_hi v81, v2 offset:2304
    ds_read_u16_d16_hi v82, v2 offset:2560
    ds_read_u16_d16_hi v83, v2 offset:2816
    ds_read_u16_d16_hi v84, v2 offset:5120
    ds_read_u16_d16_hi v85, v2 offset:5376
    ds_read_u16_d16_hi v86, v2 offset:5632
    ds_read_u16_d16_hi v87, v2 offset:5888
    s_waitcnt lgkmcnt(13)
    v_mul_f32 v88, v88, v72
    v_mul_f32 v89, v89, v73
    v_mul_f32 v90, v90, v74
    v_mul_f32 v91, v91, v75
    s_waitcnt lgkmcnt(9)
    v_mul_f32 v92, v92, v76
    v_mul_f32 v93, v93, v77
    v_mul_f32 v94, v94, v78
    v_mul_f32 v95, v95, v79
    v_cvt_pk_bf16_f32 v88, v88, v89
    v_cvt_pk_bf16_f32 v89, v90, v91
    v_cvt_pk_bf16_f32 v90, v92, v93
    v_cvt_pk_bf16_f32 v91, v94, v95
    s_nop 1
    v_mfma_f32_32x32x16_bf16 v[192:207], v[16:19], v[88:91], v[192:207]
    ds_read_u16_d16_hi v88, v2 offset:8192
    ds_read_u16_d16_hi v89, v2 offset:8448
    ds_read_u16_d16_hi v90, v2 offset:8704
    ds_read_u16_d16_hi v91, v2 offset:8960
    ds_read_u16_d16_hi v92, v2 offset:11264
    ds_read_u16_d16_hi v93, v2 offset:11520
    ds_read_u16_d16_hi v94, v2 offset:11776
    ds_read_u16_d16_hi v95, v2 offset:12032
    v_mfma_f32_32x32x16_bf16 v[96:111], v[60:63], v[24:27], v[96:111]
    ds_read_b128 v[24:27], v1 offset:17408
    s_waitcnt lgkmcnt(13)
    v_mul_f32 v80, v80, v64
    v_mul_f32 v81, v81, v65
    v_mul_f32 v82, v82, v66
    v_mul_f32 v83, v83, v67
    s_waitcnt lgkmcnt(9)
    v_mul_f32 v84, v84, v68
    v_mul_f32 v85, v85, v69
    v_mul_f32 v86, v86, v70
    v_mul_f32 v87, v87, v71
    v_cvt_pk_bf16_f32 v80, v80, v81
    v_cvt_pk_bf16_f32 v81, v82, v83
    v_cvt_pk_bf16_f32 v82, v84, v85
    v_cvt_pk_bf16_f32 v83, v86, v87
    s_nop 1
    v_mfma_f32_32x32x16_bf16 v[224:239], v[12:15], v[80:83], v[224:239]
    s_waitcnt lgkmcnt(5)
    v_mul_f32 v88, v88, v72
    v_mul_f32 v89, v89, v73
    v_mul_f32 v90, v90, v74
    v_mul_f32 v91, v91, v75
    s_waitcnt lgkmcnt(1)
    v_mul_f32 v92, v92, v76
    v_mul_f32 v93, v93, v77
    v_mul_f32 v94, v94, v78
    v_mul_f32 v95, v95, v79
    v_cvt_pk_bf16_f32 v88, v88, v89
    v_cvt_pk_bf16_f32 v89, v90, v91
    v_cvt_pk_bf16_f32 v90, v92, v93
    v_cvt_pk_bf16_f32 v91, v94, v95
    s_nop 1
    v_mfma_f32_32x32x16_bf16 v[224:239], v[16:19], v[88:91], v[224:239]
    v_mfma_f32_32x32x16_bf16 v[80:95], v[8:11], v[28:31], 0
    ds_read_b128 v[28:31], v1 offset:18432
    v_mfma_f32_32x32x16_bf16 v[64:79], v[48:51], v[20:23], 0
    ds_read_b128 v[20:23], v1 offset:19456
    v_mul_f32 v96, v96, v112
    v_mul_f32 v97, v97, v113
    v_mul_f32 v98, v98, v114
    v_mul_f32 v99, v99, v115
    v_mul_f32 v100, v100, v116
    v_mul_f32 v101, v101, v117
    v_mul_f32 v102, v102, v118
    v_mul_f32 v103, v103, v119
    v_mul_f32 v104, v104, v120
    v_mul_f32 v105, v105, v121
    v_mul_f32 v106, v106, v122
    v_mul_f32 v107, v107, v123
    v_mul_f32 v108, v108, v124
    v_mul_f32 v109, v109, v125
    v_mul_f32 v110, v110, v126
    v_mul_f32 v111, v111, v127
    ds_read_u16_d16_hi v112, v2 offset:2
    ds_read_u16_d16_hi v113, v2 offset:258
    ds_read_u16_d16_hi v114, v2 offset:514
    ds_read_u16_d16_hi v115, v2 offset:770
    ds_read_u16_d16_hi v116, v2 offset:3074
    ds_read_u16_d16_hi v117, v2 offset:3330
    ds_read_u16_d16_hi v118, v2 offset:3586
    ds_read_u16_d16_hi v119, v2 offset:3842
    ds_read_u16_d16_hi v120, v2 offset:6146
    ds_read_u16_d16_hi v121, v2 offset:6402
    ds_read_u16_d16_hi v122, v2 offset:6658
    ds_read_u16_d16_hi v123, v2 offset:6914
    ds_read_u16_d16_hi v124, v2 offset:9218
    ds_read_u16_d16_hi v125, v2 offset:9474
    ds_read_u16_d16_hi v126, v2 offset:9730
    ds_read_u16_d16_hi v127, v2 offset:9986
    s_waitcnt lgkmcnt(12)
    v_mul_f32 v112, v112, v96
    v_mul_f32 v113, v113, v97
    v_mul_f32 v114, v114, v98
    v_mul_f32 v115, v115, v99
    s_waitcnt lgkmcnt(8)
    v_mul_f32 v116, v116, v100
    v_mul_f32 v117, v117, v101
    v_mul_f32 v118, v118, v102
    v_mfma_f32_32x32x16_bf16 v[64:79], v[52:55], v[24:27], v[64:79]
    ds_read_b128 v[24:27], v1 offset:29696
    v_mul_f32 v119, v119, v103
    v_cvt_pk_bf16_f32 v112, v112, v113
    v_cvt_pk_bf16_f32 v113, v114, v115
    v_cvt_pk_bf16_f32 v114, v116, v117
    v_cvt_pk_bf16_f32 v115, v118, v119
    s_nop 1
    v_mfma_f32_32x32x16_bf16 v[176:191], v[12:15], v[112:115], v[176:191]
    ds_read_u16_d16_hi v112, v2 offset:1026
    ds_read_u16_d16_hi v113, v2 offset:1282
    ds_read_u16_d16_hi v114, v2 offset:1538
    ds_read_u16_d16_hi v115, v2 offset:1794
    ds_read_u16_d16_hi v116, v2 offset:4098
    ds_read_u16_d16_hi v117, v2 offset:4354
    ds_read_u16_d16_hi v118, v2 offset:4610
    ds_read_u16_d16_hi v119, v2 offset:4866
    s_waitcnt lgkmcnt(13)
    v_mul_f32 v120, v120, v104
    v_mul_f32 v121, v121, v105
    v_mul_f32 v122, v122, v106
    v_mul_f32 v123, v123, v107
    s_waitcnt lgkmcnt(9)
    v_mul_f32 v124, v124, v108
    v_mul_f32 v125, v125, v109
    v_mul_f32 v126, v126, v110
    v_mul_f32 v127, v127, v111
    v_cvt_pk_bf16_f32 v120, v120, v121
    v_cvt_pk_bf16_f32 v121, v122, v123
    v_cvt_pk_bf16_f32 v122, v124, v125
    v_cvt_pk_bf16_f32 v123, v126, v127
    s_nop 1
    v_mfma_f32_32x32x16_bf16 v[176:191], v[16:19], v[120:123], v[176:191]
    ds_read_u16_d16_hi v120, v2 offset:7170
    ds_read_u16_d16_hi v121, v2 offset:7426
    ds_read_u16_d16_hi v122, v2 offset:7682
    ds_read_u16_d16_hi v123, v2 offset:7938
    ds_read_u16_d16_hi v124, v2 offset:10242
    ds_read_u16_d16_hi v125, v2 offset:10498
    ds_read_u16_d16_hi v126, v2 offset:10754
    ds_read_u16_d16_hi v127, v2 offset:11010
    s_waitcnt lgkmcnt(12)
    v_mul_f32 v112, v112, v96
    v_mul_f32 v113, v113, v97
    v_mul_f32 v114, v114, v98
    v_mul_f32 v115, v115, v99
    v_mfma_f32_32x32x16_bf16 v[64:79], v[56:59], v[28:31], v[64:79]
    ds_read_b128 v[28:31], v1 offset:20480
    s_waitcnt lgkmcnt(9)
    v_mul_f32 v116, v116, v100
    v_mul_f32 v117, v117, v101
    v_mul_f32 v118, v118, v102
    v_mul_f32 v119, v119, v103
    v_cvt_pk_bf16_f32 v112, v112, v113
    v_cvt_pk_bf16_f32 v113, v114, v115
    v_cvt_pk_bf16_f32 v114, v116, v117
    v_cvt_pk_bf16_f32 v115, v118, v119
    s_nop 1
    v_mfma_f32_32x32x16_bf16 v[208:223], v[12:15], v[112:115], v[208:223]
    ds_read_u16_d16_hi v112, v2 offset:2050
    ds_read_u16_d16_hi v113, v2 offset:2306
    ds_read_u16_d16_hi v114, v2 offset:2562
    ds_read_u16_d16_hi v115, v2 offset:2818
    ds_read_u16_d16_hi v116, v2 offset:5122
    ds_read_u16_d16_hi v117, v2 offset:5378
    ds_read_u16_d16_hi v118, v2 offset:5634
    ds_read_u16_d16_hi v119, v2 offset:5890
    s_waitcnt lgkmcnt(13)
    v_mul_f32 v120, v120, v104
    v_mul_f32 v121, v121, v105
    v_mul_f32 v122, v122, v106
    v_mul_f32 v123, v123, v107
    s_waitcnt lgkmcnt(9)
    v_mul_f32 v124, v124, v108
    v_mul_f32 v125, v125, v109
    v_mul_f32 v126, v126, v110
    v_mul_f32 v127, v127, v111
    v_cvt_pk_bf16_f32 v120, v120, v121
    v_cvt_pk_bf16_f32 v121, v122, v123
    v_cvt_pk_bf16_f32 v122, v124, v125
    v_cvt_pk_bf16_f32 v123, v126, v127
    s_nop 1
    v_mfma_f32_32x32x16_bf16 v[208:223], v[16:19], v[120:123], v[208:223]
    ds_read_u16_d16_hi v120, v2 offset:8194
    ds_read_u16_d16_hi v121, v2 offset:8450
    ds_read_u16_d16_hi v122, v2 offset:8706
    ds_read_u16_d16_hi v123, v2 offset:8962
    ds_read_u16_d16_hi v124, v2 offset:11266
    ds_read_u16_d16_hi v125, v2 offset:11522
    ds_read_u16_d16_hi v126, v2 offset:11778
    ds_read_u16_d16_hi v127, v2 offset:12034
    s_waitcnt lgkmcnt(12)
    v_mul_f32 v112, v112, v96
    v_mfma_f32_32x32x16_bf16 v[64:79], v[60:63], v[20:23], v[64:79]
    ds_read_b128 v[20:23], v1 offset:21504
    v_mul_f32 v113, v113, v97
    v_mul_f32 v114, v114, v98
    v_mul_f32 v115, v115, v99
    s_waitcnt lgkmcnt(9)
    v_mul_f32 v116, v116, v100
    v_mul_f32 v117, v117, v101
    v_mul_f32 v118, v118, v102
    v_mul_f32 v119, v119, v103
    v_cvt_pk_bf16_f32 v112, v112, v113
    v_cvt_pk_bf16_f32 v113, v114, v115
    v_cvt_pk_bf16_f32 v114, v116, v117
    v_cvt_pk_bf16_f32 v115, v118, v119
    s_nop 1
    v_mfma_f32_32x32x16_bf16 v[240:255], v[12:15], v[112:115], v[240:255]
    s_waitcnt lgkmcnt(5)
    v_mul_f32 v120, v120, v104
    v_mul_f32 v121, v121, v105
    v_mul_f32 v122, v122, v106
    v_mul_f32 v123, v123, v107
    s_waitcnt lgkmcnt(1)
    v_mul_f32 v124, v124, v108
    v_mul_f32 v125, v125, v109
    v_mul_f32 v126, v126, v110
    v_mul_f32 v127, v127, v111
    v_cvt_pk_bf16_f32 v120, v120, v121
    v_cvt_pk_bf16_f32 v121, v122, v123
    v_cvt_pk_bf16_f32 v122, v124, v125
    v_cvt_pk_bf16_f32 v123, v126, v127
    s_nop 1
    v_mfma_f32_32x32x16_bf16 v[240:255], v[16:19], v[120:123], v[240:255]
    s_cmp_lg_u32 s77, 0
    s_nop 10
    s_cbranch_scc1 M_nv37
    ds_read_b32 v112, v5 offset:524
    ds_read_b32 v113, v5 offset:652
    ds_read_b32 v114, v5 offset:780
    ds_read_b32 v115, v5 offset:908
    s_waitcnt lgkmcnt(3)
    v_and_or_b32 v112, v1, s63, v112
    s_waitcnt lgkmcnt(2)
    v_and_or_b32 v113, v1, s63, v113
    s_waitcnt lgkmcnt(1)
    v_and_or_b32 v114, v1, s63, v114
    s_waitcnt lgkmcnt(0)
    v_and_or_b32 v115, v1, s63, v115
    s_add_u32 m0, s51, 0
    s_nop 0
    buffer_load_dwordx4 v112, s[28:31], s64 offen lds
    s_add_u32 m0, s51, 1024
    s_nop 0
    buffer_load_dwordx4 v112, s[28:31], s65 offen lds
    s_add_u32 m0, s51, 2048
    s_nop 0
    buffer_load_dwordx4 v112, s[28:31], s66 offen lds
    s_add_u32 m0, s51, 3072
    s_nop 0
    buffer_load_dwordx4 v113, s[28:31], s64 offen lds
    s_add_u32 m0, s51, 4096
    s_nop 0
    buffer_load_dwordx4 v113, s[28:31], s65 offen lds
    s_add_u32 m0, s51, 5120
    s_nop 0
    buffer_load_dwordx4 v113, s[28:31], s66 offen lds
    s_add_u32 m0, s51, 6144
    s_nop 0
    buffer_load_dwordx4 v114, s[28:31], s64 offen lds
    s_add_u32 m0, s51, 7168
    s_nop 0
    buffer_load_dwordx4 v114, s[28:31], s65 offen lds
    s_add_u32 m0, s51, 8192
    s_nop 0
    buffer_load_dwordx4 v114, s[28:31], s66 offen lds
    s_add_u32 m0, s51, 9216
    s_nop 0
    buffer_load_dwordx4 v115, s[28:31], s64 offen lds
    s_add_u32 m0, s51, 10240
    s_nop 0
    buffer_load_dwordx4 v115, s[28:31], s65 offen lds
    s_add_u32 m0, s51, 11264
    s_nop 0
    buffer_load_dwordx4 v115, s[28:31], s66 offen lds
    s_branch M_nj37
M_nv37:
    s_cmp_eq_u32 s76, 0
    s_cbranch_scc1 M_nj37
    v_lshrrev_b32 v112, 7, v1
    v_and_b32 v113, 1, v112
    v_lshrrev_b32 v112, 1, v112
    v_lshl_add_u32 v112, v113, 2, v112
    v_lshlrev_b32 v112, 9, v112
    v_and_or_b32 v112, v1, s63, v112
    s_add_u32 m0, s51, 1024
    s_add_u32 s53, s40, 256
    buffer_load_dwordx4 v112, s[4:7], s53 offen  lds
    s_add_u32 m0, s51, 2048
    s_add_u32 s53, s40, 384
    buffer_load_dwordx4 v112, s[4:7], s53 offen  lds
    s_add_u32 m0, s51, 4096
    s_add_u32 s53, s41, 256
    buffer_load_dwordx4 v112, s[4:7], s53 offen  lds
    s_add_u32 m0, s51, 5120
    s_add_u32 s53, s41, 384
    buffer_load_dwordx4 v112, s[4:7], s53 offen  lds
    s_add_u32 m0, s51, 7168
    s_add_u32 s53, s42, 256
    buffer_load_dwordx4 v112, s[4:7], s53 offen  lds
    s_add_u32 m0, s51, 8192
    s_add_u32 s53, s42, 384
    buffer_load_dwordx4 v112, s[4:7], s53 offen  lds
    s_add_u32 m0, s51, 10240
    s_add_u32 s53, s43, 256
    buffer_load_dwordx4 v112, s[4:7], s53 offen  lds
    s_add_u32 m0, s51, 11264
    s_add_u32 s53, s43, 384
    buffer_load_dwordx4 v112, s[4:7], s53 offen  lds
M_nj37:
    v_mfma_f32_32x32x16_bf16 v[112:127], v[8:11], v[24:27], 0
    ds_read_b128 v[24:27], v1 offset:22528
    v_mfma_f32_32x32x16_bf16 v[96:111], v[48:51], v[28:31], 0
    ds_read_b128 v[28:31], v1 offset:23552
    v_mul_f32 v64, v64, v80
    v_mul_f32 v65, v65, v81
    v_mul_f32 v66, v66, v82
    v_mul_f32 v67, v67, v83
    v_mul_f32 v68, v68, v84
    v_mul_f32 v69, v69, v85
    v_mul_f32 v70, v70, v86
    v_mul_f32 v71, v71, v87
    v_mul_f32 v72, v72, v88
    v_mul_f32 v73, v73, v89
    v_mul_f32 v74, v74, v90
    v_mul_f32 v75, v75, v91
    s_waitcnt lgkmcnt(2)
    v_mfma_f32_32x32x16_bf16 v[96:111], v[52:55], v[20:23], v[96:111]
    v_mul_f32 v76, v76, v92
    v_mul_f32 v77, v77, v93
    v_mul_f32 v78, v78, v94
    v_mul_f32 v79, v79, v95
    ds_read_b64 v[80:81], v0 offset:2080
    ds_read_b64 v[88:89], v0 offset:2088
    ds_read_b64 v[82:83], v0 offset:2192
    ds_read_b64 v[90:91], v0 offset:2200
    ds_read_b64 v[84:85], v0 offset:2304
    ds_read_b64 v[92:93], v0 offset:2312
    ds_read_b64 v[86:87], v0 offset:2416
    ds_read_b64 v[94:95], v0 offset:2424
    v_cvt_pk_bf16_f32 v64, v64, v65
    v_cvt_pk_bf16_f32 v65, v66, v67
    v_cvt_pk_bf16_f32 v66, v68, v69
    v_cvt_pk_bf16_f32 v67, v70, v71
    v_cvt_pk_bf16_f32 v68, v72, v73
    v_cvt_pk_bf16_f32 v69, v74, v75
    v_cvt_pk_bf16_f32 v70, v76, v77
    s_waitcnt lgkmcnt(9)
    v_mfma_f32_32x32x16_bf16 v[96:111], v[56:59], v[24:27], v[96:111]
    v_cvt_pk_bf16_f32 v71, v78, v79
    v_pk_lshrrev_b16 v72, 14, v12 op_sel_hi:[0,1]
    v_pk_lshrrev_b16 v73, 14, v13 op_sel_hi:[0,1]
    v_pk_lshrrev_b16 v74, 14, v14 op_sel_hi:[0,1]
    v_pk_lshrrev_b16 v75, 14, v15 op_sel_hi:[0,1]
    v_pk_lshrrev_b16 v76, 14, v16 op_sel_hi:[0,1]
    v_pk_lshrrev_b16 v77, 14, v17 op_sel_hi:[0,1]
    v_pk_lshrrev_b16 v78, 14, v18 op_sel_hi:[0,1]
    v_pk_lshrrev_b16 v79, 14, v19 op_sel_hi:[0,1]
    s_waitcnt lgkmcnt(0)
    v_pk_mul_lo_u16 v80, v72, v80
    v_pk_mul_lo_u16 v81, v73, v81
    v_pk_mul_lo_u16 v82, v74, v82
    v_mfma_f32_32x32x16_bf16 v[96:111], v[60:63], v[28:31], v[96:111]
    v_pk_mul_lo_u16 v83, v75, v83
    v_pk_mul_lo_u16 v84, v76, v84
    v_pk_mul_lo_u16 v85, v77, v85
    v_pk_mul_lo_u16 v86, v78, v86
    v_pk_mul_lo_u16 v87, v79, v87
    v_pk_mul_lo_u16 v88, v72, v88
    v_pk_mul_lo_u16 v89, v73, v89
    v_pk_mul_lo_u16 v90, v74, v90
    v_pk_mul_lo_u16 v91, v75, v91
    v_pk_mul_lo_u16 v92, v76, v92
    v_pk_mul_lo_u16 v93, v77, v93
    v_pk_mul_lo_u16 v94, v78, v94
    v_pk_mul_lo_u16 v95, v79, v95
    v_mfma_f32_32x32x16_bf16 v[160:175], v[80:83], v[64:67], v[160:175]
    v_mul_f32 v96, v96, v112
    v_mul_f32 v97, v97, v113
    v_mul_f32 v98, v98, v114
    v_mul_f32 v99, v99, v115
    v_mul_f32 v100, v100, v116
    v_mul_f32 v101, v101, v117
    v_mfma_f32_32x32x16_bf16 v[160:175], v[84:87], v[68:71], v[160:175]
    v_mul_f32 v102, v102, v118
    v_mul_f32 v103, v103, v119
    v_mul_f32 v104, v104, v120
    v_mul_f32 v105, v105, v121
    v_mul_f32 v106, v106, v122
    v_mul_f32 v107, v107, v123
    v_mfma_f32_32x32x16_bf16 v[192:207], v[88:91], v[64:67], v[192:207]
    v_mul_f32 v108, v108, v124
    v_mul_f32 v109, v109, v125
    v_mul_f32 v110, v110, v126
    v_mul_f32 v111, v111, v127
    ds_read_b64 v[112:113], v0 offset:2096
    ds_read_b64 v[114:115], v0 offset:2208
    ds_read_b64 v[116:117], v0 offset:2320
    ds_read_b64 v[118:119], v0 offset:2432
    v_cvt_pk_bf16_f32 v96, v96, v97
    v_mfma_f32_32x32x16_bf16 v[192:207], v[92:95], v[68:71], v[192:207]
    v_cvt_pk_bf16_f32 v97, v98, v99
    v_cvt_pk_bf16_f32 v98, v100, v101
    v_cvt_pk_bf16_f32 v99, v102, v103
    v_cvt_pk_bf16_f32 v100, v104, v105
    v_cvt_pk_bf16_f32 v101, v106, v107
    v_cvt_pk_bf16_f32 v102, v108, v109
    v_cvt_pk_bf16_f32 v103, v110, v111
    s_waitcnt lgkmcnt(0)
    v_pk_mul_lo_u16 v112, v72, v112
    v_pk_mul_lo_u16 v113, v73, v113
    v_pk_mul_lo_u16 v114, v74, v114
    v_pk_mul_lo_u16 v115, v75, v115
    v_pk_mul_lo_u16 v116, v76, v116
    v_pk_mul_lo_u16 v117, v77, v117
    v_pk_mul_lo_u16 v118, v78, v118
    v_pk_mul_lo_u16 v119, v79, v119
    v_mfma_f32_32x32x16_bf16 v[176:191], v[80:83], v[96:99], v[176:191]
    ds_read_b128 v[104:107], v3 offset:512
    ds_read_b128 v[72:75], v7
    ds_read_b128 v[76:79], v7 offset:16
    ds_read_b64 v[12:13], v4 offset:2496
    ds_read_b64 v[14:15], v4 offset:2608
    ds_read_b64 v[16:17], v4 offset:2720
    ds_read_b64 v[18:19], v4 offset:2832
    ds_read_b128 v[20:23], v1 offset:24576
    ds_read_b128 v[24:27], v1 offset:0
    ds_read_b128 v[28:31], v1 offset:1024
    s_waitcnt lgkmcnt(7)
    v_mul_f32 v72, v104, v72
    v_mul_f32 v73, v104, v73
    v_mul_f32 v74, v104, v74
    v_mul_f32 v75, v104, v75
    v_mul_f32 v76, v104, v76
    v_mfma_f32_32x32x16_bf16 v[176:191], v[84:87], v[100:103], v[176:191]
    v_mul_f32 v77, v104, v77
    v_mul_f32 v78, v104, v78
    v_mul_f32 v79, v104, v79
    v_cvt_pk_bf16_f32 v72, 0, v72
    v_cvt_pk_bf16_f32 v73, 0, v73
    v_cvt_pk_bf16_f32 v74, 0, v74
    v_cvt_pk_bf16_f32 v75, 0, v75
    v_mfma_f32_32x32x16_bf16 v[208:223], v[88:91], v[96:99], v[208:223]
    v_cvt_pk_bf16_f32 v76, 0, v76
    v_cvt_pk_bf16_f32 v77, 0, v77
    v_cvt_pk_bf16_f32 v78, 0, v78
    v_cvt_pk_bf16_f32 v79, 0, v79
    v_mul_f32 v72, s61, v72
    v_mul_f32 v73, s61, v73
    v_mfma_f32_32x32x16_bf16 v[208:223], v[92:95], v[100:103], v[208:223]
    v_mul_f32 v74, s61, v74
    v_mul_f32 v75, s61, v75
    v_mul_f32 v76, s61, v76
    v_mul_f32 v77, s61, v77
    v_mul_f32 v78, s61, v78
    v_mul_f32 v79, s61, v79
    v_sin_f32 v72, v72
    v_mfma_f32_32x32x16_bf16 v[224:239], v[112:115], v[64:67], v[224:239]
    v_sin_f32 v73, v73
    v_sin_f32 v74, v74
    v_sin_f32 v75, v75
    v_sin_f32 v76, v76
    v_sin_f32 v77, v77
    v_sin_f32 v78, v78
    v_sin_f32 v79, v79
    v_mfma_f32_32x32x16_bf16 v[240:255], v[112:115], v[96:99], v[240:255]
    v_mul_f32 v72, v72, v105
    v_mul_f32 v73, v73, v105
    v_mul_f32 v74, v74, v105
    v_mul_f32 v75, v75, v105
    v_mul_f32 v76, v76, v105
    v_mul_f32 v77, v77, v105
    v_mfma_f32_32x32x16_bf16 v[224:239], v[116:119], v[68:71], v[224:239]
    v_mul_f32 v78, v78, v105
    v_mul_f32 v79, v79, v105
    v_cvt_pk_bf16_f32 v8, v72, v73
    v_cvt_pk_bf16_f32 v9, v74, v75
    v_cvt_pk_bf16_f32 v10, v76, v77
    v_cvt_pk_bf16_f32 v11, v78, v79
    s_waitcnt lgkmcnt(3)
    v_pk_lshlrev_b16 v12, v6, v12
    v_mfma_f32_32x32x16_bf16 v[240:255], v[116:119], v[100:103], v[240:255]
    v_pk_lshlrev_b16 v13, v6, v13
    v_pk_lshlrev_b16 v14, v6, v14
    v_pk_lshlrev_b16 v15, v6, v15
    v_pk_lshlrev_b16 v16, v6, v16
    v_pk_lshlrev_b16 v17, v6, v17
    v_pk_lshlrev_b16 v18, v6, v18
    v_pk_lshlrev_b16 v19, v6, v19
    v_add_u32 v3, 512, v3
    v_add_u32 v4, 448, v4
    v_add_u32 v0, 448, v0
    v_add_u32 v5, 512, v5
    s_waitcnt lgkmcnt(0)
    s_add_u32 s49, s49, 1
    s_cmp_lt_u32 s49, s48
    s_cbranch_scc1 M_batch
M_wend:
    s_cmp_lg_u32 s76, 0
    s_cbranch_scc1 M_epi
M_slow:
    v_lshrrev_b32 v8, 4, v1
    v_add_u32 v86, 64, v8
    v_bfrev_b32 v14, 2
    s_cmp_lg_u32 s14, 0
    s_nop 0
    s_cbranch_scc1 M_sovf
    s_cmp_ge_u32 s15, 42
    s_cbranch_scc1 M_sph1
    s_mul_i32 s27, s15, 6
    s_lshl_b32 s53, s2, 7
    v_mul_u32_u24 v12, 205, v8
    v_lshrrev_b32 v12, 12, v12
    v_mul_u32_u24 v13, 20, v12
    v_sub_u32 v13, v8, v13
    v_add_u32 v15, s27, v12
    v_cmp_gt_u32 vcc, 120, v8
    v_cmp_gt_u32 s[54:55], s65, v15
    s_and_b64 s[54:55], s[54:55], vcc
    v_cmp_gt_u32 vcc, 250, v15
    s_and_b64 s[54:55], s[54:55], vcc
    v_lshlrev_b32 v15, 15, v15
    v_cndmask_b32 v15, v14, v15, s[54:55]
    buffer_load_dword v91, v15, s[36:39], s53 offen
    v_mul_u32_u24 v16, 12, v13
    v_add_u32 v16, v16, v15
    v_add_u32 v17, 0x8fff88, v16
    v_cmp_gt_u32 vcc, 10, v13
    s_nop 1
    v_cndmask_b32 v16, v17, v16, vcc
    v_cndmask_b32 v16, v14, v16, s[54:55]
    buffer_load_dwordx3 v[88:90], v16, s[36:39], s53 offen
    s_waitcnt vmcnt(0)
    v_lshrrev_b32 v91, 24, v91
    v_cmp_gt_u32 vcc, v91, v13
    s_and_b64 s[54:55], s[54:55], vcc
    v_bfe_u32 v16, v88, 16, 8
    v_subrev_u32 v16, s59, v16
    v_cmp_gt_u32 vcc, s45, v16
    s_and_b64 s[8:9], s[54:55], vcc
    v_mul_u32_u24 v12, 205, v86
    v_lshrrev_b32 v12, 12, v12
    v_mul_u32_u24 v13, 20, v12
    v_sub_u32 v13, v86, v13
    v_add_u32 v15, s27, v12
    v_cmp_gt_u32 vcc, 120, v86
    v_cmp_gt_u32 s[54:55], s65, v15
    s_and_b64 s[54:55], s[54:55], vcc
    v_cmp_gt_u32 vcc, 250, v15
    s_and_b64 s[54:55], s[54:55], vcc
    v_lshlrev_b32 v15, 15, v15
    v_cndmask_b32 v15, v14, v15, s[54:55]
    buffer_load_dword v95, v15, s[36:39], s53 offen
    v_mul_u32_u24 v16, 12, v13
    v_add_u32 v16, v16, v15
    v_add_u32 v17, 0x8fff88, v16
    v_cmp_gt_u32 vcc, 10, v13
    s_nop 1
    v_cndmask_b32 v16, v17, v16, vcc
    v_cndmask_b32 v16, v14, v16, s[54:55]
    buffer_load_dwordx3 v[92:94], v16, s[36:39], s53 offen
    s_waitcnt vmcnt(0)
    v_lshrrev_b32 v95, 24, v95
    v_cmp_gt_u32 vcc, v95, v13
    s_and_b64 s[54:55], s[54:55], vcc
    v_bfe_u32 v16, v92, 16, 8
    v_subrev_u32 v16, s59, v16
    v_cmp_gt_u32 vcc, s45, v16
    s_and_b64 s[10:11], s[54:55], vcc
    s_add_u32 s15, s15, 1
    s_nop 2
    s_branch M_sgo
M_sph1:
    s_mov_b32 s14, 1
    s_mov_b32 s15, 0
    s_mov_b32 s16, 0
M_sovf:
    s_cmp_ge_u32 s15, 250
    s_cbranch_scc1 M_send
    s_cmp_lg_u32 s16, 0
    s_cbranch_scc1 M_sblk
    s_lshl_b32 s27, s15, 15
    s_add_u32 s27, s27, 32124
    v_mov_b32 v12, 0
    buffer_load_dword v12, v12, s[36:39], s27 offen
    s_waitcnt vmcnt(0)
    v_readfirstlane_b32 s17, v12
    s_min_u32 s17, s17, 3200
M_sblk:
    s_cmp_lt_u32 s16, s17
    s_cbranch_scc1 M_sld
    s_add_u32 s15, s15, 1
    s_mov_b32 s16, 0
    s_branch M_sovf
M_sld:
    s_mul_i32 s27, s15, 51200
    s_add_u32 s27, s27, 0x1100000
    v_add_u32 v12, s16, v8
    v_cmp_gt_u32 s[54:55], s17, v12
    v_lshlrev_b32 v12, 4, v12
    s_nop 0
    v_cndmask_b32 v12, v14, v12, s[54:55]
    buffer_load_dwordx4 v[88:91], v12, s[36:39], s27 offen
    s_waitcnt vmcnt(0)
    v_cmp_eq_u32 vcc, s2, v91
    s_and_b64 s[54:55], s[54:55], vcc
    v_bfe_u32 v16, v88, 16, 8
    v_subrev_u32 v16, s59, v16
    v_cmp_gt_u32 vcc, s45, v16
    s_and_b64 s[8:9], s[54:55], vcc
    v_add_u32 v12, s16, v86
    v_cmp_gt_u32 s[54:55], s17, v12
    v_lshlrev_b32 v12, 4, v12
    s_nop 0
    v_cndmask_b32 v12, v14, v12, s[54:55]
    buffer_load_dwordx4 v[92:95], v12, s[36:39], s27 offen
    s_waitcnt vmcnt(0)
    v_cmp_eq_u32 vcc, s2, v95
    s_and_b64 s[54:55], s[54:55], vcc
    v_bfe_u32 v16, v92, 16, 8
    v_subrev_u32 v16, s59, v16
    v_cmp_gt_u32 vcc, s45, v16
    s_and_b64 s[10:11], s[54:55], vcc
    s_add_u32 s16, s16, 128
    s_nop 2
M_sgo:
    s_or_b64 s[54:55], s[8:9], s[10:11]
    s_cmp_eq_u64 s[54:55], 0
    s_cbranch_scc1 M_slow
    s_mov_b32 s48, 4
    s_cmp_eq_u64 s[10:11], 0
    s_cselect_b32 s48, 2, 4
    v_lshrrev_b32 v8, 4, v1
    v_lshrrev_b32 v10, 5, v8
    v_and_b32 v11, 31, v8
    v_lshlrev_b32 v3, 4, v11
    v_add_u32 v3, s52, v3
    v_mul_u32_u24 v0, 56, v10
    v_add_u32 v0, s52, v0
    v_lshrrev_b32 v13, 3, v11
    v_lshl_add_u32 v4, v13, 3, v0
    v_lshrrev_b32 v13, 3, v8
    v_and_b32 v14, 1, v13
    v_lshrrev_b32 v13, 1, v13
    v_lshl_add_u32 v13, v14, 2, v13
    v_lshlrev_b32 v5, 4, v13
    v_add_u32 v5, s52, v5
    v_add_u32 v16, s52, v1
    v_lshrrev_b32 v17, 2, v8
    v_mul_u32_u24 v17, 56, v17
    v_and_b32 v13, 3, v8
    v_lshl_add_u32 v17, v13, 1, v17
    v_add_u32 v17, s52, v17
    s_nop 1
    s_branch M_win
M_send:
    s_mov_b64 s[8:9], 0
    s_mov_b64 s[10:11], 0
    s_mov_b32 s48, 0
    s_mov_b32 s76, 1
    v_lshrrev_b32 v8, 4, v1
    v_lshrrev_b32 v10, 5, v8
    v_and_b32 v11, 31, v8
    v_lshlrev_b32 v3, 4, v11
    v_add_u32 v3, s52, v3
    v_mul_u32_u24 v0, 56, v10
    v_add_u32 v0, s52, v0
    v_lshrrev_b32 v13, 3, v11
    v_lshl_add_u32 v4, v13, 3, v0
    v_lshrrev_b32 v13, 3, v8
    v_and_b32 v14, 1, v13
    v_lshrrev_b32 v13, 1, v13
    v_lshl_add_u32 v13, v14, 2, v13
    v_lshlrev_b32 v5, 4, v13
    v_add_u32 v5, s52, v5
    v_add_u32 v16, s52, v1
    v_lshrrev_b32 v17, 2, v8
    v_mul_u32_u24 v17, 56, v17
    v_and_b32 v13, 3, v8
    v_lshl_add_u32 v17, v13, 1, v17
    v_add_u32 v17, s52, v17
    s_nop 1
    s_branch M_win
M_epi:
    v_lshrrev_b32 v8, 4, v1
    v_lshrrev_b32 v10, 5, v8
    v_and_b32 v11, 31, v8
    v_lshlrev_b32 v12, 11, v10
    v_lshl_add_u32 v12, v11, 2, v12
    v_cvt_pk_bf16_f32 v64, v128, v144
    v_cvt_pk_bf16_f32 v65, v129, v145
    v_cvt_pk_bf16_f32 v66, v130, v146
    v_cvt_pk_bf16_f32 v67, v131, v147
    v_cvt_pk_bf16_f32 v68, v132, v148
    v_cvt_pk_bf16_f32 v69, v133, v149
    v_cvt_pk_bf16_f32 v70, v134, v150
    v_cvt_pk_bf16_f32 v71, v135, v151
    v_cvt_pk_bf16_f32 v72, v136, v152
    v_cvt_pk_bf16_f32 v73, v137, v153
    v_cvt_pk_bf16_f32 v74, v138, v154
    v_cvt_pk_bf16_f32 v75, v139, v155
    buffer_store_dword v64, v12, s[32:35], s40 offen offset:0 sc1 nt
    buffer_store_dword v65, v12, s[32:35], s40 offen offset:512 sc1 nt
    buffer_store_dword v66, v12, s[32:35], s40 offen offset:1024 sc1 nt
    buffer_store_dword v67, v12, s[32:35], s40 offen offset:1536 sc1 nt
    buffer_store_dword v68, v12, s[32:35], s41 offen offset:0 sc1 nt
    buffer_store_dword v69, v12, s[32:35], s41 offen offset:512 sc1 nt
    buffer_store_dword v70, v12, s[32:35], s41 offen offset:1024 sc1 nt
    buffer_store_dword v71, v12, s[32:35], s41 offen offset:1536 sc1 nt
    buffer_store_dword v72, v12, s[32:35], s42 offen offset:0 sc1 nt
    buffer_store_dword v73, v12, s[32:35], s42 offen offset:512 sc1 nt
    buffer_store_dword v74, v12, s[32:35], s42 offen offset:1024 sc1 nt
    buffer_store_dword v75, v12, s[32:35], s42 offen offset:1536 sc1 nt
    v_cvt_pk_bf16_f32 v80, v160, v176
    v_cvt_pk_bf16_f32 v81, v161, v177
    v_cvt_pk_bf16_f32 v82, v162, v178
    v_cvt_pk_bf16_f32 v83, v163, v179
    v_cvt_pk_bf16_f32 v84, v164, v180
    v_cvt_pk_bf16_f32 v85, v165, v181
    v_cvt_pk_bf16_f32 v86, v166, v182
    v_cvt_pk_bf16_f32 v87, v167, v183
    v_cvt_pk_bf16_f32 v88, v168, v184
    v_cvt_pk_bf16_f32 v89, v169, v185
    v_cvt_pk_bf16_f32 v90, v170, v186
    v_cvt_pk_bf16_f32 v91, v171, v187
    buffer_store_dword v80, v12, s[32:35], s40 offen offset:128 sc1 nt
    buffer_store_dword v81, v12, s[32:35], s40 offen offset:640 sc1 nt
    buffer_store_dword v82, v12, s[32:35], s40 offen offset:1152 sc1 nt
    buffer_store_dword v83, v12, s[32:35], s40 offen offset:1664 sc1 nt
    buffer_store_dword v84, v12, s[32:35], s41 offen offset:128 sc1 nt
    buffer_store_dword v85, v12, s[32:35], s41 offen offset:640 sc1 nt
    buffer_store_dword v86, v12, s[32:35], s41 offen offset:1152 sc1 nt
    buffer_store_dword v87, v12, s[32:35], s41 offen offset:1664 sc1 nt
    buffer_store_dword v88, v12, s[32:35], s42 offen offset:128 sc1 nt
    buffer_store_dword v89, v12, s[32:35], s42 offen offset:640 sc1 nt
    buffer_store_dword v90, v12, s[32:35], s42 offen offset:1152 sc1 nt
    buffer_store_dword v91, v12, s[32:35], s42 offen offset:1664 sc1 nt
    s_waitcnt vmcnt(24)
    ds_read_u16_d16_hi v16, v2 offset:1024
    ds_read_u16_d16_hi v17, v2 offset:1280
    ds_read_u16_d16_hi v18, v2 offset:1536
    ds_read_u16_d16_hi v19, v2 offset:1792
    ds_read_u16_d16_hi v20, v2 offset:4096
    ds_read_u16_d16_hi v21, v2 offset:4352
    ds_read_u16_d16_hi v22, v2 offset:4608
    ds_read_u16_d16_hi v23, v2 offset:4864
    ds_read_u16_d16_hi v24, v2 offset:7168
    ds_read_u16_d16_hi v25, v2 offset:7424
    ds_read_u16_d16_hi v26, v2 offset:7680
    ds_read_u16_d16_hi v27, v2 offset:7936
    ds_read_u16_d16_hi v32, v2 offset:1026
    ds_read_u16_d16_hi v33, v2 offset:1282
    ds_read_u16_d16_hi v34, v2 offset:1538
    ds_read_u16_d16_hi v35, v2 offset:1794
    ds_read_u16_d16_hi v36, v2 offset:4098
    ds_read_u16_d16_hi v37, v2 offset:4354
    ds_read_u16_d16_hi v38, v2 offset:4610
    ds_read_u16_d16_hi v39, v2 offset:4866
    ds_read_u16_d16_hi v40, v2 offset:7170
    ds_read_u16_d16_hi v41, v2 offset:7426
    ds_read_u16_d16_hi v42, v2 offset:7682
    ds_read_u16_d16_hi v43, v2 offset:7938
    s_waitcnt lgkmcnt(15)
    v_add_f32 v192, v192, v16
    v_add_f32 v193, v193, v17
    v_add_f32 v194, v194, v18
    v_add_f32 v195, v195, v19
    v_add_f32 v196, v196, v20
    v_add_f32 v197, v197, v21
    v_add_f32 v198, v198, v22
    v_add_f32 v199, v199, v23
    v_add_f32 v200, v200, v24
    s_waitcnt lgkmcnt(14)
    v_add_f32 v201, v201, v25
    s_waitcnt lgkmcnt(13)
    v_add_f32 v202, v202, v26
    s_waitcnt lgkmcnt(12)
    v_add_f32 v203, v203, v27
    s_waitcnt lgkmcnt(11)
    v_add_f32 v208, v208, v32
    s_waitcnt lgkmcnt(10)
    v_add_f32 v209, v209, v33
    s_waitcnt lgkmcnt(9)
    v_add_f32 v210, v210, v34
    s_waitcnt lgkmcnt(8)
    v_add_f32 v211, v211, v35
    s_waitcnt lgkmcnt(7)
    v_add_f32 v212, v212, v36
    s_waitcnt lgkmcnt(6)
    v_add_f32 v213, v213, v37
    s_waitcnt lgkmcnt(5)
    v_add_f32 v214, v214, v38
    s_waitcnt lgkmcnt(4)
    v_add_f32 v215, v215, v39
    s_waitcnt lgkmcnt(3)
    v_add_f32 v216, v216, v40
    s_waitcnt lgkmcnt(2)
    v_add_f32 v217, v217, v41
    s_waitcnt lgkmcnt(1)
    v_add_f32 v218, v218, v42
    s_waitcnt lgkmcnt(0)
    v_add_f32 v219, v219, v43
    v_cvt_pk_bf16_f32 v96, v192, v208
    v_cvt_pk_bf16_f32 v97, v193, v209
    v_cvt_pk_bf16_f32 v98, v194, v210
    v_cvt_pk_bf16_f32 v99, v195, v211
    v_cvt_pk_bf16_f32 v100, v196, v212
    v_cvt_pk_bf16_f32 v101, v197, v213
    v_cvt_pk_bf16_f32 v102, v198, v214
    v_cvt_pk_bf16_f32 v103, v199, v215
    v_cvt_pk_bf16_f32 v104, v200, v216
    v_cvt_pk_bf16_f32 v105, v201, v217
    v_cvt_pk_bf16_f32 v106, v202, v218
    v_cvt_pk_bf16_f32 v107, v203, v219
    buffer_store_dword v96, v12, s[32:35], s40 offen offset:256 sc1 nt
    buffer_store_dword v97, v12, s[32:35], s40 offen offset:768 sc1 nt
    buffer_store_dword v98, v12, s[32:35], s40 offen offset:1280 sc1 nt
    buffer_store_dword v99, v12, s[32:35], s40 offen offset:1792 sc1 nt
    buffer_store_dword v100, v12, s[32:35], s41 offen offset:256 sc1 nt
    buffer_store_dword v101, v12, s[32:35], s41 offen offset:768 sc1 nt
    buffer_store_dword v102, v12, s[32:35], s41 offen offset:1280 sc1 nt
    buffer_store_dword v103, v12, s[32:35], s41 offen offset:1792 sc1 nt
    buffer_store_dword v104, v12, s[32:35], s42 offen offset:256 sc1 nt
    buffer_store_dword v105, v12, s[32:35], s42 offen offset:768 sc1 nt
    buffer_store_dword v106, v12, s[32:35], s42 offen offset:1280 sc1 nt
    buffer_store_dword v107, v12, s[32:35], s42 offen offset:1792 sc1 nt
    ds_read_u16_d16_hi v16, v2 offset:2048
    ds_read_u16_d16_hi v17, v2 offset:2304
    ds_read_u16_d16_hi v18, v2 offset:2560
    ds_read_u16_d16_hi v19, v2 offset:2816
    ds_read_u16_d16_hi v20, v2 offset:5120
    ds_read_u16_d16_hi v21, v2 offset:5376
    ds_read_u16_d16_hi v22, v2 offset:5632
    ds_read_u16_d16_hi v23, v2 offset:5888
    ds_read_u16_d16_hi v24, v2 offset:8192
    ds_read_u16_d16_hi v25, v2 offset:8448
    ds_read_u16_d16_hi v26, v2 offset:8704
    ds_read_u16_d16_hi v27, v2 offset:8960
    ds_read_u16_d16_hi v32, v2 offset:2050
    ds_read_u16_d16_hi v33, v2 offset:2306
    ds_read_u16_d16_hi v34, v2 offset:2562
    ds_read_u16_d16_hi v35, v2 offset:2818
    ds_read_u16_d16_hi v36, v2 offset:5122
    ds_read_u16_d16_hi v37, v2 offset:5378
    ds_read_u16_d16_hi v38, v2 offset:5634
    ds_read_u16_d16_hi v39, v2 offset:5890
    ds_read_u16_d16_hi v40, v2 offset:8194
    ds_read_u16_d16_hi v41, v2 offset:8450
    ds_read_u16_d16_hi v42, v2 offset:8706
    ds_read_u16_d16_hi v43, v2 offset:8962
    s_waitcnt lgkmcnt(15)
    v_add_f32 v224, v224, v16
    v_add_f32 v225, v225, v17
    v_add_f32 v226, v226, v18
    v_add_f32 v227, v227, v19
    v_add_f32 v228, v228, v20
    v_add_f32 v229, v229, v21
    v_add_f32 v230, v230, v22
    v_add_f32 v231, v231, v23
    v_add_f32 v232, v232, v24
    s_waitcnt lgkmcnt(14)
    v_add_f32 v233, v233, v25
    s_waitcnt lgkmcnt(13)
    v_add_f32 v234, v234, v26
    s_waitcnt lgkmcnt(12)
    v_add_f32 v235, v235, v27
    s_waitcnt lgkmcnt(11)
    v_add_f32 v240, v240, v32
    s_waitcnt lgkmcnt(10)
    v_add_f32 v241, v241, v33
    s_waitcnt lgkmcnt(9)
    v_add_f32 v242, v242, v34
    s_waitcnt lgkmcnt(8)
    v_add_f32 v243, v243, v35
    s_waitcnt lgkmcnt(7)
    v_add_f32 v244, v244, v36
    s_waitcnt lgkmcnt(6)
    v_add_f32 v245, v245, v37
    s_waitcnt lgkmcnt(5)
    v_add_f32 v246, v246, v38
    s_waitcnt lgkmcnt(4)
    v_add_f32 v247, v247, v39
    s_waitcnt lgkmcnt(3)
    v_add_f32 v248, v248, v40
    s_waitcnt lgkmcnt(2)
    v_add_f32 v249, v249, v41
    s_waitcnt lgkmcnt(1)
    v_add_f32 v250, v250, v42
    s_waitcnt lgkmcnt(0)
    v_add_f32 v251, v251, v43
    v_cvt_pk_bf16_f32 v112, v224, v240
    v_cvt_pk_bf16_f32 v113, v225, v241
    v_cvt_pk_bf16_f32 v114, v226, v242
    v_cvt_pk_bf16_f32 v115, v227, v243
    v_cvt_pk_bf16_f32 v116, v228, v244
    v_cvt_pk_bf16_f32 v117, v229, v245
    v_cvt_pk_bf16_f32 v118, v230, v246
    v_cvt_pk_bf16_f32 v119, v231, v247
    v_cvt_pk_bf16_f32 v120, v232, v248
    v_cvt_pk_bf16_f32 v121, v233, v249
    v_cvt_pk_bf16_f32 v122, v234, v250
    v_cvt_pk_bf16_f32 v123, v235, v251
    buffer_store_dword v112, v12, s[32:35], s40 offen offset:384 sc1 nt
    buffer_store_dword v113, v12, s[32:35], s40 offen offset:896 sc1 nt
    buffer_store_dword v114, v12, s[32:35], s40 offen offset:1408 sc1 nt
    buffer_store_dword v115, v12, s[32:35], s40 offen offset:1920 sc1 nt
    buffer_store_dword v116, v12, s[32:35], s41 offen offset:384 sc1 nt
    buffer_store_dword v117, v12, s[32:35], s41 offen offset:896 sc1 nt
    buffer_store_dword v118, v12, s[32:35], s41 offen offset:1408 sc1 nt
    buffer_store_dword v119, v12, s[32:35], s41 offen offset:1920 sc1 nt
    buffer_store_dword v120, v12, s[32:35], s42 offen offset:384 sc1 nt
    buffer_store_dword v121, v12, s[32:35], s42 offen offset:896 sc1 nt
    buffer_store_dword v122, v12, s[32:35], s42 offen offset:1408 sc1 nt
    buffer_store_dword v123, v12, s[32:35], s42 offen offset:1920 sc1 nt
    s_cmp_le_u32 s45, 24
    s_cbranch_scc1 M_fin
    v_cvt_pk_bf16_f32 v76, v140, v156
    v_cvt_pk_bf16_f32 v77, v141, v157
    v_cvt_pk_bf16_f32 v78, v142, v158
    v_cvt_pk_bf16_f32 v79, v143, v159
    buffer_store_dword v76, v12, s[32:35], s43 offen offset:0 sc1 nt
    buffer_store_dword v77, v12, s[32:35], s43 offen offset:512 sc1 nt
    buffer_store_dword v78, v12, s[32:35], s43 offen offset:1024 sc1 nt
    buffer_store_dword v79, v12, s[32:35], s43 offen offset:1536 sc1 nt
    v_cvt_pk_bf16_f32 v92, v172, v188
    v_cvt_pk_bf16_f32 v93, v173, v189
    v_cvt_pk_bf16_f32 v94, v174, v190
    v_cvt_pk_bf16_f32 v95, v175, v191
    buffer_store_dword v92, v12, s[32:35], s43 offen offset:128 sc1 nt
    buffer_store_dword v93, v12, s[32:35], s43 offen offset:640 sc1 nt
    buffer_store_dword v94, v12, s[32:35], s43 offen offset:1152 sc1 nt
    buffer_store_dword v95, v12, s[32:35], s43 offen offset:1664 sc1 nt
    ds_read_u16_d16_hi v28, v2 offset:10240
    ds_read_u16_d16_hi v29, v2 offset:10496
    ds_read_u16_d16_hi v30, v2 offset:10752
    ds_read_u16_d16_hi v31, v2 offset:11008
    ds_read_u16_d16_hi v44, v2 offset:10242
    ds_read_u16_d16_hi v45, v2 offset:10498
    ds_read_u16_d16_hi v46, v2 offset:10754
    ds_read_u16_d16_hi v47, v2 offset:11010
    s_waitcnt lgkmcnt(7)
    v_add_f32 v204, v204, v28
    s_waitcnt lgkmcnt(6)
    v_add_f32 v205, v205, v29
    s_waitcnt lgkmcnt(5)
    v_add_f32 v206, v206, v30
    s_waitcnt lgkmcnt(4)
    v_add_f32 v207, v207, v31
    s_waitcnt lgkmcnt(3)
    v_add_f32 v220, v220, v44
    s_waitcnt lgkmcnt(2)
    v_add_f32 v221, v221, v45
    s_waitcnt lgkmcnt(1)
    v_add_f32 v222, v222, v46
    s_waitcnt lgkmcnt(0)
    v_add_f32 v223, v223, v47
    v_cvt_pk_bf16_f32 v108, v204, v220
    v_cvt_pk_bf16_f32 v109, v205, v221
    v_cvt_pk_bf16_f32 v110, v206, v222
    v_cvt_pk_bf16_f32 v111, v207, v223
    buffer_store_dword v108, v12, s[32:35], s43 offen offset:256 sc1 nt
    buffer_store_dword v109, v12, s[32:35], s43 offen offset:768 sc1 nt
    buffer_store_dword v110, v12, s[32:35], s43 offen offset:1280 sc1 nt
    buffer_store_dword v111, v12, s[32:35], s43 offen offset:1792 sc1 nt
    ds_read_u16_d16_hi v28, v2 offset:11264
    ds_read_u16_d16_hi v29, v2 offset:11520
    ds_read_u16_d16_hi v30, v2 offset:11776
    ds_read_u16_d16_hi v31, v2 offset:12032
    ds_read_u16_d16_hi v44, v2 offset:11266
    ds_read_u16_d16_hi v45, v2 offset:11522
    ds_read_u16_d16_hi v46, v2 offset:11778
    ds_read_u16_d16_hi v47, v2 offset:12034
    s_waitcnt lgkmcnt(7)
    v_add_f32 v236, v236, v28
    s_waitcnt lgkmcnt(6)
    v_add_f32 v237, v237, v29
    s_waitcnt lgkmcnt(5)
    v_add_f32 v238, v238, v30
    s_waitcnt lgkmcnt(4)
    v_add_f32 v239, v239, v31
    s_waitcnt lgkmcnt(3)
    v_add_f32 v252, v252, v44
    s_waitcnt lgkmcnt(2)
    v_add_f32 v253, v253, v45
    s_waitcnt lgkmcnt(1)
    v_add_f32 v254, v254, v46
    s_waitcnt lgkmcnt(0)
    v_add_f32 v255, v255, v47
    v_cvt_pk_bf16_f32 v124, v236, v252
    v_cvt_pk_bf16_f32 v125, v237, v253
    v_cvt_pk_bf16_f32 v126, v238, v254
    v_cvt_pk_bf16_f32 v127, v239, v255
    buffer_store_dword v124, v12, s[32:35], s43 offen offset:384 sc1 nt
    buffer_store_dword v125, v12, s[32:35], s43 offen offset:896 sc1 nt
    buffer_store_dword v126, v12, s[32:35], s43 offen offset:1408 sc1 nt
    buffer_store_dword v127, v12, s[32:35], s43 offen offset:1920 sc1 nt
M_fin:
M_end:
    s_endpgm
.section .rodata,"a"
.p2align 6
.amdhsa_kernel prep_kernel
  .amdhsa_next_free_vgpr 128
  .amdhsa_next_free_sgpr 96
  .amdhsa_accum_offset 128
  .amdhsa_group_segment_fixed_size 0
  .amdhsa_kernarg_size 88
  .amdhsa_user_sgpr_count 2
  .amdhsa_user_sgpr_kernarg_segment_ptr 1
  .amdhsa_system_sgpr_workgroup_id_x 1
  .amdhsa_float_denorm_mode_32 3
.end_amdhsa_kernel
.p2align 6
.amdhsa_kernel main_kernel
  .amdhsa_next_free_vgpr 256
  .amdhsa_next_free_sgpr 96
  .amdhsa_accum_offset 256
  .amdhsa_group_segment_fixed_size 0
  .amdhsa_kernarg_size 88
  .amdhsa_user_sgpr_count 2
  .amdhsa_user_sgpr_kernarg_segment_ptr 1
  .amdhsa_system_sgpr_workgroup_id_x 1
  .amdhsa_float_denorm_mode_32 3
.end_amdhsa_kernel
```

```asm
; @launch kernel=fused_kernel grid=(250,1,1) block=(512,1,1) lds=163840
.amdgcn_target "amdgcn-amd-amdhsa--gfx950"
.text
.globl fused_kernel
.p2align 8
.type fused_kernel,@function
fused_kernel:
    s_cmp_ge_u32 s2, 250
    s_cbranch_scc1 K_end
    s_load_dwordx8 s[4:11], s[0:1], 0
    s_load_dwordx8 s[12:19], s[0:1], 32
    s_load_dwordx2 s[20:21], s[0:1], 64
    s_load_dwordx2 s[24:25], s[0:1], 80
    v_and_b32 v1, 63, v0
    v_lshrrev_b32 v119, 6, v0
    v_lshlrev_b32 v2, 4, v0
    v_readfirstlane_b32 s26, v119
    v_mov_b32 v20, 0xff000000
    v_mov_b32 v21, v20
    v_mov_b32 v22, v20
    v_mov_b32 v23, v20
    v_add_u32 v117, 131840, v2
    ds_write_b128 v117, v[20:23] offset:0
    ds_write_b128 v117, v[20:23] offset:8192
    ds_write_b128 v117, v[20:23] offset:16384
    v_cmp_gt_u32 vcc, 464, v0
    s_mov_b64 s[66:67], vcc
    s_mov_b64 exec, vcc
    ds_write_b128 v117, v[20:23] offset:24576
    s_mov_b64 exec, -1
    v_lshlrev_b32 v28, 2, v0
    v_mov_b32 v29, 0
    v_cmp_gt_u32 vcc, 256, v0
    s_and_saveexec_b64 s[60:61], vcc
    ds_write_b32 v28, v29 offset:8192
    s_mov_b64 exec, s[60:61]
    v_mov_b32 v30, 131076
    ds_write2_b32 v30, v29, v29 offset1:1
    s_mov_b32 s58, 0xffff0000
    v_lshlrev_b32 v3, 4, v1
    v_mov_b32 v116, 1
    v_lshrrev_b32 v119, 4, v1
    v_and_b32 v120, 15, v1
    v_lshlrev_b32 v121, 9, v120
    v_lshl_add_u32 v121, v119, 4, v121
    v_bfrev_b32 v118, 2
    s_cmp_eq_u32 s26, 4
    s_cselect_b32 s63, 8, 16
    s_cmp_gt_u32 s26, 4
    s_cselect_b32 s63, 0, s63
    v_cmp_gt_u32 vcc, s63, v120
    s_nop 1
    v_cndmask_b32 v36, v118, v121, vcc
    s_mul_i32 s62, s2, 200
    s_lshl_b32 s61, s26, 4
    s_add_u32 s62, s62, s61
    s_lshl_b32 s76, s62, 9
    s_add_u32 s77, s76, 65536
    s_mul_i32 s27, s2, 12800
    s_add_u32 s59, s27, 6400
    v_cmp_gt_u32 vcc, 400, v0
    s_mov_b64 s[56:57], vcc
    s_lshl_b32 s64, s26, 10
    s_add_u32 m0, s64, 0
    s_waitcnt lgkmcnt(0)
    s_barrier
    s_mov_b32 s48, s14
    s_mov_b32 s49, s15
    s_mov_b32 s50, 0x2000
    s_mov_b32 s51, 0x00020000
    s_cmp_eq_u32 s26, 7
    s_cbranch_scc1 P_w7
    s_mov_b32 s44, s10
    s_mov_b32 s45, s11
    s_mov_b32 s46, 0x30d400
    s_mov_b32 s47, 0x00020000
    s_mov_b32 s40, s8
    s_mov_b32 s41, s9
    s_mov_b32 s42, 0x30d400
    s_mov_b32 s43, 0x00020000
    s_mov_b32 s28, s4
    s_mov_b32 s29, s5
    s_mov_b32 s30, 0x186a000
    s_mov_b32 s31, 0x00020000
    buffer_load_dwordx4 v3, s[48:51], s64 offen lds
    s_mov_b64 exec, s[56:57]
    buffer_load_dwordx4 v[4:7], v2, s[44:47], s27 offen nt
    buffer_load_dwordx4 v[8:11], v2, s[44:47], s59 offen nt
    buffer_load_dwordx4 v[12:15], v2, s[40:43], s27 offen nt
    buffer_load_dwordx4 v[16:19], v2, s[40:43], s59 offen nt
    s_mov_b64 exec, -1
    buffer_load_dwordx4 v[20:23], v121, s[28:31], s76 offen offset:0
    buffer_load_dwordx4 v[24:27], v121, s[28:31], s76 offen offset:64
    buffer_load_dwordx4 v[28:31], v36, s[28:31], s77 offen offset:0
    buffer_load_dwordx4 v[32:35], v36, s[28:31], s77 offen offset:64
    s_mov_b32 s92, s6
    s_mov_b32 s93, s7
    s_mov_b32 s94, 0x493e0
    s_mov_b32 s95, 0x00020000
    s_mov_b32 s36, s24
    s_mov_b32 s37, s25
    s_mov_b32 s38, 0x241a800
    s_mov_b32 s39, 0x00020000
    s_add_u32 s72, s24, 0x1e00000
    s_addc_u32 s73, s25, 0
    s_mov_b32 s74, 0x61a800
    s_mov_b32 s75, 0x00020000
    s_mov_b32 s52, s16
    s_mov_b32 s53, s17
    s_mov_b32 s54, 0x6000
    s_mov_b32 s55, 0x00020000
    s_mov_b32 s96, s18
    s_mov_b32 s97, s19
    s_mov_b32 s98, 0x1800
    s_mov_b32 s99, 0x00020000
    s_mov_b32 s68, s12
    s_mov_b32 s69, s13
    s_mov_b32 s70, 0x20
    s_mov_b32 s71, 0x00020000
    s_mov_b32 s32, s20
    s_mov_b32 s33, s21
    s_mov_b32 s34, 0x186a000
    s_mov_b32 s35, 0x00020000
    v_bfe_u32 v122, v1, 2, 2
    v_lshl_add_u32 v122, v119, 3, v122
    v_lshlrev_b32 v122, 7, v122
    v_and_b32 v39, 3, v1
    v_lshl_add_u32 v122, v39, 3, v122
    s_mov_b32 s63, 0x147AE15
    s_movk_i32 s65, -200
    s_mov_b32 s60, 8192
    s_mov_b32 s61, 131840
    s_mov_b64 exec, s[56:57]
    s_waitcnt vmcnt(7)
    v_mul_hi_u32 v68, v4, s63
    v_lshl_add_u32 v84, v68, 2, s60
    ds_add_rtn_u32 v76, v84, v116
    v_mul_hi_u32 v69, v5, s63
    v_lshl_add_u32 v85, v69, 2, s60
    ds_add_rtn_u32 v77, v85, v116
    v_mul_hi_u32 v70, v6, s63
    v_lshl_add_u32 v86, v70, 2, s60
    ds_add_rtn_u32 v78, v86, v116
    v_mul_hi_u32 v71, v7, s63
    v_lshl_add_u32 v87, v71, 2, s60
    ds_add_rtn_u32 v79, v87, v116
    s_waitcnt vmcnt(6)
    v_mul_hi_u32 v72, v8, s63
    v_lshl_add_u32 v88, v72, 2, s60
    ds_add_rtn_u32 v80, v88, v116
    v_mul_hi_u32 v73, v9, s63
    v_lshl_add_u32 v89, v73, 2, s60
    ds_add_rtn_u32 v81, v89, v116
    v_mul_hi_u32 v74, v10, s63
    v_lshl_add_u32 v90, v74, 2, s60
    ds_add_rtn_u32 v82, v90, v116
    v_mul_hi_u32 v75, v11, s63
    v_lshl_add_u32 v91, v75, 2, s60
    ds_add_rtn_u32 v83, v91, v116
    v_mad_i32_i24 v4, v68, s65, v4
    v_lshlrev_b32 v4, 24, v4
    v_lshl_add_u32 v84, v68, 7, s61
    v_mad_i32_i24 v5, v69, s65, v5
    v_lshlrev_b32 v5, 24, v5
    v_lshl_add_u32 v85, v69, 7, s61
    v_mad_i32_i24 v6, v70, s65, v6
    v_lshlrev_b32 v6, 24, v6
    v_lshl_add_u32 v86, v70, 7, s61
    v_mad_i32_i24 v7, v71, s65, v7
    v_lshlrev_b32 v7, 24, v7
    v_lshl_add_u32 v87, v71, 7, s61
    v_mad_i32_i24 v8, v72, s65, v8
    v_lshlrev_b32 v8, 24, v8
    v_lshl_add_u32 v88, v72, 7, s61
    v_mad_i32_i24 v9, v73, s65, v9
    v_lshlrev_b32 v9, 24, v9
    v_lshl_add_u32 v89, v73, 7, s61
    v_mad_i32_i24 v10, v74, s65, v10
    v_lshlrev_b32 v10, 24, v10
    v_lshl_add_u32 v90, v74, 7, s61
    v_mad_i32_i24 v11, v75, s65, v11
    v_lshlrev_b32 v11, 24, v11
    v_lshl_add_u32 v91, v75, 7, s61
    s_waitcnt vmcnt(4)
    v_lshl_or_b32 v92, v12, 1, v4
    v_lshl_or_b32 v93, v13, 1, v5
    v_lshl_or_b32 v94, v14, 1, v6
    v_lshl_or_b32 v95, v15, 1, v7
    v_lshl_or_b32 v96, v16, 1, v8
    v_lshl_or_b32 v97, v17, 1, v9
    v_lshl_or_b32 v98, v18, 1, v10
    v_lshl_or_b32 v99, v19, 1, v11
    s_waitcnt lgkmcnt(0)
    v_max3_u32 v36, v76, v77, v78
    v_max3_u32 v37, v79, v80, v81
    v_max3_u32 v36, v36, v82, v83
    v_max_u32 v36, v36, v37
    v_lshl_add_u32 v12, v76, 2, v84
    v_lshl_add_u32 v13, v77, 2, v85
    v_lshl_add_u32 v14, v78, 2, v86
    v_lshl_add_u32 v15, v79, 2, v87
    v_lshl_add_u32 v16, v80, 2, v88
    v_lshl_add_u32 v17, v81, 2, v89
    v_lshl_add_u32 v18, v82, 2, v90
    v_lshl_add_u32 v19, v83, 2, v91
    v_cmp_lt_u32 vcc, 30, v36
    s_nop 4
    s_cbranch_vccnz P_rare
    ds_write_b32 v12, v92
    ds_write_b32 v13, v93
    ds_write_b32 v14, v94
    ds_write_b32 v15, v95
    ds_write_b32 v16, v96
    ds_write_b32 v17, v97
    ds_write_b32 v18, v98
    ds_write_b32 v19, v99
    s_mov_b64 exec, -1
    s_branch P_join
P_rare:
    v_mov_b32 v37, 131080
    v_mov_b32 v38, 131076
    s_mul_i32 s27, s2, 32768
    s_add_u32 s27, s27, 0x1100000
    s_lshl_b32 s59, s2, 15
    s_add_u32 s59, s59, 0x8fff84
    s_mov_b64 exec, s[56:57]
    v_cmp_gt_u32 vcc, 31, v76
    s_and_b64 exec, vcc, s[56:57]
    s_nop 3
    s_cbranch_execz P_r10
    ds_write_b32 v12, v92
P_r10:
    s_andn2_b64 exec, s[56:57], vcc
    s_cbranch_execz P_r30
    s_mov_b64 s[14:15], exec
    v_add_u32 v36, 0xfeffffe2, v76
    ds_max_u32 v84, v36 offset:124
    v_cmp_gt_u32 vcc, 63, v76
    s_and_b64 exec, vcc, s[14:15]
    s_nop 3
    s_cbranch_execz P_r20
    v_lshlrev_b32 v124, 7, v68
    v_lshl_add_u32 v124, v76, 2, v124
    buffer_store_dword v92, v124, s[36:39], s59 offen sc1
    s_nop 0
P_r20:
    s_andn2_b64 exec, s[14:15], vcc
    s_cbranch_execz P_r30
    ds_write_b32 v38, v116
    ds_add_rtn_u32 v124, v37, v116
    v_mov_b32 v126, v92
    v_mov_b32 v127, v68
    s_waitcnt lgkmcnt(0)
    v_lshlrev_b32 v124, 3, v124
    buffer_store_dwordx2 v[126:127], v124, s[36:39], s27 offen sc1
    s_nop 0
P_r30:
    s_mov_b64 exec, s[56:57]
    v_cmp_gt_u32 vcc, 31, v77
    s_and_b64 exec, vcc, s[56:57]
    s_nop 3
    s_cbranch_execz P_r11
    ds_write_b32 v13, v93
P_r11:
    s_andn2_b64 exec, s[56:57], vcc
    s_cbranch_execz P_r31
    s_mov_b64 s[14:15], exec
    v_add_u32 v36, 0xfeffffe2, v77
    ds_max_u32 v85, v36 offset:124
    v_cmp_gt_u32 vcc, 63, v77
    s_and_b64 exec, vcc, s[14:15]
    s_nop 3
    s_cbranch_execz P_r21
    v_lshlrev_b32 v124, 7, v69
    v_lshl_add_u32 v124, v77, 2, v124
    buffer_store_dword v93, v124, s[36:39], s59 offen sc1
    s_nop 0
P_r21:
    s_andn2_b64 exec, s[14:15], vcc
    s_cbranch_execz P_r31
    ds_write_b32 v38, v116
    ds_add_rtn_u32 v124, v37, v116
    v_mov_b32 v126, v93
    v_mov_b32 v127, v69
    s_waitcnt lgkmcnt(0)
    v_lshlrev_b32 v124, 3, v124
    buffer_store_dwordx2 v[126:127], v124, s[36:39], s27 offen sc1
    s_nop 0
P_r31:
    s_mov_b64 exec, s[56:57]
    v_cmp_gt_u32 vcc, 31, v78
    s_and_b64 exec, vcc, s[56:57]
    s_nop 3
    s_cbranch_execz P_r12
    ds_write_b32 v14, v94
P_r12:
    s_andn2_b64 exec, s[56:57], vcc
    s_cbranch_execz P_r32
    s_mov_b64 s[14:15], exec
    v_add_u32 v36, 0xfeffffe2, v78
    ds_max_u32 v86, v36 offset:124
    v_cmp_gt_u32 vcc, 63, v78
    s_and_b64 exec, vcc, s[14:15]
    s_nop 3
    s_cbranch_execz P_r22
    v_lshlrev_b32 v124, 7, v70
    v_lshl_add_u32 v124, v78, 2, v124
    buffer_store_dword v94, v124, s[36:39], s59 offen sc1
    s_nop 0
P_r22:
    s_andn2_b64 exec, s[14:15], vcc
    s_cbranch_execz P_r32
    ds_write_b32 v38, v116
    ds_add_rtn_u32 v124, v37, v116
    v_mov_b32 v126, v94
    v_mov_b32 v127, v70
    s_waitcnt lgkmcnt(0)
    v_lshlrev_b32 v124, 3, v124
    buffer_store_dwordx2 v[126:127], v124, s[36:39], s27 offen sc1
    s_nop 0
P_r32:
    s_mov_b64 exec, s[56:57]
    v_cmp_gt_u32 vcc, 31, v79
    s_and_b64 exec, vcc, s[56:57]
    s_nop 3
    s_cbranch_execz P_r13
    ds_write_b32 v15, v95
P_r13:
    s_andn2_b64 exec, s[56:57], vcc
    s_cbranch_execz P_r33
    s_mov_b64 s[14:15], exec
    v_add_u32 v36, 0xfeffffe2, v79
    ds_max_u32 v87, v36 offset:124
    v_cmp_gt_u32 vcc, 63, v79
    s_and_b64 exec, vcc, s[14:15]
    s_nop 3
    s_cbranch_execz P_r23
    v_lshlrev_b32 v124, 7, v71
    v_lshl_add_u32 v124, v79, 2, v124
    buffer_store_dword v95, v124, s[36:39], s59 offen sc1
    s_nop 0
P_r23:
    s_andn2_b64 exec, s[14:15], vcc
    s_cbranch_execz P_r33
    ds_write_b32 v38, v116
    ds_add_rtn_u32 v124, v37, v116
    v_mov_b32 v126, v95
    v_mov_b32 v127, v71
    s_waitcnt lgkmcnt(0)
    v_lshlrev_b32 v124, 3, v124
    buffer_store_dwordx2 v[126:127], v124, s[36:39], s27 offen sc1
    s_nop 0
P_r33:
    s_mov_b64 exec, s[56:57]
    v_cmp_gt_u32 vcc, 31, v80
    s_and_b64 exec, vcc, s[56:57]
    s_nop 3
    s_cbranch_execz P_r14
    ds_write_b32 v16, v96
P_r14:
    s_andn2_b64 exec, s[56:57], vcc
    s_cbranch_execz P_r34
    s_mov_b64 s[14:15], exec
    v_add_u32 v36, 0xfeffffe2, v80
    ds_max_u32 v88, v36 offset:124
    v_cmp_gt_u32 vcc, 63, v80
    s_and_b64 exec, vcc, s[14:15]
    s_nop 3
    s_cbranch_execz P_r24
    v_lshlrev_b32 v124, 7, v72
    v_lshl_add_u32 v124, v80, 2, v124
    buffer_store_dword v96, v124, s[36:39], s59 offen sc1
    s_nop 0
P_r24:
    s_andn2_b64 exec, s[14:15], vcc
    s_cbranch_execz P_r34
    ds_write_b32 v38, v116
    ds_add_rtn_u32 v124, v37, v116
    v_mov_b32 v126, v96
    v_mov_b32 v127, v72
    s_waitcnt lgkmcnt(0)
    v_lshlrev_b32 v124, 3, v124
    buffer_store_dwordx2 v[126:127], v124, s[36:39], s27 offen sc1
    s_nop 0
P_r34:
    s_mov_b64 exec, s[56:57]
    v_cmp_gt_u32 vcc, 31, v81
    s_and_b64 exec, vcc, s[56:57]
    s_nop 3
    s_cbranch_execz P_r15
    ds_write_b32 v17, v97
P_r15:
    s_andn2_b64 exec, s[56:57], vcc
    s_cbranch_execz P_r35
    s_mov_b64 s[14:15], exec
    v_add_u32 v36, 0xfeffffe2, v81
    ds_max_u32 v89, v36 offset:124
    v_cmp_gt_u32 vcc, 63, v81
    s_and_b64 exec, vcc, s[14:15]
    s_nop 3
    s_cbranch_execz P_r25
    v_lshlrev_b32 v124, 7, v73
    v_lshl_add_u32 v124, v81, 2, v124
    buffer_store_dword v97, v124, s[36:39], s59 offen sc1
    s_nop 0
P_r25:
    s_andn2_b64 exec, s[14:15], vcc
    s_cbranch_execz P_r35
    ds_write_b32 v38, v116
    ds_add_rtn_u32 v124, v37, v116
    v_mov_b32 v126, v97
    v_mov_b32 v127, v73
    s_waitcnt lgkmcnt(0)
    v_lshlrev_b32 v124, 3, v124
    buffer_store_dwordx2 v[126:127], v124, s[36:39], s27 offen sc1
    s_nop 0
P_r35:
    s_mov_b64 exec, s[56:57]
    v_cmp_gt_u32 vcc, 31, v82
    s_and_b64 exec, vcc, s[56:57]
    s_nop 3
    s_cbranch_execz P_r16
    ds_write_b32 v18, v98
P_r16:
    s_andn2_b64 exec, s[56:57], vcc
    s_cbranch_execz P_r36
    s_mov_b64 s[14:15], exec
    v_add_u32 v36, 0xfeffffe2, v82
    ds_max_u32 v90, v36 offset:124
    v_cmp_gt_u32 vcc, 63, v82
    s_and_b64 exec, vcc, s[14:15]
    s_nop 3
    s_cbranch_execz P_r26
    v_lshlrev_b32 v124, 7, v74
    v_lshl_add_u32 v124, v82, 2, v124
    buffer_store_dword v98, v124, s[36:39], s59 offen sc1
    s_nop 0
P_r26:
    s_andn2_b64 exec, s[14:15], vcc
    s_cbranch_execz P_r36
    ds_write_b32 v38, v116
    ds_add_rtn_u32 v124, v37, v116
    v_mov_b32 v126, v98
    v_mov_b32 v127, v74
    s_waitcnt lgkmcnt(0)
    v_lshlrev_b32 v124, 3, v124
    buffer_store_dwordx2 v[126:127], v124, s[36:39], s27 offen sc1
    s_nop 0
P_r36:
    s_mov_b64 exec, s[56:57]
    v_cmp_gt_u32 vcc, 31, v83
    s_and_b64 exec, vcc, s[56:57]
    s_nop 3
    s_cbranch_execz P_r17
    ds_write_b32 v19, v99
P_r17:
    s_andn2_b64 exec, s[56:57], vcc
    s_cbranch_execz P_r37
    s_mov_b64 s[14:15], exec
    v_add_u32 v36, 0xfeffffe2, v83
    ds_max_u32 v91, v36 offset:124
    v_cmp_gt_u32 vcc, 63, v83
    s_and_b64 exec, vcc, s[14:15]
    s_nop 3
    s_cbranch_execz P_r27
    v_lshlrev_b32 v124, 7, v75
    v_lshl_add_u32 v124, v83, 2, v124
    buffer_store_dword v99, v124, s[36:39], s59 offen sc1
    s_nop 0
P_r27:
    s_andn2_b64 exec, s[14:15], vcc
    s_cbranch_execz P_r37
    ds_write_b32 v38, v116
    ds_add_rtn_u32 v124, v37, v116
    v_mov_b32 v126, v99
    v_mov_b32 v127, v75
    s_waitcnt lgkmcnt(0)
    v_lshlrev_b32 v124, 3, v124
    buffer_store_dwordx2 v[126:127], v124, s[36:39], s27 offen sc1
    s_nop 0
P_r37:
    s_mov_b64 exec, -1
    s_waitcnt vmcnt(0)
    s_branch P_join
P_w7:
    s_mov_b32 s27, 0x830000
    s_mov_b32 s92, s6
    s_mov_b32 s93, s7
    s_mov_b32 s94, 0x493e0
    s_mov_b32 s95, 0x00020000
    s_mul_i32 s65, s2, 1536
    v_mul_u32_u24 v38, 24, v1
    s_cmp_ge_u32 s2, 196
    s_cselect_b32 s65, 0x40000000, s65
    buffer_load_dwordx3 v[4:6], v38, s[92:95], s65 offen
    buffer_load_dwordx3 v[8:10], v38, s[92:95], s65 offen offset:12
    buffer_load_dwordx4 v3, s[48:51], s64 offen lds
    s_load_dword s22, s[24:25], s27
    s_mov_b32 s28, s4
    s_mov_b32 s29, s5
    s_mov_b32 s30, 0x186a000
    s_mov_b32 s31, 0x00020000
    s_mov_b32 s92, s6
    s_mov_b32 s93, s7
    s_mov_b32 s94, 0x493e0
    s_mov_b32 s95, 0x00020000
    s_mov_b32 s36, s24
    s_mov_b32 s37, s25
    s_mov_b32 s38, 0x241a800
    s_mov_b32 s39, 0x00020000
    s_add_u32 s72, s24, 0x1e00000
    s_addc_u32 s73, s25, 0
    s_mov_b32 s74, 0x61a800
    s_mov_b32 s75, 0x00020000
    s_mov_b32 s52, s16
    s_mov_b32 s53, s17
    s_mov_b32 s54, 0x6000
    s_mov_b32 s55, 0x00020000
    s_mov_b32 s96, s18
    s_mov_b32 s97, s19
    s_mov_b32 s98, 0x1800
    s_mov_b32 s99, 0x00020000
    s_mov_b32 s68, s12
    s_mov_b32 s69, s13
    s_mov_b32 s70, 0x20
    s_mov_b32 s71, 0x00020000
    s_mov_b32 s32, s20
    s_mov_b32 s33, s21
    s_mov_b32 s34, 0x186a000
    s_mov_b32 s35, 0x00020000
    v_bfe_u32 v122, v1, 2, 2
    v_lshl_add_u32 v122, v119, 3, v122
    v_lshlrev_b32 v122, 7, v122
    v_and_b32 v39, 3, v1
    v_lshl_add_u32 v122, v39, 3, v122
    s_cmp_ge_u32 s2, 196
    s_nop 0
    s_cbranch_scc1 P_w7n
    s_mov_b32 s60, 0x41800000
    s_movk_i32 s65, 0xf8
    s_waitcnt vmcnt(1)
    v_lshlrev_b32 v68, 16, v4
    v_and_b32 v69, s58, v4
    v_lshlrev_b32 v70, 16, v5
    v_and_b32 v71, s58, v5
    v_lshlrev_b32 v72, 16, v6
    v_and_b32 v73, s58, v6
    v_lshlrev_b32 v74, 16, v8
    v_and_b32 v75, s58, v8
    v_lshlrev_b32 v76, 16, v9
    v_and_b32 v77, s58, v9
    v_lshlrev_b32 v78, 16, v10
    v_and_b32 v79, s58, v10
    v_mul_f32 v68, s60, v68
    v_mul_f32 v69, s60, v69
    v_mul_f32 v70, s60, v70
    v_mul_f32 v71, s60, v71
    v_mul_f32 v72, s60, v72
    v_mul_f32 v73, s60, v73
    v_mul_f32 v74, s60, v74
    v_mul_f32 v75, s60, v75
    v_mul_f32 v76, s60, v76
    v_mul_f32 v77, s60, v77
    v_mul_f32 v78, s60, v78
    v_mul_f32 v79, s60, v79
    v_cvt_flr_i32_f32 v68, v68
    v_cvt_flr_i32_f32 v69, v69
    v_cvt_flr_i32_f32 v70, v70
    v_cvt_flr_i32_f32 v71, v71
    v_cvt_flr_i32_f32 v72, v72
    v_cvt_flr_i32_f32 v73, v73
    v_cvt_flr_i32_f32 v74, v74
    v_cvt_flr_i32_f32 v75, v75
    v_cvt_flr_i32_f32 v76, v76
    v_cvt_flr_i32_f32 v77, v77
    v_cvt_flr_i32_f32 v78, v78
    v_cvt_flr_i32_f32 v79, v79
    v_bfe_u32 v84, v70, 5, 3
    v_bfe_u32 v85, v70, 2, 3
    v_and_or_b32 v68, v68, s65, v84
    v_and_or_b32 v69, v69, s65, v85
    v_lshl_or_b32 v68, v69, 8, v68
    v_bfe_u32 v84, v73, 5, 3
    v_bfe_u32 v85, v73, 2, 3
    v_and_or_b32 v71, v71, s65, v84
    v_and_or_b32 v72, v72, s65, v85
    v_lshl_or_b32 v71, v72, 8, v71
    v_bfe_u32 v84, v76, 5, 3
    v_bfe_u32 v85, v76, 2, 3
    v_and_or_b32 v74, v74, s65, v84
    v_and_or_b32 v75, v75, s65, v85
    v_lshl_or_b32 v74, v75, 8, v74
    v_bfe_u32 v84, v79, 5, 3
    v_bfe_u32 v85, v79, 2, 3
    v_and_or_b32 v77, v77, s65, v84
    v_and_or_b32 v78, v78, s65, v85
    v_lshl_or_b32 v77, v78, 8, v77
    v_lshl_or_b32 v86, v71, 16, v68
    v_lshl_or_b32 v87, v77, 16, v74
    v_lshlrev_b32 v38, 3, v1
    s_lshl_b32 s27, s2, 9
    s_add_u32 s27, s27, 0x810000
    buffer_store_dwordx2 v[86:87], v38, s[36:39], s27 offen sc1
P_w7n:
    buffer_load_dwordx4 v[20:23], v121, s[28:31], s76 offen offset:0
    buffer_load_dwordx4 v[24:27], v121, s[28:31], s76 offen offset:64
    s_waitcnt vmcnt(2) lgkmcnt(0)
    s_add_u32 s22, s22, 1
    v_mov_b32 v38, s22
    v_mov_b32 v39, 131072
    ds_write_b32 v39, v38
    s_cmp_ge_u32 s2, 196
    s_cbranch_scc1 P_join
    s_lshl_b32 s27, s2, 2
    s_add_u32 s27, s27, 0x830100
    v_mov_b32 v39, 0
    s_mov_b64 exec, 1
    buffer_store_dword v38, v39, s[36:39], s27 offen sc1
    s_mov_b64 exec, -1
P_join:
    s_lshl_b32 s23, s2, 15
    v_mov_b32 v4, 131072
    s_waitcnt lgkmcnt(0)
    s_barrier
    ds_read_b64 v[4:5], v4
    ds_read_b128 v[100:103], v117 offset:0
    ds_read_b128 v[104:107], v117 offset:8192
    ds_read_b128 v[108:111], v117 offset:16384
    ds_read_b128 v[112:115], v117 offset:24576
    s_waitcnt lgkmcnt(4)
    v_readfirstlane_b32 s18, v4
    v_readfirstlane_b32 s19, v5
    s_bfe_u32 s8, s18, 0x70001
    s_lshl_b32 s8, s8, 17
    s_bfe_u32 s27, s18, 0x10000
    s_or_b32 s8, s8, s27
    s_bfe_u32 s9, s18, 0x70009
    s_lshl_b32 s9, s9, 17
    s_bfe_u32 s27, s18, 0x10008
    s_or_b32 s9, s9, s27
    s_bfe_u32 s10, s18, 0x70011
    s_lshl_b32 s10, s10, 17
    s_bfe_u32 s27, s18, 0x10010
    s_or_b32 s10, s10, s27
    s_bfe_u32 s11, s18, 0x70019
    s_lshl_b32 s11, s11, 17
    s_bfe_u32 s27, s18, 0x10018
    s_or_b32 s11, s11, s27
    s_cmp_eq_u32 s19, 0
    s_cbranch_scc1 P_noovf
    v_mov_b32 v4, 131080
    ds_read_b32 v4, v4
    v_mov_b32 v5, 0
    s_add_u32 s27, s23, 32124
    s_waitcnt lgkmcnt(0)
    buffer_store_dword v4, v5, s[36:39], s27 offen sc1
    s_waitcnt vmcnt(0)
    s_barrier
P_noovf:
    s_waitcnt lgkmcnt(3)
    v_xor_b32 v100, s8, v100
    v_xor_b32 v101, s9, v101
    v_xor_b32 v102, s10, v102
    v_xor_b32 v103, s11, v103
    buffer_store_dwordx4 v[100:103], v2, s[36:39], s23 offen sc1
    s_waitcnt lgkmcnt(2)
    v_xor_b32 v104, s8, v104
    v_xor_b32 v105, s9, v105
    v_xor_b32 v106, s10, v106
    v_xor_b32 v107, s11, v107
    s_add_u32 s59, s23, 8192
    buffer_store_dwordx4 v[104:107], v2, s[36:39], s59 offen sc1
    s_waitcnt lgkmcnt(1)
    v_xor_b32 v108, s8, v108
    v_xor_b32 v109, s9, v109
    v_xor_b32 v110, s10, v110
    v_xor_b32 v111, s11, v111
    s_add_u32 s59, s23, 16384
    buffer_store_dwordx4 v[108:111], v2, s[36:39], s59 offen sc1
    s_waitcnt lgkmcnt(0)
    v_xor_b32 v112, s8, v112
    v_xor_b32 v113, s9, v113
    v_xor_b32 v114, s10, v114
    v_xor_b32 v115, s11, v115
    s_mov_b64 exec, s[66:67]
    s_add_u32 s59, s23, 24576
    buffer_store_dwordx4 v[112:115], v2, s[36:39], s59 offen sc1
    s_mov_b64 exec, -1
    ds_read_b64_tr_b16 v[36:37], v122 offset:0
    ds_read_b64_tr_b16 v[38:39], v122 offset:512
    ds_read_b64_tr_b16 v[40:41], v122 offset:4096
    ds_read_b64_tr_b16 v[42:43], v122 offset:4608
    ds_read_b64_tr_b16 v[44:45], v122 offset:32
    ds_read_b64_tr_b16 v[46:47], v122 offset:544
    ds_read_b64_tr_b16 v[48:49], v122 offset:4128
    ds_read_b64_tr_b16 v[50:51], v122 offset:4640
    ds_read_b64_tr_b16 v[52:53], v122 offset:64
    ds_read_b64_tr_b16 v[54:55], v122 offset:576
    ds_read_b64_tr_b16 v[56:57], v122 offset:4160
    ds_read_b64_tr_b16 v[58:59], v122 offset:4672
    ds_read_b64_tr_b16 v[60:61], v122 offset:96
    ds_read_b64_tr_b16 v[62:63], v122 offset:608
    ds_read_b64_tr_b16 v[64:65], v122 offset:4192
    ds_read_b64_tr_b16 v[66:67], v122 offset:4704
    v_lshrrev_b32 v124, 5, v1
    v_and_b32 v125, 31, v1
    v_mul_u32_u24 v124, 3072, v124
    v_lshl_add_u32 v124, v125, 2, v124
    s_lshr_b32 s60, s26, 2
    s_and_b32 s61, s26, 3
    s_mul_i32 s63, s61, 768
    s_lshl_b32 s65, s60, 7
    s_add_u32 s63, s63, s65
    s_add_u32 s65, s63, 0
    buffer_load_dword v128, v124, s[52:55], s65 offen
    s_add_u32 s65, s63, 6144
    buffer_load_dword v129, v124, s[52:55], s65 offen
    s_add_u32 s65, s63, 12288
    buffer_load_dword v130, v124, s[52:55], s65 offen
    s_add_u32 s65, s63, 18432
    buffer_load_dword v131, v124, s[52:55], s65 offen
    s_add_u32 s65, s63, 384
    buffer_load_dword v132, v124, s[52:55], s65 offen
    s_add_u32 s65, s63, 6528
    buffer_load_dword v133, v124, s[52:55], s65 offen
    s_add_u32 s65, s63, 12672
    buffer_load_dword v134, v124, s[52:55], s65 offen
    s_add_u32 s65, s63, 18816
    buffer_load_dword v135, v124, s[52:55], s65 offen
    s_cmp_ge_u32 s26, 4
    s_cbranch_scc1 P_e2
    s_add_u32 s27, s26, 8
    s_lshr_b32 s60, s27, 2
    s_and_b32 s61, s27, 3
    s_mul_i32 s63, s61, 768
    s_lshl_b32 s65, s60, 7
    s_add_u32 s63, s63, s65
    s_add_u32 s65, s63, 0
    buffer_load_dword v136, v124, s[52:55], s65 offen
    s_add_u32 s65, s63, 6144
    buffer_load_dword v137, v124, s[52:55], s65 offen
    s_add_u32 s65, s63, 12288
    buffer_load_dword v138, v124, s[52:55], s65 offen
    s_add_u32 s65, s63, 18432
    buffer_load_dword v139, v124, s[52:55], s65 offen
    s_add_u32 s65, s63, 384
    buffer_load_dword v140, v124, s[52:55], s65 offen
    s_add_u32 s65, s63, 6528
    buffer_load_dword v141, v124, s[52:55], s65 offen
    s_add_u32 s65, s63, 12672
    buffer_load_dword v142, v124, s[52:55], s65 offen
    s_add_u32 s65, s63, 18816
    buffer_load_dword v143, v124, s[52:55], s65 offen
    s_branch P_e3
P_e2:
    s_sub_u32 s60, s26, 4
    s_lshl_b32 s63, s60, 7
    s_cmp_eq_u32 s26, 7
    s_cselect_b32 s63, 0x40000000, s63
    buffer_load_dword v136, v124, s[96:99], s63 offen offset:0
    buffer_load_dword v137, v124, s[96:99], s63 offen offset:384
    buffer_load_dword v138, v124, s[96:99], s63 offen offset:768
    buffer_load_dword v139, v124, s[96:99], s63 offen offset:1152
    buffer_load_dword v140, v124, s[96:99], s63 offen offset:1536
    buffer_load_dword v141, v124, s[96:99], s63 offen offset:1920
    buffer_load_dword v142, v124, s[96:99], s63 offen offset:2304
    buffer_load_dword v143, v124, s[96:99], s63 offen offset:2688
P_e3:
    v_mul_u32_u24 v124, 6, v0
    v_and_b32 v124, -4, v124
    v_cmp_gt_u32 vcc, 200, v0
    s_nop 1
    v_cndmask_b32 v124, v118, v124, vcc
    s_mul_i32 s27, s2, 1200
    buffer_load_dwordx2 v[144:145], v124, s[92:95], s27 offen
    v_lshlrev_b32 v124, 1, v1
    buffer_load_ushort v146, v124, s[68:71], 0 offen
    v_mov_b32 v5, 0xbfb8aa3b
    v_mov_b32 v6, 1.0
    v_lshlrev_b32 v123, 9, v119
    v_lshl_add_u32 v123, v120, 3, v123
    s_lshl_b32 s27, s62, 7
    s_waitcnt lgkmcnt(0)
    s_barrier
    s_waitcnt vmcnt(22)
    v_mfma_f32_16x16x32_bf16 v[68:71], v[20:23], v[36:39], 0
    v_mfma_f32_16x16x32_bf16 v[72:75], v[20:23], v[44:47], 0
    v_mfma_f32_16x16x32_bf16 v[76:79], v[20:23], v[52:55], 0
    v_mfma_f32_16x16x32_bf16 v[80:83], v[20:23], v[60:63], 0
    v_mfma_f32_16x16x32_bf16 v[68:71], v[24:27], v[40:43], v[68:71]
    v_mfma_f32_16x16x32_bf16 v[72:75], v[24:27], v[48:51], v[72:75]
    v_mfma_f32_16x16x32_bf16 v[76:79], v[24:27], v[56:59], v[76:79]
    v_mfma_f32_16x16x32_bf16 v[80:83], v[24:27], v[64:67], v[80:83]
    s_nop 4
    v_cvt_pk_bf16_f32 v68, 0, v68
    v_cvt_pk_bf16_f32 v69, 0, v69
    v_cvt_pk_bf16_f32 v70, 0, v70
    v_cvt_pk_bf16_f32 v71, 0, v71
    v_cvt_pk_bf16_f32 v72, 0, v72
    v_cvt_pk_bf16_f32 v73, 0, v73
    v_cvt_pk_bf16_f32 v74, 0, v74
    v_cvt_pk_bf16_f32 v75, 0, v75
    v_cvt_pk_bf16_f32 v76, 0, v76
    v_cvt_pk_bf16_f32 v77, 0, v77
    v_cvt_pk_bf16_f32 v78, 0, v78
    v_cvt_pk_bf16_f32 v79, 0, v79
    v_cvt_pk_bf16_f32 v80, 0, v80
    v_cvt_pk_bf16_f32 v81, 0, v81
    v_cvt_pk_bf16_f32 v82, 0, v82
    v_cvt_pk_bf16_f32 v83, 0, v83
    v_mul_f32 v84, v5, v68
    v_mul_f32 v85, v5, v69
    v_mul_f32 v86, v5, v70
    v_mul_f32 v87, v5, v71
    v_mul_f32 v88, v5, v72
    v_mul_f32 v89, v5, v73
    v_mul_f32 v90, v5, v74
    v_mul_f32 v91, v5, v75
    v_mul_f32 v92, v5, v76
    v_mul_f32 v93, v5, v77
    v_mul_f32 v94, v5, v78
    v_mul_f32 v95, v5, v79
    v_mul_f32 v96, v5, v80
    v_mul_f32 v97, v5, v81
    v_mul_f32 v98, v5, v82
    v_mul_f32 v99, v5, v83
    v_exp_f32 v84, v84
    v_exp_f32 v85, v85
    v_exp_f32 v86, v86
    v_exp_f32 v87, v87
    v_exp_f32 v88, v88
    v_exp_f32 v89, v89
    v_exp_f32 v90, v90
    v_exp_f32 v91, v91
    v_exp_f32 v92, v92
    v_exp_f32 v93, v93
    v_exp_f32 v94, v94
    v_exp_f32 v95, v95
    v_exp_f32 v96, v96
    v_exp_f32 v97, v97
    v_exp_f32 v98, v98
    v_exp_f32 v99, v99
    v_add_f32 v84, v6, v84
    v_add_f32 v85, v6, v85
    v_add_f32 v86, v6, v86
    v_add_f32 v87, v6, v87
    v_add_f32 v88, v6, v88
    v_add_f32 v89, v6, v89
    v_add_f32 v90, v6, v90
    v_add_f32 v91, v6, v91
    v_add_f32 v92, v6, v92
    v_add_f32 v93, v6, v93
    v_add_f32 v94, v6, v94
    v_add_f32 v95, v6, v95
    v_add_f32 v96, v6, v96
    v_add_f32 v97, v6, v97
    v_add_f32 v98, v6, v98
    v_add_f32 v99, v6, v99
    v_rcp_f32 v84, v84
    v_rcp_f32 v85, v85
    v_rcp_f32 v86, v86
    v_rcp_f32 v87, v87
    v_rcp_f32 v88, v88
    v_rcp_f32 v89, v89
    v_rcp_f32 v90, v90
    v_rcp_f32 v91, v91
    v_rcp_f32 v92, v92
    v_rcp_f32 v93, v93
    v_rcp_f32 v94, v94
    v_rcp_f32 v95, v95
    v_rcp_f32 v96, v96
    v_rcp_f32 v97, v97
    v_rcp_f32 v98, v98
    v_rcp_f32 v99, v99
    v_mul_f32 v84, v68, v84
    v_mul_f32 v85, v69, v85
    v_mul_f32 v86, v70, v86
    v_mul_f32 v87, v71, v87
    v_mul_f32 v88, v72, v88
    v_mul_f32 v89, v73, v89
    v_mul_f32 v90, v74, v90
    v_mul_f32 v91, v75, v91
    v_mul_f32 v92, v76, v92
    v_mul_f32 v93, v77, v93
    v_mul_f32 v94, v78, v94
    v_mul_f32 v95, v79, v95
    v_mul_f32 v96, v80, v96
    v_mul_f32 v97, v81, v97
    v_mul_f32 v98, v82, v98
    v_mul_f32 v99, v83, v99
    v_cvt_pk_bf16_f32 v68, v84, v88
    v_cvt_pk_bf16_f32 v69, v92, v96
    buffer_store_dwordx2 v[68:69], v123, s[72:75], s27 offen offset:0 sc1
    v_cvt_pk_bf16_f32 v70, v85, v89
    v_cvt_pk_bf16_f32 v71, v93, v97
    buffer_store_dwordx2 v[70:71], v123, s[72:75], s27 offen offset:128 sc1
    v_cvt_pk_bf16_f32 v72, v86, v90
    v_cvt_pk_bf16_f32 v73, v94, v98
    buffer_store_dwordx2 v[72:73], v123, s[72:75], s27 offen offset:256 sc1
    v_cvt_pk_bf16_f32 v74, v87, v91
    v_cvt_pk_bf16_f32 v75, v95, v99
    buffer_store_dwordx2 v[74:75], v123, s[72:75], s27 offen offset:384 sc1
    s_cmp_gt_u32 s26, 4
    s_cbranch_scc1 P_h2
    s_cmp_eq_u32 s26, 4
    s_cselect_b32 s63, 2, 4
    v_cmp_gt_u32 vcc, s63, v119
    s_nop 1
    v_cndmask_b32 v7, v118, v123, vcc
    s_add_u32 s27, s27, 16384
    v_mfma_f32_16x16x32_bf16 v[68:71], v[28:31], v[36:39], 0
    v_mfma_f32_16x16x32_bf16 v[72:75], v[28:31], v[44:47], 0
    v_mfma_f32_16x16x32_bf16 v[76:79], v[28:31], v[52:55], 0
    v_mfma_f32_16x16x32_bf16 v[80:83], v[28:31], v[60:63], 0
    v_mfma_f32_16x16x32_bf16 v[68:71], v[32:35], v[40:43], v[68:71]
    v_mfma_f32_16x16x32_bf16 v[72:75], v[32:35], v[48:51], v[72:75]
    v_mfma_f32_16x16x32_bf16 v[76:79], v[32:35], v[56:59], v[76:79]
    v_mfma_f32_16x16x32_bf16 v[80:83], v[32:35], v[64:67], v[80:83]
    s_nop 4
    v_cvt_pk_bf16_f32 v68, 0, v68
    v_cvt_pk_bf16_f32 v69, 0, v69
    v_cvt_pk_bf16_f32 v70, 0, v70
    v_cvt_pk_bf16_f32 v71, 0, v71
    v_cvt_pk_bf16_f32 v72, 0, v72
    v_cvt_pk_bf16_f32 v73, 0, v73
    v_cvt_pk_bf16_f32 v74, 0, v74
    v_cvt_pk_bf16_f32 v75, 0, v75
    v_cvt_pk_bf16_f32 v76, 0, v76
    v_cvt_pk_bf16_f32 v77, 0, v77
    v_cvt_pk_bf16_f32 v78, 0, v78
    v_cvt_pk_bf16_f32 v79, 0, v79
    v_cvt_pk_bf16_f32 v80, 0, v80
    v_cvt_pk_bf16_f32 v81, 0, v81
    v_cvt_pk_bf16_f32 v82, 0, v82
    v_cvt_pk_bf16_f32 v83, 0, v83
    v_mul_f32 v84, v5, v68
    v_mul_f32 v85, v5, v69
    v_mul_f32 v86, v5, v70
    v_mul_f32 v87, v5, v71
    v_mul_f32 v88, v5, v72
    v_mul_f32 v89, v5, v73
    v_mul_f32 v90, v5, v74
    v_mul_f32 v91, v5, v75
    v_mul_f32 v92, v5, v76
    v_mul_f32 v93, v5, v77
    v_mul_f32 v94, v5, v78
    v_mul_f32 v95, v5, v79
    v_mul_f32 v96, v5, v80
    v_mul_f32 v97, v5, v81
    v_mul_f32 v98, v5, v82
    v_mul_f32 v99, v5, v83
    v_exp_f32 v84, v84
    v_exp_f32 v85, v85
    v_exp_f32 v86, v86
    v_exp_f32 v87, v87
    v_exp_f32 v88, v88
    v_exp_f32 v89, v89
    v_exp_f32 v90, v90
    v_exp_f32 v91, v91
    v_exp_f32 v92, v92
    v_exp_f32 v93, v93
    v_exp_f32 v94, v94
    v_exp_f32 v95, v95
    v_exp_f32 v96, v96
    v_exp_f32 v97, v97
    v_exp_f32 v98, v98
    v_exp_f32 v99, v99
    v_add_f32 v84, v6, v84
    v_add_f32 v85, v6, v85
    v_add_f32 v86, v6, v86
    v_add_f32 v87, v6, v87
    v_add_f32 v88, v6, v88
    v_add_f32 v89, v6, v89
    v_add_f32 v90, v6, v90
    v_add_f32 v91, v6, v91
    v_add_f32 v92, v6, v92
    v_add_f32 v93, v6, v93
    v_add_f32 v94, v6, v94
    v_add_f32 v95, v6, v95
    v_add_f32 v96, v6, v96
    v_add_f32 v97, v6, v97
    v_add_f32 v98, v6, v98
    v_add_f32 v99, v6, v99
    v_rcp_f32 v84, v84
    v_rcp_f32 v85, v85
    v_rcp_f32 v86, v86
    v_rcp_f32 v87, v87
    v_rcp_f32 v88, v88
    v_rcp_f32 v89, v89
    v_rcp_f32 v90, v90
    v_rcp_f32 v91, v91
    v_rcp_f32 v92, v92
    v_rcp_f32 v93, v93
    v_rcp_f32 v94, v94
    v_rcp_f32 v95, v95
    v_rcp_f32 v96, v96
    v_rcp_f32 v97, v97
    v_rcp_f32 v98, v98
    v_rcp_f32 v99, v99
    v_mul_f32 v84, v68, v84
    v_mul_f32 v85, v69, v85
    v_mul_f32 v86, v70, v86
    v_mul_f32 v87, v71, v87
    v_mul_f32 v88, v72, v88
    v_mul_f32 v89, v73, v89
    v_mul_f32 v90, v74, v90
    v_mul_f32 v91, v75, v91
    v_mul_f32 v92, v76, v92
    v_mul_f32 v93, v77, v93
    v_mul_f32 v94, v78, v94
    v_mul_f32 v95, v79, v95
    v_mul_f32 v96, v80, v96
    v_mul_f32 v97, v81, v97
    v_mul_f32 v98, v82, v98
    v_mul_f32 v99, v83, v99
    v_cvt_pk_bf16_f32 v68, v84, v88
    v_cvt_pk_bf16_f32 v69, v92, v96
    buffer_store_dwordx2 v[68:69], v7, s[72:75], s27 offen offset:0 sc1
    v_cvt_pk_bf16_f32 v70, v85, v89
    v_cvt_pk_bf16_f32 v71, v93, v97
    buffer_store_dwordx2 v[70:71], v7, s[72:75], s27 offen offset:128 sc1
    v_cvt_pk_bf16_f32 v72, v86, v90
    v_cvt_pk_bf16_f32 v73, v94, v98
    buffer_store_dwordx2 v[72:73], v7, s[72:75], s27 offen offset:256 sc1
    v_cvt_pk_bf16_f32 v74, v87, v91
    v_cvt_pk_bf16_f32 v75, v95, v99
    buffer_store_dwordx2 v[74:75], v7, s[72:75], s27 offen offset:384 sc1
    s_nop 0
P_h2:
    s_mov_b32 s56, 0x05040100
    s_mov_b32 s57, 0x07060302
    s_cmp_gt_u32 s26, 4
    s_cbranch_scc1 M_e4
    s_waitcnt vmcnt(8)
    s_branch M_e5
M_e4:
    s_waitcnt vmcnt(4)
M_e5:
    s_lshr_b32 s60, s26, 2
    s_and_b32 s61, s26, 3
    s_lshl_b32 s60, s60, 3
    s_add_u32 s60, s60, s61
    s_lshl_b32 s60, s60, 10
    s_movk_i32 s61, 4096
    v_perm_b32 v148, v129, v128, s56
    v_perm_b32 v152, v129, v128, s57
    v_perm_b32 v149, v131, v130, s56
    v_perm_b32 v153, v131, v130, s57
    v_perm_b32 v150, v133, v132, s56
    v_perm_b32 v154, v133, v132, s57
    v_perm_b32 v151, v135, v134, s56
    v_perm_b32 v155, v135, v134, s57
    v_add_u32 v156, s60, v3
    v_add_u32 v157, s61, v156
    ds_write_b128 v156, v[148:151]
    ds_write_b128 v157, v[152:155]
    s_cmp_eq_u32 s26, 7
    s_cbranch_scc1 M_w2
    s_add_u32 s27, s26, 8
    s_lshr_b32 s60, s27, 2
    s_and_b32 s61, s27, 3
    s_lshl_b32 s60, s60, 3
    s_add_u32 s60, s60, s61
    s_lshl_b32 s60, s60, 10
    s_movk_i32 s61, 4096
    s_cmp_lt_u32 s26, 4
    s_cbranch_scc1 M_w1
    s_sub_u32 s60, s26, 4
    s_lshl_b32 s60, s60, 11
    s_add_u32 s60, s60, 24576
    s_movk_i32 s61, 1024
M_w1:
    v_perm_b32 v148, v137, v136, s56
    v_perm_b32 v152, v137, v136, s57
    v_perm_b32 v149, v139, v138, s56
    v_perm_b32 v153, v139, v138, s57
    v_perm_b32 v150, v141, v140, s56
    v_perm_b32 v154, v141, v140, s57
    v_perm_b32 v151, v143, v142, s56
    v_perm_b32 v155, v143, v142, s57
    v_add_u32 v156, s60, v3
    v_add_u32 v157, s61, v156
    ds_write_b128 v156, v[148:151]
    ds_write_b128 v157, v[152:155]
M_w2:
    s_cmp_ge_u32 s26, 4
    s_cbranch_scc1 M_t4
    v_bfe_i32 v148, v0, 0, 1
    v_mov_b32 v149, 0x01000c0c
    s_mov_b32 s63, 0x02020000
    v_and_or_b32 v148, v148, s63, v149
    v_add_u32 v149, s63, v148
    v_add_u32 v150, s63, v149
    v_perm_b32 v152, v145, v144, v148
    v_perm_b32 v153, v145, v144, v149
    v_perm_b32 v154, v145, v144, v150
    s_mov_b32 s60, 0x41800000
    v_mul_f32 v148, s60, v152
    v_mul_f32 v149, s60, v153
    v_mul_f32 v150, s60, v154
    v_cvt_flr_i32_f32 v148, v148
    v_cvt_flr_i32_f32 v149, v149
    v_cvt_flr_i32_f32 v150, v150
    v_sub_u32 v148, 4, v148
    v_sub_u32 v149, 4, v149
    v_sub_u32 v150, 2, v150
    v_and_b32 v148, 0xff, v148
    v_and_b32 v149, 0xff, v149
    v_and_b32 v150, 0xff, v150
    v_lshl_or_b32 v148, v149, 8, v148
    v_lshl_or_b32 v148, v150, 16, v148
    v_mov_b32 v149, 0x7f000000
    v_cmp_gt_u32 vcc, 200, v0
    s_nop 1
    v_cndmask_b32 v148, v149, v148, vcc
    v_lshlrev_b32 v150, 2, v0
    v_add_u32 v150, 133120, v150
    ds_write_b32 v150, v148
    v_lshlrev_b32 v150, 4, v0
    v_add_u32 v150, 135168, v150
    s_mov_b64 exec, vcc
    ds_write_b96 v150, v[152:154]
    s_mov_b64 exec, -1
    s_branch M_t8
M_t4:
    s_cmp_eq_u32 s26, 4
    s_cbranch_scc0 M_t5
    v_lshlrev_b32 v150, 2, v1
    v_add_u32 v151, 132864, v150
    v_mov_b32 v148, 0
    ds_write_b32 v151, v148
    v_mov_b32 v151, 132672
    ds_write_b32 v151, v148
    v_add_u32 v151, 132608, v150
    v_lshlrev_b32 v148, 16, v146
    s_mov_b64 exec, 0xffff
    ds_write_b32 v151, v148
    s_mov_b64 exec, -1
    s_branch M_t8
M_t5:
    v_lshlrev_b32 v150, 4, v1
    v_cmp_gt_u32 vcc, 49, v1
    s_mov_b64 s[60:61], vcc
    s_mov_b32 s63, 0x830100
    s_mov_b32 s65, 0
    s_nop 1
M_pa:
    buffer_load_dwordx4 v[152:155], v150, s[36:39], s63 offen sc1
    s_waitcnt vmcnt(0)
    v_xor_b32 v152, s18, v152
    v_xor_b32 v153, s18, v153
    v_xor_b32 v154, s18, v154
    v_xor_b32 v155, s18, v155
    v_or3_b32 v152, v152, v153, v154
    v_or_b32 v152, v152, v155
    v_cmp_ne_u32 vcc, 0, v152
    s_and_b64 vcc, vcc, s[60:61]
    s_cbranch_vccz M_pad
    s_sleep 2
    s_add_u32 s65, s65, 1
    s_cmp_lt_u32 s65, 16384
    s_cbranch_scc1 M_pa
M_pad:
    s_sub_u32 s27, s26, 5
    s_lshl_b32 s27, s27, 10
    s_add_u32 s63, s27, 0x810000
    s_add_u32 s27, s27, 30720
    s_mov_b32 m0, s27
    s_nop 0
    buffer_load_dwordx4 v3, s[36:39], s63 offen sc1 lds
    s_add_u32 s27, s27, 3072
    s_add_u32 s63, s63, 3072
    s_mov_b32 m0, s27
    s_nop 0
    buffer_load_dwordx4 v3, s[36:39], s63 offen sc1 lds
    s_add_u32 s27, s27, 3072
    s_add_u32 s63, s63, 3072
    s_mov_b32 m0, s27
    s_nop 0
    buffer_load_dwordx4 v3, s[36:39], s63 offen sc1 lds
    s_add_u32 s27, s27, 3072
    s_add_u32 s63, s63, 3072
    s_mov_b32 m0, s27
    s_nop 0
    buffer_load_dwordx4 v3, s[36:39], s63 offen sc1 lds
    s_add_u32 s27, s27, 3072
    s_add_u32 s63, s63, 3072
    s_mov_b32 m0, s27
    s_nop 0
    buffer_load_dwordx4 v3, s[36:39], s63 offen sc1 lds
    s_add_u32 s27, s27, 3072
    s_add_u32 s63, s63, 3072
    s_mov_b32 m0, s27
    s_nop 0
    buffer_load_dwordx4 v3, s[36:39], s63 offen sc1 lds
    s_add_u32 s27, s27, 3072
    s_add_u32 s63, s63, 3072
    s_mov_b32 m0, s27
    s_nop 0
    buffer_load_dwordx4 v3, s[36:39], s63 offen sc1 lds
    s_add_u32 s27, s27, 3072
    s_add_u32 s63, s63, 3072
    s_mov_b32 m0, s27
    s_nop 0
    buffer_load_dwordx4 v3, s[36:39], s63 offen sc1 lds
    s_add_u32 s27, s27, 3072
    s_add_u32 s63, s63, 3072
    s_mov_b32 m0, s27
    s_nop 0
    buffer_load_dwordx4 v3, s[36:39], s63 offen sc1 lds
    s_add_u32 s27, s27, 3072
    s_add_u32 s63, s63, 3072
    s_mov_b32 m0, s27
    s_nop 0
    buffer_load_dwordx4 v3, s[36:39], s63 offen sc1 lds
    s_add_u32 s27, s27, 3072
    s_add_u32 s63, s63, 3072
    s_mov_b32 m0, s27
    s_nop 0
    buffer_load_dwordx4 v3, s[36:39], s63 offen sc1 lds
    s_add_u32 s27, s27, 3072
    s_add_u32 s63, s63, 3072
    s_mov_b32 m0, s27
    s_nop 0
    buffer_load_dwordx4 v3, s[36:39], s63 offen sc1 lds
    s_add_u32 s27, s27, 3072
    s_add_u32 s63, s63, 3072
    s_mov_b32 m0, s27
    s_nop 0
    buffer_load_dwordx4 v3, s[36:39], s63 offen sc1 lds
    s_add_u32 s27, s27, 3072
    s_add_u32 s63, s63, 3072
    s_mov_b32 m0, s27
    s_nop 0
    buffer_load_dwordx4 v3, s[36:39], s63 offen sc1 lds
    s_add_u32 s27, s27, 3072
    s_add_u32 s63, s63, 3072
    s_mov_b32 m0, s27
    s_nop 0
    buffer_load_dwordx4 v3, s[36:39], s63 offen sc1 lds
    s_add_u32 s27, s27, 3072
    s_add_u32 s63, s63, 3072
    s_mov_b32 m0, s27
    s_nop 0
    buffer_load_dwordx4 v3, s[36:39], s63 offen sc1 lds
    s_add_u32 s27, s27, 3072
    s_add_u32 s63, s63, 3072
    s_mov_b32 m0, s27
    s_nop 0
    buffer_load_dwordx4 v3, s[36:39], s63 offen sc1 lds
    s_add_u32 s27, s27, 3072
    s_add_u32 s63, s63, 3072
    s_mov_b32 m0, s27
    s_nop 0
    buffer_load_dwordx4 v3, s[36:39], s63 offen sc1 lds
    s_add_u32 s27, s27, 3072
    s_add_u32 s63, s63, 3072
    s_mov_b32 m0, s27
    s_nop 0
    buffer_load_dwordx4 v3, s[36:39], s63 offen sc1 lds
    s_add_u32 s27, s27, 3072
    s_add_u32 s63, s63, 3072
    s_mov_b32 m0, s27
    s_nop 0
    buffer_load_dwordx4 v3, s[36:39], s63 offen sc1 lds
    s_add_u32 s27, s27, 3072
    s_add_u32 s63, s63, 3072
    s_mov_b32 m0, s27
    s_nop 0
    buffer_load_dwordx4 v3, s[36:39], s63 offen sc1 lds
    s_add_u32 s27, s27, 3072
    s_add_u32 s63, s63, 3072
    s_mov_b32 m0, s27
    s_nop 0
    buffer_load_dwordx4 v3, s[36:39], s63 offen sc1 lds
    s_add_u32 s27, s27, 3072
    s_add_u32 s63, s63, 3072
    s_mov_b32 m0, s27
    s_nop 0
    buffer_load_dwordx4 v3, s[36:39], s63 offen sc1 lds
    s_add_u32 s27, s27, 3072
    s_add_u32 s63, s63, 3072
    s_mov_b32 m0, s27
    s_nop 0
    buffer_load_dwordx4 v3, s[36:39], s63 offen sc1 lds
    s_add_u32 s27, s27, 3072
    s_add_u32 s63, s63, 3072
    s_mov_b32 m0, s27
    s_nop 0
    buffer_load_dwordx4 v3, s[36:39], s63 offen sc1 lds
    s_add_u32 s27, s27, 3072
    s_add_u32 s63, s63, 3072
    s_mov_b32 m0, s27
    s_nop 0
    buffer_load_dwordx4 v3, s[36:39], s63 offen sc1 lds
    s_add_u32 s27, s27, 3072
    s_add_u32 s63, s63, 3072
    s_mov_b32 m0, s27
    s_nop 0
    buffer_load_dwordx4 v3, s[36:39], s63 offen sc1 lds
    s_add_u32 s27, s27, 3072
    s_add_u32 s63, s63, 3072
    s_mov_b32 m0, s27
    s_nop 0
    buffer_load_dwordx4 v3, s[36:39], s63 offen sc1 lds
    s_add_u32 s27, s27, 3072
    s_add_u32 s63, s63, 3072
    s_mov_b32 m0, s27
    s_nop 0
    buffer_load_dwordx4 v3, s[36:39], s63 offen sc1 lds
    s_add_u32 s27, s27, 3072
    s_add_u32 s63, s63, 3072
    s_mov_b32 m0, s27
    s_nop 0
    buffer_load_dwordx4 v3, s[36:39], s63 offen sc1 lds
    s_add_u32 s27, s27, 3072
    s_add_u32 s63, s63, 3072
    s_mov_b32 m0, s27
    s_nop 0
    buffer_load_dwordx4 v3, s[36:39], s63 offen sc1 lds
    s_add_u32 s27, s27, 3072
    s_add_u32 s63, s63, 3072
    s_mov_b32 m0, s27
    s_nop 0
    buffer_load_dwordx4 v3, s[36:39], s63 offen sc1 lds
    s_add_u32 s27, s27, 3072
    s_add_u32 s63, s63, 3072
    s_cmp_eq_u32 s26, 7
    s_cbranch_scc1 M_t8
    s_mov_b32 m0, s27
    s_nop 0
    buffer_load_dwordx4 v3, s[36:39], s63 offen sc1 lds
M_t8:
    v_lshrrev_b32 v24, 2, v1
    v_lshlrev_b32 v24, 15, v24
    v_and_b32 v25, 3, v1
    v_lshl_add_u32 v24, v25, 4, v24
    s_lshl_b32 s27, s26, 20
    s_lshl_b32 s53, s2, 7
    s_add_u32 s27, s27, s53
    s_add_u32 s53, s27, 524288
    s_mov_b64 s[60:61], -1
    s_cmp_eq_u32 s26, 7
    s_cselect_b32 s61, 0xff, s61
    s_xor_b32 s63, s8, 0xff000000
    v_mov_b32 v164, s63
    v_mov_b32 v172, s63
    s_xor_b32 s63, s9, 0xff000000
    v_mov_b32 v165, s63
    v_mov_b32 v173, s63
    s_xor_b32 s63, s10, 0xff000000
    v_mov_b32 v166, s63
    v_mov_b32 v174, s63
    s_xor_b32 s63, s11, 0xff000000
    v_mov_b32 v167, s63
    v_mov_b32 v175, s63
    buffer_load_dwordx4 v[160:163], v24, s[36:39], s27 offen sc1
    s_mov_b64 exec, s[60:61]
    buffer_load_dwordx4 v[164:167], v24, s[36:39], s53 offen sc1
    s_mov_b64 exec, -1
    buffer_load_dwordx4 v[168:171], v24, s[36:39], s27 offen offset:64 sc1
    s_mov_b64 exec, s[60:61]
    buffer_load_dwordx4 v[172:175], v24, s[36:39], s53 offen offset:64 sc1
    s_mov_b64 exec, -1
    v_lshlrev_b32 v1, 4, v1
    v_lshrrev_b32 v8, 4, v1
    v_lshrrev_b32 v10, 5, v8
    v_and_b32 v11, 31, v8
    s_mov_b32 s6, 0x186a000
    s_mov_b32 s7, 0x00020000
    s_mul_i32 s44, s2, 102400
    s_mul_i32 s51, s26, 12800
    s_add_u32 s51, s51, 30720
    s_mul_i32 s52, s26, 3840
    s_add_u32 s52, s52, 133120
    s_mov_b32 s67, 120320
    s_mov_b32 s3, 132864
    v_lshrrev_b32 v8, 4, v1
    v_lshrrev_b32 v10, 5, v8
    v_and_b32 v11, 31, v8
    v_lshlrev_b32 v3, 4, v11
    v_add_u32 v3, s52, v3
    v_mul_u32_u24 v0, 56, v10
    v_add_u32 v0, s52, v0
    v_lshrrev_b32 v13, 3, v11
    v_lshl_add_u32 v4, v13, 3, v0
    v_lshrrev_b32 v13, 3, v8
    v_and_b32 v14, 1, v13
    v_lshrrev_b32 v13, 1, v13
    v_lshl_add_u32 v13, v14, 2, v13
    v_lshlrev_b32 v5, 4, v13
    v_add_u32 v5, s52, v5
    v_add_u32 v16, s52, v1
    v_lshrrev_b32 v17, 2, v8
    v_mul_u32_u24 v17, 56, v17
    v_and_b32 v13, 3, v8
    v_lshl_add_u32 v17, v13, 1, v17
    v_add_u32 v17, s52, v17
    v_lshlrev_b32 v2, 7, v10
    v_lshl_add_u32 v2, v11, 2, v2
    v_add_u32 v2, s51, v2
    v_and_b32 v13, 7, v11
    v_lshlrev_b32 v13, 1, v13
    v_sub_u32 v13, 14, v13
    v_lshl_or_b32 v6, v13, 16, v13
    v_lshlrev_b32 v7, 5, v10
    v_add_u32 v7, 132608, v7
    v_lshlrev_b32 v20, 2, v8
    v_add_u32 v30, 132864, v20
    v_mov_b32 v9, 132672
    v_mov_b32 v18, 0xfc
    v_mov_b32 v19, 1
    v_mov_b32 v192, 0
    v_mov_b32 v193, 0
    v_mov_b32 v194, 0
    v_mov_b32 v195, 0
    v_mov_b32 v196, 0
    v_mov_b32 v197, 0
    v_mov_b32 v198, 0
    v_mov_b32 v199, 0
    v_mov_b32 v200, 0
    v_mov_b32 v201, 0
    v_mov_b32 v202, 0
    v_mov_b32 v203, 0
    v_mov_b32 v204, 0
    v_mov_b32 v205, 0
    v_mov_b32 v206, 0
    v_mov_b32 v207, 0
    v_mov_b32 v208, 0
    v_mov_b32 v209, 0
    v_mov_b32 v210, 0
    v_mov_b32 v211, 0
    v_mov_b32 v212, 0
    v_mov_b32 v213, 0
    v_mov_b32 v214, 0
    v_mov_b32 v215, 0
    v_mov_b32 v216, 0
    v_mov_b32 v217, 0
    v_mov_b32 v218, 0
    v_mov_b32 v219, 0
    v_mov_b32 v220, 0
    v_mov_b32 v221, 0
    v_mov_b32 v222, 0
    v_mov_b32 v223, 0
    v_mov_b32 v224, 0
    v_mov_b32 v225, 0
    v_mov_b32 v226, 0
    v_mov_b32 v227, 0
    v_mov_b32 v228, 0
    v_mov_b32 v229, 0
    v_mov_b32 v230, 0
    v_mov_b32 v231, 0
    v_mov_b32 v232, 0
    v_mov_b32 v233, 0
    v_mov_b32 v234, 0
    v_mov_b32 v235, 0
    v_mov_b32 v236, 0
    v_mov_b32 v237, 0
    v_mov_b32 v238, 0
    v_mov_b32 v239, 0
    v_mov_b32 v240, 0
    v_mov_b32 v241, 0
    v_mov_b32 v242, 0
    v_mov_b32 v243, 0
    v_mov_b32 v244, 0
    v_mov_b32 v245, 0
    v_mov_b32 v246, 0
    v_mov_b32 v247, 0
    v_mov_b32 v248, 0
    v_mov_b32 v249, 0
    v_mov_b32 v250, 0
    v_mov_b32 v251, 0
    v_mov_b32 v252, 0
    v_mov_b32 v253, 0
    v_mov_b32 v254, 0
    v_mov_b32 v255, 0
    s_mov_b32 s12, 0x1fffe
    s_movk_i32 s13, 130
    s_mov_b32 s14, 0xfc0000
    s_movk_i32 s15, 7800
    s_lshl_b32 s17, s26, 10
    s_add_u32 s17, s17, 138368
    s_mov_b32 s16, s17
    v_add_u32 v26, 134144, v20
    v_add_u32 v27, 134144, v1
    s_mov_b32 s62, 0xfe0001
    s_mov_b32 s65, 0
M_cw:
    s_waitcnt vmcnt(0)
    v_xor_b32 v176, s8, v160
    v_xor_b32 v177, s9, v161
    v_xor_b32 v178, s10, v162
    v_xor_b32 v179, s11, v163
    v_xor_b32 v180, s8, v164
    v_xor_b32 v181, s9, v165
    v_xor_b32 v182, s10, v166
    v_xor_b32 v183, s11, v167
    v_xor_b32 v184, s8, v168
    v_xor_b32 v185, s9, v169
    v_xor_b32 v186, s10, v170
    v_xor_b32 v187, s11, v171
    v_xor_b32 v188, s8, v172
    v_xor_b32 v189, s9, v173
    v_xor_b32 v190, s10, v174
    v_xor_b32 v191, s11, v175
    v_or3_b32 v148, v176, v177, v178
    v_or3_b32 v148, v148, v179, v180
    v_or3_b32 v148, v148, v181, v182
    v_or3_b32 v148, v148, v183, v184
    v_or3_b32 v148, v148, v185, v186
    v_or3_b32 v148, v148, v187, v188
    v_or3_b32 v148, v148, v189, v190
    v_or_b32 v148, v148, v191
    v_and_b32 v148, s62, v148
    v_cmp_ne_u32 vcc, 0, v148
    s_nop 4
    s_cbranch_vccz M_cok
    s_add_u32 s65, s65, 1
    s_cmp_lt_u32 s65, 16384
    s_cbranch_scc0 M_cok
    s_sleep 4
    buffer_load_dwordx4 v[160:163], v24, s[36:39], s27 offen sc1
    s_mov_b64 exec, s[60:61]
    buffer_load_dwordx4 v[164:167], v24, s[36:39], s53 offen sc1
    s_mov_b64 exec, -1
    buffer_load_dwordx4 v[168:171], v24, s[36:39], s27 offen offset:64 sc1
    s_mov_b64 exec, s[60:61]
    buffer_load_dwordx4 v[172:175], v24, s[36:39], s53 offen offset:64 sc1
    s_mov_b64 exec, -1
    s_branch M_cw
M_cok:
    s_waitcnt lgkmcnt(0)
    s_barrier
    s_cmp_eq_u32 s26, 5
    s_cbranch_scc0 M_f1
    s_lshl_b32 s27, s2, 2
    s_add_u32 s27, s27, 0x830800
    v_mov_b32 v148, s18
    v_mov_b32 v149, 0
    s_mov_b64 exec, 1
    buffer_store_dword v148, v149, s[36:39], s27 offen sc1
    s_mov_b64 exec, -1
M_f1:
    v_and_b32 v64, s12, v176
    v_alignbit_b32 v65, s13, v176, 22
    ds_read_u16 v64, v64 offset:30720
    ds_read_b32 v65, v65
    v_and_b32 v66, s12, v177
    v_alignbit_b32 v67, s13, v177, 22
    ds_read_u16 v66, v66 offset:30720
    ds_read_b32 v67, v67
    v_and_b32 v68, s12, v178
    v_alignbit_b32 v69, s13, v178, 22
    ds_read_u16 v68, v68 offset:30720
    ds_read_b32 v69, v69
    v_and_b32 v70, s12, v179
    v_alignbit_b32 v71, s13, v179, 22
    ds_read_u16 v70, v70 offset:30720
    ds_read_b32 v71, v71
    v_and_b32 v72, s12, v180
    v_alignbit_b32 v73, s13, v180, 22
    ds_read_u16 v72, v72 offset:30720
    ds_read_b32 v73, v73
    v_and_b32 v74, s12, v181
    v_alignbit_b32 v75, s13, v181, 22
    ds_read_u16 v74, v74 offset:30720
    ds_read_b32 v75, v75
    v_and_b32 v76, s12, v182
    v_alignbit_b32 v77, s13, v182, 22
    ds_read_u16 v76, v76 offset:30720
    ds_read_b32 v77, v77
    v_and_b32 v78, s12, v183
    v_alignbit_b32 v79, s13, v183, 22
    ds_read_u16 v78, v78 offset:30720
    ds_read_b32 v79, v79
    s_mov_b32 s63, 0xc8000000
    s_lshl_b32 s59, s26, 11
    s_add_u32 s59, s59, 146560
    s_mov_b32 s60, s59
    v_cmp_gt_u32 s[54:55], s63, v184
    s_nop 1
    v_mbcnt_lo_u32_b32 v148, s54, 0
    v_mbcnt_hi_u32_b32 v148, s55, v148
    v_lshl_add_u32 v148, v148, 4, s60
    s_bcnt1_i32_b64 s27, s[54:55]
    s_lshl4_add_u32 s60, s27, s60
    v_cndmask_b32 v148, v27, v148, s[54:55]
    ds_write_b128 v148, v[184:187]
    v_cmp_gt_u32 s[54:55], s63, v188
    s_nop 1
    v_mbcnt_lo_u32_b32 v148, s54, 0
    v_mbcnt_hi_u32_b32 v148, s55, v148
    v_lshl_add_u32 v148, v148, 4, s60
    s_bcnt1_i32_b64 s27, s[54:55]
    s_lshl4_add_u32 s60, s27, s60
    v_cndmask_b32 v148, v27, v148, s[54:55]
    ds_write_b128 v148, v[188:191]
    s_mov_b32 s63, 0xff000000
    v_cmp_lt_u32 s[68:69], s63, v187
    v_cmp_lt_u32 s[70:71], s63, v191
    s_waitcnt lgkmcnt(10)
    v_and_b32 v96, 0x0707, v64
    v_and_b32 v97, 0x0707, v66
    v_and_b32 v98, 0x0707, v68
    v_and_b32 v99, 0x0707, v70
    v_and_b32 v64, 0xf8f8, v64
    v_and_b32 v66, 0xf8f8, v66
    v_and_b32 v68, 0xf8f8, v68
    v_and_b32 v70, 0xf8f8, v70
    v_mul_u32_u24 v96, 0x200400, v96
    v_mul_u32_u24 v97, 0x200400, v97
    v_mul_u32_u24 v98, 0x200400, v98
    v_mul_u32_u24 v99, 0x200400, v99
    v_and_or_b32 v64, v96, s14, v64
    v_and_or_b32 v66, v97, s14, v66
    v_and_or_b32 v68, v98, s14, v68
    v_and_or_b32 v70, v99, s14, v70
    v_add_u32 v64, v64, v65
    v_add_u32 v66, v66, v67
    v_add_u32 v68, v68, v69
    v_add_u32 v70, v70, v71
    v_dot4_i32_i8 v64, v64, v64, 0
    v_dot4_i32_i8 v66, v66, v66, 0
    v_dot4_i32_i8 v68, v68, v68, 0
    v_dot4_i32_i8 v70, v70, v70, 0
    v_cmp_gt_i32 s[40:41], s15, v64
    v_cmp_gt_i32 s[42:43], s15, v66
    v_cmp_gt_i32 s[46:47], s15, v68
    v_cmp_gt_i32 s[54:55], s15, v70
    v_mbcnt_lo_u32_b32 v96, s40, 0
    v_mbcnt_lo_u32_b32 v97, s42, 0
    v_mbcnt_lo_u32_b32 v98, s46, 0
    v_mbcnt_lo_u32_b32 v99, s54, 0
    v_mbcnt_hi_u32_b32 v96, s41, v96
    v_mbcnt_hi_u32_b32 v97, s43, v97
    v_mbcnt_hi_u32_b32 v98, s47, v98
    v_mbcnt_hi_u32_b32 v99, s55, v99
    v_lshl_add_u32 v96, v96, 2, s16
    s_bcnt1_i32_b64 s27, s[40:41]
    s_lshl2_add_u32 s16, s27, s16
    v_lshl_add_u32 v97, v97, 2, s16
    s_bcnt1_i32_b64 s27, s[42:43]
    s_lshl2_add_u32 s16, s27, s16
    v_lshl_add_u32 v98, v98, 2, s16
    s_bcnt1_i32_b64 s27, s[46:47]
    s_lshl2_add_u32 s16, s27, s16
    v_lshl_add_u32 v99, v99, 2, s16
    s_bcnt1_i32_b64 s27, s[54:55]
    s_lshl2_add_u32 s16, s27, s16
    v_cndmask_b32 v96, v26, v96, s[40:41]
    ds_write_b32 v96, v176
    v_cndmask_b32 v97, v26, v97, s[42:43]
    ds_write_b32 v97, v177
    v_cndmask_b32 v98, v26, v98, s[46:47]
    ds_write_b32 v98, v178
    v_cndmask_b32 v99, v26, v99, s[54:55]
    ds_write_b32 v99, v179
    s_waitcnt lgkmcnt(6)
    v_and_b32 v100, 0x0707, v72
    v_and_b32 v101, 0x0707, v74
    v_and_b32 v102, 0x0707, v76
    v_and_b32 v103, 0x0707, v78
    v_and_b32 v72, 0xf8f8, v72
    v_and_b32 v74, 0xf8f8, v74
    v_and_b32 v76, 0xf8f8, v76
    v_and_b32 v78, 0xf8f8, v78
    v_mul_u32_u24 v100, 0x200400, v100
    v_mul_u32_u24 v101, 0x200400, v101
    v_mul_u32_u24 v102, 0x200400, v102
    v_mul_u32_u24 v103, 0x200400, v103
    v_and_or_b32 v72, v100, s14, v72
    v_and_or_b32 v74, v101, s14, v74
    v_and_or_b32 v76, v102, s14, v76
    v_and_or_b32 v78, v103, s14, v78
    v_add_u32 v72, v72, v73
    v_add_u32 v74, v74, v75
    v_add_u32 v76, v76, v77
    v_add_u32 v78, v78, v79
    v_dot4_i32_i8 v72, v72, v72, 0
    v_dot4_i32_i8 v74, v74, v74, 0
    v_dot4_i32_i8 v76, v76, v76, 0
    v_dot4_i32_i8 v78, v78, v78, 0
    v_cmp_gt_i32 s[40:41], s15, v72
    v_cmp_gt_i32 s[42:43], s15, v74
    v_cmp_gt_i32 s[46:47], s15, v76
    v_cmp_gt_i32 s[54:55], s15, v78
    v_mbcnt_lo_u32_b32 v100, s40, 0
    v_mbcnt_lo_u32_b32 v101, s42, 0
    v_mbcnt_lo_u32_b32 v102, s46, 0
    v_mbcnt_lo_u32_b32 v103, s54, 0
    v_mbcnt_hi_u32_b32 v100, s41, v100
    v_mbcnt_hi_u32_b32 v101, s43, v101
    v_mbcnt_hi_u32_b32 v102, s47, v102
    v_mbcnt_hi_u32_b32 v103, s55, v103
    v_lshl_add_u32 v100, v100, 2, s16
    s_bcnt1_i32_b64 s27, s[40:41]
    s_lshl2_add_u32 s16, s27, s16
    v_lshl_add_u32 v101, v101, 2, s16
    s_bcnt1_i32_b64 s27, s[42:43]
    s_lshl2_add_u32 s16, s27, s16
    v_lshl_add_u32 v102, v102, 2, s16
    s_bcnt1_i32_b64 s27, s[46:47]
    s_lshl2_add_u32 s16, s27, s16
    v_lshl_add_u32 v103, v103, 2, s16
    s_bcnt1_i32_b64 s27, s[54:55]
    s_lshl2_add_u32 s16, s27, s16
    v_cndmask_b32 v100, v26, v100, s[40:41]
    ds_write_b32 v100, v180
    v_cndmask_b32 v101, v26, v101, s[42:43]
    ds_write_b32 v101, v181
    v_cndmask_b32 v102, v26, v102, s[46:47]
    ds_write_b32 v102, v182
    v_cndmask_b32 v103, v26, v103, s[54:55]
    ds_write_b32 v103, v183
    s_sub_u32 s60, s60, s59
    v_add_u32 v149, s59, v20
    v_mov_b32 v150, 0xff000000
    s_nop 1
M_pc:
    s_cmp_eq_u32 s60, 0
    s_cbranch_scc1 M_pcd
    s_waitcnt lgkmcnt(0)
    ds_read_b32 v148, v149
    v_cmp_gt_u32 vcc, s60, v20
    s_waitcnt lgkmcnt(0)
    s_nop 0
    v_cndmask_b32 v148, v150, v148, vcc
    v_and_b32 v64, s12, v148
    v_alignbit_b32 v65, s13, v148, 22
    ds_read_u16 v64, v64 offset:30720
    ds_read_b32 v65, v65
    s_waitcnt lgkmcnt(0)
    v_and_b32 v96, 0x0707, v64
    v_and_b32 v64, 0xf8f8, v64
    v_mul_u32_u24 v96, 0x200400, v96
    v_and_or_b32 v64, v96, s14, v64
    v_add_u32 v64, v64, v65
    v_dot4_i32_i8 v64, v64, v64, 0
    s_nop 2
    v_cmp_gt_i32 s[40:41], s15, v64
    s_nop 1
    v_mbcnt_lo_u32_b32 v96, s40, 0
    v_mbcnt_hi_u32_b32 v96, s41, v96
    v_lshl_add_u32 v96, v96, 2, s16
    s_bcnt1_i32_b64 s27, s[40:41]
    s_lshl2_add_u32 s16, s27, s16
    v_cndmask_b32 v96, v26, v96, s[40:41]
    ds_write_b32 v96, v148
    v_add_u32 v149, 256, v149
    s_min_u32 s27, s60, 256
    s_sub_u32 s60, s60, s27
    s_sub_u32 s27, s16, s17
    s_cmp_gt_u32 s27, 1024
    s_cbranch_scc0 M_pc
M_pcd:
    s_or_b64 s[54:55], s[68:69], s[70:71]
    s_cmp_eq_u64 s[54:55], 0
    s_cbranch_scc1 M_mdd
    s_mov_b32 s59, 0
M_md:
    s_cmp_eq_u64 s[68:69], 0
    s_cbranch_scc0 M_md1
    s_cmp_lg_u32 s59, 0
    s_cbranch_scc1 M_mdd
    s_mov_b32 s59, 1
    s_mov_b64 s[68:69], s[70:71]
    v_mov_b32 v187, v191
    s_nop 1
    s_branch M_md
M_md1:
    s_ff1_i32_b64 s27, s[68:69]
    s_bitset0_b64 s[68:69], s27
    v_readlane_b32 s60, v187, s27
    s_and_b32 s60, s60, 0xffffff
    s_cmp_le_u32 s60, 32
    s_cbranch_scc1 M_md2
    ds_write_b32 v9, v19
    s_movk_i32 s60, 32
M_md2:
    s_lshr_b32 s27, s27, 2
    s_lshl_b32 s61, s59, 4
    s_add_u32 s27, s27, s61
    s_lshl_b32 s61, s26, 5
    s_add_u32 s27, s27, s61
    s_lshl_b32 s27, s27, 15
    s_lshl_b32 s61, s2, 7
    s_add_u32 s27, s27, s61
    s_add_u32 s27, s27, 0x900000
    v_mov_b32 v148, 0xff000000
    s_bfm_b64 exec, s60, 0
    buffer_load_dword v148, v20, s[36:39], s27 offen sc1
    s_mov_b64 exec, -1
    s_waitcnt vmcnt(0) lgkmcnt(0)
    v_and_b32 v64, s12, v148
    v_alignbit_b32 v65, s13, v148, 22
    ds_read_u16 v64, v64 offset:30720
    ds_read_b32 v65, v65
    s_waitcnt lgkmcnt(0)
    v_and_b32 v96, 0x0707, v64
    v_and_b32 v64, 0xf8f8, v64
    v_mul_u32_u24 v96, 0x200400, v96
    v_and_or_b32 v64, v96, s14, v64
    v_add_u32 v64, v64, v65
    v_dot4_i32_i8 v64, v64, v64, 0
    s_nop 2
    v_cmp_gt_i32 s[40:41], s15, v64
    s_nop 1
    v_mbcnt_lo_u32_b32 v96, s40, 0
    v_mbcnt_hi_u32_b32 v96, s41, v96
    v_lshl_add_u32 v96, v96, 2, s16
    s_bcnt1_i32_b64 s27, s[40:41]
    s_lshl2_add_u32 s16, s27, s16
    v_cndmask_b32 v96, v26, v96, s[40:41]
    ds_write_b32 v96, v148
    s_sub_u32 s27, s16, s17
    s_cmp_gt_u32 s27, 1024
    s_cbranch_scc0 M_md
M_mdd:
    s_sub_u32 s19, s16, s17
    s_lshr_b32 s19, s19, 2
    s_cmp_le_u32 s19, 256
    s_cbranch_scc1 M_c1
    ds_write_b32 v9, v19
    s_movk_i32 s19, 256
M_c1:
    v_add_u32 v148, s17, v20
    s_waitcnt lgkmcnt(0)
    ds_read_b32 v64, v148 offset:0
    ds_read_b32 v68, v148 offset:256
    ds_read_b32 v72, v148 offset:512
    ds_read_b32 v76, v148 offset:768
    s_mov_b32 s27, s19
    v_cmp_gt_i32 s[8:9], s27, v8
    s_sub_u32 s27, s19, 64
    v_cmp_gt_i32 s[10:11], s27, v8
    s_sub_u32 s27, s19, 128
    v_cmp_gt_i32 s[14:15], s27, v8
    s_sub_u32 s27, s19, 192
    v_cmp_gt_i32 s[16:17], s27, v8
    s_mov_b32 s63, 0x02020000
    s_mov_b32 s64, 0x322bcc77
    s_mov_b32 s62, 0x409d0000
    v_mov_b32 v149, 0x01000c0c
    v_bfrev_b32 v14, 2
    s_waitcnt lgkmcnt(0)
    v_and_b32 v150, s12, v64
    v_alignbit_b32 v151, 33, v64, 20
    v_lshl_add_u32 v150, v150, 1, v150
    ds_read_b96 v[40:42], v151
    v_and_b32 v150, -4, v150
    v_cndmask_b32 v150, v14, v150, s[8:9]
    buffer_load_dwordx2 v[32:33], v150, s[92:95], 0 offen
    v_bfe_i32 v56, v64, 1, 1
    v_and_or_b32 v56, v56, s63, v149
    s_cmp_le_u32 s19, 64
    s_nop 0
    s_cbranch_scc1 M_s2a
    v_and_b32 v150, s12, v68
    v_alignbit_b32 v151, 33, v68, 20
    v_lshl_add_u32 v150, v150, 1, v150
    ds_read_b96 v[44:46], v151
    v_and_b32 v150, -4, v150
    v_cndmask_b32 v150, v14, v150, s[10:11]
    buffer_load_dwordx2 v[34:35], v150, s[92:95], 0 offen
    v_bfe_i32 v57, v68, 1, 1
    v_and_or_b32 v57, v57, s63, v149
    s_cmp_le_u32 s19, 128
    s_nop 0
    s_cbranch_scc1 M_s2a
    v_and_b32 v150, s12, v72
    v_alignbit_b32 v151, 33, v72, 20
    v_lshl_add_u32 v150, v150, 1, v150
    ds_read_b96 v[48:50], v151
    v_and_b32 v150, -4, v150
    v_cndmask_b32 v150, v14, v150, s[14:15]
    buffer_load_dwordx2 v[36:37], v150, s[92:95], 0 offen
    v_bfe_i32 v58, v72, 1, 1
    v_and_or_b32 v58, v58, s63, v149
    s_cmp_le_u32 s19, 192
    s_nop 0
    s_cbranch_scc1 M_s2a
    v_and_b32 v150, s12, v76
    v_alignbit_b32 v151, 33, v76, 20
    v_lshl_add_u32 v150, v150, 1, v150
    ds_read_b96 v[52:54], v151
    v_and_b32 v150, -4, v150
    v_cndmask_b32 v150, v14, v150, s[16:17]
    buffer_load_dwordx2 v[38:39], v150, s[92:95], 0 offen
    v_bfe_i32 v59, v76, 1, 1
    v_and_or_b32 v59, v59, s63, v149
    s_nop 1
M_s2a:
    s_waitcnt vmcnt(0) lgkmcnt(0)
    v_add_u32 v151, s63, v56
    v_perm_b32 v148, v33, v32, v56
    v_add_u32 v152, s63, v151
    v_perm_b32 v149, v33, v32, v151
    v_perm_b32 v150, v33, v32, v152
    v_sub_f32 v148, v148, v40
    v_sub_f32 v149, v149, v41
    v_sub_f32 v150, v150, v42
    v_cvt_pk_bf16_f32 v65, v148, v149
    v_cvt_pk_bf16_f32 v150, 0, v150
    v_lshlrev_b32 v148, 16, v65
    v_and_b32 v149, s58, v65
    v_mul_f32 v153, v150, v150
    v_mul_f32 v148, v148, v148
    v_mul_f32 v149, v149, v149
    v_cvt_pk_bf16_f32 v153, 0, v153
    v_cvt_pk_bf16_f32 v148, 0, v148
    v_cvt_pk_bf16_f32 v149, 0, v149
    v_add_f32 v148, v148, v149
    v_add_f32 v148, v148, v153
    v_cvt_pk_bf16_f32 v148, 0, v148
    v_add_f32 v148, s64, v148
    v_cvt_pk_bf16_f32 v148, 0, v148
    v_sqrt_f32 v148, v148
    s_nop 0
    v_cvt_pk_bf16_f32 v66, v150, v148
    v_cmp_gt_u32 vcc, s62, v66
    s_and_b64 s[8:9], s[8:9], vcc
    v_lshrrev_b32 v96, 24, v64
    v_lshrrev_b32 v120, 21, v64
    v_and_b32 v120, 16, v120
    v_lshlrev_b32 v112, v120, v19
    v_and_or_b32 v96, v96, v18, s3
    s_mov_b64 exec, s[8:9]
    s_nop 0
    s_cbranch_execz M_sa1
    ds_add_rtn_u32 v112, v96, v112
M_sa1:
    s_mov_b64 exec, -1
    s_cmp_le_u32 s19, 64
    s_cbranch_scc1 M_s2b
    v_add_u32 v151, s63, v57
    v_perm_b32 v148, v35, v34, v57
    v_add_u32 v152, s63, v151
    v_perm_b32 v149, v35, v34, v151
    v_perm_b32 v150, v35, v34, v152
    v_sub_f32 v148, v148, v44
    v_sub_f32 v149, v149, v45
    v_sub_f32 v150, v150, v46
    v_cvt_pk_bf16_f32 v69, v148, v149
    v_cvt_pk_bf16_f32 v150, 0, v150
    v_lshlrev_b32 v148, 16, v69
    v_and_b32 v149, s58, v69
    v_mul_f32 v153, v150, v150
    v_mul_f32 v148, v148, v148
    v_mul_f32 v149, v149, v149
    v_cvt_pk_bf16_f32 v153, 0, v153
    v_cvt_pk_bf16_f32 v148, 0, v148
    v_cvt_pk_bf16_f32 v149, 0, v149
    v_add_f32 v148, v148, v149
    v_add_f32 v148, v148, v153
    v_cvt_pk_bf16_f32 v148, 0, v148
    v_add_f32 v148, s64, v148
    v_cvt_pk_bf16_f32 v148, 0, v148
    v_sqrt_f32 v148, v148
    s_nop 0
    v_cvt_pk_bf16_f32 v70, v150, v148
    v_cmp_gt_u32 vcc, s62, v70
    s_and_b64 s[10:11], s[10:11], vcc
    v_lshrrev_b32 v97, 24, v68
    v_lshrrev_b32 v121, 21, v68
    v_and_b32 v121, 16, v121
    v_lshlrev_b32 v113, v121, v19
    v_and_or_b32 v97, v97, v18, s3
    s_mov_b64 exec, s[10:11]
    s_nop 0
    s_cbranch_execz M_sa2
    ds_add_rtn_u32 v113, v97, v113
M_sa2:
    s_mov_b64 exec, -1
    s_cmp_le_u32 s19, 128
    s_cbranch_scc1 M_s2b
    v_add_u32 v151, s63, v58
    v_perm_b32 v148, v37, v36, v58
    v_add_u32 v152, s63, v151
    v_perm_b32 v149, v37, v36, v151
    v_perm_b32 v150, v37, v36, v152
    v_sub_f32 v148, v148, v48
    v_sub_f32 v149, v149, v49
    v_sub_f32 v150, v150, v50
    v_cvt_pk_bf16_f32 v73, v148, v149
    v_cvt_pk_bf16_f32 v150, 0, v150
    v_lshlrev_b32 v148, 16, v73
    v_and_b32 v149, s58, v73
    v_mul_f32 v153, v150, v150
    v_mul_f32 v148, v148, v148
    v_mul_f32 v149, v149, v149
    v_cvt_pk_bf16_f32 v153, 0, v153
    v_cvt_pk_bf16_f32 v148, 0, v148
    v_cvt_pk_bf16_f32 v149, 0, v149
    v_add_f32 v148, v148, v149
    v_add_f32 v148, v148, v153
    v_cvt_pk_bf16_f32 v148, 0, v148
    v_add_f32 v148, s64, v148
    v_cvt_pk_bf16_f32 v148, 0, v148
    v_sqrt_f32 v148, v148
    s_nop 0
    v_cvt_pk_bf16_f32 v74, v150, v148
    v_cmp_gt_u32 vcc, s62, v74
    s_and_b64 s[14:15], s[14:15], vcc
    v_lshrrev_b32 v98, 24, v72
    v_lshrrev_b32 v122, 21, v72
    v_and_b32 v122, 16, v122
    v_lshlrev_b32 v114, v122, v19
    v_and_or_b32 v98, v98, v18, s3
    s_mov_b64 exec, s[14:15]
    s_nop 0
    s_cbranch_execz M_sa3
    ds_add_rtn_u32 v114, v98, v114
M_sa3:
    s_mov_b64 exec, -1
    s_cmp_le_u32 s19, 192
    s_cbranch_scc1 M_s2b
    v_add_u32 v151, s63, v59
    v_perm_b32 v148, v39, v38, v59
    v_add_u32 v152, s63, v151
    v_perm_b32 v149, v39, v38, v151
    v_perm_b32 v150, v39, v38, v152
    v_sub_f32 v148, v148, v52
    v_sub_f32 v149, v149, v53
    v_sub_f32 v150, v150, v54
    v_cvt_pk_bf16_f32 v77, v148, v149
    v_cvt_pk_bf16_f32 v150, 0, v150
    v_lshlrev_b32 v148, 16, v77
    v_and_b32 v149, s58, v77
    v_mul_f32 v153, v150, v150
    v_mul_f32 v148, v148, v148
    v_mul_f32 v149, v149, v149
    v_cvt_pk_bf16_f32 v153, 0, v153
    v_cvt_pk_bf16_f32 v148, 0, v148
    v_cvt_pk_bf16_f32 v149, 0, v149
    v_add_f32 v148, v148, v149
    v_add_f32 v148, v148, v153
    v_cvt_pk_bf16_f32 v148, 0, v148
    v_add_f32 v148, s64, v148
    v_cvt_pk_bf16_f32 v148, 0, v148
    v_sqrt_f32 v148, v148
    s_nop 0
    v_cvt_pk_bf16_f32 v78, v150, v148
    v_cmp_gt_u32 vcc, s62, v78
    s_and_b64 s[16:17], s[16:17], vcc
    v_lshrrev_b32 v99, 24, v76
    v_lshrrev_b32 v123, 21, v76
    v_and_b32 v123, 16, v123
    v_lshlrev_b32 v115, v123, v19
    v_and_or_b32 v99, v99, v18, s3
    s_mov_b64 exec, s[16:17]
    s_nop 0
    s_cbranch_execz M_sa4
    ds_add_rtn_u32 v115, v99, v115
M_sa4:
    s_mov_b64 exec, -1
M_s2b:
    s_mov_b32 s61, 0x3e22f983
    s_movk_i32 s63, 0x70
    s_movk_i32 s64, 128
    s_movk_i32 s65, 256
    s_movk_i32 s66, 384
    v_lshrrev_b32 v21, 4, v8
    v_lshlrev_b32 v21, 9, v21
    v_and_b32 v22, 15, v8
    v_lshl_or_b32 v21, v22, 4, v21
    s_lshl_b32 s45, s26, 10
    s_add_u32 s45, s45, 30720
    s_lshl_b32 s46, s26, 11
    s_add_u32 s46, s46, s44
    s_waitcnt lgkmcnt(0)
    s_barrier
    s_cmp_eq_u32 s26, 6
    s_cbranch_scc0 M_h1
    s_mov_b32 s53, 0x830800
    buffer_load_dwordx4 v[148:151], v1, s[36:39], s53 offen sc1
M_h1:
    s_add_u32 m0, s45, 0
    s_add_u32 s53, s46, 0
    buffer_load_dwordx4 v21, s[28:31], s53 offen  lds
    s_add_u32 m0, s45, 8192
    s_add_u32 s53, s46, 16384
    buffer_load_dwordx4 v21, s[28:31], s53 offen  lds
    s_add_u32 m0, s45, 16384
    s_add_u32 s53, s46, 32768
    buffer_load_dwordx4 v21, s[28:31], s53 offen  lds
    s_add_u32 m0, s45, 24576
    s_add_u32 s53, s46, 49152
    buffer_load_dwordx4 v21, s[28:31], s53 offen  lds
    s_add_u32 m0, s45, 32768
    s_add_u32 s53, s46, 65536
    buffer_load_dwordx4 v21, s[28:31], s53 offen  lds
    s_add_u32 m0, s45, 40960
    s_add_u32 s53, s46, 81920
    buffer_load_dwordx4 v21, s[28:31], s53 offen  lds
    s_cmp_ge_u32 s26, 2
    s_cbranch_scc1 M_rs11
    s_add_u32 m0, s45, 49152
    s_add_u32 s53, s46, 98304
    buffer_load_dwordx4 v21, s[28:31], s53 offen  lds
M_rs11:
    ds_read_b32 v28, v30
    ds_read_b32 v13, v9
    s_waitcnt lgkmcnt(1)
    v_and_b32 v31, 0xffff, v28
    v_lshrrev_b32 v28, 16, v28
    v_add_u32 v28, v28, v31
    v_mov_b32 v29, v28
    s_nop 1
    v_add_u32_dpp v29, v29, v29 row_shr:1 row_mask:0xf bank_mask:0xf bound_ctrl:0
    s_nop 1
    v_add_u32_dpp v29, v29, v29 row_shr:2 row_mask:0xf bank_mask:0xf bound_ctrl:0
    s_nop 1
    v_add_u32_dpp v29, v29, v29 row_shr:4 row_mask:0xf bank_mask:0xf bound_ctrl:0
    s_nop 1
    v_add_u32_dpp v29, v29, v29 row_shr:8 row_mask:0xf bank_mask:0xf bound_ctrl:0
    s_nop 1
    v_add_u32_dpp v29, v29, v29 row_bcast:15 row_mask:0xa bank_mask:0xf
    s_nop 1
    v_add_u32_dpp v29, v29, v29 row_bcast:31 row_mask:0xc bank_mask:0xf
    v_sub_u32 v28, v29, v28
    v_add_u32 v31, v28, v31
    v_lshl_or_b32 v28, v31, 16, v28
    ds_bpermute_b32 v104, v96, v28
    ds_bpermute_b32 v105, v97, v28
    ds_bpermute_b32 v106, v98, v28
    ds_bpermute_b32 v107, v99, v28
    v_readlane_b32 s62, v29, 63
    s_mov_b32 s54, 0
    s_mov_b32 s55, 0
    s_xor_b32 s12, s26, 4
    s_cmp_gt_u32 s62, 480
    s_cselect_b32 s27, 96, 64
    v_cmp_ge_u32 vcc, s27, v29
    v_cmp_ge_u32 s[70:71], s27, v31
    s_bcnt1_i32_b64 s56, vcc
    s_bcnt1_i32_b64 s57, s[70:71]
    s_add_u32 s56, s56, s57
    s_min_u32 s56, s56, 16
    s_lshr_b32 s27, s56, 1
    s_and_b32 s69, s56, 1
    v_readlane_b32 s57, v28, s27
    s_lshl4_add_u32 s69, s69, 0x100000
    s_bfe_u32 s57, s57, s69
    s_waitcnt lgkmcnt(0)
    v_readfirstlane_b32 s46, v13
    v_add_u32 v104, v104, v112
    v_bfe_u32 v104, v104, v120, 16
    v_cmp_gt_u32 vcc, 768, v104
    v_lshl_add_u32 v104, v104, 4, s67
    s_and_b64 exec, vcc, s[8:9]
    s_nop 2
    s_cbranch_execz M_sb12
    ds_write_b96 v104, v[64:66]
M_sb12:
    s_mov_b64 exec, -1
    s_cmp_le_u32 s19, 64
    s_cbranch_scc1 M_s2c
    v_add_u32 v105, v105, v113
    v_bfe_u32 v105, v105, v121, 16
    v_cmp_gt_u32 vcc, 768, v105
    v_lshl_add_u32 v105, v105, 4, s67
    s_and_b64 exec, vcc, s[10:11]
    s_nop 2
    s_cbranch_execz M_sb13
    ds_write_b96 v105, v[68:70]
M_sb13:
    s_mov_b64 exec, -1
    s_cmp_le_u32 s19, 128
    s_cbranch_scc1 M_s2c
    v_add_u32 v106, v106, v114
    v_bfe_u32 v106, v106, v122, 16
    v_cmp_gt_u32 vcc, 768, v106
    v_lshl_add_u32 v106, v106, 4, s67
    s_and_b64 exec, vcc, s[14:15]
    s_nop 2
    s_cbranch_execz M_sb14
    ds_write_b96 v106, v[72:74]
M_sb14:
    s_mov_b64 exec, -1
    s_cmp_le_u32 s19, 192
    s_cbranch_scc1 M_s2c
    v_add_u32 v107, v107, v115
    v_bfe_u32 v107, v107, v123, 16
    v_cmp_gt_u32 vcc, 768, v107
    v_lshl_add_u32 v107, v107, 4, s67
    s_and_b64 exec, vcc, s[16:17]
    s_nop 2
    s_cbranch_execz M_sb15
    ds_write_b96 v107, v[76:78]
M_sb15:
    s_mov_b64 exec, -1
M_s2c:
    s_cmp_eq_u32 s26, 6
    s_cbranch_scc0 M_h3
    s_mov_b32 s27, 0
    v_cmp_gt_u32 s[8:9], 63, v8
    v_cmp_eq_u32 s[10:11], 62, v8
    s_waitcnt vmcnt(6)
    s_nop 3
M_h2:
    v_cndmask_b32 v150, v150, v148, s[10:11]
    v_cndmask_b32 v151, v151, v148, s[10:11]
    v_xor_b32 v148, s18, v148
    v_xor_b32 v149, s18, v149
    v_xor_b32 v150, s18, v150
    v_xor_b32 v151, s18, v151
    v_or3_b32 v148, v148, v149, v150
    v_or_b32 v148, v148, v151
    v_cmp_ne_u32 vcc, 0, v148
    s_and_b64 vcc, vcc, s[8:9]
    s_cbranch_vccz M_h3
    s_add_u32 s27, s27, 1
    s_cmp_lt_u32 s27, 16384
    s_cbranch_scc0 M_h3
    s_sleep 2
    s_mov_b32 s53, 0x830800
    buffer_load_dwordx4 v[148:151], v1, s[36:39], s53 offen sc1
    s_waitcnt vmcnt(0)
    s_branch M_h2
M_h3:
    s_cmp_eq_u32 s2, 0
    s_cbranch_scc0 M_h4
    s_cmp_eq_u32 s26, 5
    s_cbranch_scc0 M_h4
    s_mov_b32 s27, 0x830000
    v_mov_b32 v148, s18
    v_mov_b32 v149, 0
    s_mov_b64 exec, 1
    buffer_store_dword v148, v149, s[36:39], s27 offen sc1
    s_mov_b64 exec, -1
M_h4:
    s_waitcnt lgkmcnt(0)
    s_barrier
    s_cmp_eq_u32 s12, 0
    s_cbranch_scc1 M_cut
    s_sub_u32 s27, s57, s55
    s_cmp_gt_u32 s27, 64
    s_cselect_b32 s40, 64, 96
    s_mov_b32 s54, s56
    s_mov_b32 s55, s57
    s_sub_u32 s27, s62, s55
    s_cmp_gt_u32 s27, 420
    s_cselect_b32 s27, 96, 64
    s_add_u32 s27, s27, s55
    v_cmp_ge_u32 vcc, s27, v29
    v_cmp_ge_u32 s[70:71], s27, v31
    s_bcnt1_i32_b64 s56, vcc
    s_bcnt1_i32_b64 s57, s[70:71]
    s_add_u32 s27, s54, 16
    s_add_u32 s56, s56, s57
    s_min_u32 s56, s56, s27
    s_min_u32 s56, s56, 100
    s_max_u32 s56, s56, 4
    s_lshr_b32 s27, s56, 1
    s_and_b32 s69, s56, 1
    v_readlane_b32 s57, v28, s27
    s_lshl4_add_u32 s69, s69, 0x100000
    s_bfe_u32 s57, s57, s69
    s_cmp_eq_u32 s12, 1
    s_cbranch_scc1 M_cut
    s_sub_u32 s27, s57, s55
    s_cmp_gt_u32 s27, 64
    s_cselect_b32 s41, 64, 96
    s_mov_b32 s54, s56
    s_mov_b32 s55, s57
    s_sub_u32 s27, s62, s55
    s_cmp_gt_u32 s27, 360
    s_cselect_b32 s27, 96, 64
    s_add_u32 s27, s27, s55
    v_cmp_ge_u32 vcc, s27, v29
    v_cmp_ge_u32 s[70:71], s27, v31
    s_bcnt1_i32_b64 s56, vcc
    s_bcnt1_i32_b64 s57, s[70:71]
    s_add_u32 s27, s54, 16
    s_add_u32 s56, s56, s57
    s_min_u32 s56, s56, s27
    s_min_u32 s56, s56, 100
    s_max_u32 s56, s56, 20
    s_lshr_b32 s27, s56, 1
    s_and_b32 s69, s56, 1
    v_readlane_b32 s57, v28, s27
    s_lshl4_add_u32 s69, s69, 0x100000
    s_bfe_u32 s57, s57, s69
    s_cmp_eq_u32 s12, 2
    s_cbranch_scc1 M_cut
    s_sub_u32 s27, s57, s55
    s_cmp_gt_u32 s27, 64
    s_cselect_b32 s42, 64, 96
    s_mov_b32 s54, s56
    s_mov_b32 s55, s57
    s_sub_u32 s27, s62, s55
    s_cmp_gt_u32 s27, 300
    s_cselect_b32 s27, 96, 64
    s_add_u32 s27, s27, s55
    v_cmp_ge_u32 vcc, s27, v29
    v_cmp_ge_u32 s[70:71], s27, v31
    s_bcnt1_i32_b64 s56, vcc
    s_bcnt1_i32_b64 s57, s[70:71]
    s_add_u32 s27, s54, 16
    s_add_u32 s56, s56, s57
    s_min_u32 s56, s56, s27
    s_min_u32 s56, s56, 100
    s_max_u32 s56, s56, 36
    s_lshr_b32 s27, s56, 1
    s_and_b32 s69, s56, 1
    v_readlane_b32 s57, v28, s27
    s_lshl4_add_u32 s69, s69, 0x100000
    s_bfe_u32 s57, s57, s69
    s_cmp_eq_u32 s12, 3
    s_cbranch_scc1 M_cut
    s_mov_b32 s54, s56
    s_mov_b32 s55, s57
    s_sub_u32 s27, s62, s55
    s_cmp_gt_u32 s27, 248
    s_cselect_b32 s27, s40, 64
    s_add_u32 s27, s27, s55
    v_cmp_ge_u32 vcc, s27, v29
    v_cmp_ge_u32 s[70:71], s27, v31
    s_bcnt1_i32_b64 s56, vcc
    s_bcnt1_i32_b64 s57, s[70:71]
    s_add_u32 s27, s54, 16
    s_add_u32 s56, s56, s57
    s_min_u32 s56, s56, s27
    s_min_u32 s56, s56, 100
    s_max_u32 s56, s56, 52
    s_lshr_b32 s27, s56, 1
    s_and_b32 s69, s56, 1
    v_readlane_b32 s57, v28, s27
    s_lshl4_add_u32 s69, s69, 0x100000
    s_bfe_u32 s57, s57, s69
    s_cmp_eq_u32 s12, 4
    s_cbranch_scc1 M_cut
    s_mov_b32 s54, s56
    s_mov_b32 s55, s57
    s_sub_u32 s27, s62, s55
    s_cmp_gt_u32 s27, 186
    s_cselect_b32 s27, s41, 64
    s_add_u32 s27, s27, s55
    v_cmp_ge_u32 vcc, s27, v29
    v_cmp_ge_u32 s[70:71], s27, v31
    s_bcnt1_i32_b64 s56, vcc
    s_bcnt1_i32_b64 s57, s[70:71]
    s_add_u32 s27, s54, 16
    s_add_u32 s56, s56, s57
    s_min_u32 s56, s56, s27
    s_min_u32 s56, s56, 100
    s_max_u32 s56, s56, 68
    s_lshr_b32 s27, s56, 1
    s_and_b32 s69, s56, 1
    v_readlane_b32 s57, v28, s27
    s_lshl4_add_u32 s69, s69, 0x100000
    s_bfe_u32 s57, s57, s69
    s_cmp_eq_u32 s12, 5
    s_cbranch_scc1 M_cut
    s_mov_b32 s54, s56
    s_mov_b32 s55, s57
    s_sub_u32 s27, s62, s55
    s_cmp_gt_u32 s27, 124
    s_cselect_b32 s27, s42, 64
    s_add_u32 s27, s27, s55
    v_cmp_ge_u32 vcc, s27, v29
    v_cmp_ge_u32 s[70:71], s27, v31
    s_bcnt1_i32_b64 s56, vcc
    s_bcnt1_i32_b64 s57, s[70:71]
    s_add_u32 s27, s54, 16
    s_add_u32 s56, s56, s57
    s_min_u32 s56, s56, s27
    s_min_u32 s56, s56, 100
    s_max_u32 s56, s56, 84
    s_lshr_b32 s27, s56, 1
    s_and_b32 s69, s56, 1
    v_readlane_b32 s57, v28, s27
    s_lshl4_add_u32 s69, s69, 0x100000
    s_bfe_u32 s57, s57, s69
    s_cmp_eq_u32 s12, 6
    s_cbranch_scc1 M_cut
    s_mov_b32 s54, s56
    s_mov_b32 s55, s57
    s_movk_i32 s56, 100
    s_mov_b32 s57, s62
M_cut:
    s_lshl_b32 s27, s55, 4
    s_add_u32 s27, s27, s67
    v_add_u32 v14, s27, v1
    v_lshlrev_b32 v15, 4, v11
    v_add_u32 v15, s27, v15
    ds_read_b32 v15, v15
    ds_read_b96 v[88:90], v14
    ds_read_b96 v[92:94], v14 offset:1024
    s_lshl_b32 s59, s54, 1
    s_sub_u32 s45, s56, s54
    s_lshl_b32 s45, s45, 1
    s_lshl_b32 s40, s54, 10
    s_add_u32 s40, s40, s44
    s_add_u32 s41, s40, 4096
    s_add_u32 s42, s40, 8192
    s_add_u32 s43, s40, 12288
    s_lshl_b32 s6, s56, 10
    s_add_u32 s6, s6, s44
    s_mov_b32 s34, s6
    s_sub_u32 s47, s57, s55
    v_add_u32 v86, 64, v8
    s_mov_b32 s50, 1
    s_cmp_gt_u32 s47, 128
    s_cselect_b32 s27, 1, s46
    s_cmp_gt_u32 s57, 768
    s_cselect_b32 s27, 1, s27
    s_cmp_eq_u32 s27, 0
    s_cselect_b32 s47, s47, 0
    s_cselect_b32 s76, 1, 0
    s_mov_b32 s14, 0
    s_mov_b32 s15, 0
    s_mov_b32 s16, 0
    s_mov_b32 s17, 0
    v_cmp_gt_u32 s[8:9], s47, v8
    v_cmp_gt_u32 s[10:11], s47, v86
    s_add_u32 s48, s47, 31
    s_lshr_b32 s48, s48, 5
    v_bfrev_b32 v14, 2
    v_cmp_gt_u32 vcc, s47, v11
    s_mov_b32 s27, 0x1fffe
    s_waitcnt lgkmcnt(2)
    v_and_b32 v15, s27, v15
    v_lshlrev_b32 v15, 6, v15
    v_lshl_add_u32 v15, v10, 6, v15
    v_cndmask_b32 v15, v14, v15, vcc
    buffer_load_dwordx4 v[32:35], v15, s[72:75], 0 offen offset:0
    buffer_load_dwordx4 v[36:39], v15, s[72:75], 0 offen offset:16
    buffer_load_dwordx4 v[40:43], v15, s[72:75], 0 offen offset:32
    buffer_load_dwordx4 v[44:47], v15, s[72:75], 0 offen offset:48
    s_waitcnt lgkmcnt(0)
M_win:
    v_lshrrev_b32 v8, 4, v1
    s_mov_b32 s53, 0x40490fdb
    s_mov_b32 s70, 0
    s_mov_b32 s54, 0x3e4ccccd
    s_mov_b32 s55, 0x1fffe
    v_mov_b32 v87, 1
    v_bfrev_b32 v14, 2
    v_and_b32 v96, s58, v90
    v_cndmask_b32 v96, 1.0, v96, s[8:9]
    v_rcp_f32 v98, v96
    v_mul_f32 v97, s53, v96
    v_cvt_pk_bf16_f32 v97, 0, v97
    v_mul_f32 v97, s54, v97
    v_cvt_pk_bf16_f32 v97, 0, v97
    v_mul_f32 v97, s61, v97
    v_cos_f32 v97, v97
    v_lshlrev_b32 v100, 16, v89
    v_and_b32 v101, s58, v89
    v_lshlrev_b32 v102, 16, v90
    v_cvt_pk_bf16_f32 v97, 0, v97
    v_add_f32 v97, 1.0, v97
    v_cvt_pk_bf16_f32 v97, 0, v97
    v_cndmask_b32 v97, 0, v97, s[8:9]
    v_mul_f32 v97, v97, v98
    v_add_f32 v103, v98, v98
    v_mul_f32 v97, 0x3e800000, v97
    v_mul_f32 v100, v100, v103
    v_mul_f32 v101, v101, v103
    v_mul_f32 v102, v102, v103
    v_and_b32 v99, s55, v88
    v_lshlrev_b32 v99, 8, v99
    v_cndmask_b32 v99, v14, v99, s[8:9]
    v_cvt_pk_bf16_f32 v100, v100, v101
    v_cvt_pk_bf16_f32 v102, 0, v102
    v_cndmask_b32 v104, 0, v87, s[8:9]
    v_mov_b32 v105, 0
    v_lshrrev_b32 v108, 24, v88
    v_subrev_u32 v108, s59, v108
    v_lshlrev_b32 v108, 1, v108
    v_lshlrev_b64 v[106:107], v108, v[104:105]
    ds_write_b128 v16, v[96:99] offset:0
    ds_write_b16 v17, v106 offset:2048
    ds_write_b16_d16_hi v17, v106 offset:2056
    ds_write_b16 v17, v107 offset:2064
    ds_write_b16_d16_hi v17, v107 offset:2072
    ds_write_b16 v17, v100 offset:2080
    ds_write_b16_d16_hi v17, v100 offset:2088
    ds_write_b16_d16_hi v17, v102 offset:2096
    s_cmp_eq_u64 s[10:11], 0
    s_cbranch_scc1 M_g1
    v_and_b32 v112, s58, v94
    v_cndmask_b32 v112, 1.0, v112, s[10:11]
    v_rcp_f32 v114, v112
    v_mul_f32 v113, s53, v112
    v_cvt_pk_bf16_f32 v113, 0, v113
    v_mul_f32 v113, s54, v113
    v_cvt_pk_bf16_f32 v113, 0, v113
    v_mul_f32 v113, s61, v113
    v_cos_f32 v113, v113
    v_lshlrev_b32 v116, 16, v93
    v_and_b32 v117, s58, v93
    v_lshlrev_b32 v118, 16, v94
    v_cvt_pk_bf16_f32 v113, 0, v113
    v_add_f32 v113, 1.0, v113
    v_cvt_pk_bf16_f32 v113, 0, v113
    v_cndmask_b32 v113, 0, v113, s[10:11]
    v_mul_f32 v113, v113, v114
    v_add_f32 v119, v114, v114
    v_mul_f32 v113, 0x3e800000, v113
    v_mul_f32 v116, v116, v119
    v_mul_f32 v117, v117, v119
    v_mul_f32 v118, v118, v119
    v_and_b32 v115, s55, v92
    v_lshlrev_b32 v115, 8, v115
    v_cndmask_b32 v115, v14, v115, s[10:11]
    v_cvt_pk_bf16_f32 v116, v116, v117
    v_cvt_pk_bf16_f32 v118, 0, v118
    v_cndmask_b32 v120, 0, v87, s[10:11]
    v_mov_b32 v121, 0
    v_lshrrev_b32 v124, 24, v92
    v_subrev_u32 v124, s59, v124
    v_lshlrev_b32 v124, 1, v124
    v_lshlrev_b64 v[122:123], v124, v[120:121]
    ds_write_b128 v16, v[112:115] offset:1024
    ds_write_b16 v17, v122 offset:2944
    ds_write_b16_d16_hi v17, v122 offset:2952
    ds_write_b16 v17, v123 offset:2960
    ds_write_b16_d16_hi v17, v123 offset:2968
    ds_write_b16 v17, v116 offset:2976
    ds_write_b16_d16_hi v17, v116 offset:2984
    ds_write_b16_d16_hi v17, v118 offset:2992
M_g1:
    s_waitcnt lgkmcnt(0)
    s_cmp_lg_u32 s50, 0
    s_cbranch_scc1 M_first
    s_cmp_eq_u32 s48, 0
    s_cselect_b32 s77, 0x40000000, 0
    ds_read_b32 v47, v3 offset:12
    v_bfe_u32 v46, v1, 9, 1
    s_waitcnt lgkmcnt(0)
    v_lshrrev_b32 v47, 2, v47
    v_lshl_add_u32 v47, v46, 6, v47
    buffer_load_dwordx4 v[32:35], v47, s[72:75], s77 offen offset:0
    buffer_load_dwordx4 v[36:39], v47, s[72:75], s77 offen offset:16
    buffer_load_dwordx4 v[40:43], v47, s[72:75], s77 offen offset:32
    buffer_load_dwordx4 v[44:47], v47, s[72:75], s77 offen offset:48
    s_branch M_noacc
M_first:
    s_mov_b32 s50, 2
    s_sub_u32 s27, s26, 4
    s_cmp_ge_u32 s27, 3
    s_cbranch_scc1 M_late
    s_cmp_eq_u32 s48, 0
    s_cbranch_scc1 M_late
    ds_read_b32 v64, v5 offset:12
    ds_read_b32 v65, v5 offset:140
    ds_read_b32 v66, v5 offset:268
    ds_read_b32 v67, v5 offset:396
    s_waitcnt lgkmcnt(3)
    v_and_or_b32 v64, v1, s63, v64
    s_waitcnt lgkmcnt(2)
    v_and_or_b32 v65, v1, s63, v65
    s_waitcnt lgkmcnt(1)
    v_and_or_b32 v66, v1, s63, v66
    s_waitcnt lgkmcnt(0)
    v_and_or_b32 v67, v1, s63, v67
    s_add_u32 m0, s51, 0
    s_nop 0
    buffer_load_dwordx4 v64, s[28:31], s64 offen lds
    s_add_u32 m0, s51, 1024
    s_nop 0
    buffer_load_dwordx4 v64, s[28:31], s65 offen lds
    s_add_u32 m0, s51, 2048
    s_nop 0
    buffer_load_dwordx4 v64, s[28:31], s66 offen lds
    s_add_u32 m0, s51, 3072
    s_nop 0
    buffer_load_dwordx4 v65, s[28:31], s64 offen lds
    s_add_u32 m0, s51, 4096
    s_nop 0
    buffer_load_dwordx4 v65, s[28:31], s65 offen lds
    s_add_u32 m0, s51, 5120
    s_nop 0
    buffer_load_dwordx4 v65, s[28:31], s66 offen lds
    s_add_u32 m0, s51, 6144
    s_nop 0
    buffer_load_dwordx4 v66, s[28:31], s64 offen lds
    s_add_u32 m0, s51, 7168
    s_nop 0
    buffer_load_dwordx4 v66, s[28:31], s65 offen lds
    s_add_u32 m0, s51, 8192
    s_nop 0
    buffer_load_dwordx4 v66, s[28:31], s66 offen lds
    s_add_u32 m0, s51, 9216
    s_nop 0
    buffer_load_dwordx4 v67, s[28:31], s64 offen lds
    s_add_u32 m0, s51, 10240
    s_nop 0
    buffer_load_dwordx4 v67, s[28:31], s65 offen lds
    s_add_u32 m0, s51, 11264
    s_nop 0
    buffer_load_dwordx4 v67, s[28:31], s66 offen lds
    s_mov_b32 s50, 3
    s_waitcnt vmcnt(16)
    s_branch M_late2
M_late:
    s_waitcnt vmcnt(4)
M_late2:
    s_lshl_b32 s27, s59, 8
    s_add_u32 s27, s27, 30720
    v_lshlrev_b32 v12, 10, v10
    v_lshl_add_u32 v12, v11, 2, v12
    v_add_u32 v12, s27, v12
    s_barrier
    ds_read_u16_d16_hi v128, v12 offset:0
    ds_read_u16_d16_hi v144, v12 offset:2
    ds_read_u16_d16_hi v129, v12 offset:256
    ds_read_u16_d16_hi v145, v12 offset:258
    ds_read_u16_d16_hi v130, v12 offset:512
    ds_read_u16_d16_hi v146, v12 offset:514
    ds_read_u16_d16_hi v131, v12 offset:768
    ds_read_u16_d16_hi v147, v12 offset:770
    ds_read_u16_d16_hi v132, v12 offset:2048
    ds_read_u16_d16_hi v148, v12 offset:2050
    ds_read_u16_d16_hi v133, v12 offset:2304
    ds_read_u16_d16_hi v149, v12 offset:2306
    ds_read_u16_d16_hi v134, v12 offset:2560
    ds_read_u16_d16_hi v150, v12 offset:2562
    ds_read_u16_d16_hi v135, v12 offset:2816
    ds_read_u16_d16_hi v151, v12 offset:2818
    ds_read_u16_d16_hi v136, v12 offset:4096
    ds_read_u16_d16_hi v152, v12 offset:4098
    ds_read_u16_d16_hi v137, v12 offset:4352
    ds_read_u16_d16_hi v153, v12 offset:4354
    ds_read_u16_d16_hi v138, v12 offset:4608
    ds_read_u16_d16_hi v154, v12 offset:4610
    ds_read_u16_d16_hi v139, v12 offset:4864
    ds_read_u16_d16_hi v155, v12 offset:4866
    ds_read_u16_d16_hi v140, v12 offset:6144
    ds_read_u16_d16_hi v156, v12 offset:6146
    ds_read_u16_d16_hi v141, v12 offset:6400
    ds_read_u16_d16_hi v157, v12 offset:6402
    ds_read_u16_d16_hi v142, v12 offset:6656
    ds_read_u16_d16_hi v158, v12 offset:6658
    ds_read_u16_d16_hi v143, v12 offset:6912
    ds_read_u16_d16_hi v159, v12 offset:6914
    ds_read_u16_d16_hi v160, v12 offset:128
    ds_read_u16_d16_hi v176, v12 offset:130
    ds_read_u16_d16_hi v161, v12 offset:384
    ds_read_u16_d16_hi v177, v12 offset:386
    ds_read_u16_d16_hi v162, v12 offset:640
    ds_read_u16_d16_hi v178, v12 offset:642
    ds_read_u16_d16_hi v163, v12 offset:896
    ds_read_u16_d16_hi v179, v12 offset:898
    ds_read_u16_d16_hi v164, v12 offset:2176
    ds_read_u16_d16_hi v180, v12 offset:2178
    ds_read_u16_d16_hi v165, v12 offset:2432
    ds_read_u16_d16_hi v181, v12 offset:2434
    ds_read_u16_d16_hi v166, v12 offset:2688
    ds_read_u16_d16_hi v182, v12 offset:2690
    ds_read_u16_d16_hi v167, v12 offset:2944
    ds_read_u16_d16_hi v183, v12 offset:2946
    ds_read_u16_d16_hi v168, v12 offset:4224
    ds_read_u16_d16_hi v184, v12 offset:4226
    ds_read_u16_d16_hi v169, v12 offset:4480
    ds_read_u16_d16_hi v185, v12 offset:4482
    ds_read_u16_d16_hi v170, v12 offset:4736
    ds_read_u16_d16_hi v186, v12 offset:4738
    ds_read_u16_d16_hi v171, v12 offset:4992
    ds_read_u16_d16_hi v187, v12 offset:4994
    ds_read_u16_d16_hi v172, v12 offset:6272
    ds_read_u16_d16_hi v188, v12 offset:6274
    ds_read_u16_d16_hi v173, v12 offset:6528
    ds_read_u16_d16_hi v189, v12 offset:6530
    ds_read_u16_d16_hi v174, v12 offset:6784
    ds_read_u16_d16_hi v190, v12 offset:6786
    ds_read_u16_d16_hi v175, v12 offset:7040
    ds_read_u16_d16_hi v191, v12 offset:7042
    s_waitcnt lgkmcnt(0)
    s_cmp_eq_u32 s50, 3
    s_cbranch_scc1 M_noinit
    s_cmp_ge_u32 s26, 4
    s_cbranch_scc1 M_noacc
    s_barrier
    s_mov_b32 s50, 0
    s_cmp_eq_u32 s48, 0
    s_cbranch_scc1 M_noacc
    s_mov_b32 s70, 1
    s_waitcnt vmcnt(0)
    s_branch M_noinit
M_noacc:
    s_cmp_eq_u32 s48, 0
    s_cbranch_scc1 M_nob
    ds_read_b32 v64, v5 offset:12
    ds_read_b32 v65, v5 offset:140
    ds_read_b32 v66, v5 offset:268
    ds_read_b32 v67, v5 offset:396
    s_waitcnt lgkmcnt(3)
    v_and_or_b32 v64, v1, s63, v64
    s_waitcnt lgkmcnt(2)
    v_and_or_b32 v65, v1, s63, v65
    s_waitcnt lgkmcnt(1)
    v_and_or_b32 v66, v1, s63, v66
    s_waitcnt lgkmcnt(0)
    v_and_or_b32 v67, v1, s63, v67
    s_add_u32 m0, s51, 0
    s_nop 0
    buffer_load_dwordx4 v64, s[28:31], s64 offen lds
    s_add_u32 m0, s51, 1024
    s_nop 0
    buffer_load_dwordx4 v64, s[28:31], s65 offen lds
    s_add_u32 m0, s51, 2048
    s_nop 0
    buffer_load_dwordx4 v64, s[28:31], s66 offen lds
    s_add_u32 m0, s51, 3072
    s_nop 0
    buffer_load_dwordx4 v65, s[28:31], s64 offen lds
    s_add_u32 m0, s51, 4096
    s_nop 0
    buffer_load_dwordx4 v65, s[28:31], s65 offen lds
    s_add_u32 m0, s51, 5120
    s_nop 0
    buffer_load_dwordx4 v65, s[28:31], s66 offen lds
    s_add_u32 m0, s51, 6144
    s_nop 0
    buffer_load_dwordx4 v66, s[28:31], s64 offen lds
    s_add_u32 m0, s51, 7168
    s_nop 0
    buffer_load_dwordx4 v66, s[28:31], s65 offen lds
    s_add_u32 m0, s51, 8192
    s_nop 0
    buffer_load_dwordx4 v66, s[28:31], s66 offen lds
    s_add_u32 m0, s51, 9216
    s_nop 0
    buffer_load_dwordx4 v67, s[28:31], s64 offen lds
    s_add_u32 m0, s51, 10240
    s_nop 0
    buffer_load_dwordx4 v67, s[28:31], s65 offen lds
    s_add_u32 m0, s51, 11264
    s_nop 0
    buffer_load_dwordx4 v67, s[28:31], s66 offen lds
    s_branch M_noinit
M_nob:
    s_cmp_eq_u32 s76, 0
    s_cbranch_scc1 M_noinit
    v_lshrrev_b32 v64, 7, v1
    v_and_b32 v65, 1, v64
    v_lshrrev_b32 v64, 1, v64
    v_lshl_add_u32 v64, v65, 2, v64
    v_lshlrev_b32 v64, 9, v64
    v_and_or_b32 v64, v1, s63, v64
    s_add_u32 m0, s51, 1024
    s_add_u32 s53, s40, 256
    buffer_load_dwordx4 v64, s[4:7], s53 offen  lds
    s_add_u32 m0, s51, 2048
    s_add_u32 s53, s40, 384
    buffer_load_dwordx4 v64, s[4:7], s53 offen  lds
    s_add_u32 m0, s51, 4096
    s_add_u32 s53, s41, 256
    buffer_load_dwordx4 v64, s[4:7], s53 offen  lds
    s_add_u32 m0, s51, 5120
    s_add_u32 s53, s41, 384
    buffer_load_dwordx4 v64, s[4:7], s53 offen  lds
    s_add_u32 m0, s51, 7168
    s_add_u32 s53, s42, 256
    buffer_load_dwordx4 v64, s[4:7], s53 offen  lds
    s_add_u32 m0, s51, 8192
    s_add_u32 s53, s42, 384
    buffer_load_dwordx4 v64, s[4:7], s53 offen  lds
    s_add_u32 m0, s51, 10240
    s_add_u32 s53, s43, 256
    buffer_load_dwordx4 v64, s[4:7], s53 offen  lds
    s_add_u32 m0, s51, 11264
    s_add_u32 s53, s43, 384
    buffer_load_dwordx4 v64, s[4:7], s53 offen  lds
M_noinit:
    s_cmp_eq_u32 s50, 0
    s_cbranch_scc1 M_nod
    s_barrier
    s_mov_b32 s50, 0
M_nod:
    s_cmp_eq_u32 s48, 0
    s_cbranch_scc1 M_wend
    s_mov_b32 s49, 0
    s_cmp_lt_u32 s26, 4
    s_cbranch_scc1 M_yp
    s_setprio 1
M_yp:
    ds_read_b128 v[104:107], v3 offset:0
    ds_read_b128 v[72:75], v7
    ds_read_b128 v[76:79], v7 offset:16
    ds_read_b64 v[12:13], v4 offset:2048
    ds_read_b64 v[14:15], v4 offset:2160
    ds_read_b64 v[16:17], v4 offset:2272
    ds_read_b64 v[18:19], v4 offset:2384
    ds_read_b128 v[20:23], v1 offset:24576
    ds_read_b128 v[24:27], v1 offset:0
    ds_read_b128 v[28:31], v1 offset:1024
    s_waitcnt lgkmcnt(7)
    v_mul_f32 v72, v104, v72
    v_mul_f32 v73, v104, v73
    v_mul_f32 v74, v104, v74
    v_mul_f32 v75, v104, v75
    v_mul_f32 v76, v104, v76
    v_mul_f32 v77, v104, v77
    v_mul_f32 v78, v104, v78
    v_mul_f32 v79, v104, v79
    v_cvt_pk_bf16_f32 v72, 0, v72
    v_cvt_pk_bf16_f32 v73, 0, v73
    v_cvt_pk_bf16_f32 v74, 0, v74
    v_cvt_pk_bf16_f32 v75, 0, v75
    v_cvt_pk_bf16_f32 v76, 0, v76
    v_cvt_pk_bf16_f32 v77, 0, v77
    v_cvt_pk_bf16_f32 v78, 0, v78
    v_cvt_pk_bf16_f32 v79, 0, v79
    v_mul_f32 v72, s61, v72
    v_mul_f32 v73, s61, v73
    v_mul_f32 v74, s61, v74
    v_mul_f32 v75, s61, v75
    v_mul_f32 v76, s61, v76
    v_mul_f32 v77, s61, v77
    v_mul_f32 v78, s61, v78
    v_mul_f32 v79, s61, v79
    v_sin_f32 v72, v72
    v_sin_f32 v73, v73
    v_sin_f32 v74, v74
    v_sin_f32 v75, v75
    v_sin_f32 v76, v76
    v_sin_f32 v77, v77
    v_sin_f32 v78, v78
    v_sin_f32 v79, v79
    v_mul_f32 v72, v72, v105
    v_mul_f32 v73, v73, v105
    v_mul_f32 v74, v74, v105
    v_mul_f32 v75, v75, v105
    v_mul_f32 v76, v76, v105
    v_mul_f32 v77, v77, v105
    v_mul_f32 v78, v78, v105
    v_mul_f32 v79, v79, v105
    v_cvt_pk_bf16_f32 v8, v72, v73
    v_cvt_pk_bf16_f32 v9, v74, v75
    v_cvt_pk_bf16_f32 v10, v76, v77
    v_cvt_pk_bf16_f32 v11, v78, v79
    s_waitcnt lgkmcnt(3)
    v_pk_lshlrev_b16 v12, v6, v12
    v_pk_lshlrev_b16 v13, v6, v13
    v_pk_lshlrev_b16 v14, v6, v14
    v_pk_lshlrev_b16 v15, v6, v15
    v_pk_lshlrev_b16 v16, v6, v16
    v_pk_lshlrev_b16 v17, v6, v17
    v_pk_lshlrev_b16 v18, v6, v18
    v_pk_lshlrev_b16 v19, v6, v19
    s_waitcnt lgkmcnt(0)
    s_nop 0
M_batch:
    s_waitcnt vmcnt(12)
    v_mfma_f32_32x32x16_bf16 v[80:95], v[8:11], v[20:23], 0
    ds_read_b128 v[20:23], v1 offset:2048
    s_add_u32 s77, s49, 1
    s_cmp_lt_u32 s77, s48
    s_cselect_b32 s77, 0, 0x40000000
    ds_read_b32 v63, v3 offset:524
    v_bfe_u32 v62, v1, 9, 1
    s_waitcnt lgkmcnt(0)
    v_lshrrev_b32 v63, 2, v63
    v_lshl_add_u32 v63, v62, 6, v63
    buffer_load_dwordx4 v[48:51], v63, s[72:75], s77 offen offset:0
    buffer_load_dwordx4 v[52:55], v63, s[72:75], s77 offen offset:16
    buffer_load_dwordx4 v[56:59], v63, s[72:75], s77 offen offset:32
    buffer_load_dwordx4 v[60:63], v63, s[72:75], s77 offen offset:48
    s_cmp_eq_u32 s70, 0
    s_cbranch_scc1 M_vb16
    ds_read_b32 v112, v5 offset:12
    ds_read_b32 v113, v5 offset:140
    s_waitcnt lgkmcnt(1)
    v_and_or_b32 v112, v1, s63, v112
    s_add_u32 m0, s51, 0
    s_nop 0
    buffer_load_dwordx4 v112, s[28:31], s64 offen lds
    s_add_u32 m0, s51, 1024
    s_nop 0
    buffer_load_dwordx4 v112, s[28:31], s65 offen lds
    s_add_u32 m0, s51, 2048
    s_nop 0
    buffer_load_dwordx4 v112, s[28:31], s66 offen lds
    s_waitcnt lgkmcnt(0)
    v_and_or_b32 v113, v1, s63, v113
    s_add_u32 m0, s51, 3072
    s_nop 0
    buffer_load_dwordx4 v113, s[28:31], s64 offen lds
    s_add_u32 m0, s51, 4096
    s_nop 0
    buffer_load_dwordx4 v113, s[28:31], s65 offen lds
    s_add_u32 m0, s51, 5120
    s_nop 0
    buffer_load_dwordx4 v113, s[28:31], s66 offen lds
M_vb16:
    v_mfma_f32_32x32x16_bf16 v[64:79], v[32:35], v[24:27], 0
    ds_read_b128 v[24:27], v1 offset:3072
    v_mfma_f32_32x32x16_bf16 v[64:79], v[36:39], v[28:31], v[64:79]
    ds_read_b128 v[28:31], v1 offset:25600
    v_mfma_f32_32x32x16_bf16 v[64:79], v[40:43], v[20:23], v[64:79]
    ds_read_b128 v[20:23], v1 offset:4096
    s_waitcnt lgkmcnt(2)
    v_mfma_f32_32x32x16_bf16 v[64:79], v[44:47], v[24:27], v[64:79]
    ds_read_b128 v[24:27], v1 offset:5120
    s_cmp_eq_u32 s70, 0
    s_nop 9
    s_cbranch_scc1 M_vb17
    ds_read_b32 v114, v5 offset:268
    s_waitcnt lgkmcnt(0)
    v_and_or_b32 v114, v1, s63, v114
    s_add_u32 m0, s51, 6144
    s_nop 0
    buffer_load_dwordx4 v114, s[28:31], s64 offen lds
    s_add_u32 m0, s51, 7168
    s_nop 0
    buffer_load_dwordx4 v114, s[28:31], s65 offen lds
    s_add_u32 m0, s51, 8192
    s_nop 0
    buffer_load_dwordx4 v114, s[28:31], s66 offen lds
M_vb17:
    s_waitcnt lgkmcnt(2)
    v_mfma_f32_32x32x16_bf16 v[112:127], v[8:11], v[28:31], 0
    ds_read_b128 v[28:31], v1 offset:6144
    s_waitcnt lgkmcnt(2)
    v_mfma_f32_32x32x16_bf16 v[96:111], v[32:35], v[20:23], 0
    ds_read_b128 v[20:23], v1 offset:7168
    v_mul_f32 v64, v64, v80
    v_mul_f32 v65, v65, v81
    v_mul_f32 v66, v66, v82
    v_mul_f32 v67, v67, v83
    v_mul_f32 v68, v68, v84
    v_mul_f32 v69, v69, v85
    s_waitcnt lgkmcnt(2)
    v_mfma_f32_32x32x16_bf16 v[96:111], v[36:39], v[24:27], v[96:111]
    ds_read_b128 v[24:27], v1 offset:26624
    v_mul_f32 v70, v70, v86
    v_mul_f32 v71, v71, v87
    v_mul_f32 v72, v72, v88
    v_mul_f32 v73, v73, v89
    v_mul_f32 v74, v74, v90
    v_mul_f32 v75, v75, v91
    v_mul_f32 v76, v76, v92
    s_waitcnt lgkmcnt(2)
    v_mfma_f32_32x32x16_bf16 v[96:111], v[40:43], v[28:31], v[96:111]
    ds_read_b128 v[28:31], v1 offset:8192
    v_mul_f32 v77, v77, v93
    v_mul_f32 v78, v78, v94
    v_mul_f32 v79, v79, v95
    v_cvt_pk_bf16_f32 v64, v64, v65
    v_cvt_pk_bf16_f32 v65, v66, v67
    v_cvt_pk_bf16_f32 v66, v68, v69
    s_waitcnt lgkmcnt(2)
    v_mfma_f32_32x32x16_bf16 v[96:111], v[44:47], v[20:23], v[96:111]
    ds_read_b128 v[20:23], v1 offset:9216
    v_cvt_pk_bf16_f32 v67, v70, v71
    v_cvt_pk_bf16_f32 v68, v72, v73
    v_cvt_pk_bf16_f32 v69, v74, v75
    v_cvt_pk_bf16_f32 v70, v76, v77
    v_cvt_pk_bf16_f32 v71, v78, v79
    v_mfma_f32_32x32x16_bf16 v[128:143], v[12:15], v[64:67], v[128:143]
    s_nop 0
    v_mfma_f32_32x32x16_bf16 v[128:143], v[16:19], v[68:71], v[128:143]
    s_cmp_eq_u32 s70, 0
    s_nop 10
    s_cbranch_scc1 M_vb18
    ds_read_b32 v72, v5 offset:396
    s_waitcnt lgkmcnt(0)
    v_and_or_b32 v72, v1, s63, v72
    s_add_u32 m0, s51, 9216
    s_nop 0
    buffer_load_dwordx4 v72, s[28:31], s64 offen lds
    s_add_u32 m0, s51, 10240
    s_nop 0
    buffer_load_dwordx4 v72, s[28:31], s65 offen lds
    s_add_u32 m0, s51, 11264
    s_nop 0
    buffer_load_dwordx4 v72, s[28:31], s66 offen lds
M_vb18:
    s_waitcnt lgkmcnt(2)
    v_mfma_f32_32x32x16_bf16 v[80:95], v[8:11], v[24:27], 0
    ds_read_b128 v[24:27], v1 offset:10240
    s_waitcnt lgkmcnt(2)
    v_mfma_f32_32x32x16_bf16 v[64:79], v[32:35], v[28:31], 0
    ds_read_b128 v[28:31], v1 offset:11264
    v_mul_f32 v96, v96, v112
    v_mul_f32 v97, v97, v113
    v_mul_f32 v98, v98, v114
    v_mul_f32 v99, v99, v115
    v_mul_f32 v100, v100, v116
    v_mul_f32 v101, v101, v117
    s_waitcnt lgkmcnt(2)
    v_mfma_f32_32x32x16_bf16 v[64:79], v[36:39], v[20:23], v[64:79]
    ds_read_b128 v[20:23], v1 offset:27648
    v_mul_f32 v102, v102, v118
    v_mul_f32 v103, v103, v119
    v_mul_f32 v104, v104, v120
    v_mul_f32 v105, v105, v121
    v_mul_f32 v106, v106, v122
    v_mul_f32 v107, v107, v123
    v_mul_f32 v108, v108, v124
    s_waitcnt lgkmcnt(2)
    v_mfma_f32_32x32x16_bf16 v[64:79], v[40:43], v[24:27], v[64:79]
    ds_read_b128 v[24:27], v1 offset:12288
    v_mul_f32 v109, v109, v125
    v_mul_f32 v110, v110, v126
    v_mul_f32 v111, v111, v127
    v_cvt_pk_bf16_f32 v96, v96, v97
    v_cvt_pk_bf16_f32 v97, v98, v99
    v_cvt_pk_bf16_f32 v98, v100, v101
    s_waitcnt lgkmcnt(2)
    v_mfma_f32_32x32x16_bf16 v[64:79], v[44:47], v[28:31], v[64:79]
    ds_read_b128 v[28:31], v1 offset:13312
    v_cvt_pk_bf16_f32 v99, v102, v103
    v_cvt_pk_bf16_f32 v100, v104, v105
    v_cvt_pk_bf16_f32 v101, v106, v107
    v_cvt_pk_bf16_f32 v102, v108, v109
    v_cvt_pk_bf16_f32 v103, v110, v111
    v_mfma_f32_32x32x16_bf16 v[144:159], v[12:15], v[96:99], v[144:159]
    s_nop 0
    v_mfma_f32_32x32x16_bf16 v[144:159], v[16:19], v[100:103], v[144:159]
    s_waitcnt lgkmcnt(2)
    v_mfma_f32_32x32x16_bf16 v[112:127], v[8:11], v[20:23], 0
    ds_read_b128 v[20:23], v1 offset:14336
    s_waitcnt lgkmcnt(2)
    v_mfma_f32_32x32x16_bf16 v[96:111], v[32:35], v[24:27], 0
    ds_read_b128 v[24:27], v1 offset:15360
    v_mul_f32 v64, v64, v80
    v_mul_f32 v65, v65, v81
    v_mul_f32 v66, v66, v82
    v_mul_f32 v67, v67, v83
    v_mul_f32 v68, v68, v84
    v_mul_f32 v69, v69, v85
    v_mul_f32 v70, v70, v86
    v_mul_f32 v71, v71, v87
    v_mul_f32 v72, v72, v88
    v_mul_f32 v73, v73, v89
    v_mul_f32 v74, v74, v90
    v_mul_f32 v75, v75, v91
    v_mul_f32 v76, v76, v92
    v_mul_f32 v77, v77, v93
    v_mul_f32 v78, v78, v94
    v_mul_f32 v79, v79, v95
    s_cmp_eq_u32 s70, 0
    s_nop 0
    s_cbranch_scc1 M_vw19
    s_waitcnt vmcnt(0)
    s_mov_b32 s70, 0
M_vw19:
    s_waitcnt vmcnt(4)
    ds_read_u16_d16_hi v80, v2 offset:0
    ds_read_u16_d16_hi v81, v2 offset:256
    ds_read_u16_d16_hi v82, v2 offset:512
    ds_read_u16_d16_hi v83, v2 offset:768
    ds_read_u16_d16_hi v84, v2 offset:3072
    ds_read_u16_d16_hi v85, v2 offset:3328
    ds_read_u16_d16_hi v86, v2 offset:3584
    ds_read_u16_d16_hi v87, v2 offset:3840
    ds_read_u16_d16_hi v88, v2 offset:6144
    ds_read_u16_d16_hi v89, v2 offset:6400
    ds_read_u16_d16_hi v90, v2 offset:6656
    ds_read_u16_d16_hi v91, v2 offset:6912
    ds_read_u16_d16_hi v92, v2 offset:9216
    ds_read_u16_d16_hi v93, v2 offset:9472
    ds_read_u16_d16_hi v94, v2 offset:9728
    ds_read_u16_d16_hi v95, v2 offset:9984
    s_waitcnt lgkmcnt(12)
    v_mul_f32 v80, v80, v64
    v_mul_f32 v81, v81, v65
    v_mul_f32 v82, v82, v66
    v_mul_f32 v83, v83, v67
    s_waitcnt lgkmcnt(8)
    v_mul_f32 v84, v84, v68
    v_mul_f32 v85, v85, v69
    v_mfma_f32_32x32x16_bf16 v[96:111], v[36:39], v[28:31], v[96:111]
    ds_read_b128 v[28:31], v1 offset:28672
    v_mul_f32 v86, v86, v70
    v_mul_f32 v87, v87, v71
    v_cvt_pk_bf16_f32 v80, v80, v81
    v_cvt_pk_bf16_f32 v81, v82, v83
    v_cvt_pk_bf16_f32 v82, v84, v85
    v_cvt_pk_bf16_f32 v83, v86, v87
    s_nop 1
    v_mfma_f32_32x32x16_bf16 v[160:175], v[12:15], v[80:83], v[160:175]
    ds_read_u16_d16_hi v80, v2 offset:1024
    ds_read_u16_d16_hi v81, v2 offset:1280
    ds_read_u16_d16_hi v82, v2 offset:1536
    ds_read_u16_d16_hi v83, v2 offset:1792
    ds_read_u16_d16_hi v84, v2 offset:4096
    ds_read_u16_d16_hi v85, v2 offset:4352
    ds_read_u16_d16_hi v86, v2 offset:4608
    ds_read_u16_d16_hi v87, v2 offset:4864
    s_waitcnt lgkmcnt(13)
    v_mul_f32 v88, v88, v72
    v_mul_f32 v89, v89, v73
    v_mul_f32 v90, v90, v74
    v_mul_f32 v91, v91, v75
    s_waitcnt lgkmcnt(9)
    v_mul_f32 v92, v92, v76
    v_mul_f32 v93, v93, v77
    v_mul_f32 v94, v94, v78
    v_mul_f32 v95, v95, v79
    v_cvt_pk_bf16_f32 v88, v88, v89
    v_cvt_pk_bf16_f32 v89, v90, v91
    v_cvt_pk_bf16_f32 v90, v92, v93
    v_cvt_pk_bf16_f32 v91, v94, v95
    s_nop 1
    v_mfma_f32_32x32x16_bf16 v[160:175], v[16:19], v[88:91], v[160:175]
    ds_read_u16_d16_hi v88, v2 offset:7168
    ds_read_u16_d16_hi v89, v2 offset:7424
    ds_read_u16_d16_hi v90, v2 offset:7680
    ds_read_u16_d16_hi v91, v2 offset:7936
    ds_read_u16_d16_hi v92, v2 offset:10240
    ds_read_u16_d16_hi v93, v2 offset:10496
    ds_read_u16_d16_hi v94, v2 offset:10752
    ds_read_u16_d16_hi v95, v2 offset:11008
    s_waitcnt lgkmcnt(12)
    v_mul_f32 v80, v80, v64
    v_mul_f32 v81, v81, v65
    v_mul_f32 v82, v82, v66
    v_mfma_f32_32x32x16_bf16 v[96:111], v[40:43], v[20:23], v[96:111]
    ds_read_b128 v[20:23], v1 offset:16384
    v_mul_f32 v83, v83, v67
    s_waitcnt lgkmcnt(9)
    v_mul_f32 v84, v84, v68
    v_mul_f32 v85, v85, v69
    v_mul_f32 v86, v86, v70
    v_mul_f32 v87, v87, v71
    v_cvt_pk_bf16_f32 v80, v80, v81
    v_cvt_pk_bf16_f32 v81, v82, v83
    v_cvt_pk_bf16_f32 v82, v84, v85
    v_cvt_pk_bf16_f32 v83, v86, v87
    s_nop 1
    v_mfma_f32_32x32x16_bf16 v[192:207], v[12:15], v[80:83], v[192:207]
    ds_read_u16_d16_hi v80, v2 offset:2048
    ds_read_u16_d16_hi v81, v2 offset:2304
    ds_read_u16_d16_hi v82, v2 offset:2560
    ds_read_u16_d16_hi v83, v2 offset:2816
    ds_read_u16_d16_hi v84, v2 offset:5120
    ds_read_u16_d16_hi v85, v2 offset:5376
    ds_read_u16_d16_hi v86, v2 offset:5632
    ds_read_u16_d16_hi v87, v2 offset:5888
    s_waitcnt lgkmcnt(13)
    v_mul_f32 v88, v88, v72
    v_mul_f32 v89, v89, v73
    v_mul_f32 v90, v90, v74
    v_mul_f32 v91, v91, v75
    s_waitcnt lgkmcnt(9)
    v_mul_f32 v92, v92, v76
    v_mul_f32 v93, v93, v77
    v_mul_f32 v94, v94, v78
    v_mul_f32 v95, v95, v79
    v_cvt_pk_bf16_f32 v88, v88, v89
    v_cvt_pk_bf16_f32 v89, v90, v91
    v_cvt_pk_bf16_f32 v90, v92, v93
    v_cvt_pk_bf16_f32 v91, v94, v95
    s_nop 1
    v_mfma_f32_32x32x16_bf16 v[192:207], v[16:19], v[88:91], v[192:207]
    ds_read_u16_d16_hi v88, v2 offset:8192
    ds_read_u16_d16_hi v89, v2 offset:8448
    ds_read_u16_d16_hi v90, v2 offset:8704
    ds_read_u16_d16_hi v91, v2 offset:8960
    ds_read_u16_d16_hi v92, v2 offset:11264
    ds_read_u16_d16_hi v93, v2 offset:11520
    ds_read_u16_d16_hi v94, v2 offset:11776
    ds_read_u16_d16_hi v95, v2 offset:12032
    v_mfma_f32_32x32x16_bf16 v[96:111], v[44:47], v[24:27], v[96:111]
    ds_read_b128 v[24:27], v1 offset:17408
    s_waitcnt lgkmcnt(13)
    v_mul_f32 v80, v80, v64
    v_mul_f32 v81, v81, v65
    v_mul_f32 v82, v82, v66
    v_mul_f32 v83, v83, v67
    s_waitcnt lgkmcnt(9)
    v_mul_f32 v84, v84, v68
    v_mul_f32 v85, v85, v69
    v_mul_f32 v86, v86, v70
    v_mul_f32 v87, v87, v71
    v_cvt_pk_bf16_f32 v80, v80, v81
    v_cvt_pk_bf16_f32 v81, v82, v83
    v_cvt_pk_bf16_f32 v82, v84, v85
    v_cvt_pk_bf16_f32 v83, v86, v87
    s_nop 1
    v_mfma_f32_32x32x16_bf16 v[224:239], v[12:15], v[80:83], v[224:239]
    s_waitcnt lgkmcnt(5)
    v_mul_f32 v88, v88, v72
    v_mul_f32 v89, v89, v73
    v_mul_f32 v90, v90, v74
    v_mul_f32 v91, v91, v75
    s_waitcnt lgkmcnt(1)
    v_mul_f32 v92, v92, v76
    v_mul_f32 v93, v93, v77
    v_mul_f32 v94, v94, v78
    v_mul_f32 v95, v95, v79
    v_cvt_pk_bf16_f32 v88, v88, v89
    v_cvt_pk_bf16_f32 v89, v90, v91
    v_cvt_pk_bf16_f32 v90, v92, v93
    v_cvt_pk_bf16_f32 v91, v94, v95
    s_nop 1
    v_mfma_f32_32x32x16_bf16 v[224:239], v[16:19], v[88:91], v[224:239]
    v_mfma_f32_32x32x16_bf16 v[80:95], v[8:11], v[28:31], 0
    ds_read_b128 v[28:31], v1 offset:18432
    v_mfma_f32_32x32x16_bf16 v[64:79], v[32:35], v[20:23], 0
    ds_read_b128 v[20:23], v1 offset:19456
    v_mul_f32 v96, v96, v112
    v_mul_f32 v97, v97, v113
    v_mul_f32 v98, v98, v114
    v_mul_f32 v99, v99, v115
    v_mul_f32 v100, v100, v116
    v_mul_f32 v101, v101, v117
    v_mul_f32 v102, v102, v118
    v_mul_f32 v103, v103, v119
    v_mul_f32 v104, v104, v120
    v_mul_f32 v105, v105, v121
    v_mul_f32 v106, v106, v122
    v_mul_f32 v107, v107, v123
    v_mul_f32 v108, v108, v124
    v_mul_f32 v109, v109, v125
    v_mul_f32 v110, v110, v126
    v_mul_f32 v111, v111, v127
    ds_read_u16_d16_hi v112, v2 offset:2
    ds_read_u16_d16_hi v113, v2 offset:258
    ds_read_u16_d16_hi v114, v2 offset:514
    ds_read_u16_d16_hi v115, v2 offset:770
    ds_read_u16_d16_hi v116, v2 offset:3074
    ds_read_u16_d16_hi v117, v2 offset:3330
    ds_read_u16_d16_hi v118, v2 offset:3586
    ds_read_u16_d16_hi v119, v2 offset:3842
    ds_read_u16_d16_hi v120, v2 offset:6146
    ds_read_u16_d16_hi v121, v2 offset:6402
    ds_read_u16_d16_hi v122, v2 offset:6658
    ds_read_u16_d16_hi v123, v2 offset:6914
    ds_read_u16_d16_hi v124, v2 offset:9218
    ds_read_u16_d16_hi v125, v2 offset:9474
    ds_read_u16_d16_hi v126, v2 offset:9730
    ds_read_u16_d16_hi v127, v2 offset:9986
    s_waitcnt lgkmcnt(12)
    v_mul_f32 v112, v112, v96
    v_mul_f32 v113, v113, v97
    v_mul_f32 v114, v114, v98
    v_mul_f32 v115, v115, v99
    s_waitcnt lgkmcnt(8)
    v_mul_f32 v116, v116, v100
    v_mul_f32 v117, v117, v101
    v_mul_f32 v118, v118, v102
    v_mfma_f32_32x32x16_bf16 v[64:79], v[36:39], v[24:27], v[64:79]
    ds_read_b128 v[24:27], v1 offset:29696
    v_mul_f32 v119, v119, v103
    v_cvt_pk_bf16_f32 v112, v112, v113
    v_cvt_pk_bf16_f32 v113, v114, v115
    v_cvt_pk_bf16_f32 v114, v116, v117
    v_cvt_pk_bf16_f32 v115, v118, v119
    s_nop 1
    v_mfma_f32_32x32x16_bf16 v[176:191], v[12:15], v[112:115], v[176:191]
    ds_read_u16_d16_hi v112, v2 offset:1026
    ds_read_u16_d16_hi v113, v2 offset:1282
    ds_read_u16_d16_hi v114, v2 offset:1538
    ds_read_u16_d16_hi v115, v2 offset:1794
    ds_read_u16_d16_hi v116, v2 offset:4098
    ds_read_u16_d16_hi v117, v2 offset:4354
    ds_read_u16_d16_hi v118, v2 offset:4610
    ds_read_u16_d16_hi v119, v2 offset:4866
    s_waitcnt lgkmcnt(13)
    v_mul_f32 v120, v120, v104
    v_mul_f32 v121, v121, v105
    v_mul_f32 v122, v122, v106
    v_mul_f32 v123, v123, v107
    s_waitcnt lgkmcnt(9)
    v_mul_f32 v124, v124, v108
    v_mul_f32 v125, v125, v109
    v_mul_f32 v126, v126, v110
    v_mul_f32 v127, v127, v111
    v_cvt_pk_bf16_f32 v120, v120, v121
    v_cvt_pk_bf16_f32 v121, v122, v123
    v_cvt_pk_bf16_f32 v122, v124, v125
    v_cvt_pk_bf16_f32 v123, v126, v127
    s_nop 1
    v_mfma_f32_32x32x16_bf16 v[176:191], v[16:19], v[120:123], v[176:191]
    ds_read_u16_d16_hi v120, v2 offset:7170
    ds_read_u16_d16_hi v121, v2 offset:7426
    ds_read_u16_d16_hi v122, v2 offset:7682
    ds_read_u16_d16_hi v123, v2 offset:7938
    ds_read_u16_d16_hi v124, v2 offset:10242
    ds_read_u16_d16_hi v125, v2 offset:10498
    ds_read_u16_d16_hi v126, v2 offset:10754
    ds_read_u16_d16_hi v127, v2 offset:11010
    s_waitcnt lgkmcnt(12)
    v_mul_f32 v112, v112, v96
    v_mul_f32 v113, v113, v97
    v_mul_f32 v114, v114, v98
    v_mul_f32 v115, v115, v99
    v_mfma_f32_32x32x16_bf16 v[64:79], v[40:43], v[28:31], v[64:79]
    ds_read_b128 v[28:31], v1 offset:20480
    s_waitcnt lgkmcnt(9)
    v_mul_f32 v116, v116, v100
    v_mul_f32 v117, v117, v101
    v_mul_f32 v118, v118, v102
    v_mul_f32 v119, v119, v103
    v_cvt_pk_bf16_f32 v112, v112, v113
    v_cvt_pk_bf16_f32 v113, v114, v115
    v_cvt_pk_bf16_f32 v114, v116, v117
    v_cvt_pk_bf16_f32 v115, v118, v119
    s_nop 1
    v_mfma_f32_32x32x16_bf16 v[208:223], v[12:15], v[112:115], v[208:223]
    ds_read_u16_d16_hi v112, v2 offset:2050
    ds_read_u16_d16_hi v113, v2 offset:2306
    ds_read_u16_d16_hi v114, v2 offset:2562
    ds_read_u16_d16_hi v115, v2 offset:2818
    ds_read_u16_d16_hi v116, v2 offset:5122
    ds_read_u16_d16_hi v117, v2 offset:5378
    ds_read_u16_d16_hi v118, v2 offset:5634
    ds_read_u16_d16_hi v119, v2 offset:5890
    s_waitcnt lgkmcnt(13)
    v_mul_f32 v120, v120, v104
    v_mul_f32 v121, v121, v105
    v_mul_f32 v122, v122, v106
    v_mul_f32 v123, v123, v107
    s_waitcnt lgkmcnt(9)
    v_mul_f32 v124, v124, v108
    v_mul_f32 v125, v125, v109
    v_mul_f32 v126, v126, v110
    v_mul_f32 v127, v127, v111
    v_cvt_pk_bf16_f32 v120, v120, v121
    v_cvt_pk_bf16_f32 v121, v122, v123
    v_cvt_pk_bf16_f32 v122, v124, v125
    v_cvt_pk_bf16_f32 v123, v126, v127
    s_nop 1
    v_mfma_f32_32x32x16_bf16 v[208:223], v[16:19], v[120:123], v[208:223]
    ds_read_u16_d16_hi v120, v2 offset:8194
    ds_read_u16_d16_hi v121, v2 offset:8450
    ds_read_u16_d16_hi v122, v2 offset:8706
    ds_read_u16_d16_hi v123, v2 offset:8962
    ds_read_u16_d16_hi v124, v2 offset:11266
    ds_read_u16_d16_hi v125, v2 offset:11522
    ds_read_u16_d16_hi v126, v2 offset:11778
    ds_read_u16_d16_hi v127, v2 offset:12034
    s_waitcnt lgkmcnt(12)
    v_mul_f32 v112, v112, v96
    v_mfma_f32_32x32x16_bf16 v[64:79], v[44:47], v[20:23], v[64:79]
    ds_read_b128 v[20:23], v1 offset:21504
    v_mul_f32 v113, v113, v97
    v_mul_f32 v114, v114, v98
    v_mul_f32 v115, v115, v99
    s_waitcnt lgkmcnt(9)
    v_mul_f32 v116, v116, v100
    v_mul_f32 v117, v117, v101
    v_mul_f32 v118, v118, v102
    v_mul_f32 v119, v119, v103
    v_cvt_pk_bf16_f32 v112, v112, v113
    v_cvt_pk_bf16_f32 v113, v114, v115
    v_cvt_pk_bf16_f32 v114, v116, v117
    v_cvt_pk_bf16_f32 v115, v118, v119
    s_nop 1
    v_mfma_f32_32x32x16_bf16 v[240:255], v[12:15], v[112:115], v[240:255]
    s_waitcnt lgkmcnt(5)
    v_mul_f32 v120, v120, v104
    v_mul_f32 v121, v121, v105
    v_mul_f32 v122, v122, v106
    v_mul_f32 v123, v123, v107
    s_waitcnt lgkmcnt(1)
    v_mul_f32 v124, v124, v108
    v_mul_f32 v125, v125, v109
    v_mul_f32 v126, v126, v110
    v_mul_f32 v127, v127, v111
    v_cvt_pk_bf16_f32 v120, v120, v121
    v_cvt_pk_bf16_f32 v121, v122, v123
    v_cvt_pk_bf16_f32 v122, v124, v125
    v_cvt_pk_bf16_f32 v123, v126, v127
    s_nop 1
    v_mfma_f32_32x32x16_bf16 v[240:255], v[16:19], v[120:123], v[240:255]
    s_cmp_lg_u32 s77, 0
    s_nop 10
    s_cbranch_scc1 M_nv20
    ds_read_b32 v112, v5 offset:524
    ds_read_b32 v113, v5 offset:652
    ds_read_b32 v114, v5 offset:780
    ds_read_b32 v115, v5 offset:908
    s_waitcnt lgkmcnt(3)
    v_and_or_b32 v112, v1, s63, v112
    s_waitcnt lgkmcnt(2)
    v_and_or_b32 v113, v1, s63, v113
    s_waitcnt lgkmcnt(1)
    v_and_or_b32 v114, v1, s63, v114
    s_waitcnt lgkmcnt(0)
    v_and_or_b32 v115, v1, s63, v115
    s_add_u32 m0, s51, 0
    s_nop 0
    buffer_load_dwordx4 v112, s[28:31], s64 offen lds
    s_add_u32 m0, s51, 1024
    s_nop 0
    buffer_load_dwordx4 v112, s[28:31], s65 offen lds
    s_add_u32 m0, s51, 2048
    s_nop 0
    buffer_load_dwordx4 v112, s[28:31], s66 offen lds
    s_add_u32 m0, s51, 3072
    s_nop 0
    buffer_load_dwordx4 v113, s[28:31], s64 offen lds
    s_add_u32 m0, s51, 4096
    s_nop 0
    buffer_load_dwordx4 v113, s[28:31], s65 offen lds
    s_add_u32 m0, s51, 5120
    s_nop 0
    buffer_load_dwordx4 v113, s[28:31], s66 offen lds
    s_add_u32 m0, s51, 6144
    s_nop 0
    buffer_load_dwordx4 v114, s[28:31], s64 offen lds
    s_add_u32 m0, s51, 7168
    s_nop 0
    buffer_load_dwordx4 v114, s[28:31], s65 offen lds
    s_add_u32 m0, s51, 8192
    s_nop 0
    buffer_load_dwordx4 v114, s[28:31], s66 offen lds
    s_add_u32 m0, s51, 9216
    s_nop 0
    buffer_load_dwordx4 v115, s[28:31], s64 offen lds
    s_add_u32 m0, s51, 10240
    s_nop 0
    buffer_load_dwordx4 v115, s[28:31], s65 offen lds
    s_add_u32 m0, s51, 11264
    s_nop 0
    buffer_load_dwordx4 v115, s[28:31], s66 offen lds
    s_branch M_nj20
M_nv20:
    s_cmp_eq_u32 s76, 0
    s_cbranch_scc1 M_nj20
    v_lshrrev_b32 v112, 7, v1
    v_and_b32 v113, 1, v112
    v_lshrrev_b32 v112, 1, v112
    v_lshl_add_u32 v112, v113, 2, v112
    v_lshlrev_b32 v112, 9, v112
    v_and_or_b32 v112, v1, s63, v112
    s_add_u32 m0, s51, 1024
    s_add_u32 s53, s40, 256
    buffer_load_dwordx4 v112, s[4:7], s53 offen  lds
    s_add_u32 m0, s51, 2048
    s_add_u32 s53, s40, 384
    buffer_load_dwordx4 v112, s[4:7], s53 offen  lds
    s_add_u32 m0, s51, 4096
    s_add_u32 s53, s41, 256
    buffer_load_dwordx4 v112, s[4:7], s53 offen  lds
    s_add_u32 m0, s51, 5120
    s_add_u32 s53, s41, 384
    buffer_load_dwordx4 v112, s[4:7], s53 offen  lds
    s_add_u32 m0, s51, 7168
    s_add_u32 s53, s42, 256
    buffer_load_dwordx4 v112, s[4:7], s53 offen  lds
    s_add_u32 m0, s51, 8192
    s_add_u32 s53, s42, 384
    buffer_load_dwordx4 v112, s[4:7], s53 offen  lds
    s_add_u32 m0, s51, 10240
    s_add_u32 s53, s43, 256
    buffer_load_dwordx4 v112, s[4:7], s53 offen  lds
    s_add_u32 m0, s51, 11264
    s_add_u32 s53, s43, 384
    buffer_load_dwordx4 v112, s[4:7], s53 offen  lds
M_nj20:
    v_mfma_f32_32x32x16_bf16 v[112:127], v[8:11], v[24:27], 0
    ds_read_b128 v[24:27], v1 offset:22528
    v_mfma_f32_32x32x16_bf16 v[96:111], v[32:35], v[28:31], 0
    ds_read_b128 v[28:31], v1 offset:23552
    v_mul_f32 v64, v64, v80
    v_mul_f32 v65, v65, v81
    v_mul_f32 v66, v66, v82
    v_mul_f32 v67, v67, v83
    v_mul_f32 v68, v68, v84
    v_mul_f32 v69, v69, v85
    v_mul_f32 v70, v70, v86
    v_mul_f32 v71, v71, v87
    v_mul_f32 v72, v72, v88
    v_mul_f32 v73, v73, v89
    v_mul_f32 v74, v74, v90
    v_mul_f32 v75, v75, v91
    s_waitcnt lgkmcnt(2)
    v_mfma_f32_32x32x16_bf16 v[96:111], v[36:39], v[20:23], v[96:111]
    v_mul_f32 v76, v76, v92
    v_mul_f32 v77, v77, v93
    v_mul_f32 v78, v78, v94
    v_mul_f32 v79, v79, v95
    ds_read_b64 v[80:81], v0 offset:2080
    ds_read_b64 v[88:89], v0 offset:2088
    ds_read_b64 v[82:83], v0 offset:2192
    ds_read_b64 v[90:91], v0 offset:2200
    ds_read_b64 v[84:85], v0 offset:2304
    ds_read_b64 v[92:93], v0 offset:2312
    ds_read_b64 v[86:87], v0 offset:2416
    ds_read_b64 v[94:95], v0 offset:2424
    v_cvt_pk_bf16_f32 v64, v64, v65
    v_cvt_pk_bf16_f32 v65, v66, v67
    v_cvt_pk_bf16_f32 v66, v68, v69
    v_cvt_pk_bf16_f32 v67, v70, v71
    v_cvt_pk_bf16_f32 v68, v72, v73
    v_cvt_pk_bf16_f32 v69, v74, v75
    v_cvt_pk_bf16_f32 v70, v76, v77
    s_waitcnt lgkmcnt(9)
    v_mfma_f32_32x32x16_bf16 v[96:111], v[40:43], v[24:27], v[96:111]
    v_cvt_pk_bf16_f32 v71, v78, v79
    v_pk_lshrrev_b16 v72, 14, v12 op_sel_hi:[0,1]
    v_pk_lshrrev_b16 v73, 14, v13 op_sel_hi:[0,1]
    v_pk_lshrrev_b16 v74, 14, v14 op_sel_hi:[0,1]
    v_pk_lshrrev_b16 v75, 14, v15 op_sel_hi:[0,1]
    v_pk_lshrrev_b16 v76, 14, v16 op_sel_hi:[0,1]
    v_pk_lshrrev_b16 v77, 14, v17 op_sel_hi:[0,1]
    v_pk_lshrrev_b16 v78, 14, v18 op_sel_hi:[0,1]
    v_pk_lshrrev_b16 v79, 14, v19 op_sel_hi:[0,1]
    s_waitcnt lgkmcnt(0)
    v_pk_mul_lo_u16 v80, v72, v80
    v_pk_mul_lo_u16 v81, v73, v81
    v_pk_mul_lo_u16 v82, v74, v82
    v_mfma_f32_32x32x16_bf16 v[96:111], v[44:47], v[28:31], v[96:111]
    v_pk_mul_lo_u16 v83, v75, v83
    v_pk_mul_lo_u16 v84, v76, v84
    v_pk_mul_lo_u16 v85, v77, v85
    v_pk_mul_lo_u16 v86, v78, v86
    v_pk_mul_lo_u16 v87, v79, v87
    v_pk_mul_lo_u16 v88, v72, v88
    v_pk_mul_lo_u16 v89, v73, v89
    v_pk_mul_lo_u16 v90, v74, v90
    v_pk_mul_lo_u16 v91, v75, v91
    v_pk_mul_lo_u16 v92, v76, v92
    v_pk_mul_lo_u16 v93, v77, v93
    v_pk_mul_lo_u16 v94, v78, v94
    v_pk_mul_lo_u16 v95, v79, v95
    v_mfma_f32_32x32x16_bf16 v[160:175], v[80:83], v[64:67], v[160:175]
    v_mul_f32 v96, v96, v112
    v_mul_f32 v97, v97, v113
    v_mul_f32 v98, v98, v114
    v_mul_f32 v99, v99, v115
    v_mul_f32 v100, v100, v116
    v_mul_f32 v101, v101, v117
    v_mfma_f32_32x32x16_bf16 v[160:175], v[84:87], v[68:71], v[160:175]
    v_mul_f32 v102, v102, v118
    v_mul_f32 v103, v103, v119
    v_mul_f32 v104, v104, v120
    v_mul_f32 v105, v105, v121
    v_mul_f32 v106, v106, v122
    v_mul_f32 v107, v107, v123
    v_mfma_f32_32x32x16_bf16 v[192:207], v[88:91], v[64:67], v[192:207]
    v_mul_f32 v108, v108, v124
    v_mul_f32 v109, v109, v125
    v_mul_f32 v110, v110, v126
    v_mul_f32 v111, v111, v127
    ds_read_b64 v[112:113], v0 offset:2096
    ds_read_b64 v[114:115], v0 offset:2208
    ds_read_b64 v[116:117], v0 offset:2320
    ds_read_b64 v[118:119], v0 offset:2432
    v_cvt_pk_bf16_f32 v96, v96, v97
    v_mfma_f32_32x32x16_bf16 v[192:207], v[92:95], v[68:71], v[192:207]
    v_cvt_pk_bf16_f32 v97, v98, v99
    v_cvt_pk_bf16_f32 v98, v100, v101
    v_cvt_pk_bf16_f32 v99, v102, v103
    v_cvt_pk_bf16_f32 v100, v104, v105
    v_cvt_pk_bf16_f32 v101, v106, v107
    v_cvt_pk_bf16_f32 v102, v108, v109
    v_cvt_pk_bf16_f32 v103, v110, v111
    s_waitcnt lgkmcnt(0)
    v_pk_mul_lo_u16 v112, v72, v112
    v_pk_mul_lo_u16 v113, v73, v113
    v_pk_mul_lo_u16 v114, v74, v114
    v_pk_mul_lo_u16 v115, v75, v115
    v_pk_mul_lo_u16 v116, v76, v116
    v_pk_mul_lo_u16 v117, v77, v117
    v_pk_mul_lo_u16 v118, v78, v118
    v_pk_mul_lo_u16 v119, v79, v119
    v_mfma_f32_32x32x16_bf16 v[176:191], v[80:83], v[96:99], v[176:191]
    ds_read_b128 v[104:107], v3 offset:512
    ds_read_b128 v[72:75], v7
    ds_read_b128 v[76:79], v7 offset:16
    ds_read_b64 v[12:13], v4 offset:2496
    ds_read_b64 v[14:15], v4 offset:2608
    ds_read_b64 v[16:17], v4 offset:2720
    ds_read_b64 v[18:19], v4 offset:2832
    ds_read_b128 v[20:23], v1 offset:24576
    ds_read_b128 v[24:27], v1 offset:0
    ds_read_b128 v[28:31], v1 offset:1024
    s_waitcnt lgkmcnt(7)
    v_mul_f32 v72, v104, v72
    v_mul_f32 v73, v104, v73
    v_mul_f32 v74, v104, v74
    v_mul_f32 v75, v104, v75
    v_mul_f32 v76, v104, v76
    v_mfma_f32_32x32x16_bf16 v[176:191], v[84:87], v[100:103], v[176:191]
    v_mul_f32 v77, v104, v77
    v_mul_f32 v78, v104, v78
    v_mul_f32 v79, v104, v79
    v_cvt_pk_bf16_f32 v72, 0, v72
    v_cvt_pk_bf16_f32 v73, 0, v73
    v_cvt_pk_bf16_f32 v74, 0, v74
    v_cvt_pk_bf16_f32 v75, 0, v75
    v_mfma_f32_32x32x16_bf16 v[208:223], v[88:91], v[96:99], v[208:223]
    v_cvt_pk_bf16_f32 v76, 0, v76
    v_cvt_pk_bf16_f32 v77, 0, v77
    v_cvt_pk_bf16_f32 v78, 0, v78
    v_cvt_pk_bf16_f32 v79, 0, v79
    v_mul_f32 v72, s61, v72
    v_mul_f32 v73, s61, v73
    v_mfma_f32_32x32x16_bf16 v[208:223], v[92:95], v[100:103], v[208:223]
    v_mul_f32 v74, s61, v74
    v_mul_f32 v75, s61, v75
    v_mul_f32 v76, s61, v76
    v_mul_f32 v77, s61, v77
    v_mul_f32 v78, s61, v78
    v_mul_f32 v79, s61, v79
    v_sin_f32 v72, v72
    v_mfma_f32_32x32x16_bf16 v[224:239], v[112:115], v[64:67], v[224:239]
    v_sin_f32 v73, v73
    v_sin_f32 v74, v74
    v_sin_f32 v75, v75
    v_sin_f32 v76, v76
    v_sin_f32 v77, v77
    v_sin_f32 v78, v78
    v_sin_f32 v79, v79
    v_mfma_f32_32x32x16_bf16 v[240:255], v[112:115], v[96:99], v[240:255]
    v_mul_f32 v72, v72, v105
    v_mul_f32 v73, v73, v105
    v_mul_f32 v74, v74, v105
    v_mul_f32 v75, v75, v105
    v_mul_f32 v76, v76, v105
    v_mul_f32 v77, v77, v105
    v_mfma_f32_32x32x16_bf16 v[224:239], v[116:119], v[68:71], v[224:239]
    v_mul_f32 v78, v78, v105
    v_mul_f32 v79, v79, v105
    v_cvt_pk_bf16_f32 v8, v72, v73
    v_cvt_pk_bf16_f32 v9, v74, v75
    v_cvt_pk_bf16_f32 v10, v76, v77
    v_cvt_pk_bf16_f32 v11, v78, v79
    s_waitcnt lgkmcnt(3)
    v_pk_lshlrev_b16 v12, v6, v12
    v_mfma_f32_32x32x16_bf16 v[240:255], v[116:119], v[100:103], v[240:255]
    v_pk_lshlrev_b16 v13, v6, v13
    v_pk_lshlrev_b16 v14, v6, v14
    v_pk_lshlrev_b16 v15, v6, v15
    v_pk_lshlrev_b16 v16, v6, v16
    v_pk_lshlrev_b16 v17, v6, v17
    v_pk_lshlrev_b16 v18, v6, v18
    v_pk_lshlrev_b16 v19, v6, v19
    v_add_u32 v3, 512, v3
    v_add_u32 v4, 448, v4
    v_add_u32 v0, 448, v0
    v_add_u32 v5, 512, v5
    s_waitcnt lgkmcnt(0)
    s_add_u32 s49, s49, 1
    s_cmp_lt_u32 s49, s48
    s_cbranch_scc0 M_wend
    s_waitcnt vmcnt(12)
    v_mfma_f32_32x32x16_bf16 v[80:95], v[8:11], v[20:23], 0
    ds_read_b128 v[20:23], v1 offset:2048
    s_add_u32 s77, s49, 1
    s_cmp_lt_u32 s77, s48
    s_cselect_b32 s77, 0, 0x40000000
    ds_read_b32 v47, v3 offset:524
    v_bfe_u32 v46, v1, 9, 1
    s_waitcnt lgkmcnt(0)
    v_lshrrev_b32 v47, 2, v47
    v_lshl_add_u32 v47, v46, 6, v47
    buffer_load_dwordx4 v[32:35], v47, s[72:75], s77 offen offset:0
    buffer_load_dwordx4 v[36:39], v47, s[72:75], s77 offen offset:16
    buffer_load_dwordx4 v[40:43], v47, s[72:75], s77 offen offset:32
    buffer_load_dwordx4 v[44:47], v47, s[72:75], s77 offen offset:48
    v_mfma_f32_32x32x16_bf16 v[64:79], v[48:51], v[24:27], 0
    ds_read_b128 v[24:27], v1 offset:3072
    v_mfma_f32_32x32x16_bf16 v[64:79], v[52:55], v[28:31], v[64:79]
    ds_read_b128 v[28:31], v1 offset:25600
    v_mfma_f32_32x32x16_bf16 v[64:79], v[56:59], v[20:23], v[64:79]
    ds_read_b128 v[20:23], v1 offset:4096
    s_waitcnt lgkmcnt(2)
    v_mfma_f32_32x32x16_bf16 v[64:79], v[60:63], v[24:27], v[64:79]
    ds_read_b128 v[24:27], v1 offset:5120
    s_waitcnt lgkmcnt(2)
    v_mfma_f32_32x32x16_bf16 v[112:127], v[8:11], v[28:31], 0
    ds_read_b128 v[28:31], v1 offset:6144
    s_waitcnt lgkmcnt(2)
    v_mfma_f32_32x32x16_bf16 v[96:111], v[48:51], v[20:23], 0
    ds_read_b128 v[20:23], v1 offset:7168
    s_nop 4
    v_mul_f32 v64, v64, v80
    v_mul_f32 v65, v65, v81
    v_mul_f32 v66, v66, v82
    v_mul_f32 v67, v67, v83
    v_mul_f32 v68, v68, v84
    v_mul_f32 v69, v69, v85
    s_waitcnt lgkmcnt(2)
    v_mfma_f32_32x32x16_bf16 v[96:111], v[52:55], v[24:27], v[96:111]
    ds_read_b128 v[24:27], v1 offset:26624
    v_mul_f32 v70, v70, v86
    v_mul_f32 v71, v71, v87
    v_mul_f32 v72, v72, v88
    v_mul_f32 v73, v73, v89
    v_mul_f32 v74, v74, v90
    v_mul_f32 v75, v75, v91
    v_mul_f32 v76, v76, v92
    s_waitcnt lgkmcnt(2)
    v_mfma_f32_32x32x16_bf16 v[96:111], v[56:59], v[28:31], v[96:111]
    ds_read_b128 v[28:31], v1 offset:8192
    v_mul_f32 v77, v77, v93
    v_mul_f32 v78, v78, v94
    v_mul_f32 v79, v79, v95
    v_cvt_pk_bf16_f32 v64, v64, v65
    v_cvt_pk_bf16_f32 v65, v66, v67
    v_cvt_pk_bf16_f32 v66, v68, v69
    s_waitcnt lgkmcnt(2)
    v_mfma_f32_32x32x16_bf16 v[96:111], v[60:63], v[20:23], v[96:111]
    ds_read_b128 v[20:23], v1 offset:9216
    v_cvt_pk_bf16_f32 v67, v70, v71
    v_cvt_pk_bf16_f32 v68, v72, v73
    v_cvt_pk_bf16_f32 v69, v74, v75
    v_cvt_pk_bf16_f32 v70, v76, v77
    v_cvt_pk_bf16_f32 v71, v78, v79
    v_mfma_f32_32x32x16_bf16 v[128:143], v[12:15], v[64:67], v[128:143]
    s_nop 0
    v_mfma_f32_32x32x16_bf16 v[128:143], v[16:19], v[68:71], v[128:143]
    s_waitcnt lgkmcnt(2)
    v_mfma_f32_32x32x16_bf16 v[80:95], v[8:11], v[24:27], 0
    ds_read_b128 v[24:27], v1 offset:10240
    s_waitcnt lgkmcnt(2)
    v_mfma_f32_32x32x16_bf16 v[64:79], v[48:51], v[28:31], 0
    ds_read_b128 v[28:31], v1 offset:11264
    v_mul_f32 v96, v96, v112
    v_mul_f32 v97, v97, v113
    v_mul_f32 v98, v98, v114
    v_mul_f32 v99, v99, v115
    v_mul_f32 v100, v100, v116
    v_mul_f32 v101, v101, v117
    s_waitcnt lgkmcnt(2)
    v_mfma_f32_32x32x16_bf16 v[64:79], v[52:55], v[20:23], v[64:79]
    ds_read_b128 v[20:23], v1 offset:27648
    v_mul_f32 v102, v102, v118
    v_mul_f32 v103, v103, v119
    v_mul_f32 v104, v104, v120
    v_mul_f32 v105, v105, v121
    v_mul_f32 v106, v106, v122
    v_mul_f32 v107, v107, v123
    v_mul_f32 v108, v108, v124
    s_waitcnt lgkmcnt(2)
    v_mfma_f32_32x32x16_bf16 v[64:79], v[56:59], v[24:27], v[64:79]
    ds_read_b128 v[24:27], v1 offset:12288
    v_mul_f32 v109, v109, v125
    v_mul_f32 v110, v110, v126
    v_mul_f32 v111, v111, v127
    v_cvt_pk_bf16_f32 v96, v96, v97
    v_cvt_pk_bf16_f32 v97, v98, v99
    v_cvt_pk_bf16_f32 v98, v100, v101
    s_waitcnt lgkmcnt(2)
    v_mfma_f32_32x32x16_bf16 v[64:79], v[60:63], v[28:31], v[64:79]
    ds_read_b128 v[28:31], v1 offset:13312
    v_cvt_pk_bf16_f32 v99, v102, v103
    v_cvt_pk_bf16_f32 v100, v104, v105
    v_cvt_pk_bf16_f32 v101, v106, v107
    v_cvt_pk_bf16_f32 v102, v108, v109
    v_cvt_pk_bf16_f32 v103, v110, v111
    v_mfma_f32_32x32x16_bf16 v[144:159], v[12:15], v[96:99], v[144:159]
    s_nop 0
    v_mfma_f32_32x32x16_bf16 v[144:159], v[16:19], v[100:103], v[144:159]
    s_waitcnt lgkmcnt(2)
    v_mfma_f32_32x32x16_bf16 v[112:127], v[8:11], v[20:23], 0
    ds_read_b128 v[20:23], v1 offset:14336
    s_waitcnt lgkmcnt(2)
    v_mfma_f32_32x32x16_bf16 v[96:111], v[48:51], v[24:27], 0
    ds_read_b128 v[24:27], v1 offset:15360
    v_mul_f32 v64, v64, v80
    v_mul_f32 v65, v65, v81
    v_mul_f32 v66, v66, v82
    v_mul_f32 v67, v67, v83
    v_mul_f32 v68, v68, v84
    v_mul_f32 v69, v69, v85
    v_mul_f32 v70, v70, v86
    v_mul_f32 v71, v71, v87
    v_mul_f32 v72, v72, v88
    v_mul_f32 v73, v73, v89
    v_mul_f32 v74, v74, v90
    v_mul_f32 v75, v75, v91
    v_mul_f32 v76, v76, v92
    v_mul_f32 v77, v77, v93
    v_mul_f32 v78, v78, v94
    v_mul_f32 v79, v79, v95
    s_waitcnt vmcnt(4)
    ds_read_u16_d16_hi v80, v2 offset:0
    ds_read_u16_d16_hi v81, v2 offset:256
    ds_read_u16_d16_hi v82, v2 offset:512
    ds_read_u16_d16_hi v83, v2 offset:768
    ds_read_u16_d16_hi v84, v2 offset:3072
    ds_read_u16_d16_hi v85, v2 offset:3328
    ds_read_u16_d16_hi v86, v2 offset:3584
    ds_read_u16_d16_hi v87, v2 offset:3840
    ds_read_u16_d16_hi v88, v2 offset:6144
    ds_read_u16_d16_hi v89, v2 offset:6400
    ds_read_u16_d16_hi v90, v2 offset:6656
    ds_read_u16_d16_hi v91, v2 offset:6912
    ds_read_u16_d16_hi v92, v2 offset:9216
    ds_read_u16_d16_hi v93, v2 offset:9472
    ds_read_u16_d16_hi v94, v2 offset:9728
    ds_read_u16_d16_hi v95, v2 offset:9984
    s_waitcnt lgkmcnt(12)
    v_mul_f32 v80, v80, v64
    v_mul_f32 v81, v81, v65
    v_mul_f32 v82, v82, v66
    v_mul_f32 v83, v83, v67
    s_waitcnt lgkmcnt(8)
    v_mul_f32 v84, v84, v68
    v_mul_f32 v85, v85, v69
    v_mfma_f32_32x32x16_bf16 v[96:111], v[52:55], v[28:31], v[96:111]
    ds_read_b128 v[28:31], v1 offset:28672
    v_mul_f32 v86, v86, v70
    v_mul_f32 v87, v87, v71
    v_cvt_pk_bf16_f32 v80, v80, v81
    v_cvt_pk_bf16_f32 v81, v82, v83
    v_cvt_pk_bf16_f32 v82, v84, v85
    v_cvt_pk_bf16_f32 v83, v86, v87
    s_nop 1
    v_mfma_f32_32x32x16_bf16 v[160:175], v[12:15], v[80:83], v[160:175]
    ds_read_u16_d16_hi v80, v2 offset:1024
    ds_read_u16_d16_hi v81, v2 offset:1280
    ds_read_u16_d16_hi v82, v2 offset:1536
    ds_read_u16_d16_hi v83, v2 offset:1792
    ds_read_u16_d16_hi v84, v2 offset:4096
    ds_read_u16_d16_hi v85, v2 offset:4352
    ds_read_u16_d16_hi v86, v2 offset:4608
    ds_read_u16_d16_hi v87, v2 offset:4864
    s_waitcnt lgkmcnt(13)
    v_mul_f32 v88, v88, v72
    v_mul_f32 v89, v89, v73
    v_mul_f32 v90, v90, v74
    v_mul_f32 v91, v91, v75
    s_waitcnt lgkmcnt(9)
    v_mul_f32 v92, v92, v76
    v_mul_f32 v93, v93, v77
    v_mul_f32 v94, v94, v78
    v_mul_f32 v95, v95, v79
    v_cvt_pk_bf16_f32 v88, v88, v89
    v_cvt_pk_bf16_f32 v89, v90, v91
    v_cvt_pk_bf16_f32 v90, v92, v93
    v_cvt_pk_bf16_f32 v91, v94, v95
    s_nop 1
    v_mfma_f32_32x32x16_bf16 v[160:175], v[16:19], v[88:91], v[160:175]
    ds_read_u16_d16_hi v88, v2 offset:7168
    ds_read_u16_d16_hi v89, v2 offset:7424
    ds_read_u16_d16_hi v90, v2 offset:7680
    ds_read_u16_d16_hi v91, v2 offset:7936
    ds_read_u16_d16_hi v92, v2 offset:10240
    ds_read_u16_d16_hi v93, v2 offset:10496
    ds_read_u16_d16_hi v94, v2 offset:10752
    ds_read_u16_d16_hi v95, v2 offset:11008
    s_waitcnt lgkmcnt(12)
    v_mul_f32 v80, v80, v64
    v_mul_f32 v81, v81, v65
    v_mul_f32 v82, v82, v66
    v_mfma_f32_32x32x16_bf16 v[96:111], v[56:59], v[20:23], v[96:111]
    ds_read_b128 v[20:23], v1 offset:16384
    v_mul_f32 v83, v83, v67
    s_waitcnt lgkmcnt(9)
    v_mul_f32 v84, v84, v68
    v_mul_f32 v85, v85, v69
    v_mul_f32 v86, v86, v70
    v_mul_f32 v87, v87, v71
    v_cvt_pk_bf16_f32 v80, v80, v81
    v_cvt_pk_bf16_f32 v81, v82, v83
    v_cvt_pk_bf16_f32 v82, v84, v85
    v_cvt_pk_bf16_f32 v83, v86, v87
    s_nop 1
    v_mfma_f32_32x32x16_bf16 v[192:207], v[12:15], v[80:83], v[192:207]
    ds_read_u16_d16_hi v80, v2 offset:2048
    ds_read_u16_d16_hi v81, v2 offset:2304
    ds_read_u16_d16_hi v82, v2 offset:2560
    ds_read_u16_d16_hi v83, v2 offset:2816
    ds_read_u16_d16_hi v84, v2 offset:5120
    ds_read_u16_d16_hi v85, v2 offset:5376
    ds_read_u16_d16_hi v86, v2 offset:5632
    ds_read_u16_d16_hi v87, v2 offset:5888
    s_waitcnt lgkmcnt(13)
    v_mul_f32 v88, v88, v72
    v_mul_f32 v89, v89, v73
    v_mul_f32 v90, v90, v74
    v_mul_f32 v91, v91, v75
    s_waitcnt lgkmcnt(9)
    v_mul_f32 v92, v92, v76
    v_mul_f32 v93, v93, v77
    v_mul_f32 v94, v94, v78
    v_mul_f32 v95, v95, v79
    v_cvt_pk_bf16_f32 v88, v88, v89
    v_cvt_pk_bf16_f32 v89, v90, v91
    v_cvt_pk_bf16_f32 v90, v92, v93
    v_cvt_pk_bf16_f32 v91, v94, v95
    s_nop 1
    v_mfma_f32_32x32x16_bf16 v[192:207], v[16:19], v[88:91], v[192:207]
    ds_read_u16_d16_hi v88, v2 offset:8192
    ds_read_u16_d16_hi v89, v2 offset:8448
    ds_read_u16_d16_hi v90, v2 offset:8704
    ds_read_u16_d16_hi v91, v2 offset:8960
    ds_read_u16_d16_hi v92, v2 offset:11264
    ds_read_u16_d16_hi v93, v2 offset:11520
    ds_read_u16_d16_hi v94, v2 offset:11776
    ds_read_u16_d16_hi v95, v2 offset:12032
    v_mfma_f32_32x32x16_bf16 v[96:111], v[60:63], v[24:27], v[96:111]
    ds_read_b128 v[24:27], v1 offset:17408
    s_waitcnt lgkmcnt(13)
    v_mul_f32 v80, v80, v64
    v_mul_f32 v81, v81, v65
    v_mul_f32 v82, v82, v66
    v_mul_f32 v83, v83, v67
    s_waitcnt lgkmcnt(9)
    v_mul_f32 v84, v84, v68
    v_mul_f32 v85, v85, v69
    v_mul_f32 v86, v86, v70
    v_mul_f32 v87, v87, v71
    v_cvt_pk_bf16_f32 v80, v80, v81
    v_cvt_pk_bf16_f32 v81, v82, v83
    v_cvt_pk_bf16_f32 v82, v84, v85
    v_cvt_pk_bf16_f32 v83, v86, v87
    s_nop 1
    v_mfma_f32_32x32x16_bf16 v[224:239], v[12:15], v[80:83], v[224:239]
    s_waitcnt lgkmcnt(5)
    v_mul_f32 v88, v88, v72
    v_mul_f32 v89, v89, v73
    v_mul_f32 v90, v90, v74
    v_mul_f32 v91, v91, v75
    s_waitcnt lgkmcnt(1)
    v_mul_f32 v92, v92, v76
    v_mul_f32 v93, v93, v77
    v_mul_f32 v94, v94, v78
    v_mul_f32 v95, v95, v79
    v_cvt_pk_bf16_f32 v88, v88, v89
    v_cvt_pk_bf16_f32 v89, v90, v91
    v_cvt_pk_bf16_f32 v90, v92, v93
    v_cvt_pk_bf16_f32 v91, v94, v95
    s_nop 1
    v_mfma_f32_32x32x16_bf16 v[224:239], v[16:19], v[88:91], v[224:239]
    v_mfma_f32_32x32x16_bf16 v[80:95], v[8:11], v[28:31], 0
    ds_read_b128 v[28:31], v1 offset:18432
    v_mfma_f32_32x32x16_bf16 v[64:79], v[48:51], v[20:23], 0
    ds_read_b128 v[20:23], v1 offset:19456
    v_mul_f32 v96, v96, v112
    v_mul_f32 v97, v97, v113
    v_mul_f32 v98, v98, v114
    v_mul_f32 v99, v99, v115
    v_mul_f32 v100, v100, v116
    v_mul_f32 v101, v101, v117
    v_mul_f32 v102, v102, v118
    v_mul_f32 v103, v103, v119
    v_mul_f32 v104, v104, v120
    v_mul_f32 v105, v105, v121
    v_mul_f32 v106, v106, v122
    v_mul_f32 v107, v107, v123
    v_mul_f32 v108, v108, v124
    v_mul_f32 v109, v109, v125
    v_mul_f32 v110, v110, v126
    v_mul_f32 v111, v111, v127
    ds_read_u16_d16_hi v112, v2 offset:2
    ds_read_u16_d16_hi v113, v2 offset:258
    ds_read_u16_d16_hi v114, v2 offset:514
    ds_read_u16_d16_hi v115, v2 offset:770
    ds_read_u16_d16_hi v116, v2 offset:3074
    ds_read_u16_d16_hi v117, v2 offset:3330
    ds_read_u16_d16_hi v118, v2 offset:3586
    ds_read_u16_d16_hi v119, v2 offset:3842
    ds_read_u16_d16_hi v120, v2 offset:6146
    ds_read_u16_d16_hi v121, v2 offset:6402
    ds_read_u16_d16_hi v122, v2 offset:6658
    ds_read_u16_d16_hi v123, v2 offset:6914
    ds_read_u16_d16_hi v124, v2 offset:9218
    ds_read_u16_d16_hi v125, v2 offset:9474
    ds_read_u16_d16_hi v126, v2 offset:9730
    ds_read_u16_d16_hi v127, v2 offset:9986
    s_waitcnt lgkmcnt(12)
    v_mul_f32 v112, v112, v96
    v_mul_f32 v113, v113, v97
    v_mul_f32 v114, v114, v98
    v_mul_f32 v115, v115, v99
    s_waitcnt lgkmcnt(8)
    v_mul_f32 v116, v116, v100
    v_mul_f32 v117, v117, v101
    v_mul_f32 v118, v118, v102
    v_mfma_f32_32x32x16_bf16 v[64:79], v[52:55], v[24:27], v[64:79]
    ds_read_b128 v[24:27], v1 offset:29696
    v_mul_f32 v119, v119, v103
    v_cvt_pk_bf16_f32 v112, v112, v113
    v_cvt_pk_bf16_f32 v113, v114, v115
    v_cvt_pk_bf16_f32 v114, v116, v117
    v_cvt_pk_bf16_f32 v115, v118, v119
    s_nop 1
    v_mfma_f32_32x32x16_bf16 v[176:191], v[12:15], v[112:115], v[176:191]
    ds_read_u16_d16_hi v112, v2 offset:1026
    ds_read_u16_d16_hi v113, v2 offset:1282
    ds_read_u16_d16_hi v114, v2 offset:1538
    ds_read_u16_d16_hi v115, v2 offset:1794
    ds_read_u16_d16_hi v116, v2 offset:4098
    ds_read_u16_d16_hi v117, v2 offset:4354
    ds_read_u16_d16_hi v118, v2 offset:4610
    ds_read_u16_d16_hi v119, v2 offset:4866
    s_waitcnt lgkmcnt(13)
    v_mul_f32 v120, v120, v104
    v_mul_f32 v121, v121, v105
    v_mul_f32 v122, v122, v106
    v_mul_f32 v123, v123, v107
    s_waitcnt lgkmcnt(9)
    v_mul_f32 v124, v124, v108
    v_mul_f32 v125, v125, v109
    v_mul_f32 v126, v126, v110
    v_mul_f32 v127, v127, v111
    v_cvt_pk_bf16_f32 v120, v120, v121
    v_cvt_pk_bf16_f32 v121, v122, v123
    v_cvt_pk_bf16_f32 v122, v124, v125
    v_cvt_pk_bf16_f32 v123, v126, v127
    s_nop 1
    v_mfma_f32_32x32x16_bf16 v[176:191], v[16:19], v[120:123], v[176:191]
    ds_read_u16_d16_hi v120, v2 offset:7170
    ds_read_u16_d16_hi v121, v2 offset:7426
    ds_read_u16_d16_hi v122, v2 offset:7682
    ds_read_u16_d16_hi v123, v2 offset:7938
    ds_read_u16_d16_hi v124, v2 offset:10242
    ds_read_u16_d16_hi v125, v2 offset:10498
    ds_read_u16_d16_hi v126, v2 offset:10754
    ds_read_u16_d16_hi v127, v2 offset:11010
    s_waitcnt lgkmcnt(12)
    v_mul_f32 v112, v112, v96
    v_mul_f32 v113, v113, v97
    v_mul_f32 v114, v114, v98
    v_mul_f32 v115, v115, v99
    v_mfma_f32_32x32x16_bf16 v[64:79], v[56:59], v[28:31], v[64:79]
    ds_read_b128 v[28:31], v1 offset:20480
    s_waitcnt lgkmcnt(9)
    v_mul_f32 v116, v116, v100
    v_mul_f32 v117, v117, v101
    v_mul_f32 v118, v118, v102
    v_mul_f32 v119, v119, v103
    v_cvt_pk_bf16_f32 v112, v112, v113
    v_cvt_pk_bf16_f32 v113, v114, v115
    v_cvt_pk_bf16_f32 v114, v116, v117
    v_cvt_pk_bf16_f32 v115, v118, v119
    s_nop 1
    v_mfma_f32_32x32x16_bf16 v[208:223], v[12:15], v[112:115], v[208:223]
    ds_read_u16_d16_hi v112, v2 offset:2050
    ds_read_u16_d16_hi v113, v2 offset:2306
    ds_read_u16_d16_hi v114, v2 offset:2562
    ds_read_u16_d16_hi v115, v2 offset:2818
    ds_read_u16_d16_hi v116, v2 offset:5122
    ds_read_u16_d16_hi v117, v2 offset:5378
    ds_read_u16_d16_hi v118, v2 offset:5634
    ds_read_u16_d16_hi v119, v2 offset:5890
    s_waitcnt lgkmcnt(13)
    v_mul_f32 v120, v120, v104
    v_mul_f32 v121, v121, v105
    v_mul_f32 v122, v122, v106
    v_mul_f32 v123, v123, v107
    s_waitcnt lgkmcnt(9)
    v_mul_f32 v124, v124, v108
    v_mul_f32 v125, v125, v109
    v_mul_f32 v126, v126, v110
    v_mul_f32 v127, v127, v111
    v_cvt_pk_bf16_f32 v120, v120, v121
    v_cvt_pk_bf16_f32 v121, v122, v123
    v_cvt_pk_bf16_f32 v122, v124, v125
    v_cvt_pk_bf16_f32 v123, v126, v127
    s_nop 1
    v_mfma_f32_32x32x16_bf16 v[208:223], v[16:19], v[120:123], v[208:223]
    ds_read_u16_d16_hi v120, v2 offset:8194
    ds_read_u16_d16_hi v121, v2 offset:8450
    ds_read_u16_d16_hi v122, v2 offset:8706
    ds_read_u16_d16_hi v123, v2 offset:8962
    ds_read_u16_d16_hi v124, v2 offset:11266
    ds_read_u16_d16_hi v125, v2 offset:11522
    ds_read_u16_d16_hi v126, v2 offset:11778
    ds_read_u16_d16_hi v127, v2 offset:12034
    s_waitcnt lgkmcnt(12)
    v_mul_f32 v112, v112, v96
    v_mfma_f32_32x32x16_bf16 v[64:79], v[60:63], v[20:23], v[64:79]
    ds_read_b128 v[20:23], v1 offset:21504
    v_mul_f32 v113, v113, v97
    v_mul_f32 v114, v114, v98
    v_mul_f32 v115, v115, v99
    s_waitcnt lgkmcnt(9)
    v_mul_f32 v116, v116, v100
    v_mul_f32 v117, v117, v101
    v_mul_f32 v118, v118, v102
    v_mul_f32 v119, v119, v103
    v_cvt_pk_bf16_f32 v112, v112, v113
    v_cvt_pk_bf16_f32 v113, v114, v115
    v_cvt_pk_bf16_f32 v114, v116, v117
    v_cvt_pk_bf16_f32 v115, v118, v119
    s_nop 1
    v_mfma_f32_32x32x16_bf16 v[240:255], v[12:15], v[112:115], v[240:255]
    s_waitcnt lgkmcnt(5)
    v_mul_f32 v120, v120, v104
    v_mul_f32 v121, v121, v105
    v_mul_f32 v122, v122, v106
    v_mul_f32 v123, v123, v107
    s_waitcnt lgkmcnt(1)
    v_mul_f32 v124, v124, v108
    v_mul_f32 v125, v125, v109
    v_mul_f32 v126, v126, v110
    v_mul_f32 v127, v127, v111
    v_cvt_pk_bf16_f32 v120, v120, v121
    v_cvt_pk_bf16_f32 v121, v122, v123
    v_cvt_pk_bf16_f32 v122, v124, v125
    v_cvt_pk_bf16_f32 v123, v126, v127
    s_nop 1
    v_mfma_f32_32x32x16_bf16 v[240:255], v[16:19], v[120:123], v[240:255]
    s_cmp_lg_u32 s77, 0
    s_nop 10
    s_cbranch_scc1 M_nv21
    ds_read_b32 v112, v5 offset:524
    ds_read_b32 v113, v5 offset:652
    ds_read_b32 v114, v5 offset:780
    ds_read_b32 v115, v5 offset:908
    s_waitcnt lgkmcnt(3)
    v_and_or_b32 v112, v1, s63, v112
    s_waitcnt lgkmcnt(2)
    v_and_or_b32 v113, v1, s63, v113
    s_waitcnt lgkmcnt(1)
    v_and_or_b32 v114, v1, s63, v114
    s_waitcnt lgkmcnt(0)
    v_and_or_b32 v115, v1, s63, v115
    s_add_u32 m0, s51, 0
    s_nop 0
    buffer_load_dwordx4 v112, s[28:31], s64 offen lds
    s_add_u32 m0, s51, 1024
    s_nop 0
    buffer_load_dwordx4 v112, s[28:31], s65 offen lds
    s_add_u32 m0, s51, 2048
    s_nop 0
    buffer_load_dwordx4 v112, s[28:31], s66 offen lds
    s_add_u32 m0, s51, 3072
    s_nop 0
    buffer_load_dwordx4 v113, s[28:31], s64 offen lds
    s_add_u32 m0, s51, 4096
    s_nop 0
    buffer_load_dwordx4 v113, s[28:31], s65 offen lds
    s_add_u32 m0, s51, 5120
    s_nop 0
    buffer_load_dwordx4 v113, s[28:31], s66 offen lds
    s_add_u32 m0, s51, 6144
    s_nop 0
    buffer_load_dwordx4 v114, s[28:31], s64 offen lds
    s_add_u32 m0, s51, 7168
    s_nop 0
    buffer_load_dwordx4 v114, s[28:31], s65 offen lds
    s_add_u32 m0, s51, 8192
    s_nop 0
    buffer_load_dwordx4 v114, s[28:31], s66 offen lds
    s_add_u32 m0, s51, 9216
    s_nop 0
    buffer_load_dwordx4 v115, s[28:31], s64 offen lds
    s_add_u32 m0, s51, 10240
    s_nop 0
    buffer_load_dwordx4 v115, s[28:31], s65 offen lds
    s_add_u32 m0, s51, 11264
    s_nop 0
    buffer_load_dwordx4 v115, s[28:31], s66 offen lds
    s_branch M_nj21
M_nv21:
    s_cmp_eq_u32 s76, 0
    s_cbranch_scc1 M_nj21
    v_lshrrev_b32 v112, 7, v1
    v_and_b32 v113, 1, v112
    v_lshrrev_b32 v112, 1, v112
    v_lshl_add_u32 v112, v113, 2, v112
    v_lshlrev_b32 v112, 9, v112
    v_and_or_b32 v112, v1, s63, v112
    s_add_u32 m0, s51, 1024
    s_add_u32 s53, s40, 256
    buffer_load_dwordx4 v112, s[4:7], s53 offen  lds
    s_add_u32 m0, s51, 2048
    s_add_u32 s53, s40, 384
    buffer_load_dwordx4 v112, s[4:7], s53 offen  lds
    s_add_u32 m0, s51, 4096
    s_add_u32 s53, s41, 256
    buffer_load_dwordx4 v112, s[4:7], s53 offen  lds
    s_add_u32 m0, s51, 5120
    s_add_u32 s53, s41, 384
    buffer_load_dwordx4 v112, s[4:7], s53 offen  lds
    s_add_u32 m0, s51, 7168
    s_add_u32 s53, s42, 256
    buffer_load_dwordx4 v112, s[4:7], s53 offen  lds
    s_add_u32 m0, s51, 8192
    s_add_u32 s53, s42, 384
    buffer_load_dwordx4 v112, s[4:7], s53 offen  lds
    s_add_u32 m0, s51, 10240
    s_add_u32 s53, s43, 256
    buffer_load_dwordx4 v112, s[4:7], s53 offen  lds
    s_add_u32 m0, s51, 11264
    s_add_u32 s53, s43, 384
    buffer_load_dwordx4 v112, s[4:7], s53 offen  lds
M_nj21:
    v_mfma_f32_32x32x16_bf16 v[112:127], v[8:11], v[24:27], 0
    ds_read_b128 v[24:27], v1 offset:22528
    v_mfma_f32_32x32x16_bf16 v[96:111], v[48:51], v[28:31], 0
    ds_read_b128 v[28:31], v1 offset:23552
    v_mul_f32 v64, v64, v80
    v_mul_f32 v65, v65, v81
    v_mul_f32 v66, v66, v82
    v_mul_f32 v67, v67, v83
    v_mul_f32 v68, v68, v84
    v_mul_f32 v69, v69, v85
    v_mul_f32 v70, v70, v86
    v_mul_f32 v71, v71, v87
    v_mul_f32 v72, v72, v88
    v_mul_f32 v73, v73, v89
    v_mul_f32 v74, v74, v90
    v_mul_f32 v75, v75, v91
    s_waitcnt lgkmcnt(2)
    v_mfma_f32_32x32x16_bf16 v[96:111], v[52:55], v[20:23], v[96:111]
    v_mul_f32 v76, v76, v92
    v_mul_f32 v77, v77, v93
    v_mul_f32 v78, v78, v94
    v_mul_f32 v79, v79, v95
    ds_read_b64 v[80:81], v0 offset:2080
    ds_read_b64 v[88:89], v0 offset:2088
    ds_read_b64 v[82:83], v0 offset:2192
    ds_read_b64 v[90:91], v0 offset:2200
    ds_read_b64 v[84:85], v0 offset:2304
    ds_read_b64 v[92:93], v0 offset:2312
    ds_read_b64 v[86:87], v0 offset:2416
    ds_read_b64 v[94:95], v0 offset:2424
    v_cvt_pk_bf16_f32 v64, v64, v65
    v_cvt_pk_bf16_f32 v65, v66, v67
    v_cvt_pk_bf16_f32 v66, v68, v69
    v_cvt_pk_bf16_f32 v67, v70, v71
    v_cvt_pk_bf16_f32 v68, v72, v73
    v_cvt_pk_bf16_f32 v69, v74, v75
    v_cvt_pk_bf16_f32 v70, v76, v77
    s_waitcnt lgkmcnt(9)
    v_mfma_f32_32x32x16_bf16 v[96:111], v[56:59], v[24:27], v[96:111]
    v_cvt_pk_bf16_f32 v71, v78, v79
    v_pk_lshrrev_b16 v72, 14, v12 op_sel_hi:[0,1]
    v_pk_lshrrev_b16 v73, 14, v13 op_sel_hi:[0,1]
    v_pk_lshrrev_b16 v74, 14, v14 op_sel_hi:[0,1]
    v_pk_lshrrev_b16 v75, 14, v15 op_sel_hi:[0,1]
    v_pk_lshrrev_b16 v76, 14, v16 op_sel_hi:[0,1]
    v_pk_lshrrev_b16 v77, 14, v17 op_sel_hi:[0,1]
    v_pk_lshrrev_b16 v78, 14, v18 op_sel_hi:[0,1]
    v_pk_lshrrev_b16 v79, 14, v19 op_sel_hi:[0,1]
    s_waitcnt lgkmcnt(0)
    v_pk_mul_lo_u16 v80, v72, v80
    v_pk_mul_lo_u16 v81, v73, v81
    v_pk_mul_lo_u16 v82, v74, v82
    v_mfma_f32_32x32x16_bf16 v[96:111], v[60:63], v[28:31], v[96:111]
    v_pk_mul_lo_u16 v83, v75, v83
    v_pk_mul_lo_u16 v84, v76, v84
    v_pk_mul_lo_u16 v85, v77, v85
    v_pk_mul_lo_u16 v86, v78, v86
    v_pk_mul_lo_u16 v87, v79, v87
    v_pk_mul_lo_u16 v88, v72, v88
    v_pk_mul_lo_u16 v89, v73, v89
    v_pk_mul_lo_u16 v90, v74, v90
    v_pk_mul_lo_u16 v91, v75, v91
    v_pk_mul_lo_u16 v92, v76, v92
    v_pk_mul_lo_u16 v93, v77, v93
    v_pk_mul_lo_u16 v94, v78, v94
    v_pk_mul_lo_u16 v95, v79, v95
    v_mfma_f32_32x32x16_bf16 v[160:175], v[80:83], v[64:67], v[160:175]
    v_mul_f32 v96, v96, v112
    v_mul_f32 v97, v97, v113
    v_mul_f32 v98, v98, v114
    v_mul_f32 v99, v99, v115
    v_mul_f32 v100, v100, v116
    v_mul_f32 v101, v101, v117
    v_mfma_f32_32x32x16_bf16 v[160:175], v[84:87], v[68:71], v[160:175]
    v_mul_f32 v102, v102, v118
    v_mul_f32 v103, v103, v119
    v_mul_f32 v104, v104, v120
    v_mul_f32 v105, v105, v121
    v_mul_f32 v106, v106, v122
    v_mul_f32 v107, v107, v123
    v_mfma_f32_32x32x16_bf16 v[192:207], v[88:91], v[64:67], v[192:207]
    v_mul_f32 v108, v108, v124
    v_mul_f32 v109, v109, v125
    v_mul_f32 v110, v110, v126
    v_mul_f32 v111, v111, v127
    ds_read_b64 v[112:113], v0 offset:2096
    ds_read_b64 v[114:115], v0 offset:2208
    ds_read_b64 v[116:117], v0 offset:2320
    ds_read_b64 v[118:119], v0 offset:2432
    v_cvt_pk_bf16_f32 v96, v96, v97
    v_mfma_f32_32x32x16_bf16 v[192:207], v[92:95], v[68:71], v[192:207]
    v_cvt_pk_bf16_f32 v97, v98, v99
    v_cvt_pk_bf16_f32 v98, v100, v101
    v_cvt_pk_bf16_f32 v99, v102, v103
    v_cvt_pk_bf16_f32 v100, v104, v105
    v_cvt_pk_bf16_f32 v101, v106, v107
    v_cvt_pk_bf16_f32 v102, v108, v109
    v_cvt_pk_bf16_f32 v103, v110, v111
    s_waitcnt lgkmcnt(0)
    v_pk_mul_lo_u16 v112, v72, v112
    v_pk_mul_lo_u16 v113, v73, v113
    v_pk_mul_lo_u16 v114, v74, v114
    v_pk_mul_lo_u16 v115, v75, v115
    v_pk_mul_lo_u16 v116, v76, v116
    v_pk_mul_lo_u16 v117, v77, v117
    v_pk_mul_lo_u16 v118, v78, v118
    v_pk_mul_lo_u16 v119, v79, v119
    v_mfma_f32_32x32x16_bf16 v[176:191], v[80:83], v[96:99], v[176:191]
    ds_read_b128 v[104:107], v3 offset:512
    ds_read_b128 v[72:75], v7
    ds_read_b128 v[76:79], v7 offset:16
    ds_read_b64 v[12:13], v4 offset:2496
    ds_read_b64 v[14:15], v4 offset:2608
    ds_read_b64 v[16:17], v4 offset:2720
    ds_read_b64 v[18:19], v4 offset:2832
    ds_read_b128 v[20:23], v1 offset:24576
    ds_read_b128 v[24:27], v1 offset:0
    ds_read_b128 v[28:31], v1 offset:1024
    s_waitcnt lgkmcnt(7)
    v_mul_f32 v72, v104, v72
    v_mul_f32 v73, v104, v73
    v_mul_f32 v74, v104, v74
    v_mul_f32 v75, v104, v75
    v_mul_f32 v76, v104, v76
    v_mfma_f32_32x32x16_bf16 v[176:191], v[84:87], v[100:103], v[176:191]
    v_mul_f32 v77, v104, v77
    v_mul_f32 v78, v104, v78
    v_mul_f32 v79, v104, v79
    v_cvt_pk_bf16_f32 v72, 0, v72
    v_cvt_pk_bf16_f32 v73, 0, v73
    v_cvt_pk_bf16_f32 v74, 0, v74
    v_cvt_pk_bf16_f32 v75, 0, v75
    v_mfma_f32_32x32x16_bf16 v[208:223], v[88:91], v[96:99], v[208:223]
    v_cvt_pk_bf16_f32 v76, 0, v76
    v_cvt_pk_bf16_f32 v77, 0, v77
    v_cvt_pk_bf16_f32 v78, 0, v78
    v_cvt_pk_bf16_f32 v79, 0, v79
    v_mul_f32 v72, s61, v72
    v_mul_f32 v73, s61, v73
    v_mfma_f32_32x32x16_bf16 v[208:223], v[92:95], v[100:103], v[208:223]
    v_mul_f32 v74, s61, v74
    v_mul_f32 v75, s61, v75
    v_mul_f32 v76, s61, v76
    v_mul_f32 v77, s61, v77
    v_mul_f32 v78, s61, v78
    v_mul_f32 v79, s61, v79
    v_sin_f32 v72, v72
    v_mfma_f32_32x32x16_bf16 v[224:239], v[112:115], v[64:67], v[224:239]
    v_sin_f32 v73, v73
    v_sin_f32 v74, v74
    v_sin_f32 v75, v75
    v_sin_f32 v76, v76
    v_sin_f32 v77, v77
    v_sin_f32 v78, v78
    v_sin_f32 v79, v79
    v_mfma_f32_32x32x16_bf16 v[240:255], v[112:115], v[96:99], v[240:255]
    v_mul_f32 v72, v72, v105
    v_mul_f32 v73, v73, v105
    v_mul_f32 v74, v74, v105
    v_mul_f32 v75, v75, v105
    v_mul_f32 v76, v76, v105
    v_mul_f32 v77, v77, v105
    v_mfma_f32_32x32x16_bf16 v[224:239], v[116:119], v[68:71], v[224:239]
    v_mul_f32 v78, v78, v105
    v_mul_f32 v79, v79, v105
    v_cvt_pk_bf16_f32 v8, v72, v73
    v_cvt_pk_bf16_f32 v9, v74, v75
    v_cvt_pk_bf16_f32 v10, v76, v77
    v_cvt_pk_bf16_f32 v11, v78, v79
    s_waitcnt lgkmcnt(3)
    v_pk_lshlrev_b16 v12, v6, v12
    v_mfma_f32_32x32x16_bf16 v[240:255], v[116:119], v[100:103], v[240:255]
    v_pk_lshlrev_b16 v13, v6, v13
    v_pk_lshlrev_b16 v14, v6, v14
    v_pk_lshlrev_b16 v15, v6, v15
    v_pk_lshlrev_b16 v16, v6, v16
    v_pk_lshlrev_b16 v17, v6, v17
    v_pk_lshlrev_b16 v18, v6, v18
    v_pk_lshlrev_b16 v19, v6, v19
    v_add_u32 v3, 512, v3
    v_add_u32 v4, 448, v4
    v_add_u32 v0, 448, v0
    v_add_u32 v5, 512, v5
    s_waitcnt lgkmcnt(0)
    s_add_u32 s49, s49, 1
    s_cmp_lt_u32 s49, s48
    s_cbranch_scc1 M_batch
M_wend:
    s_cmp_lg_u32 s76, 0
    s_cbranch_scc1 M_epi
M_slow:
    v_lshrrev_b32 v8, 4, v1
    v_add_u32 v86, 64, v8
    v_bfrev_b32 v14, 2
    s_mov_b32 s63, 0x02020000
    s_mov_b32 s64, 0x322bcc77
    v_mov_b32 v103, 0x01000c0c
    v_and_b32 v12, 3, v8
    v_lshlrev_b32 v12, 3, v12
    v_lshrrev_b32_e64 v13, v12, s18
    v_bfe_u32 v15, v13, 1, 7
    v_lshlrev_b32 v15, 17, v15
    v_and_b32 v13, 1, v13
    v_or_b32 v95, v13, v15
    s_bfe_u32 s60, s18, 0x70019
    s_lshl_b32 s60, s60, 17
    s_bfe_u32 s27, s18, 0x10018
    s_or_b32 s60, s60, s27
    s_lshl_b32 s53, s2, 7
    s_cmp_eq_u32 s14, 2
    s_cbranch_scc1 M_sovf
    s_cmp_ge_u32 s15, 63
    s_cbranch_scc1 M_sph1
    s_lshl_b32 s62, s15, 2
    v_lshrrev_b32 v12, 5, v8
    v_and_b32 v13, 31, v8
    v_add_u32 v15, s62, v12
    v_cmp_gt_u32 vcc, 250, v15
    s_mov_b64 s[54:55], vcc
    v_lshlrev_b32 v15, 15, v15
    v_cndmask_b32 v15, v14, v15, s[54:55]
    s_cmp_lg_u32 s14, 0
    s_nop 0
    s_cbranch_scc1 M_s222
    v_lshl_add_u32 v16, v13, 2, v15
    buffer_load_dword v88, v16, s[36:39], s53 offen sc1
    s_waitcnt vmcnt(0)
    v_xor_b32 v88, v95, v88
    s_mov_b32 s27, 0xc8000000
    v_cmp_gt_u32 vcc, s27, v88
    s_and_b64 s[54:55], s[54:55], vcc
    s_nop 3
    s_branch M_s322
M_s222:
    buffer_load_dword v88, v15, s[36:39], s53 offen offset:124 sc1
    s_waitcnt vmcnt(0)
    v_xor_b32 v88, s60, v88
    v_and_b32 v88, 0xffffff, v88
    v_cmp_gt_u32 vcc, v88, v13
    s_and_b64 s[54:55], s[54:55], vcc
    v_lshl_add_u32 v16, v13, 2, v15
    v_cndmask_b32 v16, v14, v16, s[54:55]
    s_add_u32 s27, s53, 0x900000
    buffer_load_dword v88, v16, s[36:39], s27 offen sc1
    s_waitcnt vmcnt(0)
M_s322:
    v_lshrrev_b32 v16, 24, v88
    v_subrev_u32 v17, s59, v16
    v_cmp_gt_u32 vcc, s45, v17
    s_and_b64 s[54:55], s[54:55], vcc
    v_and_b32 v96, 0x1fffe, v88
    v_lshl_add_u32 v96, v96, 1, v96
    v_and_b32 v96, -4, v96
    v_cndmask_b32 v96, v14, v96, s[54:55]
    buffer_load_dwordx2 v[98:99], v96, s[92:95], 0 offen
    v_mul_u32_u24 v97, 6, v16
    v_and_b32 v97, -4, v97
    v_cndmask_b32 v97, v14, v97, s[54:55]
    s_mul_i32 s27, s2, 1200
    buffer_load_dwordx2 v[100:101], v97, s[92:95], s27 offen
    v_bfe_i32 v102, v88, 1, 1
    v_and_or_b32 v102, v102, s63, v103
    v_bfe_i32 v104, v16, 0, 1
    v_and_or_b32 v104, v104, s63, v103
    v_add_u32 v105, s63, v104
    v_add_u32 v106, s63, v105
    s_waitcnt vmcnt(0)
    v_perm_b32 v107, v101, v100, v104
    v_perm_b32 v108, v101, v100, v105
    v_perm_b32 v109, v101, v100, v106
    v_add_u32 v113, s63, v102
    v_perm_b32 v110, v99, v98, v102
    v_add_u32 v114, s63, v113
    v_perm_b32 v111, v99, v98, v113
    v_perm_b32 v112, v99, v98, v114
    v_sub_f32 v110, v110, v107
    v_sub_f32 v111, v111, v108
    v_sub_f32 v112, v112, v109
    v_cvt_pk_bf16_f32 v89, v110, v111
    v_cvt_pk_bf16_f32 v112, 0, v112
    v_lshlrev_b32 v110, 16, v89
    v_and_b32 v111, s58, v89
    v_mul_f32 v115, v112, v112
    v_mul_f32 v110, v110, v110
    v_mul_f32 v111, v111, v111
    v_cvt_pk_bf16_f32 v115, 0, v115
    v_cvt_pk_bf16_f32 v110, 0, v110
    v_cvt_pk_bf16_f32 v111, 0, v111
    v_add_f32 v110, v110, v111
    v_add_f32 v110, v110, v115
    v_cvt_pk_bf16_f32 v110, 0, v110
    v_add_f32 v110, s64, v110
    v_cvt_pk_bf16_f32 v110, 0, v110
    v_sqrt_f32 v110, v110
    s_nop 0
    v_cvt_pk_bf16_f32 v90, v112, v110
    s_mov_b32 s27, 0x409d0000
    v_cmp_gt_u32 vcc, s27, v90
    s_and_b64 s[8:9], s[54:55], vcc
    v_lshrrev_b32 v12, 5, v86
    v_and_b32 v13, 31, v86
    v_add_u32 v15, s62, v12
    v_cmp_gt_u32 vcc, 250, v15
    s_mov_b64 s[54:55], vcc
    v_lshlrev_b32 v15, 15, v15
    v_cndmask_b32 v15, v14, v15, s[54:55]
    s_cmp_lg_u32 s14, 0
    s_nop 0
    s_cbranch_scc1 M_s223
    v_lshl_add_u32 v16, v13, 2, v15
    buffer_load_dword v92, v16, s[36:39], s53 offen sc1
    s_waitcnt vmcnt(0)
    v_xor_b32 v92, v95, v92
    s_mov_b32 s27, 0xc8000000
    v_cmp_gt_u32 vcc, s27, v92
    s_and_b64 s[54:55], s[54:55], vcc
    s_nop 3
    s_branch M_s323
M_s223:
    buffer_load_dword v92, v15, s[36:39], s53 offen offset:124 sc1
    s_waitcnt vmcnt(0)
    v_xor_b32 v92, s60, v92
    v_and_b32 v92, 0xffffff, v92
    v_cmp_gt_u32 vcc, v92, v13
    s_and_b64 s[54:55], s[54:55], vcc
    v_lshl_add_u32 v16, v13, 2, v15
    v_cndmask_b32 v16, v14, v16, s[54:55]
    s_add_u32 s27, s53, 0x900000
    buffer_load_dword v92, v16, s[36:39], s27 offen sc1
    s_waitcnt vmcnt(0)
M_s323:
    v_lshrrev_b32 v16, 24, v92
    v_subrev_u32 v17, s59, v16
    v_cmp_gt_u32 vcc, s45, v17
    s_and_b64 s[54:55], s[54:55], vcc
    v_and_b32 v96, 0x1fffe, v92
    v_lshl_add_u32 v96, v96, 1, v96
    v_and_b32 v96, -4, v96
    v_cndmask_b32 v96, v14, v96, s[54:55]
    buffer_load_dwordx2 v[98:99], v96, s[92:95], 0 offen
    v_mul_u32_u24 v97, 6, v16
    v_and_b32 v97, -4, v97
    v_cndmask_b32 v97, v14, v97, s[54:55]
    s_mul_i32 s27, s2, 1200
    buffer_load_dwordx2 v[100:101], v97, s[92:95], s27 offen
    v_bfe_i32 v102, v92, 1, 1
    v_and_or_b32 v102, v102, s63, v103
    v_bfe_i32 v104, v16, 0, 1
    v_and_or_b32 v104, v104, s63, v103
    v_add_u32 v105, s63, v104
    v_add_u32 v106, s63, v105
    s_waitcnt vmcnt(0)
    v_perm_b32 v107, v101, v100, v104
    v_perm_b32 v108, v101, v100, v105
    v_perm_b32 v109, v101, v100, v106
    v_add_u32 v113, s63, v102
    v_perm_b32 v110, v99, v98, v102
    v_add_u32 v114, s63, v113
    v_perm_b32 v111, v99, v98, v113
    v_perm_b32 v112, v99, v98, v114
    v_sub_f32 v110, v110, v107
    v_sub_f32 v111, v111, v108
    v_sub_f32 v112, v112, v109
    v_cvt_pk_bf16_f32 v93, v110, v111
    v_cvt_pk_bf16_f32 v112, 0, v112
    v_lshlrev_b32 v110, 16, v93
    v_and_b32 v111, s58, v93
    v_mul_f32 v115, v112, v112
    v_mul_f32 v110, v110, v110
    v_mul_f32 v111, v111, v111
    v_cvt_pk_bf16_f32 v115, 0, v115
    v_cvt_pk_bf16_f32 v110, 0, v110
    v_cvt_pk_bf16_f32 v111, 0, v111
    v_add_f32 v110, v110, v111
    v_add_f32 v110, v110, v115
    v_cvt_pk_bf16_f32 v110, 0, v110
    v_add_f32 v110, s64, v110
    v_cvt_pk_bf16_f32 v110, 0, v110
    v_sqrt_f32 v110, v110
    s_nop 0
    v_cvt_pk_bf16_f32 v94, v112, v110
    s_mov_b32 s27, 0x409d0000
    v_cmp_gt_u32 vcc, s27, v94
    s_and_b64 s[10:11], s[54:55], vcc
    s_add_u32 s15, s15, 1
    s_nop 2
    s_branch M_sgo
M_sph1:
    s_add_u32 s14, s14, 1
    s_mov_b32 s15, 0
    s_mov_b32 s16, 0
    s_cmp_eq_u32 s14, 1
    s_cbranch_scc1 M_slow
M_sovf:
    s_cmp_ge_u32 s15, 250
    s_cbranch_scc1 M_send
    s_cmp_lg_u32 s16, 0
    s_cbranch_scc1 M_sblk
    s_lshl_b32 s27, s15, 15
    s_add_u32 s27, s27, s53
    v_mov_b32 v12, 0
    buffer_load_dword v13, v12, s[36:39], s27 offen offset:124 sc1
    s_waitcnt vmcnt(0)
    v_readfirstlane_b32 s17, v13
    s_xor_b32 s17, s17, s60
    s_and_b32 s17, s17, 0xffffff
    s_cmp_gt_u32 s17, 32
    s_cselect_b32 s17, 1, 0
    s_cbranch_scc0 M_sblk0
    s_lshl_b32 s27, s15, 15
    s_add_u32 s27, s27, 32124
    buffer_load_dword v13, v12, s[36:39], s27 offen sc1
    s_waitcnt vmcnt(0)
    v_readfirstlane_b32 s17, v13
    s_min_u32 s17, s17, 3200
M_sblk0:
M_sblk:
    s_cmp_lt_u32 s16, s17
    s_cbranch_scc1 M_sld
    s_add_u32 s15, s15, 1
    s_mov_b32 s16, 0
    s_branch M_sovf
M_sld:
    s_mul_i32 s27, s15, 32768
    s_add_u32 s27, s27, 0x1100000
    v_add_u32 v12, s16, v8
    v_cmp_gt_u32 s[54:55], s17, v12
    v_lshlrev_b32 v12, 3, v12
    s_nop 0
    v_cndmask_b32 v12, v14, v12, s[54:55]
    buffer_load_dwordx2 v[88:89], v12, s[36:39], s27 offen sc1
    s_waitcnt vmcnt(0)
    v_cmp_eq_u32 vcc, s2, v89
    s_and_b64 s[54:55], s[54:55], vcc
    v_lshrrev_b32 v16, 24, v88
    v_subrev_u32 v17, s59, v16
    v_cmp_gt_u32 vcc, s45, v17
    s_and_b64 s[54:55], s[54:55], vcc
    v_and_b32 v96, 0x1fffe, v88
    v_lshl_add_u32 v96, v96, 1, v96
    v_and_b32 v96, -4, v96
    v_cndmask_b32 v96, v14, v96, s[54:55]
    buffer_load_dwordx2 v[98:99], v96, s[92:95], 0 offen
    v_mul_u32_u24 v97, 6, v16
    v_and_b32 v97, -4, v97
    v_cndmask_b32 v97, v14, v97, s[54:55]
    s_mul_i32 s27, s2, 1200
    buffer_load_dwordx2 v[100:101], v97, s[92:95], s27 offen
    v_bfe_i32 v102, v88, 1, 1
    v_and_or_b32 v102, v102, s63, v103
    v_bfe_i32 v104, v16, 0, 1
    v_and_or_b32 v104, v104, s63, v103
    v_add_u32 v105, s63, v104
    v_add_u32 v106, s63, v105
    s_waitcnt vmcnt(0)
    v_perm_b32 v107, v101, v100, v104
    v_perm_b32 v108, v101, v100, v105
    v_perm_b32 v109, v101, v100, v106
    v_add_u32 v113, s63, v102
    v_perm_b32 v110, v99, v98, v102
    v_add_u32 v114, s63, v113
    v_perm_b32 v111, v99, v98, v113
    v_perm_b32 v112, v99, v98, v114
    v_sub_f32 v110, v110, v107
    v_sub_f32 v111, v111, v108
    v_sub_f32 v112, v112, v109
    v_cvt_pk_bf16_f32 v89, v110, v111
    v_cvt_pk_bf16_f32 v112, 0, v112
    v_lshlrev_b32 v110, 16, v89
    v_and_b32 v111, s58, v89
    v_mul_f32 v115, v112, v112
    v_mul_f32 v110, v110, v110
    v_mul_f32 v111, v111, v111
    v_cvt_pk_bf16_f32 v115, 0, v115
    v_cvt_pk_bf16_f32 v110, 0, v110
    v_cvt_pk_bf16_f32 v111, 0, v111
    v_add_f32 v110, v110, v111
    v_add_f32 v110, v110, v115
    v_cvt_pk_bf16_f32 v110, 0, v110
    v_add_f32 v110, s64, v110
    v_cvt_pk_bf16_f32 v110, 0, v110
    v_sqrt_f32 v110, v110
    s_nop 0
    v_cvt_pk_bf16_f32 v90, v112, v110
    s_mov_b32 s27, 0x409d0000
    v_cmp_gt_u32 vcc, s27, v90
    s_and_b64 s[8:9], s[54:55], vcc
    s_mul_i32 s27, s15, 32768
    s_add_u32 s27, s27, 0x1100000
    v_add_u32 v12, s16, v86
    v_cmp_gt_u32 s[54:55], s17, v12
    v_lshlrev_b32 v12, 3, v12
    s_nop 0
    v_cndmask_b32 v12, v14, v12, s[54:55]
    buffer_load_dwordx2 v[92:93], v12, s[36:39], s27 offen sc1
    s_waitcnt vmcnt(0)
    v_cmp_eq_u32 vcc, s2, v93
    s_and_b64 s[54:55], s[54:55], vcc
    v_lshrrev_b32 v16, 24, v92
    v_subrev_u32 v17, s59, v16
    v_cmp_gt_u32 vcc, s45, v17
    s_and_b64 s[54:55], s[54:55], vcc
    v_and_b32 v96, 0x1fffe, v92
    v_lshl_add_u32 v96, v96, 1, v96
    v_and_b32 v96, -4, v96
    v_cndmask_b32 v96, v14, v96, s[54:55]
    buffer_load_dwordx2 v[98:99], v96, s[92:95], 0 offen
    v_mul_u32_u24 v97, 6, v16
    v_and_b32 v97, -4, v97
    v_cndmask_b32 v97, v14, v97, s[54:55]
    s_mul_i32 s27, s2, 1200
    buffer_load_dwordx2 v[100:101], v97, s[92:95], s27 offen
    v_bfe_i32 v102, v92, 1, 1
    v_and_or_b32 v102, v102, s63, v103
    v_bfe_i32 v104, v16, 0, 1
    v_and_or_b32 v104, v104, s63, v103
    v_add_u32 v105, s63, v104
    v_add_u32 v106, s63, v105
    s_waitcnt vmcnt(0)
    v_perm_b32 v107, v101, v100, v104
    v_perm_b32 v108, v101, v100, v105
    v_perm_b32 v109, v101, v100, v106
    v_add_u32 v113, s63, v102
    v_perm_b32 v110, v99, v98, v102
    v_add_u32 v114, s63, v113
    v_perm_b32 v111, v99, v98, v113
    v_perm_b32 v112, v99, v98, v114
    v_sub_f32 v110, v110, v107
    v_sub_f32 v111, v111, v108
    v_sub_f32 v112, v112, v109
    v_cvt_pk_bf16_f32 v93, v110, v111
    v_cvt_pk_bf16_f32 v112, 0, v112
    v_lshlrev_b32 v110, 16, v93
    v_and_b32 v111, s58, v93
    v_mul_f32 v115, v112, v112
    v_mul_f32 v110, v110, v110
    v_mul_f32 v111, v111, v111
    v_cvt_pk_bf16_f32 v115, 0, v115
    v_cvt_pk_bf16_f32 v110, 0, v110
    v_cvt_pk_bf16_f32 v111, 0, v111
    v_add_f32 v110, v110, v111
    v_add_f32 v110, v110, v115
    v_cvt_pk_bf16_f32 v110, 0, v110
    v_add_f32 v110, s64, v110
    v_cvt_pk_bf16_f32 v110, 0, v110
    v_sqrt_f32 v110, v110
    s_nop 0
    v_cvt_pk_bf16_f32 v94, v112, v110
    s_mov_b32 s27, 0x409d0000
    v_cmp_gt_u32 vcc, s27, v94
    s_and_b64 s[10:11], s[54:55], vcc
    s_add_u32 s16, s16, 128
    s_nop 2
M_sgo:
    s_or_b64 s[54:55], s[8:9], s[10:11]
    s_cmp_eq_u64 s[54:55], 0
    s_cbranch_scc1 M_slow
    s_mov_b32 s48, 4
    s_cmp_eq_u64 s[10:11], 0
    s_cselect_b32 s48, 2, 4
    s_movk_i32 s63, 0x70
    s_movk_i32 s64, 128
    v_lshrrev_b32 v8, 4, v1
    v_lshrrev_b32 v10, 5, v8
    v_and_b32 v11, 31, v8
    v_lshlrev_b32 v3, 4, v11
    v_add_u32 v3, s52, v3
    v_mul_u32_u24 v0, 56, v10
    v_add_u32 v0, s52, v0
    v_lshrrev_b32 v13, 3, v11
    v_lshl_add_u32 v4, v13, 3, v0
    v_lshrrev_b32 v13, 3, v8
    v_and_b32 v14, 1, v13
    v_lshrrev_b32 v13, 1, v13
    v_lshl_add_u32 v13, v14, 2, v13
    v_lshlrev_b32 v5, 4, v13
    v_add_u32 v5, s52, v5
    v_add_u32 v16, s52, v1
    v_lshrrev_b32 v17, 2, v8
    v_mul_u32_u24 v17, 56, v17
    v_and_b32 v13, 3, v8
    v_lshl_add_u32 v17, v13, 1, v17
    v_add_u32 v17, s52, v17
    s_nop 1
    s_branch M_win
M_send:
    s_mov_b64 s[8:9], 0
    s_mov_b64 s[10:11], 0
    s_mov_b32 s48, 0
    s_mov_b32 s76, 1
    s_movk_i32 s63, 0x70
    s_movk_i32 s64, 128
    v_lshrrev_b32 v8, 4, v1
    v_lshrrev_b32 v10, 5, v8
    v_and_b32 v11, 31, v8
    v_lshlrev_b32 v3, 4, v11
    v_add_u32 v3, s52, v3
    v_mul_u32_u24 v0, 56, v10
    v_add_u32 v0, s52, v0
    v_lshrrev_b32 v13, 3, v11
    v_lshl_add_u32 v4, v13, 3, v0
    v_lshrrev_b32 v13, 3, v8
    v_and_b32 v14, 1, v13
    v_lshrrev_b32 v13, 1, v13
    v_lshl_add_u32 v13, v14, 2, v13
    v_lshlrev_b32 v5, 4, v13
    v_add_u32 v5, s52, v5
    v_add_u32 v16, s52, v1
    v_lshrrev_b32 v17, 2, v8
    v_mul_u32_u24 v17, 56, v17
    v_and_b32 v13, 3, v8
    v_lshl_add_u32 v17, v13, 1, v17
    v_add_u32 v17, s52, v17
    s_nop 1
    s_branch M_win
M_epi:
    v_lshrrev_b32 v8, 4, v1
    v_lshrrev_b32 v10, 5, v8
    v_and_b32 v11, 31, v8
    v_lshlrev_b32 v12, 11, v10
    v_lshl_add_u32 v12, v11, 2, v12
    v_cvt_pk_bf16_f32 v64, v128, v144
    v_cvt_pk_bf16_f32 v65, v129, v145
    v_cvt_pk_bf16_f32 v66, v130, v146
    v_cvt_pk_bf16_f32 v67, v131, v147
    v_cvt_pk_bf16_f32 v68, v132, v148
    v_cvt_pk_bf16_f32 v69, v133, v149
    v_cvt_pk_bf16_f32 v70, v134, v150
    v_cvt_pk_bf16_f32 v71, v135, v151
    v_cvt_pk_bf16_f32 v72, v136, v152
    v_cvt_pk_bf16_f32 v73, v137, v153
    v_cvt_pk_bf16_f32 v74, v138, v154
    v_cvt_pk_bf16_f32 v75, v139, v155
    buffer_store_dword v64, v12, s[32:35], s40 offen offset:0 sc1 nt
    buffer_store_dword v65, v12, s[32:35], s40 offen offset:512 sc1 nt
    buffer_store_dword v66, v12, s[32:35], s40 offen offset:1024 sc1 nt
    buffer_store_dword v67, v12, s[32:35], s40 offen offset:1536 sc1 nt
    buffer_store_dword v68, v12, s[32:35], s41 offen offset:0 sc1 nt
    buffer_store_dword v69, v12, s[32:35], s41 offen offset:512 sc1 nt
    buffer_store_dword v70, v12, s[32:35], s41 offen offset:1024 sc1 nt
    buffer_store_dword v71, v12, s[32:35], s41 offen offset:1536 sc1 nt
    buffer_store_dword v72, v12, s[32:35], s42 offen offset:0 sc1 nt
    buffer_store_dword v73, v12, s[32:35], s42 offen offset:512 sc1 nt
    buffer_store_dword v74, v12, s[32:35], s42 offen offset:1024 sc1 nt
    buffer_store_dword v75, v12, s[32:35], s42 offen offset:1536 sc1 nt
    v_cvt_pk_bf16_f32 v80, v160, v176
    v_cvt_pk_bf16_f32 v81, v161, v177
    v_cvt_pk_bf16_f32 v82, v162, v178
    v_cvt_pk_bf16_f32 v83, v163, v179
    v_cvt_pk_bf16_f32 v84, v164, v180
    v_cvt_pk_bf16_f32 v85, v165, v181
    v_cvt_pk_bf16_f32 v86, v166, v182
    v_cvt_pk_bf16_f32 v87, v167, v183
    v_cvt_pk_bf16_f32 v88, v168, v184
    v_cvt_pk_bf16_f32 v89, v169, v185
    v_cvt_pk_bf16_f32 v90, v170, v186
    v_cvt_pk_bf16_f32 v91, v171, v187
    buffer_store_dword v80, v12, s[32:35], s40 offen offset:128 sc1 nt
    buffer_store_dword v81, v12, s[32:35], s40 offen offset:640 sc1 nt
    buffer_store_dword v82, v12, s[32:35], s40 offen offset:1152 sc1 nt
    buffer_store_dword v83, v12, s[32:35], s40 offen offset:1664 sc1 nt
    buffer_store_dword v84, v12, s[32:35], s41 offen offset:128 sc1 nt
    buffer_store_dword v85, v12, s[32:35], s41 offen offset:640 sc1 nt
    buffer_store_dword v86, v12, s[32:35], s41 offen offset:1152 sc1 nt
    buffer_store_dword v87, v12, s[32:35], s41 offen offset:1664 sc1 nt
    buffer_store_dword v88, v12, s[32:35], s42 offen offset:128 sc1 nt
    buffer_store_dword v89, v12, s[32:35], s42 offen offset:640 sc1 nt
    buffer_store_dword v90, v12, s[32:35], s42 offen offset:1152 sc1 nt
    buffer_store_dword v91, v12, s[32:35], s42 offen offset:1664 sc1 nt
    s_waitcnt vmcnt(24)
    ds_read_u16_d16_hi v16, v2 offset:1024
    ds_read_u16_d16_hi v17, v2 offset:1280
    ds_read_u16_d16_hi v18, v2 offset:1536
    ds_read_u16_d16_hi v19, v2 offset:1792
    ds_read_u16_d16_hi v20, v2 offset:4096
    ds_read_u16_d16_hi v21, v2 offset:4352
    ds_read_u16_d16_hi v22, v2 offset:4608
    ds_read_u16_d16_hi v23, v2 offset:4864
    ds_read_u16_d16_hi v24, v2 offset:7168
    ds_read_u16_d16_hi v25, v2 offset:7424
    ds_read_u16_d16_hi v26, v2 offset:7680
    ds_read_u16_d16_hi v27, v2 offset:7936
    ds_read_u16_d16_hi v32, v2 offset:1026
    ds_read_u16_d16_hi v33, v2 offset:1282
    ds_read_u16_d16_hi v34, v2 offset:1538
    ds_read_u16_d16_hi v35, v2 offset:1794
    ds_read_u16_d16_hi v36, v2 offset:4098
    ds_read_u16_d16_hi v37, v2 offset:4354
    ds_read_u16_d16_hi v38, v2 offset:4610
    ds_read_u16_d16_hi v39, v2 offset:4866
    ds_read_u16_d16_hi v40, v2 offset:7170
    ds_read_u16_d16_hi v41, v2 offset:7426
    ds_read_u16_d16_hi v42, v2 offset:7682
    ds_read_u16_d16_hi v43, v2 offset:7938
    s_waitcnt lgkmcnt(15)
    v_add_f32 v192, v192, v16
    v_add_f32 v193, v193, v17
    v_add_f32 v194, v194, v18
    v_add_f32 v195, v195, v19
    v_add_f32 v196, v196, v20
    v_add_f32 v197, v197, v21
    v_add_f32 v198, v198, v22
    v_add_f32 v199, v199, v23
    v_add_f32 v200, v200, v24
    s_waitcnt lgkmcnt(14)
    v_add_f32 v201, v201, v25
    s_waitcnt lgkmcnt(13)
    v_add_f32 v202, v202, v26
    s_waitcnt lgkmcnt(12)
    v_add_f32 v203, v203, v27
    s_waitcnt lgkmcnt(11)
    v_add_f32 v208, v208, v32
    s_waitcnt lgkmcnt(10)
    v_add_f32 v209, v209, v33
    s_waitcnt lgkmcnt(9)
    v_add_f32 v210, v210, v34
    s_waitcnt lgkmcnt(8)
    v_add_f32 v211, v211, v35
    s_waitcnt lgkmcnt(7)
    v_add_f32 v212, v212, v36
    s_waitcnt lgkmcnt(6)
    v_add_f32 v213, v213, v37
    s_waitcnt lgkmcnt(5)
    v_add_f32 v214, v214, v38
    s_waitcnt lgkmcnt(4)
    v_add_f32 v215, v215, v39
    s_waitcnt lgkmcnt(3)
    v_add_f32 v216, v216, v40
    s_waitcnt lgkmcnt(2)
    v_add_f32 v217, v217, v41
    s_waitcnt lgkmcnt(1)
    v_add_f32 v218, v218, v42
    s_waitcnt lgkmcnt(0)
    v_add_f32 v219, v219, v43
    v_cvt_pk_bf16_f32 v96, v192, v208
    v_cvt_pk_bf16_f32 v97, v193, v209
    v_cvt_pk_bf16_f32 v98, v194, v210
    v_cvt_pk_bf16_f32 v99, v195, v211
    v_cvt_pk_bf16_f32 v100, v196, v212
    v_cvt_pk_bf16_f32 v101, v197, v213
    v_cvt_pk_bf16_f32 v102, v198, v214
    v_cvt_pk_bf16_f32 v103, v199, v215
    v_cvt_pk_bf16_f32 v104, v200, v216
    v_cvt_pk_bf16_f32 v105, v201, v217
    v_cvt_pk_bf16_f32 v106, v202, v218
    v_cvt_pk_bf16_f32 v107, v203, v219
    buffer_store_dword v96, v12, s[32:35], s40 offen offset:256 sc1 nt
    buffer_store_dword v97, v12, s[32:35], s40 offen offset:768 sc1 nt
    buffer_store_dword v98, v12, s[32:35], s40 offen offset:1280 sc1 nt
    buffer_store_dword v99, v12, s[32:35], s40 offen offset:1792 sc1 nt
    buffer_store_dword v100, v12, s[32:35], s41 offen offset:256 sc1 nt
    buffer_store_dword v101, v12, s[32:35], s41 offen offset:768 sc1 nt
    buffer_store_dword v102, v12, s[32:35], s41 offen offset:1280 sc1 nt
    buffer_store_dword v103, v12, s[32:35], s41 offen offset:1792 sc1 nt
    buffer_store_dword v104, v12, s[32:35], s42 offen offset:256 sc1 nt
    buffer_store_dword v105, v12, s[32:35], s42 offen offset:768 sc1 nt
    buffer_store_dword v106, v12, s[32:35], s42 offen offset:1280 sc1 nt
    buffer_store_dword v107, v12, s[32:35], s42 offen offset:1792 sc1 nt
    ds_read_u16_d16_hi v16, v2 offset:2048
    ds_read_u16_d16_hi v17, v2 offset:2304
    ds_read_u16_d16_hi v18, v2 offset:2560
    ds_read_u16_d16_hi v19, v2 offset:2816
    ds_read_u16_d16_hi v20, v2 offset:5120
    ds_read_u16_d16_hi v21, v2 offset:5376
    ds_read_u16_d16_hi v22, v2 offset:5632
    ds_read_u16_d16_hi v23, v2 offset:5888
    ds_read_u16_d16_hi v24, v2 offset:8192
    ds_read_u16_d16_hi v25, v2 offset:8448
    ds_read_u16_d16_hi v26, v2 offset:8704
    ds_read_u16_d16_hi v27, v2 offset:8960
    ds_read_u16_d16_hi v32, v2 offset:2050
    ds_read_u16_d16_hi v33, v2 offset:2306
    ds_read_u16_d16_hi v34, v2 offset:2562
    ds_read_u16_d16_hi v35, v2 offset:2818
    ds_read_u16_d16_hi v36, v2 offset:5122
    ds_read_u16_d16_hi v37, v2 offset:5378
    ds_read_u16_d16_hi v38, v2 offset:5634
    ds_read_u16_d16_hi v39, v2 offset:5890
    ds_read_u16_d16_hi v40, v2 offset:8194
    ds_read_u16_d16_hi v41, v2 offset:8450
    ds_read_u16_d16_hi v42, v2 offset:8706
    ds_read_u16_d16_hi v43, v2 offset:8962
    s_waitcnt lgkmcnt(15)
    v_add_f32 v224, v224, v16
    v_add_f32 v225, v225, v17
    v_add_f32 v226, v226, v18
    v_add_f32 v227, v227, v19
    v_add_f32 v228, v228, v20
    v_add_f32 v229, v229, v21
    v_add_f32 v230, v230, v22
    v_add_f32 v231, v231, v23
    v_add_f32 v232, v232, v24
    s_waitcnt lgkmcnt(14)
    v_add_f32 v233, v233, v25
    s_waitcnt lgkmcnt(13)
    v_add_f32 v234, v234, v26
    s_waitcnt lgkmcnt(12)
    v_add_f32 v235, v235, v27
    s_waitcnt lgkmcnt(11)
    v_add_f32 v240, v240, v32
    s_waitcnt lgkmcnt(10)
    v_add_f32 v241, v241, v33
    s_waitcnt lgkmcnt(9)
    v_add_f32 v242, v242, v34
    s_waitcnt lgkmcnt(8)
    v_add_f32 v243, v243, v35
    s_waitcnt lgkmcnt(7)
    v_add_f32 v244, v244, v36
    s_waitcnt lgkmcnt(6)
    v_add_f32 v245, v245, v37
    s_waitcnt lgkmcnt(5)
    v_add_f32 v246, v246, v38
    s_waitcnt lgkmcnt(4)
    v_add_f32 v247, v247, v39
    s_waitcnt lgkmcnt(3)
    v_add_f32 v248, v248, v40
    s_waitcnt lgkmcnt(2)
    v_add_f32 v249, v249, v41
    s_waitcnt lgkmcnt(1)
    v_add_f32 v250, v250, v42
    s_waitcnt lgkmcnt(0)
    v_add_f32 v251, v251, v43
    v_cvt_pk_bf16_f32 v112, v224, v240
    v_cvt_pk_bf16_f32 v113, v225, v241
    v_cvt_pk_bf16_f32 v114, v226, v242
    v_cvt_pk_bf16_f32 v115, v227, v243
    v_cvt_pk_bf16_f32 v116, v228, v244
    v_cvt_pk_bf16_f32 v117, v229, v245
    v_cvt_pk_bf16_f32 v118, v230, v246
    v_cvt_pk_bf16_f32 v119, v231, v247
    v_cvt_pk_bf16_f32 v120, v232, v248
    v_cvt_pk_bf16_f32 v121, v233, v249
    v_cvt_pk_bf16_f32 v122, v234, v250
    v_cvt_pk_bf16_f32 v123, v235, v251
    buffer_store_dword v112, v12, s[32:35], s40 offen offset:384 sc1 nt
    buffer_store_dword v113, v12, s[32:35], s40 offen offset:896 sc1 nt
    buffer_store_dword v114, v12, s[32:35], s40 offen offset:1408 sc1 nt
    buffer_store_dword v115, v12, s[32:35], s40 offen offset:1920 sc1 nt
    buffer_store_dword v116, v12, s[32:35], s41 offen offset:384 sc1 nt
    buffer_store_dword v117, v12, s[32:35], s41 offen offset:896 sc1 nt
    buffer_store_dword v118, v12, s[32:35], s41 offen offset:1408 sc1 nt
    buffer_store_dword v119, v12, s[32:35], s41 offen offset:1920 sc1 nt
    buffer_store_dword v120, v12, s[32:35], s42 offen offset:384 sc1 nt
    buffer_store_dword v121, v12, s[32:35], s42 offen offset:896 sc1 nt
    buffer_store_dword v122, v12, s[32:35], s42 offen offset:1408 sc1 nt
    buffer_store_dword v123, v12, s[32:35], s42 offen offset:1920 sc1 nt
    s_cmp_le_u32 s45, 24
    s_cbranch_scc1 M_fin
    v_cvt_pk_bf16_f32 v76, v140, v156
    v_cvt_pk_bf16_f32 v77, v141, v157
    v_cvt_pk_bf16_f32 v78, v142, v158
    v_cvt_pk_bf16_f32 v79, v143, v159
    buffer_store_dword v76, v12, s[32:35], s43 offen offset:0 sc1 nt
    buffer_store_dword v77, v12, s[32:35], s43 offen offset:512 sc1 nt
    buffer_store_dword v78, v12, s[32:35], s43 offen offset:1024 sc1 nt
    buffer_store_dword v79, v12, s[32:35], s43 offen offset:1536 sc1 nt
    v_cvt_pk_bf16_f32 v92, v172, v188
    v_cvt_pk_bf16_f32 v93, v173, v189
    v_cvt_pk_bf16_f32 v94, v174, v190
    v_cvt_pk_bf16_f32 v95, v175, v191
    buffer_store_dword v92, v12, s[32:35], s43 offen offset:128 sc1 nt
    buffer_store_dword v93, v12, s[32:35], s43 offen offset:640 sc1 nt
    buffer_store_dword v94, v12, s[32:35], s43 offen offset:1152 sc1 nt
    buffer_store_dword v95, v12, s[32:35], s43 offen offset:1664 sc1 nt
    ds_read_u16_d16_hi v28, v2 offset:10240
    ds_read_u16_d16_hi v29, v2 offset:10496
    ds_read_u16_d16_hi v30, v2 offset:10752
    ds_read_u16_d16_hi v31, v2 offset:11008
    ds_read_u16_d16_hi v44, v2 offset:10242
    ds_read_u16_d16_hi v45, v2 offset:10498
    ds_read_u16_d16_hi v46, v2 offset:10754
    ds_read_u16_d16_hi v47, v2 offset:11010
    s_waitcnt lgkmcnt(7)
    v_add_f32 v204, v204, v28
    s_waitcnt lgkmcnt(6)
    v_add_f32 v205, v205, v29
    s_waitcnt lgkmcnt(5)
    v_add_f32 v206, v206, v30
    s_waitcnt lgkmcnt(4)
    v_add_f32 v207, v207, v31
    s_waitcnt lgkmcnt(3)
    v_add_f32 v220, v220, v44
    s_waitcnt lgkmcnt(2)
    v_add_f32 v221, v221, v45
    s_waitcnt lgkmcnt(1)
    v_add_f32 v222, v222, v46
    s_waitcnt lgkmcnt(0)
    v_add_f32 v223, v223, v47
    v_cvt_pk_bf16_f32 v108, v204, v220
    v_cvt_pk_bf16_f32 v109, v205, v221
    v_cvt_pk_bf16_f32 v110, v206, v222
    v_cvt_pk_bf16_f32 v111, v207, v223
    buffer_store_dword v108, v12, s[32:35], s43 offen offset:256 sc1 nt
    buffer_store_dword v109, v12, s[32:35], s43 offen offset:768 sc1 nt
    buffer_store_dword v110, v12, s[32:35], s43 offen offset:1280 sc1 nt
    buffer_store_dword v111, v12, s[32:35], s43 offen offset:1792 sc1 nt
    ds_read_u16_d16_hi v28, v2 offset:11264
    ds_read_u16_d16_hi v29, v2 offset:11520
    ds_read_u16_d16_hi v30, v2 offset:11776
    ds_read_u16_d16_hi v31, v2 offset:12032
    ds_read_u16_d16_hi v44, v2 offset:11266
    ds_read_u16_d16_hi v45, v2 offset:11522
    ds_read_u16_d16_hi v46, v2 offset:11778
    ds_read_u16_d16_hi v47, v2 offset:12034
    s_waitcnt lgkmcnt(7)
    v_add_f32 v236, v236, v28
    s_waitcnt lgkmcnt(6)
    v_add_f32 v237, v237, v29
    s_waitcnt lgkmcnt(5)
    v_add_f32 v238, v238, v30
    s_waitcnt lgkmcnt(4)
    v_add_f32 v239, v239, v31
    s_waitcnt lgkmcnt(3)
    v_add_f32 v252, v252, v44
    s_waitcnt lgkmcnt(2)
    v_add_f32 v253, v253, v45
    s_waitcnt lgkmcnt(1)
    v_add_f32 v254, v254, v46
    s_waitcnt lgkmcnt(0)
    v_add_f32 v255, v255, v47
    v_cvt_pk_bf16_f32 v124, v236, v252
    v_cvt_pk_bf16_f32 v125, v237, v253
    v_cvt_pk_bf16_f32 v126, v238, v254
    v_cvt_pk_bf16_f32 v127, v239, v255
    buffer_store_dword v124, v12, s[32:35], s43 offen offset:384 sc1 nt
    buffer_store_dword v125, v12, s[32:35], s43 offen offset:896 sc1 nt
    buffer_store_dword v126, v12, s[32:35], s43 offen offset:1408 sc1 nt
    buffer_store_dword v127, v12, s[32:35], s43 offen offset:1920 sc1 nt
M_fin:
K_end:
    s_endpgm
.section .rodata,"a"
.p2align 6
.amdhsa_kernel fused_kernel
  .amdhsa_next_free_vgpr 256
  .amdhsa_next_free_sgpr 102
  .amdhsa_accum_offset 256
  .amdhsa_group_segment_fixed_size 0
  .amdhsa_kernarg_size 88
  .amdhsa_user_sgpr_count 2
  .amdhsa_user_sgpr_kernarg_segment_ptr 1
  .amdhsa_system_sgpr_workgroup_id_x 1
  .amdhsa_float_denorm_mode_32 3
.end_amdhsa_kernel
```

```asm
; @launch kernel=fused_kernel grid=(250,1,1) block=(512,1,1) lds=163840
.amdgcn_target "amdgcn-amd-amdhsa--gfx950"
.text
.globl fused_kernel
.p2align 8
.type fused_kernel,@function
fused_kernel:
    s_cmp_ge_u32 s2, 250
    s_cbranch_scc1 K_end
    s_load_dwordx8 s[4:11], s[0:1], 0
    s_load_dwordx8 s[12:19], s[0:1], 32
    s_load_dwordx2 s[20:21], s[0:1], 64
    s_load_dwordx2 s[24:25], s[0:1], 80
    v_and_b32 v1, 63, v0
    v_lshrrev_b32 v119, 6, v0
    v_lshlrev_b32 v2, 4, v0
    v_readfirstlane_b32 s26, v119
    v_mov_b32 v20, 0xff000000
    v_mov_b32 v21, v20
    v_mov_b32 v22, v20
    v_mov_b32 v23, v20
    v_add_u32 v117, 131840, v2
    ds_write_b128 v117, v[20:23] offset:0
    ds_write_b128 v117, v[20:23] offset:8192
    ds_write_b128 v117, v[20:23] offset:16384
    v_cmp_gt_u32 vcc, 464, v0
    s_mov_b64 s[66:67], vcc
    s_mov_b64 exec, vcc
    ds_write_b128 v117, v[20:23] offset:24576
    s_mov_b64 exec, -1
    v_lshlrev_b32 v28, 2, v0
    v_mov_b32 v29, 0
    v_cmp_gt_u32 vcc, 256, v0
    s_and_saveexec_b64 s[60:61], vcc
    ds_write_b32 v28, v29 offset:8192
    s_mov_b64 exec, s[60:61]
    v_mov_b32 v30, 131076
    ds_write2_b32 v30, v29, v29 offset1:1
    s_mov_b32 s58, 0xffff0000
    v_lshlrev_b32 v3, 4, v1
    v_mov_b32 v116, 1
    v_lshrrev_b32 v119, 4, v1
    v_and_b32 v120, 15, v1
    v_lshlrev_b32 v121, 9, v120
    v_lshl_add_u32 v121, v119, 4, v121
    v_bfrev_b32 v118, 2
    s_cmp_eq_u32 s26, 4
    s_cselect_b32 s63, 8, 16
    s_cmp_gt_u32 s26, 4
    s_cselect_b32 s63, 0, s63
    v_cmp_gt_u32 vcc, s63, v120
    s_nop 1
    v_cndmask_b32 v36, v118, v121, vcc
    s_mul_i32 s62, s2, 200
    s_lshl_b32 s61, s26, 4
    s_add_u32 s62, s62, s61
    s_lshl_b32 s76, s62, 9
    s_add_u32 s77, s76, 65536
    s_mul_i32 s27, s2, 12800
    s_add_u32 s59, s27, 6400
    v_cmp_gt_u32 vcc, 400, v0
    s_mov_b64 s[56:57], vcc
    s_lshl_b32 s64, s26, 10
    s_add_u32 m0, s64, 0
    s_waitcnt lgkmcnt(0)
    s_barrier
    s_mov_b32 s48, s14
    s_mov_b32 s49, s15
    s_mov_b32 s50, 0x2000
    s_mov_b32 s51, 0x00020000
    s_cmp_eq_u32 s26, 7
    s_cbranch_scc1 P_w7
    s_mov_b32 s44, s10
    s_mov_b32 s45, s11
    s_mov_b32 s46, 0x30d400
    s_mov_b32 s47, 0x00020000
    s_mov_b32 s40, s8
    s_mov_b32 s41, s9
    s_mov_b32 s42, 0x30d400
    s_mov_b32 s43, 0x00020000
    s_mov_b32 s28, s4
    s_mov_b32 s29, s5
    s_mov_b32 s30, 0x186a000
    s_mov_b32 s31, 0x00020000
    buffer_load_dwordx4 v3, s[48:51], s64 offen lds
    s_mov_b64 exec, s[56:57]
    buffer_load_dwordx4 v[4:7], v2, s[44:47], s27 offen nt
    buffer_load_dwordx4 v[8:11], v2, s[44:47], s59 offen nt
    buffer_load_dwordx4 v[12:15], v2, s[40:43], s27 offen nt
    buffer_load_dwordx4 v[16:19], v2, s[40:43], s59 offen nt
    s_mov_b64 exec, -1
    buffer_load_dwordx4 v[20:23], v121, s[28:31], s76 offen offset:0
    buffer_load_dwordx4 v[24:27], v121, s[28:31], s76 offen offset:64
    buffer_load_dwordx4 v[28:31], v36, s[28:31], s77 offen offset:0
    buffer_load_dwordx4 v[32:35], v36, s[28:31], s77 offen offset:64
    s_mov_b32 s92, s6
    s_mov_b32 s93, s7
    s_mov_b32 s94, 0x493e0
    s_mov_b32 s95, 0x00020000
    s_mov_b32 s36, s24
    s_mov_b32 s37, s25
    s_mov_b32 s38, 0x241a800
    s_mov_b32 s39, 0x00020000
    s_add_u32 s72, s24, 0x1e00000
    s_addc_u32 s73, s25, 0
    s_mov_b32 s74, 0x61a800
    s_mov_b32 s75, 0x00020000
    s_mov_b32 s52, s16
    s_mov_b32 s53, s17
    s_mov_b32 s54, 0x6000
    s_mov_b32 s55, 0x00020000
    s_mov_b32 s96, s18
    s_mov_b32 s97, s19
    s_mov_b32 s98, 0x1800
    s_mov_b32 s99, 0x00020000
    s_mov_b32 s68, s12
    s_mov_b32 s69, s13
    s_mov_b32 s70, 0x20
    s_mov_b32 s71, 0x00020000
    s_mov_b32 s32, s20
    s_mov_b32 s33, s21
    s_mov_b32 s34, 0x186a000
    s_mov_b32 s35, 0x00020000
    v_bfe_u32 v122, v1, 2, 2
    v_lshl_add_u32 v122, v119, 3, v122
    v_lshlrev_b32 v122, 7, v122
    v_and_b32 v39, 3, v1
    v_lshl_add_u32 v122, v39, 3, v122
    s_mov_b32 s63, 0x147AE15
    s_movk_i32 s65, -200
    s_mov_b32 s60, 8192
    s_mov_b32 s61, 131840
    s_mov_b64 exec, s[56:57]
    s_waitcnt vmcnt(7)
    v_mul_hi_u32 v68, v4, s63
    v_lshl_add_u32 v84, v68, 2, s60
    ds_add_rtn_u32 v76, v84, v116
    v_mul_hi_u32 v69, v5, s63
    v_lshl_add_u32 v85, v69, 2, s60
    ds_add_rtn_u32 v77, v85, v116
    v_mul_hi_u32 v70, v6, s63
    v_lshl_add_u32 v86, v70, 2, s60
    ds_add_rtn_u32 v78, v86, v116
    v_mul_hi_u32 v71, v7, s63
    v_lshl_add_u32 v87, v71, 2, s60
    ds_add_rtn_u32 v79, v87, v116
    s_waitcnt vmcnt(6)
    v_mul_hi_u32 v72, v8, s63
    v_lshl_add_u32 v88, v72, 2, s60
    ds_add_rtn_u32 v80, v88, v116
    v_mul_hi_u32 v73, v9, s63
    v_lshl_add_u32 v89, v73, 2, s60
    ds_add_rtn_u32 v81, v89, v116
    v_mul_hi_u32 v74, v10, s63
    v_lshl_add_u32 v90, v74, 2, s60
    ds_add_rtn_u32 v82, v90, v116
    v_mul_hi_u32 v75, v11, s63
    v_lshl_add_u32 v91, v75, 2, s60
    ds_add_rtn_u32 v83, v91, v116
    v_mad_i32_i24 v4, v68, s65, v4
    v_lshlrev_b32 v4, 24, v4
    v_lshl_add_u32 v84, v68, 7, s61
    v_mad_i32_i24 v5, v69, s65, v5
    v_lshlrev_b32 v5, 24, v5
    v_lshl_add_u32 v85, v69, 7, s61
    v_mad_i32_i24 v6, v70, s65, v6
    v_lshlrev_b32 v6, 24, v6
    v_lshl_add_u32 v86, v70, 7, s61
    v_mad_i32_i24 v7, v71, s65, v7
    v_lshlrev_b32 v7, 24, v7
    v_lshl_add_u32 v87, v71, 7, s61
    v_mad_i32_i24 v8, v72, s65, v8
    v_lshlrev_b32 v8, 24, v8
    v_lshl_add_u32 v88, v72, 7, s61
    v_mad_i32_i24 v9, v73, s65, v9
    v_lshlrev_b32 v9, 24, v9
    v_lshl_add_u32 v89, v73, 7, s61
    v_mad_i32_i24 v10, v74, s65, v10
    v_lshlrev_b32 v10, 24, v10
    v_lshl_add_u32 v90, v74, 7, s61
    v_mad_i32_i24 v11, v75, s65, v11
    v_lshlrev_b32 v11, 24, v11
    v_lshl_add_u32 v91, v75, 7, s61
    s_waitcnt vmcnt(4)
    v_lshl_or_b32 v92, v12, 1, v4
    v_lshl_or_b32 v93, v13, 1, v5
    v_lshl_or_b32 v94, v14, 1, v6
    v_lshl_or_b32 v95, v15, 1, v7
    v_lshl_or_b32 v96, v16, 1, v8
    v_lshl_or_b32 v97, v17, 1, v9
    v_lshl_or_b32 v98, v18, 1, v10
    v_lshl_or_b32 v99, v19, 1, v11
    s_waitcnt lgkmcnt(0)
    v_max3_u32 v36, v76, v77, v78
    v_max3_u32 v37, v79, v80, v81
    v_max3_u32 v36, v36, v82, v83
    v_max_u32 v36, v36, v37
    v_lshl_add_u32 v12, v76, 2, v84
    v_lshl_add_u32 v13, v77, 2, v85
    v_lshl_add_u32 v14, v78, 2, v86
    v_lshl_add_u32 v15, v79, 2, v87
    v_lshl_add_u32 v16, v80, 2, v88
    v_lshl_add_u32 v17, v81, 2, v89
    v_lshl_add_u32 v18, v82, 2, v90
    v_lshl_add_u32 v19, v83, 2, v91
    v_cmp_lt_u32 vcc, 30, v36
    s_nop 4
    s_cbranch_vccnz P_rare
    ds_write_b32 v12, v92
    ds_write_b32 v13, v93
    ds_write_b32 v14, v94
    ds_write_b32 v15, v95
    ds_write_b32 v16, v96
    ds_write_b32 v17, v97
    ds_write_b32 v18, v98
    ds_write_b32 v19, v99
    s_mov_b64 exec, -1
    s_branch P_join
P_rare:
    v_mov_b32 v37, 131080
    v_mov_b32 v38, 131076
    s_mul_i32 s27, s2, 32768
    s_add_u32 s27, s27, 0x1100000
    s_lshl_b32 s59, s2, 15
    s_add_u32 s59, s59, 0x8fff84
    s_mov_b64 exec, s[56:57]
    v_cmp_gt_u32 vcc, 31, v76
    s_and_b64 exec, vcc, s[56:57]
    s_nop 3
    s_cbranch_execz P_r10
    ds_write_b32 v12, v92
P_r10:
    s_andn2_b64 exec, s[56:57], vcc
    s_cbranch_execz P_r30
    s_mov_b64 s[14:15], exec
    v_lshlrev_b32 v36, 1, v76
    v_add_u32 v36, 0xfeffffc4, v36
    ds_max_u32 v84, v36 offset:124
    v_cmp_gt_u32 vcc, 63, v76
    s_and_b64 exec, vcc, s[14:15]
    s_nop 3
    s_cbranch_execz P_r20
    v_lshlrev_b32 v124, 7, v68
    v_lshl_add_u32 v124, v76, 2, v124
    buffer_store_dword v92, v124, s[36:39], s59 offen sc1
    s_nop 0
P_r20:
    s_andn2_b64 exec, s[14:15], vcc
    s_cbranch_execz P_r30
    ds_write_b32 v38, v116
    ds_add_rtn_u32 v124, v37, v116
    v_mov_b32 v126, v92
    v_mov_b32 v127, v68
    s_waitcnt lgkmcnt(0)
    v_lshlrev_b32 v124, 3, v124
    buffer_store_dwordx2 v[126:127], v124, s[36:39], s27 offen sc1
    s_nop 0
P_r30:
    s_mov_b64 exec, s[56:57]
    v_cmp_gt_u32 vcc, 31, v77
    s_and_b64 exec, vcc, s[56:57]
    s_nop 3
    s_cbranch_execz P_r11
    ds_write_b32 v13, v93
P_r11:
    s_andn2_b64 exec, s[56:57], vcc
    s_cbranch_execz P_r31
    s_mov_b64 s[14:15], exec
    v_lshlrev_b32 v36, 1, v77
    v_add_u32 v36, 0xfeffffc4, v36
    ds_max_u32 v85, v36 offset:124
    v_cmp_gt_u32 vcc, 63, v77
    s_and_b64 exec, vcc, s[14:15]
    s_nop 3
    s_cbranch_execz P_r21
    v_lshlrev_b32 v124, 7, v69
    v_lshl_add_u32 v124, v77, 2, v124
    buffer_store_dword v93, v124, s[36:39], s59 offen sc1
    s_nop 0
P_r21:
    s_andn2_b64 exec, s[14:15], vcc
    s_cbranch_execz P_r31
    ds_write_b32 v38, v116
    ds_add_rtn_u32 v124, v37, v116
    v_mov_b32 v126, v93
    v_mov_b32 v127, v69
    s_waitcnt lgkmcnt(0)
    v_lshlrev_b32 v124, 3, v124
    buffer_store_dwordx2 v[126:127], v124, s[36:39], s27 offen sc1
    s_nop 0
P_r31:
    s_mov_b64 exec, s[56:57]
    v_cmp_gt_u32 vcc, 31, v78
    s_and_b64 exec, vcc, s[56:57]
    s_nop 3
    s_cbranch_execz P_r12
    ds_write_b32 v14, v94
P_r12:
    s_andn2_b64 exec, s[56:57], vcc
    s_cbranch_execz P_r32
    s_mov_b64 s[14:15], exec
    v_lshlrev_b32 v36, 1, v78
    v_add_u32 v36, 0xfeffffc4, v36
    ds_max_u32 v86, v36 offset:124
    v_cmp_gt_u32 vcc, 63, v78
    s_and_b64 exec, vcc, s[14:15]
    s_nop 3
    s_cbranch_execz P_r22
    v_lshlrev_b32 v124, 7, v70
    v_lshl_add_u32 v124, v78, 2, v124
    buffer_store_dword v94, v124, s[36:39], s59 offen sc1
    s_nop 0
P_r22:
    s_andn2_b64 exec, s[14:15], vcc
    s_cbranch_execz P_r32
    ds_write_b32 v38, v116
    ds_add_rtn_u32 v124, v37, v116
    v_mov_b32 v126, v94
    v_mov_b32 v127, v70
    s_waitcnt lgkmcnt(0)
    v_lshlrev_b32 v124, 3, v124
    buffer_store_dwordx2 v[126:127], v124, s[36:39], s27 offen sc1
    s_nop 0
P_r32:
    s_mov_b64 exec, s[56:57]
    v_cmp_gt_u32 vcc, 31, v79
    s_and_b64 exec, vcc, s[56:57]
    s_nop 3
    s_cbranch_execz P_r13
    ds_write_b32 v15, v95
P_r13:
    s_andn2_b64 exec, s[56:57], vcc
    s_cbranch_execz P_r33
    s_mov_b64 s[14:15], exec
    v_lshlrev_b32 v36, 1, v79
    v_add_u32 v36, 0xfeffffc4, v36
    ds_max_u32 v87, v36 offset:124
    v_cmp_gt_u32 vcc, 63, v79
    s_and_b64 exec, vcc, s[14:15]
    s_nop 3
    s_cbranch_execz P_r23
    v_lshlrev_b32 v124, 7, v71
    v_lshl_add_u32 v124, v79, 2, v124
    buffer_store_dword v95, v124, s[36:39], s59 offen sc1
    s_nop 0
P_r23:
    s_andn2_b64 exec, s[14:15], vcc
    s_cbranch_execz P_r33
    ds_write_b32 v38, v116
    ds_add_rtn_u32 v124, v37, v116
    v_mov_b32 v126, v95
    v_mov_b32 v127, v71
    s_waitcnt lgkmcnt(0)
    v_lshlrev_b32 v124, 3, v124
    buffer_store_dwordx2 v[126:127], v124, s[36:39], s27 offen sc1
    s_nop 0
P_r33:
    s_mov_b64 exec, s[56:57]
    v_cmp_gt_u32 vcc, 31, v80
    s_and_b64 exec, vcc, s[56:57]
    s_nop 3
    s_cbranch_execz P_r14
    ds_write_b32 v16, v96
P_r14:
    s_andn2_b64 exec, s[56:57], vcc
    s_cbranch_execz P_r34
    s_mov_b64 s[14:15], exec
    v_lshlrev_b32 v36, 1, v80
    v_add_u32 v36, 0xfeffffc4, v36
    ds_max_u32 v88, v36 offset:124
    v_cmp_gt_u32 vcc, 63, v80
    s_and_b64 exec, vcc, s[14:15]
    s_nop 3
    s_cbranch_execz P_r24
    v_lshlrev_b32 v124, 7, v72
    v_lshl_add_u32 v124, v80, 2, v124
    buffer_store_dword v96, v124, s[36:39], s59 offen sc1
    s_nop 0
P_r24:
    s_andn2_b64 exec, s[14:15], vcc
    s_cbranch_execz P_r34
    ds_write_b32 v38, v116
    ds_add_rtn_u32 v124, v37, v116
    v_mov_b32 v126, v96
    v_mov_b32 v127, v72
    s_waitcnt lgkmcnt(0)
    v_lshlrev_b32 v124, 3, v124
    buffer_store_dwordx2 v[126:127], v124, s[36:39], s27 offen sc1
    s_nop 0
P_r34:
    s_mov_b64 exec, s[56:57]
    v_cmp_gt_u32 vcc, 31, v81
    s_and_b64 exec, vcc, s[56:57]
    s_nop 3
    s_cbranch_execz P_r15
    ds_write_b32 v17, v97
P_r15:
    s_andn2_b64 exec, s[56:57], vcc
    s_cbranch_execz P_r35
    s_mov_b64 s[14:15], exec
    v_lshlrev_b32 v36, 1, v81
    v_add_u32 v36, 0xfeffffc4, v36
    ds_max_u32 v89, v36 offset:124
    v_cmp_gt_u32 vcc, 63, v81
    s_and_b64 exec, vcc, s[14:15]
    s_nop 3
    s_cbranch_execz P_r25
    v_lshlrev_b32 v124, 7, v73
    v_lshl_add_u32 v124, v81, 2, v124
    buffer_store_dword v97, v124, s[36:39], s59 offen sc1
    s_nop 0
P_r25:
    s_andn2_b64 exec, s[14:15], vcc
    s_cbranch_execz P_r35
    ds_write_b32 v38, v116
    ds_add_rtn_u32 v124, v37, v116
    v_mov_b32 v126, v97
    v_mov_b32 v127, v73
    s_waitcnt lgkmcnt(0)
    v_lshlrev_b32 v124, 3, v124
    buffer_store_dwordx2 v[126:127], v124, s[36:39], s27 offen sc1
    s_nop 0
P_r35:
    s_mov_b64 exec, s[56:57]
    v_cmp_gt_u32 vcc, 31, v82
    s_and_b64 exec, vcc, s[56:57]
    s_nop 3
    s_cbranch_execz P_r16
    ds_write_b32 v18, v98
P_r16:
    s_andn2_b64 exec, s[56:57], vcc
    s_cbranch_execz P_r36
    s_mov_b64 s[14:15], exec
    v_lshlrev_b32 v36, 1, v82
    v_add_u32 v36, 0xfeffffc4, v36
    ds_max_u32 v90, v36 offset:124
    v_cmp_gt_u32 vcc, 63, v82
    s_and_b64 exec, vcc, s[14:15]
    s_nop 3
    s_cbranch_execz P_r26
    v_lshlrev_b32 v124, 7, v74
    v_lshl_add_u32 v124, v82, 2, v124
    buffer_store_dword v98, v124, s[36:39], s59 offen sc1
    s_nop 0
P_r26:
    s_andn2_b64 exec, s[14:15], vcc
    s_cbranch_execz P_r36
    ds_write_b32 v38, v116
    ds_add_rtn_u32 v124, v37, v116
    v_mov_b32 v126, v98
    v_mov_b32 v127, v74
    s_waitcnt lgkmcnt(0)
    v_lshlrev_b32 v124, 3, v124
    buffer_store_dwordx2 v[126:127], v124, s[36:39], s27 offen sc1
    s_nop 0
P_r36:
    s_mov_b64 exec, s[56:57]
    v_cmp_gt_u32 vcc, 31, v83
    s_and_b64 exec, vcc, s[56:57]
    s_nop 3
    s_cbranch_execz P_r17
    ds_write_b32 v19, v99
P_r17:
    s_andn2_b64 exec, s[56:57], vcc
    s_cbranch_execz P_r37
    s_mov_b64 s[14:15], exec
    v_lshlrev_b32 v36, 1, v83
    v_add_u32 v36, 0xfeffffc4, v36
    ds_max_u32 v91, v36 offset:124
    v_cmp_gt_u32 vcc, 63, v83
    s_and_b64 exec, vcc, s[14:15]
    s_nop 3
    s_cbranch_execz P_r27
    v_lshlrev_b32 v124, 7, v75
    v_lshl_add_u32 v124, v83, 2, v124
    buffer_store_dword v99, v124, s[36:39], s59 offen sc1
    s_nop 0
P_r27:
    s_andn2_b64 exec, s[14:15], vcc
    s_cbranch_execz P_r37
    ds_write_b32 v38, v116
    ds_add_rtn_u32 v124, v37, v116
    v_mov_b32 v126, v99
    v_mov_b32 v127, v75
    s_waitcnt lgkmcnt(0)
    v_lshlrev_b32 v124, 3, v124
    buffer_store_dwordx2 v[126:127], v124, s[36:39], s27 offen sc1
    s_nop 0
P_r37:
    s_mov_b64 exec, -1
    s_waitcnt vmcnt(0)
    s_branch P_join
P_w7:
    s_mov_b32 s27, 0x830000
    s_mov_b32 s92, s6
    s_mov_b32 s93, s7
    s_mov_b32 s94, 0x493e0
    s_mov_b32 s95, 0x00020000
    s_mul_i32 s65, s2, 1536
    v_mul_u32_u24 v38, 24, v1
    s_cmp_ge_u32 s2, 196
    s_cselect_b32 s65, 0x40000000, s65
    buffer_load_dwordx3 v[4:6], v38, s[92:95], s65 offen
    buffer_load_dwordx3 v[8:10], v38, s[92:95], s65 offen offset:12
    buffer_load_dwordx4 v3, s[48:51], s64 offen lds
    s_load_dword s22, s[24:25], s27
    s_mov_b32 s28, s4
    s_mov_b32 s29, s5
    s_mov_b32 s30, 0x186a000
    s_mov_b32 s31, 0x00020000
    s_mov_b32 s92, s6
    s_mov_b32 s93, s7
    s_mov_b32 s94, 0x493e0
    s_mov_b32 s95, 0x00020000
    s_mov_b32 s36, s24
    s_mov_b32 s37, s25
    s_mov_b32 s38, 0x241a800
    s_mov_b32 s39, 0x00020000
    s_add_u32 s72, s24, 0x1e00000
    s_addc_u32 s73, s25, 0
    s_mov_b32 s74, 0x61a800
    s_mov_b32 s75, 0x00020000
    s_mov_b32 s52, s16
    s_mov_b32 s53, s17
    s_mov_b32 s54, 0x6000
    s_mov_b32 s55, 0x00020000
    s_mov_b32 s96, s18
    s_mov_b32 s97, s19
    s_mov_b32 s98, 0x1800
    s_mov_b32 s99, 0x00020000
    s_mov_b32 s68, s12
    s_mov_b32 s69, s13
    s_mov_b32 s70, 0x20
    s_mov_b32 s71, 0x00020000
    s_mov_b32 s32, s20
    s_mov_b32 s33, s21
    s_mov_b32 s34, 0x186a000
    s_mov_b32 s35, 0x00020000
    v_bfe_u32 v122, v1, 2, 2
    v_lshl_add_u32 v122, v119, 3, v122
    v_lshlrev_b32 v122, 7, v122
    v_and_b32 v39, 3, v1
    v_lshl_add_u32 v122, v39, 3, v122
    s_cmp_ge_u32 s2, 196
    s_nop 0
    s_cbranch_scc1 P_w7n
    s_mov_b32 s60, 0x41800000
    s_movk_i32 s65, 0xf8
    s_waitcnt vmcnt(1)
    v_lshlrev_b32 v68, 16, v4
    v_and_b32 v69, s58, v4
    v_lshlrev_b32 v70, 16, v5
    v_and_b32 v71, s58, v5
    v_lshlrev_b32 v72, 16, v6
    v_and_b32 v73, s58, v6
    v_lshlrev_b32 v74, 16, v8
    v_and_b32 v75, s58, v8
    v_lshlrev_b32 v76, 16, v9
    v_and_b32 v77, s58, v9
    v_lshlrev_b32 v78, 16, v10
    v_and_b32 v79, s58, v10
    v_mul_f32 v68, s60, v68
    v_mul_f32 v69, s60, v69
    v_mul_f32 v70, s60, v70
    v_mul_f32 v71, s60, v71
    v_mul_f32 v72, s60, v72
    v_mul_f32 v73, s60, v73
    v_mul_f32 v74, s60, v74
    v_mul_f32 v75, s60, v75
    v_mul_f32 v76, s60, v76
    v_mul_f32 v77, s60, v77
    v_mul_f32 v78, s60, v78
    v_mul_f32 v79, s60, v79
    v_cvt_flr_i32_f32 v68, v68
    v_cvt_flr_i32_f32 v69, v69
    v_cvt_flr_i32_f32 v70, v70
    v_cvt_flr_i32_f32 v71, v71
    v_cvt_flr_i32_f32 v72, v72
    v_cvt_flr_i32_f32 v73, v73
    v_cvt_flr_i32_f32 v74, v74
    v_cvt_flr_i32_f32 v75, v75
    v_cvt_flr_i32_f32 v76, v76
    v_cvt_flr_i32_f32 v77, v77
    v_cvt_flr_i32_f32 v78, v78
    v_cvt_flr_i32_f32 v79, v79
    v_bfe_u32 v84, v70, 5, 3
    v_bfe_u32 v85, v70, 2, 3
    v_and_or_b32 v68, v68, s65, v84
    v_and_or_b32 v69, v69, s65, v85
    v_lshl_or_b32 v68, v69, 8, v68
    v_bfe_u32 v84, v73, 5, 3
    v_bfe_u32 v85, v73, 2, 3
    v_and_or_b32 v71, v71, s65, v84
    v_and_or_b32 v72, v72, s65, v85
    v_lshl_or_b32 v71, v72, 8, v71
    v_bfe_u32 v84, v76, 5, 3
    v_bfe_u32 v85, v76, 2, 3
    v_and_or_b32 v74, v74, s65, v84
    v_and_or_b32 v75, v75, s65, v85
    v_lshl_or_b32 v74, v75, 8, v74
    v_bfe_u32 v84, v79, 5, 3
    v_bfe_u32 v85, v79, 2, 3
    v_and_or_b32 v77, v77, s65, v84
    v_and_or_b32 v78, v78, s65, v85
    v_lshl_or_b32 v77, v78, 8, v77
    v_lshl_or_b32 v86, v71, 16, v68
    v_lshl_or_b32 v87, v77, 16, v74
    v_lshlrev_b32 v38, 3, v1
    s_lshl_b32 s27, s2, 9
    s_add_u32 s27, s27, 0x810000
    buffer_store_dwordx2 v[86:87], v38, s[36:39], s27 offen sc1
P_w7n:
    buffer_load_dwordx4 v[20:23], v121, s[28:31], s76 offen offset:0
    buffer_load_dwordx4 v[24:27], v121, s[28:31], s76 offen offset:64
    s_waitcnt vmcnt(2) lgkmcnt(0)
    s_add_u32 s22, s22, 1
    v_mov_b32 v38, s22
    v_mov_b32 v39, 131072
    ds_write_b32 v39, v38
    s_cmp_ge_u32 s2, 196
    s_cbranch_scc1 P_join
    s_lshl_b32 s27, s2, 2
    s_add_u32 s27, s27, 0x830100
    v_mov_b32 v39, 0
    s_mov_b64 exec, 1
    buffer_store_dword v38, v39, s[36:39], s27 offen sc1
    s_mov_b64 exec, -1
P_join:
    s_lshl_b32 s23, s2, 15
    v_mov_b32 v4, 131072
    s_waitcnt lgkmcnt(0)
    s_barrier
    ds_read_b64 v[4:5], v4
    ds_read_b128 v[100:103], v117 offset:0
    ds_read_b128 v[104:107], v117 offset:8192
    ds_read_b128 v[108:111], v117 offset:16384
    ds_read_b128 v[112:115], v117 offset:24576
    s_waitcnt lgkmcnt(4)
    v_readfirstlane_b32 s18, v4
    v_readfirstlane_b32 s19, v5
    s_bfe_u32 s8, s18, 0x70001
    s_lshl_b32 s8, s8, 17
    s_bfe_u32 s27, s18, 0x10000
    s_or_b32 s8, s8, s27
    s_bfe_u32 s9, s18, 0x70009
    s_lshl_b32 s9, s9, 17
    s_bfe_u32 s27, s18, 0x10008
    s_or_b32 s9, s9, s27
    s_bfe_u32 s10, s18, 0x70011
    s_lshl_b32 s10, s10, 17
    s_bfe_u32 s27, s18, 0x10010
    s_or_b32 s10, s10, s27
    s_bfe_u32 s11, s18, 0x70019
    s_lshl_b32 s11, s11, 17
    s_bfe_u32 s27, s18, 0x10018
    s_or_b32 s11, s11, s27
    s_cmp_eq_u32 s19, 0
    s_cbranch_scc1 P_noovf
    v_mov_b32 v4, 131080
    ds_read_b32 v4, v4
    v_mov_b32 v5, 0
    s_add_u32 s27, s23, 32124
    s_waitcnt lgkmcnt(0)
    buffer_store_dword v4, v5, s[36:39], s27 offen sc1
    s_waitcnt vmcnt(0)
    s_barrier
P_noovf:
    s_waitcnt lgkmcnt(3)
    v_xor_b32 v100, s8, v100
    v_xor_b32 v101, s9, v101
    v_xor_b32 v102, s10, v102
    v_xor_b32 v103, s11, v103
    buffer_store_dwordx4 v[100:103], v2, s[36:39], s23 offen sc1
    s_waitcnt lgkmcnt(2)
    v_xor_b32 v104, s8, v104
    v_xor_b32 v105, s9, v105
    v_xor_b32 v106, s10, v106
    v_xor_b32 v107, s11, v107
    s_add_u32 s59, s23, 8192
    buffer_store_dwordx4 v[104:107], v2, s[36:39], s59 offen sc1
    s_waitcnt lgkmcnt(1)
    v_xor_b32 v108, s8, v108
    v_xor_b32 v109, s9, v109
    v_xor_b32 v110, s10, v110
    v_xor_b32 v111, s11, v111
    s_add_u32 s59, s23, 16384
    buffer_store_dwordx4 v[108:111], v2, s[36:39], s59 offen sc1
    s_waitcnt lgkmcnt(0)
    v_xor_b32 v112, s8, v112
    v_xor_b32 v113, s9, v113
    v_xor_b32 v114, s10, v114
    v_xor_b32 v115, s11, v115
    s_mov_b64 exec, s[66:67]
    s_add_u32 s59, s23, 24576
    buffer_store_dwordx4 v[112:115], v2, s[36:39], s59 offen sc1
    s_mov_b64 exec, -1
    ds_read_b64_tr_b16 v[36:37], v122 offset:0
    ds_read_b64_tr_b16 v[38:39], v122 offset:512
    ds_read_b64_tr_b16 v[40:41], v122 offset:4096
    ds_read_b64_tr_b16 v[42:43], v122 offset:4608
    ds_read_b64_tr_b16 v[44:45], v122 offset:32
    ds_read_b64_tr_b16 v[46:47], v122 offset:544
    ds_read_b64_tr_b16 v[48:49], v122 offset:4128
    ds_read_b64_tr_b16 v[50:51], v122 offset:4640
    ds_read_b64_tr_b16 v[52:53], v122 offset:64
    ds_read_b64_tr_b16 v[54:55], v122 offset:576
    ds_read_b64_tr_b16 v[56:57], v122 offset:4160
    ds_read_b64_tr_b16 v[58:59], v122 offset:4672
    ds_read_b64_tr_b16 v[60:61], v122 offset:96
    ds_read_b64_tr_b16 v[62:63], v122 offset:608
    ds_read_b64_tr_b16 v[64:65], v122 offset:4192
    ds_read_b64_tr_b16 v[66:67], v122 offset:4704
    v_lshrrev_b32 v124, 5, v1
    v_and_b32 v125, 31, v1
    v_mul_u32_u24 v124, 3072, v124
    v_lshl_add_u32 v124, v125, 2, v124
    s_lshr_b32 s60, s26, 2
    s_and_b32 s61, s26, 3
    s_mul_i32 s63, s61, 768
    s_lshl_b32 s65, s60, 7
    s_add_u32 s63, s63, s65
    s_add_u32 s65, s63, 0
    buffer_load_dword v128, v124, s[52:55], s65 offen
    s_add_u32 s65, s63, 6144
    buffer_load_dword v129, v124, s[52:55], s65 offen
    s_add_u32 s65, s63, 12288
    buffer_load_dword v130, v124, s[52:55], s65 offen
    s_add_u32 s65, s63, 18432
    buffer_load_dword v131, v124, s[52:55], s65 offen
    s_add_u32 s65, s63, 384
    buffer_load_dword v132, v124, s[52:55], s65 offen
    s_add_u32 s65, s63, 6528
    buffer_load_dword v133, v124, s[52:55], s65 offen
    s_add_u32 s65, s63, 12672
    buffer_load_dword v134, v124, s[52:55], s65 offen
    s_add_u32 s65, s63, 18816
    buffer_load_dword v135, v124, s[52:55], s65 offen
    s_cmp_ge_u32 s26, 4
    s_cbranch_scc1 P_e2b
    s_add_u32 s27, s26, 8
    s_lshr_b32 s60, s27, 2
    s_and_b32 s61, s27, 3
    s_mul_i32 s63, s61, 768
    s_lshl_b32 s65, s60, 7
    s_add_u32 s63, s63, s65
    s_add_u32 s65, s63, 0
    buffer_load_dword v136, v124, s[52:55], s65 offen
    s_add_u32 s65, s63, 6144
    buffer_load_dword v137, v124, s[52:55], s65 offen
    s_add_u32 s65, s63, 12288
    buffer_load_dword v138, v124, s[52:55], s65 offen
    s_add_u32 s65, s63, 18432
    buffer_load_dword v139, v124, s[52:55], s65 offen
    s_add_u32 s65, s63, 384
    buffer_load_dword v140, v124, s[52:55], s65 offen
    s_add_u32 s65, s63, 6528
    buffer_load_dword v141, v124, s[52:55], s65 offen
    s_add_u32 s65, s63, 12672
    buffer_load_dword v142, v124, s[52:55], s65 offen
    s_add_u32 s65, s63, 18816
    buffer_load_dword v143, v124, s[52:55], s65 offen
    s_branch P_e3b
P_e2b:
    s_sub_u32 s60, s26, 4
    s_lshl_b32 s63, s60, 7
    s_cmp_eq_u32 s26, 7
    s_cselect_b32 s63, 0x40000000, s63
    buffer_load_dword v136, v124, s[96:99], s63 offen offset:0
    buffer_load_dword v137, v124, s[96:99], s63 offen offset:384
    buffer_load_dword v138, v124, s[96:99], s63 offen offset:768
    buffer_load_dword v139, v124, s[96:99], s63 offen offset:1152
    buffer_load_dword v140, v124, s[96:99], s63 offen offset:1536
    buffer_load_dword v141, v124, s[96:99], s63 offen offset:1920
    buffer_load_dword v142, v124, s[96:99], s63 offen offset:2304
    buffer_load_dword v143, v124, s[96:99], s63 offen offset:2688
P_e3b:
    v_mul_u32_u24 v124, 6, v0
    v_and_b32 v124, -4, v124
    v_cmp_gt_u32 vcc, 200, v0
    s_nop 1
    v_cndmask_b32 v124, v118, v124, vcc
    s_mul_i32 s27, s2, 1200
    buffer_load_dwordx2 v[144:145], v124, s[92:95], s27 offen
    v_lshlrev_b32 v124, 1, v1
    buffer_load_ushort v146, v124, s[68:71], 0 offen
    v_lshlrev_b32 v250, 7, v0
    v_cmp_gt_u32 vcc, 320, v0
    s_nop 1
    v_cndmask_b32 v250, v118, v250, vcc
    s_mul_i32 s65, s2, 102400
    buffer_load_dword v158, v250, s[28:31], s65 offen
    v_mov_b32 v5, 0xbfb8aa3b
    v_mov_b32 v6, 1.0
    v_lshlrev_b32 v123, 9, v119
    v_lshl_add_u32 v123, v120, 3, v123
    s_lshl_b32 s27, s62, 7
    s_waitcnt lgkmcnt(0)
    s_barrier
    s_waitcnt vmcnt(23)
    s_cmp_gt_u32 s26, 4
    s_cbranch_scc0 P_np
    s_setprio 2
P_np:
    v_mfma_f32_16x16x32_bf16 v[68:71], v[20:23], v[36:39], 0
    v_mfma_f32_16x16x32_bf16 v[72:75], v[20:23], v[44:47], 0
    v_mfma_f32_16x16x32_bf16 v[76:79], v[20:23], v[52:55], 0
    v_mfma_f32_16x16x32_bf16 v[80:83], v[20:23], v[60:63], 0
    v_mfma_f32_16x16x32_bf16 v[68:71], v[24:27], v[40:43], v[68:71]
    v_mfma_f32_16x16x32_bf16 v[72:75], v[24:27], v[48:51], v[72:75]
    v_mfma_f32_16x16x32_bf16 v[76:79], v[24:27], v[56:59], v[76:79]
    v_mfma_f32_16x16x32_bf16 v[80:83], v[24:27], v[64:67], v[80:83]
    s_nop 4
    v_cvt_pk_bf16_f32 v68, 0, v68
    v_cvt_pk_bf16_f32 v69, 0, v69
    v_cvt_pk_bf16_f32 v70, 0, v70
    v_cvt_pk_bf16_f32 v71, 0, v71
    v_cvt_pk_bf16_f32 v72, 0, v72
    v_cvt_pk_bf16_f32 v73, 0, v73
    v_cvt_pk_bf16_f32 v74, 0, v74
    v_cvt_pk_bf16_f32 v75, 0, v75
    v_cvt_pk_bf16_f32 v76, 0, v76
    v_cvt_pk_bf16_f32 v77, 0, v77
    v_cvt_pk_bf16_f32 v78, 0, v78
    v_cvt_pk_bf16_f32 v79, 0, v79
    v_cvt_pk_bf16_f32 v80, 0, v80
    v_cvt_pk_bf16_f32 v81, 0, v81
    v_cvt_pk_bf16_f32 v82, 0, v82
    v_cvt_pk_bf16_f32 v83, 0, v83
    v_mul_f32 v84, v5, v68
    v_mul_f32 v85, v5, v69
    v_mul_f32 v86, v5, v70
    v_mul_f32 v87, v5, v71
    v_mul_f32 v88, v5, v72
    v_mul_f32 v89, v5, v73
    v_mul_f32 v90, v5, v74
    v_mul_f32 v91, v5, v75
    v_mul_f32 v92, v5, v76
    v_mul_f32 v93, v5, v77
    v_mul_f32 v94, v5, v78
    v_mul_f32 v95, v5, v79
    v_mul_f32 v96, v5, v80
    v_mul_f32 v97, v5, v81
    v_mul_f32 v98, v5, v82
    v_mul_f32 v99, v5, v83
    v_exp_f32 v84, v84
    v_exp_f32 v85, v85
    v_exp_f32 v86, v86
    v_exp_f32 v87, v87
    v_exp_f32 v88, v88
    v_exp_f32 v89, v89
    v_exp_f32 v90, v90
    v_exp_f32 v91, v91
    v_exp_f32 v92, v92
    v_exp_f32 v93, v93
    v_exp_f32 v94, v94
    v_exp_f32 v95, v95
    v_exp_f32 v96, v96
    v_exp_f32 v97, v97
    v_exp_f32 v98, v98
    v_exp_f32 v99, v99
    v_add_f32 v84, v6, v84
    v_add_f32 v85, v6, v85
    v_add_f32 v86, v6, v86
    v_add_f32 v87, v6, v87
    v_add_f32 v88, v6, v88
    v_add_f32 v89, v6, v89
    v_add_f32 v90, v6, v90
    v_add_f32 v91, v6, v91
    v_add_f32 v92, v6, v92
    v_add_f32 v93, v6, v93
    v_add_f32 v94, v6, v94
    v_add_f32 v95, v6, v95
    v_add_f32 v96, v6, v96
    v_add_f32 v97, v6, v97
    v_add_f32 v98, v6, v98
    v_add_f32 v99, v6, v99
    v_rcp_f32 v84, v84
    v_rcp_f32 v85, v85
    v_rcp_f32 v86, v86
    v_rcp_f32 v87, v87
    v_rcp_f32 v88, v88
    v_rcp_f32 v89, v89
    v_rcp_f32 v90, v90
    v_rcp_f32 v91, v91
    v_rcp_f32 v92, v92
    v_rcp_f32 v93, v93
    v_rcp_f32 v94, v94
    v_rcp_f32 v95, v95
    v_rcp_f32 v96, v96
    v_rcp_f32 v97, v97
    v_rcp_f32 v98, v98
    v_rcp_f32 v99, v99
    v_mul_f32 v84, v68, v84
    v_mul_f32 v85, v69, v85
    v_mul_f32 v86, v70, v86
    v_mul_f32 v87, v71, v87
    v_mul_f32 v88, v72, v88
    v_mul_f32 v89, v73, v89
    v_mul_f32 v90, v74, v90
    v_mul_f32 v91, v75, v91
    v_mul_f32 v92, v76, v92
    v_mul_f32 v93, v77, v93
    v_mul_f32 v94, v78, v94
    v_mul_f32 v95, v79, v95
    v_mul_f32 v96, v80, v96
    v_mul_f32 v97, v81, v97
    v_mul_f32 v98, v82, v98
    v_mul_f32 v99, v83, v99
    s_mov_b32 s63, 0x830100
    s_cmp_gt_u32 s26, 4
    s_cselect_b32 s63, s63, 0x40000000
    buffer_load_dwordx4 v[236:239], v3, s[36:39], s63 offen sc1
    v_cvt_pk_bf16_f32 v68, v84, v88
    v_cvt_pk_bf16_f32 v69, v92, v96
    buffer_store_dwordx2 v[68:69], v123, s[72:75], s27 offen offset:0 sc1
    v_cvt_pk_bf16_f32 v70, v85, v89
    v_cvt_pk_bf16_f32 v71, v93, v97
    buffer_store_dwordx2 v[70:71], v123, s[72:75], s27 offen offset:128 sc1
    v_cvt_pk_bf16_f32 v72, v86, v90
    v_cvt_pk_bf16_f32 v73, v94, v98
    buffer_store_dwordx2 v[72:73], v123, s[72:75], s27 offen offset:256 sc1
    v_cvt_pk_bf16_f32 v74, v87, v91
    v_cvt_pk_bf16_f32 v75, v95, v99
    buffer_store_dwordx2 v[74:75], v123, s[72:75], s27 offen offset:384 sc1
    s_cmp_gt_u32 s26, 4
    s_cbranch_scc1 P_h2
    s_cmp_eq_u32 s26, 4
    s_cselect_b32 s63, 2, 4
    v_cmp_gt_u32 vcc, s63, v119
    s_nop 1
    v_cndmask_b32 v7, v118, v123, vcc
    s_add_u32 s27, s27, 16384
    v_mfma_f32_16x16x32_bf16 v[68:71], v[28:31], v[36:39], 0
    v_mfma_f32_16x16x32_bf16 v[72:75], v[28:31], v[44:47], 0
    v_mfma_f32_16x16x32_bf16 v[76:79], v[28:31], v[52:55], 0
    v_mfma_f32_16x16x32_bf16 v[80:83], v[28:31], v[60:63], 0
    v_mfma_f32_16x16x32_bf16 v[68:71], v[32:35], v[40:43], v[68:71]
    v_mfma_f32_16x16x32_bf16 v[72:75], v[32:35], v[48:51], v[72:75]
    v_mfma_f32_16x16x32_bf16 v[76:79], v[32:35], v[56:59], v[76:79]
    v_mfma_f32_16x16x32_bf16 v[80:83], v[32:35], v[64:67], v[80:83]
    s_nop 4
    v_cvt_pk_bf16_f32 v68, 0, v68
    v_cvt_pk_bf16_f32 v69, 0, v69
    v_cvt_pk_bf16_f32 v70, 0, v70
    v_cvt_pk_bf16_f32 v71, 0, v71
    v_cvt_pk_bf16_f32 v72, 0, v72
    v_cvt_pk_bf16_f32 v73, 0, v73
    v_cvt_pk_bf16_f32 v74, 0, v74
    v_cvt_pk_bf16_f32 v75, 0, v75
    v_cvt_pk_bf16_f32 v76, 0, v76
    v_cvt_pk_bf16_f32 v77, 0, v77
    v_cvt_pk_bf16_f32 v78, 0, v78
    v_cvt_pk_bf16_f32 v79, 0, v79
    v_cvt_pk_bf16_f32 v80, 0, v80
    v_cvt_pk_bf16_f32 v81, 0, v81
    v_cvt_pk_bf16_f32 v82, 0, v82
    v_cvt_pk_bf16_f32 v83, 0, v83
    v_mul_f32 v84, v5, v68
    v_mul_f32 v85, v5, v69
    v_mul_f32 v86, v5, v70
    v_mul_f32 v87, v5, v71
    v_mul_f32 v88, v5, v72
    v_mul_f32 v89, v5, v73
    v_mul_f32 v90, v5, v74
    v_mul_f32 v91, v5, v75
    v_mul_f32 v92, v5, v76
    v_mul_f32 v93, v5, v77
    v_mul_f32 v94, v5, v78
    v_mul_f32 v95, v5, v79
    v_mul_f32 v96, v5, v80
    v_mul_f32 v97, v5, v81
    v_mul_f32 v98, v5, v82
    v_mul_f32 v99, v5, v83
    v_exp_f32 v84, v84
    v_exp_f32 v85, v85
    v_exp_f32 v86, v86
    v_exp_f32 v87, v87
    v_exp_f32 v88, v88
    v_exp_f32 v89, v89
    v_exp_f32 v90, v90
    v_exp_f32 v91, v91
    v_exp_f32 v92, v92
    v_exp_f32 v93, v93
    v_exp_f32 v94, v94
    v_exp_f32 v95, v95
    v_exp_f32 v96, v96
    v_exp_f32 v97, v97
    v_exp_f32 v98, v98
    v_exp_f32 v99, v99
    v_add_f32 v84, v6, v84
    v_add_f32 v85, v6, v85
    v_add_f32 v86, v6, v86
    v_add_f32 v87, v6, v87
    v_add_f32 v88, v6, v88
    v_add_f32 v89, v6, v89
    v_add_f32 v90, v6, v90
    v_add_f32 v91, v6, v91
    v_add_f32 v92, v6, v92
    v_add_f32 v93, v6, v93
    v_add_f32 v94, v6, v94
    v_add_f32 v95, v6, v95
    v_add_f32 v96, v6, v96
    v_add_f32 v97, v6, v97
    v_add_f32 v98, v6, v98
    v_add_f32 v99, v6, v99
    v_rcp_f32 v84, v84
    v_rcp_f32 v85, v85
    v_rcp_f32 v86, v86
    v_rcp_f32 v87, v87
    v_rcp_f32 v88, v88
    v_rcp_f32 v89, v89
    v_rcp_f32 v90, v90
    v_rcp_f32 v91, v91
    v_rcp_f32 v92, v92
    v_rcp_f32 v93, v93
    v_rcp_f32 v94, v94
    v_rcp_f32 v95, v95
    v_rcp_f32 v96, v96
    v_rcp_f32 v97, v97
    v_rcp_f32 v98, v98
    v_rcp_f32 v99, v99
    v_mul_f32 v84, v68, v84
    v_mul_f32 v85, v69, v85
    v_mul_f32 v86, v70, v86
    v_mul_f32 v87, v71, v87
    v_mul_f32 v88, v72, v88
    v_mul_f32 v89, v73, v89
    v_mul_f32 v90, v74, v90
    v_mul_f32 v91, v75, v91
    v_mul_f32 v92, v76, v92
    v_mul_f32 v93, v77, v93
    v_mul_f32 v94, v78, v94
    v_mul_f32 v95, v79, v95
    v_mul_f32 v96, v80, v96
    v_mul_f32 v97, v81, v97
    v_mul_f32 v98, v82, v98
    v_mul_f32 v99, v83, v99
    v_cvt_pk_bf16_f32 v68, v84, v88
    v_cvt_pk_bf16_f32 v69, v92, v96
    buffer_store_dwordx2 v[68:69], v7, s[72:75], s27 offen offset:0 sc1
    v_cvt_pk_bf16_f32 v70, v85, v89
    v_cvt_pk_bf16_f32 v71, v93, v97
    buffer_store_dwordx2 v[70:71], v7, s[72:75], s27 offen offset:128 sc1
    v_cvt_pk_bf16_f32 v72, v86, v90
    v_cvt_pk_bf16_f32 v73, v94, v98
    buffer_store_dwordx2 v[72:73], v7, s[72:75], s27 offen offset:256 sc1
    v_cvt_pk_bf16_f32 v74, v87, v91
    v_cvt_pk_bf16_f32 v75, v95, v99
    buffer_store_dwordx2 v[74:75], v7, s[72:75], s27 offen offset:384 sc1
    s_nop 0
P_h2:
    s_mov_b32 s56, 0x05040100
    s_mov_b32 s57, 0x07060302
    s_cmp_gt_u32 s26, 4
    s_cbranch_scc1 M_e4
    s_waitcnt vmcnt(10)
    s_branch M_e5
M_e4:
    s_waitcnt vmcnt(4)
    v_lshlrev_b32 v150, 4, v1
    v_cmp_gt_u32 vcc, 49, v1
    s_mov_b64 s[60:61], vcc
    s_mov_b32 s63, 0x830100
    s_mov_b32 s65, 0
    s_nop 1
    s_branch M_pb
M_pa:
    buffer_load_dwordx4 v[236:239], v150, s[36:39], s63 offen sc1
    s_waitcnt vmcnt(0)
M_pb:
    v_xor_b32 v236, s18, v236
    v_xor_b32 v237, s18, v237
    v_xor_b32 v238, s18, v238
    v_xor_b32 v239, s18, v239
    v_or3_b32 v236, v236, v237, v238
    v_or_b32 v236, v236, v239
    v_cmp_ne_u32 vcc, 0, v236
    s_and_b64 vcc, vcc, s[60:61]
    s_cbranch_vccz M_pad
    s_sleep 2
    s_add_u32 s65, s65, 1
    s_cmp_lt_u32 s65, 16384
    s_cbranch_scc1 M_pa
M_pad:
    s_sub_u32 s27, s26, 5
    s_lshl_b32 s27, s27, 10
    s_add_u32 s63, s27, 0x810000
    s_add_u32 s27, s27, 30720
    s_mov_b32 m0, s27
    s_nop 0
    buffer_load_dwordx4 v3, s[36:39], s63 offen sc1 lds
    s_add_u32 s27, s27, 3072
    s_add_u32 s63, s63, 3072
    s_mov_b32 m0, s27
    s_nop 0
    buffer_load_dwordx4 v3, s[36:39], s63 offen sc1 lds
    s_add_u32 s27, s27, 3072
    s_add_u32 s63, s63, 3072
    s_mov_b32 m0, s27
    s_nop 0
    buffer_load_dwordx4 v3, s[36:39], s63 offen sc1 lds
    s_add_u32 s27, s27, 3072
    s_add_u32 s63, s63, 3072
    s_mov_b32 m0, s27
    s_nop 0
    buffer_load_dwordx4 v3, s[36:39], s63 offen sc1 lds
    s_add_u32 s27, s27, 3072
    s_add_u32 s63, s63, 3072
    s_mov_b32 m0, s27
    s_nop 0
    buffer_load_dwordx4 v3, s[36:39], s63 offen sc1 lds
    s_add_u32 s27, s27, 3072
    s_add_u32 s63, s63, 3072
    s_mov_b32 m0, s27
    s_nop 0
    buffer_load_dwordx4 v3, s[36:39], s63 offen sc1 lds
    s_add_u32 s27, s27, 3072
    s_add_u32 s63, s63, 3072
    s_mov_b32 m0, s27
    s_nop 0
    buffer_load_dwordx4 v3, s[36:39], s63 offen sc1 lds
    s_add_u32 s27, s27, 3072
    s_add_u32 s63, s63, 3072
    s_mov_b32 m0, s27
    s_nop 0
    buffer_load_dwordx4 v3, s[36:39], s63 offen sc1 lds
    s_add_u32 s27, s27, 3072
    s_add_u32 s63, s63, 3072
    s_mov_b32 m0, s27
    s_nop 0
    buffer_load_dwordx4 v3, s[36:39], s63 offen sc1 lds
    s_add_u32 s27, s27, 3072
    s_add_u32 s63, s63, 3072
    s_mov_b32 m0, s27
    s_nop 0
    buffer_load_dwordx4 v3, s[36:39], s63 offen sc1 lds
    s_add_u32 s27, s27, 3072
    s_add_u32 s63, s63, 3072
    s_mov_b32 m0, s27
    s_nop 0
    buffer_load_dwordx4 v3, s[36:39], s63 offen sc1 lds
    s_add_u32 s27, s27, 3072
    s_add_u32 s63, s63, 3072
    s_mov_b32 m0, s27
    s_nop 0
    buffer_load_dwordx4 v3, s[36:39], s63 offen sc1 lds
    s_add_u32 s27, s27, 3072
    s_add_u32 s63, s63, 3072
    s_mov_b32 m0, s27
    s_nop 0
    buffer_load_dwordx4 v3, s[36:39], s63 offen sc1 lds
    s_add_u32 s27, s27, 3072
    s_add_u32 s63, s63, 3072
    s_mov_b32 m0, s27
    s_nop 0
    buffer_load_dwordx4 v3, s[36:39], s63 offen sc1 lds
    s_add_u32 s27, s27, 3072
    s_add_u32 s63, s63, 3072
    s_mov_b32 m0, s27
    s_nop 0
    buffer_load_dwordx4 v3, s[36:39], s63 offen sc1 lds
    s_add_u32 s27, s27, 3072
    s_add_u32 s63, s63, 3072
    s_mov_b32 m0, s27
    s_nop 0
    buffer_load_dwordx4 v3, s[36:39], s63 offen sc1 lds
    s_add_u32 s27, s27, 3072
    s_add_u32 s63, s63, 3072
    s_mov_b32 m0, s27
    s_nop 0
    buffer_load_dwordx4 v3, s[36:39], s63 offen sc1 lds
    s_add_u32 s27, s27, 3072
    s_add_u32 s63, s63, 3072
    s_mov_b32 m0, s27
    s_nop 0
    buffer_load_dwordx4 v3, s[36:39], s63 offen sc1 lds
    s_add_u32 s27, s27, 3072
    s_add_u32 s63, s63, 3072
    s_mov_b32 m0, s27
    s_nop 0
    buffer_load_dwordx4 v3, s[36:39], s63 offen sc1 lds
    s_add_u32 s27, s27, 3072
    s_add_u32 s63, s63, 3072
    s_mov_b32 m0, s27
    s_nop 0
    buffer_load_dwordx4 v3, s[36:39], s63 offen sc1 lds
    s_add_u32 s27, s27, 3072
    s_add_u32 s63, s63, 3072
    s_mov_b32 m0, s27
    s_nop 0
    buffer_load_dwordx4 v3, s[36:39], s63 offen sc1 lds
    s_add_u32 s27, s27, 3072
    s_add_u32 s63, s63, 3072
    s_mov_b32 m0, s27
    s_nop 0
    buffer_load_dwordx4 v3, s[36:39], s63 offen sc1 lds
    s_add_u32 s27, s27, 3072
    s_add_u32 s63, s63, 3072
    s_mov_b32 m0, s27
    s_nop 0
    buffer_load_dwordx4 v3, s[36:39], s63 offen sc1 lds
    s_add_u32 s27, s27, 3072
    s_add_u32 s63, s63, 3072
    s_mov_b32 m0, s27
    s_nop 0
    buffer_load_dwordx4 v3, s[36:39], s63 offen sc1 lds
    s_add_u32 s27, s27, 3072
    s_add_u32 s63, s63, 3072
    s_mov_b32 m0, s27
    s_nop 0
    buffer_load_dwordx4 v3, s[36:39], s63 offen sc1 lds
    s_add_u32 s27, s27, 3072
    s_add_u32 s63, s63, 3072
    s_mov_b32 m0, s27
    s_nop 0
    buffer_load_dwordx4 v3, s[36:39], s63 offen sc1 lds
    s_add_u32 s27, s27, 3072
    s_add_u32 s63, s63, 3072
    s_mov_b32 m0, s27
    s_nop 0
    buffer_load_dwordx4 v3, s[36:39], s63 offen sc1 lds
    s_add_u32 s27, s27, 3072
    s_add_u32 s63, s63, 3072
    s_mov_b32 m0, s27
    s_nop 0
    buffer_load_dwordx4 v3, s[36:39], s63 offen sc1 lds
    s_add_u32 s27, s27, 3072
    s_add_u32 s63, s63, 3072
    s_mov_b32 m0, s27
    s_nop 0
    buffer_load_dwordx4 v3, s[36:39], s63 offen sc1 lds
    s_add_u32 s27, s27, 3072
    s_add_u32 s63, s63, 3072
    s_mov_b32 m0, s27
    s_nop 0
    buffer_load_dwordx4 v3, s[36:39], s63 offen sc1 lds
    s_add_u32 s27, s27, 3072
    s_add_u32 s63, s63, 3072
    s_mov_b32 m0, s27
    s_nop 0
    buffer_load_dwordx4 v3, s[36:39], s63 offen sc1 lds
    s_add_u32 s27, s27, 3072
    s_add_u32 s63, s63, 3072
    s_mov_b32 m0, s27
    s_nop 0
    buffer_load_dwordx4 v3, s[36:39], s63 offen sc1 lds
    s_add_u32 s27, s27, 3072
    s_add_u32 s63, s63, 3072
    s_cmp_eq_u32 s26, 7
    s_cbranch_scc1 M_tfd
    s_mov_b32 m0, s27
    s_nop 0
    buffer_load_dwordx4 v3, s[36:39], s63 offen sc1 lds
M_tfd:
    s_setprio 0
M_e5:
    s_lshr_b32 s60, s26, 2
    s_and_b32 s61, s26, 3
    s_lshl_b32 s60, s60, 3
    s_add_u32 s60, s60, s61
    s_lshl_b32 s60, s60, 10
    s_movk_i32 s61, 4096
    v_perm_b32 v148, v129, v128, s56
    v_perm_b32 v152, v129, v128, s57
    v_perm_b32 v149, v131, v130, s56
    v_perm_b32 v153, v131, v130, s57
    v_perm_b32 v150, v133, v132, s56
    v_perm_b32 v154, v133, v132, s57
    v_perm_b32 v151, v135, v134, s56
    v_perm_b32 v155, v135, v134, s57
    v_add_u32 v156, s60, v3
    v_add_u32 v157, s61, v156
    ds_write_b128 v156, v[148:151]
    ds_write_b128 v157, v[152:155]
    s_cmp_eq_u32 s26, 7
    s_cbranch_scc1 M_w2
    s_add_u32 s27, s26, 8
    s_lshr_b32 s60, s27, 2
    s_and_b32 s61, s27, 3
    s_lshl_b32 s60, s60, 3
    s_add_u32 s60, s60, s61
    s_lshl_b32 s60, s60, 10
    s_movk_i32 s61, 4096
    s_cmp_lt_u32 s26, 4
    s_cbranch_scc1 M_w1
    s_sub_u32 s60, s26, 4
    s_lshl_b32 s60, s60, 11
    s_add_u32 s60, s60, 24576
    s_movk_i32 s61, 1024
M_w1:
    v_perm_b32 v148, v137, v136, s56
    v_perm_b32 v152, v137, v136, s57
    v_perm_b32 v149, v139, v138, s56
    v_perm_b32 v153, v139, v138, s57
    v_perm_b32 v150, v141, v140, s56
    v_perm_b32 v154, v141, v140, s57
    v_perm_b32 v151, v143, v142, s56
    v_perm_b32 v155, v143, v142, s57
    v_add_u32 v156, s60, v3
    v_add_u32 v157, s61, v156
    ds_write_b128 v156, v[148:151]
    ds_write_b128 v157, v[152:155]
M_w2:
    s_cmp_ge_u32 s26, 4
    s_cbranch_scc1 M_t4
    v_bfe_i32 v148, v0, 0, 1
    v_mov_b32 v149, 0x01000c0c
    s_mov_b32 s63, 0x02020000
    v_and_or_b32 v148, v148, s63, v149
    v_add_u32 v149, s63, v148
    v_add_u32 v150, s63, v149
    v_perm_b32 v152, v145, v144, v148
    v_perm_b32 v153, v145, v144, v149
    v_perm_b32 v154, v145, v144, v150
    s_mov_b32 s60, 0x41800000
    v_mul_f32 v148, s60, v152
    v_mul_f32 v149, s60, v153
    v_mul_f32 v150, s60, v154
    v_cvt_flr_i32_f32 v148, v148
    v_cvt_flr_i32_f32 v149, v149
    v_cvt_flr_i32_f32 v150, v150
    v_sub_u32 v148, 4, v148
    v_sub_u32 v149, 4, v149
    v_sub_u32 v150, 2, v150
    v_and_b32 v148, 0xff, v148
    v_and_b32 v149, 0xff, v149
    v_and_b32 v150, 0xff, v150
    v_lshl_or_b32 v148, v149, 8, v148
    v_lshl_or_b32 v148, v150, 16, v148
    v_mov_b32 v149, 0x7f000000
    v_cmp_gt_u32 vcc, 200, v0
    s_nop 1
    v_cndmask_b32 v148, v149, v148, vcc
    v_lshlrev_b32 v150, 2, v0
    v_add_u32 v150, 133120, v150
    ds_write_b32 v150, v148
    v_lshlrev_b32 v150, 4, v0
    v_add_u32 v150, 135168, v150
    s_mov_b64 exec, vcc
    ds_write_b96 v150, v[152:154]
    s_mov_b64 exec, -1
    s_branch M_t8
M_t4:
    s_cmp_eq_u32 s26, 4
    s_cbranch_scc0 M_t5
    v_lshlrev_b32 v150, 2, v1
    v_add_u32 v151, 132864, v150
    v_mov_b32 v148, 0
    ds_write_b32 v151, v148
    v_mov_b32 v151, 132672
    ds_write_b32 v151, v148
    v_add_u32 v151, 132608, v150
    v_lshlrev_b32 v148, 16, v146
    s_mov_b64 exec, 0xffff
    ds_write_b32 v151, v148
    s_mov_b64 exec, -1
    s_branch M_t8
M_t5:
M_t8:
    v_lshrrev_b32 v24, 2, v1
    v_lshlrev_b32 v24, 15, v24
    v_and_b32 v25, 3, v1
    v_lshl_add_u32 v24, v25, 4, v24
    s_lshl_b32 s27, s26, 20
    s_lshl_b32 s53, s2, 7
    s_add_u32 s27, s27, s53
    s_add_u32 s53, s27, 524288
    s_mov_b64 s[60:61], -1
    s_cmp_eq_u32 s26, 7
    s_cselect_b32 s61, 0xff, s61
    s_xor_b32 s63, s8, 0xff000000
    v_mov_b32 v164, s63
    v_mov_b32 v172, s63
    s_xor_b32 s63, s9, 0xff000000
    v_mov_b32 v165, s63
    v_mov_b32 v173, s63
    s_xor_b32 s63, s10, 0xff000000
    v_mov_b32 v166, s63
    v_mov_b32 v174, s63
    s_xor_b32 s63, s11, 0xff000000
    v_mov_b32 v167, s63
    v_mov_b32 v175, s63
    buffer_load_dwordx4 v[160:163], v24, s[36:39], s27 offen sc1
    s_mov_b64 exec, s[60:61]
    buffer_load_dwordx4 v[164:167], v24, s[36:39], s53 offen sc1
    s_mov_b64 exec, -1
    buffer_load_dwordx4 v[168:171], v24, s[36:39], s27 offen offset:64 sc1
    s_mov_b64 exec, s[60:61]
    buffer_load_dwordx4 v[172:175], v24, s[36:39], s53 offen offset:64 sc1
    s_mov_b64 exec, -1
    v_lshlrev_b32 v1, 4, v1
    v_lshrrev_b32 v8, 4, v1
    v_lshrrev_b32 v10, 5, v8
    v_and_b32 v11, 31, v8
    s_mov_b32 s6, 0x186a000
    s_mov_b32 s7, 0x00020000
    s_mul_i32 s44, s2, 102400
    s_mul_i32 s51, s26, 12800
    s_add_u32 s51, s51, 30720
    s_mul_i32 s52, s26, 3840
    s_add_u32 s52, s52, 133120
    s_mov_b32 s67, 120320
    s_mov_b32 s3, 132864
    v_lshrrev_b32 v8, 4, v1
    v_lshrrev_b32 v10, 5, v8
    v_and_b32 v11, 31, v8
    v_lshlrev_b32 v3, 4, v11
    v_add_u32 v3, s52, v3
    v_mul_u32_u24 v0, 56, v10
    v_add_u32 v0, s52, v0
    v_lshrrev_b32 v13, 3, v11
    v_lshl_add_u32 v4, v13, 3, v0
    v_lshrrev_b32 v13, 3, v8
    v_and_b32 v14, 1, v13
    v_lshrrev_b32 v13, 1, v13
    v_lshl_add_u32 v13, v14, 2, v13
    v_lshlrev_b32 v5, 4, v13
    v_add_u32 v5, s52, v5
    v_add_u32 v16, s52, v1
    v_lshrrev_b32 v17, 2, v8
    v_mul_u32_u24 v17, 56, v17
    v_and_b32 v13, 3, v8
    v_lshl_add_u32 v17, v13, 1, v17
    v_add_u32 v17, s52, v17
    v_lshlrev_b32 v2, 7, v10
    v_lshl_add_u32 v2, v11, 2, v2
    v_add_u32 v2, s51, v2
    v_and_b32 v13, 7, v11
    v_lshlrev_b32 v13, 1, v13
    v_sub_u32 v13, 14, v13
    v_lshl_or_b32 v6, v13, 16, v13
    v_lshlrev_b32 v7, 5, v10
    v_add_u32 v7, 132608, v7
    v_lshlrev_b32 v20, 2, v8
    v_add_u32 v30, 132864, v20
    v_mov_b32 v9, 132672
    v_mov_b32 v18, 0xfc
    v_mov_b32 v19, 1
    v_mov_b32 v192, 0
    v_mov_b32 v193, 0
    v_mov_b32 v194, 0
    v_mov_b32 v195, 0
    v_mov_b32 v196, 0
    v_mov_b32 v197, 0
    v_mov_b32 v198, 0
    v_mov_b32 v199, 0
    v_mov_b32 v200, 0
    v_mov_b32 v201, 0
    v_mov_b32 v202, 0
    v_mov_b32 v203, 0
    v_mov_b32 v204, 0
    v_mov_b32 v205, 0
    v_mov_b32 v206, 0
    v_mov_b32 v207, 0
    v_mov_b32 v208, 0
    v_mov_b32 v209, 0
    v_mov_b32 v210, 0
    v_mov_b32 v211, 0
    v_mov_b32 v212, 0
    v_mov_b32 v213, 0
    v_mov_b32 v214, 0
    v_mov_b32 v215, 0
    v_mov_b32 v216, 0
    v_mov_b32 v217, 0
    v_mov_b32 v218, 0
    v_mov_b32 v219, 0
    v_mov_b32 v220, 0
    v_mov_b32 v221, 0
    v_mov_b32 v222, 0
    v_mov_b32 v223, 0
    v_mov_b32 v224, 0
    v_mov_b32 v225, 0
    v_mov_b32 v226, 0
    v_mov_b32 v227, 0
    v_mov_b32 v228, 0
    v_mov_b32 v229, 0
    v_mov_b32 v230, 0
    v_mov_b32 v231, 0
    v_mov_b32 v232, 0
    v_mov_b32 v233, 0
    v_mov_b32 v234, 0
    v_mov_b32 v235, 0
    v_mov_b32 v236, 0
    v_mov_b32 v237, 0
    v_mov_b32 v238, 0
    v_mov_b32 v239, 0
    v_mov_b32 v240, 0
    v_mov_b32 v241, 0
    v_mov_b32 v242, 0
    v_mov_b32 v243, 0
    v_mov_b32 v244, 0
    v_mov_b32 v245, 0
    v_mov_b32 v246, 0
    v_mov_b32 v247, 0
    v_mov_b32 v248, 0
    v_mov_b32 v249, 0
    v_mov_b32 v250, 0
    v_mov_b32 v251, 0
    v_mov_b32 v252, 0
    v_mov_b32 v253, 0
    v_mov_b32 v254, 0
    v_mov_b32 v255, 0
    s_mov_b32 s12, 0x1fffe
    s_movk_i32 s13, 130
    s_mov_b32 s14, 0xfc0000
    s_movk_i32 s15, 7800
    s_lshl_b32 s17, s26, 10
    s_add_u32 s17, s17, 138368
    s_mov_b32 s16, s17
    v_add_u32 v26, 134144, v20
    v_add_u32 v27, 134144, v1
    s_mov_b32 s62, 0xfe0001
    s_mov_b32 s65, 0
M_cw:
    s_waitcnt vmcnt(0)
    v_xor_b32 v176, s8, v160
    v_xor_b32 v177, s9, v161
    v_xor_b32 v178, s10, v162
    v_xor_b32 v179, s11, v163
    v_xor_b32 v180, s8, v164
    v_xor_b32 v181, s9, v165
    v_xor_b32 v182, s10, v166
    v_xor_b32 v183, s11, v167
    v_xor_b32 v184, s8, v168
    v_xor_b32 v185, s9, v169
    v_xor_b32 v186, s10, v170
    v_xor_b32 v187, s11, v171
    v_xor_b32 v188, s8, v172
    v_xor_b32 v189, s9, v173
    v_xor_b32 v190, s10, v174
    v_xor_b32 v191, s11, v175
    v_or3_b32 v148, v176, v177, v178
    v_or3_b32 v148, v148, v179, v180
    v_or3_b32 v148, v148, v181, v182
    v_or3_b32 v148, v148, v183, v184
    v_or3_b32 v148, v148, v185, v186
    v_or3_b32 v148, v148, v187, v188
    v_or3_b32 v148, v148, v189, v190
    v_or_b32 v148, v148, v191
    v_and_b32 v148, s62, v148
    v_cmp_ne_u32 vcc, 0, v148
    s_nop 4
    s_cbranch_vccz M_cok
    s_add_u32 s65, s65, 1
    s_cmp_lt_u32 s65, 16384
    s_cbranch_scc0 M_cok
    s_sleep 4
    buffer_load_dwordx4 v[160:163], v24, s[36:39], s27 offen sc1
    s_mov_b64 exec, s[60:61]
    buffer_load_dwordx4 v[164:167], v24, s[36:39], s53 offen sc1
    s_mov_b64 exec, -1
    buffer_load_dwordx4 v[168:171], v24, s[36:39], s27 offen offset:64 sc1
    s_mov_b64 exec, s[60:61]
    buffer_load_dwordx4 v[172:175], v24, s[36:39], s53 offen offset:64 sc1
    s_mov_b64 exec, -1
    s_branch M_cw
M_cok:
    s_waitcnt lgkmcnt(0)
    s_barrier
    s_cmp_eq_u32 s26, 5
    s_cbranch_scc0 M_f1
    s_lshl_b32 s27, s2, 2
    s_add_u32 s27, s27, 0x830800
    v_mov_b32 v148, s18
    v_mov_b32 v149, 0
    s_mov_b64 exec, 1
    buffer_store_dword v148, v149, s[36:39], s27 offen sc1
    s_mov_b64 exec, -1
M_f1:
    s_mov_b32 s27, s26
    v_mov_b32 v159, s27
    v_lshl_add_u32 v159, v159, 6, v8
    v_cmp_gt_u32 vcc, 240, v159
    v_lshlrev_b32 v159, 7, v159
    v_bfrev_b32 v157, 2
    v_cndmask_b32 v159, v157, v159, vcc
    s_add_u32 s27, s44, 40960
    buffer_load_dword v158, v159, s[28:31], s27 offen
    v_and_b32 v64, s12, v176
    v_alignbit_b32 v65, s13, v176, 22
    ds_read_u16 v64, v64 offset:30720
    ds_read_b32 v65, v65
    v_and_b32 v66, s12, v177
    v_alignbit_b32 v67, s13, v177, 22
    ds_read_u16 v66, v66 offset:30720
    ds_read_b32 v67, v67
    v_and_b32 v68, s12, v178
    v_alignbit_b32 v69, s13, v178, 22
    ds_read_u16 v68, v68 offset:30720
    ds_read_b32 v69, v69
    v_and_b32 v70, s12, v179
    v_alignbit_b32 v71, s13, v179, 22
    ds_read_u16 v70, v70 offset:30720
    ds_read_b32 v71, v71
    v_and_b32 v72, s12, v180
    v_alignbit_b32 v73, s13, v180, 22
    ds_read_u16 v72, v72 offset:30720
    ds_read_b32 v73, v73
    v_and_b32 v74, s12, v181
    v_alignbit_b32 v75, s13, v181, 22
    ds_read_u16 v74, v74 offset:30720
    ds_read_b32 v75, v75
    v_and_b32 v76, s12, v182
    v_alignbit_b32 v77, s13, v182, 22
    ds_read_u16 v76, v76 offset:30720
    ds_read_b32 v77, v77
    v_and_b32 v78, s12, v183
    v_alignbit_b32 v79, s13, v183, 22
    ds_read_u16 v78, v78 offset:30720
    ds_read_b32 v79, v79
    s_mov_b32 s63, 0xc8000000
    s_lshl_b32 s59, s26, 11
    s_add_u32 s59, s59, 146560
    s_mov_b32 s60, s59
    v_cmp_gt_u32 s[54:55], s63, v184
    s_nop 1
    v_mbcnt_lo_u32_b32 v148, s54, 0
    v_mbcnt_hi_u32_b32 v148, s55, v148
    v_lshl_add_u32 v148, v148, 4, s60
    s_bcnt1_i32_b64 s27, s[54:55]
    s_lshl4_add_u32 s60, s27, s60
    v_cndmask_b32 v148, v27, v148, s[54:55]
    ds_write_b128 v148, v[184:187]
    v_cmp_gt_u32 s[54:55], s63, v188
    s_nop 1
    v_mbcnt_lo_u32_b32 v148, s54, 0
    v_mbcnt_hi_u32_b32 v148, s55, v148
    v_lshl_add_u32 v148, v148, 4, s60
    s_bcnt1_i32_b64 s27, s[54:55]
    s_lshl4_add_u32 s60, s27, s60
    v_cndmask_b32 v148, v27, v148, s[54:55]
    ds_write_b128 v148, v[188:191]
    s_mov_b32 s63, 0xff000000
    v_cmp_lt_u32 s[68:69], s63, v187
    v_cmp_lt_u32 s[70:71], s63, v191
    s_waitcnt lgkmcnt(10)
    v_and_b32 v96, 0x0707, v64
    v_and_b32 v97, 0x0707, v66
    v_and_b32 v98, 0x0707, v68
    v_and_b32 v99, 0x0707, v70
    v_and_b32 v64, 0xf8f8, v64
    v_and_b32 v66, 0xf8f8, v66
    v_and_b32 v68, 0xf8f8, v68
    v_and_b32 v70, 0xf8f8, v70
    v_mul_u32_u24 v96, 0x200400, v96
    v_mul_u32_u24 v97, 0x200400, v97
    v_mul_u32_u24 v98, 0x200400, v98
    v_mul_u32_u24 v99, 0x200400, v99
    v_and_or_b32 v64, v96, s14, v64
    v_and_or_b32 v66, v97, s14, v66
    v_and_or_b32 v68, v98, s14, v68
    v_and_or_b32 v70, v99, s14, v70
    v_add_u32 v64, v64, v65
    v_add_u32 v66, v66, v67
    v_add_u32 v68, v68, v69
    v_add_u32 v70, v70, v71
    v_dot4_i32_i8 v64, v64, v64, 0
    v_dot4_i32_i8 v66, v66, v66, 0
    v_dot4_i32_i8 v68, v68, v68, 0
    v_dot4_i32_i8 v70, v70, v70, 0
    v_cmp_gt_i32 s[40:41], s15, v64
    v_cmp_gt_i32 s[42:43], s15, v66
    v_cmp_gt_i32 s[46:47], s15, v68
    v_cmp_gt_i32 s[54:55], s15, v70
    v_mbcnt_lo_u32_b32 v96, s40, 0
    v_mbcnt_lo_u32_b32 v97, s42, 0
    v_mbcnt_lo_u32_b32 v98, s46, 0
    v_mbcnt_lo_u32_b32 v99, s54, 0
    v_mbcnt_hi_u32_b32 v96, s41, v96
    v_mbcnt_hi_u32_b32 v97, s43, v97
    v_mbcnt_hi_u32_b32 v98, s47, v98
    v_mbcnt_hi_u32_b32 v99, s55, v99
    v_lshl_add_u32 v96, v96, 2, s16
    s_bcnt1_i32_b64 s27, s[40:41]
    s_lshl2_add_u32 s16, s27, s16
    v_lshl_add_u32 v97, v97, 2, s16
    s_bcnt1_i32_b64 s27, s[42:43]
    s_lshl2_add_u32 s16, s27, s16
    v_lshl_add_u32 v98, v98, 2, s16
    s_bcnt1_i32_b64 s27, s[46:47]
    s_lshl2_add_u32 s16, s27, s16
    v_lshl_add_u32 v99, v99, 2, s16
    s_bcnt1_i32_b64 s27, s[54:55]
    s_lshl2_add_u32 s16, s27, s16
    v_cndmask_b32 v96, v26, v96, s[40:41]
    ds_write_b32 v96, v176
    v_cndmask_b32 v97, v26, v97, s[42:43]
    ds_write_b32 v97, v177
    v_cndmask_b32 v98, v26, v98, s[46:47]
    ds_write_b32 v98, v178
    v_cndmask_b32 v99, v26, v99, s[54:55]
    ds_write_b32 v99, v179
    s_waitcnt lgkmcnt(6)
    v_and_b32 v100, 0x0707, v72
    v_and_b32 v101, 0x0707, v74
    v_and_b32 v102, 0x0707, v76
    v_and_b32 v103, 0x0707, v78
    v_and_b32 v72, 0xf8f8, v72
    v_and_b32 v74, 0xf8f8, v74
    v_and_b32 v76, 0xf8f8, v76
    v_and_b32 v78, 0xf8f8, v78
    v_mul_u32_u24 v100, 0x200400, v100
    v_mul_u32_u24 v101, 0x200400, v101
    v_mul_u32_u24 v102, 0x200400, v102
    v_mul_u32_u24 v103, 0x200400, v103
    v_and_or_b32 v72, v100, s14, v72
    v_and_or_b32 v74, v101, s14, v74
    v_and_or_b32 v76, v102, s14, v76
    v_and_or_b32 v78, v103, s14, v78
    v_add_u32 v72, v72, v73
    v_add_u32 v74, v74, v75
    v_add_u32 v76, v76, v77
    v_add_u32 v78, v78, v79
    v_dot4_i32_i8 v72, v72, v72, 0
    v_dot4_i32_i8 v74, v74, v74, 0
    v_dot4_i32_i8 v76, v76, v76, 0
    v_dot4_i32_i8 v78, v78, v78, 0
    v_cmp_gt_i32 s[40:41], s15, v72
    v_cmp_gt_i32 s[42:43], s15, v74
    v_cmp_gt_i32 s[46:47], s15, v76
    v_cmp_gt_i32 s[54:55], s15, v78
    v_mbcnt_lo_u32_b32 v100, s40, 0
    v_mbcnt_lo_u32_b32 v101, s42, 0
    v_mbcnt_lo_u32_b32 v102, s46, 0
    v_mbcnt_lo_u32_b32 v103, s54, 0
    v_mbcnt_hi_u32_b32 v100, s41, v100
    v_mbcnt_hi_u32_b32 v101, s43, v101
    v_mbcnt_hi_u32_b32 v102, s47, v102
    v_mbcnt_hi_u32_b32 v103, s55, v103
    v_lshl_add_u32 v100, v100, 2, s16
    s_bcnt1_i32_b64 s27, s[40:41]
    s_lshl2_add_u32 s16, s27, s16
    v_lshl_add_u32 v101, v101, 2, s16
    s_bcnt1_i32_b64 s27, s[42:43]
    s_lshl2_add_u32 s16, s27, s16
    v_lshl_add_u32 v102, v102, 2, s16
    s_bcnt1_i32_b64 s27, s[46:47]
    s_lshl2_add_u32 s16, s27, s16
    v_lshl_add_u32 v103, v103, 2, s16
    s_bcnt1_i32_b64 s27, s[54:55]
    s_lshl2_add_u32 s16, s27, s16
    v_cndmask_b32 v100, v26, v100, s[40:41]
    ds_write_b32 v100, v180
    v_cndmask_b32 v101, v26, v101, s[42:43]
    ds_write_b32 v101, v181
    v_cndmask_b32 v102, v26, v102, s[46:47]
    ds_write_b32 v102, v182
    v_cndmask_b32 v103, v26, v103, s[54:55]
    ds_write_b32 v103, v183
    s_sub_u32 s60, s60, s59
    v_add_u32 v149, s59, v20
    v_mov_b32 v150, 0xff000000
    s_nop 1
M_pc:
    s_cmp_eq_u32 s60, 0
    s_cbranch_scc1 M_pcd
    s_waitcnt lgkmcnt(0)
    ds_read_b32 v148, v149
    v_cmp_gt_u32 vcc, s60, v20
    s_waitcnt lgkmcnt(0)
    s_nop 0
    v_cndmask_b32 v148, v150, v148, vcc
    v_and_b32 v64, s12, v148
    v_alignbit_b32 v65, s13, v148, 22
    ds_read_u16 v64, v64 offset:30720
    ds_read_b32 v65, v65
    s_waitcnt lgkmcnt(0)
    v_and_b32 v96, 0x0707, v64
    v_and_b32 v64, 0xf8f8, v64
    v_mul_u32_u24 v96, 0x200400, v96
    v_and_or_b32 v64, v96, s14, v64
    v_add_u32 v64, v64, v65
    v_dot4_i32_i8 v64, v64, v64, 0
    s_nop 2
    v_cmp_gt_i32 s[40:41], s15, v64
    s_nop 1
    v_mbcnt_lo_u32_b32 v96, s40, 0
    v_mbcnt_hi_u32_b32 v96, s41, v96
    v_lshl_add_u32 v96, v96, 2, s16
    s_bcnt1_i32_b64 s27, s[40:41]
    s_lshl2_add_u32 s16, s27, s16
    v_cndmask_b32 v96, v26, v96, s[40:41]
    ds_write_b32 v96, v148
    v_add_u32 v149, 256, v149
    s_min_u32 s27, s60, 256
    s_sub_u32 s60, s60, s27
    s_sub_u32 s27, s16, s17
    s_cmp_gt_u32 s27, 1024
    s_cbranch_scc0 M_pc
M_pcd:
    s_or_b64 s[54:55], s[68:69], s[70:71]
    s_cmp_eq_u64 s[54:55], 0
    s_cbranch_scc1 M_mdd
    s_mov_b32 s59, 0
M_md:
    s_cmp_eq_u64 s[68:69], 0
    s_cbranch_scc0 M_md1
    s_cmp_lg_u32 s59, 0
    s_cbranch_scc1 M_mdd
    s_mov_b32 s59, 1
    s_mov_b64 s[68:69], s[70:71]
    v_mov_b32 v187, v191
    s_nop 1
    s_branch M_md
M_md1:
    s_ff1_i32_b64 s27, s[68:69]
    s_bitset0_b64 s[68:69], s27
    v_readlane_b32 s60, v187, s27
    s_bfe_u32 s60, s60, 0x170001
    s_cmp_le_u32 s60, 32
    s_cbranch_scc1 M_md2
    ds_write_b32 v9, v19
    s_movk_i32 s60, 32
M_md2:
    s_lshr_b32 s27, s27, 2
    s_lshl_b32 s61, s59, 4
    s_add_u32 s27, s27, s61
    s_lshl_b32 s61, s26, 5
    s_add_u32 s27, s27, s61
    s_lshl_b32 s27, s27, 15
    s_lshl_b32 s61, s2, 7
    s_add_u32 s27, s27, s61
    s_add_u32 s27, s27, 0x900000
    v_mov_b32 v148, 0xff000000
    s_bfm_b64 exec, s60, 0
    buffer_load_dword v148, v20, s[36:39], s27 offen sc1
    s_mov_b64 exec, -1
    s_waitcnt vmcnt(0) lgkmcnt(0)
    v_and_b32 v64, s12, v148
    v_alignbit_b32 v65, s13, v148, 22
    ds_read_u16 v64, v64 offset:30720
    ds_read_b32 v65, v65
    s_waitcnt lgkmcnt(0)
    v_and_b32 v96, 0x0707, v64
    v_and_b32 v64, 0xf8f8, v64
    v_mul_u32_u24 v96, 0x200400, v96
    v_and_or_b32 v64, v96, s14, v64
    v_add_u32 v64, v64, v65
    v_dot4_i32_i8 v64, v64, v64, 0
    s_nop 2
    v_cmp_gt_i32 s[40:41], s15, v64
    s_nop 1
    v_mbcnt_lo_u32_b32 v96, s40, 0
    v_mbcnt_hi_u32_b32 v96, s41, v96
    v_lshl_add_u32 v96, v96, 2, s16
    s_bcnt1_i32_b64 s27, s[40:41]
    s_lshl2_add_u32 s16, s27, s16
    v_cndmask_b32 v96, v26, v96, s[40:41]
    ds_write_b32 v96, v148
    s_sub_u32 s27, s16, s17
    s_cmp_gt_u32 s27, 1024
    s_cbranch_scc0 M_md
M_mdd:
    s_sub_u32 s19, s16, s17
    s_lshr_b32 s19, s19, 2
    s_cmp_le_u32 s19, 256
    s_cbranch_scc1 M_c1
    ds_write_b32 v9, v19
    s_movk_i32 s19, 256
M_c1:
    s_cmp_eq_u32 s26, 6
    s_cbranch_scc0 M_h0
    s_mov_b32 s53, 0x830800
    buffer_load_dwordx4 v[152:155], v1, s[36:39], s53 offen sc1
M_h0:
    v_add_u32 v148, s17, v20
    s_waitcnt lgkmcnt(0)
    ds_read_b32 v64, v148 offset:0
    ds_read_b32 v68, v148 offset:256
    ds_read_b32 v72, v148 offset:512
    ds_read_b32 v76, v148 offset:768
    s_mov_b32 s27, s19
    v_cmp_gt_i32 s[8:9], s27, v8
    s_sub_u32 s27, s19, 64
    v_cmp_gt_i32 s[10:11], s27, v8
    s_sub_u32 s27, s19, 128
    v_cmp_gt_i32 s[14:15], s27, v8
    s_sub_u32 s27, s19, 192
    v_cmp_gt_i32 s[16:17], s27, v8
    s_mov_b32 s63, 0x02020000
    s_mov_b32 s64, 0x322bcc77
    s_mov_b32 s62, 0x409d0000
    v_mov_b32 v149, 0x01000c0c
    v_bfrev_b32 v14, 2
    s_waitcnt lgkmcnt(0)
    v_and_b32 v150, s12, v64
    v_alignbit_b32 v151, 33, v64, 20
    v_lshl_add_u32 v150, v150, 1, v150
    ds_read_b96 v[40:42], v151
    v_and_b32 v150, -4, v150
    v_cndmask_b32 v150, v14, v150, s[8:9]
    buffer_load_dwordx2 v[32:33], v150, s[92:95], 0 offen
    v_bfe_i32 v56, v64, 1, 1
    v_and_or_b32 v56, v56, s63, v149
    s_cmp_le_u32 s19, 64
    s_nop 0
    s_cbranch_scc1 M_s2a
    v_and_b32 v150, s12, v68
    v_alignbit_b32 v151, 33, v68, 20
    v_lshl_add_u32 v150, v150, 1, v150
    ds_read_b96 v[44:46], v151
    v_and_b32 v150, -4, v150
    v_cndmask_b32 v150, v14, v150, s[10:11]
    buffer_load_dwordx2 v[34:35], v150, s[92:95], 0 offen
    v_bfe_i32 v57, v68, 1, 1
    v_and_or_b32 v57, v57, s63, v149
    s_cmp_le_u32 s19, 128
    s_nop 0
    s_cbranch_scc1 M_s2a
    v_and_b32 v150, s12, v72
    v_alignbit_b32 v151, 33, v72, 20
    v_lshl_add_u32 v150, v150, 1, v150
    ds_read_b96 v[48:50], v151
    v_and_b32 v150, -4, v150
    v_cndmask_b32 v150, v14, v150, s[14:15]
    buffer_load_dwordx2 v[36:37], v150, s[92:95], 0 offen
    v_bfe_i32 v58, v72, 1, 1
    v_and_or_b32 v58, v58, s63, v149
    s_cmp_le_u32 s19, 192
    s_nop 0
    s_cbranch_scc1 M_s2a
    v_and_b32 v150, s12, v76
    v_alignbit_b32 v151, 33, v76, 20
    v_lshl_add_u32 v150, v150, 1, v150
    ds_read_b96 v[52:54], v151
    v_and_b32 v150, -4, v150
    v_cndmask_b32 v150, v14, v150, s[16:17]
    buffer_load_dwordx2 v[38:39], v150, s[92:95], 0 offen
    v_bfe_i32 v59, v76, 1, 1
    v_and_or_b32 v59, v59, s63, v149
    s_nop 1
M_s2a:
    s_sub_u32 s27, s26, 4
    v_mov_b32 v159, s27
    v_lshl_add_u32 v159, v159, 6, v8
    v_cmp_gt_u32 vcc, 240, v159
    v_lshlrev_b32 v159, 7, v159
    v_bfrev_b32 v157, 2
    v_cndmask_b32 v159, v157, v159, vcc
    s_add_u32 s27, s44, 71680
    buffer_load_dword v158, v159, s[28:31], s27 offen
    s_waitcnt vmcnt(1) lgkmcnt(0)
    v_add_u32 v151, s63, v56
    v_perm_b32 v148, v33, v32, v56
    v_add_u32 v152, s63, v151
    v_perm_b32 v149, v33, v32, v151
    v_perm_b32 v150, v33, v32, v152
    v_sub_f32 v148, v148, v40
    v_sub_f32 v149, v149, v41
    v_sub_f32 v150, v150, v42
    v_cvt_pk_bf16_f32 v65, v148, v149
    v_cvt_pk_bf16_f32 v150, 0, v150
    v_lshlrev_b32 v148, 16, v65
    v_and_b32 v149, s58, v65
    v_mul_f32 v153, v150, v150
    v_mul_f32 v148, v148, v148
    v_mul_f32 v149, v149, v149
    v_cvt_pk_bf16_f32 v153, 0, v153
    v_cvt_pk_bf16_f32 v148, 0, v148
    v_cvt_pk_bf16_f32 v149, 0, v149
    v_add_f32 v148, v148, v149
    v_add_f32 v148, v148, v153
    v_cvt_pk_bf16_f32 v148, 0, v148
    v_add_f32 v148, s64, v148
    v_cvt_pk_bf16_f32 v148, 0, v148
    v_sqrt_f32 v148, v148
    s_nop 0
    v_cvt_pk_bf16_f32 v66, v150, v148
    v_cmp_gt_u32 vcc, s62, v66
    s_and_b64 s[8:9], s[8:9], vcc
    v_lshrrev_b32 v96, 24, v64
    v_lshrrev_b32 v120, 21, v64
    v_and_b32 v120, 16, v120
    v_lshlrev_b32 v112, v120, v19
    v_and_or_b32 v96, v96, v18, s3
    s_mov_b64 exec, s[8:9]
    s_nop 0
    s_cbranch_execz M_sa1
    ds_add_rtn_u32 v112, v96, v112
M_sa1:
    s_mov_b64 exec, -1
    s_cmp_le_u32 s19, 64
    s_cbranch_scc1 M_s2b
    v_add_u32 v151, s63, v57
    v_perm_b32 v148, v35, v34, v57
    v_add_u32 v152, s63, v151
    v_perm_b32 v149, v35, v34, v151
    v_perm_b32 v150, v35, v34, v152
    v_sub_f32 v148, v148, v44
    v_sub_f32 v149, v149, v45
    v_sub_f32 v150, v150, v46
    v_cvt_pk_bf16_f32 v69, v148, v149
    v_cvt_pk_bf16_f32 v150, 0, v150
    v_lshlrev_b32 v148, 16, v69
    v_and_b32 v149, s58, v69
    v_mul_f32 v153, v150, v150
    v_mul_f32 v148, v148, v148
    v_mul_f32 v149, v149, v149
    v_cvt_pk_bf16_f32 v153, 0, v153
    v_cvt_pk_bf16_f32 v148, 0, v148
    v_cvt_pk_bf16_f32 v149, 0, v149
    v_add_f32 v148, v148, v149
    v_add_f32 v148, v148, v153
    v_cvt_pk_bf16_f32 v148, 0, v148
    v_add_f32 v148, s64, v148
    v_cvt_pk_bf16_f32 v148, 0, v148
    v_sqrt_f32 v148, v148
    s_nop 0
    v_cvt_pk_bf16_f32 v70, v150, v148
    v_cmp_gt_u32 vcc, s62, v70
    s_and_b64 s[10:11], s[10:11], vcc
    v_lshrrev_b32 v97, 24, v68
    v_lshrrev_b32 v121, 21, v68
    v_and_b32 v121, 16, v121
    v_lshlrev_b32 v113, v121, v19
    v_and_or_b32 v97, v97, v18, s3
    s_mov_b64 exec, s[10:11]
    s_nop 0
    s_cbranch_execz M_sa2
    ds_add_rtn_u32 v113, v97, v113
M_sa2:
    s_mov_b64 exec, -1
    s_cmp_le_u32 s19, 128
    s_cbranch_scc1 M_s2b
    v_add_u32 v151, s63, v58
    v_perm_b32 v148, v37, v36, v58
    v_add_u32 v152, s63, v151
    v_perm_b32 v149, v37, v36, v151
    v_perm_b32 v150, v37, v36, v152
    v_sub_f32 v148, v148, v48
    v_sub_f32 v149, v149, v49
    v_sub_f32 v150, v150, v50
    v_cvt_pk_bf16_f32 v73, v148, v149
    v_cvt_pk_bf16_f32 v150, 0, v150
    v_lshlrev_b32 v148, 16, v73
    v_and_b32 v149, s58, v73
    v_mul_f32 v153, v150, v150
    v_mul_f32 v148, v148, v148
    v_mul_f32 v149, v149, v149
    v_cvt_pk_bf16_f32 v153, 0, v153
    v_cvt_pk_bf16_f32 v148, 0, v148
    v_cvt_pk_bf16_f32 v149, 0, v149
    v_add_f32 v148, v148, v149
    v_add_f32 v148, v148, v153
    v_cvt_pk_bf16_f32 v148, 0, v148
    v_add_f32 v148, s64, v148
    v_cvt_pk_bf16_f32 v148, 0, v148
    v_sqrt_f32 v148, v148
    s_nop 0
    v_cvt_pk_bf16_f32 v74, v150, v148
    v_cmp_gt_u32 vcc, s62, v74
    s_and_b64 s[14:15], s[14:15], vcc
    v_lshrrev_b32 v98, 24, v72
    v_lshrrev_b32 v122, 21, v72
    v_and_b32 v122, 16, v122
    v_lshlrev_b32 v114, v122, v19
    v_and_or_b32 v98, v98, v18, s3
    s_mov_b64 exec, s[14:15]
    s_nop 0
    s_cbranch_execz M_sa3
    ds_add_rtn_u32 v114, v98, v114
M_sa3:
    s_mov_b64 exec, -1
    s_cmp_le_u32 s19, 192
    s_cbranch_scc1 M_s2b
    v_add_u32 v151, s63, v59
    v_perm_b32 v148, v39, v38, v59
    v_add_u32 v152, s63, v151
    v_perm_b32 v149, v39, v38, v151
    v_perm_b32 v150, v39, v38, v152
    v_sub_f32 v148, v148, v52
    v_sub_f32 v149, v149, v53
    v_sub_f32 v150, v150, v54
    v_cvt_pk_bf16_f32 v77, v148, v149
    v_cvt_pk_bf16_f32 v150, 0, v150
    v_lshlrev_b32 v148, 16, v77
    v_and_b32 v149, s58, v77
    v_mul_f32 v153, v150, v150
    v_mul_f32 v148, v148, v148
    v_mul_f32 v149, v149, v149
    v_cvt_pk_bf16_f32 v153, 0, v153
    v_cvt_pk_bf16_f32 v148, 0, v148
    v_cvt_pk_bf16_f32 v149, 0, v149
    v_add_f32 v148, v148, v149
    v_add_f32 v148, v148, v153
    v_cvt_pk_bf16_f32 v148, 0, v148
    v_add_f32 v148, s64, v148
    v_cvt_pk_bf16_f32 v148, 0, v148
    v_sqrt_f32 v148, v148
    s_nop 0
    v_cvt_pk_bf16_f32 v78, v150, v148
    v_cmp_gt_u32 vcc, s62, v78
    s_and_b64 s[16:17], s[16:17], vcc
    v_lshrrev_b32 v99, 24, v76
    v_lshrrev_b32 v123, 21, v76
    v_and_b32 v123, 16, v123
    v_lshlrev_b32 v115, v123, v19
    v_and_or_b32 v99, v99, v18, s3
    s_mov_b64 exec, s[16:17]
    s_nop 0
    s_cbranch_execz M_sa4
    ds_add_rtn_u32 v115, v99, v115
M_sa4:
    s_mov_b64 exec, -1
M_s2b:
    s_mov_b32 s61, 0x3e22f983
    s_movk_i32 s63, 0x70
    s_movk_i32 s64, 128
    s_movk_i32 s65, 256
    s_movk_i32 s66, 384
    v_lshrrev_b32 v21, 4, v8
    v_lshlrev_b32 v21, 9, v21
    v_and_b32 v22, 15, v8
    v_lshl_or_b32 v21, v22, 4, v21
    s_lshl_b32 s45, s26, 10
    s_add_u32 s45, s45, 30720
    s_lshl_b32 s46, s26, 11
    s_add_u32 s46, s46, s44
    s_waitcnt lgkmcnt(0)
    s_barrier
    s_add_u32 m0, s45, 0
    s_add_u32 s53, s46, 0
    buffer_load_dwordx4 v21, s[28:31], s53 offen  lds
    s_add_u32 m0, s45, 8192
    s_add_u32 s53, s46, 16384
    buffer_load_dwordx4 v21, s[28:31], s53 offen  lds
    s_add_u32 m0, s45, 16384
    s_add_u32 s53, s46, 32768
    buffer_load_dwordx4 v21, s[28:31], s53 offen  lds
    s_add_u32 m0, s45, 24576
    s_add_u32 s53, s46, 49152
    buffer_load_dwordx4 v21, s[28:31], s53 offen  lds
    s_add_u32 m0, s45, 32768
    s_add_u32 s53, s46, 65536
    buffer_load_dwordx4 v21, s[28:31], s53 offen  lds
    s_add_u32 m0, s45, 40960
    s_add_u32 s53, s46, 81920
    buffer_load_dwordx4 v21, s[28:31], s53 offen  lds
    s_cmp_ge_u32 s26, 2
    s_cbranch_scc1 M_rs11
    s_add_u32 m0, s45, 49152
    s_add_u32 s53, s46, 98304
    buffer_load_dwordx4 v21, s[28:31], s53 offen  lds
M_rs11:
    ds_read_b32 v28, v30
    ds_read_b32 v13, v9
    s_waitcnt lgkmcnt(1)
    v_and_b32 v31, 0xffff, v28
    v_lshrrev_b32 v28, 16, v28
    v_add_u32 v28, v28, v31
    v_mov_b32 v29, v28
    s_nop 1
    v_add_u32_dpp v29, v29, v29 row_shr:1 row_mask:0xf bank_mask:0xf bound_ctrl:0
    s_nop 1
    v_add_u32_dpp v29, v29, v29 row_shr:2 row_mask:0xf bank_mask:0xf bound_ctrl:0
    s_nop 1
    v_add_u32_dpp v29, v29, v29 row_shr:4 row_mask:0xf bank_mask:0xf bound_ctrl:0
    s_nop 1
    v_add_u32_dpp v29, v29, v29 row_shr:8 row_mask:0xf bank_mask:0xf bound_ctrl:0
    s_nop 1
    v_add_u32_dpp v29, v29, v29 row_bcast:15 row_mask:0xa bank_mask:0xf
    s_nop 1
    v_add_u32_dpp v29, v29, v29 row_bcast:31 row_mask:0xc bank_mask:0xf
    v_sub_u32 v28, v29, v28
    v_add_u32 v31, v28, v31
    v_lshl_or_b32 v28, v31, 16, v28
    ds_bpermute_b32 v104, v96, v28
    ds_bpermute_b32 v105, v97, v28
    ds_bpermute_b32 v106, v98, v28
    ds_bpermute_b32 v107, v99, v28
    v_readlane_b32 s62, v29, 63
    s_mov_b32 s54, 0
    s_mov_b32 s55, 0
    s_xor_b32 s12, s26, 4
    s_cmp_gt_u32 s62, 480
    s_cselect_b32 s27, 96, 64
    v_cmp_ge_u32 vcc, s27, v29
    v_cmp_ge_u32 s[70:71], s27, v31
    s_bcnt1_i32_b64 s56, vcc
    s_bcnt1_i32_b64 s57, s[70:71]
    s_add_u32 s56, s56, s57
    s_min_u32 s56, s56, 16
    s_lshr_b32 s27, s56, 1
    s_and_b32 s69, s56, 1
    v_readlane_b32 s57, v28, s27
    s_lshl4_add_u32 s69, s69, 0x100000
    s_bfe_u32 s57, s57, s69
    s_waitcnt lgkmcnt(0)
    v_readfirstlane_b32 s46, v13
    v_add_u32 v104, v104, v112
    v_bfe_u32 v104, v104, v120, 16
    v_cmp_gt_u32 vcc, 768, v104
    v_lshl_add_u32 v104, v104, 4, s67
    s_and_b64 exec, vcc, s[8:9]
    s_nop 2
    s_cbranch_execz M_sb12
    ds_write_b96 v104, v[64:66]
M_sb12:
    s_mov_b64 exec, -1
    s_cmp_le_u32 s19, 64
    s_cbranch_scc1 M_s2c
    v_add_u32 v105, v105, v113
    v_bfe_u32 v105, v105, v121, 16
    v_cmp_gt_u32 vcc, 768, v105
    v_lshl_add_u32 v105, v105, 4, s67
    s_and_b64 exec, vcc, s[10:11]
    s_nop 2
    s_cbranch_execz M_sb13
    ds_write_b96 v105, v[68:70]
M_sb13:
    s_mov_b64 exec, -1
    s_cmp_le_u32 s19, 128
    s_cbranch_scc1 M_s2c
    v_add_u32 v106, v106, v114
    v_bfe_u32 v106, v106, v122, 16
    v_cmp_gt_u32 vcc, 768, v106
    v_lshl_add_u32 v106, v106, 4, s67
    s_and_b64 exec, vcc, s[14:15]
    s_nop 2
    s_cbranch_execz M_sb14
    ds_write_b96 v106, v[72:74]
M_sb14:
    s_mov_b64 exec, -1
    s_cmp_le_u32 s19, 192
    s_cbranch_scc1 M_s2c
    v_add_u32 v107, v107, v115
    v_bfe_u32 v107, v107, v123, 16
    v_cmp_gt_u32 vcc, 768, v107
    v_lshl_add_u32 v107, v107, 4, s67
    s_and_b64 exec, vcc, s[16:17]
    s_nop 2
    s_cbranch_execz M_sb15
    ds_write_b96 v107, v[76:78]
M_sb15:
    s_mov_b64 exec, -1
M_s2c:
    s_cmp_eq_u32 s26, 6
    s_cbranch_scc0 M_h3
    s_mov_b32 s27, 0
    v_cmp_gt_u32 s[8:9], 63, v8
    v_cmp_eq_u32 s[10:11], 62, v8
    s_nop 4
M_h2:
    v_cndmask_b32 v154, v154, v152, s[10:11]
    v_cndmask_b32 v155, v155, v152, s[10:11]
    v_xor_b32 v152, s18, v152
    v_xor_b32 v153, s18, v153
    v_xor_b32 v154, s18, v154
    v_xor_b32 v155, s18, v155
    v_or3_b32 v152, v152, v153, v154
    v_or_b32 v152, v152, v155
    v_cmp_ne_u32 vcc, 0, v152
    s_and_b64 vcc, vcc, s[8:9]
    s_cbranch_vccz M_h3
    s_add_u32 s27, s27, 1
    s_cmp_lt_u32 s27, 16384
    s_cbranch_scc0 M_h3
    s_sleep 2
    s_mov_b32 s53, 0x830800
    buffer_load_dwordx4 v[152:155], v1, s[36:39], s53 offen sc1
    s_waitcnt vmcnt(0)
    s_branch M_h2
M_h3:
    s_cmp_eq_u32 s2, 0
    s_cbranch_scc0 M_h4
    s_cmp_eq_u32 s26, 5
    s_cbranch_scc0 M_h4
    s_mov_b32 s27, 0x830000
    v_mov_b32 v148, s18
    v_mov_b32 v149, 0
    s_mov_b64 exec, 1
    buffer_store_dword v148, v149, s[36:39], s27 offen sc1
    s_mov_b64 exec, -1
M_h4:
    s_waitcnt lgkmcnt(0)
    s_barrier
    s_cmp_eq_u32 s12, 0
    s_cbranch_scc1 M_cut
    s_sub_u32 s27, s57, s55
    s_cmp_gt_u32 s27, 64
    s_cselect_b32 s40, 64, 96
    s_mov_b32 s54, s56
    s_mov_b32 s55, s57
    s_sub_u32 s27, s62, s55
    s_cmp_gt_u32 s27, 420
    s_cselect_b32 s27, 96, 64
    s_add_u32 s27, s27, s55
    v_cmp_ge_u32 vcc, s27, v29
    v_cmp_ge_u32 s[70:71], s27, v31
    s_bcnt1_i32_b64 s56, vcc
    s_bcnt1_i32_b64 s57, s[70:71]
    s_add_u32 s27, s54, 16
    s_add_u32 s56, s56, s57
    s_min_u32 s56, s56, s27
    s_min_u32 s56, s56, 100
    s_max_u32 s56, s56, 4
    s_lshr_b32 s27, s56, 1
    s_and_b32 s69, s56, 1
    v_readlane_b32 s57, v28, s27
    s_lshl4_add_u32 s69, s69, 0x100000
    s_bfe_u32 s57, s57, s69
    s_cmp_eq_u32 s12, 1
    s_cbranch_scc1 M_cut
    s_sub_u32 s27, s57, s55
    s_cmp_gt_u32 s27, 64
    s_cselect_b32 s41, 64, 96
    s_mov_b32 s54, s56
    s_mov_b32 s55, s57
    s_sub_u32 s27, s62, s55
    s_cmp_gt_u32 s27, 360
    s_cselect_b32 s27, 96, 64
    s_add_u32 s27, s27, s55
    v_cmp_ge_u32 vcc, s27, v29
    v_cmp_ge_u32 s[70:71], s27, v31
    s_bcnt1_i32_b64 s56, vcc
    s_bcnt1_i32_b64 s57, s[70:71]
    s_add_u32 s27, s54, 16
    s_add_u32 s56, s56, s57
    s_min_u32 s56, s56, s27
    s_min_u32 s56, s56, 100
    s_max_u32 s56, s56, 20
    s_lshr_b32 s27, s56, 1
    s_and_b32 s69, s56, 1
    v_readlane_b32 s57, v28, s27
    s_lshl4_add_u32 s69, s69, 0x100000
    s_bfe_u32 s57, s57, s69
    s_cmp_eq_u32 s12, 2
    s_cbranch_scc1 M_cut
    s_sub_u32 s27, s57, s55
    s_cmp_gt_u32 s27, 64
    s_cselect_b32 s42, 64, 96
    s_mov_b32 s54, s56
    s_mov_b32 s55, s57
    s_sub_u32 s27, s62, s55
    s_cmp_gt_u32 s27, 300
    s_cselect_b32 s27, 96, 64
    s_add_u32 s27, s27, s55
    v_cmp_ge_u32 vcc, s27, v29
    v_cmp_ge_u32 s[70:71], s27, v31
    s_bcnt1_i32_b64 s56, vcc
    s_bcnt1_i32_b64 s57, s[70:71]
    s_add_u32 s27, s54, 16
    s_add_u32 s56, s56, s57
    s_min_u32 s56, s56, s27
    s_min_u32 s56, s56, 100
    s_max_u32 s56, s56, 36
    s_lshr_b32 s27, s56, 1
    s_and_b32 s69, s56, 1
    v_readlane_b32 s57, v28, s27
    s_lshl4_add_u32 s69, s69, 0x100000
    s_bfe_u32 s57, s57, s69
    s_cmp_eq_u32 s12, 3
    s_cbranch_scc1 M_cut
    s_mov_b32 s54, s56
    s_mov_b32 s55, s57
    s_sub_u32 s27, s62, s55
    s_cmp_gt_u32 s27, 248
    s_cselect_b32 s27, s40, 64
    s_add_u32 s27, s27, s55
    v_cmp_ge_u32 vcc, s27, v29
    v_cmp_ge_u32 s[70:71], s27, v31
    s_bcnt1_i32_b64 s56, vcc
    s_bcnt1_i32_b64 s57, s[70:71]
    s_add_u32 s27, s54, 16
    s_add_u32 s56, s56, s57
    s_min_u32 s56, s56, s27
    s_min_u32 s56, s56, 100
    s_max_u32 s56, s56, 52
    s_lshr_b32 s27, s56, 1
    s_and_b32 s69, s56, 1
    v_readlane_b32 s57, v28, s27
    s_lshl4_add_u32 s69, s69, 0x100000
    s_bfe_u32 s57, s57, s69
    s_cmp_eq_u32 s12, 4
    s_cbranch_scc1 M_cut
    s_mov_b32 s54, s56
    s_mov_b32 s55, s57
    s_sub_u32 s27, s62, s55
    s_cmp_gt_u32 s27, 186
    s_cselect_b32 s27, s41, 64
    s_add_u32 s27, s27, s55
    v_cmp_ge_u32 vcc, s27, v29
    v_cmp_ge_u32 s[70:71], s27, v31
    s_bcnt1_i32_b64 s56, vcc
    s_bcnt1_i32_b64 s57, s[70:71]
    s_add_u32 s27, s54, 16
    s_add_u32 s56, s56, s57
    s_min_u32 s56, s56, s27
    s_min_u32 s56, s56, 100
    s_max_u32 s56, s56, 68
    s_lshr_b32 s27, s56, 1
    s_and_b32 s69, s56, 1
    v_readlane_b32 s57, v28, s27
    s_lshl4_add_u32 s69, s69, 0x100000
    s_bfe_u32 s57, s57, s69
    s_cmp_eq_u32 s12, 5
    s_cbranch_scc1 M_cut
    s_mov_b32 s54, s56
    s_mov_b32 s55, s57
    s_sub_u32 s27, s62, s55
    s_cmp_gt_u32 s27, 124
    s_cselect_b32 s27, s42, 64
    s_add_u32 s27, s27, s55
    v_cmp_ge_u32 vcc, s27, v29
    v_cmp_ge_u32 s[70:71], s27, v31
    s_bcnt1_i32_b64 s56, vcc
    s_bcnt1_i32_b64 s57, s[70:71]
    s_add_u32 s27, s54, 16
    s_add_u32 s56, s56, s57
    s_min_u32 s56, s56, s27
    s_min_u32 s56, s56, 100
    s_max_u32 s56, s56, 84
    s_lshr_b32 s27, s56, 1
    s_and_b32 s69, s56, 1
    v_readlane_b32 s57, v28, s27
    s_lshl4_add_u32 s69, s69, 0x100000
    s_bfe_u32 s57, s57, s69
    s_cmp_eq_u32 s12, 6
    s_cbranch_scc1 M_cut
    s_mov_b32 s54, s56
    s_mov_b32 s55, s57
    s_movk_i32 s56, 100
    s_mov_b32 s57, s62
M_cut:
    s_lshl_b32 s27, s55, 4
    s_add_u32 s27, s27, s67
    v_add_u32 v14, s27, v1
    v_lshlrev_b32 v15, 4, v11
    v_add_u32 v15, s27, v15
    ds_read_b32 v15, v15
    ds_read_b96 v[88:90], v14
    ds_read_b96 v[92:94], v14 offset:1024
    s_lshl_b32 s59, s54, 1
    s_sub_u32 s45, s56, s54
    s_lshl_b32 s45, s45, 1
    s_lshl_b32 s40, s54, 10
    s_add_u32 s40, s40, s44
    s_add_u32 s41, s40, 4096
    s_add_u32 s42, s40, 8192
    s_add_u32 s43, s40, 12288
    s_lshl_b32 s6, s56, 10
    s_add_u32 s6, s6, s44
    s_mov_b32 s34, s6
    s_sub_u32 s47, s57, s55
    v_add_u32 v86, 64, v8
    s_mov_b32 s50, 1
    s_cmp_gt_u32 s47, 128
    s_cselect_b32 s27, 1, s46
    s_cmp_gt_u32 s57, 768
    s_cselect_b32 s27, 1, s27
    s_cmp_eq_u32 s27, 0
    s_cselect_b32 s47, s47, 0
    s_cselect_b32 s76, 1, 0
    s_mov_b32 s14, 0
    s_mov_b32 s15, 0
    s_mov_b32 s16, 0
    s_mov_b32 s17, 0
    v_cmp_gt_u32 s[8:9], s47, v8
    v_cmp_gt_u32 s[10:11], s47, v86
    s_add_u32 s48, s47, 31
    s_lshr_b32 s48, s48, 5
    v_bfrev_b32 v14, 2
    v_cmp_gt_u32 vcc, s47, v11
    s_mov_b32 s27, 0x1fffe
    s_waitcnt lgkmcnt(2)
    v_and_b32 v15, s27, v15
    v_lshlrev_b32 v15, 6, v15
    v_lshl_add_u32 v15, v10, 6, v15
    v_cndmask_b32 v15, v14, v15, vcc
    buffer_load_dwordx4 v[32:35], v15, s[72:75], 0 offen offset:0
    buffer_load_dwordx4 v[36:39], v15, s[72:75], 0 offen offset:16
    buffer_load_dwordx4 v[40:43], v15, s[72:75], 0 offen offset:32
    buffer_load_dwordx4 v[44:47], v15, s[72:75], 0 offen offset:48
    s_waitcnt lgkmcnt(0)
M_win:
    v_lshrrev_b32 v8, 4, v1
    s_mov_b32 s53, 0x40490fdb
    s_mov_b32 s70, 0
    s_mov_b32 s54, 0x3e4ccccd
    s_mov_b32 s55, 0x1fffe
    v_mov_b32 v87, 1
    v_bfrev_b32 v14, 2
    v_and_b32 v96, s58, v90
    v_cndmask_b32 v96, 1.0, v96, s[8:9]
    v_rcp_f32 v98, v96
    v_mul_f32 v97, s53, v96
    v_cvt_pk_bf16_f32 v97, 0, v97
    v_mul_f32 v97, s54, v97
    v_cvt_pk_bf16_f32 v97, 0, v97
    v_mul_f32 v97, s61, v97
    v_cos_f32 v97, v97
    v_lshlrev_b32 v100, 16, v89
    v_and_b32 v101, s58, v89
    v_lshlrev_b32 v102, 16, v90
    v_cvt_pk_bf16_f32 v97, 0, v97
    v_add_f32 v97, 1.0, v97
    v_cvt_pk_bf16_f32 v97, 0, v97
    v_cndmask_b32 v97, 0, v97, s[8:9]
    v_mul_f32 v97, v97, v98
    v_add_f32 v103, v98, v98
    v_mul_f32 v97, 0x3e800000, v97
    v_mul_f32 v100, v100, v103
    v_mul_f32 v101, v101, v103
    v_mul_f32 v102, v102, v103
    v_and_b32 v99, s55, v88
    v_lshlrev_b32 v99, 8, v99
    v_cndmask_b32 v99, v14, v99, s[8:9]
    v_cvt_pk_bf16_f32 v100, v100, v101
    v_cvt_pk_bf16_f32 v102, 0, v102
    v_cndmask_b32 v104, 0, v87, s[8:9]
    v_mov_b32 v105, 0
    v_lshrrev_b32 v108, 24, v88
    v_subrev_u32 v108, s59, v108
    v_lshlrev_b32 v108, 1, v108
    v_lshlrev_b64 v[106:107], v108, v[104:105]
    ds_write_b128 v16, v[96:99] offset:0
    ds_write_b16 v17, v106 offset:2048
    ds_write_b16_d16_hi v17, v106 offset:2056
    ds_write_b16 v17, v107 offset:2064
    ds_write_b16_d16_hi v17, v107 offset:2072
    ds_write_b16 v17, v100 offset:2080
    ds_write_b16_d16_hi v17, v100 offset:2088
    ds_write_b16_d16_hi v17, v102 offset:2096
    s_cmp_eq_u64 s[10:11], 0
    s_cbranch_scc1 M_g1
    v_and_b32 v112, s58, v94
    v_cndmask_b32 v112, 1.0, v112, s[10:11]
    v_rcp_f32 v114, v112
    v_mul_f32 v113, s53, v112
    v_cvt_pk_bf16_f32 v113, 0, v113
    v_mul_f32 v113, s54, v113
    v_cvt_pk_bf16_f32 v113, 0, v113
    v_mul_f32 v113, s61, v113
    v_cos_f32 v113, v113
    v_lshlrev_b32 v116, 16, v93
    v_and_b32 v117, s58, v93
    v_lshlrev_b32 v118, 16, v94
    v_cvt_pk_bf16_f32 v113, 0, v113
    v_add_f32 v113, 1.0, v113
    v_cvt_pk_bf16_f32 v113, 0, v113
    v_cndmask_b32 v113, 0, v113, s[10:11]
    v_mul_f32 v113, v113, v114
    v_add_f32 v119, v114, v114
    v_mul_f32 v113, 0x3e800000, v113
    v_mul_f32 v116, v116, v119
    v_mul_f32 v117, v117, v119
    v_mul_f32 v118, v118, v119
    v_and_b32 v115, s55, v92
    v_lshlrev_b32 v115, 8, v115
    v_cndmask_b32 v115, v14, v115, s[10:11]
    v_cvt_pk_bf16_f32 v116, v116, v117
    v_cvt_pk_bf16_f32 v118, 0, v118
    v_cndmask_b32 v120, 0, v87, s[10:11]
    v_mov_b32 v121, 0
    v_lshrrev_b32 v124, 24, v92
    v_subrev_u32 v124, s59, v124
    v_lshlrev_b32 v124, 1, v124
    v_lshlrev_b64 v[122:123], v124, v[120:121]
    ds_write_b128 v16, v[112:115] offset:1024
    ds_write_b16 v17, v122 offset:2944
    ds_write_b16_d16_hi v17, v122 offset:2952
    ds_write_b16 v17, v123 offset:2960
    ds_write_b16_d16_hi v17, v123 offset:2968
    ds_write_b16 v17, v116 offset:2976
    ds_write_b16_d16_hi v17, v116 offset:2984
    ds_write_b16_d16_hi v17, v118 offset:2992
M_g1:
    s_waitcnt lgkmcnt(0)
    s_cmp_lg_u32 s50, 0
    s_cbranch_scc1 M_first
    s_cmp_eq_u32 s48, 0
    s_cselect_b32 s77, 0x40000000, 0
    ds_read_b32 v47, v3 offset:12
    v_bfe_u32 v46, v1, 9, 1
    s_waitcnt lgkmcnt(0)
    v_lshrrev_b32 v47, 2, v47
    v_lshl_add_u32 v47, v46, 6, v47
    buffer_load_dwordx4 v[32:35], v47, s[72:75], s77 offen offset:0
    buffer_load_dwordx4 v[36:39], v47, s[72:75], s77 offen offset:16
    buffer_load_dwordx4 v[40:43], v47, s[72:75], s77 offen offset:32
    buffer_load_dwordx4 v[44:47], v47, s[72:75], s77 offen offset:48
    s_branch M_noacc
M_first:
    s_mov_b32 s50, 2
    s_sub_u32 s27, s26, 4
    s_cmp_ge_u32 s27, 3
    s_cbranch_scc1 M_late
    s_cmp_eq_u32 s48, 0
    s_cbranch_scc1 M_late
    ds_read_b32 v64, v5 offset:12
    ds_read_b32 v65, v5 offset:140
    ds_read_b32 v66, v5 offset:268
    ds_read_b32 v67, v5 offset:396
    s_waitcnt lgkmcnt(3)
    v_and_or_b32 v64, v1, s63, v64
    s_waitcnt lgkmcnt(2)
    v_and_or_b32 v65, v1, s63, v65
    s_waitcnt lgkmcnt(1)
    v_and_or_b32 v66, v1, s63, v66
    s_waitcnt lgkmcnt(0)
    v_and_or_b32 v67, v1, s63, v67
    s_add_u32 m0, s51, 0
    s_nop 0
    buffer_load_dwordx4 v64, s[28:31], s64 offen lds
    s_add_u32 m0, s51, 1024
    s_nop 0
    buffer_load_dwordx4 v64, s[28:31], s65 offen lds
    s_add_u32 m0, s51, 2048
    s_nop 0
    buffer_load_dwordx4 v64, s[28:31], s66 offen lds
    s_add_u32 m0, s51, 3072
    s_nop 0
    buffer_load_dwordx4 v65, s[28:31], s64 offen lds
    s_add_u32 m0, s51, 4096
    s_nop 0
    buffer_load_dwordx4 v65, s[28:31], s65 offen lds
    s_add_u32 m0, s51, 5120
    s_nop 0
    buffer_load_dwordx4 v65, s[28:31], s66 offen lds
    s_add_u32 m0, s51, 6144
    s_nop 0
    buffer_load_dwordx4 v66, s[28:31], s64 offen lds
    s_add_u32 m0, s51, 7168
    s_nop 0
    buffer_load_dwordx4 v66, s[28:31], s65 offen lds
    s_add_u32 m0, s51, 8192
    s_nop 0
    buffer_load_dwordx4 v66, s[28:31], s66 offen lds
    s_add_u32 m0, s51, 9216
    s_nop 0
    buffer_load_dwordx4 v67, s[28:31], s64 offen lds
    s_add_u32 m0, s51, 10240
    s_nop 0
    buffer_load_dwordx4 v67, s[28:31], s65 offen lds
    s_add_u32 m0, s51, 11264
    s_nop 0
    buffer_load_dwordx4 v67, s[28:31], s66 offen lds
    s_mov_b32 s50, 3
    s_waitcnt vmcnt(16)
    s_branch M_late2
M_late:
    s_waitcnt vmcnt(4)
M_late2:
    s_lshl_b32 s27, s59, 8
    s_add_u32 s27, s27, 30720
    v_lshlrev_b32 v12, 10, v10
    v_lshl_add_u32 v12, v11, 2, v12
    v_add_u32 v12, s27, v12
    s_barrier
    ds_read_u16_d16_hi v128, v12 offset:0
    ds_read_u16_d16_hi v144, v12 offset:2
    ds_read_u16_d16_hi v129, v12 offset:256
    ds_read_u16_d16_hi v145, v12 offset:258
    ds_read_u16_d16_hi v130, v12 offset:512
    ds_read_u16_d16_hi v146, v12 offset:514
    ds_read_u16_d16_hi v131, v12 offset:768
    ds_read_u16_d16_hi v147, v12 offset:770
    ds_read_u16_d16_hi v132, v12 offset:2048
    ds_read_u16_d16_hi v148, v12 offset:2050
    ds_read_u16_d16_hi v133, v12 offset:2304
    ds_read_u16_d16_hi v149, v12 offset:2306
    ds_read_u16_d16_hi v134, v12 offset:2560
    ds_read_u16_d16_hi v150, v12 offset:2562
    ds_read_u16_d16_hi v135, v12 offset:2816
    ds_read_u16_d16_hi v151, v12 offset:2818
    ds_read_u16_d16_hi v136, v12 offset:4096
    ds_read_u16_d16_hi v152, v12 offset:4098
    ds_read_u16_d16_hi v137, v12 offset:4352
    ds_read_u16_d16_hi v153, v12 offset:4354
    ds_read_u16_d16_hi v138, v12 offset:4608
    ds_read_u16_d16_hi v154, v12 offset:4610
    ds_read_u16_d16_hi v139, v12 offset:4864
    ds_read_u16_d16_hi v155, v12 offset:4866
    ds_read_u16_d16_hi v140, v12 offset:6144
    ds_read_u16_d16_hi v156, v12 offset:6146
    ds_read_u16_d16_hi v141, v12 offset:6400
    ds_read_u16_d16_hi v157, v12 offset:6402
    ds_read_u16_d16_hi v142, v12 offset:6656
    ds_read_u16_d16_hi v158, v12 offset:6658
    ds_read_u16_d16_hi v143, v12 offset:6912
    ds_read_u16_d16_hi v159, v12 offset:6914
    ds_read_u16_d16_hi v160, v12 offset:128
    ds_read_u16_d16_hi v176, v12 offset:130
    ds_read_u16_d16_hi v161, v12 offset:384
    ds_read_u16_d16_hi v177, v12 offset:386
    ds_read_u16_d16_hi v162, v12 offset:640
    ds_read_u16_d16_hi v178, v12 offset:642
    ds_read_u16_d16_hi v163, v12 offset:896
    ds_read_u16_d16_hi v179, v12 offset:898
    ds_read_u16_d16_hi v164, v12 offset:2176
    ds_read_u16_d16_hi v180, v12 offset:2178
    ds_read_u16_d16_hi v165, v12 offset:2432
    ds_read_u16_d16_hi v181, v12 offset:2434
    ds_read_u16_d16_hi v166, v12 offset:2688
    ds_read_u16_d16_hi v182, v12 offset:2690
    ds_read_u16_d16_hi v167, v12 offset:2944
    ds_read_u16_d16_hi v183, v12 offset:2946
    ds_read_u16_d16_hi v168, v12 offset:4224
    ds_read_u16_d16_hi v184, v12 offset:4226
    ds_read_u16_d16_hi v169, v12 offset:4480
    ds_read_u16_d16_hi v185, v12 offset:4482
    ds_read_u16_d16_hi v170, v12 offset:4736
    ds_read_u16_d16_hi v186, v12 offset:4738
    ds_read_u16_d16_hi v171, v12 offset:4992
    ds_read_u16_d16_hi v187, v12 offset:4994
    ds_read_u16_d16_hi v172, v12 offset:6272
    ds_read_u16_d16_hi v188, v12 offset:6274
    ds_read_u16_d16_hi v173, v12 offset:6528
    ds_read_u16_d16_hi v189, v12 offset:6530
    ds_read_u16_d16_hi v174, v12 offset:6784
    ds_read_u16_d16_hi v190, v12 offset:6786
    ds_read_u16_d16_hi v175, v12 offset:7040
    ds_read_u16_d16_hi v191, v12 offset:7042
    s_waitcnt lgkmcnt(0)
    s_cmp_eq_u32 s50, 3
    s_cbranch_scc1 M_noinit
    s_cmp_ge_u32 s26, 4
    s_cbranch_scc1 M_noacc
    s_barrier
    s_mov_b32 s50, 0
    s_cmp_eq_u32 s48, 0
    s_cbranch_scc1 M_noacc
    s_mov_b32 s70, 1
    s_waitcnt vmcnt(0)
    s_branch M_noinit
M_noacc:
    s_cmp_eq_u32 s48, 0
    s_cbranch_scc1 M_nob
    ds_read_b32 v64, v5 offset:12
    ds_read_b32 v65, v5 offset:140
    ds_read_b32 v66, v5 offset:268
    ds_read_b32 v67, v5 offset:396
    s_waitcnt lgkmcnt(3)
    v_and_or_b32 v64, v1, s63, v64
    s_waitcnt lgkmcnt(2)
    v_and_or_b32 v65, v1, s63, v65
    s_waitcnt lgkmcnt(1)
    v_and_or_b32 v66, v1, s63, v66
    s_waitcnt lgkmcnt(0)
    v_and_or_b32 v67, v1, s63, v67
    s_add_u32 m0, s51, 0
    s_nop 0
    buffer_load_dwordx4 v64, s[28:31], s64 offen lds
    s_add_u32 m0, s51, 1024
    s_nop 0
    buffer_load_dwordx4 v64, s[28:31], s65 offen lds
    s_add_u32 m0, s51, 2048
    s_nop 0
    buffer_load_dwordx4 v64, s[28:31], s66 offen lds
    s_add_u32 m0, s51, 3072
    s_nop 0
    buffer_load_dwordx4 v65, s[28:31], s64 offen lds
    s_add_u32 m0, s51, 4096
    s_nop 0
    buffer_load_dwordx4 v65, s[28:31], s65 offen lds
    s_add_u32 m0, s51, 5120
    s_nop 0
    buffer_load_dwordx4 v65, s[28:31], s66 offen lds
    s_add_u32 m0, s51, 6144
    s_nop 0
    buffer_load_dwordx4 v66, s[28:31], s64 offen lds
    s_add_u32 m0, s51, 7168
    s_nop 0
    buffer_load_dwordx4 v66, s[28:31], s65 offen lds
    s_add_u32 m0, s51, 8192
    s_nop 0
    buffer_load_dwordx4 v66, s[28:31], s66 offen lds
    s_add_u32 m0, s51, 9216
    s_nop 0
    buffer_load_dwordx4 v67, s[28:31], s64 offen lds
    s_add_u32 m0, s51, 10240
    s_nop 0
    buffer_load_dwordx4 v67, s[28:31], s65 offen lds
    s_add_u32 m0, s51, 11264
    s_nop 0
    buffer_load_dwordx4 v67, s[28:31], s66 offen lds
    s_branch M_noinit
M_nob:
    s_cmp_eq_u32 s76, 0
    s_cbranch_scc1 M_noinit
    v_lshrrev_b32 v64, 7, v1
    v_and_b32 v65, 1, v64
    v_lshrrev_b32 v64, 1, v64
    v_lshl_add_u32 v64, v65, 2, v64
    v_lshlrev_b32 v64, 9, v64
    v_and_or_b32 v64, v1, s63, v64
    s_add_u32 m0, s51, 1024
    s_add_u32 s53, s40, 256
    buffer_load_dwordx4 v64, s[4:7], s53 offen  lds
    s_add_u32 m0, s51, 2048
    s_add_u32 s53, s40, 384
    buffer_load_dwordx4 v64, s[4:7], s53 offen  lds
    s_add_u32 m0, s51, 4096
    s_add_u32 s53, s41, 256
    buffer_load_dwordx4 v64, s[4:7], s53 offen  lds
    s_add_u32 m0, s51, 5120
    s_add_u32 s53, s41, 384
    buffer_load_dwordx4 v64, s[4:7], s53 offen  lds
    s_add_u32 m0, s51, 7168
    s_add_u32 s53, s42, 256
    buffer_load_dwordx4 v64, s[4:7], s53 offen  lds
    s_add_u32 m0, s51, 8192
    s_add_u32 s53, s42, 384
    buffer_load_dwordx4 v64, s[4:7], s53 offen  lds
    s_add_u32 m0, s51, 10240
    s_add_u32 s53, s43, 256
    buffer_load_dwordx4 v64, s[4:7], s53 offen  lds
    s_add_u32 m0, s51, 11264
    s_add_u32 s53, s43, 384
    buffer_load_dwordx4 v64, s[4:7], s53 offen  lds
M_noinit:
    s_cmp_eq_u32 s50, 0
    s_cbranch_scc1 M_nod
    s_barrier
    s_mov_b32 s50, 0
M_nod:
    s_cmp_eq_u32 s48, 0
    s_cbranch_scc1 M_wend
    s_mov_b32 s49, 0
    s_cmp_lt_u32 s26, 4
    s_cbranch_scc1 M_yp
    s_setprio 1
M_yp:
    ds_read_b128 v[104:107], v3 offset:0
    ds_read_b128 v[72:75], v7
    ds_read_b128 v[76:79], v7 offset:16
    ds_read_b64 v[12:13], v4 offset:2048
    ds_read_b64 v[14:15], v4 offset:2160
    ds_read_b64 v[16:17], v4 offset:2272
    ds_read_b64 v[18:19], v4 offset:2384
    ds_read_b128 v[20:23], v1 offset:24576
    ds_read_b128 v[24:27], v1 offset:0
    ds_read_b128 v[28:31], v1 offset:1024
    s_waitcnt lgkmcnt(7)
    v_mul_f32 v72, v104, v72
    v_mul_f32 v73, v104, v73
    v_mul_f32 v74, v104, v74
    v_mul_f32 v75, v104, v75
    v_mul_f32 v76, v104, v76
    v_mul_f32 v77, v104, v77
    v_mul_f32 v78, v104, v78
    v_mul_f32 v79, v104, v79
    v_cvt_pk_bf16_f32 v72, 0, v72
    v_cvt_pk_bf16_f32 v73, 0, v73
    v_cvt_pk_bf16_f32 v74, 0, v74
    v_cvt_pk_bf16_f32 v75, 0, v75
    v_cvt_pk_bf16_f32 v76, 0, v76
    v_cvt_pk_bf16_f32 v77, 0, v77
    v_cvt_pk_bf16_f32 v78, 0, v78
    v_cvt_pk_bf16_f32 v79, 0, v79
    v_mul_f32 v72, s61, v72
    v_mul_f32 v73, s61, v73
    v_mul_f32 v74, s61, v74
    v_mul_f32 v75, s61, v75
    v_mul_f32 v76, s61, v76
    v_mul_f32 v77, s61, v77
    v_mul_f32 v78, s61, v78
    v_mul_f32 v79, s61, v79
    v_sin_f32 v72, v72
    v_sin_f32 v73, v73
    v_sin_f32 v74, v74
    v_sin_f32 v75, v75
    v_sin_f32 v76, v76
    v_sin_f32 v77, v77
    v_sin_f32 v78, v78
    v_sin_f32 v79, v79
    v_mul_f32 v72, v72, v105
    v_mul_f32 v73, v73, v105
    v_mul_f32 v74, v74, v105
    v_mul_f32 v75, v75, v105
    v_mul_f32 v76, v76, v105
    v_mul_f32 v77, v77, v105
    v_mul_f32 v78, v78, v105
    v_mul_f32 v79, v79, v105
    v_cvt_pk_bf16_f32 v8, v72, v73
    v_cvt_pk_bf16_f32 v9, v74, v75
    v_cvt_pk_bf16_f32 v10, v76, v77
    v_cvt_pk_bf16_f32 v11, v78, v79
    s_waitcnt lgkmcnt(3)
    v_pk_lshlrev_b16 v12, v6, v12
    v_pk_lshlrev_b16 v13, v6, v13
    v_pk_lshlrev_b16 v14, v6, v14
    v_pk_lshlrev_b16 v15, v6, v15
    v_pk_lshlrev_b16 v16, v6, v16
    v_pk_lshlrev_b16 v17, v6, v17
    v_pk_lshlrev_b16 v18, v6, v18
    v_pk_lshlrev_b16 v19, v6, v19
    s_waitcnt lgkmcnt(0)
    s_nop 0
M_batch:
    s_waitcnt vmcnt(12)
    v_mfma_f32_32x32x16_bf16 v[80:95], v[8:11], v[20:23], 0
    ds_read_b128 v[20:23], v1 offset:2048
    s_add_u32 s77, s49, 1
    s_cmp_lt_u32 s77, s48
    s_cselect_b32 s77, 0, 0x40000000
    ds_read_b32 v63, v3 offset:524
    v_bfe_u32 v62, v1, 9, 1
    s_waitcnt lgkmcnt(0)
    v_lshrrev_b32 v63, 2, v63
    v_lshl_add_u32 v63, v62, 6, v63
    buffer_load_dwordx4 v[48:51], v63, s[72:75], s77 offen offset:0
    buffer_load_dwordx4 v[52:55], v63, s[72:75], s77 offen offset:16
    buffer_load_dwordx4 v[56:59], v63, s[72:75], s77 offen offset:32
    buffer_load_dwordx4 v[60:63], v63, s[72:75], s77 offen offset:48
    s_cmp_eq_u32 s70, 0
    s_cbranch_scc1 M_vb16
    ds_read_b32 v112, v5 offset:12
    ds_read_b32 v113, v5 offset:140
    s_waitcnt lgkmcnt(1)
    v_and_or_b32 v112, v1, s63, v112
    s_add_u32 m0, s51, 0
    s_nop 0
    buffer_load_dwordx4 v112, s[28:31], s64 offen lds
    s_add_u32 m0, s51, 1024
    s_nop 0
    buffer_load_dwordx4 v112, s[28:31], s65 offen lds
    s_add_u32 m0, s51, 2048
    s_nop 0
    buffer_load_dwordx4 v112, s[28:31], s66 offen lds
    s_waitcnt lgkmcnt(0)
    v_and_or_b32 v113, v1, s63, v113
    s_add_u32 m0, s51, 3072
    s_nop 0
    buffer_load_dwordx4 v113, s[28:31], s64 offen lds
    s_add_u32 m0, s51, 4096
    s_nop 0
    buffer_load_dwordx4 v113, s[28:31], s65 offen lds
    s_add_u32 m0, s51, 5120
    s_nop 0
    buffer_load_dwordx4 v113, s[28:31], s66 offen lds
M_vb16:
    v_mfma_f32_32x32x16_bf16 v[64:79], v[32:35], v[24:27], 0
    ds_read_b128 v[24:27], v1 offset:3072
    v_mfma_f32_32x32x16_bf16 v[64:79], v[36:39], v[28:31], v[64:79]
    ds_read_b128 v[28:31], v1 offset:25600
    v_mfma_f32_32x32x16_bf16 v[64:79], v[40:43], v[20:23], v[64:79]
    ds_read_b128 v[20:23], v1 offset:4096
    s_waitcnt lgkmcnt(2)
    v_mfma_f32_32x32x16_bf16 v[64:79], v[44:47], v[24:27], v[64:79]
    ds_read_b128 v[24:27], v1 offset:5120
    s_cmp_eq_u32 s70, 0
    s_nop 9
    s_cbranch_scc1 M_vb17
    ds_read_b32 v114, v5 offset:268
    s_waitcnt lgkmcnt(0)
    v_and_or_b32 v114, v1, s63, v114
    s_add_u32 m0, s51, 6144
    s_nop 0
    buffer_load_dwordx4 v114, s[28:31], s64 offen lds
    s_add_u32 m0, s51, 7168
    s_nop 0
    buffer_load_dwordx4 v114, s[28:31], s65 offen lds
    s_add_u32 m0, s51, 8192
    s_nop 0
    buffer_load_dwordx4 v114, s[28:31], s66 offen lds
M_vb17:
    s_waitcnt lgkmcnt(2)
    v_mfma_f32_32x32x16_bf16 v[112:127], v[8:11], v[28:31], 0
    ds_read_b128 v[28:31], v1 offset:6144
    s_waitcnt lgkmcnt(2)
    v_mfma_f32_32x32x16_bf16 v[96:111], v[32:35], v[20:23], 0
    ds_read_b128 v[20:23], v1 offset:7168
    v_mul_f32 v64, v64, v80
    v_mul_f32 v65, v65, v81
    v_mul_f32 v66, v66, v82
    v_mul_f32 v67, v67, v83
    v_mul_f32 v68, v68, v84
    v_mul_f32 v69, v69, v85
    s_waitcnt lgkmcnt(2)
    v_mfma_f32_32x32x16_bf16 v[96:111], v[36:39], v[24:27], v[96:111]
    ds_read_b128 v[24:27], v1 offset:26624
    v_mul_f32 v70, v70, v86
    v_mul_f32 v71, v71, v87
    v_mul_f32 v72, v72, v88
    v_mul_f32 v73, v73, v89
    v_mul_f32 v74, v74, v90
    v_mul_f32 v75, v75, v91
    v_mul_f32 v76, v76, v92
    s_waitcnt lgkmcnt(2)
    v_mfma_f32_32x32x16_bf16 v[96:111], v[40:43], v[28:31], v[96:111]
    ds_read_b128 v[28:31], v1 offset:8192
    v_mul_f32 v77, v77, v93
    v_mul_f32 v78, v78, v94
    v_mul_f32 v79, v79, v95
    v_cvt_pk_bf16_f32 v64, v64, v65
    v_cvt_pk_bf16_f32 v65, v66, v67
    v_cvt_pk_bf16_f32 v66, v68, v69
    s_waitcnt lgkmcnt(2)
    v_mfma_f32_32x32x16_bf16 v[96:111], v[44:47], v[20:23], v[96:111]
    ds_read_b128 v[20:23], v1 offset:9216
    v_cvt_pk_bf16_f32 v67, v70, v71
    v_cvt_pk_bf16_f32 v68, v72, v73
    v_cvt_pk_bf16_f32 v69, v74, v75
    v_cvt_pk_bf16_f32 v70, v76, v77
    v_cvt_pk_bf16_f32 v71, v78, v79
    v_mfma_f32_32x32x16_bf16 v[128:143], v[12:15], v[64:67], v[128:143]
    s_nop 0
    v_mfma_f32_32x32x16_bf16 v[128:143], v[16:19], v[68:71], v[128:143]
    s_cmp_eq_u32 s70, 0
    s_nop 10
    s_cbranch_scc1 M_vb18
    ds_read_b32 v72, v5 offset:396
    s_waitcnt lgkmcnt(0)
    v_and_or_b32 v72, v1, s63, v72
    s_add_u32 m0, s51, 9216
    s_nop 0
    buffer_load_dwordx4 v72, s[28:31], s64 offen lds
    s_add_u32 m0, s51, 10240
    s_nop 0
    buffer_load_dwordx4 v72, s[28:31], s65 offen lds
    s_add_u32 m0, s51, 11264
    s_nop 0
    buffer_load_dwordx4 v72, s[28:31], s66 offen lds
M_vb18:
    s_waitcnt lgkmcnt(2)
    v_mfma_f32_32x32x16_bf16 v[80:95], v[8:11], v[24:27], 0
    ds_read_b128 v[24:27], v1 offset:10240
    s_waitcnt lgkmcnt(2)
    v_mfma_f32_32x32x16_bf16 v[64:79], v[32:35], v[28:31], 0
    ds_read_b128 v[28:31], v1 offset:11264
    v_mul_f32 v96, v96, v112
    v_mul_f32 v97, v97, v113
    v_mul_f32 v98, v98, v114
    v_mul_f32 v99, v99, v115
    v_mul_f32 v100, v100, v116
    v_mul_f32 v101, v101, v117
    s_waitcnt lgkmcnt(2)
    v_mfma_f32_32x32x16_bf16 v[64:79], v[36:39], v[20:23], v[64:79]
    ds_read_b128 v[20:23], v1 offset:27648
    v_mul_f32 v102, v102, v118
    v_mul_f32 v103, v103, v119
    v_mul_f32 v104, v104, v120
    v_mul_f32 v105, v105, v121
    v_mul_f32 v106, v106, v122
    v_mul_f32 v107, v107, v123
    v_mul_f32 v108, v108, v124
    s_waitcnt lgkmcnt(2)
    v_mfma_f32_32x32x16_bf16 v[64:79], v[40:43], v[24:27], v[64:79]
    ds_read_b128 v[24:27], v1 offset:12288
    v_mul_f32 v109, v109, v125
    v_mul_f32 v110, v110, v126
    v_mul_f32 v111, v111, v127
    v_cvt_pk_bf16_f32 v96, v96, v97
    v_cvt_pk_bf16_f32 v97, v98, v99
    v_cvt_pk_bf16_f32 v98, v100, v101
    s_waitcnt lgkmcnt(2)
    v_mfma_f32_32x32x16_bf16 v[64:79], v[44:47], v[28:31], v[64:79]
    ds_read_b128 v[28:31], v1 offset:13312
    v_cvt_pk_bf16_f32 v99, v102, v103
    v_cvt_pk_bf16_f32 v100, v104, v105
    v_cvt_pk_bf16_f32 v101, v106, v107
    v_cvt_pk_bf16_f32 v102, v108, v109
    v_cvt_pk_bf16_f32 v103, v110, v111
    v_mfma_f32_32x32x16_bf16 v[144:159], v[12:15], v[96:99], v[144:159]
    s_nop 0
    v_mfma_f32_32x32x16_bf16 v[144:159], v[16:19], v[100:103], v[144:159]
    s_waitcnt lgkmcnt(2)
    v_mfma_f32_32x32x16_bf16 v[112:127], v[8:11], v[20:23], 0
    ds_read_b128 v[20:23], v1 offset:14336
    s_waitcnt lgkmcnt(2)
    v_mfma_f32_32x32x16_bf16 v[96:111], v[32:35], v[24:27], 0
    ds_read_b128 v[24:27], v1 offset:15360
    v_mul_f32 v64, v64, v80
    v_mul_f32 v65, v65, v81
    v_mul_f32 v66, v66, v82
    v_mul_f32 v67, v67, v83
    v_mul_f32 v68, v68, v84
    v_mul_f32 v69, v69, v85
    v_mul_f32 v70, v70, v86
    v_mul_f32 v71, v71, v87
    v_mul_f32 v72, v72, v88
    v_mul_f32 v73, v73, v89
    v_mul_f32 v74, v74, v90
    v_mul_f32 v75, v75, v91
    v_mul_f32 v76, v76, v92
    v_mul_f32 v77, v77, v93
    v_mul_f32 v78, v78, v94
    v_mul_f32 v79, v79, v95
    s_cmp_eq_u32 s70, 0
    s_nop 0
    s_cbranch_scc1 M_vw19
    s_waitcnt vmcnt(0)
    s_mov_b32 s70, 0
M_vw19:
    s_waitcnt vmcnt(4)
    ds_read_u16_d16_hi v80, v2 offset:0
    ds_read_u16_d16_hi v81, v2 offset:256
    ds_read_u16_d16_hi v82, v2 offset:512
    ds_read_u16_d16_hi v83, v2 offset:768
    ds_read_u16_d16_hi v84, v2 offset:3072
    ds_read_u16_d16_hi v85, v2 offset:3328
    ds_read_u16_d16_hi v86, v2 offset:3584
    ds_read_u16_d16_hi v87, v2 offset:3840
    ds_read_u16_d16_hi v88, v2 offset:6144
    ds_read_u16_d16_hi v89, v2 offset:6400
    ds_read_u16_d16_hi v90, v2 offset:6656
    ds_read_u16_d16_hi v91, v2 offset:6912
    ds_read_u16_d16_hi v92, v2 offset:9216
    ds_read_u16_d16_hi v93, v2 offset:9472
    ds_read_u16_d16_hi v94, v2 offset:9728
    ds_read_u16_d16_hi v95, v2 offset:9984
    s_waitcnt lgkmcnt(12)
    v_mul_f32 v80, v80, v64
    v_mul_f32 v81, v81, v65
    v_mul_f32 v82, v82, v66
    v_mul_f32 v83, v83, v67
    s_waitcnt lgkmcnt(8)
    v_mul_f32 v84, v84, v68
    v_mul_f32 v85, v85, v69
    v_mfma_f32_32x32x16_bf16 v[96:111], v[36:39], v[28:31], v[96:111]
    ds_read_b128 v[28:31], v1 offset:28672
    v_mul_f32 v86, v86, v70
    v_mul_f32 v87, v87, v71
    v_cvt_pk_bf16_f32 v80, v80, v81
    v_cvt_pk_bf16_f32 v81, v82, v83
    v_cvt_pk_bf16_f32 v82, v84, v85
    v_cvt_pk_bf16_f32 v83, v86, v87
    s_nop 1
    v_mfma_f32_32x32x16_bf16 v[160:175], v[12:15], v[80:83], v[160:175]
    ds_read_u16_d16_hi v80, v2 offset:1024
    ds_read_u16_d16_hi v81, v2 offset:1280
    ds_read_u16_d16_hi v82, v2 offset:1536
    ds_read_u16_d16_hi v83, v2 offset:1792
    ds_read_u16_d16_hi v84, v2 offset:4096
    ds_read_u16_d16_hi v85, v2 offset:4352
    ds_read_u16_d16_hi v86, v2 offset:4608
    ds_read_u16_d16_hi v87, v2 offset:4864
    s_waitcnt lgkmcnt(13)
    v_mul_f32 v88, v88, v72
    v_mul_f32 v89, v89, v73
    v_mul_f32 v90, v90, v74
    v_mul_f32 v91, v91, v75
    s_waitcnt lgkmcnt(9)
    v_mul_f32 v92, v92, v76
    v_mul_f32 v93, v93, v77
    v_mul_f32 v94, v94, v78
    v_mul_f32 v95, v95, v79
    v_cvt_pk_bf16_f32 v88, v88, v89
    v_cvt_pk_bf16_f32 v89, v90, v91
    v_cvt_pk_bf16_f32 v90, v92, v93
    v_cvt_pk_bf16_f32 v91, v94, v95
    s_nop 1
    v_mfma_f32_32x32x16_bf16 v[160:175], v[16:19], v[88:91], v[160:175]
    ds_read_u16_d16_hi v88, v2 offset:7168
    ds_read_u16_d16_hi v89, v2 offset:7424
    ds_read_u16_d16_hi v90, v2 offset:7680
    ds_read_u16_d16_hi v91, v2 offset:7936
    ds_read_u16_d16_hi v92, v2 offset:10240
    ds_read_u16_d16_hi v93, v2 offset:10496
    ds_read_u16_d16_hi v94, v2 offset:10752
    ds_read_u16_d16_hi v95, v2 offset:11008
    s_waitcnt lgkmcnt(12)
    v_mul_f32 v80, v80, v64
    v_mul_f32 v81, v81, v65
    v_mul_f32 v82, v82, v66
    v_mfma_f32_32x32x16_bf16 v[96:111], v[40:43], v[20:23], v[96:111]
    ds_read_b128 v[20:23], v1 offset:16384
    v_mul_f32 v83, v83, v67
    s_waitcnt lgkmcnt(9)
    v_mul_f32 v84, v84, v68
    v_mul_f32 v85, v85, v69
    v_mul_f32 v86, v86, v70
    v_mul_f32 v87, v87, v71
    v_cvt_pk_bf16_f32 v80, v80, v81
    v_cvt_pk_bf16_f32 v81, v82, v83
    v_cvt_pk_bf16_f32 v82, v84, v85
    v_cvt_pk_bf16_f32 v83, v86, v87
    s_nop 1
    v_mfma_f32_32x32x16_bf16 v[192:207], v[12:15], v[80:83], v[192:207]
    ds_read_u16_d16_hi v80, v2 offset:2048
    ds_read_u16_d16_hi v81, v2 offset:2304
    ds_read_u16_d16_hi v82, v2 offset:2560
    ds_read_u16_d16_hi v83, v2 offset:2816
    ds_read_u16_d16_hi v84, v2 offset:5120
    ds_read_u16_d16_hi v85, v2 offset:5376
    ds_read_u16_d16_hi v86, v2 offset:5632
    ds_read_u16_d16_hi v87, v2 offset:5888
    s_waitcnt lgkmcnt(13)
    v_mul_f32 v88, v88, v72
    v_mul_f32 v89, v89, v73
    v_mul_f32 v90, v90, v74
    v_mul_f32 v91, v91, v75
    s_waitcnt lgkmcnt(9)
    v_mul_f32 v92, v92, v76
    v_mul_f32 v93, v93, v77
    v_mul_f32 v94, v94, v78
    v_mul_f32 v95, v95, v79
    v_cvt_pk_bf16_f32 v88, v88, v89
    v_cvt_pk_bf16_f32 v89, v90, v91
    v_cvt_pk_bf16_f32 v90, v92, v93
    v_cvt_pk_bf16_f32 v91, v94, v95
    s_nop 1
    v_mfma_f32_32x32x16_bf16 v[192:207], v[16:19], v[88:91], v[192:207]
    ds_read_u16_d16_hi v88, v2 offset:8192
    ds_read_u16_d16_hi v89, v2 offset:8448
    ds_read_u16_d16_hi v90, v2 offset:8704
    ds_read_u16_d16_hi v91, v2 offset:8960
    ds_read_u16_d16_hi v92, v2 offset:11264
    ds_read_u16_d16_hi v93, v2 offset:11520
    ds_read_u16_d16_hi v94, v2 offset:11776
    ds_read_u16_d16_hi v95, v2 offset:12032
    v_mfma_f32_32x32x16_bf16 v[96:111], v[44:47], v[24:27], v[96:111]
    ds_read_b128 v[24:27], v1 offset:17408
    s_waitcnt lgkmcnt(13)
    v_mul_f32 v80, v80, v64
    v_mul_f32 v81, v81, v65
    v_mul_f32 v82, v82, v66
    v_mul_f32 v83, v83, v67
    s_waitcnt lgkmcnt(9)
    v_mul_f32 v84, v84, v68
    v_mul_f32 v85, v85, v69
    v_mul_f32 v86, v86, v70
    v_mul_f32 v87, v87, v71
    v_cvt_pk_bf16_f32 v80, v80, v81
    v_cvt_pk_bf16_f32 v81, v82, v83
    v_cvt_pk_bf16_f32 v82, v84, v85
    v_cvt_pk_bf16_f32 v83, v86, v87
    s_nop 1
    v_mfma_f32_32x32x16_bf16 v[224:239], v[12:15], v[80:83], v[224:239]
    s_waitcnt lgkmcnt(5)
    v_mul_f32 v88, v88, v72
    v_mul_f32 v89, v89, v73
    v_mul_f32 v90, v90, v74
    v_mul_f32 v91, v91, v75
    s_waitcnt lgkmcnt(1)
    v_mul_f32 v92, v92, v76
    v_mul_f32 v93, v93, v77
    v_mul_f32 v94, v94, v78
    v_mul_f32 v95, v95, v79
    v_cvt_pk_bf16_f32 v88, v88, v89
    v_cvt_pk_bf16_f32 v89, v90, v91
    v_cvt_pk_bf16_f32 v90, v92, v93
    v_cvt_pk_bf16_f32 v91, v94, v95
    s_nop 1
    v_mfma_f32_32x32x16_bf16 v[224:239], v[16:19], v[88:91], v[224:239]
    v_mfma_f32_32x32x16_bf16 v[80:95], v[8:11], v[28:31], 0
    ds_read_b128 v[28:31], v1 offset:18432
    v_mfma_f32_32x32x16_bf16 v[64:79], v[32:35], v[20:23], 0
    ds_read_b128 v[20:23], v1 offset:19456
    v_mul_f32 v96, v96, v112
    v_mul_f32 v97, v97, v113
    v_mul_f32 v98, v98, v114
    v_mul_f32 v99, v99, v115
    v_mul_f32 v100, v100, v116
    v_mul_f32 v101, v101, v117
    v_mul_f32 v102, v102, v118
    v_mul_f32 v103, v103, v119
    v_mul_f32 v104, v104, v120
    v_mul_f32 v105, v105, v121
    v_mul_f32 v106, v106, v122
    v_mul_f32 v107, v107, v123
    v_mul_f32 v108, v108, v124
    v_mul_f32 v109, v109, v125
    v_mul_f32 v110, v110, v126
    v_mul_f32 v111, v111, v127
    ds_read_u16_d16_hi v112, v2 offset:2
    ds_read_u16_d16_hi v113, v2 offset:258
    ds_read_u16_d16_hi v114, v2 offset:514
    ds_read_u16_d16_hi v115, v2 offset:770
    ds_read_u16_d16_hi v116, v2 offset:3074
    ds_read_u16_d16_hi v117, v2 offset:3330
    ds_read_u16_d16_hi v118, v2 offset:3586
    ds_read_u16_d16_hi v119, v2 offset:3842
    ds_read_u16_d16_hi v120, v2 offset:6146
    ds_read_u16_d16_hi v121, v2 offset:6402
    ds_read_u16_d16_hi v122, v2 offset:6658
    ds_read_u16_d16_hi v123, v2 offset:6914
    ds_read_u16_d16_hi v124, v2 offset:9218
    ds_read_u16_d16_hi v125, v2 offset:9474
    ds_read_u16_d16_hi v126, v2 offset:9730
    ds_read_u16_d16_hi v127, v2 offset:9986
    s_waitcnt lgkmcnt(12)
    v_mul_f32 v112, v112, v96
    v_mul_f32 v113, v113, v97
    v_mul_f32 v114, v114, v98
    v_mul_f32 v115, v115, v99
    s_waitcnt lgkmcnt(8)
    v_mul_f32 v116, v116, v100
    v_mul_f32 v117, v117, v101
    v_mul_f32 v118, v118, v102
    v_mfma_f32_32x32x16_bf16 v[64:79], v[36:39], v[24:27], v[64:79]
    ds_read_b128 v[24:27], v1 offset:29696
    v_mul_f32 v119, v119, v103
    v_cvt_pk_bf16_f32 v112, v112, v113
    v_cvt_pk_bf16_f32 v113, v114, v115
    v_cvt_pk_bf16_f32 v114, v116, v117
    v_cvt_pk_bf16_f32 v115, v118, v119
    s_nop 1
    v_mfma_f32_32x32x16_bf16 v[176:191], v[12:15], v[112:115], v[176:191]
    ds_read_u16_d16_hi v112, v2 offset:1026
    ds_read_u16_d16_hi v113, v2 offset:1282
    ds_read_u16_d16_hi v114, v2 offset:1538
    ds_read_u16_d16_hi v115, v2 offset:1794
    ds_read_u16_d16_hi v116, v2 offset:4098
    ds_read_u16_d16_hi v117, v2 offset:4354
    ds_read_u16_d16_hi v118, v2 offset:4610
    ds_read_u16_d16_hi v119, v2 offset:4866
    s_waitcnt lgkmcnt(13)
    v_mul_f32 v120, v120, v104
    v_mul_f32 v121, v121, v105
    v_mul_f32 v122, v122, v106
    v_mul_f32 v123, v123, v107
    s_waitcnt lgkmcnt(9)
    v_mul_f32 v124, v124, v108
    v_mul_f32 v125, v125, v109
    v_mul_f32 v126, v126, v110
    v_mul_f32 v127, v127, v111
    v_cvt_pk_bf16_f32 v120, v120, v121
    v_cvt_pk_bf16_f32 v121, v122, v123
    v_cvt_pk_bf16_f32 v122, v124, v125
    v_cvt_pk_bf16_f32 v123, v126, v127
    s_nop 1
    v_mfma_f32_32x32x16_bf16 v[176:191], v[16:19], v[120:123], v[176:191]
    ds_read_u16_d16_hi v120, v2 offset:7170
    ds_read_u16_d16_hi v121, v2 offset:7426
    ds_read_u16_d16_hi v122, v2 offset:7682
    ds_read_u16_d16_hi v123, v2 offset:7938
    ds_read_u16_d16_hi v124, v2 offset:10242
    ds_read_u16_d16_hi v125, v2 offset:10498
    ds_read_u16_d16_hi v126, v2 offset:10754
    ds_read_u16_d16_hi v127, v2 offset:11010
    s_waitcnt lgkmcnt(12)
    v_mul_f32 v112, v112, v96
    v_mul_f32 v113, v113, v97
    v_mul_f32 v114, v114, v98
    v_mul_f32 v115, v115, v99
    v_mfma_f32_32x32x16_bf16 v[64:79], v[40:43], v[28:31], v[64:79]
    ds_read_b128 v[28:31], v1 offset:20480
    s_waitcnt lgkmcnt(9)
    v_mul_f32 v116, v116, v100
    v_mul_f32 v117, v117, v101
    v_mul_f32 v118, v118, v102
    v_mul_f32 v119, v119, v103
    v_cvt_pk_bf16_f32 v112, v112, v113
    v_cvt_pk_bf16_f32 v113, v114, v115
    v_cvt_pk_bf16_f32 v114, v116, v117
    v_cvt_pk_bf16_f32 v115, v118, v119
    s_nop 1
    v_mfma_f32_32x32x16_bf16 v[208:223], v[12:15], v[112:115], v[208:223]
    ds_read_u16_d16_hi v112, v2 offset:2050
    ds_read_u16_d16_hi v113, v2 offset:2306
    ds_read_u16_d16_hi v114, v2 offset:2562
    ds_read_u16_d16_hi v115, v2 offset:2818
    ds_read_u16_d16_hi v116, v2 offset:5122
    ds_read_u16_d16_hi v117, v2 offset:5378
    ds_read_u16_d16_hi v118, v2 offset:5634
    ds_read_u16_d16_hi v119, v2 offset:5890
    s_waitcnt lgkmcnt(13)
    v_mul_f32 v120, v120, v104
    v_mul_f32 v121, v121, v105
    v_mul_f32 v122, v122, v106
    v_mul_f32 v123, v123, v107
    s_waitcnt lgkmcnt(9)
    v_mul_f32 v124, v124, v108
    v_mul_f32 v125, v125, v109
    v_mul_f32 v126, v126, v110
    v_mul_f32 v127, v127, v111
    v_cvt_pk_bf16_f32 v120, v120, v121
    v_cvt_pk_bf16_f32 v121, v122, v123
    v_cvt_pk_bf16_f32 v122, v124, v125
    v_cvt_pk_bf16_f32 v123, v126, v127
    s_nop 1
    v_mfma_f32_32x32x16_bf16 v[208:223], v[16:19], v[120:123], v[208:223]
    ds_read_u16_d16_hi v120, v2 offset:8194
    ds_read_u16_d16_hi v121, v2 offset:8450
    ds_read_u16_d16_hi v122, v2 offset:8706
    ds_read_u16_d16_hi v123, v2 offset:8962
    ds_read_u16_d16_hi v124, v2 offset:11266
    ds_read_u16_d16_hi v125, v2 offset:11522
    ds_read_u16_d16_hi v126, v2 offset:11778
    ds_read_u16_d16_hi v127, v2 offset:12034
    s_waitcnt lgkmcnt(12)
    v_mul_f32 v112, v112, v96
    v_mfma_f32_32x32x16_bf16 v[64:79], v[44:47], v[20:23], v[64:79]
    ds_read_b128 v[20:23], v1 offset:21504
    v_mul_f32 v113, v113, v97
    v_mul_f32 v114, v114, v98
    v_mul_f32 v115, v115, v99
    s_waitcnt lgkmcnt(9)
    v_mul_f32 v116, v116, v100
    v_mul_f32 v117, v117, v101
    v_mul_f32 v118, v118, v102
    v_mul_f32 v119, v119, v103
    v_cvt_pk_bf16_f32 v112, v112, v113
    v_cvt_pk_bf16_f32 v113, v114, v115
    v_cvt_pk_bf16_f32 v114, v116, v117
    v_cvt_pk_bf16_f32 v115, v118, v119
    s_nop 1
    v_mfma_f32_32x32x16_bf16 v[240:255], v[12:15], v[112:115], v[240:255]
    s_waitcnt lgkmcnt(5)
    v_mul_f32 v120, v120, v104
    v_mul_f32 v121, v121, v105
    v_mul_f32 v122, v122, v106
    v_mul_f32 v123, v123, v107
    s_waitcnt lgkmcnt(1)
    v_mul_f32 v124, v124, v108
    v_mul_f32 v125, v125, v109
    v_mul_f32 v126, v126, v110
    v_mul_f32 v127, v127, v111
    v_cvt_pk_bf16_f32 v120, v120, v121
    v_cvt_pk_bf16_f32 v121, v122, v123
    v_cvt_pk_bf16_f32 v122, v124, v125
    v_cvt_pk_bf16_f32 v123, v126, v127
    s_nop 1
    v_mfma_f32_32x32x16_bf16 v[240:255], v[16:19], v[120:123], v[240:255]
    s_cmp_lg_u32 s77, 0
    s_nop 10
    s_cbranch_scc1 M_nv20
    ds_read_b32 v112, v5 offset:524
    ds_read_b32 v113, v5 offset:652
    ds_read_b32 v114, v5 offset:780
    ds_read_b32 v115, v5 offset:908
    s_waitcnt lgkmcnt(3)
    v_and_or_b32 v112, v1, s63, v112
    s_waitcnt lgkmcnt(2)
    v_and_or_b32 v113, v1, s63, v113
    s_waitcnt lgkmcnt(1)
    v_and_or_b32 v114, v1, s63, v114
    s_waitcnt lgkmcnt(0)
    v_and_or_b32 v115, v1, s63, v115
    s_add_u32 m0, s51, 0
    s_nop 0
    buffer_load_dwordx4 v112, s[28:31], s64 offen lds
    s_add_u32 m0, s51, 1024
    s_nop 0
    buffer_load_dwordx4 v112, s[28:31], s65 offen lds
    s_add_u32 m0, s51, 2048
    s_nop 0
    buffer_load_dwordx4 v112, s[28:31], s66 offen lds
    s_add_u32 m0, s51, 3072
    s_nop 0
    buffer_load_dwordx4 v113, s[28:31], s64 offen lds
    s_add_u32 m0, s51, 4096
    s_nop 0
    buffer_load_dwordx4 v113, s[28:31], s65 offen lds
    s_add_u32 m0, s51, 5120
    s_nop 0
    buffer_load_dwordx4 v113, s[28:31], s66 offen lds
    s_add_u32 m0, s51, 6144
    s_nop 0
    buffer_load_dwordx4 v114, s[28:31], s64 offen lds
    s_add_u32 m0, s51, 7168
    s_nop 0
    buffer_load_dwordx4 v114, s[28:31], s65 offen lds
    s_add_u32 m0, s51, 8192
    s_nop 0
    buffer_load_dwordx4 v114, s[28:31], s66 offen lds
    s_add_u32 m0, s51, 9216
    s_nop 0
    buffer_load_dwordx4 v115, s[28:31], s64 offen lds
    s_add_u32 m0, s51, 10240
    s_nop 0
    buffer_load_dwordx4 v115, s[28:31], s65 offen lds
    s_add_u32 m0, s51, 11264
    s_nop 0
    buffer_load_dwordx4 v115, s[28:31], s66 offen lds
    s_branch M_nj20
M_nv20:
    s_cmp_eq_u32 s76, 0
    s_cbranch_scc1 M_nj20
    v_lshrrev_b32 v112, 7, v1
    v_and_b32 v113, 1, v112
    v_lshrrev_b32 v112, 1, v112
    v_lshl_add_u32 v112, v113, 2, v112
    v_lshlrev_b32 v112, 9, v112
    v_and_or_b32 v112, v1, s63, v112
    s_add_u32 m0, s51, 1024
    s_add_u32 s53, s40, 256
    buffer_load_dwordx4 v112, s[4:7], s53 offen  lds
    s_add_u32 m0, s51, 2048
    s_add_u32 s53, s40, 384
    buffer_load_dwordx4 v112, s[4:7], s53 offen  lds
    s_add_u32 m0, s51, 4096
    s_add_u32 s53, s41, 256
    buffer_load_dwordx4 v112, s[4:7], s53 offen  lds
    s_add_u32 m0, s51, 5120
    s_add_u32 s53, s41, 384
    buffer_load_dwordx4 v112, s[4:7], s53 offen  lds
    s_add_u32 m0, s51, 7168
    s_add_u32 s53, s42, 256
    buffer_load_dwordx4 v112, s[4:7], s53 offen  lds
    s_add_u32 m0, s51, 8192
    s_add_u32 s53, s42, 384
    buffer_load_dwordx4 v112, s[4:7], s53 offen  lds
    s_add_u32 m0, s51, 10240
    s_add_u32 s53, s43, 256
    buffer_load_dwordx4 v112, s[4:7], s53 offen  lds
    s_add_u32 m0, s51, 11264
    s_add_u32 s53, s43, 384
    buffer_load_dwordx4 v112, s[4:7], s53 offen  lds
M_nj20:
    v_mfma_f32_32x32x16_bf16 v[112:127], v[8:11], v[24:27], 0
    ds_read_b128 v[24:27], v1 offset:22528
    v_mfma_f32_32x32x16_bf16 v[96:111], v[32:35], v[28:31], 0
    ds_read_b128 v[28:31], v1 offset:23552
    v_mul_f32 v64, v64, v80
    v_mul_f32 v65, v65, v81
    v_mul_f32 v66, v66, v82
    v_mul_f32 v67, v67, v83
    v_mul_f32 v68, v68, v84
    v_mul_f32 v69, v69, v85
    v_mul_f32 v70, v70, v86
    v_mul_f32 v71, v71, v87
    v_mul_f32 v72, v72, v88
    v_mul_f32 v73, v73, v89
    v_mul_f32 v74, v74, v90
    v_mul_f32 v75, v75, v91
    s_waitcnt lgkmcnt(2)
    v_mfma_f32_32x32x16_bf16 v[96:111], v[36:39], v[20:23], v[96:111]
    v_mul_f32 v76, v76, v92
    v_mul_f32 v77, v77, v93
    v_mul_f32 v78, v78, v94
    v_mul_f32 v79, v79, v95
    ds_read_b64 v[80:81], v0 offset:2080
    ds_read_b64 v[88:89], v0 offset:2088
    ds_read_b64 v[82:83], v0 offset:2192
    ds_read_b64 v[90:91], v0 offset:2200
    ds_read_b64 v[84:85], v0 offset:2304
    ds_read_b64 v[92:93], v0 offset:2312
    ds_read_b64 v[86:87], v0 offset:2416
    ds_read_b64 v[94:95], v0 offset:2424
    v_cvt_pk_bf16_f32 v64, v64, v65
    v_cvt_pk_bf16_f32 v65, v66, v67
    v_cvt_pk_bf16_f32 v66, v68, v69
    v_cvt_pk_bf16_f32 v67, v70, v71
    v_cvt_pk_bf16_f32 v68, v72, v73
    v_cvt_pk_bf16_f32 v69, v74, v75
    v_cvt_pk_bf16_f32 v70, v76, v77
    s_waitcnt lgkmcnt(9)
    v_mfma_f32_32x32x16_bf16 v[96:111], v[40:43], v[24:27], v[96:111]
    v_cvt_pk_bf16_f32 v71, v78, v79
    v_pk_lshrrev_b16 v72, 14, v12 op_sel_hi:[0,1]
    v_pk_lshrrev_b16 v73, 14, v13 op_sel_hi:[0,1]
    v_pk_lshrrev_b16 v74, 14, v14 op_sel_hi:[0,1]
    v_pk_lshrrev_b16 v75, 14, v15 op_sel_hi:[0,1]
    v_pk_lshrrev_b16 v76, 14, v16 op_sel_hi:[0,1]
    v_pk_lshrrev_b16 v77, 14, v17 op_sel_hi:[0,1]
    v_pk_lshrrev_b16 v78, 14, v18 op_sel_hi:[0,1]
    v_pk_lshrrev_b16 v79, 14, v19 op_sel_hi:[0,1]
    s_waitcnt lgkmcnt(0)
    v_pk_mul_lo_u16 v80, v72, v80
    v_pk_mul_lo_u16 v81, v73, v81
    v_pk_mul_lo_u16 v82, v74, v82
    v_mfma_f32_32x32x16_bf16 v[96:111], v[44:47], v[28:31], v[96:111]
    v_pk_mul_lo_u16 v83, v75, v83
    v_pk_mul_lo_u16 v84, v76, v84
    v_pk_mul_lo_u16 v85, v77, v85
    v_pk_mul_lo_u16 v86, v78, v86
    v_pk_mul_lo_u16 v87, v79, v87
    v_pk_mul_lo_u16 v88, v72, v88
    v_pk_mul_lo_u16 v89, v73, v89
    v_pk_mul_lo_u16 v90, v74, v90
    v_pk_mul_lo_u16 v91, v75, v91
    v_pk_mul_lo_u16 v92, v76, v92
    v_pk_mul_lo_u16 v93, v77, v93
    v_pk_mul_lo_u16 v94, v78, v94
    v_pk_mul_lo_u16 v95, v79, v95
    v_mfma_f32_32x32x16_bf16 v[160:175], v[80:83], v[64:67], v[160:175]
    v_mul_f32 v96, v96, v112
    v_mul_f32 v97, v97, v113
    v_mul_f32 v98, v98, v114
    v_mul_f32 v99, v99, v115
    v_mul_f32 v100, v100, v116
    v_mul_f32 v101, v101, v117
    v_mfma_f32_32x32x16_bf16 v[160:175], v[84:87], v[68:71], v[160:175]
    v_mul_f32 v102, v102, v118
    v_mul_f32 v103, v103, v119
    v_mul_f32 v104, v104, v120
    v_mul_f32 v105, v105, v121
    v_mul_f32 v106, v106, v122
    v_mul_f32 v107, v107, v123
    v_mfma_f32_32x32x16_bf16 v[192:207], v[88:91], v[64:67], v[192:207]
    v_mul_f32 v108, v108, v124
    v_mul_f32 v109, v109, v125
    v_mul_f32 v110, v110, v126
    v_mul_f32 v111, v111, v127
    ds_read_b64 v[112:113], v0 offset:2096
    ds_read_b64 v[114:115], v0 offset:2208
    ds_read_b64 v[116:117], v0 offset:2320
    ds_read_b64 v[118:119], v0 offset:2432
    v_cvt_pk_bf16_f32 v96, v96, v97
    v_mfma_f32_32x32x16_bf16 v[192:207], v[92:95], v[68:71], v[192:207]
    v_cvt_pk_bf16_f32 v97, v98, v99
    v_cvt_pk_bf16_f32 v98, v100, v101
    v_cvt_pk_bf16_f32 v99, v102, v103
    v_cvt_pk_bf16_f32 v100, v104, v105
    v_cvt_pk_bf16_f32 v101, v106, v107
    v_cvt_pk_bf16_f32 v102, v108, v109
    v_cvt_pk_bf16_f32 v103, v110, v111
    s_waitcnt lgkmcnt(0)
    v_pk_mul_lo_u16 v112, v72, v112
    v_pk_mul_lo_u16 v113, v73, v113
    v_pk_mul_lo_u16 v114, v74, v114
    v_pk_mul_lo_u16 v115, v75, v115
    v_pk_mul_lo_u16 v116, v76, v116
    v_pk_mul_lo_u16 v117, v77, v117
    v_pk_mul_lo_u16 v118, v78, v118
    v_pk_mul_lo_u16 v119, v79, v119
    v_mfma_f32_32x32x16_bf16 v[176:191], v[80:83], v[96:99], v[176:191]
    ds_read_b128 v[104:107], v3 offset:512
    ds_read_b128 v[72:75], v7
    ds_read_b128 v[76:79], v7 offset:16
    ds_read_b64 v[12:13], v4 offset:2496
    ds_read_b64 v[14:15], v4 offset:2608
    ds_read_b64 v[16:17], v4 offset:2720
    ds_read_b64 v[18:19], v4 offset:2832
    ds_read_b128 v[20:23], v1 offset:24576
    ds_read_b128 v[24:27], v1 offset:0
    ds_read_b128 v[28:31], v1 offset:1024
    s_waitcnt lgkmcnt(7)
    v_mul_f32 v72, v104, v72
    v_mul_f32 v73, v104, v73
    v_mul_f32 v74, v104, v74
    v_mul_f32 v75, v104, v75
    v_mul_f32 v76, v104, v76
    v_mfma_f32_32x32x16_bf16 v[176:191], v[84:87], v[100:103], v[176:191]
    v_mul_f32 v77, v104, v77
    v_mul_f32 v78, v104, v78
    v_mul_f32 v79, v104, v79
    v_cvt_pk_bf16_f32 v72, 0, v72
    v_cvt_pk_bf16_f32 v73, 0, v73
    v_cvt_pk_bf16_f32 v74, 0, v74
    v_cvt_pk_bf16_f32 v75, 0, v75
    v_mfma_f32_32x32x16_bf16 v[208:223], v[88:91], v[96:99], v[208:223]
    v_cvt_pk_bf16_f32 v76, 0, v76
    v_cvt_pk_bf16_f32 v77, 0, v77
    v_cvt_pk_bf16_f32 v78, 0, v78
    v_cvt_pk_bf16_f32 v79, 0, v79
    v_mul_f32 v72, s61, v72
    v_mul_f32 v73, s61, v73
    v_mfma_f32_32x32x16_bf16 v[208:223], v[92:95], v[100:103], v[208:223]
    v_mul_f32 v74, s61, v74
    v_mul_f32 v75, s61, v75
    v_mul_f32 v76, s61, v76
    v_mul_f32 v77, s61, v77
    v_mul_f32 v78, s61, v78
    v_mul_f32 v79, s61, v79
    v_sin_f32 v72, v72
    v_mfma_f32_32x32x16_bf16 v[224:239], v[112:115], v[64:67], v[224:239]
    v_sin_f32 v73, v73
    v_sin_f32 v74, v74
    v_sin_f32 v75, v75
    v_sin_f32 v76, v76
    v_sin_f32 v77, v77
    v_sin_f32 v78, v78
    v_sin_f32 v79, v79
    v_mfma_f32_32x32x16_bf16 v[240:255], v[112:115], v[96:99], v[240:255]
    v_mul_f32 v72, v72, v105
    v_mul_f32 v73, v73, v105
    v_mul_f32 v74, v74, v105
    v_mul_f32 v75, v75, v105
    v_mul_f32 v76, v76, v105
    v_mul_f32 v77, v77, v105
    v_mfma_f32_32x32x16_bf16 v[224:239], v[116:119], v[68:71], v[224:239]
    v_mul_f32 v78, v78, v105
    v_mul_f32 v79, v79, v105
    v_cvt_pk_bf16_f32 v8, v72, v73
    v_cvt_pk_bf16_f32 v9, v74, v75
    v_cvt_pk_bf16_f32 v10, v76, v77
    v_cvt_pk_bf16_f32 v11, v78, v79
    s_waitcnt lgkmcnt(3)
    v_pk_lshlrev_b16 v12, v6, v12
    v_mfma_f32_32x32x16_bf16 v[240:255], v[116:119], v[100:103], v[240:255]
    v_pk_lshlrev_b16 v13, v6, v13
    v_pk_lshlrev_b16 v14, v6, v14
    v_pk_lshlrev_b16 v15, v6, v15
    v_pk_lshlrev_b16 v16, v6, v16
    v_pk_lshlrev_b16 v17, v6, v17
    v_pk_lshlrev_b16 v18, v6, v18
    v_pk_lshlrev_b16 v19, v6, v19
    v_add_u32 v3, 512, v3
    v_add_u32 v4, 448, v4
    v_add_u32 v0, 448, v0
    v_add_u32 v5, 512, v5
    s_waitcnt lgkmcnt(0)
    s_add_u32 s49, s49, 1
    s_cmp_lt_u32 s49, s48
    s_cbranch_scc0 M_wend
    s_waitcnt vmcnt(12)
    v_mfma_f32_32x32x16_bf16 v[80:95], v[8:11], v[20:23], 0
    ds_read_b128 v[20:23], v1 offset:2048
    s_add_u32 s77, s49, 1
    s_cmp_lt_u32 s77, s48
    s_cselect_b32 s77, 0, 0x40000000
    ds_read_b32 v47, v3 offset:524
    v_bfe_u32 v46, v1, 9, 1
    s_waitcnt lgkmcnt(0)
    v_lshrrev_b32 v47, 2, v47
    v_lshl_add_u32 v47, v46, 6, v47
    buffer_load_dwordx4 v[32:35], v47, s[72:75], s77 offen offset:0
    buffer_load_dwordx4 v[36:39], v47, s[72:75], s77 offen offset:16
    buffer_load_dwordx4 v[40:43], v47, s[72:75], s77 offen offset:32
    buffer_load_dwordx4 v[44:47], v47, s[72:75], s77 offen offset:48
    v_mfma_f32_32x32x16_bf16 v[64:79], v[48:51], v[24:27], 0
    ds_read_b128 v[24:27], v1 offset:3072
    v_mfma_f32_32x32x16_bf16 v[64:79], v[52:55], v[28:31], v[64:79]
    ds_read_b128 v[28:31], v1 offset:25600
    v_mfma_f32_32x32x16_bf16 v[64:79], v[56:59], v[20:23], v[64:79]
    ds_read_b128 v[20:23], v1 offset:4096
    s_waitcnt lgkmcnt(2)
    v_mfma_f32_32x32x16_bf16 v[64:79], v[60:63], v[24:27], v[64:79]
    ds_read_b128 v[24:27], v1 offset:5120
    s_waitcnt lgkmcnt(2)
    v_mfma_f32_32x32x16_bf16 v[112:127], v[8:11], v[28:31], 0
    ds_read_b128 v[28:31], v1 offset:6144
    s_waitcnt lgkmcnt(2)
    v_mfma_f32_32x32x16_bf16 v[96:111], v[48:51], v[20:23], 0
    ds_read_b128 v[20:23], v1 offset:7168
    s_nop 4
    v_mul_f32 v64, v64, v80
    v_mul_f32 v65, v65, v81
    v_mul_f32 v66, v66, v82
    v_mul_f32 v67, v67, v83
    v_mul_f32 v68, v68, v84
    v_mul_f32 v69, v69, v85
    s_waitcnt lgkmcnt(2)
    v_mfma_f32_32x32x16_bf16 v[96:111], v[52:55], v[24:27], v[96:111]
    ds_read_b128 v[24:27], v1 offset:26624
    v_mul_f32 v70, v70, v86
    v_mul_f32 v71, v71, v87
    v_mul_f32 v72, v72, v88
    v_mul_f32 v73, v73, v89
    v_mul_f32 v74, v74, v90
    v_mul_f32 v75, v75, v91
    v_mul_f32 v76, v76, v92
    s_waitcnt lgkmcnt(2)
    v_mfma_f32_32x32x16_bf16 v[96:111], v[56:59], v[28:31], v[96:111]
    ds_read_b128 v[28:31], v1 offset:8192
    v_mul_f32 v77, v77, v93
    v_mul_f32 v78, v78, v94
    v_mul_f32 v79, v79, v95
    v_cvt_pk_bf16_f32 v64, v64, v65
    v_cvt_pk_bf16_f32 v65, v66, v67
    v_cvt_pk_bf16_f32 v66, v68, v69
    s_waitcnt lgkmcnt(2)
    v_mfma_f32_32x32x16_bf16 v[96:111], v[60:63], v[20:23], v[96:111]
    ds_read_b128 v[20:23], v1 offset:9216
    v_cvt_pk_bf16_f32 v67, v70, v71
    v_cvt_pk_bf16_f32 v68, v72, v73
    v_cvt_pk_bf16_f32 v69, v74, v75
    v_cvt_pk_bf16_f32 v70, v76, v77
    v_cvt_pk_bf16_f32 v71, v78, v79
    v_mfma_f32_32x32x16_bf16 v[128:143], v[12:15], v[64:67], v[128:143]
    s_nop 0
    v_mfma_f32_32x32x16_bf16 v[128:143], v[16:19], v[68:71], v[128:143]
    s_waitcnt lgkmcnt(2)
    v_mfma_f32_32x32x16_bf16 v[80:95], v[8:11], v[24:27], 0
    ds_read_b128 v[24:27], v1 offset:10240
    s_waitcnt lgkmcnt(2)
    v_mfma_f32_32x32x16_bf16 v[64:79], v[48:51], v[28:31], 0
    ds_read_b128 v[28:31], v1 offset:11264
    v_mul_f32 v96, v96, v112
    v_mul_f32 v97, v97, v113
    v_mul_f32 v98, v98, v114
    v_mul_f32 v99, v99, v115
    v_mul_f32 v100, v100, v116
    v_mul_f32 v101, v101, v117
    s_waitcnt lgkmcnt(2)
    v_mfma_f32_32x32x16_bf16 v[64:79], v[52:55], v[20:23], v[64:79]
    ds_read_b128 v[20:23], v1 offset:27648
    v_mul_f32 v102, v102, v118
    v_mul_f32 v103, v103, v119
    v_mul_f32 v104, v104, v120
    v_mul_f32 v105, v105, v121
    v_mul_f32 v106, v106, v122
    v_mul_f32 v107, v107, v123
    v_mul_f32 v108, v108, v124
    s_waitcnt lgkmcnt(2)
    v_mfma_f32_32x32x16_bf16 v[64:79], v[56:59], v[24:27], v[64:79]
    ds_read_b128 v[24:27], v1 offset:12288
    v_mul_f32 v109, v109, v125
    v_mul_f32 v110, v110, v126
    v_mul_f32 v111, v111, v127
    v_cvt_pk_bf16_f32 v96, v96, v97
    v_cvt_pk_bf16_f32 v97, v98, v99
    v_cvt_pk_bf16_f32 v98, v100, v101
    s_waitcnt lgkmcnt(2)
    v_mfma_f32_32x32x16_bf16 v[64:79], v[60:63], v[28:31], v[64:79]
    ds_read_b128 v[28:31], v1 offset:13312
    v_cvt_pk_bf16_f32 v99, v102, v103
    v_cvt_pk_bf16_f32 v100, v104, v105
    v_cvt_pk_bf16_f32 v101, v106, v107
    v_cvt_pk_bf16_f32 v102, v108, v109
    v_cvt_pk_bf16_f32 v103, v110, v111
    v_mfma_f32_32x32x16_bf16 v[144:159], v[12:15], v[96:99], v[144:159]
    s_nop 0
    v_mfma_f32_32x32x16_bf16 v[144:159], v[16:19], v[100:103], v[144:159]
    s_waitcnt lgkmcnt(2)
    v_mfma_f32_32x32x16_bf16 v[112:127], v[8:11], v[20:23], 0
    ds_read_b128 v[20:23], v1 offset:14336
    s_waitcnt lgkmcnt(2)
    v_mfma_f32_32x32x16_bf16 v[96:111], v[48:51], v[24:27], 0
    ds_read_b128 v[24:27], v1 offset:15360
    v_mul_f32 v64, v64, v80
    v_mul_f32 v65, v65, v81
    v_mul_f32 v66, v66, v82
    v_mul_f32 v67, v67, v83
    v_mul_f32 v68, v68, v84
    v_mul_f32 v69, v69, v85
    v_mul_f32 v70, v70, v86
    v_mul_f32 v71, v71, v87
    v_mul_f32 v72, v72, v88
    v_mul_f32 v73, v73, v89
    v_mul_f32 v74, v74, v90
    v_mul_f32 v75, v75, v91
    v_mul_f32 v76, v76, v92
    v_mul_f32 v77, v77, v93
    v_mul_f32 v78, v78, v94
    v_mul_f32 v79, v79, v95
    s_waitcnt vmcnt(4)
    ds_read_u16_d16_hi v80, v2 offset:0
    ds_read_u16_d16_hi v81, v2 offset:256
    ds_read_u16_d16_hi v82, v2 offset:512
    ds_read_u16_d16_hi v83, v2 offset:768
    ds_read_u16_d16_hi v84, v2 offset:3072
    ds_read_u16_d16_hi v85, v2 offset:3328
    ds_read_u16_d16_hi v86, v2 offset:3584
    ds_read_u16_d16_hi v87, v2 offset:3840
    ds_read_u16_d16_hi v88, v2 offset:6144
    ds_read_u16_d16_hi v89, v2 offset:6400
    ds_read_u16_d16_hi v90, v2 offset:6656
    ds_read_u16_d16_hi v91, v2 offset:6912
    ds_read_u16_d16_hi v92, v2 offset:9216
    ds_read_u16_d16_hi v93, v2 offset:9472
    ds_read_u16_d16_hi v94, v2 offset:9728
    ds_read_u16_d16_hi v95, v2 offset:9984
    s_waitcnt lgkmcnt(12)
    v_mul_f32 v80, v80, v64
    v_mul_f32 v81, v81, v65
    v_mul_f32 v82, v82, v66
    v_mul_f32 v83, v83, v67
    s_waitcnt lgkmcnt(8)
    v_mul_f32 v84, v84, v68
    v_mul_f32 v85, v85, v69
    v_mfma_f32_32x32x16_bf16 v[96:111], v[52:55], v[28:31], v[96:111]
    ds_read_b128 v[28:31], v1 offset:28672
    v_mul_f32 v86, v86, v70
    v_mul_f32 v87, v87, v71
    v_cvt_pk_bf16_f32 v80, v80, v81
    v_cvt_pk_bf16_f32 v81, v82, v83
    v_cvt_pk_bf16_f32 v82, v84, v85
    v_cvt_pk_bf16_f32 v83, v86, v87
    s_nop 1
    v_mfma_f32_32x32x16_bf16 v[160:175], v[12:15], v[80:83], v[160:175]
    ds_read_u16_d16_hi v80, v2 offset:1024
    ds_read_u16_d16_hi v81, v2 offset:1280
    ds_read_u16_d16_hi v82, v2 offset:1536
    ds_read_u16_d16_hi v83, v2 offset:1792
    ds_read_u16_d16_hi v84, v2 offset:4096
    ds_read_u16_d16_hi v85, v2 offset:4352
    ds_read_u16_d16_hi v86, v2 offset:4608
    ds_read_u16_d16_hi v87, v2 offset:4864
    s_waitcnt lgkmcnt(13)
    v_mul_f32 v88, v88, v72
    v_mul_f32 v89, v89, v73
    v_mul_f32 v90, v90, v74
    v_mul_f32 v91, v91, v75
    s_waitcnt lgkmcnt(9)
    v_mul_f32 v92, v92, v76
    v_mul_f32 v93, v93, v77
    v_mul_f32 v94, v94, v78
    v_mul_f32 v95, v95, v79
    v_cvt_pk_bf16_f32 v88, v88, v89
    v_cvt_pk_bf16_f32 v89, v90, v91
    v_cvt_pk_bf16_f32 v90, v92, v93
    v_cvt_pk_bf16_f32 v91, v94, v95
    s_nop 1
    v_mfma_f32_32x32x16_bf16 v[160:175], v[16:19], v[88:91], v[160:175]
    ds_read_u16_d16_hi v88, v2 offset:7168
    ds_read_u16_d16_hi v89, v2 offset:7424
    ds_read_u16_d16_hi v90, v2 offset:7680
    ds_read_u16_d16_hi v91, v2 offset:7936
    ds_read_u16_d16_hi v92, v2 offset:10240
    ds_read_u16_d16_hi v93, v2 offset:10496
    ds_read_u16_d16_hi v94, v2 offset:10752
    ds_read_u16_d16_hi v95, v2 offset:11008
    s_waitcnt lgkmcnt(12)
    v_mul_f32 v80, v80, v64
    v_mul_f32 v81, v81, v65
    v_mul_f32 v82, v82, v66
    v_mfma_f32_32x32x16_bf16 v[96:111], v[56:59], v[20:23], v[96:111]
    ds_read_b128 v[20:23], v1 offset:16384
    v_mul_f32 v83, v83, v67
    s_waitcnt lgkmcnt(9)
    v_mul_f32 v84, v84, v68
    v_mul_f32 v85, v85, v69
    v_mul_f32 v86, v86, v70
    v_mul_f32 v87, v87, v71
    v_cvt_pk_bf16_f32 v80, v80, v81
    v_cvt_pk_bf16_f32 v81, v82, v83
    v_cvt_pk_bf16_f32 v82, v84, v85
    v_cvt_pk_bf16_f32 v83, v86, v87
    s_nop 1
    v_mfma_f32_32x32x16_bf16 v[192:207], v[12:15], v[80:83], v[192:207]
    ds_read_u16_d16_hi v80, v2 offset:2048
    ds_read_u16_d16_hi v81, v2 offset:2304
    ds_read_u16_d16_hi v82, v2 offset:2560
    ds_read_u16_d16_hi v83, v2 offset:2816
    ds_read_u16_d16_hi v84, v2 offset:5120
    ds_read_u16_d16_hi v85, v2 offset:5376
    ds_read_u16_d16_hi v86, v2 offset:5632
    ds_read_u16_d16_hi v87, v2 offset:5888
    s_waitcnt lgkmcnt(13)
    v_mul_f32 v88, v88, v72
    v_mul_f32 v89, v89, v73
    v_mul_f32 v90, v90, v74
    v_mul_f32 v91, v91, v75
    s_waitcnt lgkmcnt(9)
    v_mul_f32 v92, v92, v76
    v_mul_f32 v93, v93, v77
    v_mul_f32 v94, v94, v78
    v_mul_f32 v95, v95, v79
    v_cvt_pk_bf16_f32 v88, v88, v89
    v_cvt_pk_bf16_f32 v89, v90, v91
    v_cvt_pk_bf16_f32 v90, v92, v93
    v_cvt_pk_bf16_f32 v91, v94, v95
    s_nop 1
    v_mfma_f32_32x32x16_bf16 v[192:207], v[16:19], v[88:91], v[192:207]
    ds_read_u16_d16_hi v88, v2 offset:8192
    ds_read_u16_d16_hi v89, v2 offset:8448
    ds_read_u16_d16_hi v90, v2 offset:8704
    ds_read_u16_d16_hi v91, v2 offset:8960
    ds_read_u16_d16_hi v92, v2 offset:11264
    ds_read_u16_d16_hi v93, v2 offset:11520
    ds_read_u16_d16_hi v94, v2 offset:11776
    ds_read_u16_d16_hi v95, v2 offset:12032
    v_mfma_f32_32x32x16_bf16 v[96:111], v[60:63], v[24:27], v[96:111]
    ds_read_b128 v[24:27], v1 offset:17408
    s_waitcnt lgkmcnt(13)
    v_mul_f32 v80, v80, v64
    v_mul_f32 v81, v81, v65
    v_mul_f32 v82, v82, v66
    v_mul_f32 v83, v83, v67
    s_waitcnt lgkmcnt(9)
    v_mul_f32 v84, v84, v68
    v_mul_f32 v85, v85, v69
    v_mul_f32 v86, v86, v70
    v_mul_f32 v87, v87, v71
    v_cvt_pk_bf16_f32 v80, v80, v81
    v_cvt_pk_bf16_f32 v81, v82, v83
    v_cvt_pk_bf16_f32 v82, v84, v85
    v_cvt_pk_bf16_f32 v83, v86, v87
    s_nop 1
    v_mfma_f32_32x32x16_bf16 v[224:239], v[12:15], v[80:83], v[224:239]
    s_waitcnt lgkmcnt(5)
    v_mul_f32 v88, v88, v72
    v_mul_f32 v89, v89, v73
    v_mul_f32 v90, v90, v74
    v_mul_f32 v91, v91, v75
    s_waitcnt lgkmcnt(1)
    v_mul_f32 v92, v92, v76
    v_mul_f32 v93, v93, v77
    v_mul_f32 v94, v94, v78
    v_mul_f32 v95, v95, v79
    v_cvt_pk_bf16_f32 v88, v88, v89
    v_cvt_pk_bf16_f32 v89, v90, v91
    v_cvt_pk_bf16_f32 v90, v92, v93
    v_cvt_pk_bf16_f32 v91, v94, v95
    s_nop 1
    v_mfma_f32_32x32x16_bf16 v[224:239], v[16:19], v[88:91], v[224:239]
    v_mfma_f32_32x32x16_bf16 v[80:95], v[8:11], v[28:31], 0
    ds_read_b128 v[28:31], v1 offset:18432
    v_mfma_f32_32x32x16_bf16 v[64:79], v[48:51], v[20:23], 0
    ds_read_b128 v[20:23], v1 offset:19456
    v_mul_f32 v96, v96, v112
    v_mul_f32 v97, v97, v113
    v_mul_f32 v98, v98, v114
    v_mul_f32 v99, v99, v115
    v_mul_f32 v100, v100, v116
    v_mul_f32 v101, v101, v117
    v_mul_f32 v102, v102, v118
    v_mul_f32 v103, v103, v119
    v_mul_f32 v104, v104, v120
    v_mul_f32 v105, v105, v121
    v_mul_f32 v106, v106, v122
    v_mul_f32 v107, v107, v123
    v_mul_f32 v108, v108, v124
    v_mul_f32 v109, v109, v125
    v_mul_f32 v110, v110, v126
    v_mul_f32 v111, v111, v127
    ds_read_u16_d16_hi v112, v2 offset:2
    ds_read_u16_d16_hi v113, v2 offset:258
    ds_read_u16_d16_hi v114, v2 offset:514
    ds_read_u16_d16_hi v115, v2 offset:770
    ds_read_u16_d16_hi v116, v2 offset:3074
    ds_read_u16_d16_hi v117, v2 offset:3330
    ds_read_u16_d16_hi v118, v2 offset:3586
    ds_read_u16_d16_hi v119, v2 offset:3842
    ds_read_u16_d16_hi v120, v2 offset:6146
    ds_read_u16_d16_hi v121, v2 offset:6402
    ds_read_u16_d16_hi v122, v2 offset:6658
    ds_read_u16_d16_hi v123, v2 offset:6914
    ds_read_u16_d16_hi v124, v2 offset:9218
    ds_read_u16_d16_hi v125, v2 offset:9474
    ds_read_u16_d16_hi v126, v2 offset:9730
    ds_read_u16_d16_hi v127, v2 offset:9986
    s_waitcnt lgkmcnt(12)
    v_mul_f32 v112, v112, v96
    v_mul_f32 v113, v113, v97
    v_mul_f32 v114, v114, v98
    v_mul_f32 v115, v115, v99
    s_waitcnt lgkmcnt(8)
    v_mul_f32 v116, v116, v100
    v_mul_f32 v117, v117, v101
    v_mul_f32 v118, v118, v102
    v_mfma_f32_32x32x16_bf16 v[64:79], v[52:55], v[24:27], v[64:79]
    ds_read_b128 v[24:27], v1 offset:29696
    v_mul_f32 v119, v119, v103
    v_cvt_pk_bf16_f32 v112, v112, v113
    v_cvt_pk_bf16_f32 v113, v114, v115
    v_cvt_pk_bf16_f32 v114, v116, v117
    v_cvt_pk_bf16_f32 v115, v118, v119
    s_nop 1
    v_mfma_f32_32x32x16_bf16 v[176:191], v[12:15], v[112:115], v[176:191]
    ds_read_u16_d16_hi v112, v2 offset:1026
    ds_read_u16_d16_hi v113, v2 offset:1282
    ds_read_u16_d16_hi v114, v2 offset:1538
    ds_read_u16_d16_hi v115, v2 offset:1794
    ds_read_u16_d16_hi v116, v2 offset:4098
    ds_read_u16_d16_hi v117, v2 offset:4354
    ds_read_u16_d16_hi v118, v2 offset:4610
    ds_read_u16_d16_hi v119, v2 offset:4866
    s_waitcnt lgkmcnt(13)
    v_mul_f32 v120, v120, v104
    v_mul_f32 v121, v121, v105
    v_mul_f32 v122, v122, v106
    v_mul_f32 v123, v123, v107
    s_waitcnt lgkmcnt(9)
    v_mul_f32 v124, v124, v108
    v_mul_f32 v125, v125, v109
    v_mul_f32 v126, v126, v110
    v_mul_f32 v127, v127, v111
    v_cvt_pk_bf16_f32 v120, v120, v121
    v_cvt_pk_bf16_f32 v121, v122, v123
    v_cvt_pk_bf16_f32 v122, v124, v125
    v_cvt_pk_bf16_f32 v123, v126, v127
    s_nop 1
    v_mfma_f32_32x32x16_bf16 v[176:191], v[16:19], v[120:123], v[176:191]
    ds_read_u16_d16_hi v120, v2 offset:7170
    ds_read_u16_d16_hi v121, v2 offset:7426
    ds_read_u16_d16_hi v122, v2 offset:7682
    ds_read_u16_d16_hi v123, v2 offset:7938
    ds_read_u16_d16_hi v124, v2 offset:10242
    ds_read_u16_d16_hi v125, v2 offset:10498
    ds_read_u16_d16_hi v126, v2 offset:10754
    ds_read_u16_d16_hi v127, v2 offset:11010
    s_waitcnt lgkmcnt(12)
    v_mul_f32 v112, v112, v96
    v_mul_f32 v113, v113, v97
    v_mul_f32 v114, v114, v98
    v_mul_f32 v115, v115, v99
    v_mfma_f32_32x32x16_bf16 v[64:79], v[56:59], v[28:31], v[64:79]
    ds_read_b128 v[28:31], v1 offset:20480
    s_waitcnt lgkmcnt(9)
    v_mul_f32 v116, v116, v100
    v_mul_f32 v117, v117, v101
    v_mul_f32 v118, v118, v102
    v_mul_f32 v119, v119, v103
    v_cvt_pk_bf16_f32 v112, v112, v113
    v_cvt_pk_bf16_f32 v113, v114, v115
    v_cvt_pk_bf16_f32 v114, v116, v117
    v_cvt_pk_bf16_f32 v115, v118, v119
    s_nop 1
    v_mfma_f32_32x32x16_bf16 v[208:223], v[12:15], v[112:115], v[208:223]
    ds_read_u16_d16_hi v112, v2 offset:2050
    ds_read_u16_d16_hi v113, v2 offset:2306
    ds_read_u16_d16_hi v114, v2 offset:2562
    ds_read_u16_d16_hi v115, v2 offset:2818
    ds_read_u16_d16_hi v116, v2 offset:5122
    ds_read_u16_d16_hi v117, v2 offset:5378
    ds_read_u16_d16_hi v118, v2 offset:5634
    ds_read_u16_d16_hi v119, v2 offset:5890
    s_waitcnt lgkmcnt(13)
    v_mul_f32 v120, v120, v104
    v_mul_f32 v121, v121, v105
    v_mul_f32 v122, v122, v106
    v_mul_f32 v123, v123, v107
    s_waitcnt lgkmcnt(9)
    v_mul_f32 v124, v124, v108
    v_mul_f32 v125, v125, v109
    v_mul_f32 v126, v126, v110
    v_mul_f32 v127, v127, v111
    v_cvt_pk_bf16_f32 v120, v120, v121
    v_cvt_pk_bf16_f32 v121, v122, v123
    v_cvt_pk_bf16_f32 v122, v124, v125
    v_cvt_pk_bf16_f32 v123, v126, v127
    s_nop 1
    v_mfma_f32_32x32x16_bf16 v[208:223], v[16:19], v[120:123], v[208:223]
    ds_read_u16_d16_hi v120, v2 offset:8194
    ds_read_u16_d16_hi v121, v2 offset:8450
    ds_read_u16_d16_hi v122, v2 offset:8706
    ds_read_u16_d16_hi v123, v2 offset:8962
    ds_read_u16_d16_hi v124, v2 offset:11266
    ds_read_u16_d16_hi v125, v2 offset:11522
    ds_read_u16_d16_hi v126, v2 offset:11778
    ds_read_u16_d16_hi v127, v2 offset:12034
    s_waitcnt lgkmcnt(12)
    v_mul_f32 v112, v112, v96
    v_mfma_f32_32x32x16_bf16 v[64:79], v[60:63], v[20:23], v[64:79]
    ds_read_b128 v[20:23], v1 offset:21504
    v_mul_f32 v113, v113, v97
    v_mul_f32 v114, v114, v98
    v_mul_f32 v115, v115, v99
    s_waitcnt lgkmcnt(9)
    v_mul_f32 v116, v116, v100
    v_mul_f32 v117, v117, v101
    v_mul_f32 v118, v118, v102
    v_mul_f32 v119, v119, v103
    v_cvt_pk_bf16_f32 v112, v112, v113
    v_cvt_pk_bf16_f32 v113, v114, v115
    v_cvt_pk_bf16_f32 v114, v116, v117
    v_cvt_pk_bf16_f32 v115, v118, v119
    s_nop 1
    v_mfma_f32_32x32x16_bf16 v[240:255], v[12:15], v[112:115], v[240:255]
    s_waitcnt lgkmcnt(5)
    v_mul_f32 v120, v120, v104
    v_mul_f32 v121, v121, v105
    v_mul_f32 v122, v122, v106
    v_mul_f32 v123, v123, v107
    s_waitcnt lgkmcnt(1)
    v_mul_f32 v124, v124, v108
    v_mul_f32 v125, v125, v109
    v_mul_f32 v126, v126, v110
    v_mul_f32 v127, v127, v111
    v_cvt_pk_bf16_f32 v120, v120, v121
    v_cvt_pk_bf16_f32 v121, v122, v123
    v_cvt_pk_bf16_f32 v122, v124, v125
    v_cvt_pk_bf16_f32 v123, v126, v127
    s_nop 1
    v_mfma_f32_32x32x16_bf16 v[240:255], v[16:19], v[120:123], v[240:255]
    s_cmp_lg_u32 s77, 0
    s_nop 10
    s_cbranch_scc1 M_nv21
    ds_read_b32 v112, v5 offset:524
    ds_read_b32 v113, v5 offset:652
    ds_read_b32 v114, v5 offset:780
    ds_read_b32 v115, v5 offset:908
    s_waitcnt lgkmcnt(3)
    v_and_or_b32 v112, v1, s63, v112
    s_waitcnt lgkmcnt(2)
    v_and_or_b32 v113, v1, s63, v113
    s_waitcnt lgkmcnt(1)
    v_and_or_b32 v114, v1, s63, v114
    s_waitcnt lgkmcnt(0)
    v_and_or_b32 v115, v1, s63, v115
    s_add_u32 m0, s51, 0
    s_nop 0
    buffer_load_dwordx4 v112, s[28:31], s64 offen lds
    s_add_u32 m0, s51, 1024
    s_nop 0
    buffer_load_dwordx4 v112, s[28:31], s65 offen lds
    s_add_u32 m0, s51, 2048
    s_nop 0
    buffer_load_dwordx4 v112, s[28:31], s66 offen lds
    s_add_u32 m0, s51, 3072
    s_nop 0
    buffer_load_dwordx4 v113, s[28:31], s64 offen lds
    s_add_u32 m0, s51, 4096
    s_nop 0
    buffer_load_dwordx4 v113, s[28:31], s65 offen lds
    s_add_u32 m0, s51, 5120
    s_nop 0
    buffer_load_dwordx4 v113, s[28:31], s66 offen lds
    s_add_u32 m0, s51, 6144
    s_nop 0
    buffer_load_dwordx4 v114, s[28:31], s64 offen lds
    s_add_u32 m0, s51, 7168
    s_nop 0
    buffer_load_dwordx4 v114, s[28:31], s65 offen lds
    s_add_u32 m0, s51, 8192
    s_nop 0
    buffer_load_dwordx4 v114, s[28:31], s66 offen lds
    s_add_u32 m0, s51, 9216
    s_nop 0
    buffer_load_dwordx4 v115, s[28:31], s64 offen lds
    s_add_u32 m0, s51, 10240
    s_nop 0
    buffer_load_dwordx4 v115, s[28:31], s65 offen lds
    s_add_u32 m0, s51, 11264
    s_nop 0
    buffer_load_dwordx4 v115, s[28:31], s66 offen lds
    s_branch M_nj21
M_nv21:
    s_cmp_eq_u32 s76, 0
    s_cbranch_scc1 M_nj21
    v_lshrrev_b32 v112, 7, v1
    v_and_b32 v113, 1, v112
    v_lshrrev_b32 v112, 1, v112
    v_lshl_add_u32 v112, v113, 2, v112
    v_lshlrev_b32 v112, 9, v112
    v_and_or_b32 v112, v1, s63, v112
    s_add_u32 m0, s51, 1024
    s_add_u32 s53, s40, 256
    buffer_load_dwordx4 v112, s[4:7], s53 offen  lds
    s_add_u32 m0, s51, 2048
    s_add_u32 s53, s40, 384
    buffer_load_dwordx4 v112, s[4:7], s53 offen  lds
    s_add_u32 m0, s51, 4096
    s_add_u32 s53, s41, 256
    buffer_load_dwordx4 v112, s[4:7], s53 offen  lds
    s_add_u32 m0, s51, 5120
    s_add_u32 s53, s41, 384
    buffer_load_dwordx4 v112, s[4:7], s53 offen  lds
    s_add_u32 m0, s51, 7168
    s_add_u32 s53, s42, 256
    buffer_load_dwordx4 v112, s[4:7], s53 offen  lds
    s_add_u32 m0, s51, 8192
    s_add_u32 s53, s42, 384
    buffer_load_dwordx4 v112, s[4:7], s53 offen  lds
    s_add_u32 m0, s51, 10240
    s_add_u32 s53, s43, 256
    buffer_load_dwordx4 v112, s[4:7], s53 offen  lds
    s_add_u32 m0, s51, 11264
    s_add_u32 s53, s43, 384
    buffer_load_dwordx4 v112, s[4:7], s53 offen  lds
M_nj21:
    v_mfma_f32_32x32x16_bf16 v[112:127], v[8:11], v[24:27], 0
    ds_read_b128 v[24:27], v1 offset:22528
    v_mfma_f32_32x32x16_bf16 v[96:111], v[48:51], v[28:31], 0
    ds_read_b128 v[28:31], v1 offset:23552
    v_mul_f32 v64, v64, v80
    v_mul_f32 v65, v65, v81
    v_mul_f32 v66, v66, v82
    v_mul_f32 v67, v67, v83
    v_mul_f32 v68, v68, v84
    v_mul_f32 v69, v69, v85
    v_mul_f32 v70, v70, v86
    v_mul_f32 v71, v71, v87
    v_mul_f32 v72, v72, v88
    v_mul_f32 v73, v73, v89
    v_mul_f32 v74, v74, v90
    v_mul_f32 v75, v75, v91
    s_waitcnt lgkmcnt(2)
    v_mfma_f32_32x32x16_bf16 v[96:111], v[52:55], v[20:23], v[96:111]
    v_mul_f32 v76, v76, v92
    v_mul_f32 v77, v77, v93
    v_mul_f32 v78, v78, v94
    v_mul_f32 v79, v79, v95
    ds_read_b64 v[80:81], v0 offset:2080
    ds_read_b64 v[88:89], v0 offset:2088
    ds_read_b64 v[82:83], v0 offset:2192
    ds_read_b64 v[90:91], v0 offset:2200
    ds_read_b64 v[84:85], v0 offset:2304
    ds_read_b64 v[92:93], v0 offset:2312
    ds_read_b64 v[86:87], v0 offset:2416
    ds_read_b64 v[94:95], v0 offset:2424
    v_cvt_pk_bf16_f32 v64, v64, v65
    v_cvt_pk_bf16_f32 v65, v66, v67
    v_cvt_pk_bf16_f32 v66, v68, v69
    v_cvt_pk_bf16_f32 v67, v70, v71
    v_cvt_pk_bf16_f32 v68, v72, v73
    v_cvt_pk_bf16_f32 v69, v74, v75
    v_cvt_pk_bf16_f32 v70, v76, v77
    s_waitcnt lgkmcnt(9)
    v_mfma_f32_32x32x16_bf16 v[96:111], v[56:59], v[24:27], v[96:111]
    v_cvt_pk_bf16_f32 v71, v78, v79
    v_pk_lshrrev_b16 v72, 14, v12 op_sel_hi:[0,1]
    v_pk_lshrrev_b16 v73, 14, v13 op_sel_hi:[0,1]
    v_pk_lshrrev_b16 v74, 14, v14 op_sel_hi:[0,1]
    v_pk_lshrrev_b16 v75, 14, v15 op_sel_hi:[0,1]
    v_pk_lshrrev_b16 v76, 14, v16 op_sel_hi:[0,1]
    v_pk_lshrrev_b16 v77, 14, v17 op_sel_hi:[0,1]
    v_pk_lshrrev_b16 v78, 14, v18 op_sel_hi:[0,1]
    v_pk_lshrrev_b16 v79, 14, v19 op_sel_hi:[0,1]
    s_waitcnt lgkmcnt(0)
    v_pk_mul_lo_u16 v80, v72, v80
    v_pk_mul_lo_u16 v81, v73, v81
    v_pk_mul_lo_u16 v82, v74, v82
    v_mfma_f32_32x32x16_bf16 v[96:111], v[60:63], v[28:31], v[96:111]
    v_pk_mul_lo_u16 v83, v75, v83
    v_pk_mul_lo_u16 v84, v76, v84
    v_pk_mul_lo_u16 v85, v77, v85
    v_pk_mul_lo_u16 v86, v78, v86
    v_pk_mul_lo_u16 v87, v79, v87
    v_pk_mul_lo_u16 v88, v72, v88
    v_pk_mul_lo_u16 v89, v73, v89
    v_pk_mul_lo_u16 v90, v74, v90
    v_pk_mul_lo_u16 v91, v75, v91
    v_pk_mul_lo_u16 v92, v76, v92
    v_pk_mul_lo_u16 v93, v77, v93
    v_pk_mul_lo_u16 v94, v78, v94
    v_pk_mul_lo_u16 v95, v79, v95
    v_mfma_f32_32x32x16_bf16 v[160:175], v[80:83], v[64:67], v[160:175]
    v_mul_f32 v96, v96, v112
    v_mul_f32 v97, v97, v113
    v_mul_f32 v98, v98, v114
    v_mul_f32 v99, v99, v115
    v_mul_f32 v100, v100, v116
    v_mul_f32 v101, v101, v117
    v_mfma_f32_32x32x16_bf16 v[160:175], v[84:87], v[68:71], v[160:175]
    v_mul_f32 v102, v102, v118
    v_mul_f32 v103, v103, v119
    v_mul_f32 v104, v104, v120
    v_mul_f32 v105, v105, v121
    v_mul_f32 v106, v106, v122
    v_mul_f32 v107, v107, v123
    v_mfma_f32_32x32x16_bf16 v[192:207], v[88:91], v[64:67], v[192:207]
    v_mul_f32 v108, v108, v124
    v_mul_f32 v109, v109, v125
    v_mul_f32 v110, v110, v126
    v_mul_f32 v111, v111, v127
    ds_read_b64 v[112:113], v0 offset:2096
    ds_read_b64 v[114:115], v0 offset:2208
    ds_read_b64 v[116:117], v0 offset:2320
    ds_read_b64 v[118:119], v0 offset:2432
    v_cvt_pk_bf16_f32 v96, v96, v97
    v_mfma_f32_32x32x16_bf16 v[192:207], v[92:95], v[68:71], v[192:207]
    v_cvt_pk_bf16_f32 v97, v98, v99
    v_cvt_pk_bf16_f32 v98, v100, v101
    v_cvt_pk_bf16_f32 v99, v102, v103
    v_cvt_pk_bf16_f32 v100, v104, v105
    v_cvt_pk_bf16_f32 v101, v106, v107
    v_cvt_pk_bf16_f32 v102, v108, v109
    v_cvt_pk_bf16_f32 v103, v110, v111
    s_waitcnt lgkmcnt(0)
    v_pk_mul_lo_u16 v112, v72, v112
    v_pk_mul_lo_u16 v113, v73, v113
    v_pk_mul_lo_u16 v114, v74, v114
    v_pk_mul_lo_u16 v115, v75, v115
    v_pk_mul_lo_u16 v116, v76, v116
    v_pk_mul_lo_u16 v117, v77, v117
    v_pk_mul_lo_u16 v118, v78, v118
    v_pk_mul_lo_u16 v119, v79, v119
    v_mfma_f32_32x32x16_bf16 v[176:191], v[80:83], v[96:99], v[176:191]
    ds_read_b128 v[104:107], v3 offset:512
    ds_read_b128 v[72:75], v7
    ds_read_b128 v[76:79], v7 offset:16
    ds_read_b64 v[12:13], v4 offset:2496
    ds_read_b64 v[14:15], v4 offset:2608
    ds_read_b64 v[16:17], v4 offset:2720
    ds_read_b64 v[18:19], v4 offset:2832
    ds_read_b128 v[20:23], v1 offset:24576
    ds_read_b128 v[24:27], v1 offset:0
    ds_read_b128 v[28:31], v1 offset:1024
    s_waitcnt lgkmcnt(7)
    v_mul_f32 v72, v104, v72
    v_mul_f32 v73, v104, v73
    v_mul_f32 v74, v104, v74
    v_mul_f32 v75, v104, v75
    v_mul_f32 v76, v104, v76
    v_mfma_f32_32x32x16_bf16 v[176:191], v[84:87], v[100:103], v[176:191]
    v_mul_f32 v77, v104, v77
    v_mul_f32 v78, v104, v78
    v_mul_f32 v79, v104, v79
    v_cvt_pk_bf16_f32 v72, 0, v72
    v_cvt_pk_bf16_f32 v73, 0, v73
    v_cvt_pk_bf16_f32 v74, 0, v74
    v_cvt_pk_bf16_f32 v75, 0, v75
    v_mfma_f32_32x32x16_bf16 v[208:223], v[88:91], v[96:99], v[208:223]
    v_cvt_pk_bf16_f32 v76, 0, v76
    v_cvt_pk_bf16_f32 v77, 0, v77
    v_cvt_pk_bf16_f32 v78, 0, v78
    v_cvt_pk_bf16_f32 v79, 0, v79
    v_mul_f32 v72, s61, v72
    v_mul_f32 v73, s61, v73
    v_mfma_f32_32x32x16_bf16 v[208:223], v[92:95], v[100:103], v[208:223]
    v_mul_f32 v74, s61, v74
    v_mul_f32 v75, s61, v75
    v_mul_f32 v76, s61, v76
    v_mul_f32 v77, s61, v77
    v_mul_f32 v78, s61, v78
    v_mul_f32 v79, s61, v79
    v_sin_f32 v72, v72
    v_mfma_f32_32x32x16_bf16 v[224:239], v[112:115], v[64:67], v[224:239]
    v_sin_f32 v73, v73
    v_sin_f32 v74, v74
    v_sin_f32 v75, v75
    v_sin_f32 v76, v76
    v_sin_f32 v77, v77
    v_sin_f32 v78, v78
    v_sin_f32 v79, v79
    v_mfma_f32_32x32x16_bf16 v[240:255], v[112:115], v[96:99], v[240:255]
    v_mul_f32 v72, v72, v105
    v_mul_f32 v73, v73, v105
    v_mul_f32 v74, v74, v105
    v_mul_f32 v75, v75, v105
    v_mul_f32 v76, v76, v105
    v_mul_f32 v77, v77, v105
    v_mfma_f32_32x32x16_bf16 v[224:239], v[116:119], v[68:71], v[224:239]
    v_mul_f32 v78, v78, v105
    v_mul_f32 v79, v79, v105
    v_cvt_pk_bf16_f32 v8, v72, v73
    v_cvt_pk_bf16_f32 v9, v74, v75
    v_cvt_pk_bf16_f32 v10, v76, v77
    v_cvt_pk_bf16_f32 v11, v78, v79
    s_waitcnt lgkmcnt(3)
    v_pk_lshlrev_b16 v12, v6, v12
    v_mfma_f32_32x32x16_bf16 v[240:255], v[116:119], v[100:103], v[240:255]
    v_pk_lshlrev_b16 v13, v6, v13
    v_pk_lshlrev_b16 v14, v6, v14
    v_pk_lshlrev_b16 v15, v6, v15
    v_pk_lshlrev_b16 v16, v6, v16
    v_pk_lshlrev_b16 v17, v6, v17
    v_pk_lshlrev_b16 v18, v6, v18
    v_pk_lshlrev_b16 v19, v6, v19
    v_add_u32 v3, 512, v3
    v_add_u32 v4, 448, v4
    v_add_u32 v0, 448, v0
    v_add_u32 v5, 512, v5
    s_waitcnt lgkmcnt(0)
    s_add_u32 s49, s49, 1
    s_cmp_lt_u32 s49, s48
    s_cbranch_scc1 M_batch
M_wend:
    s_cmp_lg_u32 s76, 0
    s_cbranch_scc1 M_epi
M_slow:
    v_lshrrev_b32 v8, 4, v1
    v_add_u32 v86, 64, v8
    v_bfrev_b32 v14, 2
    s_mov_b32 s63, 0x02020000
    s_mov_b32 s64, 0x322bcc77
    v_mov_b32 v103, 0x01000c0c
    v_and_b32 v12, 3, v8
    v_lshlrev_b32 v12, 3, v12
    v_lshrrev_b32_e64 v13, v12, s18
    v_bfe_u32 v15, v13, 1, 7
    v_lshlrev_b32 v15, 17, v15
    v_and_b32 v13, 1, v13
    v_or_b32 v95, v13, v15
    s_bfe_u32 s60, s18, 0x70019
    s_lshl_b32 s60, s60, 17
    s_bfe_u32 s27, s18, 0x10018
    s_or_b32 s60, s60, s27
    s_lshl_b32 s53, s2, 7
    s_cmp_eq_u32 s14, 2
    s_cbranch_scc1 M_sovf
    s_cmp_ge_u32 s15, 63
    s_cbranch_scc1 M_sph1
    s_lshl_b32 s62, s15, 2
    v_lshrrev_b32 v12, 5, v8
    v_and_b32 v13, 31, v8
    v_add_u32 v15, s62, v12
    v_cmp_gt_u32 vcc, 250, v15
    s_mov_b64 s[54:55], vcc
    v_lshlrev_b32 v15, 15, v15
    v_cndmask_b32 v15, v14, v15, s[54:55]
    s_cmp_lg_u32 s14, 0
    s_nop 0
    s_cbranch_scc1 M_s222
    v_lshl_add_u32 v16, v13, 2, v15
    buffer_load_dword v88, v16, s[36:39], s53 offen sc1
    s_waitcnt vmcnt(0)
    v_xor_b32 v88, v95, v88
    s_mov_b32 s27, 0xc8000000
    v_cmp_gt_u32 vcc, s27, v88
    s_and_b64 s[54:55], s[54:55], vcc
    s_nop 3
    s_branch M_s322
M_s222:
    buffer_load_dword v88, v15, s[36:39], s53 offen offset:124 sc1
    s_waitcnt vmcnt(0)
    v_xor_b32 v88, s60, v88
    v_bfe_u32 v88, v88, 1, 23
    v_cmp_gt_u32 vcc, v88, v13
    s_and_b64 s[54:55], s[54:55], vcc
    v_lshl_add_u32 v16, v13, 2, v15
    v_cndmask_b32 v16, v14, v16, s[54:55]
    s_add_u32 s27, s53, 0x900000
    buffer_load_dword v88, v16, s[36:39], s27 offen sc1
    s_waitcnt vmcnt(0)
M_s322:
    v_lshrrev_b32 v16, 24, v88
    v_subrev_u32 v17, s59, v16
    v_cmp_gt_u32 vcc, s45, v17
    s_and_b64 s[54:55], s[54:55], vcc
    v_and_b32 v96, 0x1fffe, v88
    v_lshl_add_u32 v96, v96, 1, v96
    v_and_b32 v96, -4, v96
    v_cndmask_b32 v96, v14, v96, s[54:55]
    buffer_load_dwordx2 v[98:99], v96, s[92:95], 0 offen
    v_mul_u32_u24 v97, 6, v16
    v_and_b32 v97, -4, v97
    v_cndmask_b32 v97, v14, v97, s[54:55]
    s_mul_i32 s27, s2, 1200
    buffer_load_dwordx2 v[100:101], v97, s[92:95], s27 offen
    v_bfe_i32 v102, v88, 1, 1
    v_and_or_b32 v102, v102, s63, v103
    v_bfe_i32 v104, v16, 0, 1
    v_and_or_b32 v104, v104, s63, v103
    v_add_u32 v105, s63, v104
    v_add_u32 v106, s63, v105
    s_waitcnt vmcnt(0)
    v_perm_b32 v107, v101, v100, v104
    v_perm_b32 v108, v101, v100, v105
    v_perm_b32 v109, v101, v100, v106
    v_add_u32 v113, s63, v102
    v_perm_b32 v110, v99, v98, v102
    v_add_u32 v114, s63, v113
    v_perm_b32 v111, v99, v98, v113
    v_perm_b32 v112, v99, v98, v114
    v_sub_f32 v110, v110, v107
    v_sub_f32 v111, v111, v108
    v_sub_f32 v112, v112, v109
    v_cvt_pk_bf16_f32 v89, v110, v111
    v_cvt_pk_bf16_f32 v112, 0, v112
    v_lshlrev_b32 v110, 16, v89
    v_and_b32 v111, s58, v89
    v_mul_f32 v115, v112, v112
    v_mul_f32 v110, v110, v110
    v_mul_f32 v111, v111, v111
    v_cvt_pk_bf16_f32 v115, 0, v115
    v_cvt_pk_bf16_f32 v110, 0, v110
    v_cvt_pk_bf16_f32 v111, 0, v111
    v_add_f32 v110, v110, v111
    v_add_f32 v110, v110, v115
    v_cvt_pk_bf16_f32 v110, 0, v110
    v_add_f32 v110, s64, v110
    v_cvt_pk_bf16_f32 v110, 0, v110
    v_sqrt_f32 v110, v110
    s_nop 0
    v_cvt_pk_bf16_f32 v90, v112, v110
    s_mov_b32 s27, 0x409d0000
    v_cmp_gt_u32 vcc, s27, v90
    s_and_b64 s[8:9], s[54:55], vcc
    v_lshrrev_b32 v12, 5, v86
    v_and_b32 v13, 31, v86
    v_add_u32 v15, s62, v12
    v_cmp_gt_u32 vcc, 250, v15
    s_mov_b64 s[54:55], vcc
    v_lshlrev_b32 v15, 15, v15
    v_cndmask_b32 v15, v14, v15, s[54:55]
    s_cmp_lg_u32 s14, 0
    s_nop 0
    s_cbranch_scc1 M_s223
    v_lshl_add_u32 v16, v13, 2, v15
    buffer_load_dword v92, v16, s[36:39], s53 offen sc1
    s_waitcnt vmcnt(0)
    v_xor_b32 v92, v95, v92
    s_mov_b32 s27, 0xc8000000
    v_cmp_gt_u32 vcc, s27, v92
    s_and_b64 s[54:55], s[54:55], vcc
    s_nop 3
    s_branch M_s323
M_s223:
    buffer_load_dword v92, v15, s[36:39], s53 offen offset:124 sc1
    s_waitcnt vmcnt(0)
    v_xor_b32 v92, s60, v92
    v_bfe_u32 v92, v92, 1, 23
    v_cmp_gt_u32 vcc, v92, v13
    s_and_b64 s[54:55], s[54:55], vcc
    v_lshl_add_u32 v16, v13, 2, v15
    v_cndmask_b32 v16, v14, v16, s[54:55]
    s_add_u32 s27, s53, 0x900000
    buffer_load_dword v92, v16, s[36:39], s27 offen sc1
    s_waitcnt vmcnt(0)
M_s323:
    v_lshrrev_b32 v16, 24, v92
    v_subrev_u32 v17, s59, v16
    v_cmp_gt_u32 vcc, s45, v17
    s_and_b64 s[54:55], s[54:55], vcc
    v_and_b32 v96, 0x1fffe, v92
    v_lshl_add_u32 v96, v96, 1, v96
    v_and_b32 v96, -4, v96
    v_cndmask_b32 v96, v14, v96, s[54:55]
    buffer_load_dwordx2 v[98:99], v96, s[92:95], 0 offen
    v_mul_u32_u24 v97, 6, v16
    v_and_b32 v97, -4, v97
    v_cndmask_b32 v97, v14, v97, s[54:55]
    s_mul_i32 s27, s2, 1200
    buffer_load_dwordx2 v[100:101], v97, s[92:95], s27 offen
    v_bfe_i32 v102, v92, 1, 1
    v_and_or_b32 v102, v102, s63, v103
    v_bfe_i32 v104, v16, 0, 1
    v_and_or_b32 v104, v104, s63, v103
    v_add_u32 v105, s63, v104
    v_add_u32 v106, s63, v105
    s_waitcnt vmcnt(0)
    v_perm_b32 v107, v101, v100, v104
    v_perm_b32 v108, v101, v100, v105
    v_perm_b32 v109, v101, v100, v106
    v_add_u32 v113, s63, v102
    v_perm_b32 v110, v99, v98, v102
    v_add_u32 v114, s63, v113
    v_perm_b32 v111, v99, v98, v113
    v_perm_b32 v112, v99, v98, v114
    v_sub_f32 v110, v110, v107
    v_sub_f32 v111, v111, v108
    v_sub_f32 v112, v112, v109
    v_cvt_pk_bf16_f32 v93, v110, v111
    v_cvt_pk_bf16_f32 v112, 0, v112
    v_lshlrev_b32 v110, 16, v93
    v_and_b32 v111, s58, v93
    v_mul_f32 v115, v112, v112
    v_mul_f32 v110, v110, v110
    v_mul_f32 v111, v111, v111
    v_cvt_pk_bf16_f32 v115, 0, v115
    v_cvt_pk_bf16_f32 v110, 0, v110
    v_cvt_pk_bf16_f32 v111, 0, v111
    v_add_f32 v110, v110, v111
    v_add_f32 v110, v110, v115
    v_cvt_pk_bf16_f32 v110, 0, v110
    v_add_f32 v110, s64, v110
    v_cvt_pk_bf16_f32 v110, 0, v110
    v_sqrt_f32 v110, v110
    s_nop 0
    v_cvt_pk_bf16_f32 v94, v112, v110
    s_mov_b32 s27, 0x409d0000
    v_cmp_gt_u32 vcc, s27, v94
    s_and_b64 s[10:11], s[54:55], vcc
    s_add_u32 s15, s15, 1
    s_nop 2
    s_branch M_sgo
M_sph1:
    s_add_u32 s14, s14, 1
    s_mov_b32 s15, 0
    s_mov_b32 s16, 0
    s_cmp_eq_u32 s14, 1
    s_cbranch_scc1 M_slow
M_sovf:
    s_cmp_ge_u32 s15, 250
    s_cbranch_scc1 M_send
    s_cmp_lg_u32 s16, 0
    s_cbranch_scc1 M_sblk
    s_lshl_b32 s27, s15, 15
    s_add_u32 s27, s27, s53
    v_mov_b32 v12, 0
    buffer_load_dword v13, v12, s[36:39], s27 offen offset:124 sc1
    s_waitcnt vmcnt(0)
    v_readfirstlane_b32 s17, v13
    s_xor_b32 s17, s17, s60
    s_bfe_u32 s17, s17, 0x170001
    s_cmp_gt_u32 s17, 32
    s_cselect_b32 s17, 1, 0
    s_cbranch_scc0 M_sblk0
    s_lshl_b32 s27, s15, 15
    s_add_u32 s27, s27, 32124
    buffer_load_dword v13, v12, s[36:39], s27 offen sc1
    s_waitcnt vmcnt(0)
    v_readfirstlane_b32 s17, v13
    s_min_u32 s17, s17, 3200
M_sblk0:
M_sblk:
    s_cmp_lt_u32 s16, s17
    s_cbranch_scc1 M_sld
    s_add_u32 s15, s15, 1
    s_mov_b32 s16, 0
    s_branch M_sovf
M_sld:
    s_mul_i32 s27, s15, 32768
    s_add_u32 s27, s27, 0x1100000
    v_add_u32 v12, s16, v8
    v_cmp_gt_u32 s[54:55], s17, v12
    v_lshlrev_b32 v12, 3, v12
    s_nop 0
    v_cndmask_b32 v12, v14, v12, s[54:55]
    buffer_load_dwordx2 v[88:89], v12, s[36:39], s27 offen sc1
    s_waitcnt vmcnt(0)
    v_cmp_eq_u32 vcc, s2, v89
    s_and_b64 s[54:55], s[54:55], vcc
    v_lshrrev_b32 v16, 24, v88
    v_subrev_u32 v17, s59, v16
    v_cmp_gt_u32 vcc, s45, v17
    s_and_b64 s[54:55], s[54:55], vcc
    v_and_b32 v96, 0x1fffe, v88
    v_lshl_add_u32 v96, v96, 1, v96
    v_and_b32 v96, -4, v96
    v_cndmask_b32 v96, v14, v96, s[54:55]
    buffer_load_dwordx2 v[98:99], v96, s[92:95], 0 offen
    v_mul_u32_u24 v97, 6, v16
    v_and_b32 v97, -4, v97
    v_cndmask_b32 v97, v14, v97, s[54:55]
    s_mul_i32 s27, s2, 1200
    buffer_load_dwordx2 v[100:101], v97, s[92:95], s27 offen
    v_bfe_i32 v102, v88, 1, 1
    v_and_or_b32 v102, v102, s63, v103
    v_bfe_i32 v104, v16, 0, 1
    v_and_or_b32 v104, v104, s63, v103
    v_add_u32 v105, s63, v104
    v_add_u32 v106, s63, v105
    s_waitcnt vmcnt(0)
    v_perm_b32 v107, v101, v100, v104
    v_perm_b32 v108, v101, v100, v105
    v_perm_b32 v109, v101, v100, v106
    v_add_u32 v113, s63, v102
    v_perm_b32 v110, v99, v98, v102
    v_add_u32 v114, s63, v113
    v_perm_b32 v111, v99, v98, v113
    v_perm_b32 v112, v99, v98, v114
    v_sub_f32 v110, v110, v107
    v_sub_f32 v111, v111, v108
    v_sub_f32 v112, v112, v109
    v_cvt_pk_bf16_f32 v89, v110, v111
    v_cvt_pk_bf16_f32 v112, 0, v112
    v_lshlrev_b32 v110, 16, v89
    v_and_b32 v111, s58, v89
    v_mul_f32 v115, v112, v112
    v_mul_f32 v110, v110, v110
    v_mul_f32 v111, v111, v111
    v_cvt_pk_bf16_f32 v115, 0, v115
    v_cvt_pk_bf16_f32 v110, 0, v110
    v_cvt_pk_bf16_f32 v111, 0, v111
    v_add_f32 v110, v110, v111
    v_add_f32 v110, v110, v115
    v_cvt_pk_bf16_f32 v110, 0, v110
    v_add_f32 v110, s64, v110
    v_cvt_pk_bf16_f32 v110, 0, v110
    v_sqrt_f32 v110, v110
    s_nop 0
    v_cvt_pk_bf16_f32 v90, v112, v110
    s_mov_b32 s27, 0x409d0000
    v_cmp_gt_u32 vcc, s27, v90
    s_and_b64 s[8:9], s[54:55], vcc
    s_mul_i32 s27, s15, 32768
    s_add_u32 s27, s27, 0x1100000
    v_add_u32 v12, s16, v86
    v_cmp_gt_u32 s[54:55], s17, v12
    v_lshlrev_b32 v12, 3, v12
    s_nop 0
    v_cndmask_b32 v12, v14, v12, s[54:55]
    buffer_load_dwordx2 v[92:93], v12, s[36:39], s27 offen sc1
    s_waitcnt vmcnt(0)
    v_cmp_eq_u32 vcc, s2, v93
    s_and_b64 s[54:55], s[54:55], vcc
    v_lshrrev_b32 v16, 24, v92
    v_subrev_u32 v17, s59, v16
    v_cmp_gt_u32 vcc, s45, v17
    s_and_b64 s[54:55], s[54:55], vcc
    v_and_b32 v96, 0x1fffe, v92
    v_lshl_add_u32 v96, v96, 1, v96
    v_and_b32 v96, -4, v96
    v_cndmask_b32 v96, v14, v96, s[54:55]
    buffer_load_dwordx2 v[98:99], v96, s[92:95], 0 offen
    v_mul_u32_u24 v97, 6, v16
    v_and_b32 v97, -4, v97
    v_cndmask_b32 v97, v14, v97, s[54:55]
    s_mul_i32 s27, s2, 1200
    buffer_load_dwordx2 v[100:101], v97, s[92:95], s27 offen
    v_bfe_i32 v102, v92, 1, 1
    v_and_or_b32 v102, v102, s63, v103
    v_bfe_i32 v104, v16, 0, 1
    v_and_or_b32 v104, v104, s63, v103
    v_add_u32 v105, s63, v104
    v_add_u32 v106, s63, v105
    s_waitcnt vmcnt(0)
    v_perm_b32 v107, v101, v100, v104
    v_perm_b32 v108, v101, v100, v105
    v_perm_b32 v109, v101, v100, v106
    v_add_u32 v113, s63, v102
    v_perm_b32 v110, v99, v98, v102
    v_add_u32 v114, s63, v113
    v_perm_b32 v111, v99, v98, v113
    v_perm_b32 v112, v99, v98, v114
    v_sub_f32 v110, v110, v107
    v_sub_f32 v111, v111, v108
    v_sub_f32 v112, v112, v109
    v_cvt_pk_bf16_f32 v93, v110, v111
    v_cvt_pk_bf16_f32 v112, 0, v112
    v_lshlrev_b32 v110, 16, v93
    v_and_b32 v111, s58, v93
    v_mul_f32 v115, v112, v112
    v_mul_f32 v110, v110, v110
    v_mul_f32 v111, v111, v111
    v_cvt_pk_bf16_f32 v115, 0, v115
    v_cvt_pk_bf16_f32 v110, 0, v110
    v_cvt_pk_bf16_f32 v111, 0, v111
    v_add_f32 v110, v110, v111
    v_add_f32 v110, v110, v115
    v_cvt_pk_bf16_f32 v110, 0, v110
    v_add_f32 v110, s64, v110
    v_cvt_pk_bf16_f32 v110, 0, v110
    v_sqrt_f32 v110, v110
    s_nop 0
    v_cvt_pk_bf16_f32 v94, v112, v110
    s_mov_b32 s27, 0x409d0000
    v_cmp_gt_u32 vcc, s27, v94
    s_and_b64 s[10:11], s[54:55], vcc
    s_add_u32 s16, s16, 128
    s_nop 2
M_sgo:
    s_or_b64 s[54:55], s[8:9], s[10:11]
    s_cmp_eq_u64 s[54:55], 0
    s_cbranch_scc1 M_slow
    s_mov_b32 s48, 4
    s_cmp_eq_u64 s[10:11], 0
    s_cselect_b32 s48, 2, 4
    s_movk_i32 s63, 0x70
    s_movk_i32 s64, 128
    v_lshrrev_b32 v8, 4, v1
    v_lshrrev_b32 v10, 5, v8
    v_and_b32 v11, 31, v8
    v_lshlrev_b32 v3, 4, v11
    v_add_u32 v3, s52, v3
    v_mul_u32_u24 v0, 56, v10
    v_add_u32 v0, s52, v0
    v_lshrrev_b32 v13, 3, v11
    v_lshl_add_u32 v4, v13, 3, v0
    v_lshrrev_b32 v13, 3, v8
    v_and_b32 v14, 1, v13
    v_lshrrev_b32 v13, 1, v13
    v_lshl_add_u32 v13, v14, 2, v13
    v_lshlrev_b32 v5, 4, v13
    v_add_u32 v5, s52, v5
    v_add_u32 v16, s52, v1
    v_lshrrev_b32 v17, 2, v8
    v_mul_u32_u24 v17, 56, v17
    v_and_b32 v13, 3, v8
    v_lshl_add_u32 v17, v13, 1, v17
    v_add_u32 v17, s52, v17
    s_nop 1
    s_branch M_win
M_send:
    s_mov_b64 s[8:9], 0
    s_mov_b64 s[10:11], 0
    s_mov_b32 s48, 0
    s_mov_b32 s76, 1
    s_movk_i32 s63, 0x70
    s_movk_i32 s64, 128
    v_lshrrev_b32 v8, 4, v1
    v_lshrrev_b32 v10, 5, v8
    v_and_b32 v11, 31, v8
    v_lshlrev_b32 v3, 4, v11
    v_add_u32 v3, s52, v3
    v_mul_u32_u24 v0, 56, v10
    v_add_u32 v0, s52, v0
    v_lshrrev_b32 v13, 3, v11
    v_lshl_add_u32 v4, v13, 3, v0
    v_lshrrev_b32 v13, 3, v8
    v_and_b32 v14, 1, v13
    v_lshrrev_b32 v13, 1, v13
    v_lshl_add_u32 v13, v14, 2, v13
    v_lshlrev_b32 v5, 4, v13
    v_add_u32 v5, s52, v5
    v_add_u32 v16, s52, v1
    v_lshrrev_b32 v17, 2, v8
    v_mul_u32_u24 v17, 56, v17
    v_and_b32 v13, 3, v8
    v_lshl_add_u32 v17, v13, 1, v17
    v_add_u32 v17, s52, v17
    s_nop 1
    s_branch M_win
M_epi:
    v_lshrrev_b32 v8, 4, v1
    v_lshrrev_b32 v10, 5, v8
    v_and_b32 v11, 31, v8
    v_lshlrev_b32 v12, 11, v10
    v_lshl_add_u32 v12, v11, 2, v12
    v_cvt_pk_bf16_f32 v64, v128, v144
    v_cvt_pk_bf16_f32 v65, v129, v145
    v_cvt_pk_bf16_f32 v66, v130, v146
    v_cvt_pk_bf16_f32 v67, v131, v147
    v_cvt_pk_bf16_f32 v68, v132, v148
    v_cvt_pk_bf16_f32 v69, v133, v149
    v_cvt_pk_bf16_f32 v70, v134, v150
    v_cvt_pk_bf16_f32 v71, v135, v151
    v_cvt_pk_bf16_f32 v72, v136, v152
    v_cvt_pk_bf16_f32 v73, v137, v153
    v_cvt_pk_bf16_f32 v74, v138, v154
    v_cvt_pk_bf16_f32 v75, v139, v155
    buffer_store_dword v64, v12, s[32:35], s40 offen offset:0 sc1 nt
    buffer_store_dword v65, v12, s[32:35], s40 offen offset:512 sc1 nt
    buffer_store_dword v66, v12, s[32:35], s40 offen offset:1024 sc1 nt
    buffer_store_dword v67, v12, s[32:35], s40 offen offset:1536 sc1 nt
    buffer_store_dword v68, v12, s[32:35], s41 offen offset:0 sc1 nt
    buffer_store_dword v69, v12, s[32:35], s41 offen offset:512 sc1 nt
    buffer_store_dword v70, v12, s[32:35], s41 offen offset:1024 sc1 nt
    buffer_store_dword v71, v12, s[32:35], s41 offen offset:1536 sc1 nt
    buffer_store_dword v72, v12, s[32:35], s42 offen offset:0 sc1 nt
    buffer_store_dword v73, v12, s[32:35], s42 offen offset:512 sc1 nt
    buffer_store_dword v74, v12, s[32:35], s42 offen offset:1024 sc1 nt
    buffer_store_dword v75, v12, s[32:35], s42 offen offset:1536 sc1 nt
    v_cvt_pk_bf16_f32 v80, v160, v176
    v_cvt_pk_bf16_f32 v81, v161, v177
    v_cvt_pk_bf16_f32 v82, v162, v178
    v_cvt_pk_bf16_f32 v83, v163, v179
    v_cvt_pk_bf16_f32 v84, v164, v180
    v_cvt_pk_bf16_f32 v85, v165, v181
    v_cvt_pk_bf16_f32 v86, v166, v182
    v_cvt_pk_bf16_f32 v87, v167, v183
    v_cvt_pk_bf16_f32 v88, v168, v184
    v_cvt_pk_bf16_f32 v89, v169, v185
    v_cvt_pk_bf16_f32 v90, v170, v186
    v_cvt_pk_bf16_f32 v91, v171, v187
    buffer_store_dword v80, v12, s[32:35], s40 offen offset:128 sc1 nt
    buffer_store_dword v81, v12, s[32:35], s40 offen offset:640 sc1 nt
    buffer_store_dword v82, v12, s[32:35], s40 offen offset:1152 sc1 nt
    buffer_store_dword v83, v12, s[32:35], s40 offen offset:1664 sc1 nt
    buffer_store_dword v84, v12, s[32:35], s41 offen offset:128 sc1 nt
    buffer_store_dword v85, v12, s[32:35], s41 offen offset:640 sc1 nt
    buffer_store_dword v86, v12, s[32:35], s41 offen offset:1152 sc1 nt
    buffer_store_dword v87, v12, s[32:35], s41 offen offset:1664 sc1 nt
    buffer_store_dword v88, v12, s[32:35], s42 offen offset:128 sc1 nt
    buffer_store_dword v89, v12, s[32:35], s42 offen offset:640 sc1 nt
    buffer_store_dword v90, v12, s[32:35], s42 offen offset:1152 sc1 nt
    buffer_store_dword v91, v12, s[32:35], s42 offen offset:1664 sc1 nt
    s_waitcnt vmcnt(24)
    ds_read_u16_d16_hi v16, v2 offset:1024
    ds_read_u16_d16_hi v17, v2 offset:1280
    ds_read_u16_d16_hi v18, v2 offset:1536
    ds_read_u16_d16_hi v19, v2 offset:1792
    ds_read_u16_d16_hi v20, v2 offset:4096
    ds_read_u16_d16_hi v21, v2 offset:4352
    ds_read_u16_d16_hi v22, v2 offset:4608
    ds_read_u16_d16_hi v23, v2 offset:4864
    ds_read_u16_d16_hi v24, v2 offset:7168
    ds_read_u16_d16_hi v25, v2 offset:7424
    ds_read_u16_d16_hi v26, v2 offset:7680
    ds_read_u16_d16_hi v27, v2 offset:7936
    ds_read_u16_d16_hi v32, v2 offset:1026
    ds_read_u16_d16_hi v33, v2 offset:1282
    ds_read_u16_d16_hi v34, v2 offset:1538
    ds_read_u16_d16_hi v35, v2 offset:1794
    ds_read_u16_d16_hi v36, v2 offset:4098
    ds_read_u16_d16_hi v37, v2 offset:4354
    ds_read_u16_d16_hi v38, v2 offset:4610
    ds_read_u16_d16_hi v39, v2 offset:4866
    ds_read_u16_d16_hi v40, v2 offset:7170
    ds_read_u16_d16_hi v41, v2 offset:7426
    ds_read_u16_d16_hi v42, v2 offset:7682
    ds_read_u16_d16_hi v43, v2 offset:7938
    s_waitcnt lgkmcnt(15)
    v_add_f32 v192, v192, v16
    v_add_f32 v193, v193, v17
    v_add_f32 v194, v194, v18
    v_add_f32 v195, v195, v19
    v_add_f32 v196, v196, v20
    v_add_f32 v197, v197, v21
    v_add_f32 v198, v198, v22
    v_add_f32 v199, v199, v23
    v_add_f32 v200, v200, v24
    s_waitcnt lgkmcnt(14)
    v_add_f32 v201, v201, v25
    s_waitcnt lgkmcnt(13)
    v_add_f32 v202, v202, v26
    s_waitcnt lgkmcnt(12)
    v_add_f32 v203, v203, v27
    s_waitcnt lgkmcnt(11)
    v_add_f32 v208, v208, v32
    s_waitcnt lgkmcnt(10)
    v_add_f32 v209, v209, v33
    s_waitcnt lgkmcnt(9)
    v_add_f32 v210, v210, v34
    s_waitcnt lgkmcnt(8)
    v_add_f32 v211, v211, v35
    s_waitcnt lgkmcnt(7)
    v_add_f32 v212, v212, v36
    s_waitcnt lgkmcnt(6)
    v_add_f32 v213, v213, v37
    s_waitcnt lgkmcnt(5)
    v_add_f32 v214, v214, v38
    s_waitcnt lgkmcnt(4)
    v_add_f32 v215, v215, v39
    s_waitcnt lgkmcnt(3)
    v_add_f32 v216, v216, v40
    s_waitcnt lgkmcnt(2)
    v_add_f32 v217, v217, v41
    s_waitcnt lgkmcnt(1)
    v_add_f32 v218, v218, v42
    s_waitcnt lgkmcnt(0)
    v_add_f32 v219, v219, v43
    v_cvt_pk_bf16_f32 v96, v192, v208
    v_cvt_pk_bf16_f32 v97, v193, v209
    v_cvt_pk_bf16_f32 v98, v194, v210
    v_cvt_pk_bf16_f32 v99, v195, v211
    v_cvt_pk_bf16_f32 v100, v196, v212
    v_cvt_pk_bf16_f32 v101, v197, v213
    v_cvt_pk_bf16_f32 v102, v198, v214
    v_cvt_pk_bf16_f32 v103, v199, v215
    v_cvt_pk_bf16_f32 v104, v200, v216
    v_cvt_pk_bf16_f32 v105, v201, v217
    v_cvt_pk_bf16_f32 v106, v202, v218
    v_cvt_pk_bf16_f32 v107, v203, v219
    buffer_store_dword v96, v12, s[32:35], s40 offen offset:256 sc1 nt
    buffer_store_dword v97, v12, s[32:35], s40 offen offset:768 sc1 nt
    buffer_store_dword v98, v12, s[32:35], s40 offen offset:1280 sc1 nt
    buffer_store_dword v99, v12, s[32:35], s40 offen offset:1792 sc1 nt
    buffer_store_dword v100, v12, s[32:35], s41 offen offset:256 sc1 nt
    buffer_store_dword v101, v12, s[32:35], s41 offen offset:768 sc1 nt
    buffer_store_dword v102, v12, s[32:35], s41 offen offset:1280 sc1 nt
    buffer_store_dword v103, v12, s[32:35], s41 offen offset:1792 sc1 nt
    buffer_store_dword v104, v12, s[32:35], s42 offen offset:256 sc1 nt
    buffer_store_dword v105, v12, s[32:35], s42 offen offset:768 sc1 nt
    buffer_store_dword v106, v12, s[32:35], s42 offen offset:1280 sc1 nt
    buffer_store_dword v107, v12, s[32:35], s42 offen offset:1792 sc1 nt
    ds_read_u16_d16_hi v16, v2 offset:2048
    ds_read_u16_d16_hi v17, v2 offset:2304
    ds_read_u16_d16_hi v18, v2 offset:2560
    ds_read_u16_d16_hi v19, v2 offset:2816
    ds_read_u16_d16_hi v20, v2 offset:5120
    ds_read_u16_d16_hi v21, v2 offset:5376
    ds_read_u16_d16_hi v22, v2 offset:5632
    ds_read_u16_d16_hi v23, v2 offset:5888
    ds_read_u16_d16_hi v24, v2 offset:8192
    ds_read_u16_d16_hi v25, v2 offset:8448
    ds_read_u16_d16_hi v26, v2 offset:8704
    ds_read_u16_d16_hi v27, v2 offset:8960
    ds_read_u16_d16_hi v32, v2 offset:2050
    ds_read_u16_d16_hi v33, v2 offset:2306
    ds_read_u16_d16_hi v34, v2 offset:2562
    ds_read_u16_d16_hi v35, v2 offset:2818
    ds_read_u16_d16_hi v36, v2 offset:5122
    ds_read_u16_d16_hi v37, v2 offset:5378
    ds_read_u16_d16_hi v38, v2 offset:5634
    ds_read_u16_d16_hi v39, v2 offset:5890
    ds_read_u16_d16_hi v40, v2 offset:8194
    ds_read_u16_d16_hi v41, v2 offset:8450
    ds_read_u16_d16_hi v42, v2 offset:8706
    ds_read_u16_d16_hi v43, v2 offset:8962
    s_waitcnt lgkmcnt(15)
    v_add_f32 v224, v224, v16
    v_add_f32 v225, v225, v17
    v_add_f32 v226, v226, v18
    v_add_f32 v227, v227, v19
    v_add_f32 v228, v228, v20
    v_add_f32 v229, v229, v21
    v_add_f32 v230, v230, v22
    v_add_f32 v231, v231, v23
    v_add_f32 v232, v232, v24
    s_waitcnt lgkmcnt(14)
    v_add_f32 v233, v233, v25
    s_waitcnt lgkmcnt(13)
    v_add_f32 v234, v234, v26
    s_waitcnt lgkmcnt(12)
    v_add_f32 v235, v235, v27
    s_waitcnt lgkmcnt(11)
    v_add_f32 v240, v240, v32
    s_waitcnt lgkmcnt(10)
    v_add_f32 v241, v241, v33
    s_waitcnt lgkmcnt(9)
    v_add_f32 v242, v242, v34
    s_waitcnt lgkmcnt(8)
    v_add_f32 v243, v243, v35
    s_waitcnt lgkmcnt(7)
    v_add_f32 v244, v244, v36
    s_waitcnt lgkmcnt(6)
    v_add_f32 v245, v245, v37
    s_waitcnt lgkmcnt(5)
    v_add_f32 v246, v246, v38
    s_waitcnt lgkmcnt(4)
    v_add_f32 v247, v247, v39
    s_waitcnt lgkmcnt(3)
    v_add_f32 v248, v248, v40
    s_waitcnt lgkmcnt(2)
    v_add_f32 v249, v249, v41
    s_waitcnt lgkmcnt(1)
    v_add_f32 v250, v250, v42
    s_waitcnt lgkmcnt(0)
    v_add_f32 v251, v251, v43
    v_cvt_pk_bf16_f32 v112, v224, v240
    v_cvt_pk_bf16_f32 v113, v225, v241
    v_cvt_pk_bf16_f32 v114, v226, v242
    v_cvt_pk_bf16_f32 v115, v227, v243
    v_cvt_pk_bf16_f32 v116, v228, v244
    v_cvt_pk_bf16_f32 v117, v229, v245
    v_cvt_pk_bf16_f32 v118, v230, v246
    v_cvt_pk_bf16_f32 v119, v231, v247
    v_cvt_pk_bf16_f32 v120, v232, v248
    v_cvt_pk_bf16_f32 v121, v233, v249
    v_cvt_pk_bf16_f32 v122, v234, v250
    v_cvt_pk_bf16_f32 v123, v235, v251
    buffer_store_dword v112, v12, s[32:35], s40 offen offset:384 sc1 nt
    buffer_store_dword v113, v12, s[32:35], s40 offen offset:896 sc1 nt
    buffer_store_dword v114, v12, s[32:35], s40 offen offset:1408 sc1 nt
    buffer_store_dword v115, v12, s[32:35], s40 offen offset:1920 sc1 nt
    buffer_store_dword v116, v12, s[32:35], s41 offen offset:384 sc1 nt
    buffer_store_dword v117, v12, s[32:35], s41 offen offset:896 sc1 nt
    buffer_store_dword v118, v12, s[32:35], s41 offen offset:1408 sc1 nt
    buffer_store_dword v119, v12, s[32:35], s41 offen offset:1920 sc1 nt
    buffer_store_dword v120, v12, s[32:35], s42 offen offset:384 sc1 nt
    buffer_store_dword v121, v12, s[32:35], s42 offen offset:896 sc1 nt
    buffer_store_dword v122, v12, s[32:35], s42 offen offset:1408 sc1 nt
    buffer_store_dword v123, v12, s[32:35], s42 offen offset:1920 sc1 nt
    s_cmp_le_u32 s45, 24
    s_cbranch_scc1 M_fin
    v_cvt_pk_bf16_f32 v76, v140, v156
    v_cvt_pk_bf16_f32 v77, v141, v157
    v_cvt_pk_bf16_f32 v78, v142, v158
    v_cvt_pk_bf16_f32 v79, v143, v159
    buffer_store_dword v76, v12, s[32:35], s43 offen offset:0 sc1 nt
    buffer_store_dword v77, v12, s[32:35], s43 offen offset:512 sc1 nt
    buffer_store_dword v78, v12, s[32:35], s43 offen offset:1024 sc1 nt
    buffer_store_dword v79, v12, s[32:35], s43 offen offset:1536 sc1 nt
    v_cvt_pk_bf16_f32 v92, v172, v188
    v_cvt_pk_bf16_f32 v93, v173, v189
    v_cvt_pk_bf16_f32 v94, v174, v190
    v_cvt_pk_bf16_f32 v95, v175, v191
    buffer_store_dword v92, v12, s[32:35], s43 offen offset:128 sc1 nt
    buffer_store_dword v93, v12, s[32:35], s43 offen offset:640 sc1 nt
    buffer_store_dword v94, v12, s[32:35], s43 offen offset:1152 sc1 nt
    buffer_store_dword v95, v12, s[32:35], s43 offen offset:1664 sc1 nt
    ds_read_u16_d16_hi v28, v2 offset:10240
    ds_read_u16_d16_hi v29, v2 offset:10496
    ds_read_u16_d16_hi v30, v2 offset:10752
    ds_read_u16_d16_hi v31, v2 offset:11008
    ds_read_u16_d16_hi v44, v2 offset:10242
    ds_read_u16_d16_hi v45, v2 offset:10498
    ds_read_u16_d16_hi v46, v2 offset:10754
    ds_read_u16_d16_hi v47, v2 offset:11010
    s_waitcnt lgkmcnt(7)
    v_add_f32 v204, v204, v28
    s_waitcnt lgkmcnt(6)
    v_add_f32 v205, v205, v29
    s_waitcnt lgkmcnt(5)
    v_add_f32 v206, v206, v30
    s_waitcnt lgkmcnt(4)
    v_add_f32 v207, v207, v31
    s_waitcnt lgkmcnt(3)
    v_add_f32 v220, v220, v44
    s_waitcnt lgkmcnt(2)
    v_add_f32 v221, v221, v45
    s_waitcnt lgkmcnt(1)
    v_add_f32 v222, v222, v46
    s_waitcnt lgkmcnt(0)
    v_add_f32 v223, v223, v47
    v_cvt_pk_bf16_f32 v108, v204, v220
    v_cvt_pk_bf16_f32 v109, v205, v221
    v_cvt_pk_bf16_f32 v110, v206, v222
    v_cvt_pk_bf16_f32 v111, v207, v223
    buffer_store_dword v108, v12, s[32:35], s43 offen offset:256 sc1 nt
    buffer_store_dword v109, v12, s[32:35], s43 offen offset:768 sc1 nt
    buffer_store_dword v110, v12, s[32:35], s43 offen offset:1280 sc1 nt
    buffer_store_dword v111, v12, s[32:35], s43 offen offset:1792 sc1 nt
    ds_read_u16_d16_hi v28, v2 offset:11264
    ds_read_u16_d16_hi v29, v2 offset:11520
    ds_read_u16_d16_hi v30, v2 offset:11776
    ds_read_u16_d16_hi v31, v2 offset:12032
    ds_read_u16_d16_hi v44, v2 offset:11266
    ds_read_u16_d16_hi v45, v2 offset:11522
    ds_read_u16_d16_hi v46, v2 offset:11778
    ds_read_u16_d16_hi v47, v2 offset:12034
    s_waitcnt lgkmcnt(7)
    v_add_f32 v236, v236, v28
    s_waitcnt lgkmcnt(6)
    v_add_f32 v237, v237, v29
    s_waitcnt lgkmcnt(5)
    v_add_f32 v238, v238, v30
    s_waitcnt lgkmcnt(4)
    v_add_f32 v239, v239, v31
    s_waitcnt lgkmcnt(3)
    v_add_f32 v252, v252, v44
    s_waitcnt lgkmcnt(2)
    v_add_f32 v253, v253, v45
    s_waitcnt lgkmcnt(1)
    v_add_f32 v254, v254, v46
    s_waitcnt lgkmcnt(0)
    v_add_f32 v255, v255, v47
    v_cvt_pk_bf16_f32 v124, v236, v252
    v_cvt_pk_bf16_f32 v125, v237, v253
    v_cvt_pk_bf16_f32 v126, v238, v254
    v_cvt_pk_bf16_f32 v127, v239, v255
    buffer_store_dword v124, v12, s[32:35], s43 offen offset:384 sc1 nt
    buffer_store_dword v125, v12, s[32:35], s43 offen offset:896 sc1 nt
    buffer_store_dword v126, v12, s[32:35], s43 offen offset:1408 sc1 nt
    buffer_store_dword v127, v12, s[32:35], s43 offen offset:1920 sc1 nt
M_fin:
K_end:
    s_endpgm
.section .rodata,"a"
.p2align 6
.amdhsa_kernel fused_kernel
  .amdhsa_next_free_vgpr 256
  .amdhsa_next_free_sgpr 102
  .amdhsa_accum_offset 256
  .amdhsa_group_segment_fixed_size 0
  .amdhsa_kernarg_size 88
  .amdhsa_user_sgpr_count 2
  .amdhsa_user_sgpr_kernarg_segment_ptr 1
  .amdhsa_system_sgpr_workgroup_id_x 1
  .amdhsa_float_denorm_mode_32 3
.end_amdhsa_kernel
```

```asm
; @launch grid=(250,1,1) block=(512,1,1) lds=163840
.amdgcn_target "amdgcn-amd-amdhsa--gfx950"
.text
.globl standalone__molecular_angular_painn__graph_kernel
.p2align 8
.type standalone__molecular_angular_painn__graph_kernel,@function
standalone__molecular_angular_painn__graph_kernel:
    s_cmp_ge_u32 s2, 250
    s_cbranch_scc1 K_end
    s_load_dwordx8 s[4:11], s[0:1], 0
    s_load_dwordx8 s[12:19], s[0:1], 32
    s_load_dwordx2 s[20:21], s[0:1], 64
    s_load_dwordx2 s[24:25], s[0:1], 80
    v_and_b32 v1, 63, v0
    v_lshrrev_b32 v119, 6, v0
    v_lshlrev_b32 v2, 4, v0
    v_readfirstlane_b32 s26, v119
    v_mov_b32 v20, 0xff000000
    v_mov_b32 v21, v20
    v_mov_b32 v22, v20
    v_mov_b32 v23, v20
    v_add_u32 v117, 131840, v2
    ds_write_b128 v117, v[20:23] offset:0
    ds_write_b128 v117, v[20:23] offset:8192
    ds_write_b128 v117, v[20:23] offset:16384
    v_cmp_gt_u32 vcc, 464, v0
    s_mov_b64 s[66:67], vcc
    s_mov_b64 exec, vcc
    ds_write_b128 v117, v[20:23] offset:24576
    s_mov_b64 exec, -1
    v_lshlrev_b32 v28, 2, v0
    v_mov_b32 v29, 0
    v_cmp_gt_u32 vcc, 256, v0
    s_and_saveexec_b64 s[60:61], vcc
    ds_write_b32 v28, v29 offset:8192
    s_mov_b64 exec, s[60:61]
    v_mov_b32 v30, 131076
    ds_write2_b32 v30, v29, v29 offset1:1
    s_mov_b32 s58, 0xffff0000
    v_lshlrev_b32 v3, 4, v1
    v_mov_b32 v116, 1
    v_lshrrev_b32 v119, 4, v1
    v_and_b32 v120, 15, v1
    v_lshlrev_b32 v121, 9, v120
    v_lshl_add_u32 v121, v119, 4, v121
    v_bfrev_b32 v118, 2
    s_cmp_eq_u32 s26, 4
    s_cselect_b32 s63, 8, 16
    s_cmp_gt_u32 s26, 4
    s_cselect_b32 s63, 0, s63
    v_cmp_gt_u32 vcc, s63, v120
    s_nop 1
    v_cndmask_b32 v36, v118, v121, vcc
    s_mul_i32 s62, s2, 200
    s_lshl_b32 s61, s26, 4
    s_add_u32 s62, s62, s61
    s_lshl_b32 s76, s62, 9
    s_add_u32 s77, s76, 65536
    s_mul_i32 s27, s2, 12800
    s_add_u32 s59, s27, 6400
    v_cmp_gt_u32 vcc, 400, v0
    s_mov_b64 s[56:57], vcc
    s_lshl_b32 s64, s26, 10
    s_add_u32 m0, s64, 0
    s_waitcnt lgkmcnt(0)
    s_barrier
    s_mov_b32 s48, s14
    s_mov_b32 s49, s15
    s_mov_b32 s50, 0x2000
    s_mov_b32 s51, 0x00020000
    s_cmp_eq_u32 s26, 7
    s_cbranch_scc1 P_w7
    s_mov_b32 s44, s10
    s_mov_b32 s45, s11
    s_mov_b32 s46, 0x30d400
    s_mov_b32 s47, 0x00020000
    s_mov_b32 s40, s8
    s_mov_b32 s41, s9
    s_mov_b32 s42, 0x30d400
    s_mov_b32 s43, 0x00020000
    s_mov_b32 s28, s4
    s_mov_b32 s29, s5
    s_mov_b32 s30, 0x186a000
    s_mov_b32 s31, 0x00020000
    buffer_load_dwordx4 v3, s[48:51], s64 offen lds
    s_mov_b64 exec, s[56:57]
    buffer_load_dwordx4 v[4:7], v2, s[44:47], s27 offen nt
    buffer_load_dwordx4 v[8:11], v2, s[44:47], s59 offen nt
    buffer_load_dwordx4 v[12:15], v2, s[40:43], s27 offen nt
    buffer_load_dwordx4 v[16:19], v2, s[40:43], s59 offen nt
    s_mov_b64 exec, -1
    s_mov_b32 s92, s6
    s_mov_b32 s93, s7
    s_mov_b32 s94, 0x493e0
    s_mov_b32 s95, 0x00020000
    s_mov_b32 s36, s24
    s_mov_b32 s37, s25
    s_mov_b32 s38, 0x241a800
    s_mov_b32 s39, 0x00020000
    s_add_u32 s72, s24, 0x1e00000
    s_addc_u32 s73, s25, 0
    s_mov_b32 s74, 0x61a800
    s_mov_b32 s75, 0x00020000
    s_mov_b32 s52, s16
    s_mov_b32 s53, s17
    s_mov_b32 s54, 0x6000
    s_mov_b32 s55, 0x00020000
    s_mov_b32 s96, s18
    s_mov_b32 s97, s19
    s_mov_b32 s98, 0x1800
    s_mov_b32 s99, 0x00020000
    s_mov_b32 s68, s12
    s_mov_b32 s69, s13
    s_mov_b32 s70, 0x20
    s_mov_b32 s71, 0x00020000
    s_mov_b32 s32, s20
    s_mov_b32 s33, s21
    s_mov_b32 s34, 0x186a000
    s_mov_b32 s35, 0x00020000
    v_bfe_u32 v122, v1, 2, 2
    v_lshl_add_u32 v122, v119, 3, v122
    v_lshlrev_b32 v122, 7, v122
    v_and_b32 v39, 3, v1
    v_lshl_add_u32 v122, v39, 3, v122
    s_mov_b32 s63, 0x147AE15
    s_movk_i32 s65, -200
    s_mov_b32 s60, 8192
    s_mov_b32 s61, 131840
    s_mov_b64 exec, s[56:57]
    s_waitcnt vmcnt(3)
    s_mov_b64 exec, -1
    buffer_load_dwordx4 v[20:23], v121, s[28:31], s76 offen offset:0
    buffer_load_dwordx4 v[24:27], v121, s[28:31], s76 offen offset:64
    buffer_load_dwordx4 v[28:31], v36, s[28:31], s77 offen offset:0
    buffer_load_dwordx4 v[32:35], v36, s[28:31], s77 offen offset:64
    v_lshrrev_b32 v124, 5, v1
    v_and_b32 v125, 31, v1
    v_mul_u32_u24 v124, 3072, v124
    v_lshl_add_u32 v124, v125, 2, v124
    s_lshr_b32 s60, s26, 2
    s_and_b32 s61, s26, 3
    s_mul_i32 s63, s61, 768
    s_lshl_b32 s65, s60, 7
    s_add_u32 s63, s63, s65
    s_add_u32 s65, s63, 0
    buffer_load_dword v128, v124, s[52:55], s65 offen
    s_add_u32 s65, s63, 6144
    buffer_load_dword v129, v124, s[52:55], s65 offen
    s_add_u32 s65, s63, 12288
    buffer_load_dword v130, v124, s[52:55], s65 offen
    s_add_u32 s65, s63, 18432
    buffer_load_dword v131, v124, s[52:55], s65 offen
    s_add_u32 s65, s63, 384
    buffer_load_dword v132, v124, s[52:55], s65 offen
    s_add_u32 s65, s63, 6528
    buffer_load_dword v133, v124, s[52:55], s65 offen
    s_add_u32 s65, s63, 12672
    buffer_load_dword v134, v124, s[52:55], s65 offen
    s_add_u32 s65, s63, 18816
    buffer_load_dword v135, v124, s[52:55], s65 offen
    s_cmp_ge_u32 s26, 4
    s_cbranch_scc1 P_e2a
    s_add_u32 s27, s26, 8
    s_lshr_b32 s60, s27, 2
    s_and_b32 s61, s27, 3
    s_mul_i32 s63, s61, 768
    s_lshl_b32 s65, s60, 7
    s_add_u32 s63, s63, s65
    s_add_u32 s65, s63, 0
    buffer_load_dword v136, v124, s[52:55], s65 offen
    s_add_u32 s65, s63, 6144
    buffer_load_dword v137, v124, s[52:55], s65 offen
    s_add_u32 s65, s63, 12288
    buffer_load_dword v138, v124, s[52:55], s65 offen
    s_add_u32 s65, s63, 18432
    buffer_load_dword v139, v124, s[52:55], s65 offen
    s_add_u32 s65, s63, 384
    buffer_load_dword v140, v124, s[52:55], s65 offen
    s_add_u32 s65, s63, 6528
    buffer_load_dword v141, v124, s[52:55], s65 offen
    s_add_u32 s65, s63, 12672
    buffer_load_dword v142, v124, s[52:55], s65 offen
    s_add_u32 s65, s63, 18816
    buffer_load_dword v143, v124, s[52:55], s65 offen
    s_branch P_e3a
P_e2a:
    s_sub_u32 s60, s26, 4
    s_lshl_b32 s63, s60, 7
    s_cmp_eq_u32 s26, 7
    s_cselect_b32 s63, 0x40000000, s63
    buffer_load_dword v136, v124, s[96:99], s63 offen offset:0
    buffer_load_dword v137, v124, s[96:99], s63 offen offset:384
    buffer_load_dword v138, v124, s[96:99], s63 offen offset:768
    buffer_load_dword v139, v124, s[96:99], s63 offen offset:1152
    buffer_load_dword v140, v124, s[96:99], s63 offen offset:1536
    buffer_load_dword v141, v124, s[96:99], s63 offen offset:1920
    buffer_load_dword v142, v124, s[96:99], s63 offen offset:2304
    buffer_load_dword v143, v124, s[96:99], s63 offen offset:2688
P_e3a:
    v_mul_u32_u24 v124, 6, v0
    v_and_b32 v124, -4, v124
    v_cmp_gt_u32 vcc, 200, v0
    s_nop 1
    v_cndmask_b32 v124, v118, v124, vcc
    s_mul_i32 s27, s2, 1200
    buffer_load_dwordx2 v[144:145], v124, s[92:95], s27 offen
    v_lshlrev_b32 v124, 1, v1
    buffer_load_ushort v146, v124, s[68:71], 0 offen
    s_mov_b32 s63, 0x147AE15
    s_movk_i32 s65, -200
    s_mov_b32 s60, 8192
    s_mov_b32 s61, 131840
    s_mov_b64 exec, s[56:57]
    v_mul_hi_u32 v68, v4, s63
    v_lshl_add_u32 v84, v68, 2, s60
    ds_add_rtn_u32 v76, v84, v116
    v_mul_hi_u32 v69, v5, s63
    v_lshl_add_u32 v85, v69, 2, s60
    ds_add_rtn_u32 v77, v85, v116
    v_mul_hi_u32 v70, v6, s63
    v_lshl_add_u32 v86, v70, 2, s60
    ds_add_rtn_u32 v78, v86, v116
    v_mul_hi_u32 v71, v7, s63
    v_lshl_add_u32 v87, v71, 2, s60
    ds_add_rtn_u32 v79, v87, v116
    s_waitcnt vmcnt(24)
    v_mul_hi_u32 v72, v8, s63
    v_lshl_add_u32 v88, v72, 2, s60
    ds_add_rtn_u32 v80, v88, v116
    v_mul_hi_u32 v73, v9, s63
    v_lshl_add_u32 v89, v73, 2, s60
    ds_add_rtn_u32 v81, v89, v116
    v_mul_hi_u32 v74, v10, s63
    v_lshl_add_u32 v90, v74, 2, s60
    ds_add_rtn_u32 v82, v90, v116
    v_mul_hi_u32 v75, v11, s63
    v_lshl_add_u32 v91, v75, 2, s60
    ds_add_rtn_u32 v83, v91, v116
    v_mad_i32_i24 v4, v68, s65, v4
    v_lshlrev_b32 v4, 24, v4
    v_lshl_add_u32 v84, v68, 7, s61
    v_mad_i32_i24 v5, v69, s65, v5
    v_lshlrev_b32 v5, 24, v5
    v_lshl_add_u32 v85, v69, 7, s61
    v_mad_i32_i24 v6, v70, s65, v6
    v_lshlrev_b32 v6, 24, v6
    v_lshl_add_u32 v86, v70, 7, s61
    v_mad_i32_i24 v7, v71, s65, v7
    v_lshlrev_b32 v7, 24, v7
    v_lshl_add_u32 v87, v71, 7, s61
    v_mad_i32_i24 v8, v72, s65, v8
    v_lshlrev_b32 v8, 24, v8
    v_lshl_add_u32 v88, v72, 7, s61
    v_mad_i32_i24 v9, v73, s65, v9
    v_lshlrev_b32 v9, 24, v9
    v_lshl_add_u32 v89, v73, 7, s61
    v_mad_i32_i24 v10, v74, s65, v10
    v_lshlrev_b32 v10, 24, v10
    v_lshl_add_u32 v90, v74, 7, s61
    v_mad_i32_i24 v11, v75, s65, v11
    v_lshlrev_b32 v11, 24, v11
    v_lshl_add_u32 v91, v75, 7, s61
    s_waitcnt vmcnt(22)
    v_lshl_or_b32 v92, v12, 1, v4
    v_lshl_or_b32 v93, v13, 1, v5
    v_lshl_or_b32 v94, v14, 1, v6
    v_lshl_or_b32 v95, v15, 1, v7
    v_lshl_or_b32 v96, v16, 1, v8
    v_lshl_or_b32 v97, v17, 1, v9
    v_lshl_or_b32 v98, v18, 1, v10
    v_lshl_or_b32 v99, v19, 1, v11
    s_waitcnt lgkmcnt(0)
    v_max3_u32 v36, v76, v77, v78
    v_max3_u32 v37, v79, v80, v81
    v_max3_u32 v36, v36, v82, v83
    v_max_u32 v36, v36, v37
    v_lshl_add_u32 v12, v76, 2, v84
    v_lshl_add_u32 v13, v77, 2, v85
    v_lshl_add_u32 v14, v78, 2, v86
    v_lshl_add_u32 v15, v79, 2, v87
    v_lshl_add_u32 v16, v80, 2, v88
    v_lshl_add_u32 v17, v81, 2, v89
    v_lshl_add_u32 v18, v82, 2, v90
    v_lshl_add_u32 v19, v83, 2, v91
    v_cmp_lt_u32 vcc, 30, v36
    s_nop 4
    s_cbranch_vccnz P_rare
    ds_write_b32 v12, v92
    ds_write_b32 v13, v93
    ds_write_b32 v14, v94
    ds_write_b32 v15, v95
    ds_write_b32 v16, v96
    ds_write_b32 v17, v97
    ds_write_b32 v18, v98
    ds_write_b32 v19, v99
    s_mov_b64 exec, -1
    s_branch P_join
P_rare:
    v_mov_b32 v37, 131080
    v_mov_b32 v38, 131076
    s_mul_i32 s27, s2, 32768
    s_add_u32 s27, s27, 0x1100000
    s_lshl_b32 s59, s2, 15
    s_add_u32 s59, s59, 0x8fff84
    s_mov_b64 exec, s[56:57]
    v_cmp_gt_u32 vcc, 31, v76
    s_and_b64 exec, vcc, s[56:57]
    s_nop 3
    s_cbranch_execz P_r10
    ds_write_b32 v12, v92
P_r10:
    s_andn2_b64 exec, s[56:57], vcc
    s_cbranch_execz P_r30
    s_mov_b64 s[14:15], exec
    v_lshlrev_b32 v36, 1, v76
    v_add_u32 v36, 0xfeffffc4, v36
    ds_max_u32 v84, v36 offset:124
    v_cmp_gt_u32 vcc, 63, v76
    s_and_b64 exec, vcc, s[14:15]
    s_nop 3
    s_cbranch_execz P_r20
    v_lshlrev_b32 v124, 7, v68
    v_lshl_add_u32 v124, v76, 2, v124
    buffer_store_dword v92, v124, s[36:39], s59 offen sc1
    s_nop 0
P_r20:
    s_andn2_b64 exec, s[14:15], vcc
    s_cbranch_execz P_r30
    ds_write_b32 v38, v116
    ds_add_rtn_u32 v124, v37, v116
    v_mov_b32 v126, v92
    v_mov_b32 v127, v68
    s_waitcnt lgkmcnt(0)
    v_lshlrev_b32 v124, 3, v124
    buffer_store_dwordx2 v[126:127], v124, s[36:39], s27 offen sc1
    s_nop 0
P_r30:
    s_mov_b64 exec, s[56:57]
    v_cmp_gt_u32 vcc, 31, v77
    s_and_b64 exec, vcc, s[56:57]
    s_nop 3
    s_cbranch_execz P_r11
    ds_write_b32 v13, v93
P_r11:
    s_andn2_b64 exec, s[56:57], vcc
    s_cbranch_execz P_r31
    s_mov_b64 s[14:15], exec
    v_lshlrev_b32 v36, 1, v77
    v_add_u32 v36, 0xfeffffc4, v36
    ds_max_u32 v85, v36 offset:124
    v_cmp_gt_u32 vcc, 63, v77
    s_and_b64 exec, vcc, s[14:15]
    s_nop 3
    s_cbranch_execz P_r21
    v_lshlrev_b32 v124, 7, v69
    v_lshl_add_u32 v124, v77, 2, v124
    buffer_store_dword v93, v124, s[36:39], s59 offen sc1
    s_nop 0
P_r21:
    s_andn2_b64 exec, s[14:15], vcc
    s_cbranch_execz P_r31
    ds_write_b32 v38, v116
    ds_add_rtn_u32 v124, v37, v116
    v_mov_b32 v126, v93
    v_mov_b32 v127, v69
    s_waitcnt lgkmcnt(0)
    v_lshlrev_b32 v124, 3, v124
    buffer_store_dwordx2 v[126:127], v124, s[36:39], s27 offen sc1
    s_nop 0
P_r31:
    s_mov_b64 exec, s[56:57]
    v_cmp_gt_u32 vcc, 31, v78
    s_and_b64 exec, vcc, s[56:57]
    s_nop 3
    s_cbranch_execz P_r12
    ds_write_b32 v14, v94
P_r12:
    s_andn2_b64 exec, s[56:57], vcc
    s_cbranch_execz P_r32
    s_mov_b64 s[14:15], exec
    v_lshlrev_b32 v36, 1, v78
    v_add_u32 v36, 0xfeffffc4, v36
    ds_max_u32 v86, v36 offset:124
    v_cmp_gt_u32 vcc, 63, v78
    s_and_b64 exec, vcc, s[14:15]
    s_nop 3
    s_cbranch_execz P_r22
    v_lshlrev_b32 v124, 7, v70
    v_lshl_add_u32 v124, v78, 2, v124
    buffer_store_dword v94, v124, s[36:39], s59 offen sc1
    s_nop 0
P_r22:
    s_andn2_b64 exec, s[14:15], vcc
    s_cbranch_execz P_r32
    ds_write_b32 v38, v116
    ds_add_rtn_u32 v124, v37, v116
    v_mov_b32 v126, v94
    v_mov_b32 v127, v70
    s_waitcnt lgkmcnt(0)
    v_lshlrev_b32 v124, 3, v124
    buffer_store_dwordx2 v[126:127], v124, s[36:39], s27 offen sc1
    s_nop 0
P_r32:
    s_mov_b64 exec, s[56:57]
    v_cmp_gt_u32 vcc, 31, v79
    s_and_b64 exec, vcc, s[56:57]
    s_nop 3
    s_cbranch_execz P_r13
    ds_write_b32 v15, v95
P_r13:
    s_andn2_b64 exec, s[56:57], vcc
    s_cbranch_execz P_r33
    s_mov_b64 s[14:15], exec
    v_lshlrev_b32 v36, 1, v79
    v_add_u32 v36, 0xfeffffc4, v36
    ds_max_u32 v87, v36 offset:124
    v_cmp_gt_u32 vcc, 63, v79
    s_and_b64 exec, vcc, s[14:15]
    s_nop 3
    s_cbranch_execz P_r23
    v_lshlrev_b32 v124, 7, v71
    v_lshl_add_u32 v124, v79, 2, v124
    buffer_store_dword v95, v124, s[36:39], s59 offen sc1
    s_nop 0
P_r23:
    s_andn2_b64 exec, s[14:15], vcc
    s_cbranch_execz P_r33
    ds_write_b32 v38, v116
    ds_add_rtn_u32 v124, v37, v116
    v_mov_b32 v126, v95
    v_mov_b32 v127, v71
    s_waitcnt lgkmcnt(0)
    v_lshlrev_b32 v124, 3, v124
    buffer_store_dwordx2 v[126:127], v124, s[36:39], s27 offen sc1
    s_nop 0
P_r33:
    s_mov_b64 exec, s[56:57]
    v_cmp_gt_u32 vcc, 31, v80
    s_and_b64 exec, vcc, s[56:57]
    s_nop 3
    s_cbranch_execz P_r14
    ds_write_b32 v16, v96
P_r14:
    s_andn2_b64 exec, s[56:57], vcc
    s_cbranch_execz P_r34
    s_mov_b64 s[14:15], exec
    v_lshlrev_b32 v36, 1, v80
    v_add_u32 v36, 0xfeffffc4, v36
    ds_max_u32 v88, v36 offset:124
    v_cmp_gt_u32 vcc, 63, v80
    s_and_b64 exec, vcc, s[14:15]
    s_nop 3
    s_cbranch_execz P_r24
    v_lshlrev_b32 v124, 7, v72
    v_lshl_add_u32 v124, v80, 2, v124
    buffer_store_dword v96, v124, s[36:39], s59 offen sc1
    s_nop 0
P_r24:
    s_andn2_b64 exec, s[14:15], vcc
    s_cbranch_execz P_r34
    ds_write_b32 v38, v116
    ds_add_rtn_u32 v124, v37, v116
    v_mov_b32 v126, v96
    v_mov_b32 v127, v72
    s_waitcnt lgkmcnt(0)
    v_lshlrev_b32 v124, 3, v124
    buffer_store_dwordx2 v[126:127], v124, s[36:39], s27 offen sc1
    s_nop 0
P_r34:
    s_mov_b64 exec, s[56:57]
    v_cmp_gt_u32 vcc, 31, v81
    s_and_b64 exec, vcc, s[56:57]
    s_nop 3
    s_cbranch_execz P_r15
    ds_write_b32 v17, v97
P_r15:
    s_andn2_b64 exec, s[56:57], vcc
    s_cbranch_execz P_r35
    s_mov_b64 s[14:15], exec
    v_lshlrev_b32 v36, 1, v81
    v_add_u32 v36, 0xfeffffc4, v36
    ds_max_u32 v89, v36 offset:124
    v_cmp_gt_u32 vcc, 63, v81
    s_and_b64 exec, vcc, s[14:15]
    s_nop 3
    s_cbranch_execz P_r25
    v_lshlrev_b32 v124, 7, v73
    v_lshl_add_u32 v124, v81, 2, v124
    buffer_store_dword v97, v124, s[36:39], s59 offen sc1
    s_nop 0
P_r25:
    s_andn2_b64 exec, s[14:15], vcc
    s_cbranch_execz P_r35
    ds_write_b32 v38, v116
    ds_add_rtn_u32 v124, v37, v116
    v_mov_b32 v126, v97
    v_mov_b32 v127, v73
    s_waitcnt lgkmcnt(0)
    v_lshlrev_b32 v124, 3, v124
    buffer_store_dwordx2 v[126:127], v124, s[36:39], s27 offen sc1
    s_nop 0
P_r35:
    s_mov_b64 exec, s[56:57]
    v_cmp_gt_u32 vcc, 31, v82
    s_and_b64 exec, vcc, s[56:57]
    s_nop 3
    s_cbranch_execz P_r16
    ds_write_b32 v18, v98
P_r16:
    s_andn2_b64 exec, s[56:57], vcc
    s_cbranch_execz P_r36
    s_mov_b64 s[14:15], exec
    v_lshlrev_b32 v36, 1, v82
    v_add_u32 v36, 0xfeffffc4, v36
    ds_max_u32 v90, v36 offset:124
    v_cmp_gt_u32 vcc, 63, v82
    s_and_b64 exec, vcc, s[14:15]
    s_nop 3
    s_cbranch_execz P_r26
    v_lshlrev_b32 v124, 7, v74
    v_lshl_add_u32 v124, v82, 2, v124
    buffer_store_dword v98, v124, s[36:39], s59 offen sc1
    s_nop 0
P_r26:
    s_andn2_b64 exec, s[14:15], vcc
    s_cbranch_execz P_r36
    ds_write_b32 v38, v116
    ds_add_rtn_u32 v124, v37, v116
    v_mov_b32 v126, v98
    v_mov_b32 v127, v74
    s_waitcnt lgkmcnt(0)
    v_lshlrev_b32 v124, 3, v124
    buffer_store_dwordx2 v[126:127], v124, s[36:39], s27 offen sc1
    s_nop 0
P_r36:
    s_mov_b64 exec, s[56:57]
    v_cmp_gt_u32 vcc, 31, v83
    s_and_b64 exec, vcc, s[56:57]
    s_nop 3
    s_cbranch_execz P_r17
    ds_write_b32 v19, v99
P_r17:
    s_andn2_b64 exec, s[56:57], vcc
    s_cbranch_execz P_r37
    s_mov_b64 s[14:15], exec
    v_lshlrev_b32 v36, 1, v83
    v_add_u32 v36, 0xfeffffc4, v36
    ds_max_u32 v91, v36 offset:124
    v_cmp_gt_u32 vcc, 63, v83
    s_and_b64 exec, vcc, s[14:15]
    s_nop 3
    s_cbranch_execz P_r27
    v_lshlrev_b32 v124, 7, v75
    v_lshl_add_u32 v124, v83, 2, v124
    buffer_store_dword v99, v124, s[36:39], s59 offen sc1
    s_nop 0
P_r27:
    s_andn2_b64 exec, s[14:15], vcc
    s_cbranch_execz P_r37
    ds_write_b32 v38, v116
    ds_add_rtn_u32 v124, v37, v116
    v_mov_b32 v126, v99
    v_mov_b32 v127, v75
    s_waitcnt lgkmcnt(0)
    v_lshlrev_b32 v124, 3, v124
    buffer_store_dwordx2 v[126:127], v124, s[36:39], s27 offen sc1
    s_nop 0
P_r37:
    s_mov_b64 exec, -1
    s_waitcnt vmcnt(0)
    s_branch P_join
P_w7:
    s_lshr_b32 s3, s2, 3
    s_lshl_b32 s3, s3, 2
    s_and_b32 s65, s2, 3
    s_add_u32 s3, s3, s65
    s_and_b32 s65, s2, 4
    s_cselect_b32 s3, 0xffff, s3
    s_mul_i32 s65, s3, 3072
    v_mul_u32_u24 v38, 24, v1
    s_cmp_ge_u32 s3, 98
    s_cselect_b32 s65, 0x40000000, s65
    s_mov_b32 s92, s6
    s_mov_b32 s93, s7
    s_mov_b32 s94, 0x493e0
    s_mov_b32 s95, 0x00020000
    buffer_load_dwordx3 v[4:6], v38, s[92:95], s65 offen offset:0
    buffer_load_dwordx3 v[8:10], v38, s[92:95], s65 offen offset:12
    buffer_load_dwordx3 v[12:14], v38, s[92:95], s65 offen offset:1536
    buffer_load_dwordx3 v[16:18], v38, s[92:95], s65 offen offset:1548
    s_mov_b32 s27, 0x830000
    buffer_load_dwordx4 v3, s[48:51], s64 offen lds
    s_load_dword s22, s[24:25], s27
    s_mov_b32 s28, s4
    s_mov_b32 s29, s5
    s_mov_b32 s30, 0x186a000
    s_mov_b32 s31, 0x00020000
    s_mov_b32 s92, s6
    s_mov_b32 s93, s7
    s_mov_b32 s94, 0x493e0
    s_mov_b32 s95, 0x00020000
    s_mov_b32 s36, s24
    s_mov_b32 s37, s25
    s_mov_b32 s38, 0x241a800
    s_mov_b32 s39, 0x00020000
    s_add_u32 s72, s24, 0x1e00000
    s_addc_u32 s73, s25, 0
    s_mov_b32 s74, 0x61a800
    s_mov_b32 s75, 0x00020000
    s_mov_b32 s52, s16
    s_mov_b32 s53, s17
    s_mov_b32 s54, 0x6000
    s_mov_b32 s55, 0x00020000
    s_mov_b32 s96, s18
    s_mov_b32 s97, s19
    s_mov_b32 s98, 0x1800
    s_mov_b32 s99, 0x00020000
    s_mov_b32 s68, s12
    s_mov_b32 s69, s13
    s_mov_b32 s70, 0x20
    s_mov_b32 s71, 0x00020000
    s_mov_b32 s32, s20
    s_mov_b32 s33, s21
    s_mov_b32 s34, 0x186a000
    s_mov_b32 s35, 0x00020000
    v_bfe_u32 v122, v1, 2, 2
    v_lshl_add_u32 v122, v119, 3, v122
    v_lshlrev_b32 v122, 7, v122
    v_and_b32 v39, 3, v1
    v_lshl_add_u32 v122, v39, 3, v122
    s_cmp_ge_u32 s3, 98
    s_nop 0
    s_cbranch_scc1 P_w7n
    s_mov_b32 s60, 0x41800000
    s_movk_i32 s65, 0xf8
    v_lshlrev_b32 v38, 3, v1
    s_mul_i32 s27, s3, 1024
    s_add_u32 s27, s27, 0x810000
    s_waitcnt vmcnt(3)
    v_lshlrev_b32 v68, 16, v4
    v_and_b32 v69, s58, v4
    v_lshlrev_b32 v70, 16, v5
    v_and_b32 v71, s58, v5
    v_lshlrev_b32 v72, 16, v6
    v_and_b32 v73, s58, v6
    v_lshlrev_b32 v74, 16, v8
    v_and_b32 v75, s58, v8
    v_lshlrev_b32 v76, 16, v9
    v_and_b32 v77, s58, v9
    v_lshlrev_b32 v78, 16, v10
    v_and_b32 v79, s58, v10
    v_mul_f32 v68, s60, v68
    v_mul_f32 v69, s60, v69
    v_mul_f32 v70, s60, v70
    v_mul_f32 v71, s60, v71
    v_mul_f32 v72, s60, v72
    v_mul_f32 v73, s60, v73
    v_mul_f32 v74, s60, v74
    v_mul_f32 v75, s60, v75
    v_mul_f32 v76, s60, v76
    v_mul_f32 v77, s60, v77
    v_mul_f32 v78, s60, v78
    v_mul_f32 v79, s60, v79
    v_cvt_flr_i32_f32 v68, v68
    v_cvt_flr_i32_f32 v69, v69
    v_cvt_flr_i32_f32 v70, v70
    v_cvt_flr_i32_f32 v71, v71
    v_cvt_flr_i32_f32 v72, v72
    v_cvt_flr_i32_f32 v73, v73
    v_cvt_flr_i32_f32 v74, v74
    v_cvt_flr_i32_f32 v75, v75
    v_cvt_flr_i32_f32 v76, v76
    v_cvt_flr_i32_f32 v77, v77
    v_cvt_flr_i32_f32 v78, v78
    v_cvt_flr_i32_f32 v79, v79
    v_bfe_u32 v84, v70, 5, 3
    v_bfe_u32 v85, v70, 2, 3
    v_and_or_b32 v68, v68, s65, v84
    v_and_or_b32 v69, v69, s65, v85
    v_lshl_or_b32 v68, v69, 8, v68
    v_bfe_u32 v84, v73, 5, 3
    v_bfe_u32 v85, v73, 2, 3
    v_and_or_b32 v71, v71, s65, v84
    v_and_or_b32 v72, v72, s65, v85
    v_lshl_or_b32 v71, v72, 8, v71
    v_bfe_u32 v84, v76, 5, 3
    v_bfe_u32 v85, v76, 2, 3
    v_and_or_b32 v74, v74, s65, v84
    v_and_or_b32 v75, v75, s65, v85
    v_lshl_or_b32 v74, v75, 8, v74
    v_bfe_u32 v84, v79, 5, 3
    v_bfe_u32 v85, v79, 2, 3
    v_and_or_b32 v77, v77, s65, v84
    v_and_or_b32 v78, v78, s65, v85
    v_lshl_or_b32 v77, v78, 8, v77
    v_lshl_or_b32 v86, v71, 16, v68
    v_lshl_or_b32 v87, v77, 16, v74
    buffer_store_dwordx2 v[86:87], v38, s[36:39], s27 offen offset:0 sc1
    s_waitcnt vmcnt(2)
    v_lshlrev_b32 v68, 16, v12
    v_and_b32 v69, s58, v12
    v_lshlrev_b32 v70, 16, v13
    v_and_b32 v71, s58, v13
    v_lshlrev_b32 v72, 16, v14
    v_and_b32 v73, s58, v14
    v_lshlrev_b32 v74, 16, v16
    v_and_b32 v75, s58, v16
    v_lshlrev_b32 v76, 16, v17
    v_and_b32 v77, s58, v17
    v_lshlrev_b32 v78, 16, v18
    v_and_b32 v79, s58, v18
    v_mul_f32 v68, s60, v68
    v_mul_f32 v69, s60, v69
    v_mul_f32 v70, s60, v70
    v_mul_f32 v71, s60, v71
    v_mul_f32 v72, s60, v72
    v_mul_f32 v73, s60, v73
    v_mul_f32 v74, s60, v74
    v_mul_f32 v75, s60, v75
    v_mul_f32 v76, s60, v76
    v_mul_f32 v77, s60, v77
    v_mul_f32 v78, s60, v78
    v_mul_f32 v79, s60, v79
    v_cvt_flr_i32_f32 v68, v68
    v_cvt_flr_i32_f32 v69, v69
    v_cvt_flr_i32_f32 v70, v70
    v_cvt_flr_i32_f32 v71, v71
    v_cvt_flr_i32_f32 v72, v72
    v_cvt_flr_i32_f32 v73, v73
    v_cvt_flr_i32_f32 v74, v74
    v_cvt_flr_i32_f32 v75, v75
    v_cvt_flr_i32_f32 v76, v76
    v_cvt_flr_i32_f32 v77, v77
    v_cvt_flr_i32_f32 v78, v78
    v_cvt_flr_i32_f32 v79, v79
    v_bfe_u32 v84, v70, 5, 3
    v_bfe_u32 v85, v70, 2, 3
    v_and_or_b32 v68, v68, s65, v84
    v_and_or_b32 v69, v69, s65, v85
    v_lshl_or_b32 v68, v69, 8, v68
    v_bfe_u32 v84, v73, 5, 3
    v_bfe_u32 v85, v73, 2, 3
    v_and_or_b32 v71, v71, s65, v84
    v_and_or_b32 v72, v72, s65, v85
    v_lshl_or_b32 v71, v72, 8, v71
    v_bfe_u32 v84, v76, 5, 3
    v_bfe_u32 v85, v76, 2, 3
    v_and_or_b32 v74, v74, s65, v84
    v_and_or_b32 v75, v75, s65, v85
    v_lshl_or_b32 v74, v75, 8, v74
    v_bfe_u32 v84, v79, 5, 3
    v_bfe_u32 v85, v79, 2, 3
    v_and_or_b32 v77, v77, s65, v84
    v_and_or_b32 v78, v78, s65, v85
    v_lshl_or_b32 v77, v78, 8, v77
    v_lshl_or_b32 v88, v71, 16, v68
    v_lshl_or_b32 v89, v77, 16, v74
    buffer_store_dwordx2 v[88:89], v38, s[36:39], s27 offen offset:512 sc1
    s_nop 0
P_w7n:
    buffer_load_dwordx4 v[20:23], v121, s[28:31], s76 offen offset:0
    buffer_load_dwordx4 v[24:27], v121, s[28:31], s76 offen offset:64
    s_waitcnt lgkmcnt(0)
    v_lshrrev_b32 v124, 5, v1
    v_and_b32 v125, 31, v1
    v_mul_u32_u24 v124, 3072, v124
    v_lshl_add_u32 v124, v125, 2, v124
    s_lshr_b32 s60, s26, 2
    s_and_b32 s61, s26, 3
    s_mul_i32 s63, s61, 768
    s_lshl_b32 s65, s60, 7
    s_add_u32 s63, s63, s65
    s_add_u32 s65, s63, 0
    buffer_load_dword v128, v124, s[52:55], s65 offen
    s_add_u32 s65, s63, 6144
    buffer_load_dword v129, v124, s[52:55], s65 offen
    s_add_u32 s65, s63, 12288
    buffer_load_dword v130, v124, s[52:55], s65 offen
    s_add_u32 s65, s63, 18432
    buffer_load_dword v131, v124, s[52:55], s65 offen
    s_add_u32 s65, s63, 384
    buffer_load_dword v132, v124, s[52:55], s65 offen
    s_add_u32 s65, s63, 6528
    buffer_load_dword v133, v124, s[52:55], s65 offen
    s_add_u32 s65, s63, 12672
    buffer_load_dword v134, v124, s[52:55], s65 offen
    s_add_u32 s65, s63, 18816
    buffer_load_dword v135, v124, s[52:55], s65 offen
    s_cmp_ge_u32 s26, 4
    s_cbranch_scc1 P_e2c
    s_add_u32 s27, s26, 8
    s_lshr_b32 s60, s27, 2
    s_and_b32 s61, s27, 3
    s_mul_i32 s63, s61, 768
    s_lshl_b32 s65, s60, 7
    s_add_u32 s63, s63, s65
    s_add_u32 s65, s63, 0
    buffer_load_dword v136, v124, s[52:55], s65 offen
    s_add_u32 s65, s63, 6144
    buffer_load_dword v137, v124, s[52:55], s65 offen
    s_add_u32 s65, s63, 12288
    buffer_load_dword v138, v124, s[52:55], s65 offen
    s_add_u32 s65, s63, 18432
    buffer_load_dword v139, v124, s[52:55], s65 offen
    s_add_u32 s65, s63, 384
    buffer_load_dword v140, v124, s[52:55], s65 offen
    s_add_u32 s65, s63, 6528
    buffer_load_dword v141, v124, s[52:55], s65 offen
    s_add_u32 s65, s63, 12672
    buffer_load_dword v142, v124, s[52:55], s65 offen
    s_add_u32 s65, s63, 18816
    buffer_load_dword v143, v124, s[52:55], s65 offen
    s_branch P_e3c
P_e2c:
    s_sub_u32 s60, s26, 4
    s_lshl_b32 s63, s60, 7
    s_cmp_eq_u32 s26, 7
    s_cselect_b32 s63, 0x40000000, s63
    buffer_load_dword v136, v124, s[96:99], s63 offen offset:0
    buffer_load_dword v137, v124, s[96:99], s63 offen offset:384
    buffer_load_dword v138, v124, s[96:99], s63 offen offset:768
    buffer_load_dword v139, v124, s[96:99], s63 offen offset:1152
    buffer_load_dword v140, v124, s[96:99], s63 offen offset:1536
    buffer_load_dword v141, v124, s[96:99], s63 offen offset:1920
    buffer_load_dword v142, v124, s[96:99], s63 offen offset:2304
    buffer_load_dword v143, v124, s[96:99], s63 offen offset:2688
P_e3c:
    v_mul_u32_u24 v124, 6, v0
    v_and_b32 v124, -4, v124
    v_cmp_gt_u32 vcc, 200, v0
    s_nop 1
    v_cndmask_b32 v124, v118, v124, vcc
    s_mul_i32 s27, s2, 1200
    buffer_load_dwordx2 v[144:145], v124, s[92:95], s27 offen
    v_lshlrev_b32 v124, 1, v1
    buffer_load_ushort v146, v124, s[68:71], 0 offen
    s_waitcnt vmcnt(20) lgkmcnt(0)
    s_add_u32 s22, s22, 1
    v_mov_b32 v38, s22
    v_mov_b32 v39, 131072
    ds_write_b32 v39, v38
    s_cmp_ge_u32 s3, 98
    s_cbranch_scc1 P_join
    s_lshl_b32 s27, s3, 3
    s_add_u32 s27, s27, 0x830100
    v_mov_b32 v8, s22
    v_mov_b32 v9, s22
    v_mov_b32 v12, 0
    s_mov_b64 exec, 1
    buffer_store_dwordx2 v[8:9], v12, s[36:39], s27 offen sc1
    s_mov_b64 exec, -1
P_join:
    s_lshl_b32 s23, s2, 15
    v_mov_b32 v4, 131072
    s_waitcnt lgkmcnt(0)
    s_barrier
    ds_read_b64 v[4:5], v4
    ds_read_b128 v[100:103], v117 offset:0
    ds_read_b128 v[104:107], v117 offset:8192
    ds_read_b128 v[108:111], v117 offset:16384
    ds_read_b128 v[112:115], v117 offset:24576
    s_waitcnt lgkmcnt(4)
    v_readfirstlane_b32 s18, v4
    v_readfirstlane_b32 s19, v5
    s_bfe_u32 s8, s18, 0x70001
    s_lshl_b32 s8, s8, 17
    s_bfe_u32 s27, s18, 0x10000
    s_or_b32 s8, s8, s27
    s_bfe_u32 s9, s18, 0x70009
    s_lshl_b32 s9, s9, 17
    s_bfe_u32 s27, s18, 0x10008
    s_or_b32 s9, s9, s27
    s_bfe_u32 s10, s18, 0x70011
    s_lshl_b32 s10, s10, 17
    s_bfe_u32 s27, s18, 0x10010
    s_or_b32 s10, s10, s27
    s_bfe_u32 s11, s18, 0x70019
    s_lshl_b32 s11, s11, 17
    s_bfe_u32 s27, s18, 0x10018
    s_or_b32 s11, s11, s27
    s_cmp_eq_u32 s19, 0
    s_cbranch_scc1 P_noovf
    v_mov_b32 v4, 131080
    ds_read_b32 v4, v4
    v_mov_b32 v5, 0
    s_add_u32 s27, s23, 32124
    s_waitcnt lgkmcnt(0)
    buffer_store_dword v4, v5, s[36:39], s27 offen sc1
    s_waitcnt vmcnt(0)
    s_barrier
P_noovf:
    s_waitcnt lgkmcnt(3)
    v_xor_b32 v100, s8, v100
    v_xor_b32 v101, s9, v101
    v_xor_b32 v102, s10, v102
    v_xor_b32 v103, s11, v103
    buffer_store_dwordx4 v[100:103], v2, s[36:39], s23 offen sc1
    s_waitcnt lgkmcnt(2)
    v_xor_b32 v104, s8, v104
    v_xor_b32 v105, s9, v105
    v_xor_b32 v106, s10, v106
    v_xor_b32 v107, s11, v107
    s_add_u32 s59, s23, 8192
    buffer_store_dwordx4 v[104:107], v2, s[36:39], s59 offen sc1
    s_waitcnt lgkmcnt(1)
    v_xor_b32 v108, s8, v108
    v_xor_b32 v109, s9, v109
    v_xor_b32 v110, s10, v110
    v_xor_b32 v111, s11, v111
    s_add_u32 s59, s23, 16384
    buffer_store_dwordx4 v[108:111], v2, s[36:39], s59 offen sc1
    s_waitcnt lgkmcnt(0)
    v_xor_b32 v112, s8, v112
    v_xor_b32 v113, s9, v113
    v_xor_b32 v114, s10, v114
    v_xor_b32 v115, s11, v115
    s_mov_b64 exec, s[66:67]
    s_add_u32 s59, s23, 24576
    buffer_store_dwordx4 v[112:115], v2, s[36:39], s59 offen sc1
    s_mov_b64 exec, -1
    ds_read_b64_tr_b16 v[36:37], v122 offset:0
    ds_read_b64_tr_b16 v[38:39], v122 offset:512
    ds_read_b64_tr_b16 v[40:41], v122 offset:4096
    ds_read_b64_tr_b16 v[42:43], v122 offset:4608
    ds_read_b64_tr_b16 v[44:45], v122 offset:32
    ds_read_b64_tr_b16 v[46:47], v122 offset:544
    ds_read_b64_tr_b16 v[48:49], v122 offset:4128
    ds_read_b64_tr_b16 v[50:51], v122 offset:4640
    ds_read_b64_tr_b16 v[52:53], v122 offset:64
    ds_read_b64_tr_b16 v[54:55], v122 offset:576
    ds_read_b64_tr_b16 v[56:57], v122 offset:4160
    ds_read_b64_tr_b16 v[58:59], v122 offset:4672
    ds_read_b64_tr_b16 v[60:61], v122 offset:96
    ds_read_b64_tr_b16 v[62:63], v122 offset:608
    ds_read_b64_tr_b16 v[64:65], v122 offset:4192
    ds_read_b64_tr_b16 v[66:67], v122 offset:4704
    v_and_b32 v250, -2, v1
    v_add_lshl_u32 v250, v250, v1, 7
    v_cmp_gt_u32 vcc, 10, v1
    s_nop 1
    v_cndmask_b32 v250, v118, v250, vcc
    s_mul_i32 s65, s2, 102400
    s_mul_i32 s63, s26, 12800
    s_add_u32 s65, s65, s63
    buffer_load_dword v158, v250, s[28:31], s65 offen offset:256
    v_mov_b32 v5, 0xbfb8aa3b
    v_mov_b32 v6, 1.0
    v_lshlrev_b32 v123, 9, v119
    v_lshl_add_u32 v123, v120, 3, v123
    s_lshl_b32 s27, s62, 7
    s_waitcnt lgkmcnt(0)
    s_barrier
    s_mul_i32 s20, s2, 102400
    s_mul_i32 s21, s26, 12800
    s_add_u32 s20, s20, s21
    s_add_u32 s20, s4, s20
    s_addc_u32 s21, s5, 0
    s_waitcnt vmcnt(23)
    s_cmp_gt_u32 s26, 4
    s_cbranch_scc0 P_np
    s_setprio 2
P_np:
    v_mfma_f32_16x16x32_bf16 v[68:71], v[20:23], v[36:39], 0
    v_mfma_f32_16x16x32_bf16 v[72:75], v[20:23], v[44:47], 0
    v_mfma_f32_16x16x32_bf16 v[76:79], v[20:23], v[52:55], 0
    v_mfma_f32_16x16x32_bf16 v[80:83], v[20:23], v[60:63], 0
    v_mfma_f32_16x16x32_bf16 v[68:71], v[24:27], v[40:43], v[68:71]
    v_mfma_f32_16x16x32_bf16 v[72:75], v[24:27], v[48:51], v[72:75]
    v_mfma_f32_16x16x32_bf16 v[76:79], v[24:27], v[56:59], v[76:79]
    v_mfma_f32_16x16x32_bf16 v[80:83], v[24:27], v[64:67], v[80:83]
    s_nop 4
    v_cvt_pk_bf16_f32 v68, 0, v68
    v_cvt_pk_bf16_f32 v69, 0, v69
    v_cvt_pk_bf16_f32 v70, 0, v70
    v_cvt_pk_bf16_f32 v71, 0, v71
    v_cvt_pk_bf16_f32 v72, 0, v72
    v_cvt_pk_bf16_f32 v73, 0, v73
    v_cvt_pk_bf16_f32 v74, 0, v74
    v_cvt_pk_bf16_f32 v75, 0, v75
    v_cvt_pk_bf16_f32 v76, 0, v76
    v_cvt_pk_bf16_f32 v77, 0, v77
    v_cvt_pk_bf16_f32 v78, 0, v78
    v_cvt_pk_bf16_f32 v79, 0, v79
    v_cvt_pk_bf16_f32 v80, 0, v80
    v_cvt_pk_bf16_f32 v81, 0, v81
    v_cvt_pk_bf16_f32 v82, 0, v82
    v_cvt_pk_bf16_f32 v83, 0, v83
    v_mul_f32 v84, v5, v68
    v_mul_f32 v85, v5, v69
    v_mul_f32 v86, v5, v70
    v_mul_f32 v87, v5, v71
    v_mul_f32 v88, v5, v72
    v_mul_f32 v89, v5, v73
    v_mul_f32 v90, v5, v74
    v_mul_f32 v91, v5, v75
    v_mul_f32 v92, v5, v76
    v_mul_f32 v93, v5, v77
    v_mul_f32 v94, v5, v78
    v_mul_f32 v95, v5, v79
    v_mul_f32 v96, v5, v80
    v_mul_f32 v97, v5, v81
    v_mul_f32 v98, v5, v82
    v_mul_f32 v99, v5, v83
    v_exp_f32 v84, v84
    v_exp_f32 v85, v85
    v_exp_f32 v86, v86
    v_exp_f32 v87, v87
    v_exp_f32 v88, v88
    v_exp_f32 v89, v89
    v_exp_f32 v90, v90
    v_exp_f32 v91, v91
    v_exp_f32 v92, v92
    v_exp_f32 v93, v93
    v_exp_f32 v94, v94
    v_exp_f32 v95, v95
    v_exp_f32 v96, v96
    v_exp_f32 v97, v97
    v_exp_f32 v98, v98
    v_exp_f32 v99, v99
    v_add_f32 v84, v6, v84
    v_add_f32 v85, v6, v85
    v_add_f32 v86, v6, v86
    v_add_f32 v87, v6, v87
    v_add_f32 v88, v6, v88
    v_add_f32 v89, v6, v89
    v_add_f32 v90, v6, v90
    v_add_f32 v91, v6, v91
    v_add_f32 v92, v6, v92
    v_add_f32 v93, v6, v93
    v_add_f32 v94, v6, v94
    v_add_f32 v95, v6, v95
    v_add_f32 v96, v6, v96
    v_add_f32 v97, v6, v97
    v_add_f32 v98, v6, v98
    v_add_f32 v99, v6, v99
    v_rcp_f32 v84, v84
    v_rcp_f32 v85, v85
    v_rcp_f32 v86, v86
    v_rcp_f32 v87, v87
    v_rcp_f32 v88, v88
    v_rcp_f32 v89, v89
    v_rcp_f32 v90, v90
    v_rcp_f32 v91, v91
    v_rcp_f32 v92, v92
    v_rcp_f32 v93, v93
    v_rcp_f32 v94, v94
    v_rcp_f32 v95, v95
    v_rcp_f32 v96, v96
    v_rcp_f32 v97, v97
    v_rcp_f32 v98, v98
    v_rcp_f32 v99, v99
    v_mul_f32 v84, v68, v84
    v_mul_f32 v85, v69, v85
    v_mul_f32 v86, v70, v86
    v_mul_f32 v87, v71, v87
    v_mul_f32 v88, v72, v88
    v_mul_f32 v89, v73, v89
    v_mul_f32 v90, v74, v90
    v_mul_f32 v91, v75, v91
    v_mul_f32 v92, v76, v92
    v_mul_f32 v93, v77, v93
    v_mul_f32 v94, v78, v94
    v_mul_f32 v95, v79, v95
    v_mul_f32 v96, v80, v96
    v_mul_f32 v97, v81, v97
    v_mul_f32 v98, v82, v98
    v_mul_f32 v99, v83, v99
    s_mov_b32 s63, 0x830100
    s_cmp_gt_u32 s26, 4
    s_cselect_b32 s63, s63, 0x40000000
    buffer_load_dwordx4 v[236:239], v3, s[36:39], s63 offen sc1
    v_cvt_pk_bf16_f32 v68, v84, v88
    v_cvt_pk_bf16_f32 v69, v92, v96
    buffer_store_dwordx2 v[68:69], v123, s[72:75], s27 offen offset:0 sc1
    v_cvt_pk_bf16_f32 v70, v85, v89
    v_cvt_pk_bf16_f32 v71, v93, v97
    buffer_store_dwordx2 v[70:71], v123, s[72:75], s27 offen offset:128 sc1
    v_cvt_pk_bf16_f32 v72, v86, v90
    v_cvt_pk_bf16_f32 v73, v94, v98
    buffer_store_dwordx2 v[72:73], v123, s[72:75], s27 offen offset:256 sc1
    v_cvt_pk_bf16_f32 v74, v87, v91
    v_cvt_pk_bf16_f32 v75, v95, v99
    buffer_store_dwordx2 v[74:75], v123, s[72:75], s27 offen offset:384 sc1
    s_cmp_gt_u32 s26, 4
    s_cbranch_scc1 P_h2
    s_cmp_eq_u32 s26, 4
    s_cselect_b32 s63, 2, 4
    v_cmp_gt_u32 vcc, s63, v119
    s_nop 1
    v_cndmask_b32 v7, v118, v123, vcc
    s_add_u32 s27, s27, 16384
    v_mfma_f32_16x16x32_bf16 v[68:71], v[28:31], v[36:39], 0
    v_mfma_f32_16x16x32_bf16 v[72:75], v[28:31], v[44:47], 0
    v_mfma_f32_16x16x32_bf16 v[76:79], v[28:31], v[52:55], 0
    v_mfma_f32_16x16x32_bf16 v[80:83], v[28:31], v[60:63], 0
    v_mfma_f32_16x16x32_bf16 v[68:71], v[32:35], v[40:43], v[68:71]
    v_mfma_f32_16x16x32_bf16 v[72:75], v[32:35], v[48:51], v[72:75]
    v_mfma_f32_16x16x32_bf16 v[76:79], v[32:35], v[56:59], v[76:79]
    v_mfma_f32_16x16x32_bf16 v[80:83], v[32:35], v[64:67], v[80:83]
    s_nop 4
    v_cvt_pk_bf16_f32 v68, 0, v68
    v_cvt_pk_bf16_f32 v69, 0, v69
    v_cvt_pk_bf16_f32 v70, 0, v70
    v_cvt_pk_bf16_f32 v71, 0, v71
    v_cvt_pk_bf16_f32 v72, 0, v72
    v_cvt_pk_bf16_f32 v73, 0, v73
    v_cvt_pk_bf16_f32 v74, 0, v74
    v_cvt_pk_bf16_f32 v75, 0, v75
    v_cvt_pk_bf16_f32 v76, 0, v76
    v_cvt_pk_bf16_f32 v77, 0, v77
    v_cvt_pk_bf16_f32 v78, 0, v78
    v_cvt_pk_bf16_f32 v79, 0, v79
    v_cvt_pk_bf16_f32 v80, 0, v80
    v_cvt_pk_bf16_f32 v81, 0, v81
    v_cvt_pk_bf16_f32 v82, 0, v82
    v_cvt_pk_bf16_f32 v83, 0, v83
    v_mul_f32 v84, v5, v68
    v_mul_f32 v85, v5, v69
    v_mul_f32 v86, v5, v70
    v_mul_f32 v87, v5, v71
    v_mul_f32 v88, v5, v72
    v_mul_f32 v89, v5, v73
    v_mul_f32 v90, v5, v74
    v_mul_f32 v91, v5, v75
    v_mul_f32 v92, v5, v76
    v_mul_f32 v93, v5, v77
    v_mul_f32 v94, v5, v78
    v_mul_f32 v95, v5, v79
    v_mul_f32 v96, v5, v80
    v_mul_f32 v97, v5, v81
    v_mul_f32 v98, v5, v82
    v_mul_f32 v99, v5, v83
    v_exp_f32 v84, v84
    v_exp_f32 v85, v85
    v_exp_f32 v86, v86
    v_exp_f32 v87, v87
    v_exp_f32 v88, v88
    v_exp_f32 v89, v89
    v_exp_f32 v90, v90
    v_exp_f32 v91, v91
    v_exp_f32 v92, v92
    v_exp_f32 v93, v93
    v_exp_f32 v94, v94
    v_exp_f32 v95, v95
    v_exp_f32 v96, v96
    v_exp_f32 v97, v97
    v_exp_f32 v98, v98
    v_exp_f32 v99, v99
    v_add_f32 v84, v6, v84
    v_add_f32 v85, v6, v85
    v_add_f32 v86, v6, v86
    v_add_f32 v87, v6, v87
    v_add_f32 v88, v6, v88
    v_add_f32 v89, v6, v89
    v_add_f32 v90, v6, v90
    v_add_f32 v91, v6, v91
    v_add_f32 v92, v6, v92
    v_add_f32 v93, v6, v93
    v_add_f32 v94, v6, v94
    v_add_f32 v95, v6, v95
    v_add_f32 v96, v6, v96
    v_add_f32 v97, v6, v97
    v_add_f32 v98, v6, v98
    v_add_f32 v99, v6, v99
    v_rcp_f32 v84, v84
    v_rcp_f32 v85, v85
    v_rcp_f32 v86, v86
    v_rcp_f32 v87, v87
    v_rcp_f32 v88, v88
    v_rcp_f32 v89, v89
    v_rcp_f32 v90, v90
    v_rcp_f32 v91, v91
    v_rcp_f32 v92, v92
    v_rcp_f32 v93, v93
    v_rcp_f32 v94, v94
    v_rcp_f32 v95, v95
    v_rcp_f32 v96, v96
    v_rcp_f32 v97, v97
    v_rcp_f32 v98, v98
    v_rcp_f32 v99, v99
    v_mul_f32 v84, v68, v84
    v_mul_f32 v85, v69, v85
    v_mul_f32 v86, v70, v86
    v_mul_f32 v87, v71, v87
    v_mul_f32 v88, v72, v88
    v_mul_f32 v89, v73, v89
    v_mul_f32 v90, v74, v90
    v_mul_f32 v91, v75, v91
    v_mul_f32 v92, v76, v92
    v_mul_f32 v93, v77, v93
    v_mul_f32 v94, v78, v94
    v_mul_f32 v95, v79, v95
    v_mul_f32 v96, v80, v96
    v_mul_f32 v97, v81, v97
    v_mul_f32 v98, v82, v98
    v_mul_f32 v99, v83, v99
    v_cvt_pk_bf16_f32 v68, v84, v88
    v_cvt_pk_bf16_f32 v69, v92, v96
    buffer_store_dwordx2 v[68:69], v7, s[72:75], s27 offen offset:0 sc1
    v_cvt_pk_bf16_f32 v70, v85, v89
    v_cvt_pk_bf16_f32 v71, v93, v97
    buffer_store_dwordx2 v[70:71], v7, s[72:75], s27 offen offset:128 sc1
    v_cvt_pk_bf16_f32 v72, v86, v90
    v_cvt_pk_bf16_f32 v73, v94, v98
    buffer_store_dwordx2 v[72:73], v7, s[72:75], s27 offen offset:256 sc1
    v_cvt_pk_bf16_f32 v74, v87, v91
    v_cvt_pk_bf16_f32 v75, v95, v99
    buffer_store_dwordx2 v[74:75], v7, s[72:75], s27 offen offset:384 sc1
    s_nop 0
P_h2:
    s_mov_b32 s56, 0x05040100
    s_mov_b32 s57, 0x07060302
    s_cmp_gt_u32 s26, 4
    s_cbranch_scc1 M_e4
    s_waitcnt vmcnt(14)
    s_branch M_e5
M_e4:
    s_waitcnt vmcnt(4)
    v_lshlrev_b32 v150, 4, v1
    v_cmp_gt_u32 vcc, 49, v1
    s_mov_b64 s[60:61], vcc
    s_mov_b32 s63, 0x830100
    s_mov_b32 s65, 0
    s_nop 1
    s_branch M_pb
M_pa:
    buffer_load_dwordx4 v[236:239], v150, s[36:39], s63 offen sc1
    s_waitcnt vmcnt(0)
M_pb:
    v_xor_b32 v236, s18, v236
    v_xor_b32 v237, s18, v237
    v_xor_b32 v238, s18, v238
    v_xor_b32 v239, s18, v239
    v_or3_b32 v236, v236, v237, v238
    v_or_b32 v236, v236, v239
    v_cmp_ne_u32 vcc, 0, v236
    s_and_b64 vcc, vcc, s[60:61]
    s_cbranch_vccz M_pad
    s_sleep 2
    s_add_u32 s65, s65, 1
    s_cmp_lt_u32 s65, 16384
    s_cbranch_scc1 M_pa
M_pad:
    s_sub_u32 s27, s26, 5
    s_lshl_b32 s27, s27, 10
    s_add_u32 s63, s27, 0x810000
    s_add_u32 s27, s27, 30720
    s_mov_b32 m0, s27
    s_nop 0
    buffer_load_dwordx4 v3, s[36:39], s63 offen sc1 lds
    s_add_u32 s27, s27, 3072
    s_add_u32 s63, s63, 3072
    s_mov_b32 m0, s27
    s_nop 0
    buffer_load_dwordx4 v3, s[36:39], s63 offen sc1 lds
    s_add_u32 s27, s27, 3072
    s_add_u32 s63, s63, 3072
    s_mov_b32 m0, s27
    s_nop 0
    buffer_load_dwordx4 v3, s[36:39], s63 offen sc1 lds
    s_add_u32 s27, s27, 3072
    s_add_u32 s63, s63, 3072
    s_mov_b32 m0, s27
    s_nop 0
    buffer_load_dwordx4 v3, s[36:39], s63 offen sc1 lds
    s_add_u32 s27, s27, 3072
    s_add_u32 s63, s63, 3072
    s_mov_b32 m0, s27
    s_nop 0
    buffer_load_dwordx4 v3, s[36:39], s63 offen sc1 lds
    s_add_u32 s27, s27, 3072
    s_add_u32 s63, s63, 3072
    s_mov_b32 m0, s27
    s_nop 0
    buffer_load_dwordx4 v3, s[36:39], s63 offen sc1 lds
    s_add_u32 s27, s27, 3072
    s_add_u32 s63, s63, 3072
    s_mov_b32 m0, s27
    s_nop 0
    buffer_load_dwordx4 v3, s[36:39], s63 offen sc1 lds
    s_add_u32 s27, s27, 3072
    s_add_u32 s63, s63, 3072
    s_mov_b32 m0, s27
    s_nop 0
    buffer_load_dwordx4 v3, s[36:39], s63 offen sc1 lds
    s_add_u32 s27, s27, 3072
    s_add_u32 s63, s63, 3072
    s_mov_b32 m0, s27
    s_nop 0
    buffer_load_dwordx4 v3, s[36:39], s63 offen sc1 lds
    s_add_u32 s27, s27, 3072
    s_add_u32 s63, s63, 3072
    s_mov_b32 m0, s27
    s_nop 0
    buffer_load_dwordx4 v3, s[36:39], s63 offen sc1 lds
    s_add_u32 s27, s27, 3072
    s_add_u32 s63, s63, 3072
    s_mov_b32 m0, s27
    s_nop 0
    buffer_load_dwordx4 v3, s[36:39], s63 offen sc1 lds
    s_add_u32 s27, s27, 3072
    s_add_u32 s63, s63, 3072
    s_mov_b32 m0, s27
    s_nop 0
    buffer_load_dwordx4 v3, s[36:39], s63 offen sc1 lds
    s_add_u32 s27, s27, 3072
    s_add_u32 s63, s63, 3072
    s_mov_b32 m0, s27
    s_nop 0
    buffer_load_dwordx4 v3, s[36:39], s63 offen sc1 lds
    s_add_u32 s27, s27, 3072
    s_add_u32 s63, s63, 3072
    s_mov_b32 m0, s27
    s_nop 0
    buffer_load_dwordx4 v3, s[36:39], s63 offen sc1 lds
    s_add_u32 s27, s27, 3072
    s_add_u32 s63, s63, 3072
    s_mov_b32 m0, s27
    s_nop 0
    buffer_load_dwordx4 v3, s[36:39], s63 offen sc1 lds
    s_add_u32 s27, s27, 3072
    s_add_u32 s63, s63, 3072
    s_mov_b32 m0, s27
    s_nop 0
    buffer_load_dwordx4 v3, s[36:39], s63 offen sc1 lds
    s_add_u32 s27, s27, 3072
    s_add_u32 s63, s63, 3072
    s_mov_b32 m0, s27
    s_nop 0
    buffer_load_dwordx4 v3, s[36:39], s63 offen sc1 lds
    s_add_u32 s27, s27, 3072
    s_add_u32 s63, s63, 3072
    s_mov_b32 m0, s27
    s_nop 0
    buffer_load_dwordx4 v3, s[36:39], s63 offen sc1 lds
    s_add_u32 s27, s27, 3072
    s_add_u32 s63, s63, 3072
    s_mov_b32 m0, s27
    s_nop 0
    buffer_load_dwordx4 v3, s[36:39], s63 offen sc1 lds
    s_add_u32 s27, s27, 3072
    s_add_u32 s63, s63, 3072
    s_mov_b32 m0, s27
    s_nop 0
    buffer_load_dwordx4 v3, s[36:39], s63 offen sc1 lds
    s_add_u32 s27, s27, 3072
    s_add_u32 s63, s63, 3072
    s_mov_b32 m0, s27
    s_nop 0
    buffer_load_dwordx4 v3, s[36:39], s63 offen sc1 lds
    s_add_u32 s27, s27, 3072
    s_add_u32 s63, s63, 3072
    s_mov_b32 m0, s27
    s_nop 0
    buffer_load_dwordx4 v3, s[36:39], s63 offen sc1 lds
    s_add_u32 s27, s27, 3072
    s_add_u32 s63, s63, 3072
    s_mov_b32 m0, s27
    s_nop 0
    buffer_load_dwordx4 v3, s[36:39], s63 offen sc1 lds
    s_add_u32 s27, s27, 3072
    s_add_u32 s63, s63, 3072
    s_mov_b32 m0, s27
    s_nop 0
    buffer_load_dwordx4 v3, s[36:39], s63 offen sc1 lds
    s_add_u32 s27, s27, 3072
    s_add_u32 s63, s63, 3072
    s_mov_b32 m0, s27
    s_nop 0
    buffer_load_dwordx4 v3, s[36:39], s63 offen sc1 lds
    s_add_u32 s27, s27, 3072
    s_add_u32 s63, s63, 3072
    s_mov_b32 m0, s27
    s_nop 0
    buffer_load_dwordx4 v3, s[36:39], s63 offen sc1 lds
    s_add_u32 s27, s27, 3072
    s_add_u32 s63, s63, 3072
    s_mov_b32 m0, s27
    s_nop 0
    buffer_load_dwordx4 v3, s[36:39], s63 offen sc1 lds
    s_add_u32 s27, s27, 3072
    s_add_u32 s63, s63, 3072
    s_mov_b32 m0, s27
    s_nop 0
    buffer_load_dwordx4 v3, s[36:39], s63 offen sc1 lds
    s_add_u32 s27, s27, 3072
    s_add_u32 s63, s63, 3072
    s_mov_b32 m0, s27
    s_nop 0
    buffer_load_dwordx4 v3, s[36:39], s63 offen sc1 lds
    s_add_u32 s27, s27, 3072
    s_add_u32 s63, s63, 3072
    s_mov_b32 m0, s27
    s_nop 0
    buffer_load_dwordx4 v3, s[36:39], s63 offen sc1 lds
    s_add_u32 s27, s27, 3072
    s_add_u32 s63, s63, 3072
    s_mov_b32 m0, s27
    s_nop 0
    buffer_load_dwordx4 v3, s[36:39], s63 offen sc1 lds
    s_add_u32 s27, s27, 3072
    s_add_u32 s63, s63, 3072
    s_mov_b32 m0, s27
    s_nop 0
    buffer_load_dwordx4 v3, s[36:39], s63 offen sc1 lds
    s_add_u32 s27, s27, 3072
    s_add_u32 s63, s63, 3072
    s_cmp_eq_u32 s26, 7
    s_cbranch_scc1 M_tfd
    s_mov_b32 m0, s27
    s_nop 0
    buffer_load_dwordx4 v3, s[36:39], s63 offen sc1 lds
M_tfd:
    s_setprio 0
M_e5:
    s_lshr_b32 s60, s26, 2
    s_and_b32 s61, s26, 3
    s_lshl_b32 s60, s60, 3
    s_add_u32 s60, s60, s61
    s_lshl_b32 s60, s60, 10
    s_movk_i32 s61, 4096
    v_perm_b32 v148, v129, v128, s56
    v_perm_b32 v152, v129, v128, s57
    v_perm_b32 v149, v131, v130, s56
    v_perm_b32 v153, v131, v130, s57
    v_perm_b32 v150, v133, v132, s56
    v_perm_b32 v154, v133, v132, s57
    v_perm_b32 v151, v135, v134, s56
    v_perm_b32 v155, v135, v134, s57
    v_add_u32 v156, s60, v3
    v_add_u32 v157, s61, v156
    ds_write_b128 v156, v[148:151]
    ds_write_b128 v157, v[152:155]
    s_cmp_eq_u32 s26, 7
    s_cbranch_scc1 M_w2
    s_add_u32 s27, s26, 8
    s_lshr_b32 s60, s27, 2
    s_and_b32 s61, s27, 3
    s_lshl_b32 s60, s60, 3
    s_add_u32 s60, s60, s61
    s_lshl_b32 s60, s60, 10
    s_movk_i32 s61, 4096
    s_cmp_lt_u32 s26, 4
    s_cbranch_scc1 M_w1
    s_sub_u32 s60, s26, 4
    s_lshl_b32 s60, s60, 11
    s_add_u32 s60, s60, 24576
    s_movk_i32 s61, 1024
M_w1:
    v_perm_b32 v148, v137, v136, s56
    v_perm_b32 v152, v137, v136, s57
    v_perm_b32 v149, v139, v138, s56
    v_perm_b32 v153, v139, v138, s57
    v_perm_b32 v150, v141, v140, s56
    v_perm_b32 v154, v141, v140, s57
    v_perm_b32 v151, v143, v142, s56
    v_perm_b32 v155, v143, v142, s57
    v_add_u32 v156, s60, v3
    v_add_u32 v157, s61, v156
    ds_write_b128 v156, v[148:151]
    ds_write_b128 v157, v[152:155]
M_w2:
    s_cmp_ge_u32 s26, 4
    s_cbranch_scc1 M_t4
    v_bfe_i32 v148, v0, 0, 1
    v_mov_b32 v149, 0x01000c0c
    s_mov_b32 s63, 0x02020000
    v_and_or_b32 v148, v148, s63, v149
    v_add_u32 v149, s63, v148
    v_add_u32 v150, s63, v149
    v_perm_b32 v152, v145, v144, v148
    v_perm_b32 v153, v145, v144, v149
    v_perm_b32 v154, v145, v144, v150
    s_mov_b32 s60, 0x41800000
    v_mul_f32 v148, s60, v152
    v_mul_f32 v149, s60, v153
    v_mul_f32 v150, s60, v154
    v_cvt_flr_i32_f32 v148, v148
    v_cvt_flr_i32_f32 v149, v149
    v_cvt_flr_i32_f32 v150, v150
    v_sub_u32 v148, 4, v148
    v_sub_u32 v149, 4, v149
    v_sub_u32 v150, 2, v150
    v_and_b32 v148, 0xff, v148
    v_and_b32 v149, 0xff, v149
    v_and_b32 v150, 0xff, v150
    v_lshl_or_b32 v148, v149, 8, v148
    v_lshl_or_b32 v148, v150, 16, v148
    v_mov_b32 v149, 0x7f000000
    v_cmp_gt_u32 vcc, 200, v0
    s_nop 1
    v_cndmask_b32 v148, v149, v148, vcc
    v_lshlrev_b32 v150, 2, v0
    v_add_u32 v150, 133120, v150
    ds_write_b32 v150, v148
    v_lshlrev_b32 v150, 4, v0
    v_add_u32 v150, 135168, v150
    s_mov_b64 exec, vcc
    ds_write_b96 v150, v[152:154]
    s_mov_b64 exec, -1
    s_branch M_t8
M_t4:
    s_cmp_eq_u32 s26, 4
    s_cbranch_scc0 M_t5
    v_lshlrev_b32 v150, 2, v1
    v_add_u32 v151, 132864, v150
    v_mov_b32 v148, 0
    ds_write_b32 v151, v148
    v_mov_b32 v151, 132672
    ds_write_b32 v151, v148
    v_add_u32 v151, 132608, v150
    v_lshlrev_b32 v148, 16, v146
    s_mov_b64 exec, 0xffff
    ds_write_b32 v151, v148
    s_mov_b64 exec, -1
    s_branch M_t8
M_t5:
M_t8:
    v_lshrrev_b32 v24, 2, v1
    v_lshlrev_b32 v24, 15, v24
    v_and_b32 v25, 3, v1
    v_lshl_add_u32 v24, v25, 4, v24
    s_lshl_b32 s27, s26, 20
    s_lshl_b32 s53, s2, 7
    s_add_u32 s27, s27, s53
    s_add_u32 s53, s27, 524288
    s_mov_b64 s[60:61], -1
    s_cmp_eq_u32 s26, 7
    s_cselect_b32 s61, 0xff, s61
    s_xor_b32 s63, s8, 0xff000000
    v_mov_b32 v164, s63
    v_mov_b32 v172, s63
    s_xor_b32 s63, s9, 0xff000000
    v_mov_b32 v165, s63
    v_mov_b32 v173, s63
    s_xor_b32 s63, s10, 0xff000000
    v_mov_b32 v166, s63
    v_mov_b32 v174, s63
    s_xor_b32 s63, s11, 0xff000000
    v_mov_b32 v167, s63
    v_mov_b32 v175, s63
    buffer_load_dwordx4 v[160:163], v24, s[36:39], s27 offen sc1
    s_mov_b64 exec, s[60:61]
    buffer_load_dwordx4 v[164:167], v24, s[36:39], s53 offen sc1
    s_mov_b64 exec, -1
    buffer_load_dwordx4 v[168:171], v24, s[36:39], s27 offen offset:64 sc1
    s_mov_b64 exec, s[60:61]
    buffer_load_dwordx4 v[172:175], v24, s[36:39], s53 offen offset:64 sc1
    s_mov_b64 exec, -1
    v_lshlrev_b32 v1, 4, v1
    v_lshrrev_b32 v8, 4, v1
    v_lshrrev_b32 v10, 5, v8
    v_and_b32 v11, 31, v8
    s_mov_b32 s6, 0x186a000
    s_mov_b32 s7, 0x00020000
    s_mul_i32 s44, s2, 102400
    s_mul_i32 s51, s26, 12800
    s_add_u32 s51, s51, 30720
    s_mul_i32 s52, s26, 3840
    s_add_u32 s52, s52, 133120
    s_mov_b32 s67, 120320
    s_mov_b32 s3, 132864
    v_lshrrev_b32 v8, 4, v1
    v_lshrrev_b32 v10, 5, v8
    v_and_b32 v11, 31, v8
    v_lshlrev_b32 v3, 4, v11
    v_add_u32 v3, s52, v3
    v_mul_u32_u24 v0, 56, v10
    v_add_u32 v0, s52, v0
    v_lshrrev_b32 v13, 3, v11
    v_lshl_add_u32 v4, v13, 3, v0
    v_lshrrev_b32 v13, 3, v8
    v_and_b32 v14, 1, v13
    v_lshrrev_b32 v13, 1, v13
    v_lshl_add_u32 v13, v14, 2, v13
    v_lshlrev_b32 v5, 4, v13
    v_add_u32 v5, s52, v5
    v_add_u32 v16, s52, v1
    v_lshrrev_b32 v17, 2, v8
    v_mul_u32_u24 v17, 56, v17
    v_and_b32 v13, 3, v8
    v_lshl_add_u32 v17, v13, 1, v17
    v_add_u32 v17, s52, v17
    v_lshlrev_b32 v2, 7, v10
    v_lshl_add_u32 v2, v11, 2, v2
    v_add_u32 v2, s51, v2
    v_and_b32 v13, 7, v11
    v_lshlrev_b32 v13, 1, v13
    v_sub_u32 v13, 14, v13
    v_lshl_or_b32 v6, v13, 16, v13
    v_lshlrev_b32 v7, 5, v10
    v_add_u32 v7, 132608, v7
    v_lshlrev_b32 v20, 2, v8
    v_add_u32 v30, 132864, v20
    v_mov_b32 v9, 132672
    v_mov_b32 v18, 0xfc
    v_mov_b32 v19, 1
    v_mov_b32 v192, 0
    v_mov_b32 v193, 0
    v_mov_b32 v194, 0
    v_mov_b32 v195, 0
    v_mov_b32 v196, 0
    v_mov_b32 v197, 0
    v_mov_b32 v198, 0
    v_mov_b32 v199, 0
    v_mov_b32 v200, 0
    v_mov_b32 v201, 0
    v_mov_b32 v202, 0
    v_mov_b32 v203, 0
    v_mov_b32 v204, 0
    v_mov_b32 v205, 0
    v_mov_b32 v206, 0
    v_mov_b32 v207, 0
    v_mov_b32 v208, 0
    v_mov_b32 v209, 0
    v_mov_b32 v210, 0
    v_mov_b32 v211, 0
    v_mov_b32 v212, 0
    v_mov_b32 v213, 0
    v_mov_b32 v214, 0
    v_mov_b32 v215, 0
    v_mov_b32 v216, 0
    v_mov_b32 v217, 0
    v_mov_b32 v218, 0
    v_mov_b32 v219, 0
    v_mov_b32 v220, 0
    v_mov_b32 v221, 0
    v_mov_b32 v222, 0
    v_mov_b32 v223, 0
    v_mov_b32 v224, 0
    v_mov_b32 v225, 0
    v_mov_b32 v226, 0
    v_mov_b32 v227, 0
    v_mov_b32 v228, 0
    v_mov_b32 v229, 0
    v_mov_b32 v230, 0
    v_mov_b32 v231, 0
    v_mov_b32 v232, 0
    v_mov_b32 v233, 0
    v_mov_b32 v234, 0
    v_mov_b32 v235, 0
    v_mov_b32 v236, 0
    v_mov_b32 v237, 0
    v_mov_b32 v238, 0
    v_mov_b32 v239, 0
    v_mov_b32 v240, 0
    v_mov_b32 v241, 0
    v_mov_b32 v242, 0
    v_mov_b32 v243, 0
    v_mov_b32 v244, 0
    v_mov_b32 v245, 0
    v_mov_b32 v246, 0
    v_mov_b32 v247, 0
    v_mov_b32 v248, 0
    v_mov_b32 v249, 0
    v_mov_b32 v250, 0
    v_mov_b32 v251, 0
    v_mov_b32 v252, 0
    v_mov_b32 v253, 0
    v_mov_b32 v254, 0
    v_mov_b32 v255, 0
    s_mov_b32 s12, 0x1fffe
    s_movk_i32 s13, 130
    s_mov_b32 s14, 0xfc0000
    s_movk_i32 s15, 7800
    s_lshl_b32 s17, s26, 10
    s_add_u32 s17, s17, 138368
    s_mov_b32 s16, s17
    v_add_u32 v26, 134144, v20
    v_add_u32 v27, 134144, v1
    s_mov_b32 s62, 0xfe0001
    s_mov_b32 s65, 0
M_cw:
    s_waitcnt vmcnt(0)
    v_xor_b32 v176, s8, v160
    v_xor_b32 v177, s9, v161
    v_xor_b32 v178, s10, v162
    v_xor_b32 v179, s11, v163
    v_xor_b32 v180, s8, v164
    v_xor_b32 v181, s9, v165
    v_xor_b32 v182, s10, v166
    v_xor_b32 v183, s11, v167
    v_xor_b32 v184, s8, v168
    v_xor_b32 v185, s9, v169
    v_xor_b32 v186, s10, v170
    v_xor_b32 v187, s11, v171
    v_xor_b32 v188, s8, v172
    v_xor_b32 v189, s9, v173
    v_xor_b32 v190, s10, v174
    v_xor_b32 v191, s11, v175
    v_or3_b32 v148, v176, v177, v178
    v_or3_b32 v148, v148, v179, v180
    v_or3_b32 v148, v148, v181, v182
    v_or3_b32 v148, v148, v183, v184
    v_or3_b32 v148, v148, v185, v186
    v_or3_b32 v148, v148, v187, v188
    v_or3_b32 v148, v148, v189, v190
    v_or_b32 v148, v148, v191
    v_and_b32 v148, s62, v148
    v_cmp_ne_u32 vcc, 0, v148
    s_nop 4
    s_cbranch_vccz M_cok
    s_add_u32 s65, s65, 1
    s_cmp_lt_u32 s65, 16384
    s_cbranch_scc0 M_cok
    s_sleep 4
    buffer_load_dwordx4 v[160:163], v24, s[36:39], s27 offen sc1
    s_mov_b64 exec, s[60:61]
    buffer_load_dwordx4 v[164:167], v24, s[36:39], s53 offen sc1
    s_mov_b64 exec, -1
    buffer_load_dwordx4 v[168:171], v24, s[36:39], s27 offen offset:64 sc1
    s_mov_b64 exec, s[60:61]
    buffer_load_dwordx4 v[172:175], v24, s[36:39], s53 offen offset:64 sc1
    s_mov_b64 exec, -1
    s_branch M_cw
M_cok:
    s_waitcnt lgkmcnt(0)
    s_barrier
    s_cmp_eq_u32 s26, 5
    s_cbranch_scc0 M_f1
    s_lshl_b32 s27, s2, 2
    s_add_u32 s27, s27, 0x830800
    v_mov_b32 v148, s18
    v_mov_b32 v149, 0
    s_mov_b64 exec, 1
    buffer_store_dword v148, v149, s[36:39], s27 offen sc1
    s_mov_b64 exec, -1
M_f1:
    v_add_u32 v159, 10, v8
    v_and_b32 v157, -2, v159
    v_add_lshl_u32 v159, v157, v159, 7
    v_cmp_gt_u32 vcc, 40, v8
    v_bfrev_b32 v157, 2
    s_nop 0
    v_cndmask_b32 v159, v157, v159, vcc
    s_mul_i32 s27, s26, 12800
    s_add_u32 s27, s27, s44
    buffer_load_dword v63, v159, s[28:31], s27 offen offset:256
    v_and_b32 v64, s12, v176
    v_alignbit_b32 v65, s13, v176, 22
    ds_read_u16 v64, v64 offset:30720
    ds_read_b32 v65, v65
    v_and_b32 v66, s12, v177
    v_alignbit_b32 v67, s13, v177, 22
    ds_read_u16 v66, v66 offset:30720
    ds_read_b32 v67, v67
    v_and_b32 v68, s12, v178
    v_alignbit_b32 v69, s13, v178, 22
    ds_read_u16 v68, v68 offset:30720
    ds_read_b32 v69, v69
    v_and_b32 v70, s12, v179
    v_alignbit_b32 v71, s13, v179, 22
    ds_read_u16 v70, v70 offset:30720
    ds_read_b32 v71, v71
    v_and_b32 v72, s12, v180
    v_alignbit_b32 v73, s13, v180, 22
    ds_read_u16 v72, v72 offset:30720
    ds_read_b32 v73, v73
    v_and_b32 v74, s12, v181
    v_alignbit_b32 v75, s13, v181, 22
    ds_read_u16 v74, v74 offset:30720
    ds_read_b32 v75, v75
    v_and_b32 v76, s12, v182
    v_alignbit_b32 v77, s13, v182, 22
    ds_read_u16 v76, v76 offset:30720
    ds_read_b32 v77, v77
    v_and_b32 v78, s12, v183
    v_alignbit_b32 v79, s13, v183, 22
    ds_read_u16 v78, v78 offset:30720
    ds_read_b32 v79, v79
    s_mov_b32 s63, 0xc8000000
    s_lshl_b32 s59, s26, 11
    s_add_u32 s59, s59, 146560
    s_mov_b32 s60, s59
    v_cmp_gt_u32 s[54:55], s63, v184
    s_nop 1
    v_mbcnt_lo_u32_b32 v148, s54, 0
    v_mbcnt_hi_u32_b32 v148, s55, v148
    v_lshl_add_u32 v148, v148, 4, s60
    s_bcnt1_i32_b64 s27, s[54:55]
    s_lshl4_add_u32 s60, s27, s60
    v_cndmask_b32 v148, v27, v148, s[54:55]
    ds_write_b128 v148, v[184:187]
    v_cmp_gt_u32 s[54:55], s63, v188
    s_nop 1
    v_mbcnt_lo_u32_b32 v148, s54, 0
    v_mbcnt_hi_u32_b32 v148, s55, v148
    v_lshl_add_u32 v148, v148, 4, s60
    s_bcnt1_i32_b64 s27, s[54:55]
    s_lshl4_add_u32 s60, s27, s60
    v_cndmask_b32 v148, v27, v148, s[54:55]
    ds_write_b128 v148, v[188:191]
    s_mov_b32 s63, 0xff000000
    v_cmp_lt_u32 s[68:69], s63, v187
    v_cmp_lt_u32 s[70:71], s63, v191
    s_waitcnt lgkmcnt(10)
    v_and_b32 v96, 0x0707, v64
    v_and_b32 v97, 0x0707, v66
    v_and_b32 v98, 0x0707, v68
    v_and_b32 v99, 0x0707, v70
    v_and_b32 v64, 0xf8f8, v64
    v_and_b32 v66, 0xf8f8, v66
    v_and_b32 v68, 0xf8f8, v68
    v_and_b32 v70, 0xf8f8, v70
    v_mul_u32_u24 v96, 0x200400, v96
    v_mul_u32_u24 v97, 0x200400, v97
    v_mul_u32_u24 v98, 0x200400, v98
    v_mul_u32_u24 v99, 0x200400, v99
    v_and_or_b32 v64, v96, s14, v64
    v_and_or_b32 v66, v97, s14, v66
    v_and_or_b32 v68, v98, s14, v68
    v_and_or_b32 v70, v99, s14, v70
    v_add_u32 v64, v64, v65
    v_add_u32 v66, v66, v67
    v_add_u32 v68, v68, v69
    v_add_u32 v70, v70, v71
    v_dot4_i32_i8 v64, v64, v64, 0
    v_dot4_i32_i8 v66, v66, v66, 0
    v_dot4_i32_i8 v68, v68, v68, 0
    v_dot4_i32_i8 v70, v70, v70, 0
    v_cmp_gt_i32 s[40:41], s15, v64
    v_cmp_gt_i32 s[42:43], s15, v66
    v_cmp_gt_i32 s[46:47], s15, v68
    v_cmp_gt_i32 s[54:55], s15, v70
    v_mbcnt_lo_u32_b32 v96, s40, 0
    v_mbcnt_lo_u32_b32 v97, s42, 0
    v_mbcnt_lo_u32_b32 v98, s46, 0
    v_mbcnt_lo_u32_b32 v99, s54, 0
    v_mbcnt_hi_u32_b32 v96, s41, v96
    v_mbcnt_hi_u32_b32 v97, s43, v97
    v_mbcnt_hi_u32_b32 v98, s47, v98
    v_mbcnt_hi_u32_b32 v99, s55, v99
    v_lshl_add_u32 v96, v96, 2, s16
    s_bcnt1_i32_b64 s27, s[40:41]
    s_lshl2_add_u32 s16, s27, s16
    v_lshl_add_u32 v97, v97, 2, s16
    s_bcnt1_i32_b64 s27, s[42:43]
    s_lshl2_add_u32 s16, s27, s16
    v_lshl_add_u32 v98, v98, 2, s16
    s_bcnt1_i32_b64 s27, s[46:47]
    s_lshl2_add_u32 s16, s27, s16
    v_lshl_add_u32 v99, v99, 2, s16
    s_bcnt1_i32_b64 s27, s[54:55]
    s_lshl2_add_u32 s16, s27, s16
    v_cndmask_b32 v96, v26, v96, s[40:41]
    ds_write_b32 v96, v176
    v_cndmask_b32 v97, v26, v97, s[42:43]
    ds_write_b32 v97, v177
    v_cndmask_b32 v98, v26, v98, s[46:47]
    ds_write_b32 v98, v178
    v_cndmask_b32 v99, v26, v99, s[54:55]
    ds_write_b32 v99, v179
    s_waitcnt lgkmcnt(6)
    v_and_b32 v100, 0x0707, v72
    v_and_b32 v101, 0x0707, v74
    v_and_b32 v102, 0x0707, v76
    v_and_b32 v103, 0x0707, v78
    v_and_b32 v72, 0xf8f8, v72
    v_and_b32 v74, 0xf8f8, v74
    v_and_b32 v76, 0xf8f8, v76
    v_and_b32 v78, 0xf8f8, v78
    v_mul_u32_u24 v100, 0x200400, v100
    v_mul_u32_u24 v101, 0x200400, v101
    v_mul_u32_u24 v102, 0x200400, v102
    v_mul_u32_u24 v103, 0x200400, v103
    v_and_or_b32 v72, v100, s14, v72
    v_and_or_b32 v74, v101, s14, v74
    v_and_or_b32 v76, v102, s14, v76
    v_and_or_b32 v78, v103, s14, v78
    v_add_u32 v72, v72, v73
    v_add_u32 v74, v74, v75
    v_add_u32 v76, v76, v77
    v_add_u32 v78, v78, v79
    v_dot4_i32_i8 v72, v72, v72, 0
    v_dot4_i32_i8 v74, v74, v74, 0
    v_dot4_i32_i8 v76, v76, v76, 0
    v_dot4_i32_i8 v78, v78, v78, 0
    v_cmp_gt_i32 s[40:41], s15, v72
    v_cmp_gt_i32 s[42:43], s15, v74
    v_cmp_gt_i32 s[46:47], s15, v76
    v_cmp_gt_i32 s[54:55], s15, v78
    v_mbcnt_lo_u32_b32 v100, s40, 0
    v_mbcnt_lo_u32_b32 v101, s42, 0
    v_mbcnt_lo_u32_b32 v102, s46, 0
    v_mbcnt_lo_u32_b32 v103, s54, 0
    v_mbcnt_hi_u32_b32 v100, s41, v100
    v_mbcnt_hi_u32_b32 v101, s43, v101
    v_mbcnt_hi_u32_b32 v102, s47, v102
    v_mbcnt_hi_u32_b32 v103, s55, v103
    v_lshl_add_u32 v100, v100, 2, s16
    s_bcnt1_i32_b64 s27, s[40:41]
    s_lshl2_add_u32 s16, s27, s16
    v_lshl_add_u32 v101, v101, 2, s16
    s_bcnt1_i32_b64 s27, s[42:43]
    s_lshl2_add_u32 s16, s27, s16
    v_lshl_add_u32 v102, v102, 2, s16
    s_bcnt1_i32_b64 s27, s[46:47]
    s_lshl2_add_u32 s16, s27, s16
    v_lshl_add_u32 v103, v103, 2, s16
    s_bcnt1_i32_b64 s27, s[54:55]
    s_lshl2_add_u32 s16, s27, s16
    v_cndmask_b32 v100, v26, v100, s[40:41]
    ds_write_b32 v100, v180
    v_cndmask_b32 v101, v26, v101, s[42:43]
    ds_write_b32 v101, v181
    v_cndmask_b32 v102, v26, v102, s[46:47]
    ds_write_b32 v102, v182
    v_cndmask_b32 v103, v26, v103, s[54:55]
    ds_write_b32 v103, v183
    s_sub_u32 s60, s60, s59
    v_add_u32 v149, s59, v20
    v_mov_b32 v150, 0xff000000
    s_nop 1
M_pc:
    s_cmp_eq_u32 s60, 0
    s_cbranch_scc1 M_pcd
    s_waitcnt lgkmcnt(0)
    ds_read_b32 v148, v149
    v_cmp_gt_u32 vcc, s60, v20
    s_waitcnt lgkmcnt(0)
    s_nop 0
    v_cndmask_b32 v148, v150, v148, vcc
    v_and_b32 v64, s12, v148
    v_alignbit_b32 v65, s13, v148, 22
    ds_read_u16 v64, v64 offset:30720
    ds_read_b32 v65, v65
    s_waitcnt lgkmcnt(0)
    v_and_b32 v96, 0x0707, v64
    v_and_b32 v64, 0xf8f8, v64
    v_mul_u32_u24 v96, 0x200400, v96
    v_and_or_b32 v64, v96, s14, v64
    v_add_u32 v64, v64, v65
    v_dot4_i32_i8 v64, v64, v64, 0
    s_nop 2
    v_cmp_gt_i32 s[40:41], s15, v64
    s_nop 1
    v_mbcnt_lo_u32_b32 v96, s40, 0
    v_mbcnt_hi_u32_b32 v96, s41, v96
    v_lshl_add_u32 v96, v96, 2, s16
    s_bcnt1_i32_b64 s27, s[40:41]
    s_lshl2_add_u32 s16, s27, s16
    v_cndmask_b32 v96, v26, v96, s[40:41]
    ds_write_b32 v96, v148
    v_add_u32 v149, 256, v149
    s_min_u32 s27, s60, 256
    s_sub_u32 s60, s60, s27
    s_sub_u32 s27, s16, s17
    s_cmp_gt_u32 s27, 1024
    s_cbranch_scc0 M_pc
M_pcd:
    s_or_b64 s[54:55], s[68:69], s[70:71]
    s_cmp_eq_u64 s[54:55], 0
    s_cbranch_scc1 M_mdd
    s_mov_b32 s59, 0
M_md:
    s_cmp_eq_u64 s[68:69], 0
    s_cbranch_scc0 M_md1
    s_cmp_lg_u32 s59, 0
    s_cbranch_scc1 M_mdd
    s_mov_b32 s59, 1
    s_mov_b64 s[68:69], s[70:71]
    v_mov_b32 v187, v191
    s_nop 1
    s_branch M_md
M_md1:
    s_ff1_i32_b64 s27, s[68:69]
    s_bitset0_b64 s[68:69], s27
    v_readlane_b32 s60, v187, s27
    s_bfe_u32 s60, s60, 0x170001
    s_cmp_le_u32 s60, 32
    s_cbranch_scc1 M_md2
    ds_write_b32 v9, v19
    s_movk_i32 s60, 32
M_md2:
    s_lshr_b32 s27, s27, 2
    s_lshl_b32 s61, s59, 4
    s_add_u32 s27, s27, s61
    s_lshl_b32 s61, s26, 5
    s_add_u32 s27, s27, s61
    s_lshl_b32 s27, s27, 15
    s_lshl_b32 s61, s2, 7
    s_add_u32 s27, s27, s61
    s_add_u32 s27, s27, 0x900000
    v_mov_b32 v148, 0xff000000
    s_bfm_b64 exec, s60, 0
    buffer_load_dword v148, v20, s[36:39], s27 offen sc1
    s_mov_b64 exec, -1
    s_waitcnt vmcnt(0) lgkmcnt(0)
    v_and_b32 v64, s12, v148
    v_alignbit_b32 v65, s13, v148, 22
    ds_read_u16 v64, v64 offset:30720
    ds_read_b32 v65, v65
    s_waitcnt lgkmcnt(0)
    v_and_b32 v96, 0x0707, v64
    v_and_b32 v64, 0xf8f8, v64
    v_mul_u32_u24 v96, 0x200400, v96
    v_and_or_b32 v64, v96, s14, v64
    v_add_u32 v64, v64, v65
    v_dot4_i32_i8 v64, v64, v64, 0
    s_nop 2
    v_cmp_gt_i32 s[40:41], s15, v64
    s_nop 1
    v_mbcnt_lo_u32_b32 v96, s40, 0
    v_mbcnt_hi_u32_b32 v96, s41, v96
    v_lshl_add_u32 v96, v96, 2, s16
    s_bcnt1_i32_b64 s27, s[40:41]
    s_lshl2_add_u32 s16, s27, s16
    v_cndmask_b32 v96, v26, v96, s[40:41]
    ds_write_b32 v96, v148
    s_sub_u32 s27, s16, s17
    s_cmp_gt_u32 s27, 1024
    s_cbranch_scc0 M_md
M_mdd:
    s_sub_u32 s19, s16, s17
    s_lshr_b32 s19, s19, 2
    s_cmp_le_u32 s19, 256
    s_cbranch_scc1 M_c1
    ds_write_b32 v9, v19
    s_movk_i32 s19, 256
M_c1:
    s_cmp_eq_u32 s26, 6
    s_cbranch_scc0 M_h0
    s_mov_b32 s53, 0x830800
    buffer_load_dwordx4 v[140:143], v1, s[36:39], s53 offen sc1
M_h0:
    v_add_u32 v148, s17, v20
    s_waitcnt lgkmcnt(0)
    ds_read_b32 v64, v148 offset:0
    ds_read_b32 v68, v148 offset:256
    ds_read_b32 v72, v148 offset:512
    ds_read_b32 v76, v148 offset:768
    s_mov_b32 s27, s19
    v_cmp_gt_i32 s[8:9], s27, v8
    s_sub_u32 s27, s19, 64
    v_cmp_gt_i32 s[10:11], s27, v8
    s_sub_u32 s27, s19, 128
    v_cmp_gt_i32 s[14:15], s27, v8
    s_sub_u32 s27, s19, 192
    v_cmp_gt_i32 s[16:17], s27, v8
    s_mov_b32 s63, 0x02020000
    s_mov_b32 s64, 0x322bcc77
    s_mov_b32 s62, 0x409d0000
    v_mov_b32 v149, 0x01000c0c
    v_bfrev_b32 v14, 2
    s_waitcnt lgkmcnt(0)
    v_and_b32 v150, s12, v64
    v_alignbit_b32 v151, 33, v64, 20
    v_lshl_add_u32 v150, v150, 1, v150
    ds_read_b96 v[40:42], v151
    v_and_b32 v150, -4, v150
    v_cndmask_b32 v150, v14, v150, s[8:9]
    buffer_load_dwordx2 v[32:33], v150, s[92:95], 0 offen
    v_bfe_i32 v56, v64, 1, 1
    v_and_or_b32 v56, v56, s63, v149
    s_cmp_le_u32 s19, 64
    s_nop 0
    s_cbranch_scc1 M_s2a
    v_and_b32 v150, s12, v68
    v_alignbit_b32 v151, 33, v68, 20
    v_lshl_add_u32 v150, v150, 1, v150
    ds_read_b96 v[44:46], v151
    v_and_b32 v150, -4, v150
    v_cndmask_b32 v150, v14, v150, s[10:11]
    buffer_load_dwordx2 v[34:35], v150, s[92:95], 0 offen
    v_bfe_i32 v57, v68, 1, 1
    v_and_or_b32 v57, v57, s63, v149
    s_cmp_le_u32 s19, 128
    s_nop 0
    s_cbranch_scc1 M_s2a
    v_and_b32 v150, s12, v72
    v_alignbit_b32 v151, 33, v72, 20
    v_lshl_add_u32 v150, v150, 1, v150
    ds_read_b96 v[48:50], v151
    v_and_b32 v150, -4, v150
    v_cndmask_b32 v150, v14, v150, s[14:15]
    buffer_load_dwordx2 v[36:37], v150, s[92:95], 0 offen
    v_bfe_i32 v58, v72, 1, 1
    v_and_or_b32 v58, v58, s63, v149
    s_cmp_le_u32 s19, 192
    s_nop 0
    s_cbranch_scc1 M_s2a
    v_and_b32 v150, s12, v76
    v_alignbit_b32 v151, 33, v76, 20
    v_lshl_add_u32 v150, v150, 1, v150
    ds_read_b96 v[52:54], v151
    v_and_b32 v150, -4, v150
    v_cndmask_b32 v150, v14, v150, s[16:17]
    buffer_load_dwordx2 v[38:39], v150, s[92:95], 0 offen
    v_bfe_i32 v59, v76, 1, 1
    v_and_or_b32 v59, v59, s63, v149
    s_nop 1
M_s2a:
    s_waitcnt vmcnt(0) lgkmcnt(0)
    v_add_u32 v151, s63, v56
    v_perm_b32 v148, v33, v32, v56
    v_add_u32 v152, s63, v151
    v_perm_b32 v149, v33, v32, v151
    v_perm_b32 v150, v33, v32, v152
    v_sub_f32 v148, v148, v40
    v_sub_f32 v149, v149, v41
    v_sub_f32 v150, v150, v42
    v_cvt_pk_bf16_f32 v65, v148, v149
    v_cvt_pk_bf16_f32 v150, 0, v150
    v_lshlrev_b32 v148, 16, v65
    v_and_b32 v149, s58, v65
    v_mul_f32 v153, v150, v150
    v_mul_f32 v148, v148, v148
    v_mul_f32 v149, v149, v149
    v_cvt_pk_bf16_f32 v153, 0, v153
    v_cvt_pk_bf16_f32 v148, 0, v148
    v_cvt_pk_bf16_f32 v149, 0, v149
    v_add_f32 v148, v148, v149
    v_add_f32 v148, v148, v153
    v_cvt_pk_bf16_f32 v148, 0, v148
    v_add_f32 v148, s64, v148
    v_cvt_pk_bf16_f32 v148, 0, v148
    v_sqrt_f32 v148, v148
    s_nop 0
    v_cvt_pk_bf16_f32 v66, v150, v148
    v_cmp_gt_u32 vcc, s62, v66
    s_and_b64 s[8:9], s[8:9], vcc
    v_lshrrev_b32 v96, 24, v64
    v_lshrrev_b32 v120, 21, v64
    v_and_b32 v120, 16, v120
    v_lshlrev_b32 v112, v120, v19
    v_and_or_b32 v96, v96, v18, s3
    s_mov_b64 exec, s[8:9]
    s_nop 0
    s_cbranch_execz M_sa1
    ds_add_rtn_u32 v112, v96, v112
M_sa1:
    s_mov_b64 exec, -1
    s_cmp_le_u32 s19, 64
    s_cbranch_scc1 M_s2b
    v_add_u32 v151, s63, v57
    v_perm_b32 v148, v35, v34, v57
    v_add_u32 v152, s63, v151
    v_perm_b32 v149, v35, v34, v151
    v_perm_b32 v150, v35, v34, v152
    v_sub_f32 v148, v148, v44
    v_sub_f32 v149, v149, v45
    v_sub_f32 v150, v150, v46
    v_cvt_pk_bf16_f32 v69, v148, v149
    v_cvt_pk_bf16_f32 v150, 0, v150
    v_lshlrev_b32 v148, 16, v69
    v_and_b32 v149, s58, v69
    v_mul_f32 v153, v150, v150
    v_mul_f32 v148, v148, v148
    v_mul_f32 v149, v149, v149
    v_cvt_pk_bf16_f32 v153, 0, v153
    v_cvt_pk_bf16_f32 v148, 0, v148
    v_cvt_pk_bf16_f32 v149, 0, v149
    v_add_f32 v148, v148, v149
    v_add_f32 v148, v148, v153
    v_cvt_pk_bf16_f32 v148, 0, v148
    v_add_f32 v148, s64, v148
    v_cvt_pk_bf16_f32 v148, 0, v148
    v_sqrt_f32 v148, v148
    s_nop 0
    v_cvt_pk_bf16_f32 v70, v150, v148
    v_cmp_gt_u32 vcc, s62, v70
    s_and_b64 s[10:11], s[10:11], vcc
    v_lshrrev_b32 v97, 24, v68
    v_lshrrev_b32 v121, 21, v68
    v_and_b32 v121, 16, v121
    v_lshlrev_b32 v113, v121, v19
    v_and_or_b32 v97, v97, v18, s3
    s_mov_b64 exec, s[10:11]
    s_nop 0
    s_cbranch_execz M_sa2
    ds_add_rtn_u32 v113, v97, v113
M_sa2:
    s_mov_b64 exec, -1
    s_cmp_le_u32 s19, 128
    s_cbranch_scc1 M_s2b
    v_add_u32 v151, s63, v58
    v_perm_b32 v148, v37, v36, v58
    v_add_u32 v152, s63, v151
    v_perm_b32 v149, v37, v36, v151
    v_perm_b32 v150, v37, v36, v152
    v_sub_f32 v148, v148, v48
    v_sub_f32 v149, v149, v49
    v_sub_f32 v150, v150, v50
    v_cvt_pk_bf16_f32 v73, v148, v149
    v_cvt_pk_bf16_f32 v150, 0, v150
    v_lshlrev_b32 v148, 16, v73
    v_and_b32 v149, s58, v73
    v_mul_f32 v153, v150, v150
    v_mul_f32 v148, v148, v148
    v_mul_f32 v149, v149, v149
    v_cvt_pk_bf16_f32 v153, 0, v153
    v_cvt_pk_bf16_f32 v148, 0, v148
    v_cvt_pk_bf16_f32 v149, 0, v149
    v_add_f32 v148, v148, v149
    v_add_f32 v148, v148, v153
    v_cvt_pk_bf16_f32 v148, 0, v148
    v_add_f32 v148, s64, v148
    v_cvt_pk_bf16_f32 v148, 0, v148
    v_sqrt_f32 v148, v148
    s_nop 0
    v_cvt_pk_bf16_f32 v74, v150, v148
    v_cmp_gt_u32 vcc, s62, v74
    s_and_b64 s[14:15], s[14:15], vcc
    v_lshrrev_b32 v98, 24, v72
    v_lshrrev_b32 v122, 21, v72
    v_and_b32 v122, 16, v122
    v_lshlrev_b32 v114, v122, v19
    v_and_or_b32 v98, v98, v18, s3
    s_mov_b64 exec, s[14:15]
    s_nop 0
    s_cbranch_execz M_sa3
    ds_add_rtn_u32 v114, v98, v114
M_sa3:
    s_mov_b64 exec, -1
    s_cmp_le_u32 s19, 192
    s_cbranch_scc1 M_s2b
    v_add_u32 v151, s63, v59
    v_perm_b32 v148, v39, v38, v59
    v_add_u32 v152, s63, v151
    v_perm_b32 v149, v39, v38, v151
    v_perm_b32 v150, v39, v38, v152
    v_sub_f32 v148, v148, v52
    v_sub_f32 v149, v149, v53
    v_sub_f32 v150, v150, v54
    v_cvt_pk_bf16_f32 v77, v148, v149
    v_cvt_pk_bf16_f32 v150, 0, v150
    v_lshlrev_b32 v148, 16, v77
    v_and_b32 v149, s58, v77
    v_mul_f32 v153, v150, v150
    v_mul_f32 v148, v148, v148
    v_mul_f32 v149, v149, v149
    v_cvt_pk_bf16_f32 v153, 0, v153
    v_cvt_pk_bf16_f32 v148, 0, v148
    v_cvt_pk_bf16_f32 v149, 0, v149
    v_add_f32 v148, v148, v149
    v_add_f32 v148, v148, v153
    v_cvt_pk_bf16_f32 v148, 0, v148
    v_add_f32 v148, s64, v148
    v_cvt_pk_bf16_f32 v148, 0, v148
    v_sqrt_f32 v148, v148
    s_nop 0
    v_cvt_pk_bf16_f32 v78, v150, v148
    v_cmp_gt_u32 vcc, s62, v78
    s_and_b64 s[16:17], s[16:17], vcc
    v_lshrrev_b32 v99, 24, v76
    v_lshrrev_b32 v123, 21, v76
    v_and_b32 v123, 16, v123
    v_lshlrev_b32 v115, v123, v19
    v_and_or_b32 v99, v99, v18, s3
    s_mov_b64 exec, s[16:17]
    s_nop 0
    s_cbranch_execz M_sa4
    ds_add_rtn_u32 v115, v99, v115
M_sa4:
    s_mov_b64 exec, -1
M_s2b:
    s_mov_b32 s61, 0x3e22f983
    s_movk_i32 s63, 0x70
    s_movk_i32 s64, 128
    s_movk_i32 s65, 256
    s_movk_i32 s66, 384
    v_lshrrev_b32 v21, 4, v8
    v_lshlrev_b32 v21, 9, v21
    v_and_b32 v22, 15, v8
    v_lshl_or_b32 v21, v22, 4, v21
    s_lshl_b32 s45, s26, 10
    s_add_u32 s45, s45, 30720
    s_lshl_b32 s46, s26, 11
    s_add_u32 s46, s46, s44
    s_waitcnt lgkmcnt(0)
    s_barrier
    s_add_u32 m0, s45, 0
    s_add_u32 s53, s46, 0
    buffer_load_dwordx4 v21, s[28:31], s53 offen  lds
    s_add_u32 m0, s45, 8192
    s_add_u32 s53, s46, 16384
    buffer_load_dwordx4 v21, s[28:31], s53 offen  lds
    s_add_u32 m0, s45, 16384
    s_add_u32 s53, s46, 32768
    buffer_load_dwordx4 v21, s[28:31], s53 offen  lds
    s_add_u32 m0, s45, 24576
    s_add_u32 s53, s46, 49152
    buffer_load_dwordx4 v21, s[28:31], s53 offen  lds
    s_add_u32 m0, s45, 32768
    s_add_u32 s53, s46, 65536
    buffer_load_dwordx4 v21, s[28:31], s53 offen  lds
    s_add_u32 m0, s45, 40960
    s_add_u32 s53, s46, 81920
    buffer_load_dwordx4 v21, s[28:31], s53 offen  lds
    s_cmp_ge_u32 s26, 2
    s_cbranch_scc1 M_rs11
    s_add_u32 m0, s45, 49152
    s_add_u32 s53, s46, 98304
    buffer_load_dwordx4 v21, s[28:31], s53 offen  lds
M_rs11:
    ds_read_b32 v28, v30
    ds_read_b32 v13, v9
    s_waitcnt lgkmcnt(1)
    v_and_b32 v31, 0xffff, v28
    v_lshrrev_b32 v28, 16, v28
    v_add_u32 v28, v28, v31
    v_mov_b32 v29, v28
    s_nop 1
    v_add_u32_dpp v29, v29, v29 row_shr:1 row_mask:0xf bank_mask:0xf bound_ctrl:0
    s_nop 1
    v_add_u32_dpp v29, v29, v29 row_shr:2 row_mask:0xf bank_mask:0xf bound_ctrl:0
    s_nop 1
    v_add_u32_dpp v29, v29, v29 row_shr:4 row_mask:0xf bank_mask:0xf bound_ctrl:0
    s_nop 1
    v_add_u32_dpp v29, v29, v29 row_shr:8 row_mask:0xf bank_mask:0xf bound_ctrl:0
    s_nop 1
    v_add_u32_dpp v29, v29, v29 row_bcast:15 row_mask:0xa bank_mask:0xf
    s_nop 1
    v_add_u32_dpp v29, v29, v29 row_bcast:31 row_mask:0xc bank_mask:0xf
    v_sub_u32 v28, v29, v28
    v_add_u32 v31, v28, v31
    v_lshl_or_b32 v28, v31, 16, v28
    ds_bpermute_b32 v104, v96, v28
    ds_bpermute_b32 v105, v97, v28
    ds_bpermute_b32 v106, v98, v28
    ds_bpermute_b32 v107, v99, v28
    v_readlane_b32 s62, v29, 63
    s_mov_b32 s54, 0
    s_mov_b32 s55, 0
    s_xor_b32 s12, s26, 4
    s_cmp_gt_u32 s62, 480
    s_cselect_b32 s27, 96, 64
    v_cmp_ge_u32 vcc, s27, v29
    v_cmp_ge_u32 s[70:71], s27, v31
    s_bcnt1_i32_b64 s56, vcc
    s_bcnt1_i32_b64 s57, s[70:71]
    s_add_u32 s56, s56, s57
    s_min_u32 s56, s56, 16
    s_lshr_b32 s27, s56, 1
    s_and_b32 s69, s56, 1
    v_readlane_b32 s57, v28, s27
    s_lshl4_add_u32 s69, s69, 0x100000
    s_bfe_u32 s57, s57, s69
    s_waitcnt lgkmcnt(0)
    v_readfirstlane_b32 s46, v13
    v_add_u32 v104, v104, v112
    v_bfe_u32 v104, v104, v120, 16
    v_cmp_gt_u32 vcc, 768, v104
    v_lshl_add_u32 v104, v104, 4, s67
    s_and_b64 exec, vcc, s[8:9]
    s_nop 2
    s_cbranch_execz M_sb12
    ds_write_b96 v104, v[64:66]
M_sb12:
    s_mov_b64 exec, -1
    s_cmp_le_u32 s19, 64
    s_cbranch_scc1 M_s2c
    v_add_u32 v105, v105, v113
    v_bfe_u32 v105, v105, v121, 16
    v_cmp_gt_u32 vcc, 768, v105
    v_lshl_add_u32 v105, v105, 4, s67
    s_and_b64 exec, vcc, s[10:11]
    s_nop 2
    s_cbranch_execz M_sb13
    ds_write_b96 v105, v[68:70]
M_sb13:
    s_mov_b64 exec, -1
    s_cmp_le_u32 s19, 128
    s_cbranch_scc1 M_s2c
    v_add_u32 v106, v106, v114
    v_bfe_u32 v106, v106, v122, 16
    v_cmp_gt_u32 vcc, 768, v106
    v_lshl_add_u32 v106, v106, 4, s67
    s_and_b64 exec, vcc, s[14:15]
    s_nop 2
    s_cbranch_execz M_sb14
    ds_write_b96 v106, v[72:74]
M_sb14:
    s_mov_b64 exec, -1
    s_cmp_le_u32 s19, 192
    s_cbranch_scc1 M_s2c
    v_add_u32 v107, v107, v115
    v_bfe_u32 v107, v107, v123, 16
    v_cmp_gt_u32 vcc, 768, v107
    v_lshl_add_u32 v107, v107, 4, s67
    s_and_b64 exec, vcc, s[16:17]
    s_nop 2
    s_cbranch_execz M_sb15
    ds_write_b96 v107, v[76:78]
M_sb15:
    s_mov_b64 exec, -1
M_s2c:
    s_cmp_eq_u32 s26, 6
    s_cbranch_scc0 M_h3
    s_mov_b32 s27, 0
    v_cmp_gt_u32 s[8:9], 63, v8
    v_cmp_eq_u32 s[10:11], 62, v8
    s_nop 4
M_h2:
    v_cndmask_b32 v142, v142, v140, s[10:11]
    v_cndmask_b32 v143, v143, v140, s[10:11]
    v_xor_b32 v140, s18, v140
    v_xor_b32 v141, s18, v141
    v_xor_b32 v142, s18, v142
    v_xor_b32 v143, s18, v143
    v_or3_b32 v140, v140, v141, v142
    v_or_b32 v140, v140, v143
    v_cmp_ne_u32 vcc, 0, v140
    s_and_b64 vcc, vcc, s[8:9]
    s_cbranch_vccz M_h3
    s_add_u32 s27, s27, 1
    s_cmp_lt_u32 s27, 16384
    s_cbranch_scc0 M_h3
    s_sleep 2
    s_mov_b32 s53, 0x830800
    buffer_load_dwordx4 v[140:143], v1, s[36:39], s53 offen sc1
    s_waitcnt vmcnt(0)
    s_branch M_h2
M_h3:
    s_cmp_eq_u32 s2, 0
    s_cbranch_scc0 M_h4
    s_cmp_eq_u32 s26, 5
    s_cbranch_scc0 M_h4
    s_mov_b32 s27, 0x830000
    v_mov_b32 v148, s18
    v_mov_b32 v149, 0
    s_mov_b64 exec, 1
    buffer_store_dword v148, v149, s[36:39], s27 offen sc1
    s_mov_b64 exec, -1
M_h4:
    s_waitcnt lgkmcnt(0)
    s_barrier
    s_cmp_eq_u32 s12, 0
    s_cbranch_scc1 M_cut
    s_sub_u32 s27, s57, s55
    s_cmp_gt_u32 s27, 64
    s_cselect_b32 s40, 64, 96
    s_mov_b32 s54, s56
    s_mov_b32 s55, s57
    s_sub_u32 s27, s62, s55
    s_cmp_gt_u32 s27, 420
    s_cselect_b32 s27, 96, 64
    s_add_u32 s27, s27, s55
    v_cmp_ge_u32 vcc, s27, v29
    v_cmp_ge_u32 s[70:71], s27, v31
    s_bcnt1_i32_b64 s56, vcc
    s_bcnt1_i32_b64 s57, s[70:71]
    s_add_u32 s27, s54, 16
    s_add_u32 s56, s56, s57
    s_min_u32 s56, s56, s27
    s_min_u32 s56, s56, 100
    s_max_u32 s56, s56, 4
    s_lshr_b32 s27, s56, 1
    s_and_b32 s69, s56, 1
    v_readlane_b32 s57, v28, s27
    s_lshl4_add_u32 s69, s69, 0x100000
    s_bfe_u32 s57, s57, s69
    s_cmp_eq_u32 s12, 1
    s_cbranch_scc1 M_cut
    s_sub_u32 s27, s57, s55
    s_cmp_gt_u32 s27, 64
    s_cselect_b32 s41, 64, 96
    s_mov_b32 s54, s56
    s_mov_b32 s55, s57
    s_sub_u32 s27, s62, s55
    s_cmp_gt_u32 s27, 360
    s_cselect_b32 s27, 96, 64
    s_add_u32 s27, s27, s55
    v_cmp_ge_u32 vcc, s27, v29
    v_cmp_ge_u32 s[70:71], s27, v31
    s_bcnt1_i32_b64 s56, vcc
    s_bcnt1_i32_b64 s57, s[70:71]
    s_add_u32 s27, s54, 16
    s_add_u32 s56, s56, s57
    s_min_u32 s56, s56, s27
    s_min_u32 s56, s56, 100
    s_max_u32 s56, s56, 20
    s_lshr_b32 s27, s56, 1
    s_and_b32 s69, s56, 1
    v_readlane_b32 s57, v28, s27
    s_lshl4_add_u32 s69, s69, 0x100000
    s_bfe_u32 s57, s57, s69
    s_cmp_eq_u32 s12, 2
    s_cbranch_scc1 M_cut
    s_sub_u32 s27, s57, s55
    s_cmp_gt_u32 s27, 64
    s_cselect_b32 s42, 64, 96
    s_mov_b32 s54, s56
    s_mov_b32 s55, s57
    s_sub_u32 s27, s62, s55
    s_cmp_gt_u32 s27, 300
    s_cselect_b32 s27, 96, 64
    s_add_u32 s27, s27, s55
    v_cmp_ge_u32 vcc, s27, v29
    v_cmp_ge_u32 s[70:71], s27, v31
    s_bcnt1_i32_b64 s56, vcc
    s_bcnt1_i32_b64 s57, s[70:71]
    s_add_u32 s27, s54, 16
    s_add_u32 s56, s56, s57
    s_min_u32 s56, s56, s27
    s_min_u32 s56, s56, 100
    s_max_u32 s56, s56, 36
    s_lshr_b32 s27, s56, 1
    s_and_b32 s69, s56, 1
    v_readlane_b32 s57, v28, s27
    s_lshl4_add_u32 s69, s69, 0x100000
    s_bfe_u32 s57, s57, s69
    s_cmp_eq_u32 s12, 3
    s_cbranch_scc1 M_cut
    s_mov_b32 s54, s56
    s_mov_b32 s55, s57
    s_sub_u32 s27, s62, s55
    s_cmp_gt_u32 s27, 248
    s_cselect_b32 s27, s40, 64
    s_add_u32 s27, s27, s55
    v_cmp_ge_u32 vcc, s27, v29
    v_cmp_ge_u32 s[70:71], s27, v31
    s_bcnt1_i32_b64 s56, vcc
    s_bcnt1_i32_b64 s57, s[70:71]
    s_add_u32 s27, s54, 16
    s_add_u32 s56, s56, s57
    s_min_u32 s56, s56, s27
    s_min_u32 s56, s56, 100
    s_max_u32 s56, s56, 52
    s_lshr_b32 s27, s56, 1
    s_and_b32 s69, s56, 1
    v_readlane_b32 s57, v28, s27
    s_lshl4_add_u32 s69, s69, 0x100000
    s_bfe_u32 s57, s57, s69
    s_cmp_eq_u32 s12, 4
    s_cbranch_scc1 M_cut
    s_mov_b32 s54, s56
    s_mov_b32 s55, s57
    s_sub_u32 s27, s62, s55
    s_cmp_gt_u32 s27, 186
    s_cselect_b32 s27, s41, 64
    s_add_u32 s27, s27, s55
    v_cmp_ge_u32 vcc, s27, v29
    v_cmp_ge_u32 s[70:71], s27, v31
    s_bcnt1_i32_b64 s56, vcc
    s_bcnt1_i32_b64 s57, s[70:71]
    s_add_u32 s27, s54, 16
    s_add_u32 s56, s56, s57
    s_min_u32 s56, s56, s27
    s_min_u32 s56, s56, 100
    s_max_u32 s56, s56, 68
    s_lshr_b32 s27, s56, 1
    s_and_b32 s69, s56, 1
    v_readlane_b32 s57, v28, s27
    s_lshl4_add_u32 s69, s69, 0x100000
    s_bfe_u32 s57, s57, s69
    s_cmp_eq_u32 s12, 5
    s_cbranch_scc1 M_cut
    s_mov_b32 s54, s56
    s_mov_b32 s55, s57
    s_sub_u32 s27, s62, s55
    s_cmp_gt_u32 s27, 124
    s_cselect_b32 s27, s42, 64
    s_add_u32 s27, s27, s55
    v_cmp_ge_u32 vcc, s27, v29
    v_cmp_ge_u32 s[70:71], s27, v31
    s_bcnt1_i32_b64 s56, vcc
    s_bcnt1_i32_b64 s57, s[70:71]
    s_add_u32 s27, s54, 16
    s_add_u32 s56, s56, s57
    s_min_u32 s56, s56, s27
    s_min_u32 s56, s56, 100
    s_max_u32 s56, s56, 84
    s_lshr_b32 s27, s56, 1
    s_and_b32 s69, s56, 1
    v_readlane_b32 s57, v28, s27
    s_lshl4_add_u32 s69, s69, 0x100000
    s_bfe_u32 s57, s57, s69
    s_cmp_eq_u32 s12, 6
    s_cbranch_scc1 M_cut
    s_mov_b32 s54, s56
    s_mov_b32 s55, s57
    s_movk_i32 s56, 100
    s_mov_b32 s57, s62
M_cut:
    s_lshl_b32 s27, s55, 4
    s_add_u32 s27, s27, s67
    v_add_u32 v14, s27, v1
    v_lshlrev_b32 v15, 4, v11
    v_add_u32 v15, s27, v15
    ds_read_b32 v15, v15
    ds_read_b96 v[88:90], v14
    ds_read_b96 v[92:94], v14 offset:1024
    s_lshl_b32 s59, s54, 1
    s_sub_u32 s45, s56, s54
    s_lshl_b32 s45, s45, 1
    s_lshl_b32 s40, s54, 10
    s_add_u32 s40, s40, s44
    s_add_u32 s41, s40, 4096
    s_add_u32 s42, s40, 8192
    s_add_u32 s43, s40, 12288
    s_lshl_b32 s6, s56, 10
    s_add_u32 s6, s6, s44
    s_mov_b32 s34, s6
    s_sub_u32 s47, s57, s55
    v_add_u32 v86, 64, v8
    s_mov_b32 s50, 1
    s_cmp_gt_u32 s47, 128
    s_cselect_b32 s27, 1, s46
    s_cmp_gt_u32 s57, 768
    s_cselect_b32 s27, 1, s27
    s_cmp_eq_u32 s27, 0
    s_cselect_b32 s47, s47, 0
    s_cselect_b32 s76, 1, 0
    s_mov_b32 s14, 0
    s_mov_b32 s15, 0
    s_mov_b32 s16, 0
    s_mov_b32 s17, 0
    v_cmp_gt_u32 s[8:9], s47, v8
    v_cmp_gt_u32 s[10:11], s47, v86
    s_add_u32 s48, s47, 31
    s_lshr_b32 s48, s48, 5
    v_bfrev_b32 v14, 2
    v_cmp_gt_u32 vcc, s47, v11
    s_mov_b32 s27, 0x1fffe
    s_waitcnt lgkmcnt(2)
    v_and_b32 v15, s27, v15
    v_lshlrev_b32 v15, 6, v15
    v_lshl_add_u32 v15, v10, 6, v15
    v_cndmask_b32 v15, v14, v15, vcc
    buffer_load_dwordx4 v[32:35], v15, s[72:75], 0 offen offset:0
    buffer_load_dwordx4 v[36:39], v15, s[72:75], 0 offen offset:16
    buffer_load_dwordx4 v[40:43], v15, s[72:75], 0 offen offset:32
    buffer_load_dwordx4 v[44:47], v15, s[72:75], 0 offen offset:48
    s_waitcnt lgkmcnt(0)
M_win:
    v_lshrrev_b32 v8, 4, v1
    s_mov_b32 s53, 0x40490fdb
    s_mov_b32 s70, 0
    s_mov_b32 s54, 0x3e4ccccd
    s_mov_b32 s55, 0x1fffe
    v_mov_b32 v87, 1
    v_bfrev_b32 v14, 2
    v_and_b32 v96, s58, v90
    v_cndmask_b32 v96, 1.0, v96, s[8:9]
    v_rcp_f32 v98, v96
    v_mul_f32 v97, s53, v96
    v_cvt_pk_bf16_f32 v97, 0, v97
    v_mul_f32 v97, s54, v97
    v_cvt_pk_bf16_f32 v97, 0, v97
    v_mul_f32 v97, s61, v97
    v_cos_f32 v97, v97
    v_lshlrev_b32 v100, 16, v89
    v_and_b32 v101, s58, v89
    v_lshlrev_b32 v102, 16, v90
    v_cvt_pk_bf16_f32 v97, 0, v97
    v_add_f32 v97, 1.0, v97
    v_cvt_pk_bf16_f32 v97, 0, v97
    v_cndmask_b32 v97, 0, v97, s[8:9]
    v_mul_f32 v97, v97, v98
    v_add_f32 v103, v98, v98
    v_mul_f32 v97, 0x3e800000, v97
    v_mul_f32 v100, v100, v103
    v_mul_f32 v101, v101, v103
    v_mul_f32 v102, v102, v103
    v_and_b32 v99, s55, v88
    v_lshlrev_b32 v99, 8, v99
    v_cndmask_b32 v99, v14, v99, s[8:9]
    v_cvt_pk_bf16_f32 v100, v100, v101
    v_cvt_pk_bf16_f32 v102, 0, v102
    v_cndmask_b32 v104, 0, v87, s[8:9]
    v_mov_b32 v105, 0
    v_lshrrev_b32 v108, 24, v88
    v_subrev_u32 v108, s59, v108
    v_lshlrev_b32 v108, 1, v108
    v_lshlrev_b64 v[106:107], v108, v[104:105]
    ds_write_b128 v16, v[96:99] offset:0
    ds_write_b16 v17, v106 offset:2048
    ds_write_b16_d16_hi v17, v106 offset:2056
    ds_write_b16 v17, v107 offset:2064
    ds_write_b16_d16_hi v17, v107 offset:2072
    ds_write_b16 v17, v100 offset:2080
    ds_write_b16_d16_hi v17, v100 offset:2088
    ds_write_b16_d16_hi v17, v102 offset:2096
    s_cmp_eq_u64 s[10:11], 0
    s_cbranch_scc1 M_g1
    v_and_b32 v112, s58, v94
    v_cndmask_b32 v112, 1.0, v112, s[10:11]
    v_rcp_f32 v114, v112
    v_mul_f32 v113, s53, v112
    v_cvt_pk_bf16_f32 v113, 0, v113
    v_mul_f32 v113, s54, v113
    v_cvt_pk_bf16_f32 v113, 0, v113
    v_mul_f32 v113, s61, v113
    v_cos_f32 v113, v113
    v_lshlrev_b32 v116, 16, v93
    v_and_b32 v117, s58, v93
    v_lshlrev_b32 v118, 16, v94
    v_cvt_pk_bf16_f32 v113, 0, v113
    v_add_f32 v113, 1.0, v113
    v_cvt_pk_bf16_f32 v113, 0, v113
    v_cndmask_b32 v113, 0, v113, s[10:11]
    v_mul_f32 v113, v113, v114
    v_add_f32 v119, v114, v114
    v_mul_f32 v113, 0x3e800000, v113
    v_mul_f32 v116, v116, v119
    v_mul_f32 v117, v117, v119
    v_mul_f32 v118, v118, v119
    v_and_b32 v115, s55, v92
    v_lshlrev_b32 v115, 8, v115
    v_cndmask_b32 v115, v14, v115, s[10:11]
    v_cvt_pk_bf16_f32 v116, v116, v117
    v_cvt_pk_bf16_f32 v118, 0, v118
    v_cndmask_b32 v120, 0, v87, s[10:11]
    v_mov_b32 v121, 0
    v_lshrrev_b32 v124, 24, v92
    v_subrev_u32 v124, s59, v124
    v_lshlrev_b32 v124, 1, v124
    v_lshlrev_b64 v[122:123], v124, v[120:121]
    ds_write_b128 v16, v[112:115] offset:1024
    ds_write_b16 v17, v122 offset:2944
    ds_write_b16_d16_hi v17, v122 offset:2952
    ds_write_b16 v17, v123 offset:2960
    ds_write_b16_d16_hi v17, v123 offset:2968
    ds_write_b16 v17, v116 offset:2976
    ds_write_b16_d16_hi v17, v116 offset:2984
    ds_write_b16_d16_hi v17, v118 offset:2992
M_g1:
    s_waitcnt lgkmcnt(0)
    s_cmp_lg_u32 s50, 0
    s_cbranch_scc1 M_first
    s_cmp_eq_u32 s48, 0
    s_cselect_b32 s77, 0x40000000, 0
    ds_read_b32 v47, v3 offset:12
    v_bfe_u32 v46, v1, 9, 1
    s_waitcnt lgkmcnt(0)
    v_lshrrev_b32 v47, 2, v47
    v_lshl_add_u32 v47, v46, 6, v47
    buffer_load_dwordx4 v[32:35], v47, s[72:75], s77 offen offset:0
    buffer_load_dwordx4 v[36:39], v47, s[72:75], s77 offen offset:16
    buffer_load_dwordx4 v[40:43], v47, s[72:75], s77 offen offset:32
    buffer_load_dwordx4 v[44:47], v47, s[72:75], s77 offen offset:48
    s_branch M_noacc
M_first:
    s_mov_b32 s50, 2
    s_sub_u32 s27, s26, 4
    s_cmp_ge_u32 s27, 3
    s_cbranch_scc1 M_late
    s_cmp_eq_u32 s48, 0
    s_cbranch_scc1 M_late
    ds_read_b32 v64, v5 offset:12
    ds_read_b32 v65, v5 offset:140
    ds_read_b32 v66, v5 offset:268
    ds_read_b32 v67, v5 offset:396
    s_waitcnt lgkmcnt(3)
    v_and_or_b32 v64, v1, s63, v64
    s_waitcnt lgkmcnt(2)
    v_and_or_b32 v65, v1, s63, v65
    s_waitcnt lgkmcnt(1)
    v_and_or_b32 v66, v1, s63, v66
    s_waitcnt lgkmcnt(0)
    v_and_or_b32 v67, v1, s63, v67
    s_add_u32 m0, s51, 0
    s_nop 0
    buffer_load_dwordx4 v64, s[28:31], s64 offen lds
    s_add_u32 m0, s51, 1024
    s_nop 0
    buffer_load_dwordx4 v64, s[28:31], s65 offen lds
    s_add_u32 m0, s51, 2048
    s_nop 0
    buffer_load_dwordx4 v64, s[28:31], s66 offen lds
    s_add_u32 m0, s51, 3072
    s_nop 0
    buffer_load_dwordx4 v65, s[28:31], s64 offen lds
    s_add_u32 m0, s51, 4096
    s_nop 0
    buffer_load_dwordx4 v65, s[28:31], s65 offen lds
    s_add_u32 m0, s51, 5120
    s_nop 0
    buffer_load_dwordx4 v65, s[28:31], s66 offen lds
    s_add_u32 m0, s51, 6144
    s_nop 0
    buffer_load_dwordx4 v66, s[28:31], s64 offen lds
    s_add_u32 m0, s51, 7168
    s_nop 0
    buffer_load_dwordx4 v66, s[28:31], s65 offen lds
    s_add_u32 m0, s51, 8192
    s_nop 0
    buffer_load_dwordx4 v66, s[28:31], s66 offen lds
    s_add_u32 m0, s51, 9216
    s_nop 0
    buffer_load_dwordx4 v67, s[28:31], s64 offen lds
    s_add_u32 m0, s51, 10240
    s_nop 0
    buffer_load_dwordx4 v67, s[28:31], s65 offen lds
    s_add_u32 m0, s51, 11264
    s_nop 0
    buffer_load_dwordx4 v67, s[28:31], s66 offen lds
    s_mov_b32 s50, 3
    s_waitcnt vmcnt(16)
    s_branch M_late2
M_late:
    s_waitcnt vmcnt(4)
M_late2:
    s_lshl_b32 s27, s59, 8
    s_add_u32 s27, s27, 30720
    v_lshlrev_b32 v12, 10, v10
    v_lshl_add_u32 v12, v11, 2, v12
    v_add_u32 v12, s27, v12
    s_barrier
    ds_read_u16_d16_hi v128, v12 offset:0
    ds_read_u16_d16_hi v144, v12 offset:2
    ds_read_u16_d16_hi v129, v12 offset:256
    ds_read_u16_d16_hi v145, v12 offset:258
    ds_read_u16_d16_hi v130, v12 offset:512
    ds_read_u16_d16_hi v146, v12 offset:514
    ds_read_u16_d16_hi v131, v12 offset:768
    ds_read_u16_d16_hi v147, v12 offset:770
    ds_read_u16_d16_hi v132, v12 offset:2048
    ds_read_u16_d16_hi v148, v12 offset:2050
    ds_read_u16_d16_hi v133, v12 offset:2304
    ds_read_u16_d16_hi v149, v12 offset:2306
    ds_read_u16_d16_hi v134, v12 offset:2560
    ds_read_u16_d16_hi v150, v12 offset:2562
    ds_read_u16_d16_hi v135, v12 offset:2816
    ds_read_u16_d16_hi v151, v12 offset:2818
    ds_read_u16_d16_hi v136, v12 offset:4096
    ds_read_u16_d16_hi v152, v12 offset:4098
    ds_read_u16_d16_hi v137, v12 offset:4352
    ds_read_u16_d16_hi v153, v12 offset:4354
    ds_read_u16_d16_hi v138, v12 offset:4608
    ds_read_u16_d16_hi v154, v12 offset:4610
    ds_read_u16_d16_hi v139, v12 offset:4864
    ds_read_u16_d16_hi v155, v12 offset:4866
    ds_read_u16_d16_hi v140, v12 offset:6144
    ds_read_u16_d16_hi v156, v12 offset:6146
    ds_read_u16_d16_hi v141, v12 offset:6400
    ds_read_u16_d16_hi v157, v12 offset:6402
    ds_read_u16_d16_hi v142, v12 offset:6656
    ds_read_u16_d16_hi v158, v12 offset:6658
    ds_read_u16_d16_hi v143, v12 offset:6912
    ds_read_u16_d16_hi v159, v12 offset:6914
    ds_read_u16_d16_hi v160, v12 offset:128
    ds_read_u16_d16_hi v176, v12 offset:130
    ds_read_u16_d16_hi v161, v12 offset:384
    ds_read_u16_d16_hi v177, v12 offset:386
    ds_read_u16_d16_hi v162, v12 offset:640
    ds_read_u16_d16_hi v178, v12 offset:642
    ds_read_u16_d16_hi v163, v12 offset:896
    ds_read_u16_d16_hi v179, v12 offset:898
    ds_read_u16_d16_hi v164, v12 offset:2176
    ds_read_u16_d16_hi v180, v12 offset:2178
    ds_read_u16_d16_hi v165, v12 offset:2432
    ds_read_u16_d16_hi v181, v12 offset:2434
    ds_read_u16_d16_hi v166, v12 offset:2688
    ds_read_u16_d16_hi v182, v12 offset:2690
    ds_read_u16_d16_hi v167, v12 offset:2944
    ds_read_u16_d16_hi v183, v12 offset:2946
    ds_read_u16_d16_hi v168, v12 offset:4224
    ds_read_u16_d16_hi v184, v12 offset:4226
    ds_read_u16_d16_hi v169, v12 offset:4480
    ds_read_u16_d16_hi v185, v12 offset:4482
    ds_read_u16_d16_hi v170, v12 offset:4736
    ds_read_u16_d16_hi v186, v12 offset:4738
    ds_read_u16_d16_hi v171, v12 offset:4992
    ds_read_u16_d16_hi v187, v12 offset:4994
    ds_read_u16_d16_hi v172, v12 offset:6272
    ds_read_u16_d16_hi v188, v12 offset:6274
    ds_read_u16_d16_hi v173, v12 offset:6528
    ds_read_u16_d16_hi v189, v12 offset:6530
    ds_read_u16_d16_hi v174, v12 offset:6784
    ds_read_u16_d16_hi v190, v12 offset:6786
    ds_read_u16_d16_hi v175, v12 offset:7040
    ds_read_u16_d16_hi v191, v12 offset:7042
    s_waitcnt lgkmcnt(0)
    s_cmp_eq_u32 s50, 3
    s_cbranch_scc1 M_noinit
    s_cmp_ge_u32 s26, 4
    s_cbranch_scc1 M_noacc
    s_barrier
    s_mov_b32 s50, 0
    s_cmp_eq_u32 s48, 0
    s_cbranch_scc1 M_noacc
    s_mov_b32 s70, 1
    s_waitcnt vmcnt(0)
    s_branch M_noinit
M_noacc:
    s_cmp_eq_u32 s48, 0
    s_cbranch_scc1 M_nob
    ds_read_b32 v64, v5 offset:12
    ds_read_b32 v65, v5 offset:140
    ds_read_b32 v66, v5 offset:268
    ds_read_b32 v67, v5 offset:396
    s_waitcnt lgkmcnt(3)
    v_and_or_b32 v64, v1, s63, v64
    s_waitcnt lgkmcnt(2)
    v_and_or_b32 v65, v1, s63, v65
    s_waitcnt lgkmcnt(1)
    v_and_or_b32 v66, v1, s63, v66
    s_waitcnt lgkmcnt(0)
    v_and_or_b32 v67, v1, s63, v67
    s_add_u32 m0, s51, 0
    s_nop 0
    buffer_load_dwordx4 v64, s[28:31], s64 offen lds
    s_add_u32 m0, s51, 1024
    s_nop 0
    buffer_load_dwordx4 v64, s[28:31], s65 offen lds
    s_add_u32 m0, s51, 2048
    s_nop 0
    buffer_load_dwordx4 v64, s[28:31], s66 offen lds
    s_add_u32 m0, s51, 3072
    s_nop 0
    buffer_load_dwordx4 v65, s[28:31], s64 offen lds
    s_add_u32 m0, s51, 4096
    s_nop 0
    buffer_load_dwordx4 v65, s[28:31], s65 offen lds
    s_add_u32 m0, s51, 5120
    s_nop 0
    buffer_load_dwordx4 v65, s[28:31], s66 offen lds
    s_add_u32 m0, s51, 6144
    s_nop 0
    buffer_load_dwordx4 v66, s[28:31], s64 offen lds
    s_add_u32 m0, s51, 7168
    s_nop 0
    buffer_load_dwordx4 v66, s[28:31], s65 offen lds
    s_add_u32 m0, s51, 8192
    s_nop 0
    buffer_load_dwordx4 v66, s[28:31], s66 offen lds
    s_add_u32 m0, s51, 9216
    s_nop 0
    buffer_load_dwordx4 v67, s[28:31], s64 offen lds
    s_add_u32 m0, s51, 10240
    s_nop 0
    buffer_load_dwordx4 v67, s[28:31], s65 offen lds
    s_add_u32 m0, s51, 11264
    s_nop 0
    buffer_load_dwordx4 v67, s[28:31], s66 offen lds
    s_branch M_noinit
M_nob:
    s_cmp_eq_u32 s76, 0
    s_cbranch_scc1 M_noinit
    v_lshrrev_b32 v64, 7, v1
    v_and_b32 v65, 1, v64
    v_lshrrev_b32 v64, 1, v64
    v_lshl_add_u32 v64, v65, 2, v64
    v_lshlrev_b32 v64, 9, v64
    v_and_or_b32 v64, v1, s63, v64
    s_add_u32 m0, s51, 1024
    s_add_u32 s53, s40, 256
    buffer_load_dwordx4 v64, s[4:7], s53 offen  lds
    s_add_u32 m0, s51, 2048
    s_add_u32 s53, s40, 384
    buffer_load_dwordx4 v64, s[4:7], s53 offen  lds
    s_add_u32 m0, s51, 4096
    s_add_u32 s53, s41, 256
    buffer_load_dwordx4 v64, s[4:7], s53 offen  lds
    s_add_u32 m0, s51, 5120
    s_add_u32 s53, s41, 384
    buffer_load_dwordx4 v64, s[4:7], s53 offen  lds
    s_add_u32 m0, s51, 7168
    s_add_u32 s53, s42, 256
    buffer_load_dwordx4 v64, s[4:7], s53 offen  lds
    s_add_u32 m0, s51, 8192
    s_add_u32 s53, s42, 384
    buffer_load_dwordx4 v64, s[4:7], s53 offen  lds
    s_add_u32 m0, s51, 10240
    s_add_u32 s53, s43, 256
    buffer_load_dwordx4 v64, s[4:7], s53 offen  lds
    s_add_u32 m0, s51, 11264
    s_add_u32 s53, s43, 384
    buffer_load_dwordx4 v64, s[4:7], s53 offen  lds
M_noinit:
    s_cmp_eq_u32 s50, 0
    s_cbranch_scc1 M_nod
    s_barrier
    s_mov_b32 s50, 0
M_nod:
    s_cmp_eq_u32 s48, 0
    s_cbranch_scc1 M_wend
    s_mov_b32 s49, 0
    s_cmp_lt_u32 s26, 4
    s_cbranch_scc1 M_yp
    s_setprio 1
M_yp:
    ds_read_b128 v[104:107], v3 offset:0
    ds_read_b128 v[72:75], v7
    ds_read_b128 v[76:79], v7 offset:16
    ds_read_b64 v[12:13], v4 offset:2048
    ds_read_b64 v[14:15], v4 offset:2160
    ds_read_b64 v[16:17], v4 offset:2272
    ds_read_b64 v[18:19], v4 offset:2384
    ds_read_b128 v[20:23], v1 offset:24576
    ds_read_b128 v[24:27], v1 offset:0
    ds_read_b128 v[28:31], v1 offset:1024
    s_waitcnt lgkmcnt(7)
    v_mul_f32 v72, v104, v72
    v_mul_f32 v73, v104, v73
    v_mul_f32 v74, v104, v74
    v_mul_f32 v75, v104, v75
    v_mul_f32 v76, v104, v76
    v_mul_f32 v77, v104, v77
    v_mul_f32 v78, v104, v78
    v_mul_f32 v79, v104, v79
    v_cvt_pk_bf16_f32 v72, 0, v72
    v_cvt_pk_bf16_f32 v73, 0, v73
    v_cvt_pk_bf16_f32 v74, 0, v74
    v_cvt_pk_bf16_f32 v75, 0, v75
    v_cvt_pk_bf16_f32 v76, 0, v76
    v_cvt_pk_bf16_f32 v77, 0, v77
    v_cvt_pk_bf16_f32 v78, 0, v78
    v_cvt_pk_bf16_f32 v79, 0, v79
    v_mul_f32 v72, s61, v72
    v_mul_f32 v73, s61, v73
    v_mul_f32 v74, s61, v74
    v_mul_f32 v75, s61, v75
    v_mul_f32 v76, s61, v76
    v_mul_f32 v77, s61, v77
    v_mul_f32 v78, s61, v78
    v_mul_f32 v79, s61, v79
    v_sin_f32 v72, v72
    v_sin_f32 v73, v73
    v_sin_f32 v74, v74
    v_sin_f32 v75, v75
    v_sin_f32 v76, v76
    v_sin_f32 v77, v77
    v_sin_f32 v78, v78
    v_sin_f32 v79, v79
    v_mul_f32 v72, v72, v105
    v_mul_f32 v73, v73, v105
    v_mul_f32 v74, v74, v105
    v_mul_f32 v75, v75, v105
    v_mul_f32 v76, v76, v105
    v_mul_f32 v77, v77, v105
    v_mul_f32 v78, v78, v105
    v_mul_f32 v79, v79, v105
    v_cvt_pk_bf16_f32 v8, v72, v73
    v_cvt_pk_bf16_f32 v9, v74, v75
    v_cvt_pk_bf16_f32 v10, v76, v77
    v_cvt_pk_bf16_f32 v11, v78, v79
    s_waitcnt lgkmcnt(3)
    v_pk_lshlrev_b16 v12, v6, v12
    v_pk_lshlrev_b16 v13, v6, v13
    v_pk_lshlrev_b16 v14, v6, v14
    v_pk_lshlrev_b16 v15, v6, v15
    v_pk_lshlrev_b16 v16, v6, v16
    v_pk_lshlrev_b16 v17, v6, v17
    v_pk_lshlrev_b16 v18, v6, v18
    v_pk_lshlrev_b16 v19, v6, v19
    s_waitcnt lgkmcnt(0)
    s_nop 0
M_batch:
    s_waitcnt vmcnt(12)
    v_mfma_f32_32x32x16_bf16 v[80:95], v[8:11], v[20:23], 0
    ds_read_b128 v[20:23], v1 offset:2048
    s_add_u32 s77, s49, 1
    s_cmp_lt_u32 s77, s48
    s_cselect_b32 s77, 0, 0x40000000
    ds_read_b32 v63, v3 offset:524
    v_bfe_u32 v62, v1, 9, 1
    s_waitcnt lgkmcnt(0)
    v_lshrrev_b32 v63, 2, v63
    v_lshl_add_u32 v63, v62, 6, v63
    buffer_load_dwordx4 v[48:51], v63, s[72:75], s77 offen offset:0
    buffer_load_dwordx4 v[52:55], v63, s[72:75], s77 offen offset:16
    buffer_load_dwordx4 v[56:59], v63, s[72:75], s77 offen offset:32
    buffer_load_dwordx4 v[60:63], v63, s[72:75], s77 offen offset:48
    s_cmp_eq_u32 s70, 0
    s_cbranch_scc1 M_vb16
    ds_read_b32 v112, v5 offset:12
    ds_read_b32 v113, v5 offset:140
    s_waitcnt lgkmcnt(1)
    v_and_or_b32 v112, v1, s63, v112
    s_add_u32 m0, s51, 0
    s_nop 0
    buffer_load_dwordx4 v112, s[28:31], s64 offen lds
    s_add_u32 m0, s51, 1024
    s_nop 0
    buffer_load_dwordx4 v112, s[28:31], s65 offen lds
    s_add_u32 m0, s51, 2048
    s_nop 0
    buffer_load_dwordx4 v112, s[28:31], s66 offen lds
    s_waitcnt lgkmcnt(0)
    v_and_or_b32 v113, v1, s63, v113
    s_add_u32 m0, s51, 3072
    s_nop 0
    buffer_load_dwordx4 v113, s[28:31], s64 offen lds
    s_add_u32 m0, s51, 4096
    s_nop 0
    buffer_load_dwordx4 v113, s[28:31], s65 offen lds
    s_add_u32 m0, s51, 5120
    s_nop 0
    buffer_load_dwordx4 v113, s[28:31], s66 offen lds
M_vb16:
    v_mfma_f32_32x32x16_bf16 v[64:79], v[32:35], v[24:27], 0
    ds_read_b128 v[24:27], v1 offset:3072
    v_mfma_f32_32x32x16_bf16 v[64:79], v[36:39], v[28:31], v[64:79]
    ds_read_b128 v[28:31], v1 offset:25600
    v_mfma_f32_32x32x16_bf16 v[64:79], v[40:43], v[20:23], v[64:79]
    ds_read_b128 v[20:23], v1 offset:4096
    s_waitcnt lgkmcnt(2)
    v_mfma_f32_32x32x16_bf16 v[64:79], v[44:47], v[24:27], v[64:79]
    ds_read_b128 v[24:27], v1 offset:5120
    s_cmp_eq_u32 s70, 0
    s_nop 9
    s_cbranch_scc1 M_vb17
    ds_read_b32 v114, v5 offset:268
    s_waitcnt lgkmcnt(0)
    v_and_or_b32 v114, v1, s63, v114
    s_add_u32 m0, s51, 6144
    s_nop 0
    buffer_load_dwordx4 v114, s[28:31], s64 offen lds
    s_add_u32 m0, s51, 7168
    s_nop 0
    buffer_load_dwordx4 v114, s[28:31], s65 offen lds
    s_add_u32 m0, s51, 8192
    s_nop 0
    buffer_load_dwordx4 v114, s[28:31], s66 offen lds
M_vb17:
    s_waitcnt lgkmcnt(2)
    v_mfma_f32_32x32x16_bf16 v[112:127], v[8:11], v[28:31], 0
    ds_read_b128 v[28:31], v1 offset:6144
    s_waitcnt lgkmcnt(2)
    v_mfma_f32_32x32x16_bf16 v[96:111], v[32:35], v[20:23], 0
    ds_read_b128 v[20:23], v1 offset:7168
    v_mul_f32 v64, v64, v80
    v_mul_f32 v65, v65, v81
    v_mul_f32 v66, v66, v82
    v_mul_f32 v67, v67, v83
    v_mul_f32 v68, v68, v84
    v_mul_f32 v69, v69, v85
    s_waitcnt lgkmcnt(2)
    v_mfma_f32_32x32x16_bf16 v[96:111], v[36:39], v[24:27], v[96:111]
    ds_read_b128 v[24:27], v1 offset:26624
    v_mul_f32 v70, v70, v86
    v_mul_f32 v71, v71, v87
    v_mul_f32 v72, v72, v88
    v_mul_f32 v73, v73, v89
    v_mul_f32 v74, v74, v90
    v_mul_f32 v75, v75, v91
    v_mul_f32 v76, v76, v92
    s_waitcnt lgkmcnt(2)
    v_mfma_f32_32x32x16_bf16 v[96:111], v[40:43], v[28:31], v[96:111]
    ds_read_b128 v[28:31], v1 offset:8192
    v_mul_f32 v77, v77, v93
    v_mul_f32 v78, v78, v94
    v_mul_f32 v79, v79, v95
    v_cvt_pk_bf16_f32 v64, v64, v65
    v_cvt_pk_bf16_f32 v65, v66, v67
    v_cvt_pk_bf16_f32 v66, v68, v69
    s_waitcnt lgkmcnt(2)
    v_mfma_f32_32x32x16_bf16 v[96:111], v[44:47], v[20:23], v[96:111]
    ds_read_b128 v[20:23], v1 offset:9216
    v_cvt_pk_bf16_f32 v67, v70, v71
    v_cvt_pk_bf16_f32 v68, v72, v73
    v_cvt_pk_bf16_f32 v69, v74, v75
    v_cvt_pk_bf16_f32 v70, v76, v77
    v_cvt_pk_bf16_f32 v71, v78, v79
    v_mfma_f32_32x32x16_bf16 v[128:143], v[12:15], v[64:67], v[128:143]
    s_nop 0
    v_mfma_f32_32x32x16_bf16 v[128:143], v[16:19], v[68:71], v[128:143]
    s_cmp_eq_u32 s70, 0
    s_nop 10
    s_cbranch_scc1 M_vb18
    ds_read_b32 v72, v5 offset:396
    s_waitcnt lgkmcnt(0)
    v_and_or_b32 v72, v1, s63, v72
    s_add_u32 m0, s51, 9216
    s_nop 0
    buffer_load_dwordx4 v72, s[28:31], s64 offen lds
    s_add_u32 m0, s51, 10240
    s_nop 0
    buffer_load_dwordx4 v72, s[28:31], s65 offen lds
    s_add_u32 m0, s51, 11264
    s_nop 0
    buffer_load_dwordx4 v72, s[28:31], s66 offen lds
M_vb18:
    s_waitcnt lgkmcnt(2)
    v_mfma_f32_32x32x16_bf16 v[80:95], v[8:11], v[24:27], 0
    ds_read_b128 v[24:27], v1 offset:10240
    s_waitcnt lgkmcnt(2)
    v_mfma_f32_32x32x16_bf16 v[64:79], v[32:35], v[28:31], 0
    ds_read_b128 v[28:31], v1 offset:11264
    v_mul_f32 v96, v96, v112
    v_mul_f32 v97, v97, v113
    v_mul_f32 v98, v98, v114
    v_mul_f32 v99, v99, v115
    v_mul_f32 v100, v100, v116
    v_mul_f32 v101, v101, v117
    s_waitcnt lgkmcnt(2)
    v_mfma_f32_32x32x16_bf16 v[64:79], v[36:39], v[20:23], v[64:79]
    ds_read_b128 v[20:23], v1 offset:27648
    v_mul_f32 v102, v102, v118
    v_mul_f32 v103, v103, v119
    v_mul_f32 v104, v104, v120
    v_mul_f32 v105, v105, v121
    v_mul_f32 v106, v106, v122
    v_mul_f32 v107, v107, v123
    v_mul_f32 v108, v108, v124
    s_waitcnt lgkmcnt(2)
    v_mfma_f32_32x32x16_bf16 v[64:79], v[40:43], v[24:27], v[64:79]
    ds_read_b128 v[24:27], v1 offset:12288
    v_mul_f32 v109, v109, v125
    v_mul_f32 v110, v110, v126
    v_mul_f32 v111, v111, v127
    v_cvt_pk_bf16_f32 v96, v96, v97
    v_cvt_pk_bf16_f32 v97, v98, v99
    v_cvt_pk_bf16_f32 v98, v100, v101
    s_waitcnt lgkmcnt(2)
    v_mfma_f32_32x32x16_bf16 v[64:79], v[44:47], v[28:31], v[64:79]
    ds_read_b128 v[28:31], v1 offset:13312
    v_cvt_pk_bf16_f32 v99, v102, v103
    v_cvt_pk_bf16_f32 v100, v104, v105
    v_cvt_pk_bf16_f32 v101, v106, v107
    v_cvt_pk_bf16_f32 v102, v108, v109
    v_cvt_pk_bf16_f32 v103, v110, v111
    v_mfma_f32_32x32x16_bf16 v[144:159], v[12:15], v[96:99], v[144:159]
    s_nop 0
    v_mfma_f32_32x32x16_bf16 v[144:159], v[16:19], v[100:103], v[144:159]
    s_waitcnt lgkmcnt(2)
    v_mfma_f32_32x32x16_bf16 v[112:127], v[8:11], v[20:23], 0
    ds_read_b128 v[20:23], v1 offset:14336
    s_waitcnt lgkmcnt(2)
    v_mfma_f32_32x32x16_bf16 v[96:111], v[32:35], v[24:27], 0
    ds_read_b128 v[24:27], v1 offset:15360
    v_mul_f32 v64, v64, v80
    v_mul_f32 v65, v65, v81
    v_mul_f32 v66, v66, v82
    v_mul_f32 v67, v67, v83
    v_mul_f32 v68, v68, v84
    v_mul_f32 v69, v69, v85
    v_mul_f32 v70, v70, v86
    v_mul_f32 v71, v71, v87
    v_mul_f32 v72, v72, v88
    v_mul_f32 v73, v73, v89
    v_mul_f32 v74, v74, v90
    v_mul_f32 v75, v75, v91
    v_mul_f32 v76, v76, v92
    v_mul_f32 v77, v77, v93
    v_mul_f32 v78, v78, v94
    v_mul_f32 v79, v79, v95
    s_cmp_eq_u32 s70, 0
    s_nop 0
    s_cbranch_scc1 M_vw19
    s_waitcnt vmcnt(0)
    s_mov_b32 s70, 0
M_vw19:
    s_waitcnt vmcnt(4)
    ds_read_u16_d16_hi v80, v2 offset:0
    ds_read_u16_d16_hi v81, v2 offset:256
    ds_read_u16_d16_hi v82, v2 offset:512
    ds_read_u16_d16_hi v83, v2 offset:768
    ds_read_u16_d16_hi v84, v2 offset:3072
    ds_read_u16_d16_hi v85, v2 offset:3328
    ds_read_u16_d16_hi v86, v2 offset:3584
    ds_read_u16_d16_hi v87, v2 offset:3840
    ds_read_u16_d16_hi v88, v2 offset:6144
    ds_read_u16_d16_hi v89, v2 offset:6400
    ds_read_u16_d16_hi v90, v2 offset:6656
    ds_read_u16_d16_hi v91, v2 offset:6912
    ds_read_u16_d16_hi v92, v2 offset:9216
    ds_read_u16_d16_hi v93, v2 offset:9472
    ds_read_u16_d16_hi v94, v2 offset:9728
    ds_read_u16_d16_hi v95, v2 offset:9984
    s_waitcnt lgkmcnt(12)
    v_mul_f32 v80, v80, v64
    v_mul_f32 v81, v81, v65
    v_mul_f32 v82, v82, v66
    v_mul_f32 v83, v83, v67
    s_waitcnt lgkmcnt(8)
    v_mul_f32 v84, v84, v68
    v_mul_f32 v85, v85, v69
    v_mfma_f32_32x32x16_bf16 v[96:111], v[36:39], v[28:31], v[96:111]
    ds_read_b128 v[28:31], v1 offset:28672
    v_mul_f32 v86, v86, v70
    v_mul_f32 v87, v87, v71
    v_cvt_pk_bf16_f32 v80, v80, v81
    v_cvt_pk_bf16_f32 v81, v82, v83
    v_cvt_pk_bf16_f32 v82, v84, v85
    v_cvt_pk_bf16_f32 v83, v86, v87
    s_nop 1
    v_mfma_f32_32x32x16_bf16 v[160:175], v[12:15], v[80:83], v[160:175]
    ds_read_u16_d16_hi v80, v2 offset:1024
    ds_read_u16_d16_hi v81, v2 offset:1280
    ds_read_u16_d16_hi v82, v2 offset:1536
    ds_read_u16_d16_hi v83, v2 offset:1792
    ds_read_u16_d16_hi v84, v2 offset:4096
    ds_read_u16_d16_hi v85, v2 offset:4352
    ds_read_u16_d16_hi v86, v2 offset:4608
    ds_read_u16_d16_hi v87, v2 offset:4864
    s_waitcnt lgkmcnt(13)
    v_mul_f32 v88, v88, v72
    v_mul_f32 v89, v89, v73
    v_mul_f32 v90, v90, v74
    v_mul_f32 v91, v91, v75
    s_waitcnt lgkmcnt(9)
    v_mul_f32 v92, v92, v76
    v_mul_f32 v93, v93, v77
    v_mul_f32 v94, v94, v78
    v_mul_f32 v95, v95, v79
    v_cvt_pk_bf16_f32 v88, v88, v89
    v_cvt_pk_bf16_f32 v89, v90, v91
    v_cvt_pk_bf16_f32 v90, v92, v93
    v_cvt_pk_bf16_f32 v91, v94, v95
    s_nop 1
    v_mfma_f32_32x32x16_bf16 v[160:175], v[16:19], v[88:91], v[160:175]
    ds_read_u16_d16_hi v88, v2 offset:7168
    ds_read_u16_d16_hi v89, v2 offset:7424
    ds_read_u16_d16_hi v90, v2 offset:7680
    ds_read_u16_d16_hi v91, v2 offset:7936
    ds_read_u16_d16_hi v92, v2 offset:10240
    ds_read_u16_d16_hi v93, v2 offset:10496
    ds_read_u16_d16_hi v94, v2 offset:10752
    ds_read_u16_d16_hi v95, v2 offset:11008
    s_waitcnt lgkmcnt(12)
    v_mul_f32 v80, v80, v64
    v_mul_f32 v81, v81, v65
    v_mul_f32 v82, v82, v66
    v_mfma_f32_32x32x16_bf16 v[96:111], v[40:43], v[20:23], v[96:111]
    ds_read_b128 v[20:23], v1 offset:16384
    v_mul_f32 v83, v83, v67
    s_waitcnt lgkmcnt(9)
    v_mul_f32 v84, v84, v68
    v_mul_f32 v85, v85, v69
    v_mul_f32 v86, v86, v70
    v_mul_f32 v87, v87, v71
    v_cvt_pk_bf16_f32 v80, v80, v81
    v_cvt_pk_bf16_f32 v81, v82, v83
    v_cvt_pk_bf16_f32 v82, v84, v85
    v_cvt_pk_bf16_f32 v83, v86, v87
    s_nop 1
    v_mfma_f32_32x32x16_bf16 v[192:207], v[12:15], v[80:83], v[192:207]
    ds_read_u16_d16_hi v80, v2 offset:2048
    ds_read_u16_d16_hi v81, v2 offset:2304
    ds_read_u16_d16_hi v82, v2 offset:2560
    ds_read_u16_d16_hi v83, v2 offset:2816
    ds_read_u16_d16_hi v84, v2 offset:5120
    ds_read_u16_d16_hi v85, v2 offset:5376
    ds_read_u16_d16_hi v86, v2 offset:5632
    ds_read_u16_d16_hi v87, v2 offset:5888
    s_waitcnt lgkmcnt(13)
    v_mul_f32 v88, v88, v72
    v_mul_f32 v89, v89, v73
    v_mul_f32 v90, v90, v74
    v_mul_f32 v91, v91, v75
    s_waitcnt lgkmcnt(9)
    v_mul_f32 v92, v92, v76
    v_mul_f32 v93, v93, v77
    v_mul_f32 v94, v94, v78
    v_mul_f32 v95, v95, v79
    v_cvt_pk_bf16_f32 v88, v88, v89
    v_cvt_pk_bf16_f32 v89, v90, v91
    v_cvt_pk_bf16_f32 v90, v92, v93
    v_cvt_pk_bf16_f32 v91, v94, v95
    s_nop 1
    v_mfma_f32_32x32x16_bf16 v[192:207], v[16:19], v[88:91], v[192:207]
    ds_read_u16_d16_hi v88, v2 offset:8192
    ds_read_u16_d16_hi v89, v2 offset:8448
    ds_read_u16_d16_hi v90, v2 offset:8704
    ds_read_u16_d16_hi v91, v2 offset:8960
    ds_read_u16_d16_hi v92, v2 offset:11264
    ds_read_u16_d16_hi v93, v2 offset:11520
    ds_read_u16_d16_hi v94, v2 offset:11776
    ds_read_u16_d16_hi v95, v2 offset:12032
    v_mfma_f32_32x32x16_bf16 v[96:111], v[44:47], v[24:27], v[96:111]
    ds_read_b128 v[24:27], v1 offset:17408
    s_waitcnt lgkmcnt(13)
    v_mul_f32 v80, v80, v64
    v_mul_f32 v81, v81, v65
    v_mul_f32 v82, v82, v66
    v_mul_f32 v83, v83, v67
    s_waitcnt lgkmcnt(9)
    v_mul_f32 v84, v84, v68
    v_mul_f32 v85, v85, v69
    v_mul_f32 v86, v86, v70
    v_mul_f32 v87, v87, v71
    v_cvt_pk_bf16_f32 v80, v80, v81
    v_cvt_pk_bf16_f32 v81, v82, v83
    v_cvt_pk_bf16_f32 v82, v84, v85
    v_cvt_pk_bf16_f32 v83, v86, v87
    s_nop 1
    v_mfma_f32_32x32x16_bf16 v[224:239], v[12:15], v[80:83], v[224:239]
    s_waitcnt lgkmcnt(5)
    v_mul_f32 v88, v88, v72
    v_mul_f32 v89, v89, v73
    v_mul_f32 v90, v90, v74
    v_mul_f32 v91, v91, v75
    s_waitcnt lgkmcnt(1)
    v_mul_f32 v92, v92, v76
    v_mul_f32 v93, v93, v77
    v_mul_f32 v94, v94, v78
    v_mul_f32 v95, v95, v79
    v_cvt_pk_bf16_f32 v88, v88, v89
    v_cvt_pk_bf16_f32 v89, v90, v91
    v_cvt_pk_bf16_f32 v90, v92, v93
    v_cvt_pk_bf16_f32 v91, v94, v95
    s_nop 1
    v_mfma_f32_32x32x16_bf16 v[224:239], v[16:19], v[88:91], v[224:239]
    v_mfma_f32_32x32x16_bf16 v[80:95], v[8:11], v[28:31], 0
    ds_read_b128 v[28:31], v1 offset:18432
    v_mfma_f32_32x32x16_bf16 v[64:79], v[32:35], v[20:23], 0
    ds_read_b128 v[20:23], v1 offset:19456
    v_mul_f32 v96, v96, v112
    v_mul_f32 v97, v97, v113
    v_mul_f32 v98, v98, v114
    v_mul_f32 v99, v99, v115
    v_mul_f32 v100, v100, v116
    v_mul_f32 v101, v101, v117
    v_mul_f32 v102, v102, v118
    v_mul_f32 v103, v103, v119
    v_mul_f32 v104, v104, v120
    v_mul_f32 v105, v105, v121
    v_mul_f32 v106, v106, v122
    v_mul_f32 v107, v107, v123
    v_mul_f32 v108, v108, v124
    v_mul_f32 v109, v109, v125
    v_mul_f32 v110, v110, v126
    v_mul_f32 v111, v111, v127
    ds_read_u16_d16_hi v112, v2 offset:2
    ds_read_u16_d16_hi v113, v2 offset:258
    ds_read_u16_d16_hi v114, v2 offset:514
    ds_read_u16_d16_hi v115, v2 offset:770
    ds_read_u16_d16_hi v116, v2 offset:3074
    ds_read_u16_d16_hi v117, v2 offset:3330
    ds_read_u16_d16_hi v118, v2 offset:3586
    ds_read_u16_d16_hi v119, v2 offset:3842
    ds_read_u16_d16_hi v120, v2 offset:6146
    ds_read_u16_d16_hi v121, v2 offset:6402
    ds_read_u16_d16_hi v122, v2 offset:6658
    ds_read_u16_d16_hi v123, v2 offset:6914
    ds_read_u16_d16_hi v124, v2 offset:9218
    ds_read_u16_d16_hi v125, v2 offset:9474
    ds_read_u16_d16_hi v126, v2 offset:9730
    ds_read_u16_d16_hi v127, v2 offset:9986
    s_waitcnt lgkmcnt(12)
    v_mul_f32 v112, v112, v96
    v_mul_f32 v113, v113, v97
    v_mul_f32 v114, v114, v98
    v_mul_f32 v115, v115, v99
    s_waitcnt lgkmcnt(8)
    v_mul_f32 v116, v116, v100
    v_mul_f32 v117, v117, v101
    v_mul_f32 v118, v118, v102
    v_mfma_f32_32x32x16_bf16 v[64:79], v[36:39], v[24:27], v[64:79]
    ds_read_b128 v[24:27], v1 offset:29696
    v_mul_f32 v119, v119, v103
    v_cvt_pk_bf16_f32 v112, v112, v113
    v_cvt_pk_bf16_f32 v113, v114, v115
    v_cvt_pk_bf16_f32 v114, v116, v117
    v_cvt_pk_bf16_f32 v115, v118, v119
    s_nop 1
    v_mfma_f32_32x32x16_bf16 v[176:191], v[12:15], v[112:115], v[176:191]
    ds_read_u16_d16_hi v112, v2 offset:1026
    ds_read_u16_d16_hi v113, v2 offset:1282
    ds_read_u16_d16_hi v114, v2 offset:1538
    ds_read_u16_d16_hi v115, v2 offset:1794
    ds_read_u16_d16_hi v116, v2 offset:4098
    ds_read_u16_d16_hi v117, v2 offset:4354
    ds_read_u16_d16_hi v118, v2 offset:4610
    ds_read_u16_d16_hi v119, v2 offset:4866
    s_waitcnt lgkmcnt(13)
    v_mul_f32 v120, v120, v104
    v_mul_f32 v121, v121, v105
    v_mul_f32 v122, v122, v106
    v_mul_f32 v123, v123, v107
    s_waitcnt lgkmcnt(9)
    v_mul_f32 v124, v124, v108
    v_mul_f32 v125, v125, v109
    v_mul_f32 v126, v126, v110
    v_mul_f32 v127, v127, v111
    v_cvt_pk_bf16_f32 v120, v120, v121
    v_cvt_pk_bf16_f32 v121, v122, v123
    v_cvt_pk_bf16_f32 v122, v124, v125
    v_cvt_pk_bf16_f32 v123, v126, v127
    s_nop 1
    v_mfma_f32_32x32x16_bf16 v[176:191], v[16:19], v[120:123], v[176:191]
    ds_read_u16_d16_hi v120, v2 offset:7170
    ds_read_u16_d16_hi v121, v2 offset:7426
    ds_read_u16_d16_hi v122, v2 offset:7682
    ds_read_u16_d16_hi v123, v2 offset:7938
    ds_read_u16_d16_hi v124, v2 offset:10242
    ds_read_u16_d16_hi v125, v2 offset:10498
    ds_read_u16_d16_hi v126, v2 offset:10754
    ds_read_u16_d16_hi v127, v2 offset:11010
    s_waitcnt lgkmcnt(12)
    v_mul_f32 v112, v112, v96
    v_mul_f32 v113, v113, v97
    v_mul_f32 v114, v114, v98
    v_mul_f32 v115, v115, v99
    v_mfma_f32_32x32x16_bf16 v[64:79], v[40:43], v[28:31], v[64:79]
    ds_read_b128 v[28:31], v1 offset:20480
    s_waitcnt lgkmcnt(9)
    v_mul_f32 v116, v116, v100
    v_mul_f32 v117, v117, v101
    v_mul_f32 v118, v118, v102
    v_mul_f32 v119, v119, v103
    v_cvt_pk_bf16_f32 v112, v112, v113
    v_cvt_pk_bf16_f32 v113, v114, v115
    v_cvt_pk_bf16_f32 v114, v116, v117
    v_cvt_pk_bf16_f32 v115, v118, v119
    s_nop 1
    v_mfma_f32_32x32x16_bf16 v[208:223], v[12:15], v[112:115], v[208:223]
    ds_read_u16_d16_hi v112, v2 offset:2050
    ds_read_u16_d16_hi v113, v2 offset:2306
    ds_read_u16_d16_hi v114, v2 offset:2562
    ds_read_u16_d16_hi v115, v2 offset:2818
    ds_read_u16_d16_hi v116, v2 offset:5122
    ds_read_u16_d16_hi v117, v2 offset:5378
    ds_read_u16_d16_hi v118, v2 offset:5634
    ds_read_u16_d16_hi v119, v2 offset:5890
    s_waitcnt lgkmcnt(13)
    v_mul_f32 v120, v120, v104
    v_mul_f32 v121, v121, v105
    v_mul_f32 v122, v122, v106
    v_mul_f32 v123, v123, v107
    s_waitcnt lgkmcnt(9)
    v_mul_f32 v124, v124, v108
    v_mul_f32 v125, v125, v109
    v_mul_f32 v126, v126, v110
    v_mul_f32 v127, v127, v111
    v_cvt_pk_bf16_f32 v120, v120, v121
    v_cvt_pk_bf16_f32 v121, v122, v123
    v_cvt_pk_bf16_f32 v122, v124, v125
    v_cvt_pk_bf16_f32 v123, v126, v127
    s_nop 1
    v_mfma_f32_32x32x16_bf16 v[208:223], v[16:19], v[120:123], v[208:223]
    ds_read_u16_d16_hi v120, v2 offset:8194
    ds_read_u16_d16_hi v121, v2 offset:8450
    ds_read_u16_d16_hi v122, v2 offset:8706
    ds_read_u16_d16_hi v123, v2 offset:8962
    ds_read_u16_d16_hi v124, v2 offset:11266
    ds_read_u16_d16_hi v125, v2 offset:11522
    ds_read_u16_d16_hi v126, v2 offset:11778
    ds_read_u16_d16_hi v127, v2 offset:12034
    s_waitcnt lgkmcnt(12)
    v_mul_f32 v112, v112, v96
    v_mfma_f32_32x32x16_bf16 v[64:79], v[44:47], v[20:23], v[64:79]
    ds_read_b128 v[20:23], v1 offset:21504
    v_mul_f32 v113, v113, v97
    v_mul_f32 v114, v114, v98
    v_mul_f32 v115, v115, v99
    s_waitcnt lgkmcnt(9)
    v_mul_f32 v116, v116, v100
    v_mul_f32 v117, v117, v101
    v_mul_f32 v118, v118, v102
    v_mul_f32 v119, v119, v103
    v_cvt_pk_bf16_f32 v112, v112, v113
    v_cvt_pk_bf16_f32 v113, v114, v115
    v_cvt_pk_bf16_f32 v114, v116, v117
    v_cvt_pk_bf16_f32 v115, v118, v119
    s_nop 1
    v_mfma_f32_32x32x16_bf16 v[240:255], v[12:15], v[112:115], v[240:255]
    s_waitcnt lgkmcnt(5)
    v_mul_f32 v120, v120, v104
    v_mul_f32 v121, v121, v105
    v_mul_f32 v122, v122, v106
    v_mul_f32 v123, v123, v107
    s_waitcnt lgkmcnt(1)
    v_mul_f32 v124, v124, v108
    v_mul_f32 v125, v125, v109
    v_mul_f32 v126, v126, v110
    v_mul_f32 v127, v127, v111
    v_cvt_pk_bf16_f32 v120, v120, v121
    v_cvt_pk_bf16_f32 v121, v122, v123
    v_cvt_pk_bf16_f32 v122, v124, v125
    v_cvt_pk_bf16_f32 v123, v126, v127
    s_nop 1
    v_mfma_f32_32x32x16_bf16 v[240:255], v[16:19], v[120:123], v[240:255]
    s_cmp_lg_u32 s77, 0
    s_nop 10
    s_cbranch_scc1 M_nv20
    ds_read_b32 v112, v5 offset:524
    ds_read_b32 v113, v5 offset:652
    ds_read_b32 v114, v5 offset:780
    ds_read_b32 v115, v5 offset:908
    s_waitcnt lgkmcnt(3)
    v_and_or_b32 v112, v1, s63, v112
    s_waitcnt lgkmcnt(2)
    v_and_or_b32 v113, v1, s63, v113
    s_waitcnt lgkmcnt(1)
    v_and_or_b32 v114, v1, s63, v114
    s_waitcnt lgkmcnt(0)
    v_and_or_b32 v115, v1, s63, v115
    s_add_u32 m0, s51, 0
    s_nop 0
    buffer_load_dwordx4 v112, s[28:31], s64 offen lds
    s_add_u32 m0, s51, 1024
    s_nop 0
    buffer_load_dwordx4 v112, s[28:31], s65 offen lds
    s_add_u32 m0, s51, 2048
    s_nop 0
    buffer_load_dwordx4 v112, s[28:31], s66 offen lds
    s_add_u32 m0, s51, 3072
    s_nop 0
    buffer_load_dwordx4 v113, s[28:31], s64 offen lds
    s_add_u32 m0, s51, 4096
    s_nop 0
    buffer_load_dwordx4 v113, s[28:31], s65 offen lds
    s_add_u32 m0, s51, 5120
    s_nop 0
    buffer_load_dwordx4 v113, s[28:31], s66 offen lds
    s_add_u32 m0, s51, 6144
    s_nop 0
    buffer_load_dwordx4 v114, s[28:31], s64 offen lds
    s_add_u32 m0, s51, 7168
    s_nop 0
    buffer_load_dwordx4 v114, s[28:31], s65 offen lds
    s_add_u32 m0, s51, 8192
    s_nop 0
    buffer_load_dwordx4 v114, s[28:31], s66 offen lds
    s_add_u32 m0, s51, 9216
    s_nop 0
    buffer_load_dwordx4 v115, s[28:31], s64 offen lds
    s_add_u32 m0, s51, 10240
    s_nop 0
    buffer_load_dwordx4 v115, s[28:31], s65 offen lds
    s_add_u32 m0, s51, 11264
    s_nop 0
    buffer_load_dwordx4 v115, s[28:31], s66 offen lds
    s_branch M_nj20
M_nv20:
    s_cmp_eq_u32 s76, 0
    s_cbranch_scc1 M_nj20
    v_lshrrev_b32 v112, 7, v1
    v_and_b32 v113, 1, v112
    v_lshrrev_b32 v112, 1, v112
    v_lshl_add_u32 v112, v113, 2, v112
    v_lshlrev_b32 v112, 9, v112
    v_and_or_b32 v112, v1, s63, v112
    s_add_u32 m0, s51, 1024
    s_add_u32 s53, s40, 256
    buffer_load_dwordx4 v112, s[4:7], s53 offen  lds
    s_add_u32 m0, s51, 2048
    s_add_u32 s53, s40, 384
    buffer_load_dwordx4 v112, s[4:7], s53 offen  lds
    s_add_u32 m0, s51, 4096
    s_add_u32 s53, s41, 256
    buffer_load_dwordx4 v112, s[4:7], s53 offen  lds
    s_add_u32 m0, s51, 5120
    s_add_u32 s53, s41, 384
    buffer_load_dwordx4 v112, s[4:7], s53 offen  lds
    s_add_u32 m0, s51, 7168
    s_add_u32 s53, s42, 256
    buffer_load_dwordx4 v112, s[4:7], s53 offen  lds
    s_add_u32 m0, s51, 8192
    s_add_u32 s53, s42, 384
    buffer_load_dwordx4 v112, s[4:7], s53 offen  lds
    s_add_u32 m0, s51, 10240
    s_add_u32 s53, s43, 256
    buffer_load_dwordx4 v112, s[4:7], s53 offen  lds
    s_add_u32 m0, s51, 11264
    s_add_u32 s53, s43, 384
    buffer_load_dwordx4 v112, s[4:7], s53 offen  lds
M_nj20:
    v_mfma_f32_32x32x16_bf16 v[112:127], v[8:11], v[24:27], 0
    ds_read_b128 v[24:27], v1 offset:22528
    v_mfma_f32_32x32x16_bf16 v[96:111], v[32:35], v[28:31], 0
    ds_read_b128 v[28:31], v1 offset:23552
    v_mul_f32 v64, v64, v80
    v_mul_f32 v65, v65, v81
    v_mul_f32 v66, v66, v82
    v_mul_f32 v67, v67, v83
    v_mul_f32 v68, v68, v84
    v_mul_f32 v69, v69, v85
    v_mul_f32 v70, v70, v86
    v_mul_f32 v71, v71, v87
    v_mul_f32 v72, v72, v88
    v_mul_f32 v73, v73, v89
    v_mul_f32 v74, v74, v90
    v_mul_f32 v75, v75, v91
    s_waitcnt lgkmcnt(2)
    v_mfma_f32_32x32x16_bf16 v[96:111], v[36:39], v[20:23], v[96:111]
    v_mul_f32 v76, v76, v92
    v_mul_f32 v77, v77, v93
    v_mul_f32 v78, v78, v94
    v_mul_f32 v79, v79, v95
    ds_read_b64 v[80:81], v0 offset:2080
    ds_read_b64 v[88:89], v0 offset:2088
    ds_read_b64 v[82:83], v0 offset:2192
    ds_read_b64 v[90:91], v0 offset:2200
    ds_read_b64 v[84:85], v0 offset:2304
    ds_read_b64 v[92:93], v0 offset:2312
    ds_read_b64 v[86:87], v0 offset:2416
    ds_read_b64 v[94:95], v0 offset:2424
    v_cvt_pk_bf16_f32 v64, v64, v65
    v_cvt_pk_bf16_f32 v65, v66, v67
    v_cvt_pk_bf16_f32 v66, v68, v69
    v_cvt_pk_bf16_f32 v67, v70, v71
    v_cvt_pk_bf16_f32 v68, v72, v73
    v_cvt_pk_bf16_f32 v69, v74, v75
    v_cvt_pk_bf16_f32 v70, v76, v77
    s_waitcnt lgkmcnt(9)
    v_mfma_f32_32x32x16_bf16 v[96:111], v[40:43], v[24:27], v[96:111]
    v_cvt_pk_bf16_f32 v71, v78, v79
    v_pk_lshrrev_b16 v72, 14, v12 op_sel_hi:[0,1]
    v_pk_lshrrev_b16 v73, 14, v13 op_sel_hi:[0,1]
    v_pk_lshrrev_b16 v74, 14, v14 op_sel_hi:[0,1]
    v_pk_lshrrev_b16 v75, 14, v15 op_sel_hi:[0,1]
    v_pk_lshrrev_b16 v76, 14, v16 op_sel_hi:[0,1]
    v_pk_lshrrev_b16 v77, 14, v17 op_sel_hi:[0,1]
    v_pk_lshrrev_b16 v78, 14, v18 op_sel_hi:[0,1]
    v_pk_lshrrev_b16 v79, 14, v19 op_sel_hi:[0,1]
    s_waitcnt lgkmcnt(0)
    v_pk_mul_lo_u16 v80, v72, v80
    v_pk_mul_lo_u16 v81, v73, v81
    v_pk_mul_lo_u16 v82, v74, v82
    v_mfma_f32_32x32x16_bf16 v[96:111], v[44:47], v[28:31], v[96:111]
    v_pk_mul_lo_u16 v83, v75, v83
    v_pk_mul_lo_u16 v84, v76, v84
    v_pk_mul_lo_u16 v85, v77, v85
    v_pk_mul_lo_u16 v86, v78, v86
    v_pk_mul_lo_u16 v87, v79, v87
    v_pk_mul_lo_u16 v88, v72, v88
    v_pk_mul_lo_u16 v89, v73, v89
    v_pk_mul_lo_u16 v90, v74, v90
    v_pk_mul_lo_u16 v91, v75, v91
    v_pk_mul_lo_u16 v92, v76, v92
    v_pk_mul_lo_u16 v93, v77, v93
    v_pk_mul_lo_u16 v94, v78, v94
    v_pk_mul_lo_u16 v95, v79, v95
    v_mfma_f32_32x32x16_bf16 v[160:175], v[80:83], v[64:67], v[160:175]
    v_mul_f32 v96, v96, v112
    v_mul_f32 v97, v97, v113
    v_mul_f32 v98, v98, v114
    v_mul_f32 v99, v99, v115
    v_mul_f32 v100, v100, v116
    v_mul_f32 v101, v101, v117
    v_mfma_f32_32x32x16_bf16 v[160:175], v[84:87], v[68:71], v[160:175]
    v_mul_f32 v102, v102, v118
    v_mul_f32 v103, v103, v119
    v_mul_f32 v104, v104, v120
    v_mul_f32 v105, v105, v121
    v_mul_f32 v106, v106, v122
    v_mul_f32 v107, v107, v123
    v_mfma_f32_32x32x16_bf16 v[192:207], v[88:91], v[64:67], v[192:207]
    v_mul_f32 v108, v108, v124
    v_mul_f32 v109, v109, v125
    v_mul_f32 v110, v110, v126
    v_mul_f32 v111, v111, v127
    ds_read_b64 v[112:113], v0 offset:2096
    ds_read_b64 v[114:115], v0 offset:2208
    ds_read_b64 v[116:117], v0 offset:2320
    ds_read_b64 v[118:119], v0 offset:2432
    v_cvt_pk_bf16_f32 v96, v96, v97
    v_mfma_f32_32x32x16_bf16 v[192:207], v[92:95], v[68:71], v[192:207]
    v_cvt_pk_bf16_f32 v97, v98, v99
    v_cvt_pk_bf16_f32 v98, v100, v101
    v_cvt_pk_bf16_f32 v99, v102, v103
    v_cvt_pk_bf16_f32 v100, v104, v105
    v_cvt_pk_bf16_f32 v101, v106, v107
    v_cvt_pk_bf16_f32 v102, v108, v109
    v_cvt_pk_bf16_f32 v103, v110, v111
    s_waitcnt lgkmcnt(0)
    v_pk_mul_lo_u16 v112, v72, v112
    v_pk_mul_lo_u16 v113, v73, v113
    v_pk_mul_lo_u16 v114, v74, v114
    v_pk_mul_lo_u16 v115, v75, v115
    v_pk_mul_lo_u16 v116, v76, v116
    v_pk_mul_lo_u16 v117, v77, v117
    v_pk_mul_lo_u16 v118, v78, v118
    v_pk_mul_lo_u16 v119, v79, v119
    v_mfma_f32_32x32x16_bf16 v[176:191], v[80:83], v[96:99], v[176:191]
    ds_read_b128 v[104:107], v3 offset:512
    ds_read_b128 v[72:75], v7
    ds_read_b128 v[76:79], v7 offset:16
    ds_read_b64 v[12:13], v4 offset:2496
    ds_read_b64 v[14:15], v4 offset:2608
    ds_read_b64 v[16:17], v4 offset:2720
    ds_read_b64 v[18:19], v4 offset:2832
    ds_read_b128 v[20:23], v1 offset:24576
    ds_read_b128 v[24:27], v1 offset:0
    ds_read_b128 v[28:31], v1 offset:1024
    s_waitcnt lgkmcnt(7)
    v_mul_f32 v72, v104, v72
    v_mul_f32 v73, v104, v73
    v_mul_f32 v74, v104, v74
    v_mul_f32 v75, v104, v75
    v_mul_f32 v76, v104, v76
    v_mfma_f32_32x32x16_bf16 v[176:191], v[84:87], v[100:103], v[176:191]
    v_mul_f32 v77, v104, v77
    v_mul_f32 v78, v104, v78
    v_mul_f32 v79, v104, v79
    v_cvt_pk_bf16_f32 v72, 0, v72
    v_cvt_pk_bf16_f32 v73, 0, v73
    v_cvt_pk_bf16_f32 v74, 0, v74
    v_cvt_pk_bf16_f32 v75, 0, v75
    v_mfma_f32_32x32x16_bf16 v[208:223], v[88:91], v[96:99], v[208:223]
    v_cvt_pk_bf16_f32 v76, 0, v76
    v_cvt_pk_bf16_f32 v77, 0, v77
    v_cvt_pk_bf16_f32 v78, 0, v78
    v_cvt_pk_bf16_f32 v79, 0, v79
    v_mul_f32 v72, s61, v72
    v_mul_f32 v73, s61, v73
    v_mfma_f32_32x32x16_bf16 v[208:223], v[92:95], v[100:103], v[208:223]
    v_mul_f32 v74, s61, v74
    v_mul_f32 v75, s61, v75
    v_mul_f32 v76, s61, v76
    v_mul_f32 v77, s61, v77
    v_mul_f32 v78, s61, v78
    v_mul_f32 v79, s61, v79
    v_sin_f32 v72, v72
    v_mfma_f32_32x32x16_bf16 v[224:239], v[112:115], v[64:67], v[224:239]
    v_sin_f32 v73, v73
    v_sin_f32 v74, v74
    v_sin_f32 v75, v75
    v_sin_f32 v76, v76
    v_sin_f32 v77, v77
    v_sin_f32 v78, v78
    v_sin_f32 v79, v79
    v_mfma_f32_32x32x16_bf16 v[240:255], v[112:115], v[96:99], v[240:255]
    v_mul_f32 v72, v72, v105
    v_mul_f32 v73, v73, v105
    v_mul_f32 v74, v74, v105
    v_mul_f32 v75, v75, v105
    v_mul_f32 v76, v76, v105
    v_mul_f32 v77, v77, v105
    v_mfma_f32_32x32x16_bf16 v[224:239], v[116:119], v[68:71], v[224:239]
    v_mul_f32 v78, v78, v105
    v_mul_f32 v79, v79, v105
    v_cvt_pk_bf16_f32 v8, v72, v73
    v_cvt_pk_bf16_f32 v9, v74, v75
    v_cvt_pk_bf16_f32 v10, v76, v77
    v_cvt_pk_bf16_f32 v11, v78, v79
    s_waitcnt lgkmcnt(3)
    v_pk_lshlrev_b16 v12, v6, v12
    v_mfma_f32_32x32x16_bf16 v[240:255], v[116:119], v[100:103], v[240:255]
    v_pk_lshlrev_b16 v13, v6, v13
    v_pk_lshlrev_b16 v14, v6, v14
    v_pk_lshlrev_b16 v15, v6, v15
    v_pk_lshlrev_b16 v16, v6, v16
    v_pk_lshlrev_b16 v17, v6, v17
    v_pk_lshlrev_b16 v18, v6, v18
    v_pk_lshlrev_b16 v19, v6, v19
    v_add_u32 v3, 512, v3
    v_add_u32 v4, 448, v4
    v_add_u32 v0, 448, v0
    v_add_u32 v5, 512, v5
    s_waitcnt lgkmcnt(0)
    s_add_u32 s49, s49, 1
    s_cmp_lt_u32 s49, s48
    s_cbranch_scc0 M_wend
    s_waitcnt vmcnt(12)
    v_mfma_f32_32x32x16_bf16 v[80:95], v[8:11], v[20:23], 0
    ds_read_b128 v[20:23], v1 offset:2048
    s_add_u32 s77, s49, 1
    s_cmp_lt_u32 s77, s48
    s_cselect_b32 s77, 0, 0x40000000
    ds_read_b32 v47, v3 offset:524
    v_bfe_u32 v46, v1, 9, 1
    s_waitcnt lgkmcnt(0)
    v_lshrrev_b32 v47, 2, v47
    v_lshl_add_u32 v47, v46, 6, v47
    buffer_load_dwordx4 v[32:35], v47, s[72:75], s77 offen offset:0
    buffer_load_dwordx4 v[36:39], v47, s[72:75], s77 offen offset:16
    buffer_load_dwordx4 v[40:43], v47, s[72:75], s77 offen offset:32
    buffer_load_dwordx4 v[44:47], v47, s[72:75], s77 offen offset:48
    v_mfma_f32_32x32x16_bf16 v[64:79], v[48:51], v[24:27], 0
    ds_read_b128 v[24:27], v1 offset:3072
    v_mfma_f32_32x32x16_bf16 v[64:79], v[52:55], v[28:31], v[64:79]
    ds_read_b128 v[28:31], v1 offset:25600
    v_mfma_f32_32x32x16_bf16 v[64:79], v[56:59], v[20:23], v[64:79]
    ds_read_b128 v[20:23], v1 offset:4096
    s_waitcnt lgkmcnt(2)
    v_mfma_f32_32x32x16_bf16 v[64:79], v[60:63], v[24:27], v[64:79]
    ds_read_b128 v[24:27], v1 offset:5120
    s_waitcnt lgkmcnt(2)
    v_mfma_f32_32x32x16_bf16 v[112:127], v[8:11], v[28:31], 0
    ds_read_b128 v[28:31], v1 offset:6144
    s_waitcnt lgkmcnt(2)
    v_mfma_f32_32x32x16_bf16 v[96:111], v[48:51], v[20:23], 0
    ds_read_b128 v[20:23], v1 offset:7168
    s_nop 4
    v_mul_f32 v64, v64, v80
    v_mul_f32 v65, v65, v81
    v_mul_f32 v66, v66, v82
    v_mul_f32 v67, v67, v83
    v_mul_f32 v68, v68, v84
    v_mul_f32 v69, v69, v85
    s_waitcnt lgkmcnt(2)
    v_mfma_f32_32x32x16_bf16 v[96:111], v[52:55], v[24:27], v[96:111]
    ds_read_b128 v[24:27], v1 offset:26624
    v_mul_f32 v70, v70, v86
    v_mul_f32 v71, v71, v87
    v_mul_f32 v72, v72, v88
    v_mul_f32 v73, v73, v89
    v_mul_f32 v74, v74, v90
    v_mul_f32 v75, v75, v91
    v_mul_f32 v76, v76, v92
    s_waitcnt lgkmcnt(2)
    v_mfma_f32_32x32x16_bf16 v[96:111], v[56:59], v[28:31], v[96:111]
    ds_read_b128 v[28:31], v1 offset:8192
    v_mul_f32 v77, v77, v93
    v_mul_f32 v78, v78, v94
    v_mul_f32 v79, v79, v95
    v_cvt_pk_bf16_f32 v64, v64, v65
    v_cvt_pk_bf16_f32 v65, v66, v67
    v_cvt_pk_bf16_f32 v66, v68, v69
    s_waitcnt lgkmcnt(2)
    v_mfma_f32_32x32x16_bf16 v[96:111], v[60:63], v[20:23], v[96:111]
    ds_read_b128 v[20:23], v1 offset:9216
    v_cvt_pk_bf16_f32 v67, v70, v71
    v_cvt_pk_bf16_f32 v68, v72, v73
    v_cvt_pk_bf16_f32 v69, v74, v75
    v_cvt_pk_bf16_f32 v70, v76, v77
    v_cvt_pk_bf16_f32 v71, v78, v79
    v_mfma_f32_32x32x16_bf16 v[128:143], v[12:15], v[64:67], v[128:143]
    s_nop 0
    v_mfma_f32_32x32x16_bf16 v[128:143], v[16:19], v[68:71], v[128:143]
    s_waitcnt lgkmcnt(2)
    v_mfma_f32_32x32x16_bf16 v[80:95], v[8:11], v[24:27], 0
    ds_read_b128 v[24:27], v1 offset:10240
    s_waitcnt lgkmcnt(2)
    v_mfma_f32_32x32x16_bf16 v[64:79], v[48:51], v[28:31], 0
    ds_read_b128 v[28:31], v1 offset:11264
    v_mul_f32 v96, v96, v112
    v_mul_f32 v97, v97, v113
    v_mul_f32 v98, v98, v114
    v_mul_f32 v99, v99, v115
    v_mul_f32 v100, v100, v116
    v_mul_f32 v101, v101, v117
    s_waitcnt lgkmcnt(2)
    v_mfma_f32_32x32x16_bf16 v[64:79], v[52:55], v[20:23], v[64:79]
    ds_read_b128 v[20:23], v1 offset:27648
    v_mul_f32 v102, v102, v118
    v_mul_f32 v103, v103, v119
    v_mul_f32 v104, v104, v120
    v_mul_f32 v105, v105, v121
    v_mul_f32 v106, v106, v122
    v_mul_f32 v107, v107, v123
    v_mul_f32 v108, v108, v124
    s_waitcnt lgkmcnt(2)
    v_mfma_f32_32x32x16_bf16 v[64:79], v[56:59], v[24:27], v[64:79]
    ds_read_b128 v[24:27], v1 offset:12288
    v_mul_f32 v109, v109, v125
    v_mul_f32 v110, v110, v126
    v_mul_f32 v111, v111, v127
    v_cvt_pk_bf16_f32 v96, v96, v97
    v_cvt_pk_bf16_f32 v97, v98, v99
    v_cvt_pk_bf16_f32 v98, v100, v101
    s_waitcnt lgkmcnt(2)
    v_mfma_f32_32x32x16_bf16 v[64:79], v[60:63], v[28:31], v[64:79]
    ds_read_b128 v[28:31], v1 offset:13312
    v_cvt_pk_bf16_f32 v99, v102, v103
    v_cvt_pk_bf16_f32 v100, v104, v105
    v_cvt_pk_bf16_f32 v101, v106, v107
    v_cvt_pk_bf16_f32 v102, v108, v109
    v_cvt_pk_bf16_f32 v103, v110, v111
    v_mfma_f32_32x32x16_bf16 v[144:159], v[12:15], v[96:99], v[144:159]
    s_nop 0
    v_mfma_f32_32x32x16_bf16 v[144:159], v[16:19], v[100:103], v[144:159]
    s_waitcnt lgkmcnt(2)
    v_mfma_f32_32x32x16_bf16 v[112:127], v[8:11], v[20:23], 0
    ds_read_b128 v[20:23], v1 offset:14336
    s_waitcnt lgkmcnt(2)
    v_mfma_f32_32x32x16_bf16 v[96:111], v[48:51], v[24:27], 0
    ds_read_b128 v[24:27], v1 offset:15360
    v_mul_f32 v64, v64, v80
    v_mul_f32 v65, v65, v81
    v_mul_f32 v66, v66, v82
    v_mul_f32 v67, v67, v83
    v_mul_f32 v68, v68, v84
    v_mul_f32 v69, v69, v85
    v_mul_f32 v70, v70, v86
    v_mul_f32 v71, v71, v87
    v_mul_f32 v72, v72, v88
    v_mul_f32 v73, v73, v89
    v_mul_f32 v74, v74, v90
    v_mul_f32 v75, v75, v91
    v_mul_f32 v76, v76, v92
    v_mul_f32 v77, v77, v93
    v_mul_f32 v78, v78, v94
    v_mul_f32 v79, v79, v95
    s_waitcnt vmcnt(4)
    ds_read_u16_d16_hi v80, v2 offset:0
    ds_read_u16_d16_hi v81, v2 offset:256
    ds_read_u16_d16_hi v82, v2 offset:512
    ds_read_u16_d16_hi v83, v2 offset:768
    ds_read_u16_d16_hi v84, v2 offset:3072
    ds_read_u16_d16_hi v85, v2 offset:3328
    ds_read_u16_d16_hi v86, v2 offset:3584
    ds_read_u16_d16_hi v87, v2 offset:3840
    ds_read_u16_d16_hi v88, v2 offset:6144
    ds_read_u16_d16_hi v89, v2 offset:6400
    ds_read_u16_d16_hi v90, v2 offset:6656
    ds_read_u16_d16_hi v91, v2 offset:6912
    ds_read_u16_d16_hi v92, v2 offset:9216
    ds_read_u16_d16_hi v93, v2 offset:9472
    ds_read_u16_d16_hi v94, v2 offset:9728
    ds_read_u16_d16_hi v95, v2 offset:9984
    s_waitcnt lgkmcnt(12)
    v_mul_f32 v80, v80, v64
    v_mul_f32 v81, v81, v65
    v_mul_f32 v82, v82, v66
    v_mul_f32 v83, v83, v67
    s_waitcnt lgkmcnt(8)
    v_mul_f32 v84, v84, v68
    v_mul_f32 v85, v85, v69
    v_mfma_f32_32x32x16_bf16 v[96:111], v[52:55], v[28:31], v[96:111]
    ds_read_b128 v[28:31], v1 offset:28672
    v_mul_f32 v86, v86, v70
    v_mul_f32 v87, v87, v71
    v_cvt_pk_bf16_f32 v80, v80, v81
    v_cvt_pk_bf16_f32 v81, v82, v83
    v_cvt_pk_bf16_f32 v82, v84, v85
    v_cvt_pk_bf16_f32 v83, v86, v87
    s_nop 1
    v_mfma_f32_32x32x16_bf16 v[160:175], v[12:15], v[80:83], v[160:175]
    ds_read_u16_d16_hi v80, v2 offset:1024
    ds_read_u16_d16_hi v81, v2 offset:1280
    ds_read_u16_d16_hi v82, v2 offset:1536
    ds_read_u16_d16_hi v83, v2 offset:1792
    ds_read_u16_d16_hi v84, v2 offset:4096
    ds_read_u16_d16_hi v85, v2 offset:4352
    ds_read_u16_d16_hi v86, v2 offset:4608
    ds_read_u16_d16_hi v87, v2 offset:4864
    s_waitcnt lgkmcnt(13)
    v_mul_f32 v88, v88, v72
    v_mul_f32 v89, v89, v73
    v_mul_f32 v90, v90, v74
    v_mul_f32 v91, v91, v75
    s_waitcnt lgkmcnt(9)
    v_mul_f32 v92, v92, v76
    v_mul_f32 v93, v93, v77
    v_mul_f32 v94, v94, v78
    v_mul_f32 v95, v95, v79
    v_cvt_pk_bf16_f32 v88, v88, v89
    v_cvt_pk_bf16_f32 v89, v90, v91
    v_cvt_pk_bf16_f32 v90, v92, v93
    v_cvt_pk_bf16_f32 v91, v94, v95
    s_nop 1
    v_mfma_f32_32x32x16_bf16 v[160:175], v[16:19], v[88:91], v[160:175]
    ds_read_u16_d16_hi v88, v2 offset:7168
    ds_read_u16_d16_hi v89, v2 offset:7424
    ds_read_u16_d16_hi v90, v2 offset:7680
    ds_read_u16_d16_hi v91, v2 offset:7936
    ds_read_u16_d16_hi v92, v2 offset:10240
    ds_read_u16_d16_hi v93, v2 offset:10496
    ds_read_u16_d16_hi v94, v2 offset:10752
    ds_read_u16_d16_hi v95, v2 offset:11008
    s_waitcnt lgkmcnt(12)
    v_mul_f32 v80, v80, v64
    v_mul_f32 v81, v81, v65
    v_mul_f32 v82, v82, v66
    v_mfma_f32_32x32x16_bf16 v[96:111], v[56:59], v[20:23], v[96:111]
    ds_read_b128 v[20:23], v1 offset:16384
    v_mul_f32 v83, v83, v67
    s_waitcnt lgkmcnt(9)
    v_mul_f32 v84, v84, v68
    v_mul_f32 v85, v85, v69
    v_mul_f32 v86, v86, v70
    v_mul_f32 v87, v87, v71
    v_cvt_pk_bf16_f32 v80, v80, v81
    v_cvt_pk_bf16_f32 v81, v82, v83
    v_cvt_pk_bf16_f32 v82, v84, v85
    v_cvt_pk_bf16_f32 v83, v86, v87
    s_nop 1
    v_mfma_f32_32x32x16_bf16 v[192:207], v[12:15], v[80:83], v[192:207]
    ds_read_u16_d16_hi v80, v2 offset:2048
    ds_read_u16_d16_hi v81, v2 offset:2304
    ds_read_u16_d16_hi v82, v2 offset:2560
    ds_read_u16_d16_hi v83, v2 offset:2816
    ds_read_u16_d16_hi v84, v2 offset:5120
    ds_read_u16_d16_hi v85, v2 offset:5376
    ds_read_u16_d16_hi v86, v2 offset:5632
    ds_read_u16_d16_hi v87, v2 offset:5888
    s_waitcnt lgkmcnt(13)
    v_mul_f32 v88, v88, v72
    v_mul_f32 v89, v89, v73
    v_mul_f32 v90, v90, v74
    v_mul_f32 v91, v91, v75
    s_waitcnt lgkmcnt(9)
    v_mul_f32 v92, v92, v76
    v_mul_f32 v93, v93, v77
    v_mul_f32 v94, v94, v78
    v_mul_f32 v95, v95, v79
    v_cvt_pk_bf16_f32 v88, v88, v89
    v_cvt_pk_bf16_f32 v89, v90, v91
    v_cvt_pk_bf16_f32 v90, v92, v93
    v_cvt_pk_bf16_f32 v91, v94, v95
    s_nop 1
    v_mfma_f32_32x32x16_bf16 v[192:207], v[16:19], v[88:91], v[192:207]
    ds_read_u16_d16_hi v88, v2 offset:8192
    ds_read_u16_d16_hi v89, v2 offset:8448
    ds_read_u16_d16_hi v90, v2 offset:8704
    ds_read_u16_d16_hi v91, v2 offset:8960
    ds_read_u16_d16_hi v92, v2 offset:11264
    ds_read_u16_d16_hi v93, v2 offset:11520
    ds_read_u16_d16_hi v94, v2 offset:11776
    ds_read_u16_d16_hi v95, v2 offset:12032
    v_mfma_f32_32x32x16_bf16 v[96:111], v[60:63], v[24:27], v[96:111]
    ds_read_b128 v[24:27], v1 offset:17408
    s_waitcnt lgkmcnt(13)
    v_mul_f32 v80, v80, v64
    v_mul_f32 v81, v81, v65
    v_mul_f32 v82, v82, v66
    v_mul_f32 v83, v83, v67
    s_waitcnt lgkmcnt(9)
    v_mul_f32 v84, v84, v68
    v_mul_f32 v85, v85, v69
    v_mul_f32 v86, v86, v70
    v_mul_f32 v87, v87, v71
    v_cvt_pk_bf16_f32 v80, v80, v81
    v_cvt_pk_bf16_f32 v81, v82, v83
    v_cvt_pk_bf16_f32 v82, v84, v85
    v_cvt_pk_bf16_f32 v83, v86, v87
    s_nop 1
    v_mfma_f32_32x32x16_bf16 v[224:239], v[12:15], v[80:83], v[224:239]
    s_waitcnt lgkmcnt(5)
    v_mul_f32 v88, v88, v72
    v_mul_f32 v89, v89, v73
    v_mul_f32 v90, v90, v74
    v_mul_f32 v91, v91, v75
    s_waitcnt lgkmcnt(1)
    v_mul_f32 v92, v92, v76
    v_mul_f32 v93, v93, v77
    v_mul_f32 v94, v94, v78
    v_mul_f32 v95, v95, v79
    v_cvt_pk_bf16_f32 v88, v88, v89
    v_cvt_pk_bf16_f32 v89, v90, v91
    v_cvt_pk_bf16_f32 v90, v92, v93
    v_cvt_pk_bf16_f32 v91, v94, v95
    s_nop 1
    v_mfma_f32_32x32x16_bf16 v[224:239], v[16:19], v[88:91], v[224:239]
    v_mfma_f32_32x32x16_bf16 v[80:95], v[8:11], v[28:31], 0
    ds_read_b128 v[28:31], v1 offset:18432
    v_mfma_f32_32x32x16_bf16 v[64:79], v[48:51], v[20:23], 0
    ds_read_b128 v[20:23], v1 offset:19456
    v_mul_f32 v96, v96, v112
    v_mul_f32 v97, v97, v113
    v_mul_f32 v98, v98, v114
    v_mul_f32 v99, v99, v115
    v_mul_f32 v100, v100, v116
    v_mul_f32 v101, v101, v117
    v_mul_f32 v102, v102, v118
    v_mul_f32 v103, v103, v119
    v_mul_f32 v104, v104, v120
    v_mul_f32 v105, v105, v121
    v_mul_f32 v106, v106, v122
    v_mul_f32 v107, v107, v123
    v_mul_f32 v108, v108, v124
    v_mul_f32 v109, v109, v125
    v_mul_f32 v110, v110, v126
    v_mul_f32 v111, v111, v127
    ds_read_u16_d16_hi v112, v2 offset:2
    ds_read_u16_d16_hi v113, v2 offset:258
    ds_read_u16_d16_hi v114, v2 offset:514
    ds_read_u16_d16_hi v115, v2 offset:770
    ds_read_u16_d16_hi v116, v2 offset:3074
    ds_read_u16_d16_hi v117, v2 offset:3330
    ds_read_u16_d16_hi v118, v2 offset:3586
    ds_read_u16_d16_hi v119, v2 offset:3842
    ds_read_u16_d16_hi v120, v2 offset:6146
    ds_read_u16_d16_hi v121, v2 offset:6402
    ds_read_u16_d16_hi v122, v2 offset:6658
    ds_read_u16_d16_hi v123, v2 offset:6914
    ds_read_u16_d16_hi v124, v2 offset:9218
    ds_read_u16_d16_hi v125, v2 offset:9474
    ds_read_u16_d16_hi v126, v2 offset:9730
    ds_read_u16_d16_hi v127, v2 offset:9986
    s_waitcnt lgkmcnt(12)
    v_mul_f32 v112, v112, v96
    v_mul_f32 v113, v113, v97
    v_mul_f32 v114, v114, v98
    v_mul_f32 v115, v115, v99
    s_waitcnt lgkmcnt(8)
    v_mul_f32 v116, v116, v100
    v_mul_f32 v117, v117, v101
    v_mul_f32 v118, v118, v102
    v_mfma_f32_32x32x16_bf16 v[64:79], v[52:55], v[24:27], v[64:79]
    ds_read_b128 v[24:27], v1 offset:29696
    v_mul_f32 v119, v119, v103
    v_cvt_pk_bf16_f32 v112, v112, v113
    v_cvt_pk_bf16_f32 v113, v114, v115
    v_cvt_pk_bf16_f32 v114, v116, v117
    v_cvt_pk_bf16_f32 v115, v118, v119
    s_nop 1
    v_mfma_f32_32x32x16_bf16 v[176:191], v[12:15], v[112:115], v[176:191]
    ds_read_u16_d16_hi v112, v2 offset:1026
    ds_read_u16_d16_hi v113, v2 offset:1282
    ds_read_u16_d16_hi v114, v2 offset:1538
    ds_read_u16_d16_hi v115, v2 offset:1794
    ds_read_u16_d16_hi v116, v2 offset:4098
    ds_read_u16_d16_hi v117, v2 offset:4354
    ds_read_u16_d16_hi v118, v2 offset:4610
    ds_read_u16_d16_hi v119, v2 offset:4866
    s_waitcnt lgkmcnt(13)
    v_mul_f32 v120, v120, v104
    v_mul_f32 v121, v121, v105
    v_mul_f32 v122, v122, v106
    v_mul_f32 v123, v123, v107
    s_waitcnt lgkmcnt(9)
    v_mul_f32 v124, v124, v108
    v_mul_f32 v125, v125, v109
    v_mul_f32 v126, v126, v110
    v_mul_f32 v127, v127, v111
    v_cvt_pk_bf16_f32 v120, v120, v121
    v_cvt_pk_bf16_f32 v121, v122, v123
    v_cvt_pk_bf16_f32 v122, v124, v125
    v_cvt_pk_bf16_f32 v123, v126, v127
    s_nop 1
    v_mfma_f32_32x32x16_bf16 v[176:191], v[16:19], v[120:123], v[176:191]
    ds_read_u16_d16_hi v120, v2 offset:7170
    ds_read_u16_d16_hi v121, v2 offset:7426
    ds_read_u16_d16_hi v122, v2 offset:7682
    ds_read_u16_d16_hi v123, v2 offset:7938
    ds_read_u16_d16_hi v124, v2 offset:10242
    ds_read_u16_d16_hi v125, v2 offset:10498
    ds_read_u16_d16_hi v126, v2 offset:10754
    ds_read_u16_d16_hi v127, v2 offset:11010
    s_waitcnt lgkmcnt(12)
    v_mul_f32 v112, v112, v96
    v_mul_f32 v113, v113, v97
    v_mul_f32 v114, v114, v98
    v_mul_f32 v115, v115, v99
    v_mfma_f32_32x32x16_bf16 v[64:79], v[56:59], v[28:31], v[64:79]
    ds_read_b128 v[28:31], v1 offset:20480
    s_waitcnt lgkmcnt(9)
    v_mul_f32 v116, v116, v100
    v_mul_f32 v117, v117, v101
    v_mul_f32 v118, v118, v102
    v_mul_f32 v119, v119, v103
    v_cvt_pk_bf16_f32 v112, v112, v113
    v_cvt_pk_bf16_f32 v113, v114, v115
    v_cvt_pk_bf16_f32 v114, v116, v117
    v_cvt_pk_bf16_f32 v115, v118, v119
    s_nop 1
    v_mfma_f32_32x32x16_bf16 v[208:223], v[12:15], v[112:115], v[208:223]
    ds_read_u16_d16_hi v112, v2 offset:2050
    ds_read_u16_d16_hi v113, v2 offset:2306
    ds_read_u16_d16_hi v114, v2 offset:2562
    ds_read_u16_d16_hi v115, v2 offset:2818
    ds_read_u16_d16_hi v116, v2 offset:5122
    ds_read_u16_d16_hi v117, v2 offset:5378
    ds_read_u16_d16_hi v118, v2 offset:5634
    ds_read_u16_d16_hi v119, v2 offset:5890
    s_waitcnt lgkmcnt(13)
    v_mul_f32 v120, v120, v104
    v_mul_f32 v121, v121, v105
    v_mul_f32 v122, v122, v106
    v_mul_f32 v123, v123, v107
    s_waitcnt lgkmcnt(9)
    v_mul_f32 v124, v124, v108
    v_mul_f32 v125, v125, v109
    v_mul_f32 v126, v126, v110
    v_mul_f32 v127, v127, v111
    v_cvt_pk_bf16_f32 v120, v120, v121
    v_cvt_pk_bf16_f32 v121, v122, v123
    v_cvt_pk_bf16_f32 v122, v124, v125
    v_cvt_pk_bf16_f32 v123, v126, v127
    s_nop 1
    v_mfma_f32_32x32x16_bf16 v[208:223], v[16:19], v[120:123], v[208:223]
    ds_read_u16_d16_hi v120, v2 offset:8194
    ds_read_u16_d16_hi v121, v2 offset:8450
    ds_read_u16_d16_hi v122, v2 offset:8706
    ds_read_u16_d16_hi v123, v2 offset:8962
    ds_read_u16_d16_hi v124, v2 offset:11266
    ds_read_u16_d16_hi v125, v2 offset:11522
    ds_read_u16_d16_hi v126, v2 offset:11778
    ds_read_u16_d16_hi v127, v2 offset:12034
    s_waitcnt lgkmcnt(12)
    v_mul_f32 v112, v112, v96
    v_mfma_f32_32x32x16_bf16 v[64:79], v[60:63], v[20:23], v[64:79]
    ds_read_b128 v[20:23], v1 offset:21504
    v_mul_f32 v113, v113, v97
    v_mul_f32 v114, v114, v98
    v_mul_f32 v115, v115, v99
    s_waitcnt lgkmcnt(9)
    v_mul_f32 v116, v116, v100
    v_mul_f32 v117, v117, v101
    v_mul_f32 v118, v118, v102
    v_mul_f32 v119, v119, v103
    v_cvt_pk_bf16_f32 v112, v112, v113
    v_cvt_pk_bf16_f32 v113, v114, v115
    v_cvt_pk_bf16_f32 v114, v116, v117
    v_cvt_pk_bf16_f32 v115, v118, v119
    s_nop 1
    v_mfma_f32_32x32x16_bf16 v[240:255], v[12:15], v[112:115], v[240:255]
    s_waitcnt lgkmcnt(5)
    v_mul_f32 v120, v120, v104
    v_mul_f32 v121, v121, v105
    v_mul_f32 v122, v122, v106
    v_mul_f32 v123, v123, v107
    s_waitcnt lgkmcnt(1)
    v_mul_f32 v124, v124, v108
    v_mul_f32 v125, v125, v109
    v_mul_f32 v126, v126, v110
    v_mul_f32 v127, v127, v111
    v_cvt_pk_bf16_f32 v120, v120, v121
    v_cvt_pk_bf16_f32 v121, v122, v123
    v_cvt_pk_bf16_f32 v122, v124, v125
    v_cvt_pk_bf16_f32 v123, v126, v127
    s_nop 1
    v_mfma_f32_32x32x16_bf16 v[240:255], v[16:19], v[120:123], v[240:255]
    s_cmp_lg_u32 s77, 0
    s_nop 10
    s_cbranch_scc1 M_nv21
    ds_read_b32 v112, v5 offset:524
    ds_read_b32 v113, v5 offset:652
    ds_read_b32 v114, v5 offset:780
    ds_read_b32 v115, v5 offset:908
    s_waitcnt lgkmcnt(3)
    v_and_or_b32 v112, v1, s63, v112
    s_waitcnt lgkmcnt(2)
    v_and_or_b32 v113, v1, s63, v113
    s_waitcnt lgkmcnt(1)
    v_and_or_b32 v114, v1, s63, v114
    s_waitcnt lgkmcnt(0)
    v_and_or_b32 v115, v1, s63, v115
    s_add_u32 m0, s51, 0
    s_nop 0
    buffer_load_dwordx4 v112, s[28:31], s64 offen lds
    s_add_u32 m0, s51, 1024
    s_nop 0
    buffer_load_dwordx4 v112, s[28:31], s65 offen lds
    s_add_u32 m0, s51, 2048
    s_nop 0
    buffer_load_dwordx4 v112, s[28:31], s66 offen lds
    s_add_u32 m0, s51, 3072
    s_nop 0
    buffer_load_dwordx4 v113, s[28:31], s64 offen lds
    s_add_u32 m0, s51, 4096
    s_nop 0
    buffer_load_dwordx4 v113, s[28:31], s65 offen lds
    s_add_u32 m0, s51, 5120
    s_nop 0
    buffer_load_dwordx4 v113, s[28:31], s66 offen lds
    s_add_u32 m0, s51, 6144
    s_nop 0
    buffer_load_dwordx4 v114, s[28:31], s64 offen lds
    s_add_u32 m0, s51, 7168
    s_nop 0
    buffer_load_dwordx4 v114, s[28:31], s65 offen lds
    s_add_u32 m0, s51, 8192
    s_nop 0
    buffer_load_dwordx4 v114, s[28:31], s66 offen lds
    s_add_u32 m0, s51, 9216
    s_nop 0
    buffer_load_dwordx4 v115, s[28:31], s64 offen lds
    s_add_u32 m0, s51, 10240
    s_nop 0
    buffer_load_dwordx4 v115, s[28:31], s65 offen lds
    s_add_u32 m0, s51, 11264
    s_nop 0
    buffer_load_dwordx4 v115, s[28:31], s66 offen lds
    s_branch M_nj21
M_nv21:
    s_cmp_eq_u32 s76, 0
    s_cbranch_scc1 M_nj21
    v_lshrrev_b32 v112, 7, v1
    v_and_b32 v113, 1, v112
    v_lshrrev_b32 v112, 1, v112
    v_lshl_add_u32 v112, v113, 2, v112
    v_lshlrev_b32 v112, 9, v112
    v_and_or_b32 v112, v1, s63, v112
    s_add_u32 m0, s51, 1024
    s_add_u32 s53, s40, 256
    buffer_load_dwordx4 v112, s[4:7], s53 offen  lds
    s_add_u32 m0, s51, 2048
    s_add_u32 s53, s40, 384
    buffer_load_dwordx4 v112, s[4:7], s53 offen  lds
    s_add_u32 m0, s51, 4096
    s_add_u32 s53, s41, 256
    buffer_load_dwordx4 v112, s[4:7], s53 offen  lds
    s_add_u32 m0, s51, 5120
    s_add_u32 s53, s41, 384
    buffer_load_dwordx4 v112, s[4:7], s53 offen  lds
    s_add_u32 m0, s51, 7168
    s_add_u32 s53, s42, 256
    buffer_load_dwordx4 v112, s[4:7], s53 offen  lds
    s_add_u32 m0, s51, 8192
    s_add_u32 s53, s42, 384
    buffer_load_dwordx4 v112, s[4:7], s53 offen  lds
    s_add_u32 m0, s51, 10240
    s_add_u32 s53, s43, 256
    buffer_load_dwordx4 v112, s[4:7], s53 offen  lds
    s_add_u32 m0, s51, 11264
    s_add_u32 s53, s43, 384
    buffer_load_dwordx4 v112, s[4:7], s53 offen  lds
M_nj21:
    v_mfma_f32_32x32x16_bf16 v[112:127], v[8:11], v[24:27], 0
    ds_read_b128 v[24:27], v1 offset:22528
    v_mfma_f32_32x32x16_bf16 v[96:111], v[48:51], v[28:31], 0
    ds_read_b128 v[28:31], v1 offset:23552
    v_mul_f32 v64, v64, v80
    v_mul_f32 v65, v65, v81
    v_mul_f32 v66, v66, v82
    v_mul_f32 v67, v67, v83
    v_mul_f32 v68, v68, v84
    v_mul_f32 v69, v69, v85
    v_mul_f32 v70, v70, v86
    v_mul_f32 v71, v71, v87
    v_mul_f32 v72, v72, v88
    v_mul_f32 v73, v73, v89
    v_mul_f32 v74, v74, v90
    v_mul_f32 v75, v75, v91
    s_waitcnt lgkmcnt(2)
    v_mfma_f32_32x32x16_bf16 v[96:111], v[52:55], v[20:23], v[96:111]
    v_mul_f32 v76, v76, v92
    v_mul_f32 v77, v77, v93
    v_mul_f32 v78, v78, v94
    v_mul_f32 v79, v79, v95
    ds_read_b64 v[80:81], v0 offset:2080
    ds_read_b64 v[88:89], v0 offset:2088
    ds_read_b64 v[82:83], v0 offset:2192
    ds_read_b64 v[90:91], v0 offset:2200
    ds_read_b64 v[84:85], v0 offset:2304
    ds_read_b64 v[92:93], v0 offset:2312
    ds_read_b64 v[86:87], v0 offset:2416
    ds_read_b64 v[94:95], v0 offset:2424
    v_cvt_pk_bf16_f32 v64, v64, v65
    v_cvt_pk_bf16_f32 v65, v66, v67
    v_cvt_pk_bf16_f32 v66, v68, v69
    v_cvt_pk_bf16_f32 v67, v70, v71
    v_cvt_pk_bf16_f32 v68, v72, v73
    v_cvt_pk_bf16_f32 v69, v74, v75
    v_cvt_pk_bf16_f32 v70, v76, v77
    s_waitcnt lgkmcnt(9)
    v_mfma_f32_32x32x16_bf16 v[96:111], v[56:59], v[24:27], v[96:111]
    v_cvt_pk_bf16_f32 v71, v78, v79
    v_pk_lshrrev_b16 v72, 14, v12 op_sel_hi:[0,1]
    v_pk_lshrrev_b16 v73, 14, v13 op_sel_hi:[0,1]
    v_pk_lshrrev_b16 v74, 14, v14 op_sel_hi:[0,1]
    v_pk_lshrrev_b16 v75, 14, v15 op_sel_hi:[0,1]
    v_pk_lshrrev_b16 v76, 14, v16 op_sel_hi:[0,1]
    v_pk_lshrrev_b16 v77, 14, v17 op_sel_hi:[0,1]
    v_pk_lshrrev_b16 v78, 14, v18 op_sel_hi:[0,1]
    v_pk_lshrrev_b16 v79, 14, v19 op_sel_hi:[0,1]
    s_waitcnt lgkmcnt(0)
    v_pk_mul_lo_u16 v80, v72, v80
    v_pk_mul_lo_u16 v81, v73, v81
    v_pk_mul_lo_u16 v82, v74, v82
    v_mfma_f32_32x32x16_bf16 v[96:111], v[60:63], v[28:31], v[96:111]
    v_pk_mul_lo_u16 v83, v75, v83
    v_pk_mul_lo_u16 v84, v76, v84
    v_pk_mul_lo_u16 v85, v77, v85
    v_pk_mul_lo_u16 v86, v78, v86
    v_pk_mul_lo_u16 v87, v79, v87
    v_pk_mul_lo_u16 v88, v72, v88
    v_pk_mul_lo_u16 v89, v73, v89
    v_pk_mul_lo_u16 v90, v74, v90
    v_pk_mul_lo_u16 v91, v75, v91
    v_pk_mul_lo_u16 v92, v76, v92
    v_pk_mul_lo_u16 v93, v77, v93
    v_pk_mul_lo_u16 v94, v78, v94
    v_pk_mul_lo_u16 v95, v79, v95
    v_mfma_f32_32x32x16_bf16 v[160:175], v[80:83], v[64:67], v[160:175]
    v_mul_f32 v96, v96, v112
    v_mul_f32 v97, v97, v113
    v_mul_f32 v98, v98, v114
    v_mul_f32 v99, v99, v115
    v_mul_f32 v100, v100, v116
    v_mul_f32 v101, v101, v117
    v_mfma_f32_32x32x16_bf16 v[160:175], v[84:87], v[68:71], v[160:175]
    v_mul_f32 v102, v102, v118
    v_mul_f32 v103, v103, v119
    v_mul_f32 v104, v104, v120
    v_mul_f32 v105, v105, v121
    v_mul_f32 v106, v106, v122
    v_mul_f32 v107, v107, v123
    v_mfma_f32_32x32x16_bf16 v[192:207], v[88:91], v[64:67], v[192:207]
    v_mul_f32 v108, v108, v124
    v_mul_f32 v109, v109, v125
    v_mul_f32 v110, v110, v126
    v_mul_f32 v111, v111, v127
    ds_read_b64 v[112:113], v0 offset:2096
    ds_read_b64 v[114:115], v0 offset:2208
    ds_read_b64 v[116:117], v0 offset:2320
    ds_read_b64 v[118:119], v0 offset:2432
    v_cvt_pk_bf16_f32 v96, v96, v97
    v_mfma_f32_32x32x16_bf16 v[192:207], v[92:95], v[68:71], v[192:207]
    v_cvt_pk_bf16_f32 v97, v98, v99
    v_cvt_pk_bf16_f32 v98, v100, v101
    v_cvt_pk_bf16_f32 v99, v102, v103
    v_cvt_pk_bf16_f32 v100, v104, v105
    v_cvt_pk_bf16_f32 v101, v106, v107
    v_cvt_pk_bf16_f32 v102, v108, v109
    v_cvt_pk_bf16_f32 v103, v110, v111
    s_waitcnt lgkmcnt(0)
    v_pk_mul_lo_u16 v112, v72, v112
    v_pk_mul_lo_u16 v113, v73, v113
    v_pk_mul_lo_u16 v114, v74, v114
    v_pk_mul_lo_u16 v115, v75, v115
    v_pk_mul_lo_u16 v116, v76, v116
    v_pk_mul_lo_u16 v117, v77, v117
    v_pk_mul_lo_u16 v118, v78, v118
    v_pk_mul_lo_u16 v119, v79, v119
    v_mfma_f32_32x32x16_bf16 v[176:191], v[80:83], v[96:99], v[176:191]
    ds_read_b128 v[104:107], v3 offset:512
    ds_read_b128 v[72:75], v7
    ds_read_b128 v[76:79], v7 offset:16
    ds_read_b64 v[12:13], v4 offset:2496
    ds_read_b64 v[14:15], v4 offset:2608
    ds_read_b64 v[16:17], v4 offset:2720
    ds_read_b64 v[18:19], v4 offset:2832
    ds_read_b128 v[20:23], v1 offset:24576
    ds_read_b128 v[24:27], v1 offset:0
    ds_read_b128 v[28:31], v1 offset:1024
    s_waitcnt lgkmcnt(7)
    v_mul_f32 v72, v104, v72
    v_mul_f32 v73, v104, v73
    v_mul_f32 v74, v104, v74
    v_mul_f32 v75, v104, v75
    v_mul_f32 v76, v104, v76
    v_mfma_f32_32x32x16_bf16 v[176:191], v[84:87], v[100:103], v[176:191]
    v_mul_f32 v77, v104, v77
    v_mul_f32 v78, v104, v78
    v_mul_f32 v79, v104, v79
    v_cvt_pk_bf16_f32 v72, 0, v72
    v_cvt_pk_bf16_f32 v73, 0, v73
    v_cvt_pk_bf16_f32 v74, 0, v74
    v_cvt_pk_bf16_f32 v75, 0, v75
    v_mfma_f32_32x32x16_bf16 v[208:223], v[88:91], v[96:99], v[208:223]
    v_cvt_pk_bf16_f32 v76, 0, v76
    v_cvt_pk_bf16_f32 v77, 0, v77
    v_cvt_pk_bf16_f32 v78, 0, v78
    v_cvt_pk_bf16_f32 v79, 0, v79
    v_mul_f32 v72, s61, v72
    v_mul_f32 v73, s61, v73
    v_mfma_f32_32x32x16_bf16 v[208:223], v[92:95], v[100:103], v[208:223]
    v_mul_f32 v74, s61, v74
    v_mul_f32 v75, s61, v75
    v_mul_f32 v76, s61, v76
    v_mul_f32 v77, s61, v77
    v_mul_f32 v78, s61, v78
    v_mul_f32 v79, s61, v79
    v_sin_f32 v72, v72
    v_mfma_f32_32x32x16_bf16 v[224:239], v[112:115], v[64:67], v[224:239]
    v_sin_f32 v73, v73
    v_sin_f32 v74, v74
    v_sin_f32 v75, v75
    v_sin_f32 v76, v76
    v_sin_f32 v77, v77
    v_sin_f32 v78, v78
    v_sin_f32 v79, v79
    v_mfma_f32_32x32x16_bf16 v[240:255], v[112:115], v[96:99], v[240:255]
    v_mul_f32 v72, v72, v105
    v_mul_f32 v73, v73, v105
    v_mul_f32 v74, v74, v105
    v_mul_f32 v75, v75, v105
    v_mul_f32 v76, v76, v105
    v_mul_f32 v77, v77, v105
    v_mfma_f32_32x32x16_bf16 v[224:239], v[116:119], v[68:71], v[224:239]
    v_mul_f32 v78, v78, v105
    v_mul_f32 v79, v79, v105
    v_cvt_pk_bf16_f32 v8, v72, v73
    v_cvt_pk_bf16_f32 v9, v74, v75
    v_cvt_pk_bf16_f32 v10, v76, v77
    v_cvt_pk_bf16_f32 v11, v78, v79
    s_waitcnt lgkmcnt(3)
    v_pk_lshlrev_b16 v12, v6, v12
    v_mfma_f32_32x32x16_bf16 v[240:255], v[116:119], v[100:103], v[240:255]
    v_pk_lshlrev_b16 v13, v6, v13
    v_pk_lshlrev_b16 v14, v6, v14
    v_pk_lshlrev_b16 v15, v6, v15
    v_pk_lshlrev_b16 v16, v6, v16
    v_pk_lshlrev_b16 v17, v6, v17
    v_pk_lshlrev_b16 v18, v6, v18
    v_pk_lshlrev_b16 v19, v6, v19
    v_add_u32 v3, 512, v3
    v_add_u32 v4, 448, v4
    v_add_u32 v0, 448, v0
    v_add_u32 v5, 512, v5
    s_waitcnt lgkmcnt(0)
    s_add_u32 s49, s49, 1
    s_cmp_lt_u32 s49, s48
    s_cbranch_scc1 M_batch
M_wend:
    s_cmp_lg_u32 s76, 0
    s_cbranch_scc1 M_epi
M_slow:
    v_lshrrev_b32 v8, 4, v1
    v_add_u32 v86, 64, v8
    v_bfrev_b32 v14, 2
    s_mov_b32 s63, 0x02020000
    s_mov_b32 s64, 0x322bcc77
    v_mov_b32 v103, 0x01000c0c
    v_and_b32 v12, 3, v8
    v_lshlrev_b32 v12, 3, v12
    v_lshrrev_b32_e64 v13, v12, s18
    v_bfe_u32 v15, v13, 1, 7
    v_lshlrev_b32 v15, 17, v15
    v_and_b32 v13, 1, v13
    v_or_b32 v95, v13, v15
    s_bfe_u32 s60, s18, 0x70019
    s_lshl_b32 s60, s60, 17
    s_bfe_u32 s27, s18, 0x10018
    s_or_b32 s60, s60, s27
    s_lshl_b32 s53, s2, 7
    s_cmp_eq_u32 s14, 2
    s_cbranch_scc1 M_sovf
    s_cmp_ge_u32 s15, 63
    s_cbranch_scc1 M_sph1
    s_lshl_b32 s62, s15, 2
    v_lshrrev_b32 v12, 5, v8
    v_and_b32 v13, 31, v8
    v_add_u32 v15, s62, v12
    v_cmp_gt_u32 vcc, 250, v15
    s_mov_b64 s[54:55], vcc
    v_lshlrev_b32 v15, 15, v15
    v_cndmask_b32 v15, v14, v15, s[54:55]
    s_cmp_lg_u32 s14, 0
    s_nop 0
    s_cbranch_scc1 M_s222
    v_lshl_add_u32 v16, v13, 2, v15
    buffer_load_dword v88, v16, s[36:39], s53 offen sc1
    s_waitcnt vmcnt(0)
    v_xor_b32 v88, v95, v88
    s_mov_b32 s27, 0xc8000000
    v_cmp_gt_u32 vcc, s27, v88
    s_and_b64 s[54:55], s[54:55], vcc
    s_nop 3
    s_branch M_s322
M_s222:
    buffer_load_dword v88, v15, s[36:39], s53 offen offset:124 sc1
    s_waitcnt vmcnt(0)
    v_xor_b32 v88, s60, v88
    v_bfe_u32 v88, v88, 1, 23
    v_cmp_gt_u32 vcc, v88, v13
    s_and_b64 s[54:55], s[54:55], vcc
    v_lshl_add_u32 v16, v13, 2, v15
    v_cndmask_b32 v16, v14, v16, s[54:55]
    s_add_u32 s27, s53, 0x900000
    buffer_load_dword v88, v16, s[36:39], s27 offen sc1
    s_waitcnt vmcnt(0)
M_s322:
    v_lshrrev_b32 v16, 24, v88
    v_subrev_u32 v17, s59, v16
    v_cmp_gt_u32 vcc, s45, v17
    s_and_b64 s[54:55], s[54:55], vcc
    v_and_b32 v96, 0x1fffe, v88
    v_lshl_add_u32 v96, v96, 1, v96
    v_and_b32 v96, -4, v96
    v_cndmask_b32 v96, v14, v96, s[54:55]
    buffer_load_dwordx2 v[98:99], v96, s[92:95], 0 offen
    v_mul_u32_u24 v97, 6, v16
    v_and_b32 v97, -4, v97
    v_cndmask_b32 v97, v14, v97, s[54:55]
    s_mul_i32 s27, s2, 1200
    buffer_load_dwordx2 v[100:101], v97, s[92:95], s27 offen
    v_bfe_i32 v102, v88, 1, 1
    v_and_or_b32 v102, v102, s63, v103
    v_bfe_i32 v104, v16, 0, 1
    v_and_or_b32 v104, v104, s63, v103
    v_add_u32 v105, s63, v104
    v_add_u32 v106, s63, v105
    s_waitcnt vmcnt(0)
    v_perm_b32 v107, v101, v100, v104
    v_perm_b32 v108, v101, v100, v105
    v_perm_b32 v109, v101, v100, v106
    v_add_u32 v113, s63, v102
    v_perm_b32 v110, v99, v98, v102
    v_add_u32 v114, s63, v113
    v_perm_b32 v111, v99, v98, v113
    v_perm_b32 v112, v99, v98, v114
    v_sub_f32 v110, v110, v107
    v_sub_f32 v111, v111, v108
    v_sub_f32 v112, v112, v109
    v_cvt_pk_bf16_f32 v89, v110, v111
    v_cvt_pk_bf16_f32 v112, 0, v112
    v_lshlrev_b32 v110, 16, v89
    v_and_b32 v111, s58, v89
    v_mul_f32 v115, v112, v112
    v_mul_f32 v110, v110, v110
    v_mul_f32 v111, v111, v111
    v_cvt_pk_bf16_f32 v115, 0, v115
    v_cvt_pk_bf16_f32 v110, 0, v110
    v_cvt_pk_bf16_f32 v111, 0, v111
    v_add_f32 v110, v110, v111
    v_add_f32 v110, v110, v115
    v_cvt_pk_bf16_f32 v110, 0, v110
    v_add_f32 v110, s64, v110
    v_cvt_pk_bf16_f32 v110, 0, v110
    v_sqrt_f32 v110, v110
    s_nop 0
    v_cvt_pk_bf16_f32 v90, v112, v110
    s_mov_b32 s27, 0x409d0000
    v_cmp_gt_u32 vcc, s27, v90
    s_and_b64 s[8:9], s[54:55], vcc
    v_lshrrev_b32 v12, 5, v86
    v_and_b32 v13, 31, v86
    v_add_u32 v15, s62, v12
    v_cmp_gt_u32 vcc, 250, v15
    s_mov_b64 s[54:55], vcc
    v_lshlrev_b32 v15, 15, v15
    v_cndmask_b32 v15, v14, v15, s[54:55]
    s_cmp_lg_u32 s14, 0
    s_nop 0
    s_cbranch_scc1 M_s223
    v_lshl_add_u32 v16, v13, 2, v15
    buffer_load_dword v92, v16, s[36:39], s53 offen sc1
    s_waitcnt vmcnt(0)
    v_xor_b32 v92, v95, v92
    s_mov_b32 s27, 0xc8000000
    v_cmp_gt_u32 vcc, s27, v92
    s_and_b64 s[54:55], s[54:55], vcc
    s_nop 3
    s_branch M_s323
M_s223:
    buffer_load_dword v92, v15, s[36:39], s53 offen offset:124 sc1
    s_waitcnt vmcnt(0)
    v_xor_b32 v92, s60, v92
    v_bfe_u32 v92, v92, 1, 23
    v_cmp_gt_u32 vcc, v92, v13
    s_and_b64 s[54:55], s[54:55], vcc
    v_lshl_add_u32 v16, v13, 2, v15
    v_cndmask_b32 v16, v14, v16, s[54:55]
    s_add_u32 s27, s53, 0x900000
    buffer_load_dword v92, v16, s[36:39], s27 offen sc1
    s_waitcnt vmcnt(0)
M_s323:
    v_lshrrev_b32 v16, 24, v92
    v_subrev_u32 v17, s59, v16
    v_cmp_gt_u32 vcc, s45, v17
    s_and_b64 s[54:55], s[54:55], vcc
    v_and_b32 v96, 0x1fffe, v92
    v_lshl_add_u32 v96, v96, 1, v96
    v_and_b32 v96, -4, v96
    v_cndmask_b32 v96, v14, v96, s[54:55]
    buffer_load_dwordx2 v[98:99], v96, s[92:95], 0 offen
    v_mul_u32_u24 v97, 6, v16
    v_and_b32 v97, -4, v97
    v_cndmask_b32 v97, v14, v97, s[54:55]
    s_mul_i32 s27, s2, 1200
    buffer_load_dwordx2 v[100:101], v97, s[92:95], s27 offen
    v_bfe_i32 v102, v92, 1, 1
    v_and_or_b32 v102, v102, s63, v103
    v_bfe_i32 v104, v16, 0, 1
    v_and_or_b32 v104, v104, s63, v103
    v_add_u32 v105, s63, v104
    v_add_u32 v106, s63, v105
    s_waitcnt vmcnt(0)
    v_perm_b32 v107, v101, v100, v104
    v_perm_b32 v108, v101, v100, v105
    v_perm_b32 v109, v101, v100, v106
    v_add_u32 v113, s63, v102
    v_perm_b32 v110, v99, v98, v102
    v_add_u32 v114, s63, v113
    v_perm_b32 v111, v99, v98, v113
    v_perm_b32 v112, v99, v98, v114
    v_sub_f32 v110, v110, v107
    v_sub_f32 v111, v111, v108
    v_sub_f32 v112, v112, v109
    v_cvt_pk_bf16_f32 v93, v110, v111
    v_cvt_pk_bf16_f32 v112, 0, v112
    v_lshlrev_b32 v110, 16, v93
    v_and_b32 v111, s58, v93
    v_mul_f32 v115, v112, v112
    v_mul_f32 v110, v110, v110
    v_mul_f32 v111, v111, v111
    v_cvt_pk_bf16_f32 v115, 0, v115
    v_cvt_pk_bf16_f32 v110, 0, v110
    v_cvt_pk_bf16_f32 v111, 0, v111
    v_add_f32 v110, v110, v111
    v_add_f32 v110, v110, v115
    v_cvt_pk_bf16_f32 v110, 0, v110
    v_add_f32 v110, s64, v110
    v_cvt_pk_bf16_f32 v110, 0, v110
    v_sqrt_f32 v110, v110
    s_nop 0
    v_cvt_pk_bf16_f32 v94, v112, v110
    s_mov_b32 s27, 0x409d0000
    v_cmp_gt_u32 vcc, s27, v94
    s_and_b64 s[10:11], s[54:55], vcc
    s_add_u32 s15, s15, 1
    s_nop 2
    s_branch M_sgo
M_sph1:
    s_add_u32 s14, s14, 1
    s_mov_b32 s15, 0
    s_mov_b32 s16, 0
    s_cmp_eq_u32 s14, 1
    s_cbranch_scc1 M_slow
M_sovf:
    s_cmp_ge_u32 s15, 250
    s_cbranch_scc1 M_send
    s_cmp_lg_u32 s16, 0
    s_cbranch_scc1 M_sblk
    s_lshl_b32 s27, s15, 15
    s_add_u32 s27, s27, s53
    v_mov_b32 v12, 0
    buffer_load_dword v13, v12, s[36:39], s27 offen offset:124 sc1
    s_waitcnt vmcnt(0)
    v_readfirstlane_b32 s17, v13
    s_xor_b32 s17, s17, s60
    s_bfe_u32 s17, s17, 0x170001
    s_cmp_gt_u32 s17, 32
    s_cselect_b32 s17, 1, 0
    s_cbranch_scc0 M_sblk0
    s_lshl_b32 s27, s15, 15
    s_add_u32 s27, s27, 32124
    buffer_load_dword v13, v12, s[36:39], s27 offen sc1
    s_waitcnt vmcnt(0)
    v_readfirstlane_b32 s17, v13
    s_min_u32 s17, s17, 3200
M_sblk0:
M_sblk:
    s_cmp_lt_u32 s16, s17
    s_cbranch_scc1 M_sld
    s_add_u32 s15, s15, 1
    s_mov_b32 s16, 0
    s_branch M_sovf
M_sld:
    s_mul_i32 s27, s15, 32768
    s_add_u32 s27, s27, 0x1100000
    v_add_u32 v12, s16, v8
    v_cmp_gt_u32 s[54:55], s17, v12
    v_lshlrev_b32 v12, 3, v12
    s_nop 0
    v_cndmask_b32 v12, v14, v12, s[54:55]
    buffer_load_dwordx2 v[88:89], v12, s[36:39], s27 offen sc1
    s_waitcnt vmcnt(0)
    v_cmp_eq_u32 vcc, s2, v89
    s_and_b64 s[54:55], s[54:55], vcc
    v_lshrrev_b32 v16, 24, v88
    v_subrev_u32 v17, s59, v16
    v_cmp_gt_u32 vcc, s45, v17
    s_and_b64 s[54:55], s[54:55], vcc
    v_and_b32 v96, 0x1fffe, v88
    v_lshl_add_u32 v96, v96, 1, v96
    v_and_b32 v96, -4, v96
    v_cndmask_b32 v96, v14, v96, s[54:55]
    buffer_load_dwordx2 v[98:99], v96, s[92:95], 0 offen
    v_mul_u32_u24 v97, 6, v16
    v_and_b32 v97, -4, v97
    v_cndmask_b32 v97, v14, v97, s[54:55]
    s_mul_i32 s27, s2, 1200
    buffer_load_dwordx2 v[100:101], v97, s[92:95], s27 offen
    v_bfe_i32 v102, v88, 1, 1
    v_and_or_b32 v102, v102, s63, v103
    v_bfe_i32 v104, v16, 0, 1
    v_and_or_b32 v104, v104, s63, v103
    v_add_u32 v105, s63, v104
    v_add_u32 v106, s63, v105
    s_waitcnt vmcnt(0)
    v_perm_b32 v107, v101, v100, v104
    v_perm_b32 v108, v101, v100, v105
    v_perm_b32 v109, v101, v100, v106
    v_add_u32 v113, s63, v102
    v_perm_b32 v110, v99, v98, v102
    v_add_u32 v114, s63, v113
    v_perm_b32 v111, v99, v98, v113
    v_perm_b32 v112, v99, v98, v114
    v_sub_f32 v110, v110, v107
    v_sub_f32 v111, v111, v108
    v_sub_f32 v112, v112, v109
    v_cvt_pk_bf16_f32 v89, v110, v111
    v_cvt_pk_bf16_f32 v112, 0, v112
    v_lshlrev_b32 v110, 16, v89
    v_and_b32 v111, s58, v89
    v_mul_f32 v115, v112, v112
    v_mul_f32 v110, v110, v110
    v_mul_f32 v111, v111, v111
    v_cvt_pk_bf16_f32 v115, 0, v115
    v_cvt_pk_bf16_f32 v110, 0, v110
    v_cvt_pk_bf16_f32 v111, 0, v111
    v_add_f32 v110, v110, v111
    v_add_f32 v110, v110, v115
    v_cvt_pk_bf16_f32 v110, 0, v110
    v_add_f32 v110, s64, v110
    v_cvt_pk_bf16_f32 v110, 0, v110
    v_sqrt_f32 v110, v110
    s_nop 0
    v_cvt_pk_bf16_f32 v90, v112, v110
    s_mov_b32 s27, 0x409d0000
    v_cmp_gt_u32 vcc, s27, v90
    s_and_b64 s[8:9], s[54:55], vcc
    s_mul_i32 s27, s15, 32768
    s_add_u32 s27, s27, 0x1100000
    v_add_u32 v12, s16, v86
    v_cmp_gt_u32 s[54:55], s17, v12
    v_lshlrev_b32 v12, 3, v12
    s_nop 0
    v_cndmask_b32 v12, v14, v12, s[54:55]
    buffer_load_dwordx2 v[92:93], v12, s[36:39], s27 offen sc1
    s_waitcnt vmcnt(0)
    v_cmp_eq_u32 vcc, s2, v93
    s_and_b64 s[54:55], s[54:55], vcc
    v_lshrrev_b32 v16, 24, v92
    v_subrev_u32 v17, s59, v16
    v_cmp_gt_u32 vcc, s45, v17
    s_and_b64 s[54:55], s[54:55], vcc
    v_and_b32 v96, 0x1fffe, v92
    v_lshl_add_u32 v96, v96, 1, v96
    v_and_b32 v96, -4, v96
    v_cndmask_b32 v96, v14, v96, s[54:55]
    buffer_load_dwordx2 v[98:99], v96, s[92:95], 0 offen
    v_mul_u32_u24 v97, 6, v16
    v_and_b32 v97, -4, v97
    v_cndmask_b32 v97, v14, v97, s[54:55]
    s_mul_i32 s27, s2, 1200
    buffer_load_dwordx2 v[100:101], v97, s[92:95], s27 offen
    v_bfe_i32 v102, v92, 1, 1
    v_and_or_b32 v102, v102, s63, v103
    v_bfe_i32 v104, v16, 0, 1
    v_and_or_b32 v104, v104, s63, v103
    v_add_u32 v105, s63, v104
    v_add_u32 v106, s63, v105
    s_waitcnt vmcnt(0)
    v_perm_b32 v107, v101, v100, v104
    v_perm_b32 v108, v101, v100, v105
    v_perm_b32 v109, v101, v100, v106
    v_add_u32 v113, s63, v102
    v_perm_b32 v110, v99, v98, v102
    v_add_u32 v114, s63, v113
    v_perm_b32 v111, v99, v98, v113
    v_perm_b32 v112, v99, v98, v114
    v_sub_f32 v110, v110, v107
    v_sub_f32 v111, v111, v108
    v_sub_f32 v112, v112, v109
    v_cvt_pk_bf16_f32 v93, v110, v111
    v_cvt_pk_bf16_f32 v112, 0, v112
    v_lshlrev_b32 v110, 16, v93
    v_and_b32 v111, s58, v93
    v_mul_f32 v115, v112, v112
    v_mul_f32 v110, v110, v110
    v_mul_f32 v111, v111, v111
    v_cvt_pk_bf16_f32 v115, 0, v115
    v_cvt_pk_bf16_f32 v110, 0, v110
    v_cvt_pk_bf16_f32 v111, 0, v111
    v_add_f32 v110, v110, v111
    v_add_f32 v110, v110, v115
    v_cvt_pk_bf16_f32 v110, 0, v110
    v_add_f32 v110, s64, v110
    v_cvt_pk_bf16_f32 v110, 0, v110
    v_sqrt_f32 v110, v110
    s_nop 0
    v_cvt_pk_bf16_f32 v94, v112, v110
    s_mov_b32 s27, 0x409d0000
    v_cmp_gt_u32 vcc, s27, v94
    s_and_b64 s[10:11], s[54:55], vcc
    s_add_u32 s16, s16, 128
    s_nop 2
M_sgo:
    s_or_b64 s[54:55], s[8:9], s[10:11]
    s_cmp_eq_u64 s[54:55], 0
    s_cbranch_scc1 M_slow
    s_mov_b32 s48, 4
    s_cmp_eq_u64 s[10:11], 0
    s_cselect_b32 s48, 2, 4
    s_movk_i32 s63, 0x70
    s_movk_i32 s64, 128
    v_lshrrev_b32 v8, 4, v1
    v_lshrrev_b32 v10, 5, v8
    v_and_b32 v11, 31, v8
    v_lshlrev_b32 v3, 4, v11
    v_add_u32 v3, s52, v3
    v_mul_u32_u24 v0, 56, v10
    v_add_u32 v0, s52, v0
    v_lshrrev_b32 v13, 3, v11
    v_lshl_add_u32 v4, v13, 3, v0
    v_lshrrev_b32 v13, 3, v8
    v_and_b32 v14, 1, v13
    v_lshrrev_b32 v13, 1, v13
    v_lshl_add_u32 v13, v14, 2, v13
    v_lshlrev_b32 v5, 4, v13
    v_add_u32 v5, s52, v5
    v_add_u32 v16, s52, v1
    v_lshrrev_b32 v17, 2, v8
    v_mul_u32_u24 v17, 56, v17
    v_and_b32 v13, 3, v8
    v_lshl_add_u32 v17, v13, 1, v17
    v_add_u32 v17, s52, v17
    s_nop 1
    s_branch M_win
M_send:
    s_mov_b64 s[8:9], 0
    s_mov_b64 s[10:11], 0
    s_mov_b32 s48, 0
    s_mov_b32 s76, 1
    s_movk_i32 s63, 0x70
    s_movk_i32 s64, 128
    v_lshrrev_b32 v8, 4, v1
    v_lshrrev_b32 v10, 5, v8
    v_and_b32 v11, 31, v8
    v_lshlrev_b32 v3, 4, v11
    v_add_u32 v3, s52, v3
    v_mul_u32_u24 v0, 56, v10
    v_add_u32 v0, s52, v0
    v_lshrrev_b32 v13, 3, v11
    v_lshl_add_u32 v4, v13, 3, v0
    v_lshrrev_b32 v13, 3, v8
    v_and_b32 v14, 1, v13
    v_lshrrev_b32 v13, 1, v13
    v_lshl_add_u32 v13, v14, 2, v13
    v_lshlrev_b32 v5, 4, v13
    v_add_u32 v5, s52, v5
    v_add_u32 v16, s52, v1
    v_lshrrev_b32 v17, 2, v8
    v_mul_u32_u24 v17, 56, v17
    v_and_b32 v13, 3, v8
    v_lshl_add_u32 v17, v13, 1, v17
    v_add_u32 v17, s52, v17
    s_nop 1
    s_branch M_win
M_epi:
    v_lshrrev_b32 v8, 4, v1
    v_lshrrev_b32 v10, 5, v8
    v_and_b32 v11, 31, v8
    v_lshlrev_b32 v12, 11, v10
    v_lshl_add_u32 v12, v11, 2, v12
    v_cvt_pk_bf16_f32 v64, v128, v144
    v_cvt_pk_bf16_f32 v65, v129, v145
    v_cvt_pk_bf16_f32 v66, v130, v146
    v_cvt_pk_bf16_f32 v67, v131, v147
    v_cvt_pk_bf16_f32 v68, v132, v148
    v_cvt_pk_bf16_f32 v69, v133, v149
    v_cvt_pk_bf16_f32 v70, v134, v150
    v_cvt_pk_bf16_f32 v71, v135, v151
    v_cvt_pk_bf16_f32 v72, v136, v152
    v_cvt_pk_bf16_f32 v73, v137, v153
    v_cvt_pk_bf16_f32 v74, v138, v154
    v_cvt_pk_bf16_f32 v75, v139, v155
    buffer_store_dword v64, v12, s[32:35], s40 offen offset:0 sc1 nt
    buffer_store_dword v65, v12, s[32:35], s40 offen offset:512 sc1 nt
    buffer_store_dword v66, v12, s[32:35], s40 offen offset:1024 sc1 nt
    buffer_store_dword v67, v12, s[32:35], s40 offen offset:1536 sc1 nt
    buffer_store_dword v68, v12, s[32:35], s41 offen offset:0 sc1 nt
    buffer_store_dword v69, v12, s[32:35], s41 offen offset:512 sc1 nt
    buffer_store_dword v70, v12, s[32:35], s41 offen offset:1024 sc1 nt
    buffer_store_dword v71, v12, s[32:35], s41 offen offset:1536 sc1 nt
    buffer_store_dword v72, v12, s[32:35], s42 offen offset:0 sc1 nt
    buffer_store_dword v73, v12, s[32:35], s42 offen offset:512 sc1 nt
    buffer_store_dword v74, v12, s[32:35], s42 offen offset:1024 sc1 nt
    buffer_store_dword v75, v12, s[32:35], s42 offen offset:1536 sc1 nt
    v_cvt_pk_bf16_f32 v80, v160, v176
    v_cvt_pk_bf16_f32 v81, v161, v177
    v_cvt_pk_bf16_f32 v82, v162, v178
    v_cvt_pk_bf16_f32 v83, v163, v179
    v_cvt_pk_bf16_f32 v84, v164, v180
    v_cvt_pk_bf16_f32 v85, v165, v181
    v_cvt_pk_bf16_f32 v86, v166, v182
    v_cvt_pk_bf16_f32 v87, v167, v183
    v_cvt_pk_bf16_f32 v88, v168, v184
    v_cvt_pk_bf16_f32 v89, v169, v185
    v_cvt_pk_bf16_f32 v90, v170, v186
    v_cvt_pk_bf16_f32 v91, v171, v187
    buffer_store_dword v80, v12, s[32:35], s40 offen offset:128 sc1 nt
    buffer_store_dword v81, v12, s[32:35], s40 offen offset:640 sc1 nt
    buffer_store_dword v82, v12, s[32:35], s40 offen offset:1152 sc1 nt
    buffer_store_dword v83, v12, s[32:35], s40 offen offset:1664 sc1 nt
    buffer_store_dword v84, v12, s[32:35], s41 offen offset:128 sc1 nt
    buffer_store_dword v85, v12, s[32:35], s41 offen offset:640 sc1 nt
    buffer_store_dword v86, v12, s[32:35], s41 offen offset:1152 sc1 nt
    buffer_store_dword v87, v12, s[32:35], s41 offen offset:1664 sc1 nt
    buffer_store_dword v88, v12, s[32:35], s42 offen offset:128 sc1 nt
    buffer_store_dword v89, v12, s[32:35], s42 offen offset:640 sc1 nt
    buffer_store_dword v90, v12, s[32:35], s42 offen offset:1152 sc1 nt
    buffer_store_dword v91, v12, s[32:35], s42 offen offset:1664 sc1 nt
    s_waitcnt vmcnt(24)
    ds_read_u16_d16_hi v16, v2 offset:1024
    ds_read_u16_d16_hi v17, v2 offset:1280
    ds_read_u16_d16_hi v18, v2 offset:1536
    ds_read_u16_d16_hi v19, v2 offset:1792
    ds_read_u16_d16_hi v20, v2 offset:4096
    ds_read_u16_d16_hi v21, v2 offset:4352
    ds_read_u16_d16_hi v22, v2 offset:4608
    ds_read_u16_d16_hi v23, v2 offset:4864
    ds_read_u16_d16_hi v24, v2 offset:7168
    ds_read_u16_d16_hi v25, v2 offset:7424
    ds_read_u16_d16_hi v26, v2 offset:7680
    ds_read_u16_d16_hi v27, v2 offset:7936
    ds_read_u16_d16_hi v32, v2 offset:1026
    ds_read_u16_d16_hi v33, v2 offset:1282
    ds_read_u16_d16_hi v34, v2 offset:1538
    ds_read_u16_d16_hi v35, v2 offset:1794
    ds_read_u16_d16_hi v36, v2 offset:4098
    ds_read_u16_d16_hi v37, v2 offset:4354
    ds_read_u16_d16_hi v38, v2 offset:4610
    ds_read_u16_d16_hi v39, v2 offset:4866
    ds_read_u16_d16_hi v40, v2 offset:7170
    ds_read_u16_d16_hi v41, v2 offset:7426
    ds_read_u16_d16_hi v42, v2 offset:7682
    ds_read_u16_d16_hi v43, v2 offset:7938
    s_waitcnt lgkmcnt(15)
    v_add_f32 v192, v192, v16
    v_add_f32 v193, v193, v17
    v_add_f32 v194, v194, v18
    v_add_f32 v195, v195, v19
    v_add_f32 v196, v196, v20
    v_add_f32 v197, v197, v21
    v_add_f32 v198, v198, v22
    v_add_f32 v199, v199, v23
    v_add_f32 v200, v200, v24
    s_waitcnt lgkmcnt(14)
    v_add_f32 v201, v201, v25
    s_waitcnt lgkmcnt(13)
    v_add_f32 v202, v202, v26
    s_waitcnt lgkmcnt(12)
    v_add_f32 v203, v203, v27
    s_waitcnt lgkmcnt(11)
    v_add_f32 v208, v208, v32
    s_waitcnt lgkmcnt(10)
    v_add_f32 v209, v209, v33
    s_waitcnt lgkmcnt(9)
    v_add_f32 v210, v210, v34
    s_waitcnt lgkmcnt(8)
    v_add_f32 v211, v211, v35
    s_waitcnt lgkmcnt(7)
    v_add_f32 v212, v212, v36
    s_waitcnt lgkmcnt(6)
    v_add_f32 v213, v213, v37
    s_waitcnt lgkmcnt(5)
    v_add_f32 v214, v214, v38
    s_waitcnt lgkmcnt(4)
    v_add_f32 v215, v215, v39
    s_waitcnt lgkmcnt(3)
    v_add_f32 v216, v216, v40
    s_waitcnt lgkmcnt(2)
    v_add_f32 v217, v217, v41
    s_waitcnt lgkmcnt(1)
    v_add_f32 v218, v218, v42
    s_waitcnt lgkmcnt(0)
    v_add_f32 v219, v219, v43
    v_cvt_pk_bf16_f32 v96, v192, v208
    v_cvt_pk_bf16_f32 v97, v193, v209
    v_cvt_pk_bf16_f32 v98, v194, v210
    v_cvt_pk_bf16_f32 v99, v195, v211
    v_cvt_pk_bf16_f32 v100, v196, v212
    v_cvt_pk_bf16_f32 v101, v197, v213
    v_cvt_pk_bf16_f32 v102, v198, v214
    v_cvt_pk_bf16_f32 v103, v199, v215
    v_cvt_pk_bf16_f32 v104, v200, v216
    v_cvt_pk_bf16_f32 v105, v201, v217
    v_cvt_pk_bf16_f32 v106, v202, v218
    v_cvt_pk_bf16_f32 v107, v203, v219
    buffer_store_dword v96, v12, s[32:35], s40 offen offset:256 sc1 nt
    buffer_store_dword v97, v12, s[32:35], s40 offen offset:768 sc1 nt
    buffer_store_dword v98, v12, s[32:35], s40 offen offset:1280 sc1 nt
    buffer_store_dword v99, v12, s[32:35], s40 offen offset:1792 sc1 nt
    buffer_store_dword v100, v12, s[32:35], s41 offen offset:256 sc1 nt
    buffer_store_dword v101, v12, s[32:35], s41 offen offset:768 sc1 nt
    buffer_store_dword v102, v12, s[32:35], s41 offen offset:1280 sc1 nt
    buffer_store_dword v103, v12, s[32:35], s41 offen offset:1792 sc1 nt
    buffer_store_dword v104, v12, s[32:35], s42 offen offset:256 sc1 nt
    buffer_store_dword v105, v12, s[32:35], s42 offen offset:768 sc1 nt
    buffer_store_dword v106, v12, s[32:35], s42 offen offset:1280 sc1 nt
    buffer_store_dword v107, v12, s[32:35], s42 offen offset:1792 sc1 nt
    ds_read_u16_d16_hi v16, v2 offset:2048
    ds_read_u16_d16_hi v17, v2 offset:2304
    ds_read_u16_d16_hi v18, v2 offset:2560
    ds_read_u16_d16_hi v19, v2 offset:2816
    ds_read_u16_d16_hi v20, v2 offset:5120
    ds_read_u16_d16_hi v21, v2 offset:5376
    ds_read_u16_d16_hi v22, v2 offset:5632
    ds_read_u16_d16_hi v23, v2 offset:5888
    ds_read_u16_d16_hi v24, v2 offset:8192
    ds_read_u16_d16_hi v25, v2 offset:8448
    ds_read_u16_d16_hi v26, v2 offset:8704
    ds_read_u16_d16_hi v27, v2 offset:8960
    ds_read_u16_d16_hi v32, v2 offset:2050
    ds_read_u16_d16_hi v33, v2 offset:2306
    ds_read_u16_d16_hi v34, v2 offset:2562
    ds_read_u16_d16_hi v35, v2 offset:2818
    ds_read_u16_d16_hi v36, v2 offset:5122
    ds_read_u16_d16_hi v37, v2 offset:5378
    ds_read_u16_d16_hi v38, v2 offset:5634
    ds_read_u16_d16_hi v39, v2 offset:5890
    ds_read_u16_d16_hi v40, v2 offset:8194
    ds_read_u16_d16_hi v41, v2 offset:8450
    ds_read_u16_d16_hi v42, v2 offset:8706
    ds_read_u16_d16_hi v43, v2 offset:8962
    s_waitcnt lgkmcnt(15)
    v_add_f32 v224, v224, v16
    v_add_f32 v225, v225, v17
    v_add_f32 v226, v226, v18
    v_add_f32 v227, v227, v19
    v_add_f32 v228, v228, v20
    v_add_f32 v229, v229, v21
    v_add_f32 v230, v230, v22
    v_add_f32 v231, v231, v23
    v_add_f32 v232, v232, v24
    s_waitcnt lgkmcnt(14)
    v_add_f32 v233, v233, v25
    s_waitcnt lgkmcnt(13)
    v_add_f32 v234, v234, v26
    s_waitcnt lgkmcnt(12)
    v_add_f32 v235, v235, v27
    s_waitcnt lgkmcnt(11)
    v_add_f32 v240, v240, v32
    s_waitcnt lgkmcnt(10)
    v_add_f32 v241, v241, v33
    s_waitcnt lgkmcnt(9)
    v_add_f32 v242, v242, v34
    s_waitcnt lgkmcnt(8)
    v_add_f32 v243, v243, v35
    s_waitcnt lgkmcnt(7)
    v_add_f32 v244, v244, v36
    s_waitcnt lgkmcnt(6)
    v_add_f32 v245, v245, v37
    s_waitcnt lgkmcnt(5)
    v_add_f32 v246, v246, v38
    s_waitcnt lgkmcnt(4)
    v_add_f32 v247, v247, v39
    s_waitcnt lgkmcnt(3)
    v_add_f32 v248, v248, v40
    s_waitcnt lgkmcnt(2)
    v_add_f32 v249, v249, v41
    s_waitcnt lgkmcnt(1)
    v_add_f32 v250, v250, v42
    s_waitcnt lgkmcnt(0)
    v_add_f32 v251, v251, v43
    v_cvt_pk_bf16_f32 v112, v224, v240
    v_cvt_pk_bf16_f32 v113, v225, v241
    v_cvt_pk_bf16_f32 v114, v226, v242
    v_cvt_pk_bf16_f32 v115, v227, v243
    v_cvt_pk_bf16_f32 v116, v228, v244
    v_cvt_pk_bf16_f32 v117, v229, v245
    v_cvt_pk_bf16_f32 v118, v230, v246
    v_cvt_pk_bf16_f32 v119, v231, v247
    v_cvt_pk_bf16_f32 v120, v232, v248
    v_cvt_pk_bf16_f32 v121, v233, v249
    v_cvt_pk_bf16_f32 v122, v234, v250
    v_cvt_pk_bf16_f32 v123, v235, v251
    buffer_store_dword v112, v12, s[32:35], s40 offen offset:384 sc1 nt
    buffer_store_dword v113, v12, s[32:35], s40 offen offset:896 sc1 nt
    buffer_store_dword v114, v12, s[32:35], s40 offen offset:1408 sc1 nt
    buffer_store_dword v115, v12, s[32:35], s40 offen offset:1920 sc1 nt
    buffer_store_dword v116, v12, s[32:35], s41 offen offset:384 sc1 nt
    buffer_store_dword v117, v12, s[32:35], s41 offen offset:896 sc1 nt
    buffer_store_dword v118, v12, s[32:35], s41 offen offset:1408 sc1 nt
    buffer_store_dword v119, v12, s[32:35], s41 offen offset:1920 sc1 nt
    buffer_store_dword v120, v12, s[32:35], s42 offen offset:384 sc1 nt
    buffer_store_dword v121, v12, s[32:35], s42 offen offset:896 sc1 nt
    buffer_store_dword v122, v12, s[32:35], s42 offen offset:1408 sc1 nt
    buffer_store_dword v123, v12, s[32:35], s42 offen offset:1920 sc1 nt
    s_cmp_le_u32 s45, 24
    s_cbranch_scc1 M_fin
    v_cvt_pk_bf16_f32 v76, v140, v156
    v_cvt_pk_bf16_f32 v77, v141, v157
    v_cvt_pk_bf16_f32 v78, v142, v158
    v_cvt_pk_bf16_f32 v79, v143, v159
    buffer_store_dword v76, v12, s[32:35], s43 offen offset:0 sc1 nt
    buffer_store_dword v77, v12, s[32:35], s43 offen offset:512 sc1 nt
    buffer_store_dword v78, v12, s[32:35], s43 offen offset:1024 sc1 nt
    buffer_store_dword v79, v12, s[32:35], s43 offen offset:1536 sc1 nt
    v_cvt_pk_bf16_f32 v92, v172, v188
    v_cvt_pk_bf16_f32 v93, v173, v189
    v_cvt_pk_bf16_f32 v94, v174, v190
    v_cvt_pk_bf16_f32 v95, v175, v191
    buffer_store_dword v92, v12, s[32:35], s43 offen offset:128 sc1 nt
    buffer_store_dword v93, v12, s[32:35], s43 offen offset:640 sc1 nt
    buffer_store_dword v94, v12, s[32:35], s43 offen offset:1152 sc1 nt
    buffer_store_dword v95, v12, s[32:35], s43 offen offset:1664 sc1 nt
    ds_read_u16_d16_hi v28, v2 offset:10240
    ds_read_u16_d16_hi v29, v2 offset:10496
    ds_read_u16_d16_hi v30, v2 offset:10752
    ds_read_u16_d16_hi v31, v2 offset:11008
    ds_read_u16_d16_hi v44, v2 offset:10242
    ds_read_u16_d16_hi v45, v2 offset:10498
    ds_read_u16_d16_hi v46, v2 offset:10754
    ds_read_u16_d16_hi v47, v2 offset:11010
    s_waitcnt lgkmcnt(7)
    v_add_f32 v204, v204, v28
    s_waitcnt lgkmcnt(6)
    v_add_f32 v205, v205, v29
    s_waitcnt lgkmcnt(5)
    v_add_f32 v206, v206, v30
    s_waitcnt lgkmcnt(4)
    v_add_f32 v207, v207, v31
    s_waitcnt lgkmcnt(3)
    v_add_f32 v220, v220, v44
    s_waitcnt lgkmcnt(2)
    v_add_f32 v221, v221, v45
    s_waitcnt lgkmcnt(1)
    v_add_f32 v222, v222, v46
    s_waitcnt lgkmcnt(0)
    v_add_f32 v223, v223, v47
    v_cvt_pk_bf16_f32 v108, v204, v220
    v_cvt_pk_bf16_f32 v109, v205, v221
    v_cvt_pk_bf16_f32 v110, v206, v222
    v_cvt_pk_bf16_f32 v111, v207, v223
    buffer_store_dword v108, v12, s[32:35], s43 offen offset:256 sc1 nt
    buffer_store_dword v109, v12, s[32:35], s43 offen offset:768 sc1 nt
    buffer_store_dword v110, v12, s[32:35], s43 offen offset:1280 sc1 nt
    buffer_store_dword v111, v12, s[32:35], s43 offen offset:1792 sc1 nt
    ds_read_u16_d16_hi v28, v2 offset:11264
    ds_read_u16_d16_hi v29, v2 offset:11520
    ds_read_u16_d16_hi v30, v2 offset:11776
    ds_read_u16_d16_hi v31, v2 offset:12032
    ds_read_u16_d16_hi v44, v2 offset:11266
    ds_read_u16_d16_hi v45, v2 offset:11522
    ds_read_u16_d16_hi v46, v2 offset:11778
    ds_read_u16_d16_hi v47, v2 offset:12034
    s_waitcnt lgkmcnt(7)
    v_add_f32 v236, v236, v28
    s_waitcnt lgkmcnt(6)
    v_add_f32 v237, v237, v29
    s_waitcnt lgkmcnt(5)
    v_add_f32 v238, v238, v30
    s_waitcnt lgkmcnt(4)
    v_add_f32 v239, v239, v31
    s_waitcnt lgkmcnt(3)
    v_add_f32 v252, v252, v44
    s_waitcnt lgkmcnt(2)
    v_add_f32 v253, v253, v45
    s_waitcnt lgkmcnt(1)
    v_add_f32 v254, v254, v46
    s_waitcnt lgkmcnt(0)
    v_add_f32 v255, v255, v47
    v_cvt_pk_bf16_f32 v124, v236, v252
    v_cvt_pk_bf16_f32 v125, v237, v253
    v_cvt_pk_bf16_f32 v126, v238, v254
    v_cvt_pk_bf16_f32 v127, v239, v255
    buffer_store_dword v124, v12, s[32:35], s43 offen offset:384 sc1 nt
    buffer_store_dword v125, v12, s[32:35], s43 offen offset:896 sc1 nt
    buffer_store_dword v126, v12, s[32:35], s43 offen offset:1408 sc1 nt
    buffer_store_dword v127, v12, s[32:35], s43 offen offset:1920 sc1 nt
M_fin:
K_end:
    s_endpgm
.section .rodata,"a"
.p2align 6
.amdhsa_kernel standalone__molecular_angular_painn__graph_kernel
  .amdhsa_next_free_vgpr 256
  .amdhsa_next_free_sgpr 102
  .amdhsa_accum_offset 256
  .amdhsa_group_segment_fixed_size 0
  .amdhsa_kernarg_size 88
  .amdhsa_user_sgpr_count 2
  .amdhsa_user_sgpr_kernarg_segment_ptr 1
  .amdhsa_system_sgpr_workgroup_id_x 1
  .amdhsa_float_denorm_mode_32 3
.end_amdhsa_kernel
```

```asm
; @launch grid=(250,1,1) block=(512,1,1) lds=163840
.amdgcn_target "amdgcn-amd-amdhsa--gfx950"
.text
.globl standalone__molecular_angular_painn__graph_kernel
.p2align 12
.p2align 8
.type standalone__molecular_angular_painn__graph_kernel,@function
standalone__molecular_angular_painn__graph_kernel:
    s_cmp_ge_u32 s2, 250
    s_cbranch_scc1 K_end
    s_load_dwordx8 s[4:11], s[0:1], 0
    s_load_dwordx8 s[12:19], s[0:1], 32
    s_load_dwordx2 s[20:21], s[0:1], 64
    s_load_dwordx2 s[24:25], s[0:1], 80
    v_and_b32 v1, 63, v0
    v_lshrrev_b32 v119, 6, v0
    v_lshlrev_b32 v2, 4, v0
    v_readfirstlane_b32 s26, v119
    v_mov_b32 v20, 0xff000000
    v_mov_b32 v21, v20
    v_mov_b32 v22, v20
    v_mov_b32 v23, v20
    v_add_u32 v117, 131840, v2
    ds_write_b128 v117, v[20:23] offset:0
    ds_write_b128 v117, v[20:23] offset:8192
    ds_write_b128 v117, v[20:23] offset:16384
    v_cmp_gt_u32 vcc, 464, v0
    s_mov_b64 s[66:67], vcc
    s_mov_b64 exec, vcc
    ds_write_b128 v117, v[20:23] offset:24576
    s_mov_b64 exec, -1
    v_lshlrev_b32 v28, 2, v0
    v_mov_b32 v29, 0
    v_cmp_gt_u32 vcc, 256, v0
    s_and_saveexec_b64 s[60:61], vcc
    ds_write_b32 v28, v29 offset:8192
    s_mov_b64 exec, -1
    v_mov_b32 v30, 131076
    ds_write2_b32 v30, v29, v29 offset1:1
    s_mov_b32 s58, 0xffff0000
    v_lshlrev_b32 v3, 4, v1
    v_mov_b32 v116, 1
    v_lshrrev_b32 v119, 4, v1
    v_and_b32 v120, 15, v1
    v_lshlrev_b32 v121, 9, v120
    v_lshl_add_u32 v121, v119, 4, v121
    v_bfrev_b32 v118, 2
    s_cmp_eq_u32 s26, 4
    s_cselect_b32 s63, 8, 16
    s_cmp_gt_u32 s26, 4
    s_cselect_b32 s63, 0, s63
    v_cmp_gt_u32 vcc, s63, v120
    s_nop 1
    v_cndmask_b32 v36, v118, v121, vcc
    s_mul_i32 s62, s2, 200
    s_lshl_b32 s61, s26, 4
    s_add_u32 s62, s62, s61
    s_lshl_b32 s76, s62, 9
    s_add_u32 s77, s76, 65536
    s_mul_i32 s27, s2, 12800
    s_add_u32 s59, s27, 6400
    v_cmp_gt_u32 vcc, 400, v0
    s_mov_b64 s[56:57], vcc
    s_lshl_b32 s64, s26, 10
    s_add_u32 m0, s64, 0
    s_waitcnt lgkmcnt(0)
    s_barrier
    s_mov_b32 s48, s14
    s_mov_b32 s49, s15
    s_mov_b32 s50, 0x2000
    s_mov_b32 s51, 0x00020000
    s_cmp_eq_u32 s26, 7
    s_cbranch_scc1 P_w7
    s_mov_b32 s44, s10
    s_mov_b32 s45, s11
    s_mov_b32 s46, 0x30d400
    s_mov_b32 s47, 0x00020000
    s_mov_b32 s40, s8
    s_mov_b32 s41, s9
    s_mov_b32 s42, 0x30d400
    s_mov_b32 s43, 0x00020000
    s_mov_b32 s28, s4
    s_mov_b32 s29, s5
    s_mov_b32 s30, 0x186a000
    s_mov_b32 s31, 0x00020000
    buffer_load_dwordx4 v3, s[48:51], s64 offen lds
    s_mov_b64 exec, s[56:57]
    buffer_load_dwordx4 v[4:7], v2, s[44:47], s27 offen nt
    buffer_load_dwordx4 v[8:11], v2, s[44:47], s59 offen nt
    buffer_load_dwordx4 v[12:15], v2, s[40:43], s27 offen nt
    buffer_load_dwordx4 v[16:19], v2, s[40:43], s59 offen nt
    s_mov_b64 exec, -1
    s_mov_b32 s92, s6
    s_mov_b32 s93, s7
    s_mov_b32 s94, 0x493e0
    s_mov_b32 s95, 0x00020000
    s_mov_b32 s36, s24
    s_mov_b32 s37, s25
    s_mov_b32 s38, 0x241a800
    s_mov_b32 s39, 0x00020000
    s_add_u32 s72, s24, 0x1e00000
    s_addc_u32 s73, s25, 0
    s_mov_b32 s74, 0x61a800
    s_mov_b32 s75, 0x00020000
    s_mov_b32 s52, s16
    s_mov_b32 s53, s17
    s_mov_b32 s54, 0x6000
    s_mov_b32 s55, 0x00020000
    s_mov_b32 s96, s18
    s_mov_b32 s97, s19
    s_mov_b32 s98, 0x1800
    s_mov_b32 s99, 0x00020000
    s_mov_b32 s68, s12
    s_mov_b32 s69, s13
    s_mov_b32 s70, 0x20
    s_mov_b32 s71, 0x00020000
    s_mov_b32 s32, s20
    s_mov_b32 s33, s21
    s_mov_b32 s34, 0x186a000
    s_mov_b32 s35, 0x00020000
    v_bfe_u32 v122, v1, 2, 2
    v_lshl_add_u32 v122, v119, 3, v122
    v_lshlrev_b32 v122, 7, v122
    v_and_b32 v39, 3, v1
    v_lshl_add_u32 v122, v39, 3, v122
    s_mov_b64 exec, 0
    s_cmp_eq_u32 s26, 0
    s_cbranch_scc1 WUP_412
    s_cmp_eq_u32 s26, 1
    s_cbranch_scc1 WUP_548
    s_cmp_eq_u32 s26, 2
    s_cbranch_scc1 WUP_935
    s_cmp_eq_u32 s26, 3
    s_cbranch_scc1 WUP_4548
    s_cmp_eq_u32 s26, 4
    s_cbranch_scc1 WUP_4660
    s_cmp_eq_u32 s26, 5
    s_cbranch_scc1 WUP_1295
    s_cmp_eq_u32 s26, 6
    s_cbranch_scc1 WUP_1624
WUR_0:
    s_mov_b64 exec, -1
    s_nop 1
    s_branch P_bin
P_w7:
    s_lshr_b32 s3, s2, 3
    s_lshl_b32 s3, s3, 2
    s_and_b32 s65, s2, 3
    s_add_u32 s3, s3, s65
    s_and_b32 s65, s2, 4
    s_cselect_b32 s3, 0xffff, s3
    s_mul_i32 s65, s3, 3072
    v_mul_u32_u24 v38, 24, v1
    s_cmp_ge_u32 s3, 98
    s_cselect_b32 s65, 0x40000000, s65
    s_mov_b32 s92, s6
    s_mov_b32 s93, s7
    s_mov_b32 s94, 0x493e0
    s_mov_b32 s95, 0x00020000
    buffer_load_dwordx3 v[4:6], v38, s[92:95], s65 offen offset:0
    buffer_load_dwordx3 v[8:10], v38, s[92:95], s65 offen offset:12
    buffer_load_dwordx3 v[12:14], v38, s[92:95], s65 offen offset:1536
    buffer_load_dwordx3 v[16:18], v38, s[92:95], s65 offen offset:1548
    s_mov_b32 s27, 0x830000
    buffer_load_dwordx4 v3, s[48:51], s64 offen lds
    s_load_dword s22, s[24:25], s27
    s_mov_b32 s28, s4
    s_mov_b32 s29, s5
    s_mov_b32 s30, 0x186a000
    s_mov_b32 s31, 0x00020000
    s_mov_b32 s92, s6
    s_mov_b32 s93, s7
    s_mov_b32 s94, 0x493e0
    s_mov_b32 s95, 0x00020000
    s_mov_b32 s36, s24
    s_mov_b32 s37, s25
    s_mov_b32 s38, 0x241a800
    s_mov_b32 s39, 0x00020000
    s_add_u32 s72, s24, 0x1e00000
    s_addc_u32 s73, s25, 0
    s_mov_b32 s74, 0x61a800
    s_mov_b32 s75, 0x00020000
    s_mov_b32 s52, s16
    s_mov_b32 s53, s17
    s_mov_b32 s54, 0x6000
    s_mov_b32 s55, 0x00020000
    s_mov_b32 s96, s18
    s_mov_b32 s97, s19
    s_mov_b32 s98, 0x1800
    s_mov_b32 s99, 0x00020000
    s_mov_b32 s68, s12
    s_mov_b32 s69, s13
    s_mov_b32 s70, 0x20
    s_mov_b32 s71, 0x00020000
    s_mov_b32 s32, s20
    s_mov_b32 s33, s21
    s_mov_b32 s34, 0x186a000
    s_mov_b32 s35, 0x00020000
    v_bfe_u32 v122, v1, 2, 2
    v_lshl_add_u32 v122, v119, 3, v122
    v_lshlrev_b32 v122, 7, v122
    v_and_b32 v39, 3, v1
    v_lshl_add_u32 v122, v39, 3, v122
    s_cmp_ge_u32 s3, 98
    s_nop 0
    s_cbranch_scc1 P_w7n
    s_mov_b32 s60, 0x41800000
    s_movk_i32 s65, 0xf8
    v_lshlrev_b32 v38, 3, v1
    s_mul_i32 s27, s3, 1024
    s_add_u32 s27, s27, 0x810000
    s_waitcnt vmcnt(3)
    v_lshlrev_b32 v68, 16, v4
    v_and_b32 v69, s58, v4
    v_lshlrev_b32 v70, 16, v5
    v_and_b32 v71, s58, v5
    v_lshlrev_b32 v72, 16, v6
    v_and_b32 v73, s58, v6
    v_lshlrev_b32 v74, 16, v8
    v_and_b32 v75, s58, v8
    v_lshlrev_b32 v76, 16, v9
    v_and_b32 v77, s58, v9
    v_lshlrev_b32 v78, 16, v10
    v_and_b32 v79, s58, v10
    v_mul_f32 v68, s60, v68
    v_mul_f32 v69, s60, v69
    v_mul_f32 v70, s60, v70
    v_mul_f32 v71, s60, v71
    v_mul_f32 v72, s60, v72
    v_mul_f32 v73, s60, v73
    v_mul_f32 v74, s60, v74
    v_mul_f32 v75, s60, v75
    v_mul_f32 v76, s60, v76
    v_mul_f32 v77, s60, v77
    v_mul_f32 v78, s60, v78
    v_mul_f32 v79, s60, v79
    v_cvt_flr_i32_f32 v68, v68
    v_cvt_flr_i32_f32 v69, v69
    v_cvt_flr_i32_f32 v70, v70
    v_cvt_flr_i32_f32 v71, v71
    v_cvt_flr_i32_f32 v72, v72
    v_cvt_flr_i32_f32 v73, v73
    v_cvt_flr_i32_f32 v74, v74
    v_cvt_flr_i32_f32 v75, v75
    v_cvt_flr_i32_f32 v76, v76
    v_cvt_flr_i32_f32 v77, v77
    v_cvt_flr_i32_f32 v78, v78
    v_cvt_flr_i32_f32 v79, v79
    v_bfe_u32 v84, v70, 5, 3
    v_bfe_u32 v85, v70, 2, 3
    v_and_or_b32 v68, v68, s65, v84
    v_and_or_b32 v69, v69, s65, v85
    v_lshl_or_b32 v68, v69, 8, v68
    v_bfe_u32 v84, v73, 5, 3
    v_bfe_u32 v85, v73, 2, 3
    v_and_or_b32 v71, v71, s65, v84
    v_and_or_b32 v72, v72, s65, v85
    v_lshl_or_b32 v71, v72, 8, v71
    v_bfe_u32 v84, v76, 5, 3
    v_bfe_u32 v85, v76, 2, 3
    v_and_or_b32 v74, v74, s65, v84
    v_and_or_b32 v75, v75, s65, v85
    v_lshl_or_b32 v74, v75, 8, v74
    v_bfe_u32 v84, v79, 5, 3
    v_bfe_u32 v85, v79, 2, 3
    v_and_or_b32 v77, v77, s65, v84
    v_and_or_b32 v78, v78, s65, v85
    v_lshl_or_b32 v77, v78, 8, v77
    v_lshl_or_b32 v86, v71, 16, v68
    v_lshl_or_b32 v87, v77, 16, v74
    buffer_store_dwordx2 v[86:87], v38, s[36:39], s27 offen offset:0 sc1
    s_waitcnt vmcnt(2)
    v_lshlrev_b32 v68, 16, v12
    v_and_b32 v69, s58, v12
    v_lshlrev_b32 v70, 16, v13
    v_and_b32 v71, s58, v13
    v_lshlrev_b32 v72, 16, v14
    v_and_b32 v73, s58, v14
    v_lshlrev_b32 v74, 16, v16
    v_and_b32 v75, s58, v16
    v_lshlrev_b32 v76, 16, v17
    v_and_b32 v77, s58, v17
    v_lshlrev_b32 v78, 16, v18
    v_and_b32 v79, s58, v18
    v_mul_f32 v68, s60, v68
    v_mul_f32 v69, s60, v69
    v_mul_f32 v70, s60, v70
    v_mul_f32 v71, s60, v71
    v_mul_f32 v72, s60, v72
    v_mul_f32 v73, s60, v73
    v_mul_f32 v74, s60, v74
    v_mul_f32 v75, s60, v75
    v_mul_f32 v76, s60, v76
    v_mul_f32 v77, s60, v77
    v_mul_f32 v78, s60, v78
    v_mul_f32 v79, s60, v79
    v_cvt_flr_i32_f32 v68, v68
    v_cvt_flr_i32_f32 v69, v69
    v_cvt_flr_i32_f32 v70, v70
    v_cvt_flr_i32_f32 v71, v71
    v_cvt_flr_i32_f32 v72, v72
    v_cvt_flr_i32_f32 v73, v73
    v_cvt_flr_i32_f32 v74, v74
    v_cvt_flr_i32_f32 v75, v75
    v_cvt_flr_i32_f32 v76, v76
    v_cvt_flr_i32_f32 v77, v77
    v_cvt_flr_i32_f32 v78, v78
    v_cvt_flr_i32_f32 v79, v79
    v_bfe_u32 v84, v70, 5, 3
    v_bfe_u32 v85, v70, 2, 3
    v_and_or_b32 v68, v68, s65, v84
    v_and_or_b32 v69, v69, s65, v85
    v_lshl_or_b32 v68, v69, 8, v68
    v_bfe_u32 v84, v73, 5, 3
    v_bfe_u32 v85, v73, 2, 3
    v_and_or_b32 v71, v71, s65, v84
    v_and_or_b32 v72, v72, s65, v85
    v_lshl_or_b32 v71, v72, 8, v71
    v_bfe_u32 v84, v76, 5, 3
    v_bfe_u32 v85, v76, 2, 3
    v_and_or_b32 v74, v74, s65, v84
    v_and_or_b32 v75, v75, s65, v85
    v_lshl_or_b32 v74, v75, 8, v74
    v_bfe_u32 v84, v79, 5, 3
    v_bfe_u32 v85, v79, 2, 3
    v_and_or_b32 v77, v77, s65, v84
    v_and_or_b32 v78, v78, s65, v85
    v_lshl_or_b32 v77, v78, 8, v77
    v_lshl_or_b32 v88, v71, 16, v68
    v_lshl_or_b32 v89, v77, 16, v74
    buffer_store_dwordx2 v[88:89], v38, s[36:39], s27 offen offset:512 sc1
    s_nop 0
P_w7n:
    buffer_load_dwordx4 v[20:23], v121, s[28:31], s76 offen offset:0
    buffer_load_dwordx4 v[24:27], v121, s[28:31], s76 offen offset:64
    s_waitcnt lgkmcnt(0)
    v_lshrrev_b32 v124, 5, v1
    v_and_b32 v125, 31, v1
    v_mul_u32_u24 v124, 3072, v124
    v_lshl_add_u32 v124, v125, 2, v124
    s_lshr_b32 s60, s26, 2
    s_and_b32 s61, s26, 3
    s_mul_i32 s63, s61, 768
    s_lshl_b32 s65, s60, 7
    s_add_u32 s63, s63, s65
    s_add_u32 s65, s63, 0
    buffer_load_dword v128, v124, s[52:55], s65 offen
    s_add_u32 s65, s63, 6144
    buffer_load_dword v129, v124, s[52:55], s65 offen
    s_add_u32 s65, s63, 12288
    buffer_load_dword v130, v124, s[52:55], s65 offen
    s_add_u32 s65, s63, 18432
    buffer_load_dword v131, v124, s[52:55], s65 offen
    s_add_u32 s65, s63, 384
    buffer_load_dword v132, v124, s[52:55], s65 offen
    s_add_u32 s65, s63, 6528
    buffer_load_dword v133, v124, s[52:55], s65 offen
    s_add_u32 s65, s63, 12672
    buffer_load_dword v134, v124, s[52:55], s65 offen
    s_add_u32 s65, s63, 18816
    buffer_load_dword v135, v124, s[52:55], s65 offen
    s_cmp_ge_u32 s26, 4
    s_cbranch_scc1 P_e2c
    s_add_u32 s27, s26, 8
    s_lshr_b32 s60, s27, 2
    s_and_b32 s61, s27, 3
    s_mul_i32 s63, s61, 768
    s_lshl_b32 s65, s60, 7
    s_add_u32 s63, s63, s65
    s_add_u32 s65, s63, 0
    buffer_load_dword v136, v124, s[52:55], s65 offen
    s_add_u32 s65, s63, 6144
    buffer_load_dword v137, v124, s[52:55], s65 offen
    s_add_u32 s65, s63, 12288
    buffer_load_dword v138, v124, s[52:55], s65 offen
    s_add_u32 s65, s63, 18432
    buffer_load_dword v139, v124, s[52:55], s65 offen
    s_add_u32 s65, s63, 384
    buffer_load_dword v140, v124, s[52:55], s65 offen
    s_add_u32 s65, s63, 6528
    buffer_load_dword v141, v124, s[52:55], s65 offen
    s_add_u32 s65, s63, 12672
    buffer_load_dword v142, v124, s[52:55], s65 offen
    s_add_u32 s65, s63, 18816
    buffer_load_dword v143, v124, s[52:55], s65 offen
    s_branch P_e3c
P_e2c:
    s_sub_u32 s60, s26, 4
    s_lshl_b32 s63, s60, 7
    s_cmp_eq_u32 s26, 7
    s_cselect_b32 s63, 0x40000000, s63
    buffer_load_dword v136, v124, s[96:99], s63 offen offset:0
    buffer_load_dword v137, v124, s[96:99], s63 offen offset:384
    buffer_load_dword v138, v124, s[96:99], s63 offen offset:768
    buffer_load_dword v139, v124, s[96:99], s63 offen offset:1152
    buffer_load_dword v140, v124, s[96:99], s63 offen offset:1536
    buffer_load_dword v141, v124, s[96:99], s63 offen offset:1920
    buffer_load_dword v142, v124, s[96:99], s63 offen offset:2304
    buffer_load_dword v143, v124, s[96:99], s63 offen offset:2688
P_e3c:
    v_mul_u32_u24 v124, 6, v0
    v_and_b32 v124, -4, v124
    v_cmp_gt_u32 vcc, 200, v0
    s_nop 1
    v_cndmask_b32 v124, v118, v124, vcc
    s_mul_i32 s27, s2, 1200
    buffer_load_dwordx2 v[144:145], v124, s[92:95], s27 offen
    v_lshlrev_b32 v124, 1, v1
    buffer_load_ushort v146, v124, s[68:71], 0 offen
    s_waitcnt vmcnt(20) lgkmcnt(0)
    s_add_u32 s22, s22, 1
    v_mov_b32 v38, s22
    v_mov_b32 v39, 131072
    ds_write_b32 v39, v38
    s_cmp_ge_u32 s3, 98
    s_cbranch_scc1 P_join
    s_lshl_b32 s27, s3, 3
    s_add_u32 s27, s27, 0x830100
    v_mov_b32 v8, s22
    v_mov_b32 v9, s22
    v_mov_b32 v12, 0
    s_mov_b64 exec, 1
    buffer_store_dwordx2 v[8:9], v12, s[36:39], s27 offen sc1
    s_mov_b64 exec, -1
    s_branch P_join
P_bin:
WUP_412:
    s_cbranch_execz WUR_0
    s_mov_b32 s63, 0x147AE15
    s_movk_i32 s65, -200
    s_mov_b32 s60, 8192
    s_mov_b32 s61, 131840
    s_mov_b64 exec, s[56:57]
    s_waitcnt vmcnt(3)
    s_mov_b64 exec, -1
    buffer_load_dwordx4 v[20:23], v121, s[28:31], s76 offen offset:0
    buffer_load_dwordx4 v[24:27], v121, s[28:31], s76 offen offset:64
    buffer_load_dwordx4 v[28:31], v36, s[28:31], s77 offen offset:0
    buffer_load_dwordx4 v[32:35], v36, s[28:31], s77 offen offset:64
    v_lshrrev_b32 v124, 5, v1
    v_and_b32 v125, 31, v1
    v_mul_u32_u24 v124, 3072, v124
    v_lshl_add_u32 v124, v125, 2, v124
    s_lshr_b32 s60, s26, 2
    s_and_b32 s61, s26, 3
    s_mul_i32 s63, s61, 768
    s_lshl_b32 s65, s60, 7
    s_add_u32 s63, s63, s65
    s_add_u32 s65, s63, 0
    buffer_load_dword v128, v124, s[52:55], s65 offen
    s_add_u32 s65, s63, 6144
    buffer_load_dword v129, v124, s[52:55], s65 offen
    s_add_u32 s65, s63, 12288
    buffer_load_dword v130, v124, s[52:55], s65 offen
    s_add_u32 s65, s63, 18432
    buffer_load_dword v131, v124, s[52:55], s65 offen
    s_add_u32 s65, s63, 384
    buffer_load_dword v132, v124, s[52:55], s65 offen
    s_add_u32 s65, s63, 6528
    buffer_load_dword v133, v124, s[52:55], s65 offen
    s_add_u32 s65, s63, 12672
    buffer_load_dword v134, v124, s[52:55], s65 offen
    s_add_u32 s65, s63, 18816
    buffer_load_dword v135, v124, s[52:55], s65 offen
    s_cmp_ge_u32 s26, 4
    s_cbranch_scc1 P_e2a
    s_add_u32 s27, s26, 8
    s_lshr_b32 s60, s27, 2
    s_and_b32 s61, s27, 3
    s_mul_i32 s63, s61, 768
    s_lshl_b32 s65, s60, 7
    s_add_u32 s63, s63, s65
    s_add_u32 s65, s63, 0
    buffer_load_dword v136, v124, s[52:55], s65 offen
    s_add_u32 s65, s63, 6144
    buffer_load_dword v137, v124, s[52:55], s65 offen
    s_add_u32 s65, s63, 12288
    buffer_load_dword v138, v124, s[52:55], s65 offen
    s_add_u32 s65, s63, 18432
    buffer_load_dword v139, v124, s[52:55], s65 offen
    s_add_u32 s65, s63, 384
    buffer_load_dword v140, v124, s[52:55], s65 offen
    s_add_u32 s65, s63, 6528
    buffer_load_dword v141, v124, s[52:55], s65 offen
    s_add_u32 s65, s63, 12672
    buffer_load_dword v142, v124, s[52:55], s65 offen
    s_add_u32 s65, s63, 18816
    buffer_load_dword v143, v124, s[52:55], s65 offen
    s_branch P_e3a
P_e2a:
    s_sub_u32 s60, s26, 4
    s_lshl_b32 s63, s60, 7
    s_cmp_eq_u32 s26, 7
    s_cselect_b32 s63, 0x40000000, s63
    buffer_load_dword v136, v124, s[96:99], s63 offen offset:0
    buffer_load_dword v137, v124, s[96:99], s63 offen offset:384
    buffer_load_dword v138, v124, s[96:99], s63 offen offset:768
    buffer_load_dword v139, v124, s[96:99], s63 offen offset:1152
    buffer_load_dword v140, v124, s[96:99], s63 offen offset:1536
    buffer_load_dword v141, v124, s[96:99], s63 offen offset:1920
    buffer_load_dword v142, v124, s[96:99], s63 offen offset:2304
    buffer_load_dword v143, v124, s[96:99], s63 offen offset:2688
P_e3a:
    v_mul_u32_u24 v124, 6, v0
    v_and_b32 v124, -4, v124
    v_cmp_gt_u32 vcc, 200, v0
    s_nop 1
    v_cndmask_b32 v124, v118, v124, vcc
    s_mul_i32 s27, s2, 1200
    buffer_load_dwordx2 v[144:145], v124, s[92:95], s27 offen
    v_lshlrev_b32 v124, 1, v1
    buffer_load_ushort v146, v124, s[68:71], 0 offen
    s_mov_b32 s63, 0x147AE15
    s_movk_i32 s65, -200
    s_mov_b32 s60, 8192
    s_mov_b32 s61, 131840
    s_mov_b64 exec, s[56:57]
    v_mul_hi_u32 v68, v4, s63
    v_lshl_add_u32 v84, v68, 2, s60
    ds_add_rtn_u32 v76, v84, v116
    v_mul_hi_u32 v69, v5, s63
    v_lshl_add_u32 v85, v69, 2, s60
    ds_add_rtn_u32 v77, v85, v116
    v_mul_hi_u32 v70, v6, s63
    v_lshl_add_u32 v86, v70, 2, s60
    ds_add_rtn_u32 v78, v86, v116
    v_mul_hi_u32 v71, v7, s63
    v_lshl_add_u32 v87, v71, 2, s60
    ds_add_rtn_u32 v79, v87, v116
    s_waitcnt vmcnt(24)
    v_mul_hi_u32 v72, v8, s63
    v_lshl_add_u32 v88, v72, 2, s60
    ds_add_rtn_u32 v80, v88, v116
    v_mul_hi_u32 v73, v9, s63
    v_lshl_add_u32 v89, v73, 2, s60
    ds_add_rtn_u32 v81, v89, v116
    v_mul_hi_u32 v74, v10, s63
    v_lshl_add_u32 v90, v74, 2, s60
    ds_add_rtn_u32 v82, v90, v116
    v_mul_hi_u32 v75, v11, s63
    v_lshl_add_u32 v91, v75, 2, s60
    ds_add_rtn_u32 v83, v91, v116
    v_mad_i32_i24 v4, v68, s65, v4
    v_lshlrev_b32 v4, 24, v4
    v_lshl_add_u32 v84, v68, 7, s61
    v_mad_i32_i24 v5, v69, s65, v5
    v_lshlrev_b32 v5, 24, v5
    v_lshl_add_u32 v85, v69, 7, s61
    v_mad_i32_i24 v6, v70, s65, v6
    v_lshlrev_b32 v6, 24, v6
    v_lshl_add_u32 v86, v70, 7, s61
    v_mad_i32_i24 v7, v71, s65, v7
    v_lshlrev_b32 v7, 24, v7
    v_lshl_add_u32 v87, v71, 7, s61
    v_mad_i32_i24 v8, v72, s65, v8
    v_lshlrev_b32 v8, 24, v8
    v_lshl_add_u32 v88, v72, 7, s61
    v_mad_i32_i24 v9, v73, s65, v9
    v_lshlrev_b32 v9, 24, v9
    v_lshl_add_u32 v89, v73, 7, s61
    v_mad_i32_i24 v10, v74, s65, v10
    v_lshlrev_b32 v10, 24, v10
    v_lshl_add_u32 v90, v74, 7, s61
    v_mad_i32_i24 v11, v75, s65, v11
    v_lshlrev_b32 v11, 24, v11
    v_lshl_add_u32 v91, v75, 7, s61
WUP_548:
    s_cbranch_execz WUP_721
    s_waitcnt vmcnt(22)
    v_lshl_or_b32 v92, v12, 1, v4
    v_lshl_or_b32 v93, v13, 1, v5
    v_lshl_or_b32 v94, v14, 1, v6
    v_lshl_or_b32 v95, v15, 1, v7
    v_lshl_or_b32 v96, v16, 1, v8
    v_lshl_or_b32 v97, v17, 1, v9
    v_lshl_or_b32 v98, v18, 1, v10
    v_lshl_or_b32 v99, v19, 1, v11
    s_waitcnt lgkmcnt(0)
    v_max3_u32 v36, v76, v77, v78
    v_max3_u32 v37, v79, v80, v81
    v_max3_u32 v36, v36, v82, v83
    v_max_u32 v36, v36, v37
    v_lshl_add_u32 v12, v76, 2, v84
    v_lshl_add_u32 v13, v77, 2, v85
    v_lshl_add_u32 v14, v78, 2, v86
    v_lshl_add_u32 v15, v79, 2, v87
    v_lshl_add_u32 v16, v80, 2, v88
    v_lshl_add_u32 v17, v81, 2, v89
    v_lshl_add_u32 v18, v82, 2, v90
    v_lshl_add_u32 v19, v83, 2, v91
    v_cmp_lt_u32 vcc, 30, v36
    s_nop 4
    s_cbranch_vccnz P_rare
    ds_write_b32 v12, v92
    ds_write_b32 v13, v93
    ds_write_b32 v14, v94
    ds_write_b32 v15, v95
    ds_write_b32 v16, v96
    ds_write_b32 v17, v97
    ds_write_b32 v18, v98
    ds_write_b32 v19, v99
    s_mov_b64 exec, -1
P_join:
    s_lshl_b32 s23, s2, 15
    v_mov_b32 v4, 131072
    s_waitcnt lgkmcnt(0)
    s_mov_b64 exec, 0
    s_cmp_eq_u32 s26, 0
    s_cbranch_scc1 WUP_1989
    s_cmp_eq_u32 s26, 1
    s_cbranch_scc1 WUP_2334
    s_cmp_eq_u32 s26, 2
    s_cbranch_scc1 WUP_2509
    s_cmp_eq_u32 s26, 3
    s_cbranch_scc1 WUP_2657
WUR_1:
    s_mov_b64 exec, -1
    s_barrier
    ds_read_b64 v[4:5], v4
    ds_read_b128 v[100:103], v117 offset:0
    ds_read_b128 v[104:107], v117 offset:8192
    ds_read_b128 v[108:111], v117 offset:16384
    ds_read_b128 v[112:115], v117 offset:24576
    s_waitcnt lgkmcnt(4)
    v_readfirstlane_b32 s18, v4
    v_readfirstlane_b32 s19, v5
    s_bfe_u32 s8, s18, 0x70001
    s_lshl_b32 s8, s8, 17
    s_bfe_u32 s27, s18, 0x10000
    s_or_b32 s8, s8, s27
    s_bfe_u32 s9, s18, 0x70009
    s_lshl_b32 s9, s9, 17
    s_bfe_u32 s27, s18, 0x10008
    s_or_b32 s9, s9, s27
    s_bfe_u32 s10, s18, 0x70011
    s_lshl_b32 s10, s10, 17
    s_bfe_u32 s27, s18, 0x10010
    s_or_b32 s10, s10, s27
    s_bfe_u32 s11, s18, 0x70019
    s_lshl_b32 s11, s11, 17
    s_bfe_u32 s27, s18, 0x10018
    s_or_b32 s11, s11, s27
    s_cmp_eq_u32 s19, 0
    s_cbranch_scc1 P_noovf
    v_mov_b32 v4, 131080
    ds_read_b32 v4, v4
    v_mov_b32 v5, 0
    s_add_u32 s27, s23, 32124
    s_waitcnt lgkmcnt(0)
    buffer_store_dword v4, v5, s[36:39], s27 offen sc1
    s_waitcnt vmcnt(0)
    s_barrier
P_noovf:
    s_waitcnt lgkmcnt(3)
    v_xor_b32 v100, s8, v100
    v_xor_b32 v101, s9, v101
    v_xor_b32 v102, s10, v102
    v_xor_b32 v103, s11, v103
    buffer_store_dwordx4 v[100:103], v2, s[36:39], s23 offen sc1
    s_waitcnt lgkmcnt(2)
    v_xor_b32 v104, s8, v104
    v_xor_b32 v105, s9, v105
    v_xor_b32 v106, s10, v106
    v_xor_b32 v107, s11, v107
    s_add_u32 s59, s23, 8192
    buffer_store_dwordx4 v[104:107], v2, s[36:39], s59 offen sc1
    s_waitcnt lgkmcnt(1)
    v_xor_b32 v108, s8, v108
    v_xor_b32 v109, s9, v109
    v_xor_b32 v110, s10, v110
    v_xor_b32 v111, s11, v111
    s_add_u32 s59, s23, 16384
    buffer_store_dwordx4 v[108:111], v2, s[36:39], s59 offen sc1
    s_waitcnt lgkmcnt(0)
    v_xor_b32 v112, s8, v112
    v_xor_b32 v113, s9, v113
    v_xor_b32 v114, s10, v114
    v_xor_b32 v115, s11, v115
    s_mov_b64 exec, s[66:67]
    s_add_u32 s59, s23, 24576
    buffer_store_dwordx4 v[112:115], v2, s[36:39], s59 offen sc1
    s_mov_b64 exec, -1
    ds_read_b64_tr_b16 v[36:37], v122 offset:0
    ds_read_b64_tr_b16 v[38:39], v122 offset:512
    ds_read_b64_tr_b16 v[40:41], v122 offset:4096
    ds_read_b64_tr_b16 v[42:43], v122 offset:4608
    ds_read_b64_tr_b16 v[44:45], v122 offset:32
    ds_read_b64_tr_b16 v[46:47], v122 offset:544
    ds_read_b64_tr_b16 v[48:49], v122 offset:4128
    ds_read_b64_tr_b16 v[50:51], v122 offset:4640
    ds_read_b64_tr_b16 v[52:53], v122 offset:64
    ds_read_b64_tr_b16 v[54:55], v122 offset:576
    ds_read_b64_tr_b16 v[56:57], v122 offset:4160
    ds_read_b64_tr_b16 v[58:59], v122 offset:4672
    ds_read_b64_tr_b16 v[60:61], v122 offset:96
    ds_read_b64_tr_b16 v[62:63], v122 offset:608
    ds_read_b64_tr_b16 v[64:65], v122 offset:4192
    ds_read_b64_tr_b16 v[66:67], v122 offset:4704
    v_and_b32 v250, -2, v1
    v_add_lshl_u32 v250, v250, v1, 7
    v_cmp_gt_u32 vcc, 10, v1
    s_nop 1
    v_cndmask_b32 v250, v118, v250, vcc
    s_mul_i32 s65, s2, 102400
    s_mul_i32 s63, s26, 12800
    s_add_u32 s65, s65, s63
    buffer_load_dword v158, v250, s[28:31], s65 offen offset:256
    v_mov_b32 v5, 0xbfb8aa3b
    v_mov_b32 v6, 1.0
    v_lshlrev_b32 v123, 9, v119
    v_lshl_add_u32 v123, v120, 3, v123
    s_lshl_b32 s27, s62, 7
    s_waitcnt lgkmcnt(0)
    s_barrier
    s_mul_i32 s20, s2, 102400
    s_mul_i32 s21, s26, 12800
    s_add_u32 s20, s20, s21
    s_add_u32 s20, s4, s20
    s_addc_u32 s21, s5, 0
    s_waitcnt vmcnt(23)
    s_cmp_gt_u32 s26, 4
    s_cbranch_scc0 P_np
    s_setprio 2
P_np:
    v_mfma_f32_16x16x32_bf16 v[68:71], v[20:23], v[36:39], 0
    v_mfma_f32_16x16x32_bf16 v[72:75], v[20:23], v[44:47], 0
    v_mfma_f32_16x16x32_bf16 v[76:79], v[20:23], v[52:55], 0
    v_mfma_f32_16x16x32_bf16 v[80:83], v[20:23], v[60:63], 0
    v_mfma_f32_16x16x32_bf16 v[68:71], v[24:27], v[40:43], v[68:71]
    v_mfma_f32_16x16x32_bf16 v[72:75], v[24:27], v[48:51], v[72:75]
    v_mfma_f32_16x16x32_bf16 v[76:79], v[24:27], v[56:59], v[76:79]
    v_mfma_f32_16x16x32_bf16 v[80:83], v[24:27], v[64:67], v[80:83]
    s_nop 4
    v_cvt_pk_bf16_f32 v68, 0, v68
    v_cvt_pk_bf16_f32 v69, 0, v69
    v_cvt_pk_bf16_f32 v70, 0, v70
    v_cvt_pk_bf16_f32 v71, 0, v71
    v_cvt_pk_bf16_f32 v72, 0, v72
    v_cvt_pk_bf16_f32 v73, 0, v73
    v_cvt_pk_bf16_f32 v74, 0, v74
    v_cvt_pk_bf16_f32 v75, 0, v75
    v_cvt_pk_bf16_f32 v76, 0, v76
    v_cvt_pk_bf16_f32 v77, 0, v77
    v_cvt_pk_bf16_f32 v78, 0, v78
    v_cvt_pk_bf16_f32 v79, 0, v79
WUP_721:
    s_cbranch_execz WUR_0
    v_cvt_pk_bf16_f32 v80, 0, v80
    v_cvt_pk_bf16_f32 v81, 0, v81
    v_cvt_pk_bf16_f32 v82, 0, v82
    v_cvt_pk_bf16_f32 v83, 0, v83
    v_mul_f32 v84, v5, v68
    v_mul_f32 v85, v5, v69
    v_mul_f32 v86, v5, v70
    v_mul_f32 v87, v5, v71
    v_mul_f32 v88, v5, v72
    v_mul_f32 v89, v5, v73
    v_mul_f32 v90, v5, v74
    v_mul_f32 v91, v5, v75
    v_mul_f32 v92, v5, v76
    v_mul_f32 v93, v5, v77
    v_mul_f32 v94, v5, v78
    v_mul_f32 v95, v5, v79
    v_mul_f32 v96, v5, v80
    v_mul_f32 v97, v5, v81
    v_mul_f32 v98, v5, v82
    v_mul_f32 v99, v5, v83
    v_exp_f32 v84, v84
    v_exp_f32 v85, v85
    v_exp_f32 v86, v86
    v_exp_f32 v87, v87
    v_exp_f32 v88, v88
    v_exp_f32 v89, v89
    v_exp_f32 v90, v90
    v_exp_f32 v91, v91
    v_exp_f32 v92, v92
    v_exp_f32 v93, v93
    v_exp_f32 v94, v94
    v_exp_f32 v95, v95
    v_exp_f32 v96, v96
    v_exp_f32 v97, v97
    v_exp_f32 v98, v98
    v_exp_f32 v99, v99
    v_add_f32 v84, v6, v84
    v_add_f32 v85, v6, v85
    v_add_f32 v86, v6, v86
    v_add_f32 v87, v6, v87
    v_add_f32 v88, v6, v88
    v_add_f32 v89, v6, v89
    v_add_f32 v90, v6, v90
    v_add_f32 v91, v6, v91
    v_add_f32 v92, v6, v92
    v_add_f32 v93, v6, v93
    v_add_f32 v94, v6, v94
    v_add_f32 v95, v6, v95
    v_add_f32 v96, v6, v96
    v_add_f32 v97, v6, v97
    v_add_f32 v98, v6, v98
    v_add_f32 v99, v6, v99
    v_rcp_f32 v84, v84
    v_rcp_f32 v85, v85
    v_rcp_f32 v86, v86
    v_rcp_f32 v87, v87
    v_rcp_f32 v88, v88
    v_rcp_f32 v89, v89
    v_rcp_f32 v90, v90
    v_rcp_f32 v91, v91
    v_rcp_f32 v92, v92
    v_rcp_f32 v93, v93
    v_rcp_f32 v94, v94
    v_rcp_f32 v95, v95
    v_rcp_f32 v96, v96
    v_rcp_f32 v97, v97
    v_rcp_f32 v98, v98
    v_rcp_f32 v99, v99
    v_mul_f32 v84, v68, v84
    v_mul_f32 v85, v69, v85
    v_mul_f32 v86, v70, v86
    v_mul_f32 v87, v71, v87
    v_mul_f32 v88, v72, v88
    v_mul_f32 v89, v73, v89
    v_mul_f32 v90, v74, v90
    v_mul_f32 v91, v75, v91
    v_mul_f32 v92, v76, v92
    v_mul_f32 v93, v77, v93
    v_mul_f32 v94, v78, v94
    v_mul_f32 v95, v79, v95
    v_mul_f32 v96, v80, v96
    v_mul_f32 v97, v81, v97
    v_mul_f32 v98, v82, v98
    v_mul_f32 v99, v83, v99
    s_mov_b32 s63, 0x830100
    s_cmp_gt_u32 s26, 4
    s_cselect_b32 s63, s63, 0x40000000
    buffer_load_dwordx4 v[236:239], v3, s[36:39], s63 offen sc1
    v_cvt_pk_bf16_f32 v68, v84, v88
    v_cvt_pk_bf16_f32 v69, v92, v96
    buffer_store_dwordx2 v[68:69], v123, s[72:75], s27 offen offset:0 sc1
    v_cvt_pk_bf16_f32 v70, v85, v89
    v_cvt_pk_bf16_f32 v71, v93, v97
    buffer_store_dwordx2 v[70:71], v123, s[72:75], s27 offen offset:128 sc1
    v_cvt_pk_bf16_f32 v72, v86, v90
    v_cvt_pk_bf16_f32 v73, v94, v98
    buffer_store_dwordx2 v[72:73], v123, s[72:75], s27 offen offset:256 sc1
    v_cvt_pk_bf16_f32 v74, v87, v91
    v_cvt_pk_bf16_f32 v75, v95, v99
    buffer_store_dwordx2 v[74:75], v123, s[72:75], s27 offen offset:384 sc1
    s_cmp_gt_u32 s26, 4
    s_cbranch_scc1 M_e4x
    s_cmp_eq_u32 s26, 4
    s_cselect_b32 s63, 2, 4
    v_cmp_gt_u32 vcc, s63, v119
    s_nop 1
    v_cndmask_b32 v7, v118, v123, vcc
    s_add_u32 s27, s27, 16384
    v_mfma_f32_16x16x32_bf16 v[68:71], v[28:31], v[36:39], 0
    v_mfma_f32_16x16x32_bf16 v[72:75], v[28:31], v[44:47], 0
    v_mfma_f32_16x16x32_bf16 v[76:79], v[28:31], v[52:55], 0
    v_mfma_f32_16x16x32_bf16 v[80:83], v[28:31], v[60:63], 0
    v_mfma_f32_16x16x32_bf16 v[68:71], v[32:35], v[40:43], v[68:71]
    v_mfma_f32_16x16x32_bf16 v[72:75], v[32:35], v[48:51], v[72:75]
    v_mfma_f32_16x16x32_bf16 v[76:79], v[32:35], v[56:59], v[76:79]
    v_mfma_f32_16x16x32_bf16 v[80:83], v[32:35], v[64:67], v[80:83]
    s_nop 4
    v_cvt_pk_bf16_f32 v68, 0, v68
    v_cvt_pk_bf16_f32 v69, 0, v69
    v_cvt_pk_bf16_f32 v70, 0, v70
    v_cvt_pk_bf16_f32 v71, 0, v71
    v_cvt_pk_bf16_f32 v72, 0, v72
    v_cvt_pk_bf16_f32 v73, 0, v73
    v_cvt_pk_bf16_f32 v74, 0, v74
    v_cvt_pk_bf16_f32 v75, 0, v75
    v_cvt_pk_bf16_f32 v76, 0, v76
    v_cvt_pk_bf16_f32 v77, 0, v77
    v_cvt_pk_bf16_f32 v78, 0, v78
    v_cvt_pk_bf16_f32 v79, 0, v79
    v_cvt_pk_bf16_f32 v80, 0, v80
    v_cvt_pk_bf16_f32 v81, 0, v81
    v_cvt_pk_bf16_f32 v82, 0, v82
    v_cvt_pk_bf16_f32 v83, 0, v83
    v_mul_f32 v84, v5, v68
    v_mul_f32 v85, v5, v69
    v_mul_f32 v86, v5, v70
    v_mul_f32 v87, v5, v71
    v_mul_f32 v88, v5, v72
    v_mul_f32 v89, v5, v73
    v_mul_f32 v90, v5, v74
    v_mul_f32 v91, v5, v75
    v_mul_f32 v92, v5, v76
    v_mul_f32 v93, v5, v77
    v_mul_f32 v94, v5, v78
    v_mul_f32 v95, v5, v79
    v_mul_f32 v96, v5, v80
    v_mul_f32 v97, v5, v81
    v_mul_f32 v98, v5, v82
    v_mul_f32 v99, v5, v83
    v_exp_f32 v84, v84
    v_exp_f32 v85, v85
    v_exp_f32 v86, v86
    v_exp_f32 v87, v87
    v_exp_f32 v88, v88
    v_exp_f32 v89, v89
    v_exp_f32 v90, v90
    v_exp_f32 v91, v91
    v_exp_f32 v92, v92
    v_exp_f32 v93, v93
    v_exp_f32 v94, v94
    v_exp_f32 v95, v95
    v_exp_f32 v96, v96
    v_exp_f32 v97, v97
    v_exp_f32 v98, v98
    v_exp_f32 v99, v99
    v_add_f32 v84, v6, v84
    v_add_f32 v85, v6, v85
    v_add_f32 v86, v6, v86
    v_add_f32 v87, v6, v87
    v_add_f32 v88, v6, v88
    v_add_f32 v89, v6, v89
    v_add_f32 v90, v6, v90
    v_add_f32 v91, v6, v91
    v_add_f32 v92, v6, v92
    v_add_f32 v93, v6, v93
    v_add_f32 v94, v6, v94
    v_add_f32 v95, v6, v95
    v_add_f32 v96, v6, v96
    v_add_f32 v97, v6, v97
    v_add_f32 v98, v6, v98
    v_add_f32 v99, v6, v99
    v_rcp_f32 v84, v84
    v_rcp_f32 v85, v85
    v_rcp_f32 v86, v86
    v_rcp_f32 v87, v87
    v_rcp_f32 v88, v88
    v_rcp_f32 v89, v89
    v_rcp_f32 v90, v90
    v_rcp_f32 v91, v91
    v_rcp_f32 v92, v92
    v_rcp_f32 v93, v93
    v_rcp_f32 v94, v94
    v_rcp_f32 v95, v95
    v_rcp_f32 v96, v96
    v_rcp_f32 v97, v97
    v_rcp_f32 v98, v98
    v_rcp_f32 v99, v99
    v_mul_f32 v84, v68, v84
    v_mul_f32 v85, v69, v85
    v_mul_f32 v86, v70, v86
    v_mul_f32 v87, v71, v87
    v_mul_f32 v88, v72, v88
    v_mul_f32 v89, v73, v89
    v_mul_f32 v90, v74, v90
    v_mul_f32 v91, v75, v91
    v_mul_f32 v92, v76, v92
    v_mul_f32 v93, v77, v93
    v_mul_f32 v94, v78, v94
    v_mul_f32 v95, v79, v95
    v_mul_f32 v96, v80, v96
    v_mul_f32 v97, v81, v97
    v_mul_f32 v98, v82, v98
    v_mul_f32 v99, v83, v99
    v_cvt_pk_bf16_f32 v68, v84, v88
WUP_935:
    s_cbranch_execz WUP_1119
    v_cvt_pk_bf16_f32 v69, v92, v96
    buffer_store_dwordx2 v[68:69], v7, s[72:75], s27 offen offset:0 sc1
    v_cvt_pk_bf16_f32 v70, v85, v89
    v_cvt_pk_bf16_f32 v71, v93, v97
    buffer_store_dwordx2 v[70:71], v7, s[72:75], s27 offen offset:128 sc1
    v_cvt_pk_bf16_f32 v72, v86, v90
    v_cvt_pk_bf16_f32 v73, v94, v98
    buffer_store_dwordx2 v[72:73], v7, s[72:75], s27 offen offset:256 sc1
    v_cvt_pk_bf16_f32 v74, v87, v91
    v_cvt_pk_bf16_f32 v75, v95, v99
    buffer_store_dwordx2 v[74:75], v7, s[72:75], s27 offen offset:384 sc1
    s_nop 0
P_h2:
    s_mov_b32 s56, 0x05040100
    s_mov_b32 s57, 0x07060302
    s_waitcnt vmcnt(14)
M_e5:
    s_lshr_b32 s60, s26, 2
    s_and_b32 s61, s26, 3
    s_lshl_b32 s60, s60, 3
    s_add_u32 s60, s60, s61
    s_lshl_b32 s60, s60, 10
    s_movk_i32 s61, 4096
    v_perm_b32 v148, v129, v128, s56
    v_perm_b32 v152, v129, v128, s57
    v_perm_b32 v149, v131, v130, s56
    v_perm_b32 v153, v131, v130, s57
    v_perm_b32 v150, v133, v132, s56
    v_perm_b32 v154, v133, v132, s57
    v_perm_b32 v151, v135, v134, s56
    v_perm_b32 v155, v135, v134, s57
    v_add_u32 v156, s60, v3
    v_add_u32 v157, s61, v156
    ds_write_b128 v156, v[148:151]
    ds_write_b128 v157, v[152:155]
    s_cmp_eq_u32 s26, 7
    s_cbranch_scc1 M_w2
    s_add_u32 s27, s26, 8
    s_lshr_b32 s60, s27, 2
    s_and_b32 s61, s27, 3
    s_lshl_b32 s60, s60, 3
    s_add_u32 s60, s60, s61
    s_lshl_b32 s60, s60, 10
    s_movk_i32 s61, 4096
    s_cmp_lt_u32 s26, 4
    s_cbranch_scc1 M_w1
    s_sub_u32 s60, s26, 4
    s_lshl_b32 s60, s60, 11
    s_add_u32 s60, s60, 24576
    s_movk_i32 s61, 1024
M_w1:
    v_perm_b32 v148, v137, v136, s56
    v_perm_b32 v152, v137, v136, s57
    v_perm_b32 v149, v139, v138, s56
    v_perm_b32 v153, v139, v138, s57
    v_perm_b32 v150, v141, v140, s56
    v_perm_b32 v154, v141, v140, s57
    v_perm_b32 v151, v143, v142, s56
    v_perm_b32 v155, v143, v142, s57
    v_add_u32 v156, s60, v3
    v_add_u32 v157, s61, v156
    ds_write_b128 v156, v[148:151]
    ds_write_b128 v157, v[152:155]
M_w2:
    s_cmp_ge_u32 s26, 4
    s_cbranch_scc1 M_t4
    v_bfe_i32 v148, v0, 0, 1
    v_mov_b32 v149, 0x01000c0c
    s_mov_b32 s63, 0x02020000
    v_and_or_b32 v148, v148, s63, v149
    v_add_u32 v149, s63, v148
    v_add_u32 v150, s63, v149
    v_perm_b32 v152, v145, v144, v148
    v_perm_b32 v153, v145, v144, v149
    v_perm_b32 v154, v145, v144, v150
    s_mov_b32 s60, 0x41800000
    v_mul_f32 v148, s60, v152
    v_mul_f32 v149, s60, v153
    v_mul_f32 v150, s60, v154
    v_cvt_flr_i32_f32 v148, v148
    v_cvt_flr_i32_f32 v149, v149
    v_cvt_flr_i32_f32 v150, v150
    v_sub_u32 v148, 4, v148
    v_sub_u32 v149, 4, v149
    v_sub_u32 v150, 2, v150
    v_and_b32 v148, 0xff, v148
    v_and_b32 v149, 0xff, v149
    v_and_b32 v150, 0xff, v150
    v_lshl_or_b32 v148, v149, 8, v148
    v_lshl_or_b32 v148, v150, 16, v148
    v_mov_b32 v149, 0x7f000000
    v_cmp_gt_u32 vcc, 200, v0
    s_nop 1
    v_cndmask_b32 v148, v149, v148, vcc
    v_lshlrev_b32 v150, 2, v0
    v_add_u32 v150, 133120, v150
    ds_write_b32 v150, v148
    v_lshlrev_b32 v150, 4, v0
    v_add_u32 v150, 135168, v150
    s_mov_b64 exec, vcc
    ds_write_b96 v150, v[152:154]
    s_mov_b64 exec, -1
    s_branch M_t8
M_t4:
    s_cmp_eq_u32 s26, 4
    s_cbranch_scc0 M_t5
    v_lshlrev_b32 v150, 2, v1
    v_add_u32 v151, 132864, v150
    v_mov_b32 v148, 0
    ds_write_b32 v151, v148
    v_mov_b32 v151, 132672
    ds_write_b32 v151, v148
    v_add_u32 v151, 132608, v150
    v_lshlrev_b32 v148, 16, v146
    s_mov_b64 exec, 0xffff
    ds_write_b32 v151, v148
    s_mov_b64 exec, -1
    s_branch M_t8
M_t5:
M_t8:
    v_lshrrev_b32 v24, 2, v1
    v_lshlrev_b32 v24, 15, v24
    v_and_b32 v25, 3, v1
    v_lshl_add_u32 v24, v25, 4, v24
    s_lshl_b32 s27, s26, 20
    s_lshl_b32 s53, s2, 7
    s_add_u32 s27, s27, s53
    s_add_u32 s53, s27, 524288
    s_mov_b64 s[60:61], -1
    s_cmp_eq_u32 s26, 7
    s_cselect_b32 s61, 0xff, s61
    s_xor_b32 s63, s8, 0xff000000
    v_mov_b32 v164, s63
    v_mov_b32 v172, s63
    s_xor_b32 s63, s9, 0xff000000
    v_mov_b32 v165, s63
    v_mov_b32 v173, s63
    s_xor_b32 s63, s10, 0xff000000
    v_mov_b32 v166, s63
    v_mov_b32 v174, s63
    s_xor_b32 s63, s11, 0xff000000
    v_mov_b32 v167, s63
    v_mov_b32 v175, s63
    buffer_load_dwordx4 v[160:163], v24, s[36:39], s27 offen sc1
    s_mov_b64 exec, s[60:61]
    buffer_load_dwordx4 v[164:167], v24, s[36:39], s53 offen sc1
    s_mov_b64 exec, -1
    buffer_load_dwordx4 v[168:171], v24, s[36:39], s27 offen offset:64 sc1
    s_mov_b64 exec, s[60:61]
    buffer_load_dwordx4 v[172:175], v24, s[36:39], s53 offen offset:64 sc1
    s_mov_b64 exec, -1
    v_lshlrev_b32 v1, 4, v1
    v_lshrrev_b32 v8, 4, v1
    v_lshrrev_b32 v10, 5, v8
    v_and_b32 v11, 31, v8
    s_mov_b32 s6, 0x186a000
    s_mov_b32 s7, 0x00020000
    s_mul_i32 s44, s2, 102400
    s_mul_i32 s51, s26, 12800
    s_add_u32 s51, s51, 30720
    s_mul_i32 s52, s26, 3840
    s_add_u32 s52, s52, 133120
    s_mov_b32 s67, 120320
    s_mov_b32 s3, 132864
    v_lshrrev_b32 v8, 4, v1
    v_lshrrev_b32 v10, 5, v8
    v_and_b32 v11, 31, v8
    v_lshlrev_b32 v3, 4, v11
    v_add_u32 v3, s52, v3
    v_mul_u32_u24 v0, 56, v10
    v_add_u32 v0, s52, v0
    v_lshrrev_b32 v13, 3, v11
    v_lshl_add_u32 v4, v13, 3, v0
    v_lshrrev_b32 v13, 3, v8
    v_and_b32 v14, 1, v13
    v_lshrrev_b32 v13, 1, v13
    v_lshl_add_u32 v13, v14, 2, v13
    v_lshlrev_b32 v5, 4, v13
    v_add_u32 v5, s52, v5
    v_add_u32 v16, s52, v1
    v_lshrrev_b32 v17, 2, v8
    v_mul_u32_u24 v17, 56, v17
    v_and_b32 v13, 3, v8
    v_lshl_add_u32 v17, v13, 1, v17
    v_add_u32 v17, s52, v17
    v_lshlrev_b32 v2, 7, v10
    v_lshl_add_u32 v2, v11, 2, v2
    v_add_u32 v2, s51, v2
    v_and_b32 v13, 7, v11
    v_lshlrev_b32 v13, 1, v13
    v_sub_u32 v13, 14, v13
WUP_1119:
    s_cbranch_execz WUR_0
    v_lshl_or_b32 v6, v13, 16, v13
    v_lshlrev_b32 v7, 5, v10
    v_add_u32 v7, 132608, v7
    v_lshlrev_b32 v20, 2, v8
    v_add_u32 v30, 132864, v20
    v_mov_b32 v9, 132672
    v_mov_b32 v18, 0xfc
    v_mov_b32 v19, 1
    v_mov_b32 v192, 0
    v_mov_b32 v193, 0
    v_mov_b32 v194, 0
    v_mov_b32 v195, 0
    v_mov_b32 v196, 0
    v_mov_b32 v197, 0
    v_mov_b32 v198, 0
    v_mov_b32 v199, 0
    v_mov_b32 v200, 0
    v_mov_b32 v201, 0
    v_mov_b32 v202, 0
    v_mov_b32 v203, 0
    v_mov_b32 v204, 0
    v_mov_b32 v205, 0
    v_mov_b32 v206, 0
    v_mov_b32 v207, 0
    v_mov_b32 v208, 0
    v_mov_b32 v209, 0
    v_mov_b32 v210, 0
    v_mov_b32 v211, 0
    v_mov_b32 v212, 0
    v_mov_b32 v213, 0
    v_mov_b32 v214, 0
    v_mov_b32 v215, 0
    v_mov_b32 v216, 0
    v_mov_b32 v217, 0
    v_mov_b32 v218, 0
    v_mov_b32 v219, 0
    v_mov_b32 v220, 0
    v_mov_b32 v221, 0
    v_mov_b32 v222, 0
    v_mov_b32 v223, 0
    v_mov_b32 v224, 0
    v_mov_b32 v225, 0
    v_mov_b32 v226, 0
    v_mov_b32 v227, 0
    v_mov_b32 v228, 0
    v_mov_b32 v229, 0
    v_mov_b32 v230, 0
    v_mov_b32 v231, 0
    v_mov_b32 v232, 0
    v_mov_b32 v233, 0
    v_mov_b32 v234, 0
    v_mov_b32 v235, 0
    v_mov_b32 v236, 0
    v_mov_b32 v237, 0
    v_mov_b32 v238, 0
    v_mov_b32 v239, 0
    v_mov_b32 v240, 0
    v_mov_b32 v241, 0
    v_mov_b32 v242, 0
    v_mov_b32 v243, 0
    v_mov_b32 v244, 0
    v_mov_b32 v245, 0
    v_mov_b32 v246, 0
    v_mov_b32 v247, 0
    v_mov_b32 v248, 0
    v_mov_b32 v249, 0
    v_mov_b32 v250, 0
    v_mov_b32 v251, 0
    v_mov_b32 v252, 0
    v_mov_b32 v253, 0
    v_mov_b32 v254, 0
    v_mov_b32 v255, 0
    s_mov_b32 s12, 0x1fffe
    s_movk_i32 s13, 130
    s_mov_b32 s14, 0xfc0000
    s_movk_i32 s15, 7800
    s_lshl_b32 s17, s26, 10
    s_add_u32 s17, s17, 138368
    s_mov_b32 s16, s17
    v_add_u32 v26, 134144, v20
    v_add_u32 v27, 134144, v1
    s_mov_b32 s62, 0xfe0001
    s_mov_b32 s65, 0
M_cw:
    s_waitcnt vmcnt(0)
    v_xor_b32 v176, s8, v160
    v_xor_b32 v177, s9, v161
    v_xor_b32 v178, s10, v162
    v_xor_b32 v179, s11, v163
    v_xor_b32 v180, s8, v164
    v_xor_b32 v181, s9, v165
    v_xor_b32 v182, s10, v166
    v_xor_b32 v183, s11, v167
    v_xor_b32 v184, s8, v168
    v_xor_b32 v185, s9, v169
    v_xor_b32 v186, s10, v170
    v_xor_b32 v187, s11, v171
    v_xor_b32 v188, s8, v172
    v_xor_b32 v189, s9, v173
    v_xor_b32 v190, s10, v174
    v_xor_b32 v191, s11, v175
    v_or3_b32 v148, v176, v177, v178
    v_or3_b32 v148, v148, v179, v180
    v_or3_b32 v148, v148, v181, v182
    v_or3_b32 v148, v148, v183, v184
    v_or3_b32 v148, v148, v185, v186
    v_or3_b32 v148, v148, v187, v188
    v_or3_b32 v148, v148, v189, v190
    v_or_b32 v148, v148, v191
    v_and_b32 v148, s62, v148
    v_cmp_ne_u32 vcc, 0, v148
    s_nop 4
    s_cbranch_vccz M_cok
    s_add_u32 s65, s65, 1
    s_cmp_lt_u32 s65, 16384
    s_cbranch_scc0 M_cok
    s_sleep 4
    buffer_load_dwordx4 v[160:163], v24, s[36:39], s27 offen sc1
    s_mov_b64 exec, s[60:61]
    buffer_load_dwordx4 v[164:167], v24, s[36:39], s53 offen sc1
    s_mov_b64 exec, -1
    buffer_load_dwordx4 v[168:171], v24, s[36:39], s27 offen offset:64 sc1
    s_mov_b64 exec, s[60:61]
    buffer_load_dwordx4 v[172:175], v24, s[36:39], s53 offen offset:64 sc1
    s_mov_b64 exec, -1
    s_branch M_cw
M_cok:
    s_waitcnt lgkmcnt(0)
    s_barrier
    s_cmp_eq_u32 s26, 5
    s_cbranch_scc0 M_f1
    s_lshl_b32 s27, s2, 2
    s_add_u32 s27, s27, 0x830800
    v_mov_b32 v148, s18
    v_mov_b32 v149, 0
    s_mov_b64 exec, 1
    buffer_store_dword v148, v149, s[36:39], s27 offen sc1
    s_mov_b64 exec, -1
M_f1:
    v_add_u32 v159, 10, v8
    v_and_b32 v157, -2, v159
    v_add_lshl_u32 v159, v157, v159, 7
    v_cmp_gt_u32 vcc, 40, v8
    v_bfrev_b32 v157, 2
    s_nop 0
    v_cndmask_b32 v159, v157, v159, vcc
    s_mul_i32 s27, s26, 12800
    s_add_u32 s27, s27, s44
    buffer_load_dword v63, v159, s[28:31], s27 offen offset:256
    v_and_b32 v64, s12, v176
    v_alignbit_b32 v65, s13, v176, 22
    ds_read_u16 v64, v64 offset:30720
    ds_read_b32 v65, v65
    v_and_b32 v66, s12, v177
    v_alignbit_b32 v67, s13, v177, 22
    ds_read_u16 v66, v66 offset:30720
    ds_read_b32 v67, v67
    v_and_b32 v68, s12, v178
    v_alignbit_b32 v69, s13, v178, 22
    ds_read_u16 v68, v68 offset:30720
    ds_read_b32 v69, v69
    v_and_b32 v70, s12, v179
    v_alignbit_b32 v71, s13, v179, 22
    ds_read_u16 v70, v70 offset:30720
    ds_read_b32 v71, v71
    v_and_b32 v72, s12, v180
    v_alignbit_b32 v73, s13, v180, 22
    ds_read_u16 v72, v72 offset:30720
    ds_read_b32 v73, v73
    v_and_b32 v74, s12, v181
    v_alignbit_b32 v75, s13, v181, 22
    ds_read_u16 v74, v74 offset:30720
    ds_read_b32 v75, v75
    v_and_b32 v76, s12, v182
    v_alignbit_b32 v77, s13, v182, 22
    ds_read_u16 v76, v76 offset:30720
    ds_read_b32 v77, v77
    v_and_b32 v78, s12, v183
    v_alignbit_b32 v79, s13, v183, 22
WUP_1295:
    s_cbranch_execz WUP_1452
    ds_read_u16 v78, v78 offset:30720
    ds_read_b32 v79, v79
    s_mov_b32 s63, 0xc8000000
    s_lshl_b32 s59, s26, 11
    s_add_u32 s59, s59, 146560
    s_mov_b32 s60, s59
    v_cmp_gt_u32 s[54:55], s63, v184
    s_nop 1
    v_mbcnt_lo_u32_b32 v148, s54, 0
    v_mbcnt_hi_u32_b32 v148, s55, v148
    v_lshl_add_u32 v148, v148, 4, s60
    s_bcnt1_i32_b64 s27, s[54:55]
    s_lshl4_add_u32 s60, s27, s60
    v_cndmask_b32 v148, v27, v148, s[54:55]
    ds_write_b128 v148, v[184:187]
    v_cmp_gt_u32 s[54:55], s63, v188
    s_nop 1
    v_mbcnt_lo_u32_b32 v148, s54, 0
    v_mbcnt_hi_u32_b32 v148, s55, v148
    v_lshl_add_u32 v148, v148, 4, s60
    s_bcnt1_i32_b64 s27, s[54:55]
    s_lshl4_add_u32 s60, s27, s60
    v_cndmask_b32 v148, v27, v148, s[54:55]
    ds_write_b128 v148, v[188:191]
    s_mov_b32 s63, 0xff000000
    v_cmp_lt_u32 s[68:69], s63, v187
    v_cmp_lt_u32 s[70:71], s63, v191
    s_waitcnt lgkmcnt(10)
    v_and_b32 v96, 0x0707, v64
    v_and_b32 v97, 0x0707, v66
    v_and_b32 v98, 0x0707, v68
    v_and_b32 v99, 0x0707, v70
    v_and_b32 v64, 0xf8f8, v64
    v_and_b32 v66, 0xf8f8, v66
    v_and_b32 v68, 0xf8f8, v68
    v_and_b32 v70, 0xf8f8, v70
    v_mul_u32_u24 v96, 0x200400, v96
    v_mul_u32_u24 v97, 0x200400, v97
    v_mul_u32_u24 v98, 0x200400, v98
    v_mul_u32_u24 v99, 0x200400, v99
    v_and_or_b32 v64, v96, s14, v64
    v_and_or_b32 v66, v97, s14, v66
    v_and_or_b32 v68, v98, s14, v68
    v_and_or_b32 v70, v99, s14, v70
    v_add_u32 v64, v64, v65
    v_add_u32 v66, v66, v67
    v_add_u32 v68, v68, v69
    v_add_u32 v70, v70, v71
    v_dot4_i32_i8 v64, v64, v64, 0
    v_dot4_i32_i8 v66, v66, v66, 0
    v_dot4_i32_i8 v68, v68, v68, 0
    v_dot4_i32_i8 v70, v70, v70, 0
    v_cmp_gt_i32 s[40:41], s15, v64
    v_cmp_gt_i32 s[42:43], s15, v66
    v_cmp_gt_i32 s[46:47], s15, v68
    v_cmp_gt_i32 s[54:55], s15, v70
    v_mbcnt_lo_u32_b32 v96, s40, 0
    v_mbcnt_lo_u32_b32 v97, s42, 0
    v_mbcnt_lo_u32_b32 v98, s46, 0
    v_mbcnt_lo_u32_b32 v99, s54, 0
    v_mbcnt_hi_u32_b32 v96, s41, v96
    v_mbcnt_hi_u32_b32 v97, s43, v97
    v_mbcnt_hi_u32_b32 v98, s47, v98
    v_mbcnt_hi_u32_b32 v99, s55, v99
    v_lshl_add_u32 v96, v96, 2, s16
    s_bcnt1_i32_b64 s27, s[40:41]
    s_lshl2_add_u32 s16, s27, s16
    v_lshl_add_u32 v97, v97, 2, s16
    s_bcnt1_i32_b64 s27, s[42:43]
    s_lshl2_add_u32 s16, s27, s16
    v_lshl_add_u32 v98, v98, 2, s16
    s_bcnt1_i32_b64 s27, s[46:47]
    s_lshl2_add_u32 s16, s27, s16
    v_lshl_add_u32 v99, v99, 2, s16
    s_bcnt1_i32_b64 s27, s[54:55]
    s_lshl2_add_u32 s16, s27, s16
    v_cndmask_b32 v96, v26, v96, s[40:41]
    ds_write_b32 v96, v176
    v_cndmask_b32 v97, v26, v97, s[42:43]
    ds_write_b32 v97, v177
    v_cndmask_b32 v98, v26, v98, s[46:47]
    ds_write_b32 v98, v178
    v_cndmask_b32 v99, v26, v99, s[54:55]
    ds_write_b32 v99, v179
    s_waitcnt lgkmcnt(6)
    v_and_b32 v100, 0x0707, v72
    v_and_b32 v101, 0x0707, v74
    v_and_b32 v102, 0x0707, v76
    v_and_b32 v103, 0x0707, v78
    v_and_b32 v72, 0xf8f8, v72
    v_and_b32 v74, 0xf8f8, v74
    v_and_b32 v76, 0xf8f8, v76
    v_and_b32 v78, 0xf8f8, v78
    v_mul_u32_u24 v100, 0x200400, v100
    v_mul_u32_u24 v101, 0x200400, v101
    v_mul_u32_u24 v102, 0x200400, v102
    v_mul_u32_u24 v103, 0x200400, v103
    v_and_or_b32 v72, v100, s14, v72
    v_and_or_b32 v74, v101, s14, v74
    v_and_or_b32 v76, v102, s14, v76
    v_and_or_b32 v78, v103, s14, v78
    v_add_u32 v72, v72, v73
    v_add_u32 v74, v74, v75
    v_add_u32 v76, v76, v77
    v_add_u32 v78, v78, v79
    v_dot4_i32_i8 v72, v72, v72, 0
    v_dot4_i32_i8 v74, v74, v74, 0
    v_dot4_i32_i8 v76, v76, v76, 0
    v_dot4_i32_i8 v78, v78, v78, 0
    v_cmp_gt_i32 s[40:41], s15, v72
    v_cmp_gt_i32 s[42:43], s15, v74
    v_cmp_gt_i32 s[46:47], s15, v76
    v_cmp_gt_i32 s[54:55], s15, v78
    v_mbcnt_lo_u32_b32 v100, s40, 0
    v_mbcnt_lo_u32_b32 v101, s42, 0
    v_mbcnt_lo_u32_b32 v102, s46, 0
    v_mbcnt_lo_u32_b32 v103, s54, 0
    v_mbcnt_hi_u32_b32 v100, s41, v100
    v_mbcnt_hi_u32_b32 v101, s43, v101
    v_mbcnt_hi_u32_b32 v102, s47, v102
    v_mbcnt_hi_u32_b32 v103, s55, v103
    v_lshl_add_u32 v100, v100, 2, s16
    s_bcnt1_i32_b64 s27, s[40:41]
    s_lshl2_add_u32 s16, s27, s16
    v_lshl_add_u32 v101, v101, 2, s16
    s_bcnt1_i32_b64 s27, s[42:43]
    s_lshl2_add_u32 s16, s27, s16
    v_lshl_add_u32 v102, v102, 2, s16
    s_bcnt1_i32_b64 s27, s[46:47]
    s_lshl2_add_u32 s16, s27, s16
    v_lshl_add_u32 v103, v103, 2, s16
    s_bcnt1_i32_b64 s27, s[54:55]
    s_lshl2_add_u32 s16, s27, s16
    v_cndmask_b32 v100, v26, v100, s[40:41]
    ds_write_b32 v100, v180
    v_cndmask_b32 v101, v26, v101, s[42:43]
    ds_write_b32 v101, v181
    v_cndmask_b32 v102, v26, v102, s[46:47]
    ds_write_b32 v102, v182
    v_cndmask_b32 v103, v26, v103, s[54:55]
    ds_write_b32 v103, v183
    s_sub_u32 s60, s60, s59
    v_add_u32 v149, s59, v20
    v_mov_b32 v150, 0xff000000
    s_nop 1
M_pc:
    s_cmp_eq_u32 s60, 0
    s_cbranch_scc1 M_pcd
    s_waitcnt lgkmcnt(0)
    ds_read_b32 v148, v149
    v_cmp_gt_u32 vcc, s60, v20
    s_waitcnt lgkmcnt(0)
    s_nop 0
    v_cndmask_b32 v148, v150, v148, vcc
    v_and_b32 v64, s12, v148
    v_alignbit_b32 v65, s13, v148, 22
    ds_read_u16 v64, v64 offset:30720
    ds_read_b32 v65, v65
WUP_1452:
    s_cbranch_execz WUR_0
    s_waitcnt lgkmcnt(0)
    v_and_b32 v96, 0x0707, v64
    v_and_b32 v64, 0xf8f8, v64
    v_mul_u32_u24 v96, 0x200400, v96
    v_and_or_b32 v64, v96, s14, v64
    v_add_u32 v64, v64, v65
    v_dot4_i32_i8 v64, v64, v64, 0
    s_nop 2
    v_cmp_gt_i32 s[40:41], s15, v64
    s_nop 1
    v_mbcnt_lo_u32_b32 v96, s40, 0
    v_mbcnt_hi_u32_b32 v96, s41, v96
    v_lshl_add_u32 v96, v96, 2, s16
    s_bcnt1_i32_b64 s27, s[40:41]
    s_lshl2_add_u32 s16, s27, s16
    v_cndmask_b32 v96, v26, v96, s[40:41]
    ds_write_b32 v96, v148
    v_add_u32 v149, 256, v149
    s_min_u32 s27, s60, 256
    s_sub_u32 s60, s60, s27
    s_sub_u32 s27, s16, s17
    s_cmp_gt_u32 s27, 1024
    s_cbranch_scc0 M_pc
M_pcd:
    s_or_b64 s[54:55], s[68:69], s[70:71]
    s_cmp_eq_u64 s[54:55], 0
    s_cbranch_scc0 M_mdx
M_mdd:
    s_sub_u32 s19, s16, s17
    s_lshr_b32 s19, s19, 2
    s_cmp_le_u32 s19, 256
    s_cbranch_scc1 M_c1
    ds_write_b32 v9, v19
    s_movk_i32 s19, 256
M_c1:
    v_add_u32 v148, s17, v20
    s_waitcnt lgkmcnt(0)
    ds_read_b32 v64, v148 offset:0
    ds_read_b32 v68, v148 offset:256
    ds_read_b32 v72, v148 offset:512
    ds_read_b32 v76, v148 offset:768
    s_mov_b32 s27, s19
    v_cmp_gt_i32 s[8:9], s27, v8
    s_sub_u32 s27, s19, 64
    v_cmp_gt_i32 s[10:11], s27, v8
    s_sub_u32 s27, s19, 128
    v_cmp_gt_i32 s[14:15], s27, v8
    s_sub_u32 s27, s19, 192
    v_cmp_gt_i32 s[16:17], s27, v8
    s_mov_b32 s63, 0x02020000
    s_mov_b32 s64, 0x322bcc77
    s_mov_b32 s62, 0x409d0000
    v_mov_b32 v149, 0x01000c0c
    v_bfrev_b32 v14, 2
    s_waitcnt lgkmcnt(0)
    v_and_b32 v150, s12, v64
    v_alignbit_b32 v151, 33, v64, 20
    v_lshl_add_u32 v150, v150, 1, v150
    ds_read_b96 v[40:42], v151
    v_and_b32 v150, -4, v150
    v_cndmask_b32 v150, v14, v150, s[8:9]
    buffer_load_dwordx2 v[32:33], v150, s[92:95], 0 offen
    v_bfe_i32 v56, v64, 1, 1
    v_and_or_b32 v56, v56, s63, v149
    s_cmp_le_u32 s19, 64
    s_nop 0
    s_cbranch_scc1 M_s2a
    v_and_b32 v150, s12, v68
    v_alignbit_b32 v151, 33, v68, 20
    v_lshl_add_u32 v150, v150, 1, v150
    ds_read_b96 v[44:46], v151
    v_and_b32 v150, -4, v150
    v_cndmask_b32 v150, v14, v150, s[10:11]
    buffer_load_dwordx2 v[34:35], v150, s[92:95], 0 offen
    v_bfe_i32 v57, v68, 1, 1
    v_and_or_b32 v57, v57, s63, v149
    s_cmp_le_u32 s19, 128
    s_nop 0
    s_cbranch_scc1 M_s2a
    v_and_b32 v150, s12, v72
    v_alignbit_b32 v151, 33, v72, 20
    v_lshl_add_u32 v150, v150, 1, v150
    ds_read_b96 v[48:50], v151
    v_and_b32 v150, -4, v150
    v_cndmask_b32 v150, v14, v150, s[14:15]
    buffer_load_dwordx2 v[36:37], v150, s[92:95], 0 offen
    v_bfe_i32 v58, v72, 1, 1
    v_and_or_b32 v58, v58, s63, v149
    s_cmp_le_u32 s19, 192
    s_nop 0
    s_cbranch_scc1 M_s2a
    v_and_b32 v150, s12, v76
    v_alignbit_b32 v151, 33, v76, 20
    v_lshl_add_u32 v150, v150, 1, v150
    ds_read_b96 v[52:54], v151
    v_and_b32 v150, -4, v150
    v_cndmask_b32 v150, v14, v150, s[16:17]
    buffer_load_dwordx2 v[38:39], v150, s[92:95], 0 offen
    v_bfe_i32 v59, v76, 1, 1
    v_and_or_b32 v59, v59, s63, v149
    s_nop 1
M_s2a:
    s_waitcnt vmcnt(0) lgkmcnt(0)
    v_add_u32 v151, s63, v56
    v_perm_b32 v148, v33, v32, v56
    v_add_u32 v152, s63, v151
    v_perm_b32 v149, v33, v32, v151
    v_perm_b32 v150, v33, v32, v152
    v_sub_f32 v148, v148, v40
    v_sub_f32 v149, v149, v41
    v_sub_f32 v150, v150, v42
    v_cvt_pk_bf16_f32 v65, v148, v149
    v_cvt_pk_bf16_f32 v150, 0, v150
    v_lshlrev_b32 v148, 16, v65
    v_and_b32 v149, s58, v65
    v_mul_f32 v153, v150, v150
    v_mul_f32 v148, v148, v148
    v_mul_f32 v149, v149, v149
    v_cvt_pk_bf16_f32 v153, 0, v153
    v_cvt_pk_bf16_f32 v148, 0, v148
    v_cvt_pk_bf16_f32 v149, 0, v149
    v_add_f32 v148, v148, v149
    v_add_f32 v148, v148, v153
    v_cvt_pk_bf16_f32 v148, 0, v148
    v_add_f32 v148, s64, v148
    v_cvt_pk_bf16_f32 v148, 0, v148
    v_sqrt_f32 v148, v148
    s_nop 0
    v_cvt_pk_bf16_f32 v66, v150, v148
    v_cmp_gt_u32 vcc, s62, v66
    s_and_b64 s[8:9], s[8:9], vcc
    v_lshrrev_b32 v96, 24, v64
    v_lshrrev_b32 v120, 21, v64
    v_and_b32 v120, 16, v120
    v_lshlrev_b32 v112, v120, v19
    v_and_or_b32 v96, v96, v18, s3
    s_mov_b64 exec, s[8:9]
    s_nop 0
    s_cbranch_execz M_sa1
    ds_add_rtn_u32 v112, v96, v112
M_sa1:
    s_mov_b64 exec, -1
    s_cmp_le_u32 s19, 64
    s_cbranch_scc1 M_s2b
    v_add_u32 v151, s63, v57
    v_perm_b32 v148, v35, v34, v57
    v_add_u32 v152, s63, v151
    v_perm_b32 v149, v35, v34, v151
    v_perm_b32 v150, v35, v34, v152
    v_sub_f32 v148, v148, v44
    v_sub_f32 v149, v149, v45
    v_sub_f32 v150, v150, v46
    v_cvt_pk_bf16_f32 v69, v148, v149
    v_cvt_pk_bf16_f32 v150, 0, v150
    v_lshlrev_b32 v148, 16, v69
    v_and_b32 v149, s58, v69
    v_mul_f32 v153, v150, v150
    v_mul_f32 v148, v148, v148
    v_mul_f32 v149, v149, v149
    v_cvt_pk_bf16_f32 v153, 0, v153
    v_cvt_pk_bf16_f32 v148, 0, v148
    v_cvt_pk_bf16_f32 v149, 0, v149
    v_add_f32 v148, v148, v149
    v_add_f32 v148, v148, v153
    v_cvt_pk_bf16_f32 v148, 0, v148
    v_add_f32 v148, s64, v148
    v_cvt_pk_bf16_f32 v148, 0, v148
    v_sqrt_f32 v148, v148
    s_nop 0
    v_cvt_pk_bf16_f32 v70, v150, v148
    v_cmp_gt_u32 vcc, s62, v70
    s_and_b64 s[10:11], s[10:11], vcc
    v_lshrrev_b32 v97, 24, v68
    v_lshrrev_b32 v121, 21, v68
    v_and_b32 v121, 16, v121
    v_lshlrev_b32 v113, v121, v19
    v_and_or_b32 v97, v97, v18, s3
WUP_1624:
    s_cbranch_execz WUP_1811
    s_mov_b64 exec, s[10:11]
    s_nop 0
    s_cbranch_execz M_sa2
    ds_add_rtn_u32 v113, v97, v113
M_sa2:
    s_mov_b64 exec, -1
    s_cmp_le_u32 s19, 128
    s_cbranch_scc1 M_s2b
    v_add_u32 v151, s63, v58
    v_perm_b32 v148, v37, v36, v58
    v_add_u32 v152, s63, v151
    v_perm_b32 v149, v37, v36, v151
    v_perm_b32 v150, v37, v36, v152
    v_sub_f32 v148, v148, v48
    v_sub_f32 v149, v149, v49
    v_sub_f32 v150, v150, v50
    v_cvt_pk_bf16_f32 v73, v148, v149
    v_cvt_pk_bf16_f32 v150, 0, v150
    v_lshlrev_b32 v148, 16, v73
    v_and_b32 v149, s58, v73
    v_mul_f32 v153, v150, v150
    v_mul_f32 v148, v148, v148
    v_mul_f32 v149, v149, v149
    v_cvt_pk_bf16_f32 v153, 0, v153
    v_cvt_pk_bf16_f32 v148, 0, v148
    v_cvt_pk_bf16_f32 v149, 0, v149
    v_add_f32 v148, v148, v149
    v_add_f32 v148, v148, v153
    v_cvt_pk_bf16_f32 v148, 0, v148
    v_add_f32 v148, s64, v148
    v_cvt_pk_bf16_f32 v148, 0, v148
    v_sqrt_f32 v148, v148
    s_nop 0
    v_cvt_pk_bf16_f32 v74, v150, v148
    v_cmp_gt_u32 vcc, s62, v74
    s_and_b64 s[14:15], s[14:15], vcc
    v_lshrrev_b32 v98, 24, v72
    v_lshrrev_b32 v122, 21, v72
    v_and_b32 v122, 16, v122
    v_lshlrev_b32 v114, v122, v19
    v_and_or_b32 v98, v98, v18, s3
    s_mov_b64 exec, s[14:15]
    s_nop 0
    s_cbranch_execz M_sa3
    ds_add_rtn_u32 v114, v98, v114
M_sa3:
    s_mov_b64 exec, -1
    s_cmp_le_u32 s19, 192
    s_cbranch_scc1 M_s2b
    v_add_u32 v151, s63, v59
    v_perm_b32 v148, v39, v38, v59
    v_add_u32 v152, s63, v151
    v_perm_b32 v149, v39, v38, v151
    v_perm_b32 v150, v39, v38, v152
    v_sub_f32 v148, v148, v52
    v_sub_f32 v149, v149, v53
    v_sub_f32 v150, v150, v54
    v_cvt_pk_bf16_f32 v77, v148, v149
    v_cvt_pk_bf16_f32 v150, 0, v150
    v_lshlrev_b32 v148, 16, v77
    v_and_b32 v149, s58, v77
    v_mul_f32 v153, v150, v150
    v_mul_f32 v148, v148, v148
    v_mul_f32 v149, v149, v149
    v_cvt_pk_bf16_f32 v153, 0, v153
    v_cvt_pk_bf16_f32 v148, 0, v148
    v_cvt_pk_bf16_f32 v149, 0, v149
    v_add_f32 v148, v148, v149
    v_add_f32 v148, v148, v153
    v_cvt_pk_bf16_f32 v148, 0, v148
    v_add_f32 v148, s64, v148
    v_cvt_pk_bf16_f32 v148, 0, v148
    v_sqrt_f32 v148, v148
    s_nop 0
    v_cvt_pk_bf16_f32 v78, v150, v148
    v_cmp_gt_u32 vcc, s62, v78
    s_and_b64 s[16:17], s[16:17], vcc
    v_lshrrev_b32 v99, 24, v76
    v_lshrrev_b32 v123, 21, v76
    v_and_b32 v123, 16, v123
    v_lshlrev_b32 v115, v123, v19
    v_and_or_b32 v99, v99, v18, s3
    s_mov_b64 exec, s[16:17]
    s_nop 0
    s_cbranch_execz M_sa4
    ds_add_rtn_u32 v115, v99, v115
M_sa4:
    s_mov_b64 exec, -1
M_s2b:
    s_mov_b32 s61, 0x3e22f983
    s_movk_i32 s63, 0x70
    s_movk_i32 s64, 128
    s_movk_i32 s65, 256
    s_movk_i32 s66, 384
    v_lshrrev_b32 v21, 4, v8
    v_lshlrev_b32 v21, 9, v21
    v_and_b32 v22, 15, v8
    v_lshl_or_b32 v21, v22, 4, v21
    s_lshl_b32 s45, s26, 10
    s_add_u32 s45, s45, 30720
    s_lshl_b32 s46, s26, 11
    s_add_u32 s46, s46, s44
    s_waitcnt lgkmcnt(0)
    s_barrier
    s_cmp_eq_u32 s26, 6
    s_cbranch_scc0 M_h1
    s_mov_b32 s53, 0x830800
    buffer_load_dwordx4 v[148:151], v1, s[36:39], s53 offen sc1
M_h1:
    s_add_u32 m0, s45, 0
    s_add_u32 s53, s46, 0
    buffer_load_dwordx4 v21, s[28:31], s53 offen  lds
    s_add_u32 m0, s45, 8192
    s_add_u32 s53, s46, 16384
    buffer_load_dwordx4 v21, s[28:31], s53 offen  lds
    s_add_u32 m0, s45, 16384
    s_add_u32 s53, s46, 32768
    buffer_load_dwordx4 v21, s[28:31], s53 offen  lds
    s_add_u32 m0, s45, 24576
    s_add_u32 s53, s46, 49152
    buffer_load_dwordx4 v21, s[28:31], s53 offen  lds
    s_add_u32 m0, s45, 32768
    s_add_u32 s53, s46, 65536
    buffer_load_dwordx4 v21, s[28:31], s53 offen  lds
    s_add_u32 m0, s45, 40960
    s_add_u32 s53, s46, 81920
    buffer_load_dwordx4 v21, s[28:31], s53 offen  lds
    s_cmp_ge_u32 s26, 2
    s_cbranch_scc1 M_rs11
    s_add_u32 m0, s45, 49152
    s_add_u32 s53, s46, 98304
    buffer_load_dwordx4 v21, s[28:31], s53 offen  lds
M_rs11:
    ds_read_b32 v28, v30
    ds_read_b32 v13, v9
    s_waitcnt lgkmcnt(1)
    v_and_b32 v31, 0xffff, v28
    v_lshrrev_b32 v28, 16, v28
    v_add_u32 v28, v28, v31
    v_mov_b32 v29, v28
    s_nop 1
    v_add_u32_dpp v29, v29, v29 row_shr:1 row_mask:0xf bank_mask:0xf bound_ctrl:0
    s_nop 1
    v_add_u32_dpp v29, v29, v29 row_shr:2 row_mask:0xf bank_mask:0xf bound_ctrl:0
    s_nop 1
    v_add_u32_dpp v29, v29, v29 row_shr:4 row_mask:0xf bank_mask:0xf bound_ctrl:0
    s_nop 1
    v_add_u32_dpp v29, v29, v29 row_shr:8 row_mask:0xf bank_mask:0xf bound_ctrl:0
    s_nop 1
    v_add_u32_dpp v29, v29, v29 row_bcast:15 row_mask:0xa bank_mask:0xf
    s_nop 1
    v_add_u32_dpp v29, v29, v29 row_bcast:31 row_mask:0xc bank_mask:0xf
    v_sub_u32 v28, v29, v28
    v_add_u32 v31, v28, v31
    v_lshl_or_b32 v28, v31, 16, v28
    ds_bpermute_b32 v104, v96, v28
    ds_bpermute_b32 v105, v97, v28
    ds_bpermute_b32 v106, v98, v28
    ds_bpermute_b32 v107, v99, v28
    v_readlane_b32 s62, v29, 63
    s_mov_b32 s54, 0
    s_mov_b32 s55, 0
    s_xor_b32 s12, s26, 4
    s_cmp_gt_u32 s62, 480
    s_cselect_b32 s27, 96, 64
    v_cmp_ge_u32 vcc, s27, v29
    v_cmp_ge_u32 s[70:71], s27, v31
    s_bcnt1_i32_b64 s56, vcc
    s_bcnt1_i32_b64 s57, s[70:71]
    s_add_u32 s56, s56, s57
    s_min_u32 s56, s56, 16
    s_lshr_b32 s27, s56, 1
    s_and_b32 s69, s56, 1
    v_readlane_b32 s57, v28, s27
    s_lshl4_add_u32 s69, s69, 0x100000
    s_bfe_u32 s57, s57, s69
    s_waitcnt lgkmcnt(0)
    v_readfirstlane_b32 s46, v13
    v_add_u32 v104, v104, v112
    v_bfe_u32 v104, v104, v120, 16
    v_cmp_gt_u32 vcc, 768, v104
    v_lshl_add_u32 v104, v104, 4, s67
    s_and_b64 exec, vcc, s[8:9]
    s_nop 2
    s_cbranch_execz M_sb12
    ds_write_b96 v104, v[64:66]
M_sb12:
    s_mov_b64 exec, -1
    s_cmp_le_u32 s19, 64
    s_cbranch_scc1 M_s2c
    v_add_u32 v105, v105, v113
    v_bfe_u32 v105, v105, v121, 16
    v_cmp_gt_u32 vcc, 768, v105
    v_lshl_add_u32 v105, v105, 4, s67
WUP_1811:
    s_cbranch_execz WUR_0
    s_and_b64 exec, vcc, s[10:11]
    s_nop 2
    s_cbranch_execz M_sb13
    ds_write_b96 v105, v[68:70]
M_sb13:
    s_mov_b64 exec, -1
    s_cmp_le_u32 s19, 128
    s_cbranch_scc1 M_s2c
    v_add_u32 v106, v106, v114
    v_bfe_u32 v106, v106, v122, 16
    v_cmp_gt_u32 vcc, 768, v106
    v_lshl_add_u32 v106, v106, 4, s67
    s_and_b64 exec, vcc, s[14:15]
    s_nop 2
    s_cbranch_execz M_sb14
    ds_write_b96 v106, v[72:74]
M_sb14:
    s_mov_b64 exec, -1
    s_cmp_le_u32 s19, 192
    s_cbranch_scc1 M_s2c
    v_add_u32 v107, v107, v115
    v_bfe_u32 v107, v107, v123, 16
    v_cmp_gt_u32 vcc, 768, v107
    v_lshl_add_u32 v107, v107, 4, s67
    s_and_b64 exec, vcc, s[16:17]
    s_nop 2
    s_cbranch_execz M_sb15
    ds_write_b96 v107, v[76:78]
M_sb15:
    s_mov_b64 exec, -1
M_s2c:
    s_cmp_eq_u32 s26, 6
    s_cbranch_scc0 M_h3
    s_mov_b32 s27, 0
    v_cmp_gt_u32 s[8:9], 63, v8
    v_cmp_eq_u32 s[10:11], 62, v8
    s_waitcnt vmcnt(6)
    s_nop 3
M_h2:
    v_cndmask_b32 v150, v150, v148, s[10:11]
    v_cndmask_b32 v151, v151, v148, s[10:11]
    v_xor_b32 v148, s18, v148
    v_xor_b32 v149, s18, v149
    v_xor_b32 v150, s18, v150
    v_xor_b32 v151, s18, v151
    v_or3_b32 v148, v148, v149, v150
    v_or_b32 v148, v148, v151
    v_cmp_ne_u32 vcc, 0, v148
    s_and_b64 vcc, vcc, s[8:9]
    s_cbranch_vccz M_h3
    s_add_u32 s27, s27, 1
    s_cmp_lt_u32 s27, 16384
    s_cbranch_scc0 M_h3
    s_sleep 2
    s_mov_b32 s53, 0x830800
    buffer_load_dwordx4 v[148:151], v1, s[36:39], s53 offen sc1
    s_waitcnt vmcnt(0)
    s_branch M_h2
M_h3:
    s_cmp_eq_u32 s2, 0
    s_cbranch_scc0 M_h4
    s_cmp_eq_u32 s26, 5
    s_cbranch_scc0 M_h4
    s_mov_b32 s27, 0x830000
    v_mov_b32 v148, s18
    v_mov_b32 v149, 0
    s_mov_b64 exec, 1
    buffer_store_dword v148, v149, s[36:39], s27 offen sc1
    s_mov_b64 exec, -1
M_h4:
    s_waitcnt lgkmcnt(0)
    s_barrier
    s_cmp_eq_u32 s12, 0
    s_cbranch_scc1 M_cut
    s_sub_u32 s27, s57, s55
    s_cmp_gt_u32 s27, 64
    s_cselect_b32 s40, 64, 96
    s_mov_b32 s54, s56
    s_mov_b32 s55, s57
    s_sub_u32 s27, s62, s55
    s_cmp_gt_u32 s27, 420
    s_cselect_b32 s27, 96, 64
    s_add_u32 s27, s27, s55
    v_cmp_ge_u32 vcc, s27, v29
    v_cmp_ge_u32 s[70:71], s27, v31
    s_bcnt1_i32_b64 s56, vcc
    s_bcnt1_i32_b64 s57, s[70:71]
    s_add_u32 s27, s54, 16
    s_add_u32 s56, s56, s57
    s_min_u32 s56, s56, s27
    s_min_u32 s56, s56, 100
    s_max_u32 s56, s56, 4
    s_lshr_b32 s27, s56, 1
    s_and_b32 s69, s56, 1
    v_readlane_b32 s57, v28, s27
    s_lshl4_add_u32 s69, s69, 0x100000
    s_bfe_u32 s57, s57, s69
    s_cmp_eq_u32 s12, 1
    s_cbranch_scc1 M_cut
    s_sub_u32 s27, s57, s55
    s_cmp_gt_u32 s27, 64
    s_cselect_b32 s41, 64, 96
    s_mov_b32 s54, s56
    s_mov_b32 s55, s57
    s_sub_u32 s27, s62, s55
    s_cmp_gt_u32 s27, 360
    s_cselect_b32 s27, 96, 64
    s_add_u32 s27, s27, s55
    v_cmp_ge_u32 vcc, s27, v29
    v_cmp_ge_u32 s[70:71], s27, v31
    s_bcnt1_i32_b64 s56, vcc
    s_bcnt1_i32_b64 s57, s[70:71]
    s_add_u32 s27, s54, 16
    s_add_u32 s56, s56, s57
    s_min_u32 s56, s56, s27
    s_min_u32 s56, s56, 100
    s_max_u32 s56, s56, 20
    s_lshr_b32 s27, s56, 1
    s_and_b32 s69, s56, 1
    v_readlane_b32 s57, v28, s27
    s_lshl4_add_u32 s69, s69, 0x100000
    s_bfe_u32 s57, s57, s69
    s_cmp_eq_u32 s12, 2
    s_cbranch_scc1 M_cut
    s_sub_u32 s27, s57, s55
    s_cmp_gt_u32 s27, 64
    s_cselect_b32 s42, 64, 96
    s_mov_b32 s54, s56
    s_mov_b32 s55, s57
    s_sub_u32 s27, s62, s55
    s_cmp_gt_u32 s27, 300
    s_cselect_b32 s27, 96, 64
    s_add_u32 s27, s27, s55
    v_cmp_ge_u32 vcc, s27, v29
    v_cmp_ge_u32 s[70:71], s27, v31
    s_bcnt1_i32_b64 s56, vcc
    s_bcnt1_i32_b64 s57, s[70:71]
    s_add_u32 s27, s54, 16
    s_add_u32 s56, s56, s57
    s_min_u32 s56, s56, s27
    s_min_u32 s56, s56, 100
    s_max_u32 s56, s56, 36
    s_lshr_b32 s27, s56, 1
    s_and_b32 s69, s56, 1
    v_readlane_b32 s57, v28, s27
    s_lshl4_add_u32 s69, s69, 0x100000
    s_bfe_u32 s57, s57, s69
    s_cmp_eq_u32 s12, 3
    s_cbranch_scc1 M_cut
    s_mov_b32 s54, s56
    s_mov_b32 s55, s57
    s_sub_u32 s27, s62, s55
    s_cmp_gt_u32 s27, 248
    s_cselect_b32 s27, s40, 64
    s_add_u32 s27, s27, s55
    v_cmp_ge_u32 vcc, s27, v29
    v_cmp_ge_u32 s[70:71], s27, v31
    s_bcnt1_i32_b64 s56, vcc
    s_bcnt1_i32_b64 s57, s[70:71]
    s_add_u32 s27, s54, 16
    s_add_u32 s56, s56, s57
    s_min_u32 s56, s56, s27
    s_min_u32 s56, s56, 100
    s_max_u32 s56, s56, 52
    s_lshr_b32 s27, s56, 1
    s_and_b32 s69, s56, 1
    v_readlane_b32 s57, v28, s27
    s_lshl4_add_u32 s69, s69, 0x100000
    s_bfe_u32 s57, s57, s69
    s_cmp_eq_u32 s12, 4
    s_cbranch_scc1 M_cut
    s_mov_b32 s54, s56
    s_mov_b32 s55, s57
    s_sub_u32 s27, s62, s55
    s_cmp_gt_u32 s27, 186
    s_cselect_b32 s27, s41, 64
    s_add_u32 s27, s27, s55
    v_cmp_ge_u32 vcc, s27, v29
    v_cmp_ge_u32 s[70:71], s27, v31
    s_bcnt1_i32_b64 s56, vcc
    s_bcnt1_i32_b64 s57, s[70:71]
    s_add_u32 s27, s54, 16
    s_add_u32 s56, s56, s57
    s_min_u32 s56, s56, s27
    s_min_u32 s56, s56, 100
WUP_1989:
    s_cbranch_execz WUP_2183
    s_max_u32 s56, s56, 68
    s_lshr_b32 s27, s56, 1
    s_and_b32 s69, s56, 1
    v_readlane_b32 s57, v28, s27
    s_lshl4_add_u32 s69, s69, 0x100000
    s_bfe_u32 s57, s57, s69
    s_cmp_eq_u32 s12, 5
    s_cbranch_scc1 M_cut
    s_mov_b32 s54, s56
    s_mov_b32 s55, s57
    s_sub_u32 s27, s62, s55
    s_cmp_gt_u32 s27, 124
    s_cselect_b32 s27, s42, 64
    s_add_u32 s27, s27, s55
    v_cmp_ge_u32 vcc, s27, v29
    v_cmp_ge_u32 s[70:71], s27, v31
    s_bcnt1_i32_b64 s56, vcc
    s_bcnt1_i32_b64 s57, s[70:71]
    s_add_u32 s27, s54, 16
    s_add_u32 s56, s56, s57
    s_min_u32 s56, s56, s27
    s_min_u32 s56, s56, 100
    s_max_u32 s56, s56, 84
    s_lshr_b32 s27, s56, 1
    s_and_b32 s69, s56, 1
    v_readlane_b32 s57, v28, s27
    s_lshl4_add_u32 s69, s69, 0x100000
    s_bfe_u32 s57, s57, s69
    s_cmp_eq_u32 s12, 6
    s_cbranch_scc1 M_cut
    s_mov_b32 s54, s56
    s_mov_b32 s55, s57
    s_movk_i32 s56, 100
    s_mov_b32 s57, s62
M_cut:
    s_lshl_b32 s27, s55, 4
    s_add_u32 s27, s27, s67
    v_add_u32 v14, s27, v1
    v_lshlrev_b32 v15, 4, v11
    v_add_u32 v15, s27, v15
    ds_read_b32 v15, v15
    ds_read_b96 v[88:90], v14
    ds_read_b96 v[92:94], v14 offset:1024
    s_lshl_b32 s59, s54, 1
    s_sub_u32 s45, s56, s54
    s_lshl_b32 s45, s45, 1
    s_lshl_b32 s40, s54, 10
    s_add_u32 s40, s40, s44
    s_add_u32 s41, s40, 4096
    s_add_u32 s42, s40, 8192
    s_add_u32 s43, s40, 12288
    s_lshl_b32 s6, s56, 10
    s_add_u32 s6, s6, s44
    s_mov_b32 s34, s6
    s_sub_u32 s47, s57, s55
    v_add_u32 v86, 64, v8
    s_mov_b32 s50, 1
    s_cmp_gt_u32 s47, 128
    s_cselect_b32 s27, 1, s46
    s_cmp_gt_u32 s57, 768
    s_cselect_b32 s27, 1, s27
    s_cmp_eq_u32 s27, 0
    s_cselect_b32 s47, s47, 0
    s_cselect_b32 s76, 1, 0
    s_mov_b32 s14, 0
    s_mov_b32 s15, 0
    s_mov_b32 s16, 0
    s_mov_b32 s17, 0
    v_cmp_gt_u32 s[8:9], s47, v8
    v_cmp_gt_u32 s[10:11], s47, v86
    s_add_u32 s48, s47, 31
    s_lshr_b32 s48, s48, 5
    v_bfrev_b32 v14, 2
    v_cmp_gt_u32 vcc, s47, v11
    s_mov_b32 s27, 0x1fffe
    s_waitcnt lgkmcnt(2)
    v_and_b32 v15, s27, v15
    v_lshlrev_b32 v15, 6, v15
    v_lshl_add_u32 v15, v10, 6, v15
    v_cndmask_b32 v15, v14, v15, vcc
    buffer_load_dwordx4 v[32:35], v15, s[72:75], 0 offen offset:0
    buffer_load_dwordx4 v[36:39], v15, s[72:75], 0 offen offset:16
    buffer_load_dwordx4 v[40:43], v15, s[72:75], 0 offen offset:32
    buffer_load_dwordx4 v[44:47], v15, s[72:75], 0 offen offset:48
    s_waitcnt lgkmcnt(0)
M_win:
    v_lshrrev_b32 v8, 4, v1
    s_mov_b32 s53, 0x40490fdb
    s_mov_b32 s70, 0
    s_mov_b32 s54, 0x3e4ccccd
    s_mov_b32 s55, 0x1fffe
    v_mov_b32 v87, 1
    v_bfrev_b32 v14, 2
    v_and_b32 v96, s58, v90
    v_cndmask_b32 v96, 1.0, v96, s[8:9]
    v_rcp_f32 v98, v96
    v_mul_f32 v97, s53, v96
    v_cvt_pk_bf16_f32 v97, 0, v97
    v_mul_f32 v97, s54, v97
    v_cvt_pk_bf16_f32 v97, 0, v97
    v_mul_f32 v97, s61, v97
    v_cos_f32 v97, v97
    v_lshlrev_b32 v100, 16, v89
    v_and_b32 v101, s58, v89
    v_lshlrev_b32 v102, 16, v90
    v_cvt_pk_bf16_f32 v97, 0, v97
    v_add_f32 v97, 1.0, v97
    v_cvt_pk_bf16_f32 v97, 0, v97
    v_cndmask_b32 v97, 0, v97, s[8:9]
    v_mul_f32 v97, v97, v98
    v_add_f32 v103, v98, v98
    v_mul_f32 v97, 0x3e800000, v97
    v_mul_f32 v100, v100, v103
    v_mul_f32 v101, v101, v103
    v_mul_f32 v102, v102, v103
    v_and_b32 v99, s55, v88
    v_lshlrev_b32 v99, 8, v99
    v_cndmask_b32 v99, v14, v99, s[8:9]
    v_cvt_pk_bf16_f32 v100, v100, v101
    v_cvt_pk_bf16_f32 v102, 0, v102
    v_cndmask_b32 v104, 0, v87, s[8:9]
    v_mov_b32 v105, 0
    v_lshrrev_b32 v108, 24, v88
    v_subrev_u32 v108, s59, v108
    v_lshlrev_b32 v108, 1, v108
    v_lshlrev_b64 v[106:107], v108, v[104:105]
    ds_write_b128 v16, v[96:99] offset:0
    ds_write_b16 v17, v106 offset:2048
    ds_write_b16_d16_hi v17, v106 offset:2056
    ds_write_b16 v17, v107 offset:2064
    ds_write_b16_d16_hi v17, v107 offset:2072
    ds_write_b16 v17, v100 offset:2080
    ds_write_b16_d16_hi v17, v100 offset:2088
    ds_write_b16_d16_hi v17, v102 offset:2096
    s_cmp_eq_u64 s[10:11], 0
    s_cbranch_scc1 M_g1
    v_and_b32 v112, s58, v94
    v_cndmask_b32 v112, 1.0, v112, s[10:11]
    v_rcp_f32 v114, v112
    v_mul_f32 v113, s53, v112
    v_cvt_pk_bf16_f32 v113, 0, v113
    v_mul_f32 v113, s54, v113
    v_cvt_pk_bf16_f32 v113, 0, v113
    v_mul_f32 v113, s61, v113
    v_cos_f32 v113, v113
    v_lshlrev_b32 v116, 16, v93
    v_and_b32 v117, s58, v93
    v_lshlrev_b32 v118, 16, v94
    v_cvt_pk_bf16_f32 v113, 0, v113
    v_add_f32 v113, 1.0, v113
    v_cvt_pk_bf16_f32 v113, 0, v113
    v_cndmask_b32 v113, 0, v113, s[10:11]
    v_mul_f32 v113, v113, v114
    v_add_f32 v119, v114, v114
    v_mul_f32 v113, 0x3e800000, v113
    v_mul_f32 v116, v116, v119
    v_mul_f32 v117, v117, v119
    v_mul_f32 v118, v118, v119
    v_and_b32 v115, s55, v92
    v_lshlrev_b32 v115, 8, v115
    v_cndmask_b32 v115, v14, v115, s[10:11]
    v_cvt_pk_bf16_f32 v116, v116, v117
    v_cvt_pk_bf16_f32 v118, 0, v118
    v_cndmask_b32 v120, 0, v87, s[10:11]
    v_mov_b32 v121, 0
    v_lshrrev_b32 v124, 24, v92
    v_subrev_u32 v124, s59, v124
    v_lshlrev_b32 v124, 1, v124
    v_lshlrev_b64 v[122:123], v124, v[120:121]
    ds_write_b128 v16, v[112:115] offset:1024
    ds_write_b16 v17, v122 offset:2944
    ds_write_b16_d16_hi v17, v122 offset:2952
    ds_write_b16 v17, v123 offset:2960
    ds_write_b16_d16_hi v17, v123 offset:2968
    ds_write_b16 v17, v116 offset:2976
    ds_write_b16_d16_hi v17, v116 offset:2984
    ds_write_b16_d16_hi v17, v118 offset:2992
M_g1:
    s_waitcnt lgkmcnt(0)
    s_cmp_lg_u32 s50, 0
    s_cbranch_scc1 M_first
    s_cmp_eq_u32 s48, 0
    s_cselect_b32 s77, 0x40000000, 0
    ds_read_b32 v47, v3 offset:12
    v_bfe_u32 v46, v1, 9, 1
    s_waitcnt lgkmcnt(0)
    v_lshrrev_b32 v47, 2, v47
    v_lshl_add_u32 v47, v46, 6, v47
    buffer_load_dwordx4 v[32:35], v47, s[72:75], s77 offen offset:0
    buffer_load_dwordx4 v[36:39], v47, s[72:75], s77 offen offset:16
    buffer_load_dwordx4 v[40:43], v47, s[72:75], s77 offen offset:32
    buffer_load_dwordx4 v[44:47], v47, s[72:75], s77 offen offset:48
    s_branch M_noacc
M_first:
    s_mov_b32 s50, 2
    s_sub_u32 s27, s26, 4
    s_cmp_ge_u32 s27, 3
    s_cbranch_scc1 M_late
WUP_2183:
    s_cbranch_execz WUP_3313
    s_cmp_eq_u32 s48, 0
    s_cbranch_scc1 M_late
    ds_read_b32 v64, v5 offset:12
    ds_read_b32 v65, v5 offset:140
    ds_read_b32 v66, v5 offset:268
    ds_read_b32 v67, v5 offset:396
    s_waitcnt lgkmcnt(3)
    v_and_or_b32 v64, v1, s63, v64
    s_waitcnt lgkmcnt(2)
    v_and_or_b32 v65, v1, s63, v65
    s_waitcnt lgkmcnt(1)
    v_and_or_b32 v66, v1, s63, v66
    s_waitcnt lgkmcnt(0)
    v_and_or_b32 v67, v1, s63, v67
    s_add_u32 m0, s51, 0
    s_nop 0
    buffer_load_dwordx4 v64, s[28:31], s64 offen lds
    s_add_u32 m0, s51, 1024
    s_nop 0
    buffer_load_dwordx4 v64, s[28:31], s65 offen lds
    s_add_u32 m0, s51, 2048
    s_nop 0
    buffer_load_dwordx4 v64, s[28:31], s66 offen lds
    s_add_u32 m0, s51, 3072
    s_nop 0
    buffer_load_dwordx4 v65, s[28:31], s64 offen lds
    s_add_u32 m0, s51, 4096
    s_nop 0
    buffer_load_dwordx4 v65, s[28:31], s65 offen lds
    s_add_u32 m0, s51, 5120
    s_nop 0
    buffer_load_dwordx4 v65, s[28:31], s66 offen lds
    s_add_u32 m0, s51, 6144
    s_nop 0
    buffer_load_dwordx4 v66, s[28:31], s64 offen lds
    s_add_u32 m0, s51, 7168
    s_nop 0
    buffer_load_dwordx4 v66, s[28:31], s65 offen lds
    s_add_u32 m0, s51, 8192
    s_nop 0
    buffer_load_dwordx4 v66, s[28:31], s66 offen lds
    s_add_u32 m0, s51, 9216
    s_nop 0
    buffer_load_dwordx4 v67, s[28:31], s64 offen lds
    s_add_u32 m0, s51, 10240
    s_nop 0
    buffer_load_dwordx4 v67, s[28:31], s65 offen lds
    s_add_u32 m0, s51, 11264
    s_nop 0
    buffer_load_dwordx4 v67, s[28:31], s66 offen lds
    s_mov_b32 s50, 3
    s_waitcnt vmcnt(16)
    s_branch M_late2
M_late:
    s_waitcnt vmcnt(4)
M_late2:
    s_lshl_b32 s27, s59, 8
    s_add_u32 s27, s27, 30720
    v_lshlrev_b32 v12, 10, v10
    v_lshl_add_u32 v12, v11, 2, v12
    v_add_u32 v12, s27, v12
    s_barrier
    ds_read_u16_d16_hi v128, v12 offset:0
    ds_read_u16_d16_hi v144, v12 offset:2
    ds_read_u16_d16_hi v129, v12 offset:256
    ds_read_u16_d16_hi v145, v12 offset:258
    ds_read_u16_d16_hi v130, v12 offset:512
    ds_read_u16_d16_hi v146, v12 offset:514
    ds_read_u16_d16_hi v131, v12 offset:768
    ds_read_u16_d16_hi v147, v12 offset:770
    ds_read_u16_d16_hi v132, v12 offset:2048
    ds_read_u16_d16_hi v148, v12 offset:2050
    ds_read_u16_d16_hi v133, v12 offset:2304
    ds_read_u16_d16_hi v149, v12 offset:2306
    ds_read_u16_d16_hi v134, v12 offset:2560
    ds_read_u16_d16_hi v150, v12 offset:2562
    ds_read_u16_d16_hi v135, v12 offset:2816
    ds_read_u16_d16_hi v151, v12 offset:2818
    ds_read_u16_d16_hi v136, v12 offset:4096
    ds_read_u16_d16_hi v152, v12 offset:4098
    ds_read_u16_d16_hi v137, v12 offset:4352
    ds_read_u16_d16_hi v153, v12 offset:4354
    ds_read_u16_d16_hi v138, v12 offset:4608
    ds_read_u16_d16_hi v154, v12 offset:4610
    ds_read_u16_d16_hi v139, v12 offset:4864
    ds_read_u16_d16_hi v155, v12 offset:4866
    ds_read_u16_d16_hi v140, v12 offset:6144
    ds_read_u16_d16_hi v156, v12 offset:6146
    ds_read_u16_d16_hi v141, v12 offset:6400
    ds_read_u16_d16_hi v157, v12 offset:6402
    ds_read_u16_d16_hi v142, v12 offset:6656
    ds_read_u16_d16_hi v158, v12 offset:6658
    ds_read_u16_d16_hi v143, v12 offset:6912
    ds_read_u16_d16_hi v159, v12 offset:6914
    ds_read_u16_d16_hi v160, v12 offset:128
    ds_read_u16_d16_hi v176, v12 offset:130
    ds_read_u16_d16_hi v161, v12 offset:384
    ds_read_u16_d16_hi v177, v12 offset:386
    ds_read_u16_d16_hi v162, v12 offset:640
    ds_read_u16_d16_hi v178, v12 offset:642
    ds_read_u16_d16_hi v163, v12 offset:896
    ds_read_u16_d16_hi v179, v12 offset:898
    ds_read_u16_d16_hi v164, v12 offset:2176
    ds_read_u16_d16_hi v180, v12 offset:2178
    ds_read_u16_d16_hi v165, v12 offset:2432
    ds_read_u16_d16_hi v181, v12 offset:2434
    ds_read_u16_d16_hi v166, v12 offset:2688
    ds_read_u16_d16_hi v182, v12 offset:2690
    ds_read_u16_d16_hi v167, v12 offset:2944
    ds_read_u16_d16_hi v183, v12 offset:2946
    ds_read_u16_d16_hi v168, v12 offset:4224
    ds_read_u16_d16_hi v184, v12 offset:4226
    ds_read_u16_d16_hi v169, v12 offset:4480
    ds_read_u16_d16_hi v185, v12 offset:4482
    ds_read_u16_d16_hi v170, v12 offset:4736
    ds_read_u16_d16_hi v186, v12 offset:4738
    ds_read_u16_d16_hi v171, v12 offset:4992
    ds_read_u16_d16_hi v187, v12 offset:4994
    ds_read_u16_d16_hi v172, v12 offset:6272
    ds_read_u16_d16_hi v188, v12 offset:6274
    ds_read_u16_d16_hi v173, v12 offset:6528
    ds_read_u16_d16_hi v189, v12 offset:6530
    ds_read_u16_d16_hi v174, v12 offset:6784
    ds_read_u16_d16_hi v190, v12 offset:6786
    ds_read_u16_d16_hi v175, v12 offset:7040
    ds_read_u16_d16_hi v191, v12 offset:7042
    s_waitcnt lgkmcnt(0)
    s_cmp_eq_u32 s50, 3
    s_cbranch_scc1 M_noinit
    s_cmp_ge_u32 s26, 4
    s_cbranch_scc1 M_noacc
    s_barrier
    s_mov_b32 s50, 0
    s_cmp_eq_u32 s48, 0
    s_cbranch_scc1 M_noacc
    s_mov_b32 s70, 1
    s_waitcnt vmcnt(0)
    s_branch M_noinit
M_noacc:
    s_cmp_eq_u32 s48, 0
    s_cbranch_scc1 M_nob
    ds_read_b32 v64, v5 offset:12
    ds_read_b32 v65, v5 offset:140
    ds_read_b32 v66, v5 offset:268
    ds_read_b32 v67, v5 offset:396
    s_waitcnt lgkmcnt(3)
    v_and_or_b32 v64, v1, s63, v64
    s_waitcnt lgkmcnt(2)
    v_and_or_b32 v65, v1, s63, v65
    s_waitcnt lgkmcnt(1)
    v_and_or_b32 v66, v1, s63, v66
    s_waitcnt lgkmcnt(0)
    v_and_or_b32 v67, v1, s63, v67
    s_add_u32 m0, s51, 0
WUP_2334:
    s_cbranch_execz WUP_3969
    s_nop 0
    buffer_load_dwordx4 v64, s[28:31], s64 offen lds
    s_add_u32 m0, s51, 1024
    s_nop 0
    buffer_load_dwordx4 v64, s[28:31], s65 offen lds
    s_add_u32 m0, s51, 2048
    s_nop 0
    buffer_load_dwordx4 v64, s[28:31], s66 offen lds
    s_add_u32 m0, s51, 3072
    s_nop 0
    buffer_load_dwordx4 v65, s[28:31], s64 offen lds
    s_add_u32 m0, s51, 4096
    s_nop 0
    buffer_load_dwordx4 v65, s[28:31], s65 offen lds
    s_add_u32 m0, s51, 5120
    s_nop 0
    buffer_load_dwordx4 v65, s[28:31], s66 offen lds
    s_add_u32 m0, s51, 6144
    s_nop 0
    buffer_load_dwordx4 v66, s[28:31], s64 offen lds
    s_add_u32 m0, s51, 7168
    s_nop 0
    buffer_load_dwordx4 v66, s[28:31], s65 offen lds
    s_add_u32 m0, s51, 8192
    s_nop 0
    buffer_load_dwordx4 v66, s[28:31], s66 offen lds
    s_add_u32 m0, s51, 9216
    s_nop 0
    buffer_load_dwordx4 v67, s[28:31], s64 offen lds
    s_add_u32 m0, s51, 10240
    s_nop 0
    buffer_load_dwordx4 v67, s[28:31], s65 offen lds
    s_add_u32 m0, s51, 11264
    s_nop 0
    buffer_load_dwordx4 v67, s[28:31], s66 offen lds
    s_branch M_noinit
M_nob:
    s_cmp_eq_u32 s76, 0
    s_cbranch_scc1 M_noinit
    v_lshrrev_b32 v64, 7, v1
    v_and_b32 v65, 1, v64
    v_lshrrev_b32 v64, 1, v64
    v_lshl_add_u32 v64, v65, 2, v64
    v_lshlrev_b32 v64, 9, v64
    v_and_or_b32 v64, v1, s63, v64
    s_add_u32 m0, s51, 1024
    s_add_u32 s53, s40, 256
    buffer_load_dwordx4 v64, s[4:7], s53 offen  lds
    s_add_u32 m0, s51, 2048
    s_add_u32 s53, s40, 384
    buffer_load_dwordx4 v64, s[4:7], s53 offen  lds
    s_add_u32 m0, s51, 4096
    s_add_u32 s53, s41, 256
    buffer_load_dwordx4 v64, s[4:7], s53 offen  lds
    s_add_u32 m0, s51, 5120
    s_add_u32 s53, s41, 384
    buffer_load_dwordx4 v64, s[4:7], s53 offen  lds
    s_add_u32 m0, s51, 7168
    s_add_u32 s53, s42, 256
    buffer_load_dwordx4 v64, s[4:7], s53 offen  lds
    s_add_u32 m0, s51, 8192
    s_add_u32 s53, s42, 384
    buffer_load_dwordx4 v64, s[4:7], s53 offen  lds
    s_add_u32 m0, s51, 10240
    s_add_u32 s53, s43, 256
    buffer_load_dwordx4 v64, s[4:7], s53 offen  lds
    s_add_u32 m0, s51, 11264
    s_add_u32 s53, s43, 384
    buffer_load_dwordx4 v64, s[4:7], s53 offen  lds
M_noinit:
    s_cmp_eq_u32 s50, 0
    s_cbranch_scc1 M_nod
    s_barrier
    s_mov_b32 s50, 0
M_nod:
    s_cmp_eq_u32 s48, 0
    s_cbranch_scc1 M_wend
    s_mov_b32 s49, 0
    s_cmp_lt_u32 s26, 4
    s_cbranch_scc1 M_yp
    s_setprio 1
M_yp:
    ds_read_b128 v[104:107], v3 offset:0
    ds_read_b128 v[72:75], v7
    ds_read_b128 v[76:79], v7 offset:16
    ds_read_b64 v[12:13], v4 offset:2048
    ds_read_b64 v[14:15], v4 offset:2160
    ds_read_b64 v[16:17], v4 offset:2272
    ds_read_b64 v[18:19], v4 offset:2384
    ds_read_b128 v[20:23], v1 offset:24576
    ds_read_b128 v[24:27], v1 offset:0
    ds_read_b128 v[28:31], v1 offset:1024
    s_waitcnt lgkmcnt(7)
    v_mul_f32 v72, v104, v72
    v_mul_f32 v73, v104, v73
    v_mul_f32 v74, v104, v74
    v_mul_f32 v75, v104, v75
    v_mul_f32 v76, v104, v76
    v_mul_f32 v77, v104, v77
    v_mul_f32 v78, v104, v78
    v_mul_f32 v79, v104, v79
    v_cvt_pk_bf16_f32 v72, 0, v72
    v_cvt_pk_bf16_f32 v73, 0, v73
    v_cvt_pk_bf16_f32 v74, 0, v74
    v_cvt_pk_bf16_f32 v75, 0, v75
    v_cvt_pk_bf16_f32 v76, 0, v76
    v_cvt_pk_bf16_f32 v77, 0, v77
    v_cvt_pk_bf16_f32 v78, 0, v78
    v_cvt_pk_bf16_f32 v79, 0, v79
    v_mul_f32 v72, s61, v72
    v_mul_f32 v73, s61, v73
    v_mul_f32 v74, s61, v74
    v_mul_f32 v75, s61, v75
    v_mul_f32 v76, s61, v76
    v_mul_f32 v77, s61, v77
    v_mul_f32 v78, s61, v78
    v_mul_f32 v79, s61, v79
    v_sin_f32 v72, v72
    v_sin_f32 v73, v73
    v_sin_f32 v74, v74
    v_sin_f32 v75, v75
    v_sin_f32 v76, v76
    v_sin_f32 v77, v77
    v_sin_f32 v78, v78
    v_sin_f32 v79, v79
    v_mul_f32 v72, v72, v105
    v_mul_f32 v73, v73, v105
    v_mul_f32 v74, v74, v105
    v_mul_f32 v75, v75, v105
    v_mul_f32 v76, v76, v105
    v_mul_f32 v77, v77, v105
    v_mul_f32 v78, v78, v105
    v_mul_f32 v79, v79, v105
    v_cvt_pk_bf16_f32 v8, v72, v73
    v_cvt_pk_bf16_f32 v9, v74, v75
    v_cvt_pk_bf16_f32 v10, v76, v77
    v_cvt_pk_bf16_f32 v11, v78, v79
    s_waitcnt lgkmcnt(3)
    v_pk_lshlrev_b16 v12, v6, v12
    v_pk_lshlrev_b16 v13, v6, v13
    v_pk_lshlrev_b16 v14, v6, v14
    v_pk_lshlrev_b16 v15, v6, v15
    v_pk_lshlrev_b16 v16, v6, v16
    v_pk_lshlrev_b16 v17, v6, v17
    v_pk_lshlrev_b16 v18, v6, v18
    v_pk_lshlrev_b16 v19, v6, v19
    s_waitcnt lgkmcnt(0)
    s_nop 0
M_batch:
    s_waitcnt vmcnt(12)
    v_mfma_f32_32x32x16_bf16 v[80:95], v[8:11], v[20:23], 0
    ds_read_b128 v[20:23], v1 offset:2048
    s_add_u32 s77, s49, 1
    s_cmp_lt_u32 s77, s48
    s_cselect_b32 s77, 0, 0x40000000
    ds_read_b32 v63, v3 offset:524
    v_bfe_u32 v62, v1, 9, 1
    s_waitcnt lgkmcnt(0)
    v_lshrrev_b32 v63, 2, v63
    v_lshl_add_u32 v63, v62, 6, v63
    buffer_load_dwordx4 v[48:51], v63, s[72:75], s77 offen offset:0
    buffer_load_dwordx4 v[52:55], v63, s[72:75], s77 offen offset:16
    buffer_load_dwordx4 v[56:59], v63, s[72:75], s77 offen offset:32
    buffer_load_dwordx4 v[60:63], v63, s[72:75], s77 offen offset:48
    s_cmp_eq_u32 s70, 0
    s_cbranch_scc1 M_vb16
    ds_read_b32 v112, v5 offset:12
    ds_read_b32 v113, v5 offset:140
    s_waitcnt lgkmcnt(1)
    v_and_or_b32 v112, v1, s63, v112
    s_add_u32 m0, s51, 0
    s_nop 0
    buffer_load_dwordx4 v112, s[28:31], s64 offen lds
    s_add_u32 m0, s51, 1024
    s_nop 0
    buffer_load_dwordx4 v112, s[28:31], s65 offen lds
    s_add_u32 m0, s51, 2048
    s_nop 0
    buffer_load_dwordx4 v112, s[28:31], s66 offen lds
    s_waitcnt lgkmcnt(0)
WUP_2509:
    s_cbranch_execz WUP_4130
    v_and_or_b32 v113, v1, s63, v113
    s_add_u32 m0, s51, 3072
    s_nop 0
    buffer_load_dwordx4 v113, s[28:31], s64 offen lds
    s_add_u32 m0, s51, 4096
    s_nop 0
    buffer_load_dwordx4 v113, s[28:31], s65 offen lds
    s_add_u32 m0, s51, 5120
    s_nop 0
    buffer_load_dwordx4 v113, s[28:31], s66 offen lds
M_vb16:
    v_mfma_f32_32x32x16_bf16 v[64:79], v[32:35], v[24:27], 0
    ds_read_b128 v[24:27], v1 offset:3072
    v_mfma_f32_32x32x16_bf16 v[64:79], v[36:39], v[28:31], v[64:79]
    ds_read_b128 v[28:31], v1 offset:25600
    v_mfma_f32_32x32x16_bf16 v[64:79], v[40:43], v[20:23], v[64:79]
    ds_read_b128 v[20:23], v1 offset:4096
    s_waitcnt lgkmcnt(2)
    v_mfma_f32_32x32x16_bf16 v[64:79], v[44:47], v[24:27], v[64:79]
    ds_read_b128 v[24:27], v1 offset:5120
    s_cmp_eq_u32 s70, 0
    s_nop 9
    s_cbranch_scc1 M_vb17
    ds_read_b32 v114, v5 offset:268
    s_waitcnt lgkmcnt(0)
    v_and_or_b32 v114, v1, s63, v114
    s_add_u32 m0, s51, 6144
    s_nop 0
    buffer_load_dwordx4 v114, s[28:31], s64 offen lds
    s_add_u32 m0, s51, 7168
    s_nop 0
    buffer_load_dwordx4 v114, s[28:31], s65 offen lds
    s_add_u32 m0, s51, 8192
    s_nop 0
    buffer_load_dwordx4 v114, s[28:31], s66 offen lds
M_vb17:
    s_waitcnt lgkmcnt(2)
    v_mfma_f32_32x32x16_bf16 v[112:127], v[8:11], v[28:31], 0
    ds_read_b128 v[28:31], v1 offset:6144
    s_waitcnt lgkmcnt(2)
    v_mfma_f32_32x32x16_bf16 v[96:111], v[32:35], v[20:23], 0
    ds_read_b128 v[20:23], v1 offset:7168
    v_mul_f32 v64, v64, v80
    v_mul_f32 v65, v65, v81
    v_mul_f32 v66, v66, v82
    v_mul_f32 v67, v67, v83
    v_mul_f32 v68, v68, v84
    v_mul_f32 v69, v69, v85
    s_waitcnt lgkmcnt(2)
    v_mfma_f32_32x32x16_bf16 v[96:111], v[36:39], v[24:27], v[96:111]
    ds_read_b128 v[24:27], v1 offset:26624
    v_mul_f32 v70, v70, v86
    v_mul_f32 v71, v71, v87
    v_mul_f32 v72, v72, v88
    v_mul_f32 v73, v73, v89
    v_mul_f32 v74, v74, v90
    v_mul_f32 v75, v75, v91
    v_mul_f32 v76, v76, v92
    s_waitcnt lgkmcnt(2)
    v_mfma_f32_32x32x16_bf16 v[96:111], v[40:43], v[28:31], v[96:111]
    ds_read_b128 v[28:31], v1 offset:8192
    v_mul_f32 v77, v77, v93
    v_mul_f32 v78, v78, v94
    v_mul_f32 v79, v79, v95
    v_cvt_pk_bf16_f32 v64, v64, v65
    v_cvt_pk_bf16_f32 v65, v66, v67
    v_cvt_pk_bf16_f32 v66, v68, v69
    s_waitcnt lgkmcnt(2)
    v_mfma_f32_32x32x16_bf16 v[96:111], v[44:47], v[20:23], v[96:111]
    ds_read_b128 v[20:23], v1 offset:9216
    v_cvt_pk_bf16_f32 v67, v70, v71
    v_cvt_pk_bf16_f32 v68, v72, v73
    v_cvt_pk_bf16_f32 v69, v74, v75
    v_cvt_pk_bf16_f32 v70, v76, v77
    v_cvt_pk_bf16_f32 v71, v78, v79
    v_mfma_f32_32x32x16_bf16 v[128:143], v[12:15], v[64:67], v[128:143]
    s_nop 0
    v_mfma_f32_32x32x16_bf16 v[128:143], v[16:19], v[68:71], v[128:143]
    s_cmp_eq_u32 s70, 0
    s_nop 10
    s_cbranch_scc1 M_vb18
    ds_read_b32 v72, v5 offset:396
    s_waitcnt lgkmcnt(0)
    v_and_or_b32 v72, v1, s63, v72
    s_add_u32 m0, s51, 9216
    s_nop 0
    buffer_load_dwordx4 v72, s[28:31], s64 offen lds
    s_add_u32 m0, s51, 10240
    s_nop 0
    buffer_load_dwordx4 v72, s[28:31], s65 offen lds
    s_add_u32 m0, s51, 11264
    s_nop 0
    buffer_load_dwordx4 v72, s[28:31], s66 offen lds
M_vb18:
    s_waitcnt lgkmcnt(2)
    v_mfma_f32_32x32x16_bf16 v[80:95], v[8:11], v[24:27], 0
    ds_read_b128 v[24:27], v1 offset:10240
    s_waitcnt lgkmcnt(2)
    v_mfma_f32_32x32x16_bf16 v[64:79], v[32:35], v[28:31], 0
    ds_read_b128 v[28:31], v1 offset:11264
    v_mul_f32 v96, v96, v112
    v_mul_f32 v97, v97, v113
    v_mul_f32 v98, v98, v114
    v_mul_f32 v99, v99, v115
    v_mul_f32 v100, v100, v116
    v_mul_f32 v101, v101, v117
    s_waitcnt lgkmcnt(2)
    v_mfma_f32_32x32x16_bf16 v[64:79], v[36:39], v[20:23], v[64:79]
    ds_read_b128 v[20:23], v1 offset:27648
    v_mul_f32 v102, v102, v118
    v_mul_f32 v103, v103, v119
    v_mul_f32 v104, v104, v120
    v_mul_f32 v105, v105, v121
    v_mul_f32 v106, v106, v122
    v_mul_f32 v107, v107, v123
    v_mul_f32 v108, v108, v124
    s_waitcnt lgkmcnt(2)
    v_mfma_f32_32x32x16_bf16 v[64:79], v[40:43], v[24:27], v[64:79]
    ds_read_b128 v[24:27], v1 offset:12288
    v_mul_f32 v109, v109, v125
    v_mul_f32 v110, v110, v126
    v_mul_f32 v111, v111, v127
    v_cvt_pk_bf16_f32 v96, v96, v97
    v_cvt_pk_bf16_f32 v97, v98, v99
    v_cvt_pk_bf16_f32 v98, v100, v101
    s_waitcnt lgkmcnt(2)
    v_mfma_f32_32x32x16_bf16 v[64:79], v[44:47], v[28:31], v[64:79]
    ds_read_b128 v[28:31], v1 offset:13312
    v_cvt_pk_bf16_f32 v99, v102, v103
    v_cvt_pk_bf16_f32 v100, v104, v105
    v_cvt_pk_bf16_f32 v101, v106, v107
    v_cvt_pk_bf16_f32 v102, v108, v109
    v_cvt_pk_bf16_f32 v103, v110, v111
    v_mfma_f32_32x32x16_bf16 v[144:159], v[12:15], v[96:99], v[144:159]
    s_nop 0
    v_mfma_f32_32x32x16_bf16 v[144:159], v[16:19], v[100:103], v[144:159]
    s_waitcnt lgkmcnt(2)
    v_mfma_f32_32x32x16_bf16 v[112:127], v[8:11], v[20:23], 0
    ds_read_b128 v[20:23], v1 offset:14336
    s_waitcnt lgkmcnt(2)
    v_mfma_f32_32x32x16_bf16 v[96:111], v[32:35], v[24:27], 0
    ds_read_b128 v[24:27], v1 offset:15360
    v_mul_f32 v64, v64, v80
    v_mul_f32 v65, v65, v81
    v_mul_f32 v66, v66, v82
    v_mul_f32 v67, v67, v83
    v_mul_f32 v68, v68, v84
    v_mul_f32 v69, v69, v85
    v_mul_f32 v70, v70, v86
    v_mul_f32 v71, v71, v87
    v_mul_f32 v72, v72, v88
WUP_2657:
    s_cbranch_execz WUR_1
    v_mul_f32 v73, v73, v89
    v_mul_f32 v74, v74, v90
    v_mul_f32 v75, v75, v91
    v_mul_f32 v76, v76, v92
    v_mul_f32 v77, v77, v93
    v_mul_f32 v78, v78, v94
    v_mul_f32 v79, v79, v95
    s_cmp_eq_u32 s70, 0
    s_nop 0
    s_cbranch_scc1 M_vw19
    s_waitcnt vmcnt(0)
    s_mov_b32 s70, 0
M_vw19:
    s_waitcnt vmcnt(4)
    ds_read_u16_d16_hi v80, v2 offset:0
    ds_read_u16_d16_hi v81, v2 offset:256
    ds_read_u16_d16_hi v82, v2 offset:512
    ds_read_u16_d16_hi v83, v2 offset:768
    ds_read_u16_d16_hi v84, v2 offset:3072
    ds_read_u16_d16_hi v85, v2 offset:3328
    ds_read_u16_d16_hi v86, v2 offset:3584
    ds_read_u16_d16_hi v87, v2 offset:3840
    ds_read_u16_d16_hi v88, v2 offset:6144
    ds_read_u16_d16_hi v89, v2 offset:6400
    ds_read_u16_d16_hi v90, v2 offset:6656
    ds_read_u16_d16_hi v91, v2 offset:6912
    ds_read_u16_d16_hi v92, v2 offset:9216
    ds_read_u16_d16_hi v93, v2 offset:9472
    ds_read_u16_d16_hi v94, v2 offset:9728
    ds_read_u16_d16_hi v95, v2 offset:9984
    s_waitcnt lgkmcnt(12)
    v_mul_f32 v80, v80, v64
    v_mul_f32 v81, v81, v65
    v_mul_f32 v82, v82, v66
    v_mul_f32 v83, v83, v67
    s_waitcnt lgkmcnt(8)
    v_mul_f32 v84, v84, v68
    v_mul_f32 v85, v85, v69
    v_mfma_f32_32x32x16_bf16 v[96:111], v[36:39], v[28:31], v[96:111]
    ds_read_b128 v[28:31], v1 offset:28672
    v_mul_f32 v86, v86, v70
    v_mul_f32 v87, v87, v71
    v_cvt_pk_bf16_f32 v80, v80, v81
    v_cvt_pk_bf16_f32 v81, v82, v83
    v_cvt_pk_bf16_f32 v82, v84, v85
    v_cvt_pk_bf16_f32 v83, v86, v87
    s_nop 1
    v_mfma_f32_32x32x16_bf16 v[160:175], v[12:15], v[80:83], v[160:175]
    ds_read_u16_d16_hi v80, v2 offset:1024
    ds_read_u16_d16_hi v81, v2 offset:1280
    ds_read_u16_d16_hi v82, v2 offset:1536
    ds_read_u16_d16_hi v83, v2 offset:1792
    ds_read_u16_d16_hi v84, v2 offset:4096
    ds_read_u16_d16_hi v85, v2 offset:4352
    ds_read_u16_d16_hi v86, v2 offset:4608
    ds_read_u16_d16_hi v87, v2 offset:4864
    s_waitcnt lgkmcnt(13)
    v_mul_f32 v88, v88, v72
    v_mul_f32 v89, v89, v73
    v_mul_f32 v90, v90, v74
    v_mul_f32 v91, v91, v75
    s_waitcnt lgkmcnt(9)
    v_mul_f32 v92, v92, v76
    v_mul_f32 v93, v93, v77
    v_mul_f32 v94, v94, v78
    v_mul_f32 v95, v95, v79
    v_cvt_pk_bf16_f32 v88, v88, v89
    v_cvt_pk_bf16_f32 v89, v90, v91
    v_cvt_pk_bf16_f32 v90, v92, v93
    v_cvt_pk_bf16_f32 v91, v94, v95
    s_nop 1
    v_mfma_f32_32x32x16_bf16 v[160:175], v[16:19], v[88:91], v[160:175]
    ds_read_u16_d16_hi v88, v2 offset:7168
    ds_read_u16_d16_hi v89, v2 offset:7424
    ds_read_u16_d16_hi v90, v2 offset:7680
    ds_read_u16_d16_hi v91, v2 offset:7936
    ds_read_u16_d16_hi v92, v2 offset:10240
    ds_read_u16_d16_hi v93, v2 offset:10496
    ds_read_u16_d16_hi v94, v2 offset:10752
    ds_read_u16_d16_hi v95, v2 offset:11008
    s_waitcnt lgkmcnt(12)
    v_mul_f32 v80, v80, v64
    v_mul_f32 v81, v81, v65
    v_mul_f32 v82, v82, v66
    v_mfma_f32_32x32x16_bf16 v[96:111], v[40:43], v[20:23], v[96:111]
    ds_read_b128 v[20:23], v1 offset:16384
    v_mul_f32 v83, v83, v67
    s_waitcnt lgkmcnt(9)
    v_mul_f32 v84, v84, v68
    v_mul_f32 v85, v85, v69
    v_mul_f32 v86, v86, v70
    v_mul_f32 v87, v87, v71
    v_cvt_pk_bf16_f32 v80, v80, v81
    v_cvt_pk_bf16_f32 v81, v82, v83
    v_cvt_pk_bf16_f32 v82, v84, v85
    v_cvt_pk_bf16_f32 v83, v86, v87
    s_nop 1
    v_mfma_f32_32x32x16_bf16 v[192:207], v[12:15], v[80:83], v[192:207]
    ds_read_u16_d16_hi v80, v2 offset:2048
    ds_read_u16_d16_hi v81, v2 offset:2304
    ds_read_u16_d16_hi v82, v2 offset:2560
    ds_read_u16_d16_hi v83, v2 offset:2816
    ds_read_u16_d16_hi v84, v2 offset:5120
    ds_read_u16_d16_hi v85, v2 offset:5376
    ds_read_u16_d16_hi v86, v2 offset:5632
    ds_read_u16_d16_hi v87, v2 offset:5888
    s_waitcnt lgkmcnt(13)
    v_mul_f32 v88, v88, v72
    v_mul_f32 v89, v89, v73
    v_mul_f32 v90, v90, v74
    v_mul_f32 v91, v91, v75
    s_waitcnt lgkmcnt(9)
    v_mul_f32 v92, v92, v76
    v_mul_f32 v93, v93, v77
    v_mul_f32 v94, v94, v78
    v_mul_f32 v95, v95, v79
    v_cvt_pk_bf16_f32 v88, v88, v89
    v_cvt_pk_bf16_f32 v89, v90, v91
    v_cvt_pk_bf16_f32 v90, v92, v93
    v_cvt_pk_bf16_f32 v91, v94, v95
    s_nop 1
    v_mfma_f32_32x32x16_bf16 v[192:207], v[16:19], v[88:91], v[192:207]
    ds_read_u16_d16_hi v88, v2 offset:8192
    ds_read_u16_d16_hi v89, v2 offset:8448
    ds_read_u16_d16_hi v90, v2 offset:8704
    ds_read_u16_d16_hi v91, v2 offset:8960
    ds_read_u16_d16_hi v92, v2 offset:11264
    ds_read_u16_d16_hi v93, v2 offset:11520
    ds_read_u16_d16_hi v94, v2 offset:11776
    ds_read_u16_d16_hi v95, v2 offset:12032
    v_mfma_f32_32x32x16_bf16 v[96:111], v[44:47], v[24:27], v[96:111]
    ds_read_b128 v[24:27], v1 offset:17408
    s_waitcnt lgkmcnt(13)
    v_mul_f32 v80, v80, v64
    v_mul_f32 v81, v81, v65
    v_mul_f32 v82, v82, v66
    v_mul_f32 v83, v83, v67
    s_waitcnt lgkmcnt(9)
    v_mul_f32 v84, v84, v68
    v_mul_f32 v85, v85, v69
    v_mul_f32 v86, v86, v70
    v_mul_f32 v87, v87, v71
    v_cvt_pk_bf16_f32 v80, v80, v81
    v_cvt_pk_bf16_f32 v81, v82, v83
    v_cvt_pk_bf16_f32 v82, v84, v85
    v_cvt_pk_bf16_f32 v83, v86, v87
    s_nop 1
    v_mfma_f32_32x32x16_bf16 v[224:239], v[12:15], v[80:83], v[224:239]
    s_waitcnt lgkmcnt(5)
    v_mul_f32 v88, v88, v72
    v_mul_f32 v89, v89, v73
    v_mul_f32 v90, v90, v74
    v_mul_f32 v91, v91, v75
    s_waitcnt lgkmcnt(1)
    v_mul_f32 v92, v92, v76
    v_mul_f32 v93, v93, v77
    v_mul_f32 v94, v94, v78
    v_mul_f32 v95, v95, v79
    v_cvt_pk_bf16_f32 v88, v88, v89
    v_cvt_pk_bf16_f32 v89, v90, v91
    v_cvt_pk_bf16_f32 v90, v92, v93
    v_cvt_pk_bf16_f32 v91, v94, v95
    s_nop 1
    v_mfma_f32_32x32x16_bf16 v[224:239], v[16:19], v[88:91], v[224:239]
    v_mfma_f32_32x32x16_bf16 v[80:95], v[8:11], v[28:31], 0
    ds_read_b128 v[28:31], v1 offset:18432
    v_mfma_f32_32x32x16_bf16 v[64:79], v[32:35], v[20:23], 0
    ds_read_b128 v[20:23], v1 offset:19456
    v_mul_f32 v96, v96, v112
    v_mul_f32 v97, v97, v113
    v_mul_f32 v98, v98, v114
    v_mul_f32 v99, v99, v115
    v_mul_f32 v100, v100, v116
    v_mul_f32 v101, v101, v117
    v_mul_f32 v102, v102, v118
    v_mul_f32 v103, v103, v119
    v_mul_f32 v104, v104, v120
    v_mul_f32 v105, v105, v121
    v_mul_f32 v106, v106, v122
    v_mul_f32 v107, v107, v123
    v_mul_f32 v108, v108, v124
    v_mul_f32 v109, v109, v125
    v_mul_f32 v110, v110, v126
    v_mul_f32 v111, v111, v127
    ds_read_u16_d16_hi v112, v2 offset:2
    ds_read_u16_d16_hi v113, v2 offset:258
    ds_read_u16_d16_hi v114, v2 offset:514
    ds_read_u16_d16_hi v115, v2 offset:770
    ds_read_u16_d16_hi v116, v2 offset:3074
    ds_read_u16_d16_hi v117, v2 offset:3330
    ds_read_u16_d16_hi v118, v2 offset:3586
    ds_read_u16_d16_hi v119, v2 offset:3842
    ds_read_u16_d16_hi v120, v2 offset:6146
    ds_read_u16_d16_hi v121, v2 offset:6402
    ds_read_u16_d16_hi v122, v2 offset:6658
    ds_read_u16_d16_hi v123, v2 offset:6914
    ds_read_u16_d16_hi v124, v2 offset:9218
    ds_read_u16_d16_hi v125, v2 offset:9474
    ds_read_u16_d16_hi v126, v2 offset:9730
    ds_read_u16_d16_hi v127, v2 offset:9986
    s_waitcnt lgkmcnt(12)
    v_mul_f32 v112, v112, v96
    v_mul_f32 v113, v113, v97
    v_mul_f32 v114, v114, v98
    v_mul_f32 v115, v115, v99
    s_waitcnt lgkmcnt(8)
    v_mul_f32 v116, v116, v100
    v_mul_f32 v117, v117, v101
    v_mul_f32 v118, v118, v102
    v_mfma_f32_32x32x16_bf16 v[64:79], v[36:39], v[24:27], v[64:79]
    ds_read_b128 v[24:27], v1 offset:29696
    v_mul_f32 v119, v119, v103
    v_cvt_pk_bf16_f32 v112, v112, v113
    v_cvt_pk_bf16_f32 v113, v114, v115
    v_cvt_pk_bf16_f32 v114, v116, v117
    v_cvt_pk_bf16_f32 v115, v118, v119
    s_nop 1
    v_mfma_f32_32x32x16_bf16 v[176:191], v[12:15], v[112:115], v[176:191]
    ds_read_u16_d16_hi v112, v2 offset:1026
    ds_read_u16_d16_hi v113, v2 offset:1282
    ds_read_u16_d16_hi v114, v2 offset:1538
    ds_read_u16_d16_hi v115, v2 offset:1794
    ds_read_u16_d16_hi v116, v2 offset:4098
    ds_read_u16_d16_hi v117, v2 offset:4354
    ds_read_u16_d16_hi v118, v2 offset:4610
    ds_read_u16_d16_hi v119, v2 offset:4866
    s_waitcnt lgkmcnt(13)
    v_mul_f32 v120, v120, v104
    v_mul_f32 v121, v121, v105
    v_mul_f32 v122, v122, v106
    v_mul_f32 v123, v123, v107
    s_waitcnt lgkmcnt(9)
    v_mul_f32 v124, v124, v108
    v_mul_f32 v125, v125, v109
    v_mul_f32 v126, v126, v110
    v_mul_f32 v127, v127, v111
    v_cvt_pk_bf16_f32 v120, v120, v121
    v_cvt_pk_bf16_f32 v121, v122, v123
    v_cvt_pk_bf16_f32 v122, v124, v125
    v_cvt_pk_bf16_f32 v123, v126, v127
    s_nop 1
    v_mfma_f32_32x32x16_bf16 v[176:191], v[16:19], v[120:123], v[176:191]
    ds_read_u16_d16_hi v120, v2 offset:7170
    ds_read_u16_d16_hi v121, v2 offset:7426
    ds_read_u16_d16_hi v122, v2 offset:7682
    ds_read_u16_d16_hi v123, v2 offset:7938
    ds_read_u16_d16_hi v124, v2 offset:10242
    ds_read_u16_d16_hi v125, v2 offset:10498
    ds_read_u16_d16_hi v126, v2 offset:10754
    ds_read_u16_d16_hi v127, v2 offset:11010
    s_waitcnt lgkmcnt(12)
    v_mul_f32 v112, v112, v96
    v_mul_f32 v113, v113, v97
    v_mul_f32 v114, v114, v98
    v_mul_f32 v115, v115, v99
    v_mfma_f32_32x32x16_bf16 v[64:79], v[40:43], v[28:31], v[64:79]
    ds_read_b128 v[28:31], v1 offset:20480
    s_waitcnt lgkmcnt(9)
    v_mul_f32 v116, v116, v100
    v_mul_f32 v117, v117, v101
    v_mul_f32 v118, v118, v102
    v_mul_f32 v119, v119, v103
    v_cvt_pk_bf16_f32 v112, v112, v113
    v_cvt_pk_bf16_f32 v113, v114, v115
    v_cvt_pk_bf16_f32 v114, v116, v117
    v_cvt_pk_bf16_f32 v115, v118, v119
    s_nop 1
    v_mfma_f32_32x32x16_bf16 v[208:223], v[12:15], v[112:115], v[208:223]
    ds_read_u16_d16_hi v112, v2 offset:2050
    ds_read_u16_d16_hi v113, v2 offset:2306
    ds_read_u16_d16_hi v114, v2 offset:2562
    ds_read_u16_d16_hi v115, v2 offset:2818
    ds_read_u16_d16_hi v116, v2 offset:5122
    ds_read_u16_d16_hi v117, v2 offset:5378
    ds_read_u16_d16_hi v118, v2 offset:5634
    ds_read_u16_d16_hi v119, v2 offset:5890
    s_waitcnt lgkmcnt(13)
    v_mul_f32 v120, v120, v104
    v_mul_f32 v121, v121, v105
    v_mul_f32 v122, v122, v106
    v_mul_f32 v123, v123, v107
    s_waitcnt lgkmcnt(9)
    v_mul_f32 v124, v124, v108
    v_mul_f32 v125, v125, v109
    v_mul_f32 v126, v126, v110
    v_mul_f32 v127, v127, v111
    v_cvt_pk_bf16_f32 v120, v120, v121
    v_cvt_pk_bf16_f32 v121, v122, v123
    v_cvt_pk_bf16_f32 v122, v124, v125
    v_cvt_pk_bf16_f32 v123, v126, v127
    s_nop 1
    v_mfma_f32_32x32x16_bf16 v[208:223], v[16:19], v[120:123], v[208:223]
    ds_read_u16_d16_hi v120, v2 offset:8194
    ds_read_u16_d16_hi v121, v2 offset:8450
    ds_read_u16_d16_hi v122, v2 offset:8706
    ds_read_u16_d16_hi v123, v2 offset:8962
    ds_read_u16_d16_hi v124, v2 offset:11266
    ds_read_u16_d16_hi v125, v2 offset:11522
    ds_read_u16_d16_hi v126, v2 offset:11778
    ds_read_u16_d16_hi v127, v2 offset:12034
    s_waitcnt lgkmcnt(12)
    v_mul_f32 v112, v112, v96
    v_mfma_f32_32x32x16_bf16 v[64:79], v[44:47], v[20:23], v[64:79]
    ds_read_b128 v[20:23], v1 offset:21504
    v_mul_f32 v113, v113, v97
    v_mul_f32 v114, v114, v98
    v_mul_f32 v115, v115, v99
    s_waitcnt lgkmcnt(9)
    v_mul_f32 v116, v116, v100
    v_mul_f32 v117, v117, v101
    v_mul_f32 v118, v118, v102
    v_mul_f32 v119, v119, v103
    v_cvt_pk_bf16_f32 v112, v112, v113
    v_cvt_pk_bf16_f32 v113, v114, v115
    v_cvt_pk_bf16_f32 v114, v116, v117
    v_cvt_pk_bf16_f32 v115, v118, v119
    s_nop 1
    v_mfma_f32_32x32x16_bf16 v[240:255], v[12:15], v[112:115], v[240:255]
    s_waitcnt lgkmcnt(5)
    v_mul_f32 v120, v120, v104
    v_mul_f32 v121, v121, v105
    v_mul_f32 v122, v122, v106
    v_mul_f32 v123, v123, v107
    s_waitcnt lgkmcnt(1)
    v_mul_f32 v124, v124, v108
    v_mul_f32 v125, v125, v109
    v_mul_f32 v126, v126, v110
    v_mul_f32 v127, v127, v111
    v_cvt_pk_bf16_f32 v120, v120, v121
    v_cvt_pk_bf16_f32 v121, v122, v123
    v_cvt_pk_bf16_f32 v122, v124, v125
    v_cvt_pk_bf16_f32 v123, v126, v127
    s_nop 1
    v_mfma_f32_32x32x16_bf16 v[240:255], v[16:19], v[120:123], v[240:255]
    s_cmp_lg_u32 s77, 0
    s_nop 10
    s_cbranch_scc1 M_nv20
    ds_read_b32 v112, v5 offset:524
    ds_read_b32 v113, v5 offset:652
    ds_read_b32 v114, v5 offset:780
    ds_read_b32 v115, v5 offset:908
    s_waitcnt lgkmcnt(3)
    v_and_or_b32 v112, v1, s63, v112
    s_waitcnt lgkmcnt(2)
    v_and_or_b32 v113, v1, s63, v113
    s_waitcnt lgkmcnt(1)
    v_and_or_b32 v114, v1, s63, v114
    s_waitcnt lgkmcnt(0)
    v_and_or_b32 v115, v1, s63, v115
    s_add_u32 m0, s51, 0
    s_nop 0
    buffer_load_dwordx4 v112, s[28:31], s64 offen lds
    s_add_u32 m0, s51, 1024
    s_nop 0
    buffer_load_dwordx4 v112, s[28:31], s65 offen lds
    s_add_u32 m0, s51, 2048
    s_nop 0
    buffer_load_dwordx4 v112, s[28:31], s66 offen lds
    s_add_u32 m0, s51, 3072
    s_nop 0
    buffer_load_dwordx4 v113, s[28:31], s64 offen lds
    s_add_u32 m0, s51, 4096
    s_nop 0
    buffer_load_dwordx4 v113, s[28:31], s65 offen lds
    s_add_u32 m0, s51, 5120
    s_nop 0
    buffer_load_dwordx4 v113, s[28:31], s66 offen lds
    s_add_u32 m0, s51, 6144
    s_nop 0
    buffer_load_dwordx4 v114, s[28:31], s64 offen lds
    s_add_u32 m0, s51, 7168
    s_nop 0
    buffer_load_dwordx4 v114, s[28:31], s65 offen lds
    s_add_u32 m0, s51, 8192
    s_nop 0
    buffer_load_dwordx4 v114, s[28:31], s66 offen lds
    s_add_u32 m0, s51, 9216
    s_nop 0
    buffer_load_dwordx4 v115, s[28:31], s64 offen lds
    s_add_u32 m0, s51, 10240
    s_nop 0
    buffer_load_dwordx4 v115, s[28:31], s65 offen lds
    s_add_u32 m0, s51, 11264
    s_nop 0
    buffer_load_dwordx4 v115, s[28:31], s66 offen lds
    s_branch M_nj20
M_nv20:
    s_cmp_eq_u32 s76, 0
    s_cbranch_scc1 M_nj20
    v_lshrrev_b32 v112, 7, v1
    v_and_b32 v113, 1, v112
    v_lshrrev_b32 v112, 1, v112
    v_lshl_add_u32 v112, v113, 2, v112
    v_lshlrev_b32 v112, 9, v112
    v_and_or_b32 v112, v1, s63, v112
    s_add_u32 m0, s51, 1024
    s_add_u32 s53, s40, 256
    buffer_load_dwordx4 v112, s[4:7], s53 offen  lds
    s_add_u32 m0, s51, 2048
    s_add_u32 s53, s40, 384
    buffer_load_dwordx4 v112, s[4:7], s53 offen  lds
    s_add_u32 m0, s51, 4096
    s_add_u32 s53, s41, 256
    buffer_load_dwordx4 v112, s[4:7], s53 offen  lds
    s_add_u32 m0, s51, 5120
    s_add_u32 s53, s41, 384
    buffer_load_dwordx4 v112, s[4:7], s53 offen  lds
    s_add_u32 m0, s51, 7168
    s_add_u32 s53, s42, 256
    buffer_load_dwordx4 v112, s[4:7], s53 offen  lds
    s_add_u32 m0, s51, 8192
    s_add_u32 s53, s42, 384
    buffer_load_dwordx4 v112, s[4:7], s53 offen  lds
    s_add_u32 m0, s51, 10240
    s_add_u32 s53, s43, 256
    buffer_load_dwordx4 v112, s[4:7], s53 offen  lds
    s_add_u32 m0, s51, 11264
    s_add_u32 s53, s43, 384
    buffer_load_dwordx4 v112, s[4:7], s53 offen  lds
M_nj20:
    v_mfma_f32_32x32x16_bf16 v[112:127], v[8:11], v[24:27], 0
    ds_read_b128 v[24:27], v1 offset:22528
    v_mfma_f32_32x32x16_bf16 v[96:111], v[32:35], v[28:31], 0
    ds_read_b128 v[28:31], v1 offset:23552
    v_mul_f32 v64, v64, v80
    v_mul_f32 v65, v65, v81
    v_mul_f32 v66, v66, v82
    v_mul_f32 v67, v67, v83
    v_mul_f32 v68, v68, v84
    v_mul_f32 v69, v69, v85
    v_mul_f32 v70, v70, v86
    v_mul_f32 v71, v71, v87
    v_mul_f32 v72, v72, v88
    v_mul_f32 v73, v73, v89
    v_mul_f32 v74, v74, v90
    v_mul_f32 v75, v75, v91
    s_waitcnt lgkmcnt(2)
    v_mfma_f32_32x32x16_bf16 v[96:111], v[36:39], v[20:23], v[96:111]
    v_mul_f32 v76, v76, v92
    v_mul_f32 v77, v77, v93
    v_mul_f32 v78, v78, v94
    v_mul_f32 v79, v79, v95
    ds_read_b64 v[80:81], v0 offset:2080
    ds_read_b64 v[88:89], v0 offset:2088
    ds_read_b64 v[82:83], v0 offset:2192
    ds_read_b64 v[90:91], v0 offset:2200
    ds_read_b64 v[84:85], v0 offset:2304
    ds_read_b64 v[92:93], v0 offset:2312
    ds_read_b64 v[86:87], v0 offset:2416
    ds_read_b64 v[94:95], v0 offset:2424
    v_cvt_pk_bf16_f32 v64, v64, v65
    v_cvt_pk_bf16_f32 v65, v66, v67
    v_cvt_pk_bf16_f32 v66, v68, v69
    v_cvt_pk_bf16_f32 v67, v70, v71
    v_cvt_pk_bf16_f32 v68, v72, v73
    v_cvt_pk_bf16_f32 v69, v74, v75
    v_cvt_pk_bf16_f32 v70, v76, v77
    s_waitcnt lgkmcnt(9)
    v_mfma_f32_32x32x16_bf16 v[96:111], v[40:43], v[24:27], v[96:111]
    v_cvt_pk_bf16_f32 v71, v78, v79
    v_pk_lshrrev_b16 v72, 14, v12 op_sel_hi:[0,1]
    v_pk_lshrrev_b16 v73, 14, v13 op_sel_hi:[0,1]
    v_pk_lshrrev_b16 v74, 14, v14 op_sel_hi:[0,1]
    v_pk_lshrrev_b16 v75, 14, v15 op_sel_hi:[0,1]
    v_pk_lshrrev_b16 v76, 14, v16 op_sel_hi:[0,1]
    v_pk_lshrrev_b16 v77, 14, v17 op_sel_hi:[0,1]
    v_pk_lshrrev_b16 v78, 14, v18 op_sel_hi:[0,1]
    v_pk_lshrrev_b16 v79, 14, v19 op_sel_hi:[0,1]
    s_waitcnt lgkmcnt(0)
    v_pk_mul_lo_u16 v80, v72, v80
    v_pk_mul_lo_u16 v81, v73, v81
    v_pk_mul_lo_u16 v82, v74, v82
    v_mfma_f32_32x32x16_bf16 v[96:111], v[44:47], v[28:31], v[96:111]
    v_pk_mul_lo_u16 v83, v75, v83
    v_pk_mul_lo_u16 v84, v76, v84
    v_pk_mul_lo_u16 v85, v77, v85
    v_pk_mul_lo_u16 v86, v78, v86
    v_pk_mul_lo_u16 v87, v79, v87
    v_pk_mul_lo_u16 v88, v72, v88
    v_pk_mul_lo_u16 v89, v73, v89
    v_pk_mul_lo_u16 v90, v74, v90
    v_pk_mul_lo_u16 v91, v75, v91
    v_pk_mul_lo_u16 v92, v76, v92
    v_pk_mul_lo_u16 v93, v77, v93
    v_pk_mul_lo_u16 v94, v78, v94
    v_pk_mul_lo_u16 v95, v79, v95
    v_mfma_f32_32x32x16_bf16 v[160:175], v[80:83], v[64:67], v[160:175]
    v_mul_f32 v96, v96, v112
    v_mul_f32 v97, v97, v113
    v_mul_f32 v98, v98, v114
    v_mul_f32 v99, v99, v115
    v_mul_f32 v100, v100, v116
    v_mul_f32 v101, v101, v117
    v_mfma_f32_32x32x16_bf16 v[160:175], v[84:87], v[68:71], v[160:175]
    v_mul_f32 v102, v102, v118
    v_mul_f32 v103, v103, v119
    v_mul_f32 v104, v104, v120
    v_mul_f32 v105, v105, v121
    v_mul_f32 v106, v106, v122
    v_mul_f32 v107, v107, v123
    v_mfma_f32_32x32x16_bf16 v[192:207], v[88:91], v[64:67], v[192:207]
    v_mul_f32 v108, v108, v124
    v_mul_f32 v109, v109, v125
    v_mul_f32 v110, v110, v126
    v_mul_f32 v111, v111, v127
    ds_read_b64 v[112:113], v0 offset:2096
    ds_read_b64 v[114:115], v0 offset:2208
    ds_read_b64 v[116:117], v0 offset:2320
    ds_read_b64 v[118:119], v0 offset:2432
    v_cvt_pk_bf16_f32 v96, v96, v97
    v_mfma_f32_32x32x16_bf16 v[192:207], v[92:95], v[68:71], v[192:207]
    v_cvt_pk_bf16_f32 v97, v98, v99
    v_cvt_pk_bf16_f32 v98, v100, v101
    v_cvt_pk_bf16_f32 v99, v102, v103
    v_cvt_pk_bf16_f32 v100, v104, v105
    v_cvt_pk_bf16_f32 v101, v106, v107
    v_cvt_pk_bf16_f32 v102, v108, v109
    v_cvt_pk_bf16_f32 v103, v110, v111
    s_waitcnt lgkmcnt(0)
    v_pk_mul_lo_u16 v112, v72, v112
    v_pk_mul_lo_u16 v113, v73, v113
    v_pk_mul_lo_u16 v114, v74, v114
    v_pk_mul_lo_u16 v115, v75, v115
    v_pk_mul_lo_u16 v116, v76, v116
    v_pk_mul_lo_u16 v117, v77, v117
    v_pk_mul_lo_u16 v118, v78, v118
    v_pk_mul_lo_u16 v119, v79, v119
    v_mfma_f32_32x32x16_bf16 v[176:191], v[80:83], v[96:99], v[176:191]
    ds_read_b128 v[104:107], v3 offset:512
    ds_read_b128 v[72:75], v7
    ds_read_b128 v[76:79], v7 offset:16
    ds_read_b64 v[12:13], v4 offset:2496
    ds_read_b64 v[14:15], v4 offset:2608
    ds_read_b64 v[16:17], v4 offset:2720
    ds_read_b64 v[18:19], v4 offset:2832
    ds_read_b128 v[20:23], v1 offset:24576
    ds_read_b128 v[24:27], v1 offset:0
    ds_read_b128 v[28:31], v1 offset:1024
    s_waitcnt lgkmcnt(7)
    v_mul_f32 v72, v104, v72
    v_mul_f32 v73, v104, v73
    v_mul_f32 v74, v104, v74
    v_mul_f32 v75, v104, v75
    v_mul_f32 v76, v104, v76
    v_mfma_f32_32x32x16_bf16 v[176:191], v[84:87], v[100:103], v[176:191]
    v_mul_f32 v77, v104, v77
    v_mul_f32 v78, v104, v78
    v_mul_f32 v79, v104, v79
    v_cvt_pk_bf16_f32 v72, 0, v72
    v_cvt_pk_bf16_f32 v73, 0, v73
    v_cvt_pk_bf16_f32 v74, 0, v74
    v_cvt_pk_bf16_f32 v75, 0, v75
    v_mfma_f32_32x32x16_bf16 v[208:223], v[88:91], v[96:99], v[208:223]
    v_cvt_pk_bf16_f32 v76, 0, v76
    v_cvt_pk_bf16_f32 v77, 0, v77
    v_cvt_pk_bf16_f32 v78, 0, v78
    v_cvt_pk_bf16_f32 v79, 0, v79
    v_mul_f32 v72, s61, v72
    v_mul_f32 v73, s61, v73
    v_mfma_f32_32x32x16_bf16 v[208:223], v[92:95], v[100:103], v[208:223]
    v_mul_f32 v74, s61, v74
    v_mul_f32 v75, s61, v75
    v_mul_f32 v76, s61, v76
    v_mul_f32 v77, s61, v77
    v_mul_f32 v78, s61, v78
    v_mul_f32 v79, s61, v79
    v_sin_f32 v72, v72
    v_mfma_f32_32x32x16_bf16 v[224:239], v[112:115], v[64:67], v[224:239]
    v_sin_f32 v73, v73
    v_sin_f32 v74, v74
    v_sin_f32 v75, v75
    v_sin_f32 v76, v76
    v_sin_f32 v77, v77
    v_sin_f32 v78, v78
    v_sin_f32 v79, v79
    v_mfma_f32_32x32x16_bf16 v[240:255], v[112:115], v[96:99], v[240:255]
    v_mul_f32 v72, v72, v105
    v_mul_f32 v73, v73, v105
    v_mul_f32 v74, v74, v105
    v_mul_f32 v75, v75, v105
    v_mul_f32 v76, v76, v105
    v_mul_f32 v77, v77, v105
    v_mfma_f32_32x32x16_bf16 v[224:239], v[116:119], v[68:71], v[224:239]
    v_mul_f32 v78, v78, v105
    v_mul_f32 v79, v79, v105
    v_cvt_pk_bf16_f32 v8, v72, v73
    v_cvt_pk_bf16_f32 v9, v74, v75
    v_cvt_pk_bf16_f32 v10, v76, v77
    v_cvt_pk_bf16_f32 v11, v78, v79
    s_waitcnt lgkmcnt(3)
    v_pk_lshlrev_b16 v12, v6, v12
    v_mfma_f32_32x32x16_bf16 v[240:255], v[116:119], v[100:103], v[240:255]
    v_pk_lshlrev_b16 v13, v6, v13
    v_pk_lshlrev_b16 v14, v6, v14
    v_pk_lshlrev_b16 v15, v6, v15
    v_pk_lshlrev_b16 v16, v6, v16
    v_pk_lshlrev_b16 v17, v6, v17
    v_pk_lshlrev_b16 v18, v6, v18
    v_pk_lshlrev_b16 v19, v6, v19
    v_add_u32 v3, 512, v3
    v_add_u32 v4, 448, v4
    v_add_u32 v0, 448, v0
    v_add_u32 v5, 512, v5
    s_waitcnt lgkmcnt(0)
    s_add_u32 s49, s49, 1
    s_cmp_lt_u32 s49, s48
    s_cbranch_scc0 M_wend
    s_waitcnt vmcnt(12)
    v_mfma_f32_32x32x16_bf16 v[80:95], v[8:11], v[20:23], 0
    ds_read_b128 v[20:23], v1 offset:2048
    s_add_u32 s77, s49, 1
    s_cmp_lt_u32 s77, s48
    s_cselect_b32 s77, 0, 0x40000000
    ds_read_b32 v47, v3 offset:524
    v_bfe_u32 v46, v1, 9, 1
    s_waitcnt lgkmcnt(0)
    v_lshrrev_b32 v47, 2, v47
    v_lshl_add_u32 v47, v46, 6, v47
    buffer_load_dwordx4 v[32:35], v47, s[72:75], s77 offen offset:0
    buffer_load_dwordx4 v[36:39], v47, s[72:75], s77 offen offset:16
    buffer_load_dwordx4 v[40:43], v47, s[72:75], s77 offen offset:32
    buffer_load_dwordx4 v[44:47], v47, s[72:75], s77 offen offset:48
    v_mfma_f32_32x32x16_bf16 v[64:79], v[48:51], v[24:27], 0
    ds_read_b128 v[24:27], v1 offset:3072
    v_mfma_f32_32x32x16_bf16 v[64:79], v[52:55], v[28:31], v[64:79]
    ds_read_b128 v[28:31], v1 offset:25600
    v_mfma_f32_32x32x16_bf16 v[64:79], v[56:59], v[20:23], v[64:79]
    ds_read_b128 v[20:23], v1 offset:4096
    s_waitcnt lgkmcnt(2)
    v_mfma_f32_32x32x16_bf16 v[64:79], v[60:63], v[24:27], v[64:79]
    ds_read_b128 v[24:27], v1 offset:5120
    s_waitcnt lgkmcnt(2)
    v_mfma_f32_32x32x16_bf16 v[112:127], v[8:11], v[28:31], 0
    ds_read_b128 v[28:31], v1 offset:6144
    s_waitcnt lgkmcnt(2)
    v_mfma_f32_32x32x16_bf16 v[96:111], v[48:51], v[20:23], 0
    ds_read_b128 v[20:23], v1 offset:7168
    s_nop 4
    v_mul_f32 v64, v64, v80
    v_mul_f32 v65, v65, v81
    v_mul_f32 v66, v66, v82
    v_mul_f32 v67, v67, v83
    v_mul_f32 v68, v68, v84
    v_mul_f32 v69, v69, v85
    s_waitcnt lgkmcnt(2)
    v_mfma_f32_32x32x16_bf16 v[96:111], v[52:55], v[24:27], v[96:111]
    ds_read_b128 v[24:27], v1 offset:26624
    v_mul_f32 v70, v70, v86
    v_mul_f32 v71, v71, v87
    v_mul_f32 v72, v72, v88
    v_mul_f32 v73, v73, v89
    v_mul_f32 v74, v74, v90
    v_mul_f32 v75, v75, v91
    v_mul_f32 v76, v76, v92
    s_waitcnt lgkmcnt(2)
    v_mfma_f32_32x32x16_bf16 v[96:111], v[56:59], v[28:31], v[96:111]
    ds_read_b128 v[28:31], v1 offset:8192
    v_mul_f32 v77, v77, v93
    v_mul_f32 v78, v78, v94
WUP_3313:
    s_cbranch_execz WUR_1
    v_mul_f32 v79, v79, v95
    v_cvt_pk_bf16_f32 v64, v64, v65
    v_cvt_pk_bf16_f32 v65, v66, v67
    v_cvt_pk_bf16_f32 v66, v68, v69
    s_waitcnt lgkmcnt(2)
    v_mfma_f32_32x32x16_bf16 v[96:111], v[60:63], v[20:23], v[96:111]
    ds_read_b128 v[20:23], v1 offset:9216
    v_cvt_pk_bf16_f32 v67, v70, v71
    v_cvt_pk_bf16_f32 v68, v72, v73
    v_cvt_pk_bf16_f32 v69, v74, v75
    v_cvt_pk_bf16_f32 v70, v76, v77
    v_cvt_pk_bf16_f32 v71, v78, v79
    v_mfma_f32_32x32x16_bf16 v[128:143], v[12:15], v[64:67], v[128:143]
    s_nop 0
    v_mfma_f32_32x32x16_bf16 v[128:143], v[16:19], v[68:71], v[128:143]
    s_waitcnt lgkmcnt(2)
    v_mfma_f32_32x32x16_bf16 v[80:95], v[8:11], v[24:27], 0
    ds_read_b128 v[24:27], v1 offset:10240
    s_waitcnt lgkmcnt(2)
    v_mfma_f32_32x32x16_bf16 v[64:79], v[48:51], v[28:31], 0
    ds_read_b128 v[28:31], v1 offset:11264
    v_mul_f32 v96, v96, v112
    v_mul_f32 v97, v97, v113
    v_mul_f32 v98, v98, v114
    v_mul_f32 v99, v99, v115
    v_mul_f32 v100, v100, v116
    v_mul_f32 v101, v101, v117
    s_waitcnt lgkmcnt(2)
    v_mfma_f32_32x32x16_bf16 v[64:79], v[52:55], v[20:23], v[64:79]
    ds_read_b128 v[20:23], v1 offset:27648
    v_mul_f32 v102, v102, v118
    v_mul_f32 v103, v103, v119
    v_mul_f32 v104, v104, v120
    v_mul_f32 v105, v105, v121
    v_mul_f32 v106, v106, v122
    v_mul_f32 v107, v107, v123
    v_mul_f32 v108, v108, v124
    s_waitcnt lgkmcnt(2)
    v_mfma_f32_32x32x16_bf16 v[64:79], v[56:59], v[24:27], v[64:79]
    ds_read_b128 v[24:27], v1 offset:12288
    v_mul_f32 v109, v109, v125
    v_mul_f32 v110, v110, v126
    v_mul_f32 v111, v111, v127
    v_cvt_pk_bf16_f32 v96, v96, v97
    v_cvt_pk_bf16_f32 v97, v98, v99
    v_cvt_pk_bf16_f32 v98, v100, v101
    s_waitcnt lgkmcnt(2)
    v_mfma_f32_32x32x16_bf16 v[64:79], v[60:63], v[28:31], v[64:79]
    ds_read_b128 v[28:31], v1 offset:13312
    v_cvt_pk_bf16_f32 v99, v102, v103
    v_cvt_pk_bf16_f32 v100, v104, v105
    v_cvt_pk_bf16_f32 v101, v106, v107
    v_cvt_pk_bf16_f32 v102, v108, v109
    v_cvt_pk_bf16_f32 v103, v110, v111
    v_mfma_f32_32x32x16_bf16 v[144:159], v[12:15], v[96:99], v[144:159]
    s_nop 0
    v_mfma_f32_32x32x16_bf16 v[144:159], v[16:19], v[100:103], v[144:159]
    s_waitcnt lgkmcnt(2)
    v_mfma_f32_32x32x16_bf16 v[112:127], v[8:11], v[20:23], 0
    ds_read_b128 v[20:23], v1 offset:14336
    s_waitcnt lgkmcnt(2)
    v_mfma_f32_32x32x16_bf16 v[96:111], v[48:51], v[24:27], 0
    ds_read_b128 v[24:27], v1 offset:15360
    v_mul_f32 v64, v64, v80
    v_mul_f32 v65, v65, v81
    v_mul_f32 v66, v66, v82
    v_mul_f32 v67, v67, v83
    v_mul_f32 v68, v68, v84
    v_mul_f32 v69, v69, v85
    v_mul_f32 v70, v70, v86
    v_mul_f32 v71, v71, v87
    v_mul_f32 v72, v72, v88
    v_mul_f32 v73, v73, v89
    v_mul_f32 v74, v74, v90
    v_mul_f32 v75, v75, v91
    v_mul_f32 v76, v76, v92
    v_mul_f32 v77, v77, v93
    v_mul_f32 v78, v78, v94
    v_mul_f32 v79, v79, v95
    s_waitcnt vmcnt(4)
    ds_read_u16_d16_hi v80, v2 offset:0
    ds_read_u16_d16_hi v81, v2 offset:256
    ds_read_u16_d16_hi v82, v2 offset:512
    ds_read_u16_d16_hi v83, v2 offset:768
    ds_read_u16_d16_hi v84, v2 offset:3072
    ds_read_u16_d16_hi v85, v2 offset:3328
    ds_read_u16_d16_hi v86, v2 offset:3584
    ds_read_u16_d16_hi v87, v2 offset:3840
    ds_read_u16_d16_hi v88, v2 offset:6144
    ds_read_u16_d16_hi v89, v2 offset:6400
    ds_read_u16_d16_hi v90, v2 offset:6656
    ds_read_u16_d16_hi v91, v2 offset:6912
    ds_read_u16_d16_hi v92, v2 offset:9216
    ds_read_u16_d16_hi v93, v2 offset:9472
    ds_read_u16_d16_hi v94, v2 offset:9728
    ds_read_u16_d16_hi v95, v2 offset:9984
    s_waitcnt lgkmcnt(12)
    v_mul_f32 v80, v80, v64
    v_mul_f32 v81, v81, v65
    v_mul_f32 v82, v82, v66
    v_mul_f32 v83, v83, v67
    s_waitcnt lgkmcnt(8)
    v_mul_f32 v84, v84, v68
    v_mul_f32 v85, v85, v69
    v_mfma_f32_32x32x16_bf16 v[96:111], v[52:55], v[28:31], v[96:111]
    ds_read_b128 v[28:31], v1 offset:28672
    v_mul_f32 v86, v86, v70
    v_mul_f32 v87, v87, v71
    v_cvt_pk_bf16_f32 v80, v80, v81
    v_cvt_pk_bf16_f32 v81, v82, v83
    v_cvt_pk_bf16_f32 v82, v84, v85
    v_cvt_pk_bf16_f32 v83, v86, v87
    s_nop 1
    v_mfma_f32_32x32x16_bf16 v[160:175], v[12:15], v[80:83], v[160:175]
    ds_read_u16_d16_hi v80, v2 offset:1024
    ds_read_u16_d16_hi v81, v2 offset:1280
    ds_read_u16_d16_hi v82, v2 offset:1536
    ds_read_u16_d16_hi v83, v2 offset:1792
    ds_read_u16_d16_hi v84, v2 offset:4096
    ds_read_u16_d16_hi v85, v2 offset:4352
    ds_read_u16_d16_hi v86, v2 offset:4608
    ds_read_u16_d16_hi v87, v2 offset:4864
    s_waitcnt lgkmcnt(13)
    v_mul_f32 v88, v88, v72
    v_mul_f32 v89, v89, v73
    v_mul_f32 v90, v90, v74
    v_mul_f32 v91, v91, v75
    s_waitcnt lgkmcnt(9)
    v_mul_f32 v92, v92, v76
    v_mul_f32 v93, v93, v77
    v_mul_f32 v94, v94, v78
    v_mul_f32 v95, v95, v79
    v_cvt_pk_bf16_f32 v88, v88, v89
    v_cvt_pk_bf16_f32 v89, v90, v91
    v_cvt_pk_bf16_f32 v90, v92, v93
    v_cvt_pk_bf16_f32 v91, v94, v95
    s_nop 1
    v_mfma_f32_32x32x16_bf16 v[160:175], v[16:19], v[88:91], v[160:175]
    ds_read_u16_d16_hi v88, v2 offset:7168
    ds_read_u16_d16_hi v89, v2 offset:7424
    ds_read_u16_d16_hi v90, v2 offset:7680
    ds_read_u16_d16_hi v91, v2 offset:7936
    ds_read_u16_d16_hi v92, v2 offset:10240
    ds_read_u16_d16_hi v93, v2 offset:10496
    ds_read_u16_d16_hi v94, v2 offset:10752
    ds_read_u16_d16_hi v95, v2 offset:11008
    s_waitcnt lgkmcnt(12)
    v_mul_f32 v80, v80, v64
    v_mul_f32 v81, v81, v65
    v_mul_f32 v82, v82, v66
    v_mfma_f32_32x32x16_bf16 v[96:111], v[56:59], v[20:23], v[96:111]
    ds_read_b128 v[20:23], v1 offset:16384
    v_mul_f32 v83, v83, v67
    s_waitcnt lgkmcnt(9)
    v_mul_f32 v84, v84, v68
    v_mul_f32 v85, v85, v69
    v_mul_f32 v86, v86, v70
    v_mul_f32 v87, v87, v71
    v_cvt_pk_bf16_f32 v80, v80, v81
    v_cvt_pk_bf16_f32 v81, v82, v83
    v_cvt_pk_bf16_f32 v82, v84, v85
    v_cvt_pk_bf16_f32 v83, v86, v87
    s_nop 1
    v_mfma_f32_32x32x16_bf16 v[192:207], v[12:15], v[80:83], v[192:207]
    ds_read_u16_d16_hi v80, v2 offset:2048
    ds_read_u16_d16_hi v81, v2 offset:2304
    ds_read_u16_d16_hi v82, v2 offset:2560
    ds_read_u16_d16_hi v83, v2 offset:2816
    ds_read_u16_d16_hi v84, v2 offset:5120
    ds_read_u16_d16_hi v85, v2 offset:5376
    ds_read_u16_d16_hi v86, v2 offset:5632
    ds_read_u16_d16_hi v87, v2 offset:5888
    s_waitcnt lgkmcnt(13)
    v_mul_f32 v88, v88, v72
    v_mul_f32 v89, v89, v73
    v_mul_f32 v90, v90, v74
    v_mul_f32 v91, v91, v75
    s_waitcnt lgkmcnt(9)
    v_mul_f32 v92, v92, v76
    v_mul_f32 v93, v93, v77
    v_mul_f32 v94, v94, v78
    v_mul_f32 v95, v95, v79
    v_cvt_pk_bf16_f32 v88, v88, v89
    v_cvt_pk_bf16_f32 v89, v90, v91
    v_cvt_pk_bf16_f32 v90, v92, v93
    v_cvt_pk_bf16_f32 v91, v94, v95
    s_nop 1
    v_mfma_f32_32x32x16_bf16 v[192:207], v[16:19], v[88:91], v[192:207]
    ds_read_u16_d16_hi v88, v2 offset:8192
    ds_read_u16_d16_hi v89, v2 offset:8448
    ds_read_u16_d16_hi v90, v2 offset:8704
    ds_read_u16_d16_hi v91, v2 offset:8960
    ds_read_u16_d16_hi v92, v2 offset:11264
    ds_read_u16_d16_hi v93, v2 offset:11520
    ds_read_u16_d16_hi v94, v2 offset:11776
    ds_read_u16_d16_hi v95, v2 offset:12032
    v_mfma_f32_32x32x16_bf16 v[96:111], v[60:63], v[24:27], v[96:111]
    ds_read_b128 v[24:27], v1 offset:17408
    s_waitcnt lgkmcnt(13)
    v_mul_f32 v80, v80, v64
    v_mul_f32 v81, v81, v65
    v_mul_f32 v82, v82, v66
    v_mul_f32 v83, v83, v67
    s_waitcnt lgkmcnt(9)
    v_mul_f32 v84, v84, v68
    v_mul_f32 v85, v85, v69
    v_mul_f32 v86, v86, v70
    v_mul_f32 v87, v87, v71
    v_cvt_pk_bf16_f32 v80, v80, v81
    v_cvt_pk_bf16_f32 v81, v82, v83
    v_cvt_pk_bf16_f32 v82, v84, v85
    v_cvt_pk_bf16_f32 v83, v86, v87
    s_nop 1
    v_mfma_f32_32x32x16_bf16 v[224:239], v[12:15], v[80:83], v[224:239]
    s_waitcnt lgkmcnt(5)
    v_mul_f32 v88, v88, v72
    v_mul_f32 v89, v89, v73
    v_mul_f32 v90, v90, v74
    v_mul_f32 v91, v91, v75
    s_waitcnt lgkmcnt(1)
    v_mul_f32 v92, v92, v76
    v_mul_f32 v93, v93, v77
    v_mul_f32 v94, v94, v78
    v_mul_f32 v95, v95, v79
    v_cvt_pk_bf16_f32 v88, v88, v89
    v_cvt_pk_bf16_f32 v89, v90, v91
    v_cvt_pk_bf16_f32 v90, v92, v93
    v_cvt_pk_bf16_f32 v91, v94, v95
    s_nop 1
    v_mfma_f32_32x32x16_bf16 v[224:239], v[16:19], v[88:91], v[224:239]
    v_mfma_f32_32x32x16_bf16 v[80:95], v[8:11], v[28:31], 0
    ds_read_b128 v[28:31], v1 offset:18432
    v_mfma_f32_32x32x16_bf16 v[64:79], v[48:51], v[20:23], 0
    ds_read_b128 v[20:23], v1 offset:19456
    v_mul_f32 v96, v96, v112
    v_mul_f32 v97, v97, v113
    v_mul_f32 v98, v98, v114
    v_mul_f32 v99, v99, v115
    v_mul_f32 v100, v100, v116
    v_mul_f32 v101, v101, v117
    v_mul_f32 v102, v102, v118
    v_mul_f32 v103, v103, v119
    v_mul_f32 v104, v104, v120
    v_mul_f32 v105, v105, v121
    v_mul_f32 v106, v106, v122
    v_mul_f32 v107, v107, v123
    v_mul_f32 v108, v108, v124
    v_mul_f32 v109, v109, v125
    v_mul_f32 v110, v110, v126
    v_mul_f32 v111, v111, v127
    ds_read_u16_d16_hi v112, v2 offset:2
    ds_read_u16_d16_hi v113, v2 offset:258
    ds_read_u16_d16_hi v114, v2 offset:514
    ds_read_u16_d16_hi v115, v2 offset:770
    ds_read_u16_d16_hi v116, v2 offset:3074
    ds_read_u16_d16_hi v117, v2 offset:3330
    ds_read_u16_d16_hi v118, v2 offset:3586
    ds_read_u16_d16_hi v119, v2 offset:3842
    ds_read_u16_d16_hi v120, v2 offset:6146
    ds_read_u16_d16_hi v121, v2 offset:6402
    ds_read_u16_d16_hi v122, v2 offset:6658
    ds_read_u16_d16_hi v123, v2 offset:6914
    ds_read_u16_d16_hi v124, v2 offset:9218
    ds_read_u16_d16_hi v125, v2 offset:9474
    ds_read_u16_d16_hi v126, v2 offset:9730
    ds_read_u16_d16_hi v127, v2 offset:9986
    s_waitcnt lgkmcnt(12)
    v_mul_f32 v112, v112, v96
    v_mul_f32 v113, v113, v97
    v_mul_f32 v114, v114, v98
    v_mul_f32 v115, v115, v99
    s_waitcnt lgkmcnt(8)
    v_mul_f32 v116, v116, v100
    v_mul_f32 v117, v117, v101
    v_mul_f32 v118, v118, v102
    v_mfma_f32_32x32x16_bf16 v[64:79], v[52:55], v[24:27], v[64:79]
    ds_read_b128 v[24:27], v1 offset:29696
    v_mul_f32 v119, v119, v103
    v_cvt_pk_bf16_f32 v112, v112, v113
    v_cvt_pk_bf16_f32 v113, v114, v115
    v_cvt_pk_bf16_f32 v114, v116, v117
    v_cvt_pk_bf16_f32 v115, v118, v119
    s_nop 1
    v_mfma_f32_32x32x16_bf16 v[176:191], v[12:15], v[112:115], v[176:191]
    ds_read_u16_d16_hi v112, v2 offset:1026
    ds_read_u16_d16_hi v113, v2 offset:1282
    ds_read_u16_d16_hi v114, v2 offset:1538
    ds_read_u16_d16_hi v115, v2 offset:1794
    ds_read_u16_d16_hi v116, v2 offset:4098
    ds_read_u16_d16_hi v117, v2 offset:4354
    ds_read_u16_d16_hi v118, v2 offset:4610
    ds_read_u16_d16_hi v119, v2 offset:4866
    s_waitcnt lgkmcnt(13)
    v_mul_f32 v120, v120, v104
    v_mul_f32 v121, v121, v105
    v_mul_f32 v122, v122, v106
    v_mul_f32 v123, v123, v107
    s_waitcnt lgkmcnt(9)
    v_mul_f32 v124, v124, v108
    v_mul_f32 v125, v125, v109
    v_mul_f32 v126, v126, v110
    v_mul_f32 v127, v127, v111
    v_cvt_pk_bf16_f32 v120, v120, v121
    v_cvt_pk_bf16_f32 v121, v122, v123
    v_cvt_pk_bf16_f32 v122, v124, v125
    v_cvt_pk_bf16_f32 v123, v126, v127
    s_nop 1
    v_mfma_f32_32x32x16_bf16 v[176:191], v[16:19], v[120:123], v[176:191]
    ds_read_u16_d16_hi v120, v2 offset:7170
    ds_read_u16_d16_hi v121, v2 offset:7426
    ds_read_u16_d16_hi v122, v2 offset:7682
    ds_read_u16_d16_hi v123, v2 offset:7938
    ds_read_u16_d16_hi v124, v2 offset:10242
    ds_read_u16_d16_hi v125, v2 offset:10498
    ds_read_u16_d16_hi v126, v2 offset:10754
    ds_read_u16_d16_hi v127, v2 offset:11010
    s_waitcnt lgkmcnt(12)
    v_mul_f32 v112, v112, v96
    v_mul_f32 v113, v113, v97
    v_mul_f32 v114, v114, v98
    v_mul_f32 v115, v115, v99
    v_mfma_f32_32x32x16_bf16 v[64:79], v[56:59], v[28:31], v[64:79]
    ds_read_b128 v[28:31], v1 offset:20480
    s_waitcnt lgkmcnt(9)
    v_mul_f32 v116, v116, v100
    v_mul_f32 v117, v117, v101
    v_mul_f32 v118, v118, v102
    v_mul_f32 v119, v119, v103
    v_cvt_pk_bf16_f32 v112, v112, v113
    v_cvt_pk_bf16_f32 v113, v114, v115
    v_cvt_pk_bf16_f32 v114, v116, v117
    v_cvt_pk_bf16_f32 v115, v118, v119
    s_nop 1
    v_mfma_f32_32x32x16_bf16 v[208:223], v[12:15], v[112:115], v[208:223]
    ds_read_u16_d16_hi v112, v2 offset:2050
    ds_read_u16_d16_hi v113, v2 offset:2306
    ds_read_u16_d16_hi v114, v2 offset:2562
    ds_read_u16_d16_hi v115, v2 offset:2818
    ds_read_u16_d16_hi v116, v2 offset:5122
    ds_read_u16_d16_hi v117, v2 offset:5378
    ds_read_u16_d16_hi v118, v2 offset:5634
    ds_read_u16_d16_hi v119, v2 offset:5890
    s_waitcnt lgkmcnt(13)
    v_mul_f32 v120, v120, v104
    v_mul_f32 v121, v121, v105
    v_mul_f32 v122, v122, v106
    v_mul_f32 v123, v123, v107
    s_waitcnt lgkmcnt(9)
    v_mul_f32 v124, v124, v108
    v_mul_f32 v125, v125, v109
    v_mul_f32 v126, v126, v110
    v_mul_f32 v127, v127, v111
    v_cvt_pk_bf16_f32 v120, v120, v121
    v_cvt_pk_bf16_f32 v121, v122, v123
    v_cvt_pk_bf16_f32 v122, v124, v125
    v_cvt_pk_bf16_f32 v123, v126, v127
    s_nop 1
    v_mfma_f32_32x32x16_bf16 v[208:223], v[16:19], v[120:123], v[208:223]
    ds_read_u16_d16_hi v120, v2 offset:8194
    ds_read_u16_d16_hi v121, v2 offset:8450
    ds_read_u16_d16_hi v122, v2 offset:8706
    ds_read_u16_d16_hi v123, v2 offset:8962
    ds_read_u16_d16_hi v124, v2 offset:11266
    ds_read_u16_d16_hi v125, v2 offset:11522
    ds_read_u16_d16_hi v126, v2 offset:11778
    ds_read_u16_d16_hi v127, v2 offset:12034
    s_waitcnt lgkmcnt(12)
    v_mul_f32 v112, v112, v96
    v_mfma_f32_32x32x16_bf16 v[64:79], v[60:63], v[20:23], v[64:79]
    ds_read_b128 v[20:23], v1 offset:21504
    v_mul_f32 v113, v113, v97
    v_mul_f32 v114, v114, v98
    v_mul_f32 v115, v115, v99
    s_waitcnt lgkmcnt(9)
    v_mul_f32 v116, v116, v100
    v_mul_f32 v117, v117, v101
    v_mul_f32 v118, v118, v102
    v_mul_f32 v119, v119, v103
    v_cvt_pk_bf16_f32 v112, v112, v113
    v_cvt_pk_bf16_f32 v113, v114, v115
    v_cvt_pk_bf16_f32 v114, v116, v117
    v_cvt_pk_bf16_f32 v115, v118, v119
    s_nop 1
    v_mfma_f32_32x32x16_bf16 v[240:255], v[12:15], v[112:115], v[240:255]
    s_waitcnt lgkmcnt(5)
    v_mul_f32 v120, v120, v104
    v_mul_f32 v121, v121, v105
    v_mul_f32 v122, v122, v106
    v_mul_f32 v123, v123, v107
    s_waitcnt lgkmcnt(1)
    v_mul_f32 v124, v124, v108
    v_mul_f32 v125, v125, v109
    v_mul_f32 v126, v126, v110
    v_mul_f32 v127, v127, v111
    v_cvt_pk_bf16_f32 v120, v120, v121
    v_cvt_pk_bf16_f32 v121, v122, v123
    v_cvt_pk_bf16_f32 v122, v124, v125
    v_cvt_pk_bf16_f32 v123, v126, v127
    s_nop 1
    v_mfma_f32_32x32x16_bf16 v[240:255], v[16:19], v[120:123], v[240:255]
    s_cmp_lg_u32 s77, 0
    s_nop 10
    s_cbranch_scc1 M_nv21
    ds_read_b32 v112, v5 offset:524
    ds_read_b32 v113, v5 offset:652
    ds_read_b32 v114, v5 offset:780
    ds_read_b32 v115, v5 offset:908
    s_waitcnt lgkmcnt(3)
    v_and_or_b32 v112, v1, s63, v112
    s_waitcnt lgkmcnt(2)
    v_and_or_b32 v113, v1, s63, v113
    s_waitcnt lgkmcnt(1)
    v_and_or_b32 v114, v1, s63, v114
    s_waitcnt lgkmcnt(0)
    v_and_or_b32 v115, v1, s63, v115
    s_add_u32 m0, s51, 0
    s_nop 0
    buffer_load_dwordx4 v112, s[28:31], s64 offen lds
    s_add_u32 m0, s51, 1024
    s_nop 0
    buffer_load_dwordx4 v112, s[28:31], s65 offen lds
    s_add_u32 m0, s51, 2048
    s_nop 0
    buffer_load_dwordx4 v112, s[28:31], s66 offen lds
    s_add_u32 m0, s51, 3072
    s_nop 0
    buffer_load_dwordx4 v113, s[28:31], s64 offen lds
    s_add_u32 m0, s51, 4096
    s_nop 0
    buffer_load_dwordx4 v113, s[28:31], s65 offen lds
    s_add_u32 m0, s51, 5120
    s_nop 0
    buffer_load_dwordx4 v113, s[28:31], s66 offen lds
    s_add_u32 m0, s51, 6144
    s_nop 0
    buffer_load_dwordx4 v114, s[28:31], s64 offen lds
    s_add_u32 m0, s51, 7168
    s_nop 0
    buffer_load_dwordx4 v114, s[28:31], s65 offen lds
    s_add_u32 m0, s51, 8192
    s_nop 0
    buffer_load_dwordx4 v114, s[28:31], s66 offen lds
    s_add_u32 m0, s51, 9216
    s_nop 0
    buffer_load_dwordx4 v115, s[28:31], s64 offen lds
    s_add_u32 m0, s51, 10240
    s_nop 0
    buffer_load_dwordx4 v115, s[28:31], s65 offen lds
    s_add_u32 m0, s51, 11264
    s_nop 0
    buffer_load_dwordx4 v115, s[28:31], s66 offen lds
    s_branch M_nj21
M_nv21:
    s_cmp_eq_u32 s76, 0
    s_cbranch_scc1 M_nj21
    v_lshrrev_b32 v112, 7, v1
    v_and_b32 v113, 1, v112
    v_lshrrev_b32 v112, 1, v112
    v_lshl_add_u32 v112, v113, 2, v112
    v_lshlrev_b32 v112, 9, v112
    v_and_or_b32 v112, v1, s63, v112
    s_add_u32 m0, s51, 1024
    s_add_u32 s53, s40, 256
    buffer_load_dwordx4 v112, s[4:7], s53 offen  lds
    s_add_u32 m0, s51, 2048
    s_add_u32 s53, s40, 384
    buffer_load_dwordx4 v112, s[4:7], s53 offen  lds
    s_add_u32 m0, s51, 4096
    s_add_u32 s53, s41, 256
    buffer_load_dwordx4 v112, s[4:7], s53 offen  lds
    s_add_u32 m0, s51, 5120
    s_add_u32 s53, s41, 384
    buffer_load_dwordx4 v112, s[4:7], s53 offen  lds
    s_add_u32 m0, s51, 7168
    s_add_u32 s53, s42, 256
    buffer_load_dwordx4 v112, s[4:7], s53 offen  lds
    s_add_u32 m0, s51, 8192
    s_add_u32 s53, s42, 384
    buffer_load_dwordx4 v112, s[4:7], s53 offen  lds
    s_add_u32 m0, s51, 10240
    s_add_u32 s53, s43, 256
    buffer_load_dwordx4 v112, s[4:7], s53 offen  lds
    s_add_u32 m0, s51, 11264
    s_add_u32 s53, s43, 384
    buffer_load_dwordx4 v112, s[4:7], s53 offen  lds
M_nj21:
    v_mfma_f32_32x32x16_bf16 v[112:127], v[8:11], v[24:27], 0
    ds_read_b128 v[24:27], v1 offset:22528
    v_mfma_f32_32x32x16_bf16 v[96:111], v[48:51], v[28:31], 0
    ds_read_b128 v[28:31], v1 offset:23552
    v_mul_f32 v64, v64, v80
    v_mul_f32 v65, v65, v81
    v_mul_f32 v66, v66, v82
    v_mul_f32 v67, v67, v83
    v_mul_f32 v68, v68, v84
    v_mul_f32 v69, v69, v85
    v_mul_f32 v70, v70, v86
    v_mul_f32 v71, v71, v87
    v_mul_f32 v72, v72, v88
    v_mul_f32 v73, v73, v89
    v_mul_f32 v74, v74, v90
    v_mul_f32 v75, v75, v91
    s_waitcnt lgkmcnt(2)
    v_mfma_f32_32x32x16_bf16 v[96:111], v[52:55], v[20:23], v[96:111]
    v_mul_f32 v76, v76, v92
    v_mul_f32 v77, v77, v93
    v_mul_f32 v78, v78, v94
    v_mul_f32 v79, v79, v95
    ds_read_b64 v[80:81], v0 offset:2080
    ds_read_b64 v[88:89], v0 offset:2088
    ds_read_b64 v[82:83], v0 offset:2192
    ds_read_b64 v[90:91], v0 offset:2200
    ds_read_b64 v[84:85], v0 offset:2304
    ds_read_b64 v[92:93], v0 offset:2312
    ds_read_b64 v[86:87], v0 offset:2416
    ds_read_b64 v[94:95], v0 offset:2424
    v_cvt_pk_bf16_f32 v64, v64, v65
    v_cvt_pk_bf16_f32 v65, v66, v67
    v_cvt_pk_bf16_f32 v66, v68, v69
    v_cvt_pk_bf16_f32 v67, v70, v71
    v_cvt_pk_bf16_f32 v68, v72, v73
    v_cvt_pk_bf16_f32 v69, v74, v75
    v_cvt_pk_bf16_f32 v70, v76, v77
    s_waitcnt lgkmcnt(9)
    v_mfma_f32_32x32x16_bf16 v[96:111], v[56:59], v[24:27], v[96:111]
    v_cvt_pk_bf16_f32 v71, v78, v79
    v_pk_lshrrev_b16 v72, 14, v12 op_sel_hi:[0,1]
    v_pk_lshrrev_b16 v73, 14, v13 op_sel_hi:[0,1]
    v_pk_lshrrev_b16 v74, 14, v14 op_sel_hi:[0,1]
    v_pk_lshrrev_b16 v75, 14, v15 op_sel_hi:[0,1]
    v_pk_lshrrev_b16 v76, 14, v16 op_sel_hi:[0,1]
    v_pk_lshrrev_b16 v77, 14, v17 op_sel_hi:[0,1]
    v_pk_lshrrev_b16 v78, 14, v18 op_sel_hi:[0,1]
    v_pk_lshrrev_b16 v79, 14, v19 op_sel_hi:[0,1]
    s_waitcnt lgkmcnt(0)
    v_pk_mul_lo_u16 v80, v72, v80
    v_pk_mul_lo_u16 v81, v73, v81
    v_pk_mul_lo_u16 v82, v74, v82
    v_mfma_f32_32x32x16_bf16 v[96:111], v[60:63], v[28:31], v[96:111]
    v_pk_mul_lo_u16 v83, v75, v83
    v_pk_mul_lo_u16 v84, v76, v84
    v_pk_mul_lo_u16 v85, v77, v85
    v_pk_mul_lo_u16 v86, v78, v86
    v_pk_mul_lo_u16 v87, v79, v87
    v_pk_mul_lo_u16 v88, v72, v88
    v_pk_mul_lo_u16 v89, v73, v89
    v_pk_mul_lo_u16 v90, v74, v90
    v_pk_mul_lo_u16 v91, v75, v91
    v_pk_mul_lo_u16 v92, v76, v92
    v_pk_mul_lo_u16 v93, v77, v93
    v_pk_mul_lo_u16 v94, v78, v94
    v_pk_mul_lo_u16 v95, v79, v95
    v_mfma_f32_32x32x16_bf16 v[160:175], v[80:83], v[64:67], v[160:175]
    v_mul_f32 v96, v96, v112
    v_mul_f32 v97, v97, v113
    v_mul_f32 v98, v98, v114
    v_mul_f32 v99, v99, v115
    v_mul_f32 v100, v100, v116
    v_mul_f32 v101, v101, v117
    v_mfma_f32_32x32x16_bf16 v[160:175], v[84:87], v[68:71], v[160:175]
    v_mul_f32 v102, v102, v118
    v_mul_f32 v103, v103, v119
    v_mul_f32 v104, v104, v120
    v_mul_f32 v105, v105, v121
    v_mul_f32 v106, v106, v122
    v_mul_f32 v107, v107, v123
    v_mfma_f32_32x32x16_bf16 v[192:207], v[88:91], v[64:67], v[192:207]
    v_mul_f32 v108, v108, v124
    v_mul_f32 v109, v109, v125
    v_mul_f32 v110, v110, v126
    v_mul_f32 v111, v111, v127
    ds_read_b64 v[112:113], v0 offset:2096
    ds_read_b64 v[114:115], v0 offset:2208
    ds_read_b64 v[116:117], v0 offset:2320
    ds_read_b64 v[118:119], v0 offset:2432
    v_cvt_pk_bf16_f32 v96, v96, v97
    v_mfma_f32_32x32x16_bf16 v[192:207], v[92:95], v[68:71], v[192:207]
    v_cvt_pk_bf16_f32 v97, v98, v99
    v_cvt_pk_bf16_f32 v98, v100, v101
    v_cvt_pk_bf16_f32 v99, v102, v103
    v_cvt_pk_bf16_f32 v100, v104, v105
    v_cvt_pk_bf16_f32 v101, v106, v107
    v_cvt_pk_bf16_f32 v102, v108, v109
    v_cvt_pk_bf16_f32 v103, v110, v111
    s_waitcnt lgkmcnt(0)
    v_pk_mul_lo_u16 v112, v72, v112
    v_pk_mul_lo_u16 v113, v73, v113
    v_pk_mul_lo_u16 v114, v74, v114
    v_pk_mul_lo_u16 v115, v75, v115
    v_pk_mul_lo_u16 v116, v76, v116
    v_pk_mul_lo_u16 v117, v77, v117
    v_pk_mul_lo_u16 v118, v78, v118
    v_pk_mul_lo_u16 v119, v79, v119
    v_mfma_f32_32x32x16_bf16 v[176:191], v[80:83], v[96:99], v[176:191]
    ds_read_b128 v[104:107], v3 offset:512
    ds_read_b128 v[72:75], v7
    ds_read_b128 v[76:79], v7 offset:16
    ds_read_b64 v[12:13], v4 offset:2496
    ds_read_b64 v[14:15], v4 offset:2608
    ds_read_b64 v[16:17], v4 offset:2720
    ds_read_b64 v[18:19], v4 offset:2832
    ds_read_b128 v[20:23], v1 offset:24576
    ds_read_b128 v[24:27], v1 offset:0
    ds_read_b128 v[28:31], v1 offset:1024
    s_waitcnt lgkmcnt(7)
    v_mul_f32 v72, v104, v72
    v_mul_f32 v73, v104, v73
    v_mul_f32 v74, v104, v74
    v_mul_f32 v75, v104, v75
    v_mul_f32 v76, v104, v76
    v_mfma_f32_32x32x16_bf16 v[176:191], v[84:87], v[100:103], v[176:191]
    v_mul_f32 v77, v104, v77
    v_mul_f32 v78, v104, v78
    v_mul_f32 v79, v104, v79
    v_cvt_pk_bf16_f32 v72, 0, v72
    v_cvt_pk_bf16_f32 v73, 0, v73
    v_cvt_pk_bf16_f32 v74, 0, v74
    v_cvt_pk_bf16_f32 v75, 0, v75
    v_mfma_f32_32x32x16_bf16 v[208:223], v[88:91], v[96:99], v[208:223]
    v_cvt_pk_bf16_f32 v76, 0, v76
    v_cvt_pk_bf16_f32 v77, 0, v77
    v_cvt_pk_bf16_f32 v78, 0, v78
    v_cvt_pk_bf16_f32 v79, 0, v79
    v_mul_f32 v72, s61, v72
    v_mul_f32 v73, s61, v73
    v_mfma_f32_32x32x16_bf16 v[208:223], v[92:95], v[100:103], v[208:223]
    v_mul_f32 v74, s61, v74
    v_mul_f32 v75, s61, v75
    v_mul_f32 v76, s61, v76
    v_mul_f32 v77, s61, v77
    v_mul_f32 v78, s61, v78
    v_mul_f32 v79, s61, v79
    v_sin_f32 v72, v72
    v_mfma_f32_32x32x16_bf16 v[224:239], v[112:115], v[64:67], v[224:239]
    v_sin_f32 v73, v73
    v_sin_f32 v74, v74
    v_sin_f32 v75, v75
    v_sin_f32 v76, v76
    v_sin_f32 v77, v77
    v_sin_f32 v78, v78
    v_sin_f32 v79, v79
    v_mfma_f32_32x32x16_bf16 v[240:255], v[112:115], v[96:99], v[240:255]
    v_mul_f32 v72, v72, v105
    v_mul_f32 v73, v73, v105
    v_mul_f32 v74, v74, v105
    v_mul_f32 v75, v75, v105
    v_mul_f32 v76, v76, v105
    v_mul_f32 v77, v77, v105
    v_mfma_f32_32x32x16_bf16 v[224:239], v[116:119], v[68:71], v[224:239]
    v_mul_f32 v78, v78, v105
    v_mul_f32 v79, v79, v105
    v_cvt_pk_bf16_f32 v8, v72, v73
    v_cvt_pk_bf16_f32 v9, v74, v75
    v_cvt_pk_bf16_f32 v10, v76, v77
    v_cvt_pk_bf16_f32 v11, v78, v79
    s_waitcnt lgkmcnt(3)
    v_pk_lshlrev_b16 v12, v6, v12
    v_mfma_f32_32x32x16_bf16 v[240:255], v[116:119], v[100:103], v[240:255]
WUP_3969:
    s_cbranch_execz WUR_1
    v_pk_lshlrev_b16 v13, v6, v13
    v_pk_lshlrev_b16 v14, v6, v14
    v_pk_lshlrev_b16 v15, v6, v15
    v_pk_lshlrev_b16 v16, v6, v16
    v_pk_lshlrev_b16 v17, v6, v17
    v_pk_lshlrev_b16 v18, v6, v18
    v_pk_lshlrev_b16 v19, v6, v19
    v_add_u32 v3, 512, v3
    v_add_u32 v4, 448, v4
    v_add_u32 v0, 448, v0
    v_add_u32 v5, 512, v5
    s_waitcnt lgkmcnt(0)
    s_add_u32 s49, s49, 1
    s_cmp_lt_u32 s49, s48
    s_cbranch_scc1 M_batch
M_wend:
    s_cmp_eq_u32 s76, 0
    s_cbranch_scc1 M_slow
M_epi:
    v_lshrrev_b32 v8, 4, v1
    v_lshrrev_b32 v10, 5, v8
    v_and_b32 v11, 31, v8
    v_lshlrev_b32 v12, 11, v10
    v_lshl_add_u32 v12, v11, 2, v12
    v_cvt_pk_bf16_f32 v64, v128, v144
    v_cvt_pk_bf16_f32 v65, v129, v145
    v_cvt_pk_bf16_f32 v66, v130, v146
    v_cvt_pk_bf16_f32 v67, v131, v147
    v_cvt_pk_bf16_f32 v68, v132, v148
    v_cvt_pk_bf16_f32 v69, v133, v149
    v_cvt_pk_bf16_f32 v70, v134, v150
    v_cvt_pk_bf16_f32 v71, v135, v151
    v_cvt_pk_bf16_f32 v72, v136, v152
    v_cvt_pk_bf16_f32 v73, v137, v153
    v_cvt_pk_bf16_f32 v74, v138, v154
    v_cvt_pk_bf16_f32 v75, v139, v155
    buffer_store_dword v64, v12, s[32:35], s40 offen offset:0 sc1 nt
    buffer_store_dword v65, v12, s[32:35], s40 offen offset:512 sc1 nt
    buffer_store_dword v66, v12, s[32:35], s40 offen offset:1024 sc1 nt
    buffer_store_dword v67, v12, s[32:35], s40 offen offset:1536 sc1 nt
    buffer_store_dword v68, v12, s[32:35], s41 offen offset:0 sc1 nt
    buffer_store_dword v69, v12, s[32:35], s41 offen offset:512 sc1 nt
    buffer_store_dword v70, v12, s[32:35], s41 offen offset:1024 sc1 nt
    buffer_store_dword v71, v12, s[32:35], s41 offen offset:1536 sc1 nt
    buffer_store_dword v72, v12, s[32:35], s42 offen offset:0 sc1 nt
    buffer_store_dword v73, v12, s[32:35], s42 offen offset:512 sc1 nt
    buffer_store_dword v74, v12, s[32:35], s42 offen offset:1024 sc1 nt
    buffer_store_dword v75, v12, s[32:35], s42 offen offset:1536 sc1 nt
    v_cvt_pk_bf16_f32 v80, v160, v176
    v_cvt_pk_bf16_f32 v81, v161, v177
    v_cvt_pk_bf16_f32 v82, v162, v178
    v_cvt_pk_bf16_f32 v83, v163, v179
    v_cvt_pk_bf16_f32 v84, v164, v180
    v_cvt_pk_bf16_f32 v85, v165, v181
    v_cvt_pk_bf16_f32 v86, v166, v182
    v_cvt_pk_bf16_f32 v87, v167, v183
    v_cvt_pk_bf16_f32 v88, v168, v184
    v_cvt_pk_bf16_f32 v89, v169, v185
    v_cvt_pk_bf16_f32 v90, v170, v186
    v_cvt_pk_bf16_f32 v91, v171, v187
    buffer_store_dword v80, v12, s[32:35], s40 offen offset:128 sc1 nt
    buffer_store_dword v81, v12, s[32:35], s40 offen offset:640 sc1 nt
    buffer_store_dword v82, v12, s[32:35], s40 offen offset:1152 sc1 nt
    buffer_store_dword v83, v12, s[32:35], s40 offen offset:1664 sc1 nt
    buffer_store_dword v84, v12, s[32:35], s41 offen offset:128 sc1 nt
    buffer_store_dword v85, v12, s[32:35], s41 offen offset:640 sc1 nt
    buffer_store_dword v86, v12, s[32:35], s41 offen offset:1152 sc1 nt
    buffer_store_dword v87, v12, s[32:35], s41 offen offset:1664 sc1 nt
    buffer_store_dword v88, v12, s[32:35], s42 offen offset:128 sc1 nt
    buffer_store_dword v89, v12, s[32:35], s42 offen offset:640 sc1 nt
    buffer_store_dword v90, v12, s[32:35], s42 offen offset:1152 sc1 nt
    buffer_store_dword v91, v12, s[32:35], s42 offen offset:1664 sc1 nt
    s_waitcnt vmcnt(24)
    ds_read_u16_d16_hi v16, v2 offset:1024
    ds_read_u16_d16_hi v17, v2 offset:1280
    ds_read_u16_d16_hi v18, v2 offset:1536
    ds_read_u16_d16_hi v19, v2 offset:1792
    ds_read_u16_d16_hi v20, v2 offset:4096
    ds_read_u16_d16_hi v21, v2 offset:4352
    ds_read_u16_d16_hi v22, v2 offset:4608
    ds_read_u16_d16_hi v23, v2 offset:4864
    ds_read_u16_d16_hi v24, v2 offset:7168
    ds_read_u16_d16_hi v25, v2 offset:7424
    ds_read_u16_d16_hi v26, v2 offset:7680
    ds_read_u16_d16_hi v27, v2 offset:7936
    ds_read_u16_d16_hi v32, v2 offset:1026
    ds_read_u16_d16_hi v33, v2 offset:1282
    ds_read_u16_d16_hi v34, v2 offset:1538
    ds_read_u16_d16_hi v35, v2 offset:1794
    ds_read_u16_d16_hi v36, v2 offset:4098
    ds_read_u16_d16_hi v37, v2 offset:4354
    ds_read_u16_d16_hi v38, v2 offset:4610
    ds_read_u16_d16_hi v39, v2 offset:4866
    ds_read_u16_d16_hi v40, v2 offset:7170
    ds_read_u16_d16_hi v41, v2 offset:7426
    ds_read_u16_d16_hi v42, v2 offset:7682
    ds_read_u16_d16_hi v43, v2 offset:7938
    s_waitcnt lgkmcnt(15)
    v_add_f32 v192, v192, v16
    v_add_f32 v193, v193, v17
    v_add_f32 v194, v194, v18
    v_add_f32 v195, v195, v19
    v_add_f32 v196, v196, v20
    v_add_f32 v197, v197, v21
    v_add_f32 v198, v198, v22
    v_add_f32 v199, v199, v23
    v_add_f32 v200, v200, v24
    s_waitcnt lgkmcnt(14)
    v_add_f32 v201, v201, v25
    s_waitcnt lgkmcnt(13)
    v_add_f32 v202, v202, v26
    s_waitcnt lgkmcnt(12)
    v_add_f32 v203, v203, v27
    s_waitcnt lgkmcnt(11)
    v_add_f32 v208, v208, v32
    s_waitcnt lgkmcnt(10)
    v_add_f32 v209, v209, v33
    s_waitcnt lgkmcnt(9)
    v_add_f32 v210, v210, v34
    s_waitcnt lgkmcnt(8)
    v_add_f32 v211, v211, v35
    s_waitcnt lgkmcnt(7)
    v_add_f32 v212, v212, v36
    s_waitcnt lgkmcnt(6)
    v_add_f32 v213, v213, v37
    s_waitcnt lgkmcnt(5)
    v_add_f32 v214, v214, v38
    s_waitcnt lgkmcnt(4)
    v_add_f32 v215, v215, v39
    s_waitcnt lgkmcnt(3)
    v_add_f32 v216, v216, v40
    s_waitcnt lgkmcnt(2)
    v_add_f32 v217, v217, v41
    s_waitcnt lgkmcnt(1)
    v_add_f32 v218, v218, v42
    s_waitcnt lgkmcnt(0)
    v_add_f32 v219, v219, v43
    v_cvt_pk_bf16_f32 v96, v192, v208
    v_cvt_pk_bf16_f32 v97, v193, v209
    v_cvt_pk_bf16_f32 v98, v194, v210
    v_cvt_pk_bf16_f32 v99, v195, v211
    v_cvt_pk_bf16_f32 v100, v196, v212
    v_cvt_pk_bf16_f32 v101, v197, v213
    v_cvt_pk_bf16_f32 v102, v198, v214
    v_cvt_pk_bf16_f32 v103, v199, v215
    v_cvt_pk_bf16_f32 v104, v200, v216
    v_cvt_pk_bf16_f32 v105, v201, v217
    v_cvt_pk_bf16_f32 v106, v202, v218
    v_cvt_pk_bf16_f32 v107, v203, v219
    buffer_store_dword v96, v12, s[32:35], s40 offen offset:256 sc1 nt
    buffer_store_dword v97, v12, s[32:35], s40 offen offset:768 sc1 nt
    buffer_store_dword v98, v12, s[32:35], s40 offen offset:1280 sc1 nt
    buffer_store_dword v99, v12, s[32:35], s40 offen offset:1792 sc1 nt
    buffer_store_dword v100, v12, s[32:35], s41 offen offset:256 sc1 nt
    buffer_store_dword v101, v12, s[32:35], s41 offen offset:768 sc1 nt
    buffer_store_dword v102, v12, s[32:35], s41 offen offset:1280 sc1 nt
    buffer_store_dword v103, v12, s[32:35], s41 offen offset:1792 sc1 nt
    buffer_store_dword v104, v12, s[32:35], s42 offen offset:256 sc1 nt
    buffer_store_dword v105, v12, s[32:35], s42 offen offset:768 sc1 nt
    buffer_store_dword v106, v12, s[32:35], s42 offen offset:1280 sc1 nt
    buffer_store_dword v107, v12, s[32:35], s42 offen offset:1792 sc1 nt
    ds_read_u16_d16_hi v16, v2 offset:2048
    ds_read_u16_d16_hi v17, v2 offset:2304
WUP_4130:
    s_cbranch_execz WUR_1
    ds_read_u16_d16_hi v18, v2 offset:2560
    ds_read_u16_d16_hi v19, v2 offset:2816
    ds_read_u16_d16_hi v20, v2 offset:5120
    ds_read_u16_d16_hi v21, v2 offset:5376
    ds_read_u16_d16_hi v22, v2 offset:5632
    ds_read_u16_d16_hi v23, v2 offset:5888
    ds_read_u16_d16_hi v24, v2 offset:8192
    ds_read_u16_d16_hi v25, v2 offset:8448
    ds_read_u16_d16_hi v26, v2 offset:8704
    ds_read_u16_d16_hi v27, v2 offset:8960
    ds_read_u16_d16_hi v32, v2 offset:2050
    ds_read_u16_d16_hi v33, v2 offset:2306
    ds_read_u16_d16_hi v34, v2 offset:2562
    ds_read_u16_d16_hi v35, v2 offset:2818
    ds_read_u16_d16_hi v36, v2 offset:5122
    ds_read_u16_d16_hi v37, v2 offset:5378
    ds_read_u16_d16_hi v38, v2 offset:5634
    ds_read_u16_d16_hi v39, v2 offset:5890
    ds_read_u16_d16_hi v40, v2 offset:8194
    ds_read_u16_d16_hi v41, v2 offset:8450
    ds_read_u16_d16_hi v42, v2 offset:8706
    ds_read_u16_d16_hi v43, v2 offset:8962
    s_waitcnt lgkmcnt(15)
    v_add_f32 v224, v224, v16
    v_add_f32 v225, v225, v17
    v_add_f32 v226, v226, v18
    v_add_f32 v227, v227, v19
    v_add_f32 v228, v228, v20
    v_add_f32 v229, v229, v21
    v_add_f32 v230, v230, v22
    v_add_f32 v231, v231, v23
    v_add_f32 v232, v232, v24
    s_waitcnt lgkmcnt(14)
    v_add_f32 v233, v233, v25
    s_waitcnt lgkmcnt(13)
    v_add_f32 v234, v234, v26
    s_waitcnt lgkmcnt(12)
    v_add_f32 v235, v235, v27
    s_waitcnt lgkmcnt(11)
    v_add_f32 v240, v240, v32
    s_waitcnt lgkmcnt(10)
    v_add_f32 v241, v241, v33
    s_waitcnt lgkmcnt(9)
    v_add_f32 v242, v242, v34
    s_waitcnt lgkmcnt(8)
    v_add_f32 v243, v243, v35
    s_waitcnt lgkmcnt(7)
    v_add_f32 v244, v244, v36
    s_waitcnt lgkmcnt(6)
    v_add_f32 v245, v245, v37
    s_waitcnt lgkmcnt(5)
    v_add_f32 v246, v246, v38
    s_waitcnt lgkmcnt(4)
    v_add_f32 v247, v247, v39
    s_waitcnt lgkmcnt(3)
    v_add_f32 v248, v248, v40
    s_waitcnt lgkmcnt(2)
    v_add_f32 v249, v249, v41
    s_waitcnt lgkmcnt(1)
    v_add_f32 v250, v250, v42
    s_waitcnt lgkmcnt(0)
    v_add_f32 v251, v251, v43
    v_cvt_pk_bf16_f32 v112, v224, v240
    v_cvt_pk_bf16_f32 v113, v225, v241
    v_cvt_pk_bf16_f32 v114, v226, v242
    v_cvt_pk_bf16_f32 v115, v227, v243
    v_cvt_pk_bf16_f32 v116, v228, v244
    v_cvt_pk_bf16_f32 v117, v229, v245
    v_cvt_pk_bf16_f32 v118, v230, v246
    v_cvt_pk_bf16_f32 v119, v231, v247
    v_cvt_pk_bf16_f32 v120, v232, v248
    v_cvt_pk_bf16_f32 v121, v233, v249
    v_cvt_pk_bf16_f32 v122, v234, v250
    v_cvt_pk_bf16_f32 v123, v235, v251
    buffer_store_dword v112, v12, s[32:35], s40 offen offset:384 sc1 nt
    buffer_store_dword v113, v12, s[32:35], s40 offen offset:896 sc1 nt
    buffer_store_dword v114, v12, s[32:35], s40 offen offset:1408 sc1 nt
    buffer_store_dword v115, v12, s[32:35], s40 offen offset:1920 sc1 nt
    buffer_store_dword v116, v12, s[32:35], s41 offen offset:384 sc1 nt
    buffer_store_dword v117, v12, s[32:35], s41 offen offset:896 sc1 nt
    buffer_store_dword v118, v12, s[32:35], s41 offen offset:1408 sc1 nt
    buffer_store_dword v119, v12, s[32:35], s41 offen offset:1920 sc1 nt
    buffer_store_dword v120, v12, s[32:35], s42 offen offset:384 sc1 nt
    buffer_store_dword v121, v12, s[32:35], s42 offen offset:896 sc1 nt
    buffer_store_dword v122, v12, s[32:35], s42 offen offset:1408 sc1 nt
    buffer_store_dword v123, v12, s[32:35], s42 offen offset:1920 sc1 nt
    s_cmp_le_u32 s45, 24
    s_cbranch_scc1 M_fin
    v_cvt_pk_bf16_f32 v76, v140, v156
    v_cvt_pk_bf16_f32 v77, v141, v157
    v_cvt_pk_bf16_f32 v78, v142, v158
    v_cvt_pk_bf16_f32 v79, v143, v159
    buffer_store_dword v76, v12, s[32:35], s43 offen offset:0 sc1 nt
    buffer_store_dword v77, v12, s[32:35], s43 offen offset:512 sc1 nt
    buffer_store_dword v78, v12, s[32:35], s43 offen offset:1024 sc1 nt
    buffer_store_dword v79, v12, s[32:35], s43 offen offset:1536 sc1 nt
    v_cvt_pk_bf16_f32 v92, v172, v188
    v_cvt_pk_bf16_f32 v93, v173, v189
    v_cvt_pk_bf16_f32 v94, v174, v190
    v_cvt_pk_bf16_f32 v95, v175, v191
    buffer_store_dword v92, v12, s[32:35], s43 offen offset:128 sc1 nt
    buffer_store_dword v93, v12, s[32:35], s43 offen offset:640 sc1 nt
    buffer_store_dword v94, v12, s[32:35], s43 offen offset:1152 sc1 nt
    buffer_store_dword v95, v12, s[32:35], s43 offen offset:1664 sc1 nt
    ds_read_u16_d16_hi v28, v2 offset:10240
    ds_read_u16_d16_hi v29, v2 offset:10496
    ds_read_u16_d16_hi v30, v2 offset:10752
    ds_read_u16_d16_hi v31, v2 offset:11008
    ds_read_u16_d16_hi v44, v2 offset:10242
    ds_read_u16_d16_hi v45, v2 offset:10498
    ds_read_u16_d16_hi v46, v2 offset:10754
    ds_read_u16_d16_hi v47, v2 offset:11010
    s_waitcnt lgkmcnt(7)
    v_add_f32 v204, v204, v28
    s_waitcnt lgkmcnt(6)
    v_add_f32 v205, v205, v29
    s_waitcnt lgkmcnt(5)
    v_add_f32 v206, v206, v30
    s_waitcnt lgkmcnt(4)
    v_add_f32 v207, v207, v31
    s_waitcnt lgkmcnt(3)
    v_add_f32 v220, v220, v44
    s_waitcnt lgkmcnt(2)
    v_add_f32 v221, v221, v45
    s_waitcnt lgkmcnt(1)
    v_add_f32 v222, v222, v46
    s_waitcnt lgkmcnt(0)
    v_add_f32 v223, v223, v47
    v_cvt_pk_bf16_f32 v108, v204, v220
    v_cvt_pk_bf16_f32 v109, v205, v221
    v_cvt_pk_bf16_f32 v110, v206, v222
    v_cvt_pk_bf16_f32 v111, v207, v223
    buffer_store_dword v108, v12, s[32:35], s43 offen offset:256 sc1 nt
    buffer_store_dword v109, v12, s[32:35], s43 offen offset:768 sc1 nt
    buffer_store_dword v110, v12, s[32:35], s43 offen offset:1280 sc1 nt
    buffer_store_dword v111, v12, s[32:35], s43 offen offset:1792 sc1 nt
    ds_read_u16_d16_hi v28, v2 offset:11264
    ds_read_u16_d16_hi v29, v2 offset:11520
    ds_read_u16_d16_hi v30, v2 offset:11776
    ds_read_u16_d16_hi v31, v2 offset:12032
    ds_read_u16_d16_hi v44, v2 offset:11266
    ds_read_u16_d16_hi v45, v2 offset:11522
    ds_read_u16_d16_hi v46, v2 offset:11778
    ds_read_u16_d16_hi v47, v2 offset:12034
    s_waitcnt lgkmcnt(7)
    v_add_f32 v236, v236, v28
    s_waitcnt lgkmcnt(6)
    v_add_f32 v237, v237, v29
    s_waitcnt lgkmcnt(5)
    v_add_f32 v238, v238, v30
    s_waitcnt lgkmcnt(4)
    v_add_f32 v239, v239, v31
    s_waitcnt lgkmcnt(3)
    v_add_f32 v252, v252, v44
    s_waitcnt lgkmcnt(2)
    v_add_f32 v253, v253, v45
    s_waitcnt lgkmcnt(1)
    v_add_f32 v254, v254, v46
    s_waitcnt lgkmcnt(0)
    v_add_f32 v255, v255, v47
    v_cvt_pk_bf16_f32 v124, v236, v252
    v_cvt_pk_bf16_f32 v125, v237, v253
    v_cvt_pk_bf16_f32 v126, v238, v254
    v_cvt_pk_bf16_f32 v127, v239, v255
    buffer_store_dword v124, v12, s[32:35], s43 offen offset:384 sc1 nt
    buffer_store_dword v125, v12, s[32:35], s43 offen offset:896 sc1 nt
    buffer_store_dword v126, v12, s[32:35], s43 offen offset:1408 sc1 nt
    buffer_store_dword v127, v12, s[32:35], s43 offen offset:1920 sc1 nt
M_fin:
K_end:
    s_endpgm
P_rare:
    v_mov_b32 v37, 131080
    v_mov_b32 v38, 131076
    s_mul_i32 s27, s2, 32768
    s_add_u32 s27, s27, 0x1100000
    s_lshl_b32 s59, s2, 15
    s_add_u32 s59, s59, 0x8fff84
    s_mov_b64 exec, s[56:57]
    v_cmp_gt_u32 vcc, 31, v76
    s_and_b64 exec, vcc, s[56:57]
    s_nop 3
    s_cbranch_execz P_r10
    ds_write_b32 v12, v92
P_r10:
    s_andn2_b64 exec, s[56:57], vcc
    s_cbranch_execz P_r30
    s_mov_b64 s[14:15], exec
    v_lshlrev_b32 v36, 1, v76
    v_add_u32 v36, 0xfeffffc4, v36
    ds_max_u32 v84, v36 offset:124
    v_cmp_gt_u32 vcc, 63, v76
    s_and_b64 exec, vcc, s[14:15]
    s_nop 3
    s_cbranch_execz P_r20
    v_lshlrev_b32 v124, 7, v68
    v_lshl_add_u32 v124, v76, 2, v124
    buffer_store_dword v92, v124, s[36:39], s59 offen sc1
    s_nop 0
P_r20:
    s_andn2_b64 exec, s[14:15], vcc
    s_cbranch_execz P_r30
    ds_write_b32 v38, v116
    ds_add_rtn_u32 v124, v37, v116
    v_mov_b32 v126, v92
    v_mov_b32 v127, v68
    s_waitcnt lgkmcnt(0)
    v_lshlrev_b32 v124, 3, v124
    buffer_store_dwordx2 v[126:127], v124, s[36:39], s27 offen sc1
    s_nop 0
P_r30:
    s_mov_b64 exec, s[56:57]
    v_cmp_gt_u32 vcc, 31, v77
    s_and_b64 exec, vcc, s[56:57]
    s_nop 3
    s_cbranch_execz P_r11
    ds_write_b32 v13, v93
P_r11:
    s_andn2_b64 exec, s[56:57], vcc
    s_cbranch_execz P_r31
    s_mov_b64 s[14:15], exec
    v_lshlrev_b32 v36, 1, v77
    v_add_u32 v36, 0xfeffffc4, v36
    ds_max_u32 v85, v36 offset:124
    v_cmp_gt_u32 vcc, 63, v77
    s_and_b64 exec, vcc, s[14:15]
    s_nop 3
    s_cbranch_execz P_r21
    v_lshlrev_b32 v124, 7, v69
    v_lshl_add_u32 v124, v77, 2, v124
    buffer_store_dword v93, v124, s[36:39], s59 offen sc1
    s_nop 0
P_r21:
    s_andn2_b64 exec, s[14:15], vcc
    s_cbranch_execz P_r31
    ds_write_b32 v38, v116
    ds_add_rtn_u32 v124, v37, v116
    v_mov_b32 v126, v93
    v_mov_b32 v127, v69
    s_waitcnt lgkmcnt(0)
    v_lshlrev_b32 v124, 3, v124
    buffer_store_dwordx2 v[126:127], v124, s[36:39], s27 offen sc1
    s_nop 0
P_r31:
    s_mov_b64 exec, s[56:57]
    v_cmp_gt_u32 vcc, 31, v78
    s_and_b64 exec, vcc, s[56:57]
    s_nop 3
    s_cbranch_execz P_r12
    ds_write_b32 v14, v94
P_r12:
    s_andn2_b64 exec, s[56:57], vcc
    s_cbranch_execz P_r32
    s_mov_b64 s[14:15], exec
    v_lshlrev_b32 v36, 1, v78
    v_add_u32 v36, 0xfeffffc4, v36
    ds_max_u32 v86, v36 offset:124
    v_cmp_gt_u32 vcc, 63, v78
    s_and_b64 exec, vcc, s[14:15]
    s_nop 3
    s_cbranch_execz P_r22
    v_lshlrev_b32 v124, 7, v70
    v_lshl_add_u32 v124, v78, 2, v124
    buffer_store_dword v94, v124, s[36:39], s59 offen sc1
    s_nop 0
P_r22:
    s_andn2_b64 exec, s[14:15], vcc
    s_cbranch_execz P_r32
    ds_write_b32 v38, v116
    ds_add_rtn_u32 v124, v37, v116
    v_mov_b32 v126, v94
    v_mov_b32 v127, v70
    s_waitcnt lgkmcnt(0)
    v_lshlrev_b32 v124, 3, v124
    buffer_store_dwordx2 v[126:127], v124, s[36:39], s27 offen sc1
    s_nop 0
P_r32:
    s_mov_b64 exec, s[56:57]
    v_cmp_gt_u32 vcc, 31, v79
    s_and_b64 exec, vcc, s[56:57]
    s_nop 3
    s_cbranch_execz P_r13
    ds_write_b32 v15, v95
P_r13:
    s_andn2_b64 exec, s[56:57], vcc
    s_cbranch_execz P_r33
    s_mov_b64 s[14:15], exec
    v_lshlrev_b32 v36, 1, v79
    v_add_u32 v36, 0xfeffffc4, v36
    ds_max_u32 v87, v36 offset:124
    v_cmp_gt_u32 vcc, 63, v79
    s_and_b64 exec, vcc, s[14:15]
    s_nop 3
    s_cbranch_execz P_r23
    v_lshlrev_b32 v124, 7, v71
    v_lshl_add_u32 v124, v79, 2, v124
    buffer_store_dword v95, v124, s[36:39], s59 offen sc1
    s_nop 0
P_r23:
    s_andn2_b64 exec, s[14:15], vcc
    s_cbranch_execz P_r33
    ds_write_b32 v38, v116
    ds_add_rtn_u32 v124, v37, v116
    v_mov_b32 v126, v95
    v_mov_b32 v127, v71
    s_waitcnt lgkmcnt(0)
    v_lshlrev_b32 v124, 3, v124
    buffer_store_dwordx2 v[126:127], v124, s[36:39], s27 offen sc1
    s_nop 0
P_r33:
    s_mov_b64 exec, s[56:57]
    v_cmp_gt_u32 vcc, 31, v80
    s_and_b64 exec, vcc, s[56:57]
    s_nop 3
    s_cbranch_execz P_r14
    ds_write_b32 v16, v96
P_r14:
    s_andn2_b64 exec, s[56:57], vcc
    s_cbranch_execz P_r34
    s_mov_b64 s[14:15], exec
    v_lshlrev_b32 v36, 1, v80
    v_add_u32 v36, 0xfeffffc4, v36
    ds_max_u32 v88, v36 offset:124
    v_cmp_gt_u32 vcc, 63, v80
    s_and_b64 exec, vcc, s[14:15]
    s_nop 3
    s_cbranch_execz P_r24
    v_lshlrev_b32 v124, 7, v72
    v_lshl_add_u32 v124, v80, 2, v124
    buffer_store_dword v96, v124, s[36:39], s59 offen sc1
    s_nop 0
P_r24:
    s_andn2_b64 exec, s[14:15], vcc
    s_cbranch_execz P_r34
    ds_write_b32 v38, v116
    ds_add_rtn_u32 v124, v37, v116
    v_mov_b32 v126, v96
    v_mov_b32 v127, v72
    s_waitcnt lgkmcnt(0)
    v_lshlrev_b32 v124, 3, v124
    buffer_store_dwordx2 v[126:127], v124, s[36:39], s27 offen sc1
    s_nop 0
P_r34:
    s_mov_b64 exec, s[56:57]
    v_cmp_gt_u32 vcc, 31, v81
    s_and_b64 exec, vcc, s[56:57]
    s_nop 3
    s_cbranch_execz P_r15
    ds_write_b32 v17, v97
P_r15:
    s_andn2_b64 exec, s[56:57], vcc
    s_cbranch_execz P_r35
    s_mov_b64 s[14:15], exec
    v_lshlrev_b32 v36, 1, v81
    v_add_u32 v36, 0xfeffffc4, v36
    ds_max_u32 v89, v36 offset:124
    v_cmp_gt_u32 vcc, 63, v81
    s_and_b64 exec, vcc, s[14:15]
    s_nop 3
    s_cbranch_execz P_r25
    v_lshlrev_b32 v124, 7, v73
    v_lshl_add_u32 v124, v81, 2, v124
    buffer_store_dword v97, v124, s[36:39], s59 offen sc1
    s_nop 0
P_r25:
    s_andn2_b64 exec, s[14:15], vcc
    s_cbranch_execz P_r35
    ds_write_b32 v38, v116
    ds_add_rtn_u32 v124, v37, v116
    v_mov_b32 v126, v97
    v_mov_b32 v127, v73
    s_waitcnt lgkmcnt(0)
    v_lshlrev_b32 v124, 3, v124
    buffer_store_dwordx2 v[126:127], v124, s[36:39], s27 offen sc1
    s_nop 0
P_r35:
    s_mov_b64 exec, s[56:57]
    v_cmp_gt_u32 vcc, 31, v82
    s_and_b64 exec, vcc, s[56:57]
    s_nop 3
    s_cbranch_execz P_r16
    ds_write_b32 v18, v98
P_r16:
    s_andn2_b64 exec, s[56:57], vcc
    s_cbranch_execz P_r36
    s_mov_b64 s[14:15], exec
    v_lshlrev_b32 v36, 1, v82
    v_add_u32 v36, 0xfeffffc4, v36
    ds_max_u32 v90, v36 offset:124
    v_cmp_gt_u32 vcc, 63, v82
    s_and_b64 exec, vcc, s[14:15]
    s_nop 3
    s_cbranch_execz P_r26
    v_lshlrev_b32 v124, 7, v74
    v_lshl_add_u32 v124, v82, 2, v124
    buffer_store_dword v98, v124, s[36:39], s59 offen sc1
    s_nop 0
P_r26:
    s_andn2_b64 exec, s[14:15], vcc
    s_cbranch_execz P_r36
    ds_write_b32 v38, v116
    ds_add_rtn_u32 v124, v37, v116
    v_mov_b32 v126, v98
    v_mov_b32 v127, v74
    s_waitcnt lgkmcnt(0)
    v_lshlrev_b32 v124, 3, v124
    buffer_store_dwordx2 v[126:127], v124, s[36:39], s27 offen sc1
    s_nop 0
P_r36:
    s_mov_b64 exec, s[56:57]
    v_cmp_gt_u32 vcc, 31, v83
    s_and_b64 exec, vcc, s[56:57]
    s_nop 3
    s_cbranch_execz P_r17
    ds_write_b32 v19, v99
P_r17:
    s_andn2_b64 exec, s[56:57], vcc
    s_cbranch_execz P_r37
    s_mov_b64 s[14:15], exec
    v_lshlrev_b32 v36, 1, v83
    v_add_u32 v36, 0xfeffffc4, v36
    ds_max_u32 v91, v36 offset:124
    v_cmp_gt_u32 vcc, 63, v83
    s_and_b64 exec, vcc, s[14:15]
    s_nop 3
    s_cbranch_execz P_r27
    v_lshlrev_b32 v124, 7, v75
    v_lshl_add_u32 v124, v83, 2, v124
    buffer_store_dword v99, v124, s[36:39], s59 offen sc1
    s_nop 0
P_r27:
    s_andn2_b64 exec, s[14:15], vcc
    s_cbranch_execz P_r37
    ds_write_b32 v38, v116
    ds_add_rtn_u32 v124, v37, v116
    v_mov_b32 v126, v99
    v_mov_b32 v127, v75
    s_waitcnt lgkmcnt(0)
    v_lshlrev_b32 v124, 3, v124
    buffer_store_dwordx2 v[126:127], v124, s[36:39], s27 offen sc1
    s_nop 0
P_r37:
    s_mov_b64 exec, -1
    s_waitcnt vmcnt(0)
    s_branch P_join
M_e4x:
WUP_4548:
    s_cbranch_execz WUR_0
    s_mov_b32 s56, 0x05040100
    s_mov_b32 s57, 0x07060302
    s_waitcnt vmcnt(4)
    v_lshlrev_b32 v150, 4, v1
    v_cmp_gt_u32 vcc, 49, v1
    s_mov_b64 s[60:61], vcc
    s_mov_b32 s63, 0x830100
    s_mov_b32 s65, 0
    s_nop 1
    s_branch M_pb
M_pa:
    buffer_load_dwordx4 v[236:239], v150, s[36:39], s63 offen sc1
    s_waitcnt vmcnt(0)
M_pb:
    v_xor_b32 v236, s18, v236
    v_xor_b32 v237, s18, v237
    v_xor_b32 v238, s18, v238
    v_xor_b32 v239, s18, v239
    v_or3_b32 v236, v236, v237, v238
    v_or_b32 v236, v236, v239
    v_cmp_ne_u32 vcc, 0, v236
    s_and_b64 vcc, vcc, s[60:61]
    s_cbranch_vccz M_pad
    s_sleep 2
    s_add_u32 s65, s65, 1
    s_cmp_lt_u32 s65, 16384
    s_cbranch_scc1 M_pa
M_pad:
    s_sub_u32 s27, s26, 5
    s_lshl_b32 s27, s27, 10
    s_add_u32 s63, s27, 0x810000
    s_add_u32 s27, s27, 30720
    s_mov_b32 m0, s27
    s_nop 0
    buffer_load_dwordx4 v3, s[36:39], s63 offen sc1 lds
    s_add_u32 s27, s27, 3072
    s_add_u32 s63, s63, 3072
    s_mov_b32 m0, s27
    s_nop 0
    buffer_load_dwordx4 v3, s[36:39], s63 offen sc1 lds
    s_add_u32 s27, s27, 3072
    s_add_u32 s63, s63, 3072
    s_mov_b32 m0, s27
    s_nop 0
    buffer_load_dwordx4 v3, s[36:39], s63 offen sc1 lds
    s_add_u32 s27, s27, 3072
    s_add_u32 s63, s63, 3072
    s_mov_b32 m0, s27
    s_nop 0
    buffer_load_dwordx4 v3, s[36:39], s63 offen sc1 lds
    s_add_u32 s27, s27, 3072
    s_add_u32 s63, s63, 3072
    s_mov_b32 m0, s27
    s_nop 0
    buffer_load_dwordx4 v3, s[36:39], s63 offen sc1 lds
    s_add_u32 s27, s27, 3072
    s_add_u32 s63, s63, 3072
    s_mov_b32 m0, s27
    s_nop 0
    buffer_load_dwordx4 v3, s[36:39], s63 offen sc1 lds
    s_add_u32 s27, s27, 3072
    s_add_u32 s63, s63, 3072
    s_mov_b32 m0, s27
    s_nop 0
    buffer_load_dwordx4 v3, s[36:39], s63 offen sc1 lds
    s_add_u32 s27, s27, 3072
    s_add_u32 s63, s63, 3072
    s_mov_b32 m0, s27
    s_nop 0
    buffer_load_dwordx4 v3, s[36:39], s63 offen sc1 lds
    s_add_u32 s27, s27, 3072
    s_add_u32 s63, s63, 3072
    s_mov_b32 m0, s27
    s_nop 0
    buffer_load_dwordx4 v3, s[36:39], s63 offen sc1 lds
    s_add_u32 s27, s27, 3072
    s_add_u32 s63, s63, 3072
    s_mov_b32 m0, s27
    s_nop 0
    buffer_load_dwordx4 v3, s[36:39], s63 offen sc1 lds
    s_add_u32 s27, s27, 3072
    s_add_u32 s63, s63, 3072
    s_mov_b32 m0, s27
    s_nop 0
    buffer_load_dwordx4 v3, s[36:39], s63 offen sc1 lds
    s_add_u32 s27, s27, 3072
    s_add_u32 s63, s63, 3072
    s_mov_b32 m0, s27
    s_nop 0
    buffer_load_dwordx4 v3, s[36:39], s63 offen sc1 lds
    s_add_u32 s27, s27, 3072
    s_add_u32 s63, s63, 3072
    s_mov_b32 m0, s27
    s_nop 0
    buffer_load_dwordx4 v3, s[36:39], s63 offen sc1 lds
    s_add_u32 s27, s27, 3072
    s_add_u32 s63, s63, 3072
    s_mov_b32 m0, s27
    s_nop 0
    buffer_load_dwordx4 v3, s[36:39], s63 offen sc1 lds
    s_add_u32 s27, s27, 3072
    s_add_u32 s63, s63, 3072
    s_mov_b32 m0, s27
    s_nop 0
    buffer_load_dwordx4 v3, s[36:39], s63 offen sc1 lds
    s_add_u32 s27, s27, 3072
    s_add_u32 s63, s63, 3072
    s_mov_b32 m0, s27
    s_nop 0
    buffer_load_dwordx4 v3, s[36:39], s63 offen sc1 lds
    s_add_u32 s27, s27, 3072
    s_add_u32 s63, s63, 3072
    s_mov_b32 m0, s27
    s_nop 0
    buffer_load_dwordx4 v3, s[36:39], s63 offen sc1 lds
WUP_4660:
    s_cbranch_execz WUR_0
    s_add_u32 s27, s27, 3072
    s_add_u32 s63, s63, 3072
    s_mov_b32 m0, s27
    s_nop 0
    buffer_load_dwordx4 v3, s[36:39], s63 offen sc1 lds
    s_add_u32 s27, s27, 3072
    s_add_u32 s63, s63, 3072
    s_mov_b32 m0, s27
    s_nop 0
    buffer_load_dwordx4 v3, s[36:39], s63 offen sc1 lds
    s_add_u32 s27, s27, 3072
    s_add_u32 s63, s63, 3072
    s_mov_b32 m0, s27
    s_nop 0
    buffer_load_dwordx4 v3, s[36:39], s63 offen sc1 lds
    s_add_u32 s27, s27, 3072
    s_add_u32 s63, s63, 3072
    s_mov_b32 m0, s27
    s_nop 0
    buffer_load_dwordx4 v3, s[36:39], s63 offen sc1 lds
    s_add_u32 s27, s27, 3072
    s_add_u32 s63, s63, 3072
    s_mov_b32 m0, s27
    s_nop 0
    buffer_load_dwordx4 v3, s[36:39], s63 offen sc1 lds
    s_add_u32 s27, s27, 3072
    s_add_u32 s63, s63, 3072
    s_mov_b32 m0, s27
    s_nop 0
    buffer_load_dwordx4 v3, s[36:39], s63 offen sc1 lds
    s_add_u32 s27, s27, 3072
    s_add_u32 s63, s63, 3072
    s_mov_b32 m0, s27
    s_nop 0
    buffer_load_dwordx4 v3, s[36:39], s63 offen sc1 lds
    s_add_u32 s27, s27, 3072
    s_add_u32 s63, s63, 3072
    s_mov_b32 m0, s27
    s_nop 0
    buffer_load_dwordx4 v3, s[36:39], s63 offen sc1 lds
    s_add_u32 s27, s27, 3072
    s_add_u32 s63, s63, 3072
    s_mov_b32 m0, s27
    s_nop 0
    buffer_load_dwordx4 v3, s[36:39], s63 offen sc1 lds
    s_add_u32 s27, s27, 3072
    s_add_u32 s63, s63, 3072
    s_mov_b32 m0, s27
    s_nop 0
    buffer_load_dwordx4 v3, s[36:39], s63 offen sc1 lds
    s_add_u32 s27, s27, 3072
    s_add_u32 s63, s63, 3072
    s_mov_b32 m0, s27
    s_nop 0
    buffer_load_dwordx4 v3, s[36:39], s63 offen sc1 lds
    s_add_u32 s27, s27, 3072
    s_add_u32 s63, s63, 3072
    s_mov_b32 m0, s27
    s_nop 0
    buffer_load_dwordx4 v3, s[36:39], s63 offen sc1 lds
    s_add_u32 s27, s27, 3072
    s_add_u32 s63, s63, 3072
    s_mov_b32 m0, s27
    s_nop 0
    buffer_load_dwordx4 v3, s[36:39], s63 offen sc1 lds
    s_add_u32 s27, s27, 3072
    s_add_u32 s63, s63, 3072
    s_mov_b32 m0, s27
    s_nop 0
    buffer_load_dwordx4 v3, s[36:39], s63 offen sc1 lds
    s_add_u32 s27, s27, 3072
    s_add_u32 s63, s63, 3072
    s_mov_b32 m0, s27
    s_nop 0
    buffer_load_dwordx4 v3, s[36:39], s63 offen sc1 lds
    s_add_u32 s27, s27, 3072
    s_add_u32 s63, s63, 3072
    s_cmp_eq_u32 s26, 7
    s_cbranch_scc1 M_tfd
    s_mov_b32 m0, s27
    s_nop 0
    buffer_load_dwordx4 v3, s[36:39], s63 offen sc1 lds
M_tfd:
    s_setprio 0
    s_branch M_e5
M_mdx:
    s_mov_b32 s59, 0
M_md:
    s_cmp_eq_u64 s[68:69], 0
    s_cbranch_scc0 M_md1
    s_cmp_lg_u32 s59, 0
    s_cbranch_scc1 M_mdd
    s_mov_b32 s59, 1
    s_mov_b64 s[68:69], s[70:71]
    v_mov_b32 v187, v191
    s_nop 1
    s_branch M_md
M_md1:
    s_ff1_i32_b64 s27, s[68:69]
    s_bitset0_b64 s[68:69], s27
    v_readlane_b32 s60, v187, s27
    s_bfe_u32 s60, s60, 0x170001
    s_cmp_le_u32 s60, 32
    s_cbranch_scc1 M_md2
    ds_write_b32 v9, v19
    s_movk_i32 s60, 32
M_md2:
    s_lshr_b32 s27, s27, 2
    s_lshl_b32 s61, s59, 4
    s_add_u32 s27, s27, s61
    s_lshl_b32 s61, s26, 5
    s_add_u32 s27, s27, s61
    s_lshl_b32 s27, s27, 15
    s_lshl_b32 s61, s2, 7
    s_add_u32 s27, s27, s61
    s_add_u32 s27, s27, 0x900000
    v_mov_b32 v148, 0xff000000
    s_bfm_b64 exec, s60, 0
    buffer_load_dword v148, v20, s[36:39], s27 offen sc1
    s_mov_b64 exec, -1
    s_waitcnt vmcnt(0) lgkmcnt(0)
    v_and_b32 v64, s12, v148
    v_alignbit_b32 v65, s13, v148, 22
    ds_read_u16 v64, v64 offset:30720
    ds_read_b32 v65, v65
    s_waitcnt lgkmcnt(0)
    v_and_b32 v96, 0x0707, v64
    v_and_b32 v64, 0xf8f8, v64
    v_mul_u32_u24 v96, 0x200400, v96
    v_and_or_b32 v64, v96, s14, v64
    v_add_u32 v64, v64, v65
    v_dot4_i32_i8 v64, v64, v64, 0
    s_nop 2
    v_cmp_gt_i32 s[40:41], s15, v64
    s_nop 1
    v_mbcnt_lo_u32_b32 v96, s40, 0
    v_mbcnt_hi_u32_b32 v96, s41, v96
    v_lshl_add_u32 v96, v96, 2, s16
    s_bcnt1_i32_b64 s27, s[40:41]
    s_lshl2_add_u32 s16, s27, s16
    v_cndmask_b32 v96, v26, v96, s[40:41]
    ds_write_b32 v96, v148
    s_sub_u32 s27, s16, s17
    s_cmp_gt_u32 s27, 1024
    s_cbranch_scc0 M_md
    s_branch M_mdd
M_slow:
    v_lshrrev_b32 v8, 4, v1
    v_add_u32 v86, 64, v8
    v_bfrev_b32 v14, 2
    s_mov_b32 s63, 0x02020000
    s_mov_b32 s64, 0x322bcc77
    v_mov_b32 v103, 0x01000c0c
    v_and_b32 v12, 3, v8
    v_lshlrev_b32 v12, 3, v12
    v_lshrrev_b32_e64 v13, v12, s18
    v_bfe_u32 v15, v13, 1, 7
    v_lshlrev_b32 v15, 17, v15
    v_and_b32 v13, 1, v13
    v_or_b32 v95, v13, v15
    s_bfe_u32 s60, s18, 0x70019
    s_lshl_b32 s60, s60, 17
    s_bfe_u32 s27, s18, 0x10018
    s_or_b32 s60, s60, s27
    s_lshl_b32 s53, s2, 7
    s_cmp_eq_u32 s14, 2
    s_cbranch_scc1 M_sovf
    s_cmp_ge_u32 s15, 63
    s_cbranch_scc1 M_sph1
    s_lshl_b32 s62, s15, 2
    v_lshrrev_b32 v12, 5, v8
    v_and_b32 v13, 31, v8
    v_add_u32 v15, s62, v12
    v_cmp_gt_u32 vcc, 250, v15
    s_mov_b64 s[54:55], vcc
    v_lshlrev_b32 v15, 15, v15
    v_cndmask_b32 v15, v14, v15, s[54:55]
    s_cmp_lg_u32 s14, 0
    s_nop 0
    s_cbranch_scc1 M_s222
    v_lshl_add_u32 v16, v13, 2, v15
    buffer_load_dword v88, v16, s[36:39], s53 offen sc1
    s_waitcnt vmcnt(0)
    v_xor_b32 v88, v95, v88
    s_mov_b32 s27, 0xc8000000
    v_cmp_gt_u32 vcc, s27, v88
    s_and_b64 s[54:55], s[54:55], vcc
    s_nop 3
    s_branch M_s322
M_s222:
    buffer_load_dword v88, v15, s[36:39], s53 offen offset:124 sc1
    s_waitcnt vmcnt(0)
    v_xor_b32 v88, s60, v88
    v_bfe_u32 v88, v88, 1, 23
    v_cmp_gt_u32 vcc, v88, v13
    s_and_b64 s[54:55], s[54:55], vcc
    v_lshl_add_u32 v16, v13, 2, v15
    v_cndmask_b32 v16, v14, v16, s[54:55]
    s_add_u32 s27, s53, 0x900000
    buffer_load_dword v88, v16, s[36:39], s27 offen sc1
    s_waitcnt vmcnt(0)
M_s322:
    v_lshrrev_b32 v16, 24, v88
    v_subrev_u32 v17, s59, v16
    v_cmp_gt_u32 vcc, s45, v17
    s_and_b64 s[54:55], s[54:55], vcc
    v_and_b32 v96, 0x1fffe, v88
    v_lshl_add_u32 v96, v96, 1, v96
    v_and_b32 v96, -4, v96
    v_cndmask_b32 v96, v14, v96, s[54:55]
    buffer_load_dwordx2 v[98:99], v96, s[92:95], 0 offen
    v_mul_u32_u24 v97, 6, v16
    v_and_b32 v97, -4, v97
    v_cndmask_b32 v97, v14, v97, s[54:55]
    s_mul_i32 s27, s2, 1200
    buffer_load_dwordx2 v[100:101], v97, s[92:95], s27 offen
    v_bfe_i32 v102, v88, 1, 1
    v_and_or_b32 v102, v102, s63, v103
    v_bfe_i32 v104, v16, 0, 1
    v_and_or_b32 v104, v104, s63, v103
    v_add_u32 v105, s63, v104
    v_add_u32 v106, s63, v105
    s_waitcnt vmcnt(0)
    v_perm_b32 v107, v101, v100, v104
    v_perm_b32 v108, v101, v100, v105
    v_perm_b32 v109, v101, v100, v106
    v_add_u32 v113, s63, v102
    v_perm_b32 v110, v99, v98, v102
    v_add_u32 v114, s63, v113
    v_perm_b32 v111, v99, v98, v113
    v_perm_b32 v112, v99, v98, v114
    v_sub_f32 v110, v110, v107
    v_sub_f32 v111, v111, v108
    v_sub_f32 v112, v112, v109
    v_cvt_pk_bf16_f32 v89, v110, v111
    v_cvt_pk_bf16_f32 v112, 0, v112
    v_lshlrev_b32 v110, 16, v89
    v_and_b32 v111, s58, v89
    v_mul_f32 v115, v112, v112
    v_mul_f32 v110, v110, v110
    v_mul_f32 v111, v111, v111
    v_cvt_pk_bf16_f32 v115, 0, v115
    v_cvt_pk_bf16_f32 v110, 0, v110
    v_cvt_pk_bf16_f32 v111, 0, v111
    v_add_f32 v110, v110, v111
    v_add_f32 v110, v110, v115
    v_cvt_pk_bf16_f32 v110, 0, v110
    v_add_f32 v110, s64, v110
    v_cvt_pk_bf16_f32 v110, 0, v110
    v_sqrt_f32 v110, v110
    s_nop 0
    v_cvt_pk_bf16_f32 v90, v112, v110
    s_mov_b32 s27, 0x409d0000
    v_cmp_gt_u32 vcc, s27, v90
    s_and_b64 s[8:9], s[54:55], vcc
    v_lshrrev_b32 v12, 5, v86
    v_and_b32 v13, 31, v86
    v_add_u32 v15, s62, v12
    v_cmp_gt_u32 vcc, 250, v15
    s_mov_b64 s[54:55], vcc
    v_lshlrev_b32 v15, 15, v15
    v_cndmask_b32 v15, v14, v15, s[54:55]
    s_cmp_lg_u32 s14, 0
    s_nop 0
    s_cbranch_scc1 M_s223
    v_lshl_add_u32 v16, v13, 2, v15
    buffer_load_dword v92, v16, s[36:39], s53 offen sc1
    s_waitcnt vmcnt(0)
    v_xor_b32 v92, v95, v92
    s_mov_b32 s27, 0xc8000000
    v_cmp_gt_u32 vcc, s27, v92
    s_and_b64 s[54:55], s[54:55], vcc
    s_nop 3
    s_branch M_s323
M_s223:
    buffer_load_dword v92, v15, s[36:39], s53 offen offset:124 sc1
    s_waitcnt vmcnt(0)
    v_xor_b32 v92, s60, v92
    v_bfe_u32 v92, v92, 1, 23
    v_cmp_gt_u32 vcc, v92, v13
    s_and_b64 s[54:55], s[54:55], vcc
    v_lshl_add_u32 v16, v13, 2, v15
    v_cndmask_b32 v16, v14, v16, s[54:55]
    s_add_u32 s27, s53, 0x900000
    buffer_load_dword v92, v16, s[36:39], s27 offen sc1
    s_waitcnt vmcnt(0)
M_s323:
    v_lshrrev_b32 v16, 24, v92
    v_subrev_u32 v17, s59, v16
    v_cmp_gt_u32 vcc, s45, v17
    s_and_b64 s[54:55], s[54:55], vcc
    v_and_b32 v96, 0x1fffe, v92
    v_lshl_add_u32 v96, v96, 1, v96
    v_and_b32 v96, -4, v96
    v_cndmask_b32 v96, v14, v96, s[54:55]
    buffer_load_dwordx2 v[98:99], v96, s[92:95], 0 offen
    v_mul_u32_u24 v97, 6, v16
    v_and_b32 v97, -4, v97
    v_cndmask_b32 v97, v14, v97, s[54:55]
    s_mul_i32 s27, s2, 1200
    buffer_load_dwordx2 v[100:101], v97, s[92:95], s27 offen
    v_bfe_i32 v102, v92, 1, 1
    v_and_or_b32 v102, v102, s63, v103
    v_bfe_i32 v104, v16, 0, 1
    v_and_or_b32 v104, v104, s63, v103
    v_add_u32 v105, s63, v104
    v_add_u32 v106, s63, v105
    s_waitcnt vmcnt(0)
    v_perm_b32 v107, v101, v100, v104
    v_perm_b32 v108, v101, v100, v105
    v_perm_b32 v109, v101, v100, v106
    v_add_u32 v113, s63, v102
    v_perm_b32 v110, v99, v98, v102
    v_add_u32 v114, s63, v113
    v_perm_b32 v111, v99, v98, v113
    v_perm_b32 v112, v99, v98, v114
    v_sub_f32 v110, v110, v107
    v_sub_f32 v111, v111, v108
    v_sub_f32 v112, v112, v109
    v_cvt_pk_bf16_f32 v93, v110, v111
    v_cvt_pk_bf16_f32 v112, 0, v112
    v_lshlrev_b32 v110, 16, v93
    v_and_b32 v111, s58, v93
    v_mul_f32 v115, v112, v112
    v_mul_f32 v110, v110, v110
    v_mul_f32 v111, v111, v111
    v_cvt_pk_bf16_f32 v115, 0, v115
    v_cvt_pk_bf16_f32 v110, 0, v110
    v_cvt_pk_bf16_f32 v111, 0, v111
    v_add_f32 v110, v110, v111
    v_add_f32 v110, v110, v115
    v_cvt_pk_bf16_f32 v110, 0, v110
    v_add_f32 v110, s64, v110
    v_cvt_pk_bf16_f32 v110, 0, v110
    v_sqrt_f32 v110, v110
    s_nop 0
    v_cvt_pk_bf16_f32 v94, v112, v110
    s_mov_b32 s27, 0x409d0000
    v_cmp_gt_u32 vcc, s27, v94
    s_and_b64 s[10:11], s[54:55], vcc
    s_add_u32 s15, s15, 1
    s_nop 2
    s_branch M_sgo
M_sph1:
    s_add_u32 s14, s14, 1
    s_mov_b32 s15, 0
    s_mov_b32 s16, 0
    s_cmp_eq_u32 s14, 1
    s_cbranch_scc1 M_slow
M_sovf:
    s_cmp_ge_u32 s15, 250
    s_cbranch_scc1 M_send
    s_cmp_lg_u32 s16, 0
    s_cbranch_scc1 M_sblk
    s_lshl_b32 s27, s15, 15
    s_add_u32 s27, s27, s53
    v_mov_b32 v12, 0
    buffer_load_dword v13, v12, s[36:39], s27 offen offset:124 sc1
    s_waitcnt vmcnt(0)
    v_readfirstlane_b32 s17, v13
    s_xor_b32 s17, s17, s60
    s_bfe_u32 s17, s17, 0x170001
    s_cmp_gt_u32 s17, 32
    s_cselect_b32 s17, 1, 0
    s_cbranch_scc0 M_sblk0
    s_lshl_b32 s27, s15, 15
    s_add_u32 s27, s27, 32124
    buffer_load_dword v13, v12, s[36:39], s27 offen sc1
    s_waitcnt vmcnt(0)
    v_readfirstlane_b32 s17, v13
    s_min_u32 s17, s17, 3200
M_sblk0:
M_sblk:
    s_cmp_lt_u32 s16, s17
    s_cbranch_scc1 M_sld
    s_add_u32 s15, s15, 1
    s_mov_b32 s16, 0
    s_branch M_sovf
M_sld:
    s_mul_i32 s27, s15, 32768
    s_add_u32 s27, s27, 0x1100000
    v_add_u32 v12, s16, v8
    v_cmp_gt_u32 s[54:55], s17, v12
    v_lshlrev_b32 v12, 3, v12
    s_nop 0
    v_cndmask_b32 v12, v14, v12, s[54:55]
    buffer_load_dwordx2 v[88:89], v12, s[36:39], s27 offen sc1
    s_waitcnt vmcnt(0)
    v_cmp_eq_u32 vcc, s2, v89
    s_and_b64 s[54:55], s[54:55], vcc
    v_lshrrev_b32 v16, 24, v88
    v_subrev_u32 v17, s59, v16
    v_cmp_gt_u32 vcc, s45, v17
    s_and_b64 s[54:55], s[54:55], vcc
    v_and_b32 v96, 0x1fffe, v88
    v_lshl_add_u32 v96, v96, 1, v96
    v_and_b32 v96, -4, v96
    v_cndmask_b32 v96, v14, v96, s[54:55]
    buffer_load_dwordx2 v[98:99], v96, s[92:95], 0 offen
    v_mul_u32_u24 v97, 6, v16
    v_and_b32 v97, -4, v97
    v_cndmask_b32 v97, v14, v97, s[54:55]
    s_mul_i32 s27, s2, 1200
    buffer_load_dwordx2 v[100:101], v97, s[92:95], s27 offen
    v_bfe_i32 v102, v88, 1, 1
    v_and_or_b32 v102, v102, s63, v103
    v_bfe_i32 v104, v16, 0, 1
    v_and_or_b32 v104, v104, s63, v103
    v_add_u32 v105, s63, v104
    v_add_u32 v106, s63, v105
    s_waitcnt vmcnt(0)
    v_perm_b32 v107, v101, v100, v104
    v_perm_b32 v108, v101, v100, v105
    v_perm_b32 v109, v101, v100, v106
    v_add_u32 v113, s63, v102
    v_perm_b32 v110, v99, v98, v102
    v_add_u32 v114, s63, v113
    v_perm_b32 v111, v99, v98, v113
    v_perm_b32 v112, v99, v98, v114
    v_sub_f32 v110, v110, v107
    v_sub_f32 v111, v111, v108
    v_sub_f32 v112, v112, v109
    v_cvt_pk_bf16_f32 v89, v110, v111
    v_cvt_pk_bf16_f32 v112, 0, v112
    v_lshlrev_b32 v110, 16, v89
    v_and_b32 v111, s58, v89
    v_mul_f32 v115, v112, v112
    v_mul_f32 v110, v110, v110
    v_mul_f32 v111, v111, v111
    v_cvt_pk_bf16_f32 v115, 0, v115
    v_cvt_pk_bf16_f32 v110, 0, v110
    v_cvt_pk_bf16_f32 v111, 0, v111
    v_add_f32 v110, v110, v111
    v_add_f32 v110, v110, v115
    v_cvt_pk_bf16_f32 v110, 0, v110
    v_add_f32 v110, s64, v110
    v_cvt_pk_bf16_f32 v110, 0, v110
    v_sqrt_f32 v110, v110
    s_nop 0
    v_cvt_pk_bf16_f32 v90, v112, v110
    s_mov_b32 s27, 0x409d0000
    v_cmp_gt_u32 vcc, s27, v90
    s_and_b64 s[8:9], s[54:55], vcc
    s_mul_i32 s27, s15, 32768
    s_add_u32 s27, s27, 0x1100000
    v_add_u32 v12, s16, v86
    v_cmp_gt_u32 s[54:55], s17, v12
    v_lshlrev_b32 v12, 3, v12
    s_nop 0
    v_cndmask_b32 v12, v14, v12, s[54:55]
    buffer_load_dwordx2 v[92:93], v12, s[36:39], s27 offen sc1
    s_waitcnt vmcnt(0)
    v_cmp_eq_u32 vcc, s2, v93
    s_and_b64 s[54:55], s[54:55], vcc
    v_lshrrev_b32 v16, 24, v92
    v_subrev_u32 v17, s59, v16
    v_cmp_gt_u32 vcc, s45, v17
    s_and_b64 s[54:55], s[54:55], vcc
    v_and_b32 v96, 0x1fffe, v92
    v_lshl_add_u32 v96, v96, 1, v96
    v_and_b32 v96, -4, v96
    v_cndmask_b32 v96, v14, v96, s[54:55]
    buffer_load_dwordx2 v[98:99], v96, s[92:95], 0 offen
    v_mul_u32_u24 v97, 6, v16
    v_and_b32 v97, -4, v97
    v_cndmask_b32 v97, v14, v97, s[54:55]
    s_mul_i32 s27, s2, 1200
    buffer_load_dwordx2 v[100:101], v97, s[92:95], s27 offen
    v_bfe_i32 v102, v92, 1, 1
    v_and_or_b32 v102, v102, s63, v103
    v_bfe_i32 v104, v16, 0, 1
    v_and_or_b32 v104, v104, s63, v103
    v_add_u32 v105, s63, v104
    v_add_u32 v106, s63, v105
    s_waitcnt vmcnt(0)
    v_perm_b32 v107, v101, v100, v104
    v_perm_b32 v108, v101, v100, v105
    v_perm_b32 v109, v101, v100, v106
    v_add_u32 v113, s63, v102
    v_perm_b32 v110, v99, v98, v102
    v_add_u32 v114, s63, v113
    v_perm_b32 v111, v99, v98, v113
    v_perm_b32 v112, v99, v98, v114
    v_sub_f32 v110, v110, v107
    v_sub_f32 v111, v111, v108
    v_sub_f32 v112, v112, v109
    v_cvt_pk_bf16_f32 v93, v110, v111
    v_cvt_pk_bf16_f32 v112, 0, v112
    v_lshlrev_b32 v110, 16, v93
    v_and_b32 v111, s58, v93
    v_mul_f32 v115, v112, v112
    v_mul_f32 v110, v110, v110
    v_mul_f32 v111, v111, v111
    v_cvt_pk_bf16_f32 v115, 0, v115
    v_cvt_pk_bf16_f32 v110, 0, v110
    v_cvt_pk_bf16_f32 v111, 0, v111
    v_add_f32 v110, v110, v111
    v_add_f32 v110, v110, v115
    v_cvt_pk_bf16_f32 v110, 0, v110
    v_add_f32 v110, s64, v110
    v_cvt_pk_bf16_f32 v110, 0, v110
    v_sqrt_f32 v110, v110
    s_nop 0
    v_cvt_pk_bf16_f32 v94, v112, v110
    s_mov_b32 s27, 0x409d0000
    v_cmp_gt_u32 vcc, s27, v94
    s_and_b64 s[10:11], s[54:55], vcc
    s_add_u32 s16, s16, 128
    s_nop 2
M_sgo:
    s_or_b64 s[54:55], s[8:9], s[10:11]
    s_cmp_eq_u64 s[54:55], 0
    s_cbranch_scc1 M_slow
    s_mov_b32 s48, 4
    s_cmp_eq_u64 s[10:11], 0
    s_cselect_b32 s48, 2, 4
    s_movk_i32 s63, 0x70
    s_movk_i32 s64, 128
    v_lshrrev_b32 v8, 4, v1
    v_lshrrev_b32 v10, 5, v8
    v_and_b32 v11, 31, v8
    v_lshlrev_b32 v3, 4, v11
    v_add_u32 v3, s52, v3
    v_mul_u32_u24 v0, 56, v10
    v_add_u32 v0, s52, v0
    v_lshrrev_b32 v13, 3, v11
    v_lshl_add_u32 v4, v13, 3, v0
    v_lshrrev_b32 v13, 3, v8
    v_and_b32 v14, 1, v13
    v_lshrrev_b32 v13, 1, v13
    v_lshl_add_u32 v13, v14, 2, v13
    v_lshlrev_b32 v5, 4, v13
    v_add_u32 v5, s52, v5
    v_add_u32 v16, s52, v1
    v_lshrrev_b32 v17, 2, v8
    v_mul_u32_u24 v17, 56, v17
    v_and_b32 v13, 3, v8
    v_lshl_add_u32 v17, v13, 1, v17
    v_add_u32 v17, s52, v17
    s_nop 1
    s_branch M_win
M_send:
    s_mov_b64 s[8:9], 0
    s_mov_b64 s[10:11], 0
    s_mov_b32 s48, 0
    s_mov_b32 s76, 1
    s_movk_i32 s63, 0x70
    s_movk_i32 s64, 128
    v_lshrrev_b32 v8, 4, v1
    v_lshrrev_b32 v10, 5, v8
    v_and_b32 v11, 31, v8
    v_lshlrev_b32 v3, 4, v11
    v_add_u32 v3, s52, v3
    v_mul_u32_u24 v0, 56, v10
    v_add_u32 v0, s52, v0
    v_lshrrev_b32 v13, 3, v11
    v_lshl_add_u32 v4, v13, 3, v0
    v_lshrrev_b32 v13, 3, v8
    v_and_b32 v14, 1, v13
    v_lshrrev_b32 v13, 1, v13
    v_lshl_add_u32 v13, v14, 2, v13
    v_lshlrev_b32 v5, 4, v13
    v_add_u32 v5, s52, v5
    v_add_u32 v16, s52, v1
    v_lshrrev_b32 v17, 2, v8
    v_mul_u32_u24 v17, 56, v17
    v_and_b32 v13, 3, v8
    v_lshl_add_u32 v17, v13, 1, v17
    v_add_u32 v17, s52, v17
    s_nop 1
    s_branch M_win
.section .rodata,"a"
.p2align 6
.amdhsa_kernel standalone__molecular_angular_painn__graph_kernel
  .amdhsa_next_free_vgpr 256
  .amdhsa_next_free_sgpr 102
  .amdhsa_accum_offset 256
  .amdhsa_group_segment_fixed_size 0
  .amdhsa_kernarg_size 88
  .amdhsa_user_sgpr_count 2
  .amdhsa_user_sgpr_kernarg_segment_ptr 1
  .amdhsa_system_sgpr_workgroup_id_x 1
  .amdhsa_float_denorm_mode_32 3
.end_amdhsa_kernel
```

```asm
; @launch grid=(250,1,1) block=(512,1,1) lds=163840
.amdgcn_target "amdgcn-amd-amdhsa--gfx950"
.text
.globl standalone__molecular_angular_painn__graph_kernel
.p2align 12
.p2align 8
.type standalone__molecular_angular_painn__graph_kernel,@function
standalone__molecular_angular_painn__graph_kernel:
    s_cmp_ge_u32 s2, 250
    s_cbranch_scc1 K_end
    s_load_dwordx8 s[4:11], s[0:1], 0
    s_load_dwordx8 s[12:19], s[0:1], 32
    s_load_dwordx2 s[20:21], s[0:1], 64
    s_load_dwordx2 s[24:25], s[0:1], 80
    v_and_b32 v1, 63, v0
    v_lshrrev_b32 v119, 6, v0
    v_lshlrev_b32 v2, 4, v0
    v_readfirstlane_b32 s26, v119
    v_mov_b32 v20, 0xff000000
    v_mov_b32 v21, v20
    v_mov_b32 v22, v20
    v_mov_b32 v23, v20
    v_add_u32 v117, 131840, v2
    ds_write_b128 v117, v[20:23] offset:0
    ds_write_b128 v117, v[20:23] offset:8192
    ds_write_b128 v117, v[20:23] offset:16384
    v_cmp_gt_u32 vcc, 464, v0
    s_mov_b64 s[66:67], vcc
    s_mov_b64 exec, vcc
    ds_write_b128 v117, v[20:23] offset:24576
    s_mov_b64 exec, -1
    v_lshlrev_b32 v28, 2, v0
    v_mov_b32 v29, 0
    v_cmp_gt_u32 vcc, 256, v0
    s_and_saveexec_b64 s[60:61], vcc
    ds_write_b32 v28, v29 offset:8192
    s_mov_b64 exec, -1
    v_mov_b32 v30, 131076
    ds_write2_b32 v30, v29, v29 offset1:1
    ds_write_b32 v30, v29 offset:8
    s_mov_b32 s58, 0xffff0000
    v_lshlrev_b32 v3, 4, v1
    v_mov_b32 v116, 1
    v_lshrrev_b32 v119, 4, v1
    v_and_b32 v120, 15, v1
    v_lshlrev_b32 v121, 9, v120
    v_lshl_add_u32 v121, v119, 4, v121
    v_bfrev_b32 v118, 2
    s_cmp_eq_u32 s26, 4
    s_cselect_b32 s63, 8, 16
    s_cmp_gt_u32 s26, 4
    s_cselect_b32 s63, 0, s63
    v_cmp_gt_u32 vcc, s63, v120
    s_nop 1
    v_cndmask_b32 v36, v118, v121, vcc
    s_mul_i32 s62, s2, 200
    s_lshl_b32 s61, s26, 4
    s_add_u32 s62, s62, s61
    s_lshl_b32 s76, s62, 9
    s_add_u32 s77, s76, 65536
    s_mul_i32 s27, s2, 12800
    s_add_u32 s59, s27, 6400
    v_cmp_gt_u32 vcc, 400, v0
    s_mov_b64 s[56:57], vcc
    s_lshl_b32 s64, s26, 10
    s_add_u32 m0, s64, 0
    s_waitcnt lgkmcnt(0)
    s_barrier
    s_mov_b32 s48, s14
    s_mov_b32 s49, s15
    s_mov_b32 s50, 0x2000
    s_mov_b32 s51, 0x00020000
    s_cmp_eq_u32 s26, 7
    s_cbranch_scc1 P_w7
    s_mov_b32 s44, s10
    s_mov_b32 s45, s11
    s_mov_b32 s46, 0x30d400
    s_mov_b32 s47, 0x00020000
    s_mov_b32 s40, s8
    s_mov_b32 s41, s9
    s_mov_b32 s42, 0x30d400
    s_mov_b32 s43, 0x00020000
    s_mov_b32 s28, s4
    s_mov_b32 s29, s5
    s_mov_b32 s30, 0x186a000
    s_mov_b32 s31, 0x00020000
    buffer_load_dwordx4 v3, s[48:51], s64 offen lds
    s_mov_b64 exec, s[56:57]
    buffer_load_dwordx4 v[4:7], v2, s[44:47], s27 offen nt
    buffer_load_dwordx4 v[8:11], v2, s[44:47], s59 offen nt
    buffer_load_dwordx4 v[12:15], v2, s[40:43], s27 offen nt
    buffer_load_dwordx4 v[16:19], v2, s[40:43], s59 offen nt
    s_mov_b64 exec, -1
    s_mov_b32 s92, s6
    s_mov_b32 s93, s7
    s_mov_b32 s94, 0x493e0
    s_mov_b32 s95, 0x00020000
    s_mov_b32 s36, s24
    s_mov_b32 s37, s25
    s_mov_b32 s38, 0x241a800
    s_mov_b32 s39, 0x00020000
    s_add_u32 s72, s24, 0x1e00000
    s_addc_u32 s73, s25, 0
    s_mov_b32 s74, 0x61a800
    s_mov_b32 s75, 0x00020000
    s_mov_b32 s52, s16
    s_mov_b32 s53, s17
    s_mov_b32 s54, 0x6000
    s_mov_b32 s55, 0x00020000
    s_mov_b32 s96, s18
    s_mov_b32 s97, s19
    s_mov_b32 s98, 0x1800
    s_mov_b32 s99, 0x00020000
    s_mov_b32 s68, s12
    s_mov_b32 s69, s13
    s_mov_b32 s70, 0x20
    s_mov_b32 s71, 0x00020000
    s_mov_b32 s32, s20
    s_mov_b32 s33, s21
    s_mov_b32 s34, 0x186a000
    s_mov_b32 s35, 0x00020000
    v_bfe_u32 v122, v1, 2, 2
    v_lshl_add_u32 v122, v119, 3, v122
    v_lshlrev_b32 v122, 7, v122
    v_and_b32 v39, 3, v1
    v_lshl_add_u32 v122, v39, 3, v122
    s_mov_b64 exec, 0
    s_cmp_eq_u32 s26, 0
    s_cbranch_scc1 WUP_413
    s_cmp_eq_u32 s26, 1
    s_cbranch_scc1 WUP_548
    s_cmp_eq_u32 s26, 2
    s_cbranch_scc1 WUP_934
    s_cmp_eq_u32 s26, 3
    s_cbranch_scc1 WUP_4328
    s_cmp_eq_u32 s26, 4
    s_cbranch_scc1 WUP_1270
    s_cmp_eq_u32 s26, 5
    s_cbranch_scc1 WUP_1607
    s_cmp_eq_u32 s26, 6
    s_cbranch_scc1 WUP_1974
WUR_0:
    s_mov_b64 exec, -1
    s_nop 1
    s_branch P_bin
P_w7:
    s_lshr_b32 s3, s2, 3
    s_lshl_b32 s3, s3, 2
    s_and_b32 s65, s2, 3
    s_add_u32 s3, s3, s65
    s_and_b32 s65, s2, 4
    s_cselect_b32 s3, 0xffff, s3
    s_mul_i32 s65, s3, 3072
    v_mul_u32_u24 v38, 24, v1
    s_cmp_ge_u32 s3, 98
    s_cselect_b32 s65, 0x40000000, s65
    s_mov_b32 s92, s6
    s_mov_b32 s93, s7
    s_mov_b32 s94, 0x493e0
    s_mov_b32 s95, 0x00020000
    buffer_load_dwordx3 v[4:6], v38, s[92:95], s65 offen offset:0
    buffer_load_dwordx3 v[8:10], v38, s[92:95], s65 offen offset:12
    buffer_load_dwordx3 v[12:14], v38, s[92:95], s65 offen offset:1536
    buffer_load_dwordx3 v[16:18], v38, s[92:95], s65 offen offset:1548
    s_mov_b32 s27, 0x830000
    buffer_load_dwordx4 v3, s[48:51], s64 offen lds
    s_load_dword s22, s[24:25], s27
    s_mov_b32 s28, s4
    s_mov_b32 s29, s5
    s_mov_b32 s30, 0x186a000
    s_mov_b32 s31, 0x00020000
    s_mov_b32 s92, s6
    s_mov_b32 s93, s7
    s_mov_b32 s94, 0x493e0
    s_mov_b32 s95, 0x00020000
    s_mov_b32 s36, s24
    s_mov_b32 s37, s25
    s_mov_b32 s38, 0x241a800
    s_mov_b32 s39, 0x00020000
    s_add_u32 s72, s24, 0x1e00000
    s_addc_u32 s73, s25, 0
    s_mov_b32 s74, 0x61a800
    s_mov_b32 s75, 0x00020000
    s_mov_b32 s52, s16
    s_mov_b32 s53, s17
    s_mov_b32 s54, 0x6000
    s_mov_b32 s55, 0x00020000
    s_mov_b32 s96, s18
    s_mov_b32 s97, s19
    s_mov_b32 s98, 0x1800
    s_mov_b32 s99, 0x00020000
    s_mov_b32 s68, s12
    s_mov_b32 s69, s13
    s_mov_b32 s70, 0x20
    s_mov_b32 s71, 0x00020000
    s_mov_b32 s32, s20
    s_mov_b32 s33, s21
    s_mov_b32 s34, 0x186a000
    s_mov_b32 s35, 0x00020000
    v_bfe_u32 v122, v1, 2, 2
    v_lshl_add_u32 v122, v119, 3, v122
    v_lshlrev_b32 v122, 7, v122
    v_and_b32 v39, 3, v1
    v_lshl_add_u32 v122, v39, 3, v122
    s_cmp_ge_u32 s3, 98
    s_nop 0
    s_cbranch_scc1 P_w7n
    s_mov_b32 s60, 0x41800000
    s_movk_i32 s65, 0xf8
    v_lshlrev_b32 v38, 3, v1
    s_mul_i32 s27, s3, 1024
    s_add_u32 s27, s27, 0x810000
    s_waitcnt vmcnt(3)
    v_lshlrev_b32 v68, 16, v4
    v_and_b32 v69, s58, v4
    v_lshlrev_b32 v70, 16, v5
    v_and_b32 v71, s58, v5
    v_lshlrev_b32 v72, 16, v6
    v_and_b32 v73, s58, v6
    v_lshlrev_b32 v74, 16, v8
    v_and_b32 v75, s58, v8
    v_lshlrev_b32 v76, 16, v9
    v_and_b32 v77, s58, v9
    v_lshlrev_b32 v78, 16, v10
    v_and_b32 v79, s58, v10
    v_mul_f32 v68, s60, v68
    v_mul_f32 v69, s60, v69
    v_mul_f32 v70, s60, v70
    v_mul_f32 v71, s60, v71
    v_mul_f32 v72, s60, v72
    v_mul_f32 v73, s60, v73
    v_mul_f32 v74, s60, v74
    v_mul_f32 v75, s60, v75
    v_mul_f32 v76, s60, v76
    v_mul_f32 v77, s60, v77
    v_mul_f32 v78, s60, v78
    v_mul_f32 v79, s60, v79
    v_cvt_flr_i32_f32 v68, v68
    v_cvt_flr_i32_f32 v69, v69
    v_cvt_flr_i32_f32 v70, v70
    v_cvt_flr_i32_f32 v71, v71
    v_cvt_flr_i32_f32 v72, v72
    v_cvt_flr_i32_f32 v73, v73
    v_cvt_flr_i32_f32 v74, v74
    v_cvt_flr_i32_f32 v75, v75
    v_cvt_flr_i32_f32 v76, v76
    v_cvt_flr_i32_f32 v77, v77
    v_cvt_flr_i32_f32 v78, v78
    v_cvt_flr_i32_f32 v79, v79
    v_bfe_u32 v84, v70, 5, 3
    v_bfe_u32 v85, v70, 2, 3
    v_and_or_b32 v68, v68, s65, v84
    v_and_or_b32 v69, v69, s65, v85
    v_lshl_or_b32 v68, v69, 8, v68
    v_bfe_u32 v84, v73, 5, 3
    v_bfe_u32 v85, v73, 2, 3
    v_and_or_b32 v71, v71, s65, v84
    v_and_or_b32 v72, v72, s65, v85
    v_lshl_or_b32 v71, v72, 8, v71
    v_bfe_u32 v84, v76, 5, 3
    v_bfe_u32 v85, v76, 2, 3
    v_and_or_b32 v74, v74, s65, v84
    v_and_or_b32 v75, v75, s65, v85
    v_lshl_or_b32 v74, v75, 8, v74
    v_bfe_u32 v84, v79, 5, 3
    v_bfe_u32 v85, v79, 2, 3
    v_and_or_b32 v77, v77, s65, v84
    v_and_or_b32 v78, v78, s65, v85
    v_lshl_or_b32 v77, v78, 8, v77
    v_lshl_or_b32 v86, v71, 16, v68
    v_lshl_or_b32 v87, v77, 16, v74
    buffer_store_dwordx2 v[86:87], v38, s[36:39], s27 offen offset:0 sc1
    s_waitcnt vmcnt(2)
    v_lshlrev_b32 v68, 16, v12
    v_and_b32 v69, s58, v12
    v_lshlrev_b32 v70, 16, v13
    v_and_b32 v71, s58, v13
    v_lshlrev_b32 v72, 16, v14
    v_and_b32 v73, s58, v14
    v_lshlrev_b32 v74, 16, v16
    v_and_b32 v75, s58, v16
    v_lshlrev_b32 v76, 16, v17
    v_and_b32 v77, s58, v17
    v_lshlrev_b32 v78, 16, v18
    v_and_b32 v79, s58, v18
    v_mul_f32 v68, s60, v68
    v_mul_f32 v69, s60, v69
    v_mul_f32 v70, s60, v70
    v_mul_f32 v71, s60, v71
    v_mul_f32 v72, s60, v72
    v_mul_f32 v73, s60, v73
    v_mul_f32 v74, s60, v74
    v_mul_f32 v75, s60, v75
    v_mul_f32 v76, s60, v76
    v_mul_f32 v77, s60, v77
    v_mul_f32 v78, s60, v78
    v_mul_f32 v79, s60, v79
    v_cvt_flr_i32_f32 v68, v68
    v_cvt_flr_i32_f32 v69, v69
    v_cvt_flr_i32_f32 v70, v70
    v_cvt_flr_i32_f32 v71, v71
    v_cvt_flr_i32_f32 v72, v72
    v_cvt_flr_i32_f32 v73, v73
    v_cvt_flr_i32_f32 v74, v74
    v_cvt_flr_i32_f32 v75, v75
    v_cvt_flr_i32_f32 v76, v76
    v_cvt_flr_i32_f32 v77, v77
    v_cvt_flr_i32_f32 v78, v78
    v_cvt_flr_i32_f32 v79, v79
    v_bfe_u32 v84, v70, 5, 3
    v_bfe_u32 v85, v70, 2, 3
    v_and_or_b32 v68, v68, s65, v84
    v_and_or_b32 v69, v69, s65, v85
    v_lshl_or_b32 v68, v69, 8, v68
    v_bfe_u32 v84, v73, 5, 3
    v_bfe_u32 v85, v73, 2, 3
    v_and_or_b32 v71, v71, s65, v84
    v_and_or_b32 v72, v72, s65, v85
    v_lshl_or_b32 v71, v72, 8, v71
    v_bfe_u32 v84, v76, 5, 3
    v_bfe_u32 v85, v76, 2, 3
    v_and_or_b32 v74, v74, s65, v84
    v_and_or_b32 v75, v75, s65, v85
    v_lshl_or_b32 v74, v75, 8, v74
    v_bfe_u32 v84, v79, 5, 3
    v_bfe_u32 v85, v79, 2, 3
    v_and_or_b32 v77, v77, s65, v84
    v_and_or_b32 v78, v78, s65, v85
    v_lshl_or_b32 v77, v78, 8, v77
    v_lshl_or_b32 v88, v71, 16, v68
    v_lshl_or_b32 v89, v77, 16, v74
    buffer_store_dwordx2 v[88:89], v38, s[36:39], s27 offen offset:512 sc1
    s_nop 0
P_w7n:
    buffer_load_dwordx4 v[20:23], v121, s[28:31], s76 offen offset:0
    buffer_load_dwordx4 v[24:27], v121, s[28:31], s76 offen offset:64
    s_waitcnt lgkmcnt(0)
    v_lshrrev_b32 v124, 5, v1
    v_and_b32 v125, 31, v1
    v_mul_u32_u24 v124, 3072, v124
    v_lshl_add_u32 v124, v125, 2, v124
    s_lshr_b32 s60, s26, 2
    s_and_b32 s61, s26, 3
    s_mul_i32 s63, s61, 768
    s_lshl_b32 s65, s60, 7
    s_add_u32 s63, s63, s65
    s_add_u32 s65, s63, 0
    buffer_load_dword v128, v124, s[52:55], s65 offen
    s_add_u32 s65, s63, 6144
    buffer_load_dword v129, v124, s[52:55], s65 offen
    s_add_u32 s65, s63, 12288
    buffer_load_dword v130, v124, s[52:55], s65 offen
    s_add_u32 s65, s63, 18432
    buffer_load_dword v131, v124, s[52:55], s65 offen
    s_add_u32 s65, s63, 384
    buffer_load_dword v132, v124, s[52:55], s65 offen
    s_add_u32 s65, s63, 6528
    buffer_load_dword v133, v124, s[52:55], s65 offen
    s_add_u32 s65, s63, 12672
    buffer_load_dword v134, v124, s[52:55], s65 offen
    s_add_u32 s65, s63, 18816
    buffer_load_dword v135, v124, s[52:55], s65 offen
    s_cmp_ge_u32 s26, 4
    s_cbranch_scc1 P_e2c
    s_add_u32 s27, s26, 8
    s_lshr_b32 s60, s27, 2
    s_and_b32 s61, s27, 3
    s_mul_i32 s63, s61, 768
    s_lshl_b32 s65, s60, 7
    s_add_u32 s63, s63, s65
    s_add_u32 s65, s63, 0
    buffer_load_dword v136, v124, s[52:55], s65 offen
    s_add_u32 s65, s63, 6144
    buffer_load_dword v137, v124, s[52:55], s65 offen
    s_add_u32 s65, s63, 12288
    buffer_load_dword v138, v124, s[52:55], s65 offen
    s_add_u32 s65, s63, 18432
    buffer_load_dword v139, v124, s[52:55], s65 offen
    s_add_u32 s65, s63, 384
    buffer_load_dword v140, v124, s[52:55], s65 offen
    s_add_u32 s65, s63, 6528
    buffer_load_dword v141, v124, s[52:55], s65 offen
    s_add_u32 s65, s63, 12672
    buffer_load_dword v142, v124, s[52:55], s65 offen
    s_add_u32 s65, s63, 18816
    buffer_load_dword v143, v124, s[52:55], s65 offen
    s_branch P_e3c
P_e2c:
    s_sub_u32 s60, s26, 4
    s_lshl_b32 s63, s60, 7
    s_cmp_eq_u32 s26, 7
    s_cselect_b32 s63, 0x40000000, s63
    buffer_load_dword v136, v124, s[96:99], s63 offen offset:0
    buffer_load_dword v137, v124, s[96:99], s63 offen offset:384
    buffer_load_dword v138, v124, s[96:99], s63 offen offset:768
    buffer_load_dword v139, v124, s[96:99], s63 offen offset:1152
    buffer_load_dword v140, v124, s[96:99], s63 offen offset:1536
    buffer_load_dword v141, v124, s[96:99], s63 offen offset:1920
    buffer_load_dword v142, v124, s[96:99], s63 offen offset:2304
    buffer_load_dword v143, v124, s[96:99], s63 offen offset:2688
P_e3c:
    v_mul_u32_u24 v124, 6, v0
    v_and_b32 v124, -4, v124
    v_cmp_gt_u32 vcc, 200, v0
    s_nop 1
    v_cndmask_b32 v124, v118, v124, vcc
    s_mul_i32 s27, s2, 1200
    buffer_load_dwordx2 v[144:145], v124, s[92:95], s27 offen
    v_lshlrev_b32 v124, 1, v1
    buffer_load_ushort v146, v124, s[68:71], 0 offen
    s_waitcnt vmcnt(20) lgkmcnt(0)
    s_add_u32 s22, s22, 1
    v_mov_b32 v38, s22
    v_mov_b32 v39, 131072
    ds_write_b32 v39, v38
    s_cmp_ge_u32 s3, 98
    s_cbranch_scc1 P_join
    s_lshl_b32 s27, s3, 3
    s_add_u32 s27, s27, 0x830100
    v_mov_b32 v8, s22
    v_mov_b32 v9, s22
    v_mov_b32 v12, 0
    s_mov_b64 exec, 1
    buffer_store_dwordx2 v[8:9], v12, s[36:39], s27 offen sc1
    s_mov_b64 exec, -1
    s_branch P_join
P_bin:
WUP_413:
    s_cbranch_execz WUR_0
    s_mov_b32 s63, 0x147AE15
    s_movk_i32 s65, -200
    s_mov_b32 s60, 8192
    s_mov_b32 s61, 131840
    s_mov_b64 exec, s[56:57]
    s_waitcnt vmcnt(3)
    s_mov_b64 exec, -1
    buffer_load_dwordx4 v[20:23], v121, s[28:31], s76 offen offset:0
    buffer_load_dwordx4 v[24:27], v121, s[28:31], s76 offen offset:64
    buffer_load_dwordx4 v[28:31], v36, s[28:31], s77 offen offset:0
    buffer_load_dwordx4 v[32:35], v36, s[28:31], s77 offen offset:64
    v_lshrrev_b32 v124, 5, v1
    v_and_b32 v125, 31, v1
    v_mul_u32_u24 v124, 3072, v124
    v_lshl_add_u32 v124, v125, 2, v124
    s_lshr_b32 s60, s26, 2
    s_and_b32 s61, s26, 3
    s_mul_i32 s63, s61, 768
    s_lshl_b32 s65, s60, 7
    s_add_u32 s63, s63, s65
    s_add_u32 s65, s63, 0
    buffer_load_dword v128, v124, s[52:55], s65 offen
    s_add_u32 s65, s63, 6144
    buffer_load_dword v129, v124, s[52:55], s65 offen
    s_add_u32 s65, s63, 12288
    buffer_load_dword v130, v124, s[52:55], s65 offen
    s_add_u32 s65, s63, 18432
    buffer_load_dword v131, v124, s[52:55], s65 offen
    s_add_u32 s65, s63, 384
    buffer_load_dword v132, v124, s[52:55], s65 offen
    s_add_u32 s65, s63, 6528
    buffer_load_dword v133, v124, s[52:55], s65 offen
    s_add_u32 s65, s63, 12672
    buffer_load_dword v134, v124, s[52:55], s65 offen
    s_add_u32 s65, s63, 18816
    buffer_load_dword v135, v124, s[52:55], s65 offen
    s_cmp_ge_u32 s26, 4
    s_cbranch_scc1 P_e2a
    s_add_u32 s27, s26, 8
    s_lshr_b32 s60, s27, 2
    s_and_b32 s61, s27, 3
    s_mul_i32 s63, s61, 768
    s_lshl_b32 s65, s60, 7
    s_add_u32 s63, s63, s65
    s_add_u32 s65, s63, 0
    buffer_load_dword v136, v124, s[52:55], s65 offen
    s_add_u32 s65, s63, 6144
    buffer_load_dword v137, v124, s[52:55], s65 offen
    s_add_u32 s65, s63, 12288
    buffer_load_dword v138, v124, s[52:55], s65 offen
    s_add_u32 s65, s63, 18432
    buffer_load_dword v139, v124, s[52:55], s65 offen
    s_add_u32 s65, s63, 384
    buffer_load_dword v140, v124, s[52:55], s65 offen
    s_add_u32 s65, s63, 6528
    buffer_load_dword v141, v124, s[52:55], s65 offen
    s_add_u32 s65, s63, 12672
    buffer_load_dword v142, v124, s[52:55], s65 offen
    s_add_u32 s65, s63, 18816
    buffer_load_dword v143, v124, s[52:55], s65 offen
    s_branch P_e3a
P_e2a:
    s_sub_u32 s60, s26, 4
    s_lshl_b32 s63, s60, 7
    s_cmp_eq_u32 s26, 7
    s_cselect_b32 s63, 0x40000000, s63
    buffer_load_dword v136, v124, s[96:99], s63 offen offset:0
    buffer_load_dword v137, v124, s[96:99], s63 offen offset:384
    buffer_load_dword v138, v124, s[96:99], s63 offen offset:768
    buffer_load_dword v139, v124, s[96:99], s63 offen offset:1152
    buffer_load_dword v140, v124, s[96:99], s63 offen offset:1536
    buffer_load_dword v141, v124, s[96:99], s63 offen offset:1920
    buffer_load_dword v142, v124, s[96:99], s63 offen offset:2304
    buffer_load_dword v143, v124, s[96:99], s63 offen offset:2688
P_e3a:
    v_mul_u32_u24 v124, 6, v0
    v_and_b32 v124, -4, v124
    v_cmp_gt_u32 vcc, 200, v0
    s_nop 1
    v_cndmask_b32 v124, v118, v124, vcc
    s_mul_i32 s27, s2, 1200
    buffer_load_dwordx2 v[144:145], v124, s[92:95], s27 offen
    v_lshlrev_b32 v124, 1, v1
    buffer_load_ushort v146, v124, s[68:71], 0 offen
    s_mov_b32 s63, 0x147AE15
    s_movk_i32 s65, -200
    s_mov_b32 s60, 8192
    s_mov_b32 s61, 131840
    s_mov_b64 exec, s[56:57]
    v_mul_hi_u32 v68, v4, s63
    v_lshl_add_u32 v84, v68, 2, s60
    ds_add_rtn_u32 v76, v84, v116
    v_mul_hi_u32 v69, v5, s63
    v_lshl_add_u32 v85, v69, 2, s60
    ds_add_rtn_u32 v77, v85, v116
    v_mul_hi_u32 v70, v6, s63
    v_lshl_add_u32 v86, v70, 2, s60
    ds_add_rtn_u32 v78, v86, v116
    v_mul_hi_u32 v71, v7, s63
    v_lshl_add_u32 v87, v71, 2, s60
    ds_add_rtn_u32 v79, v87, v116
    s_waitcnt vmcnt(24)
    v_mul_hi_u32 v72, v8, s63
    v_lshl_add_u32 v88, v72, 2, s60
    ds_add_rtn_u32 v80, v88, v116
    v_mul_hi_u32 v73, v9, s63
    v_lshl_add_u32 v89, v73, 2, s60
    ds_add_rtn_u32 v81, v89, v116
    v_mul_hi_u32 v74, v10, s63
    v_lshl_add_u32 v90, v74, 2, s60
    ds_add_rtn_u32 v82, v90, v116
    v_mul_hi_u32 v75, v11, s63
    v_lshl_add_u32 v91, v75, 2, s60
    ds_add_rtn_u32 v83, v91, v116
    v_mad_i32_i24 v4, v68, s65, v4
    v_lshlrev_b32 v4, 24, v4
    v_lshl_add_u32 v84, v68, 7, s61
    v_mad_i32_i24 v5, v69, s65, v5
    v_lshlrev_b32 v5, 24, v5
    v_lshl_add_u32 v85, v69, 7, s61
    v_mad_i32_i24 v6, v70, s65, v6
    v_lshlrev_b32 v6, 24, v6
    v_lshl_add_u32 v86, v70, 7, s61
    v_mad_i32_i24 v7, v71, s65, v7
    v_lshlrev_b32 v7, 24, v7
    v_lshl_add_u32 v87, v71, 7, s61
    v_mad_i32_i24 v8, v72, s65, v8
    v_lshlrev_b32 v8, 24, v8
    v_lshl_add_u32 v88, v72, 7, s61
    v_mad_i32_i24 v9, v73, s65, v9
    v_lshlrev_b32 v9, 24, v9
    v_lshl_add_u32 v89, v73, 7, s61
    v_mad_i32_i24 v10, v74, s65, v10
    v_lshlrev_b32 v10, 24, v10
    v_lshl_add_u32 v90, v74, 7, s61
    v_mad_i32_i24 v11, v75, s65, v11
    v_lshlrev_b32 v11, 24, v11
WUP_548:
    s_cbranch_execz WUP_721
    v_lshl_add_u32 v91, v75, 7, s61
    s_waitcnt vmcnt(22)
    v_lshl_or_b32 v92, v12, 1, v4
    v_lshl_or_b32 v93, v13, 1, v5
    v_lshl_or_b32 v94, v14, 1, v6
    v_lshl_or_b32 v95, v15, 1, v7
    v_lshl_or_b32 v96, v16, 1, v8
    v_lshl_or_b32 v97, v17, 1, v9
    v_lshl_or_b32 v98, v18, 1, v10
    v_lshl_or_b32 v99, v19, 1, v11
    s_waitcnt lgkmcnt(0)
    v_max3_u32 v36, v76, v77, v78
    v_max3_u32 v37, v79, v80, v81
    v_max3_u32 v36, v36, v82, v83
    v_max_u32 v36, v36, v37
    v_lshl_add_u32 v12, v76, 2, v84
    v_lshl_add_u32 v13, v77, 2, v85
    v_lshl_add_u32 v14, v78, 2, v86
    v_lshl_add_u32 v15, v79, 2, v87
    v_lshl_add_u32 v16, v80, 2, v88
    v_lshl_add_u32 v17, v81, 2, v89
    v_lshl_add_u32 v18, v82, 2, v90
    v_lshl_add_u32 v19, v83, 2, v91
    v_cmp_lt_u32 vcc, 30, v36
    s_nop 4
    s_cbranch_vccnz P_rare
    ds_write_b32 v12, v92
    ds_write_b32 v13, v93
    ds_write_b32 v14, v94
    ds_write_b32 v15, v95
    ds_write_b32 v16, v96
    ds_write_b32 v17, v97
    ds_write_b32 v18, v98
    ds_write_b32 v19, v99
    s_mov_b64 exec, -1
P_join:
    s_lshl_b32 s23, s2, 15
    v_mov_b32 v4, 131072
    s_waitcnt lgkmcnt(0)
    s_mov_b64 exec, 0
    s_cmp_eq_u32 s26, 0
    s_cbranch_scc1 WUP_2304
    s_cmp_eq_u32 s26, 1
    s_cbranch_scc1 WUP_2482
    s_cmp_eq_u32 s26, 2
    s_cbranch_scc1 WUP_2645
    s_cmp_eq_u32 s26, 3
    s_cbranch_scc1 WUP_3316
WUR_1:
    s_mov_b64 exec, -1
    s_barrier
    ds_read_b64 v[4:5], v4
    ds_read_b128 v[100:103], v117 offset:0
    ds_read_b128 v[104:107], v117 offset:8192
    ds_read_b128 v[108:111], v117 offset:16384
    ds_read_b128 v[112:115], v117 offset:24576
    s_waitcnt lgkmcnt(4)
    v_readfirstlane_b32 s18, v4
    v_readfirstlane_b32 s19, v5
    s_bfe_u32 s8, s18, 0x70001
    s_lshl_b32 s8, s8, 17
    s_bfe_u32 s27, s18, 0x10000
    s_or_b32 s8, s8, s27
    s_bfe_u32 s9, s18, 0x70009
    s_lshl_b32 s9, s9, 17
    s_bfe_u32 s27, s18, 0x10008
    s_or_b32 s9, s9, s27
    s_bfe_u32 s10, s18, 0x70011
    s_lshl_b32 s10, s10, 17
    s_bfe_u32 s27, s18, 0x10010
    s_or_b32 s10, s10, s27
    s_bfe_u32 s11, s18, 0x70019
    s_lshl_b32 s11, s11, 17
    s_bfe_u32 s27, s18, 0x10018
    s_or_b32 s11, s11, s27
    s_cmp_eq_u32 s19, 0
    s_cbranch_scc1 P_noovf
    v_mov_b32 v4, 131080
    ds_read_b32 v4, v4
    v_mov_b32 v5, 0
    s_add_u32 s27, s23, 32124
    s_waitcnt lgkmcnt(0)
    buffer_store_dword v4, v5, s[36:39], s27 offen sc1
    s_waitcnt vmcnt(0)
    s_barrier
P_noovf:
    s_waitcnt lgkmcnt(3)
    v_xor_b32 v100, s8, v100
    v_xor_b32 v101, s9, v101
    v_xor_b32 v102, s10, v102
    v_xor_b32 v103, s11, v103
    buffer_store_dwordx4 v[100:103], v2, s[36:39], s23 offen sc1
    s_waitcnt lgkmcnt(2)
    v_xor_b32 v104, s8, v104
    v_xor_b32 v105, s9, v105
    v_xor_b32 v106, s10, v106
    v_xor_b32 v107, s11, v107
    s_add_u32 s59, s23, 8192
    buffer_store_dwordx4 v[104:107], v2, s[36:39], s59 offen sc1
    s_waitcnt lgkmcnt(1)
    v_xor_b32 v108, s8, v108
    v_xor_b32 v109, s9, v109
    v_xor_b32 v110, s10, v110
    v_xor_b32 v111, s11, v111
    s_add_u32 s59, s23, 16384
    buffer_store_dwordx4 v[108:111], v2, s[36:39], s59 offen sc1
    s_waitcnt lgkmcnt(0)
    v_xor_b32 v112, s8, v112
    v_xor_b32 v113, s9, v113
    v_xor_b32 v114, s10, v114
    v_xor_b32 v115, s11, v115
    s_mov_b64 exec, s[66:67]
    s_add_u32 s59, s23, 24576
    buffer_store_dwordx4 v[112:115], v2, s[36:39], s59 offen sc1
    s_mov_b64 exec, -1
    ds_read_b64_tr_b16 v[36:37], v122 offset:0
    ds_read_b64_tr_b16 v[38:39], v122 offset:512
    ds_read_b64_tr_b16 v[40:41], v122 offset:4096
    ds_read_b64_tr_b16 v[42:43], v122 offset:4608
    ds_read_b64_tr_b16 v[44:45], v122 offset:32
    ds_read_b64_tr_b16 v[46:47], v122 offset:544
    ds_read_b64_tr_b16 v[48:49], v122 offset:4128
    ds_read_b64_tr_b16 v[50:51], v122 offset:4640
    ds_read_b64_tr_b16 v[52:53], v122 offset:64
    ds_read_b64_tr_b16 v[54:55], v122 offset:576
    ds_read_b64_tr_b16 v[56:57], v122 offset:4160
    ds_read_b64_tr_b16 v[58:59], v122 offset:4672
    ds_read_b64_tr_b16 v[60:61], v122 offset:96
    ds_read_b64_tr_b16 v[62:63], v122 offset:608
    ds_read_b64_tr_b16 v[64:65], v122 offset:4192
    ds_read_b64_tr_b16 v[66:67], v122 offset:4704
    v_and_b32 v250, -2, v1
    v_add_lshl_u32 v250, v250, v1, 7
    v_cmp_gt_u32 vcc, 10, v1
    s_nop 1
    v_cndmask_b32 v250, v118, v250, vcc
    s_mul_i32 s65, s2, 102400
    s_mul_i32 s63, s26, 12800
    s_add_u32 s65, s65, s63
    buffer_load_dword v158, v250, s[28:31], s65 offen offset:256
    v_mov_b32 v5, 0xbfb8aa3b
    v_mov_b32 v6, 1.0
    v_lshlrev_b32 v123, 9, v119
    v_lshl_add_u32 v123, v120, 3, v123
    s_lshl_b32 s27, s62, 7
    s_waitcnt lgkmcnt(0)
    s_barrier
    s_mul_i32 s20, s2, 102400
    s_mul_i32 s21, s26, 12800
    s_add_u32 s20, s20, s21
    s_add_u32 s20, s4, s20
    s_addc_u32 s21, s5, 0
    s_waitcnt vmcnt(23)
    s_cmp_gt_u32 s26, 4
    s_cbranch_scc0 P_np
    s_setprio 2
P_np:
    v_mfma_f32_16x16x32_bf16 v[68:71], v[20:23], v[36:39], 0
    v_mfma_f32_16x16x32_bf16 v[72:75], v[20:23], v[44:47], 0
    v_mfma_f32_16x16x32_bf16 v[76:79], v[20:23], v[52:55], 0
    v_mfma_f32_16x16x32_bf16 v[80:83], v[20:23], v[60:63], 0
    v_mfma_f32_16x16x32_bf16 v[68:71], v[24:27], v[40:43], v[68:71]
    v_mfma_f32_16x16x32_bf16 v[72:75], v[24:27], v[48:51], v[72:75]
    v_mfma_f32_16x16x32_bf16 v[76:79], v[24:27], v[56:59], v[76:79]
    v_mfma_f32_16x16x32_bf16 v[80:83], v[24:27], v[64:67], v[80:83]
    s_nop 4
    v_cvt_pk_bf16_f32 v68, 0, v68
    v_cvt_pk_bf16_f32 v69, 0, v69
    v_cvt_pk_bf16_f32 v70, 0, v70
    v_cvt_pk_bf16_f32 v71, 0, v71
    v_cvt_pk_bf16_f32 v72, 0, v72
    v_cvt_pk_bf16_f32 v73, 0, v73
    v_cvt_pk_bf16_f32 v74, 0, v74
    v_cvt_pk_bf16_f32 v75, 0, v75
    v_cvt_pk_bf16_f32 v76, 0, v76
    v_cvt_pk_bf16_f32 v77, 0, v77
    v_cvt_pk_bf16_f32 v78, 0, v78
WUP_721:
    s_cbranch_execz WUR_0
    v_cvt_pk_bf16_f32 v79, 0, v79
    v_cvt_pk_bf16_f32 v80, 0, v80
    v_cvt_pk_bf16_f32 v81, 0, v81
    v_cvt_pk_bf16_f32 v82, 0, v82
    v_cvt_pk_bf16_f32 v83, 0, v83
    v_mul_f32 v84, v5, v68
    v_mul_f32 v85, v5, v69
    v_mul_f32 v86, v5, v70
    v_mul_f32 v87, v5, v71
    v_mul_f32 v88, v5, v72
    v_mul_f32 v89, v5, v73
    v_mul_f32 v90, v5, v74
    v_mul_f32 v91, v5, v75
    v_mul_f32 v92, v5, v76
    v_mul_f32 v93, v5, v77
    v_mul_f32 v94, v5, v78
    v_mul_f32 v95, v5, v79
    v_mul_f32 v96, v5, v80
    v_mul_f32 v97, v5, v81
    v_mul_f32 v98, v5, v82
    v_mul_f32 v99, v5, v83
    v_exp_f32 v84, v84
    v_exp_f32 v85, v85
    v_exp_f32 v86, v86
    v_exp_f32 v87, v87
    v_exp_f32 v88, v88
    v_exp_f32 v89, v89
    v_exp_f32 v90, v90
    v_exp_f32 v91, v91
    v_exp_f32 v92, v92
    v_exp_f32 v93, v93
    v_exp_f32 v94, v94
    v_exp_f32 v95, v95
    v_exp_f32 v96, v96
    v_exp_f32 v97, v97
    v_exp_f32 v98, v98
    v_exp_f32 v99, v99
    v_add_f32 v84, v6, v84
    v_add_f32 v85, v6, v85
    v_add_f32 v86, v6, v86
    v_add_f32 v87, v6, v87
    v_add_f32 v88, v6, v88
    v_add_f32 v89, v6, v89
    v_add_f32 v90, v6, v90
    v_add_f32 v91, v6, v91
    v_add_f32 v92, v6, v92
    v_add_f32 v93, v6, v93
    v_add_f32 v94, v6, v94
    v_add_f32 v95, v6, v95
    v_add_f32 v96, v6, v96
    v_add_f32 v97, v6, v97
    v_add_f32 v98, v6, v98
    v_add_f32 v99, v6, v99
    v_rcp_f32 v84, v84
    v_rcp_f32 v85, v85
    v_rcp_f32 v86, v86
    v_rcp_f32 v87, v87
    v_rcp_f32 v88, v88
    v_rcp_f32 v89, v89
    v_rcp_f32 v90, v90
    v_rcp_f32 v91, v91
    v_rcp_f32 v92, v92
    v_rcp_f32 v93, v93
    v_rcp_f32 v94, v94
    v_rcp_f32 v95, v95
    v_rcp_f32 v96, v96
    v_rcp_f32 v97, v97
    v_rcp_f32 v98, v98
    v_rcp_f32 v99, v99
    v_mul_f32 v84, v68, v84
    v_mul_f32 v85, v69, v85
    v_mul_f32 v86, v70, v86
    v_mul_f32 v87, v71, v87
    v_mul_f32 v88, v72, v88
    v_mul_f32 v89, v73, v89
    v_mul_f32 v90, v74, v90
    v_mul_f32 v91, v75, v91
    v_mul_f32 v92, v76, v92
    v_mul_f32 v93, v77, v93
    v_mul_f32 v94, v78, v94
    v_mul_f32 v95, v79, v95
    v_mul_f32 v96, v80, v96
    v_mul_f32 v97, v81, v97
    v_mul_f32 v98, v82, v98
    v_mul_f32 v99, v83, v99
    s_mov_b32 s63, 0x830100
    s_cmp_gt_u32 s26, 4
    s_cselect_b32 s63, s63, 0x40000000
    buffer_load_dwordx4 v[236:239], v3, s[36:39], s63 offen sc1
    v_cvt_pk_bf16_f32 v68, v84, v88
    v_cvt_pk_bf16_f32 v69, v92, v96
    buffer_store_dwordx2 v[68:69], v123, s[72:75], s27 offen offset:0 sc1
    v_cvt_pk_bf16_f32 v70, v85, v89
    v_cvt_pk_bf16_f32 v71, v93, v97
    buffer_store_dwordx2 v[70:71], v123, s[72:75], s27 offen offset:128 sc1
    v_cvt_pk_bf16_f32 v72, v86, v90
    v_cvt_pk_bf16_f32 v73, v94, v98
    buffer_store_dwordx2 v[72:73], v123, s[72:75], s27 offen offset:256 sc1
    v_cvt_pk_bf16_f32 v74, v87, v91
    v_cvt_pk_bf16_f32 v75, v95, v99
    buffer_store_dwordx2 v[74:75], v123, s[72:75], s27 offen offset:384 sc1
    s_cmp_gt_u32 s26, 4
    s_cbranch_scc1 M_e4x
    s_cmp_eq_u32 s26, 4
    s_cselect_b32 s63, 2, 4
    v_cmp_gt_u32 vcc, s63, v119
    s_nop 1
    v_cndmask_b32 v7, v118, v123, vcc
    s_add_u32 s27, s27, 16384
    v_mfma_f32_16x16x32_bf16 v[68:71], v[28:31], v[36:39], 0
    v_mfma_f32_16x16x32_bf16 v[72:75], v[28:31], v[44:47], 0
    v_mfma_f32_16x16x32_bf16 v[76:79], v[28:31], v[52:55], 0
    v_mfma_f32_16x16x32_bf16 v[80:83], v[28:31], v[60:63], 0
    v_mfma_f32_16x16x32_bf16 v[68:71], v[32:35], v[40:43], v[68:71]
    v_mfma_f32_16x16x32_bf16 v[72:75], v[32:35], v[48:51], v[72:75]
    v_mfma_f32_16x16x32_bf16 v[76:79], v[32:35], v[56:59], v[76:79]
    v_mfma_f32_16x16x32_bf16 v[80:83], v[32:35], v[64:67], v[80:83]
    s_nop 4
    v_cvt_pk_bf16_f32 v68, 0, v68
    v_cvt_pk_bf16_f32 v69, 0, v69
    v_cvt_pk_bf16_f32 v70, 0, v70
    v_cvt_pk_bf16_f32 v71, 0, v71
    v_cvt_pk_bf16_f32 v72, 0, v72
    v_cvt_pk_bf16_f32 v73, 0, v73
    v_cvt_pk_bf16_f32 v74, 0, v74
    v_cvt_pk_bf16_f32 v75, 0, v75
    v_cvt_pk_bf16_f32 v76, 0, v76
    v_cvt_pk_bf16_f32 v77, 0, v77
    v_cvt_pk_bf16_f32 v78, 0, v78
    v_cvt_pk_bf16_f32 v79, 0, v79
    v_cvt_pk_bf16_f32 v80, 0, v80
    v_cvt_pk_bf16_f32 v81, 0, v81
    v_cvt_pk_bf16_f32 v82, 0, v82
    v_cvt_pk_bf16_f32 v83, 0, v83
    v_mul_f32 v84, v5, v68
    v_mul_f32 v85, v5, v69
    v_mul_f32 v86, v5, v70
    v_mul_f32 v87, v5, v71
    v_mul_f32 v88, v5, v72
    v_mul_f32 v89, v5, v73
    v_mul_f32 v90, v5, v74
    v_mul_f32 v91, v5, v75
    v_mul_f32 v92, v5, v76
    v_mul_f32 v93, v5, v77
    v_mul_f32 v94, v5, v78
    v_mul_f32 v95, v5, v79
    v_mul_f32 v96, v5, v80
    v_mul_f32 v97, v5, v81
    v_mul_f32 v98, v5, v82
    v_mul_f32 v99, v5, v83
    v_exp_f32 v84, v84
    v_exp_f32 v85, v85
    v_exp_f32 v86, v86
    v_exp_f32 v87, v87
    v_exp_f32 v88, v88
    v_exp_f32 v89, v89
    v_exp_f32 v90, v90
    v_exp_f32 v91, v91
    v_exp_f32 v92, v92
    v_exp_f32 v93, v93
    v_exp_f32 v94, v94
    v_exp_f32 v95, v95
    v_exp_f32 v96, v96
    v_exp_f32 v97, v97
    v_exp_f32 v98, v98
    v_exp_f32 v99, v99
    v_add_f32 v84, v6, v84
    v_add_f32 v85, v6, v85
    v_add_f32 v86, v6, v86
    v_add_f32 v87, v6, v87
    v_add_f32 v88, v6, v88
    v_add_f32 v89, v6, v89
    v_add_f32 v90, v6, v90
    v_add_f32 v91, v6, v91
    v_add_f32 v92, v6, v92
    v_add_f32 v93, v6, v93
    v_add_f32 v94, v6, v94
    v_add_f32 v95, v6, v95
    v_add_f32 v96, v6, v96
    v_add_f32 v97, v6, v97
    v_add_f32 v98, v6, v98
    v_add_f32 v99, v6, v99
    v_rcp_f32 v84, v84
    v_rcp_f32 v85, v85
    v_rcp_f32 v86, v86
    v_rcp_f32 v87, v87
    v_rcp_f32 v88, v88
    v_rcp_f32 v89, v89
    v_rcp_f32 v90, v90
    v_rcp_f32 v91, v91
    v_rcp_f32 v92, v92
    v_rcp_f32 v93, v93
    v_rcp_f32 v94, v94
    v_rcp_f32 v95, v95
    v_rcp_f32 v96, v96
    v_rcp_f32 v97, v97
    v_rcp_f32 v98, v98
    v_rcp_f32 v99, v99
    v_mul_f32 v84, v68, v84
    v_mul_f32 v85, v69, v85
    v_mul_f32 v86, v70, v86
    v_mul_f32 v87, v71, v87
    v_mul_f32 v88, v72, v88
    v_mul_f32 v89, v73, v89
    v_mul_f32 v90, v74, v90
    v_mul_f32 v91, v75, v91
    v_mul_f32 v92, v76, v92
    v_mul_f32 v93, v77, v93
    v_mul_f32 v94, v78, v94
    v_mul_f32 v95, v79, v95
    v_mul_f32 v96, v80, v96
    v_mul_f32 v97, v81, v97
    v_mul_f32 v98, v82, v98
WUP_934:
    s_cbranch_execz WUP_1119
    v_mul_f32 v99, v83, v99
    v_cvt_pk_bf16_f32 v68, v84, v88
    v_cvt_pk_bf16_f32 v69, v92, v96
    buffer_store_dwordx2 v[68:69], v7, s[72:75], s27 offen offset:0 sc1
    v_cvt_pk_bf16_f32 v70, v85, v89
    v_cvt_pk_bf16_f32 v71, v93, v97
    buffer_store_dwordx2 v[70:71], v7, s[72:75], s27 offen offset:128 sc1
    v_cvt_pk_bf16_f32 v72, v86, v90
    v_cvt_pk_bf16_f32 v73, v94, v98
    buffer_store_dwordx2 v[72:73], v7, s[72:75], s27 offen offset:256 sc1
    v_cvt_pk_bf16_f32 v74, v87, v91
    v_cvt_pk_bf16_f32 v75, v95, v99
    buffer_store_dwordx2 v[74:75], v7, s[72:75], s27 offen offset:384 sc1
    s_nop 0
P_h2:
    s_mov_b32 s56, 0x05040100
    s_mov_b32 s57, 0x07060302
    s_waitcnt vmcnt(14)
M_e5:
    s_lshr_b32 s60, s26, 2
    s_and_b32 s61, s26, 3
    s_lshl_b32 s60, s60, 3
    s_add_u32 s60, s60, s61
    s_lshl_b32 s60, s60, 10
    s_movk_i32 s61, 4096
    v_perm_b32 v148, v129, v128, s56
    v_perm_b32 v152, v129, v128, s57
    v_perm_b32 v149, v131, v130, s56
    v_perm_b32 v153, v131, v130, s57
    v_perm_b32 v150, v133, v132, s56
    v_perm_b32 v154, v133, v132, s57
    v_perm_b32 v151, v135, v134, s56
    v_perm_b32 v155, v135, v134, s57
    v_add_u32 v156, s60, v3
    v_add_u32 v157, s61, v156
    ds_write_b128 v156, v[148:151]
    ds_write_b128 v157, v[152:155]
    s_cmp_eq_u32 s26, 7
    s_cbranch_scc1 M_w2
    s_add_u32 s27, s26, 8
    s_lshr_b32 s60, s27, 2
    s_and_b32 s61, s27, 3
    s_lshl_b32 s60, s60, 3
    s_add_u32 s60, s60, s61
    s_lshl_b32 s60, s60, 10
    s_movk_i32 s61, 4096
    s_cmp_lt_u32 s26, 4
    s_cbranch_scc1 M_w1
    s_sub_u32 s60, s26, 4
    s_lshl_b32 s60, s60, 11
    s_add_u32 s60, s60, 24576
    s_movk_i32 s61, 1024
M_w1:
    v_perm_b32 v148, v137, v136, s56
    v_perm_b32 v152, v137, v136, s57
    v_perm_b32 v149, v139, v138, s56
    v_perm_b32 v153, v139, v138, s57
    v_perm_b32 v150, v141, v140, s56
    v_perm_b32 v154, v141, v140, s57
    v_perm_b32 v151, v143, v142, s56
    v_perm_b32 v155, v143, v142, s57
    v_add_u32 v156, s60, v3
    v_add_u32 v157, s61, v156
    ds_write_b128 v156, v[148:151]
    ds_write_b128 v157, v[152:155]
M_w2:
    s_cmp_ge_u32 s26, 4
    s_cbranch_scc1 M_t4
    v_bfe_i32 v148, v0, 0, 1
    v_mov_b32 v149, 0x01000c0c
    s_mov_b32 s63, 0x02020000
    v_and_or_b32 v148, v148, s63, v149
    v_add_u32 v149, s63, v148
    v_add_u32 v150, s63, v149
    v_perm_b32 v152, v145, v144, v148
    v_perm_b32 v153, v145, v144, v149
    v_perm_b32 v154, v145, v144, v150
    s_mov_b32 s60, 0x41800000
    v_mul_f32 v148, s60, v152
    v_mul_f32 v149, s60, v153
    v_mul_f32 v150, s60, v154
    v_cvt_flr_i32_f32 v148, v148
    v_cvt_flr_i32_f32 v149, v149
    v_cvt_flr_i32_f32 v150, v150
    v_sub_u32 v148, 4, v148
    v_sub_u32 v149, 4, v149
    v_sub_u32 v150, 2, v150
    v_and_b32 v148, 0xff, v148
    v_and_b32 v149, 0xff, v149
    v_and_b32 v150, 0xff, v150
    v_lshl_or_b32 v148, v149, 8, v148
    v_lshl_or_b32 v148, v150, 16, v148
    v_mov_b32 v149, 0x7f000000
    v_cmp_gt_u32 vcc, 200, v0
    s_nop 1
    v_cndmask_b32 v148, v149, v148, vcc
    v_lshlrev_b32 v150, 2, v0
    v_add_u32 v150, 133120, v150
    ds_write_b32 v150, v148
    v_lshlrev_b32 v150, 4, v0
    v_add_u32 v150, 135168, v150
    s_mov_b64 exec, vcc
    ds_write_b96 v150, v[152:154]
    s_mov_b64 exec, -1
    s_branch M_t8
M_t4:
    s_cmp_eq_u32 s26, 4
    s_cbranch_scc0 M_t5
    v_lshlrev_b32 v150, 2, v1
    v_add_u32 v151, 132864, v150
    v_mov_b32 v148, 0
    ds_write_b32 v151, v148
    v_mov_b32 v151, 132672
    ds_write_b32 v151, v148
    v_add_u32 v151, 132608, v150
    v_lshlrev_b32 v148, 16, v146
    s_mov_b64 exec, 0xffff
    ds_write_b32 v151, v148
    s_mov_b64 exec, -1
    s_branch M_t8
M_t5:
M_t8:
    v_lshrrev_b32 v24, 2, v1
    v_lshlrev_b32 v24, 15, v24
    v_and_b32 v25, 3, v1
    v_lshl_add_u32 v24, v25, 4, v24
    s_lshl_b32 s27, s26, 20
    s_lshl_b32 s53, s2, 7
    s_add_u32 s27, s27, s53
    s_add_u32 s53, s27, 524288
    s_mov_b64 s[60:61], -1
    s_cmp_eq_u32 s26, 7
    s_cselect_b32 s61, 0xff, s61
    s_xor_b32 s63, s8, 0xff000000
    v_mov_b32 v164, s63
    v_mov_b32 v172, s63
    s_xor_b32 s63, s9, 0xff000000
    v_mov_b32 v165, s63
    v_mov_b32 v173, s63
    s_xor_b32 s63, s10, 0xff000000
    v_mov_b32 v166, s63
    v_mov_b32 v174, s63
    s_xor_b32 s63, s11, 0xff000000
    v_mov_b32 v167, s63
    v_mov_b32 v175, s63
    buffer_load_dwordx4 v[160:163], v24, s[36:39], s27 offen sc1
    s_mov_b64 exec, s[60:61]
    buffer_load_dwordx4 v[164:167], v24, s[36:39], s53 offen sc1
    s_mov_b64 exec, -1
    buffer_load_dwordx4 v[168:171], v24, s[36:39], s27 offen offset:64 sc1
    s_mov_b64 exec, s[60:61]
    buffer_load_dwordx4 v[172:175], v24, s[36:39], s53 offen offset:64 sc1
    s_mov_b64 exec, -1
    v_lshlrev_b32 v1, 4, v1
    v_lshrrev_b32 v8, 4, v1
    v_lshrrev_b32 v10, 5, v8
    v_and_b32 v11, 31, v8
    s_mov_b32 s6, 0x186a000
    s_mov_b32 s7, 0x00020000
    s_mul_i32 s44, s2, 102400
    s_mul_i32 s51, s26, 12800
    s_add_u32 s51, s51, 30720
    s_mul_i32 s52, s26, 3840
    s_add_u32 s52, s52, 133120
    s_mov_b32 s67, 120320
    s_mov_b32 s3, 132864
    v_lshrrev_b32 v8, 4, v1
    v_lshrrev_b32 v10, 5, v8
    v_and_b32 v11, 31, v8
    v_lshlrev_b32 v3, 4, v11
    v_add_u32 v3, s52, v3
    v_mul_u32_u24 v0, 56, v10
    v_add_u32 v0, s52, v0
    v_lshrrev_b32 v13, 3, v11
    v_lshl_add_u32 v4, v13, 3, v0
    v_lshrrev_b32 v13, 3, v8
    v_and_b32 v14, 1, v13
    v_lshrrev_b32 v13, 1, v13
    v_lshl_add_u32 v13, v14, 2, v13
    v_lshlrev_b32 v5, 4, v13
    v_add_u32 v5, s52, v5
    v_add_u32 v16, s52, v1
    v_lshrrev_b32 v17, 2, v8
    v_mul_u32_u24 v17, 56, v17
    v_and_b32 v13, 3, v8
    v_lshl_add_u32 v17, v13, 1, v17
    v_add_u32 v17, s52, v17
    v_lshlrev_b32 v2, 7, v10
    v_lshl_add_u32 v2, v11, 2, v2
    v_add_u32 v2, s51, v2
    v_and_b32 v13, 7, v11
    v_lshlrev_b32 v13, 1, v13
WUP_1119:
    s_cbranch_execz WUR_0
    v_sub_u32 v13, 14, v13
    v_lshl_or_b32 v6, v13, 16, v13
    v_lshlrev_b32 v7, 5, v10
    v_add_u32 v7, 132608, v7
    v_lshlrev_b32 v20, 2, v8
    v_add_u32 v30, 132864, v20
    v_mov_b32 v9, 132672
    v_mov_b32 v18, 0xfc
    v_mov_b32 v19, 1
    s_mov_b32 s12, 0x1fffe
    s_movk_i32 s13, 130
    s_mov_b32 s14, 0xfc0000
    s_movk_i32 s15, 7800
    s_lshl_b32 s17, s26, 10
    s_add_u32 s17, s17, 138368
    s_mov_b32 s16, s17
    v_add_u32 v26, 134144, v20
    v_add_u32 v27, 134144, v1
    s_mov_b32 s62, 0xfe0001
    s_mov_b32 s65, 0
    s_waitcnt vmcnt(4)
    v_mov_b32 v148, 131084
    s_mov_b64 exec, 1
    ds_add_rtn_u32 v149, v148, v19
    s_lshl_b32 s63, s2, 2
    s_add_u32 s63, s63, 0x830800
    v_mov_b32 v150, s18
    v_mov_b32 v151, 0
    s_waitcnt lgkmcnt(0)
    v_readfirstlane_b32 s19, v149
    s_cmp_eq_u32 s19, 7
    s_cselect_b32 s63, s63, 0x40000000
    buffer_store_dword v150, v151, s[36:39], s63 offen sc1
    s_mov_b64 exec, -1
    s_waitcnt vmcnt(1)
    s_branch M_cw2
M_cw:
    s_waitcnt vmcnt(0)
M_cw2:
    v_xor_b32 v176, s8, v160
    v_xor_b32 v177, s9, v161
    v_xor_b32 v178, s10, v162
    v_xor_b32 v179, s11, v163
    v_xor_b32 v180, s8, v164
    v_xor_b32 v181, s9, v165
    v_xor_b32 v182, s10, v166
    v_xor_b32 v183, s11, v167
    v_xor_b32 v184, s8, v168
    v_xor_b32 v185, s9, v169
    v_xor_b32 v186, s10, v170
    v_xor_b32 v187, s11, v171
    v_xor_b32 v188, s8, v172
    v_xor_b32 v189, s9, v173
    v_xor_b32 v190, s10, v174
    v_xor_b32 v191, s11, v175
    v_or3_b32 v148, v176, v177, v178
    v_or3_b32 v148, v148, v179, v180
    v_or3_b32 v148, v148, v181, v182
    v_or3_b32 v148, v148, v183, v184
    v_or3_b32 v148, v148, v185, v186
    v_or3_b32 v148, v148, v187, v188
    v_or3_b32 v148, v148, v189, v190
    v_or_b32 v148, v148, v191
    v_and_b32 v148, s62, v148
    v_cmp_ne_u32 vcc, 0, v148
    s_nop 4
    s_cbranch_vccz M_cok
    s_add_u32 s65, s65, 1
    s_cmp_lt_u32 s65, 16384
    s_cbranch_scc0 M_cok
    s_sleep 4
    buffer_load_dwordx4 v[160:163], v24, s[36:39], s27 offen sc1
    s_mov_b64 exec, s[60:61]
    buffer_load_dwordx4 v[164:167], v24, s[36:39], s53 offen sc1
    s_mov_b64 exec, -1
    buffer_load_dwordx4 v[168:171], v24, s[36:39], s27 offen offset:64 sc1
    s_mov_b64 exec, s[60:61]
    buffer_load_dwordx4 v[172:175], v24, s[36:39], s53 offen offset:64 sc1
    s_mov_b64 exec, -1
    s_branch M_cw
M_cok:
    s_waitcnt lgkmcnt(0)
    s_barrier
M_f1:
    v_add_u32 v159, 10, v8
    v_and_b32 v157, -2, v159
    v_add_lshl_u32 v159, v157, v159, 7
    v_cmp_gt_u32 vcc, 20, v8
    v_bfrev_b32 v157, 2
    s_nop 0
    v_cndmask_b32 v159, v157, v159, vcc
    s_mul_i32 s27, s26, 12800
    s_add_u32 s27, s27, s44
    buffer_load_dword v63, v159, s[28:31], s27 offen offset:256
    v_and_b32 v64, s12, v176
    v_alignbit_b32 v65, s13, v176, 22
    ds_read_u16 v64, v64 offset:30720
    ds_read_b32 v65, v65
    v_and_b32 v66, s12, v177
    v_alignbit_b32 v67, s13, v177, 22
    ds_read_u16 v66, v66 offset:30720
    ds_read_b32 v67, v67
    v_and_b32 v68, s12, v178
    v_alignbit_b32 v69, s13, v178, 22
    ds_read_u16 v68, v68 offset:30720
    ds_read_b32 v69, v69
    v_and_b32 v70, s12, v179
    v_alignbit_b32 v71, s13, v179, 22
    ds_read_u16 v70, v70 offset:30720
    ds_read_b32 v71, v71
    v_and_b32 v72, s12, v180
    v_alignbit_b32 v73, s13, v180, 22
    ds_read_u16 v72, v72 offset:30720
    ds_read_b32 v73, v73
    v_and_b32 v74, s12, v181
    v_alignbit_b32 v75, s13, v181, 22
    ds_read_u16 v74, v74 offset:30720
    ds_read_b32 v75, v75
    v_and_b32 v76, s12, v182
    v_alignbit_b32 v77, s13, v182, 22
    ds_read_u16 v76, v76 offset:30720
    ds_read_b32 v77, v77
    v_and_b32 v78, s12, v183
    v_alignbit_b32 v79, s13, v183, 22
    ds_read_u16 v78, v78 offset:30720
    ds_read_b32 v79, v79
    s_mov_b32 s63, 0xc8000000
    s_lshl_b32 s59, s26, 11
    s_add_u32 s59, s59, 146560
    s_mov_b32 s60, s59
    v_cmp_gt_u32 s[54:55], s63, v184
    s_nop 1
    v_mbcnt_lo_u32_b32 v148, s54, 0
    v_mbcnt_hi_u32_b32 v148, s55, v148
    v_lshl_add_u32 v148, v148, 4, s60
    s_bcnt1_i32_b64 s27, s[54:55]
    s_lshl4_add_u32 s60, s27, s60
    v_cndmask_b32 v148, v27, v148, s[54:55]
    ds_write_b128 v148, v[184:187]
    v_cmp_gt_u32 s[54:55], s63, v188
    s_nop 1
    v_mbcnt_lo_u32_b32 v148, s54, 0
    v_mbcnt_hi_u32_b32 v148, s55, v148
    v_lshl_add_u32 v148, v148, 4, s60
    s_bcnt1_i32_b64 s27, s[54:55]
    s_lshl4_add_u32 s60, s27, s60
    v_cndmask_b32 v148, v27, v148, s[54:55]
    ds_write_b128 v148, v[188:191]
    s_mov_b32 s63, 0xff000000
    v_cmp_lt_u32 s[68:69], s63, v187
    v_cmp_lt_u32 s[70:71], s63, v191
    s_waitcnt lgkmcnt(10)
    v_and_b32 v96, 0x0707, v64
    v_and_b32 v97, 0x0707, v66
    v_and_b32 v98, 0x0707, v68
WUP_1270:
    s_cbranch_execz WUP_1431
    v_and_b32 v99, 0x0707, v70
    v_and_b32 v64, 0xf8f8, v64
    v_and_b32 v66, 0xf8f8, v66
    v_and_b32 v68, 0xf8f8, v68
    v_and_b32 v70, 0xf8f8, v70
    v_mul_u32_u24 v96, 0x200400, v96
    v_mul_u32_u24 v97, 0x200400, v97
    v_mul_u32_u24 v98, 0x200400, v98
    v_mul_u32_u24 v99, 0x200400, v99
    v_and_or_b32 v64, v96, s14, v64
    v_and_or_b32 v66, v97, s14, v66
    v_and_or_b32 v68, v98, s14, v68
    v_and_or_b32 v70, v99, s14, v70
    v_add_u32 v64, v64, v65
    v_add_u32 v66, v66, v67
    v_add_u32 v68, v68, v69
    v_add_u32 v70, v70, v71
    v_dot4_i32_i8 v64, v64, v64, 0
    v_dot4_i32_i8 v66, v66, v66, 0
    v_dot4_i32_i8 v68, v68, v68, 0
    v_dot4_i32_i8 v70, v70, v70, 0
    v_cmp_gt_i32 s[40:41], s15, v64
    v_cmp_gt_i32 s[42:43], s15, v66
    v_cmp_gt_i32 s[46:47], s15, v68
    v_cmp_gt_i32 s[54:55], s15, v70
    v_mbcnt_lo_u32_b32 v96, s40, 0
    v_mbcnt_lo_u32_b32 v97, s42, 0
    v_mbcnt_lo_u32_b32 v98, s46, 0
    v_mbcnt_lo_u32_b32 v99, s54, 0
    v_mbcnt_hi_u32_b32 v96, s41, v96
    v_mbcnt_hi_u32_b32 v97, s43, v97
    v_mbcnt_hi_u32_b32 v98, s47, v98
    v_mbcnt_hi_u32_b32 v99, s55, v99
    v_lshl_add_u32 v96, v96, 2, s16
    s_bcnt1_i32_b64 s27, s[40:41]
    s_lshl2_add_u32 s16, s27, s16
    v_lshl_add_u32 v97, v97, 2, s16
    s_bcnt1_i32_b64 s27, s[42:43]
    s_lshl2_add_u32 s16, s27, s16
    v_lshl_add_u32 v98, v98, 2, s16
    s_bcnt1_i32_b64 s27, s[46:47]
    s_lshl2_add_u32 s16, s27, s16
    v_lshl_add_u32 v99, v99, 2, s16
    s_bcnt1_i32_b64 s27, s[54:55]
    s_lshl2_add_u32 s16, s27, s16
    v_cndmask_b32 v96, v26, v96, s[40:41]
    ds_write_b32 v96, v176
    v_cndmask_b32 v97, v26, v97, s[42:43]
    ds_write_b32 v97, v177
    v_cndmask_b32 v98, v26, v98, s[46:47]
    ds_write_b32 v98, v178
    v_cndmask_b32 v99, v26, v99, s[54:55]
    ds_write_b32 v99, v179
    s_waitcnt lgkmcnt(6)
    v_and_b32 v100, 0x0707, v72
    v_and_b32 v101, 0x0707, v74
    v_and_b32 v102, 0x0707, v76
    v_and_b32 v103, 0x0707, v78
    v_and_b32 v72, 0xf8f8, v72
    v_and_b32 v74, 0xf8f8, v74
    v_and_b32 v76, 0xf8f8, v76
    v_and_b32 v78, 0xf8f8, v78
    v_mul_u32_u24 v100, 0x200400, v100
    v_mul_u32_u24 v101, 0x200400, v101
    v_mul_u32_u24 v102, 0x200400, v102
    v_mul_u32_u24 v103, 0x200400, v103
    v_and_or_b32 v72, v100, s14, v72
    v_and_or_b32 v74, v101, s14, v74
    v_and_or_b32 v76, v102, s14, v76
    v_and_or_b32 v78, v103, s14, v78
    v_add_u32 v72, v72, v73
    v_add_u32 v74, v74, v75
    v_add_u32 v76, v76, v77
    v_add_u32 v78, v78, v79
    v_dot4_i32_i8 v72, v72, v72, 0
    v_dot4_i32_i8 v74, v74, v74, 0
    v_dot4_i32_i8 v76, v76, v76, 0
    v_dot4_i32_i8 v78, v78, v78, 0
    v_cmp_gt_i32 s[40:41], s15, v72
    v_cmp_gt_i32 s[42:43], s15, v74
    v_cmp_gt_i32 s[46:47], s15, v76
    v_cmp_gt_i32 s[54:55], s15, v78
    v_mbcnt_lo_u32_b32 v100, s40, 0
    v_mbcnt_lo_u32_b32 v101, s42, 0
    v_mbcnt_lo_u32_b32 v102, s46, 0
    v_mbcnt_lo_u32_b32 v103, s54, 0
    v_mbcnt_hi_u32_b32 v100, s41, v100
    v_mbcnt_hi_u32_b32 v101, s43, v101
    v_mbcnt_hi_u32_b32 v102, s47, v102
    v_mbcnt_hi_u32_b32 v103, s55, v103
    v_lshl_add_u32 v100, v100, 2, s16
    s_bcnt1_i32_b64 s27, s[40:41]
    s_lshl2_add_u32 s16, s27, s16
    v_lshl_add_u32 v101, v101, 2, s16
    s_bcnt1_i32_b64 s27, s[42:43]
    s_lshl2_add_u32 s16, s27, s16
    v_lshl_add_u32 v102, v102, 2, s16
    s_bcnt1_i32_b64 s27, s[46:47]
    s_lshl2_add_u32 s16, s27, s16
    v_lshl_add_u32 v103, v103, 2, s16
    s_bcnt1_i32_b64 s27, s[54:55]
    s_lshl2_add_u32 s16, s27, s16
    v_cndmask_b32 v100, v26, v100, s[40:41]
    ds_write_b32 v100, v180
    v_cndmask_b32 v101, v26, v101, s[42:43]
    ds_write_b32 v101, v181
    v_cndmask_b32 v102, v26, v102, s[46:47]
    ds_write_b32 v102, v182
    v_cndmask_b32 v103, v26, v103, s[54:55]
    ds_write_b32 v103, v183
    s_sub_u32 s60, s60, s59
    v_add_u32 v149, s59, v20
    v_mov_b32 v150, 0xff000000
    s_nop 1
M_pc:
    s_cmp_eq_u32 s60, 0
    s_cbranch_scc1 M_pcd
    s_waitcnt lgkmcnt(0)
    ds_read_b32 v148, v149
    v_cmp_gt_u32 vcc, s60, v20
    s_waitcnt lgkmcnt(0)
    s_nop 0
    v_cndmask_b32 v148, v150, v148, vcc
    v_and_b32 v64, s12, v148
    v_alignbit_b32 v65, s13, v148, 22
    ds_read_u16 v64, v64 offset:30720
    ds_read_b32 v65, v65
    s_waitcnt lgkmcnt(0)
    v_and_b32 v96, 0x0707, v64
    v_and_b32 v64, 0xf8f8, v64
    v_mul_u32_u24 v96, 0x200400, v96
    v_and_or_b32 v64, v96, s14, v64
    v_add_u32 v64, v64, v65
    v_dot4_i32_i8 v64, v64, v64, 0
    s_nop 2
    v_cmp_gt_i32 s[40:41], s15, v64
    s_nop 1
    v_mbcnt_lo_u32_b32 v96, s40, 0
    v_mbcnt_hi_u32_b32 v96, s41, v96
    v_lshl_add_u32 v96, v96, 2, s16
    s_bcnt1_i32_b64 s27, s[40:41]
    s_lshl2_add_u32 s16, s27, s16
    v_cndmask_b32 v96, v26, v96, s[40:41]
    ds_write_b32 v96, v148
    v_add_u32 v149, 256, v149
    s_min_u32 s27, s60, 256
    s_sub_u32 s60, s60, s27
    s_sub_u32 s27, s16, s17
    s_cmp_gt_u32 s27, 1024
    s_cbranch_scc0 M_pc
M_pcd:
    s_or_b64 s[54:55], s[68:69], s[70:71]
    s_cmp_eq_u64 s[54:55], 0
    s_cbranch_scc0 M_mdx
M_mdd:
    s_sub_u32 s19, s16, s17
    s_lshr_b32 s19, s19, 2
    s_cmp_le_u32 s19, 256
    s_cbranch_scc1 M_c1
    ds_write_b32 v9, v19
    s_movk_i32 s19, 256
M_c1:
    v_add_u32 v148, s17, v20
    s_waitcnt lgkmcnt(0)
    ds_read_b32 v64, v148 offset:0
WUP_1431:
    s_cbranch_execz WUR_0
    ds_read_b32 v68, v148 offset:256
    ds_read_b32 v72, v148 offset:512
    ds_read_b32 v76, v148 offset:768
    s_mov_b32 s27, s19
    v_cmp_gt_i32 s[8:9], s27, v8
    s_sub_u32 s27, s19, 64
    v_cmp_gt_i32 s[10:11], s27, v8
    s_sub_u32 s27, s19, 128
    v_cmp_gt_i32 s[14:15], s27, v8
    s_sub_u32 s27, s19, 192
    v_cmp_gt_i32 s[16:17], s27, v8
    s_mov_b32 s63, 0x02020000
    s_mov_b32 s64, 0x322bcc77
    s_mov_b32 s62, 0x409d0000
    v_mov_b32 v149, 0x01000c0c
    v_bfrev_b32 v14, 2
    s_waitcnt lgkmcnt(0)
    v_and_b32 v150, s12, v64
    v_alignbit_b32 v151, 33, v64, 20
    v_lshl_add_u32 v150, v150, 1, v150
    ds_read_b96 v[40:42], v151
    v_and_b32 v150, -4, v150
    v_cndmask_b32 v150, v14, v150, s[8:9]
    buffer_load_dwordx2 v[32:33], v150, s[92:95], 0 offen
    v_bfe_i32 v56, v64, 1, 1
    v_and_or_b32 v56, v56, s63, v149
    s_cmp_le_u32 s19, 64
    s_nop 0
    s_cbranch_scc1 M_s2a
    v_and_b32 v150, s12, v68
    v_alignbit_b32 v151, 33, v68, 20
    v_lshl_add_u32 v150, v150, 1, v150
    ds_read_b96 v[44:46], v151
    v_and_b32 v150, -4, v150
    v_cndmask_b32 v150, v14, v150, s[10:11]
    buffer_load_dwordx2 v[34:35], v150, s[92:95], 0 offen
    v_bfe_i32 v57, v68, 1, 1
    v_and_or_b32 v57, v57, s63, v149
    s_cmp_le_u32 s19, 128
    s_nop 0
    s_cbranch_scc1 M_s2a
    v_and_b32 v150, s12, v72
    v_alignbit_b32 v151, 33, v72, 20
    v_lshl_add_u32 v150, v150, 1, v150
    ds_read_b96 v[48:50], v151
    v_and_b32 v150, -4, v150
    v_cndmask_b32 v150, v14, v150, s[14:15]
    buffer_load_dwordx2 v[36:37], v150, s[92:95], 0 offen
    v_bfe_i32 v58, v72, 1, 1
    v_and_or_b32 v58, v58, s63, v149
    s_cmp_le_u32 s19, 192
    s_nop 0
    s_cbranch_scc1 M_s2a
    v_and_b32 v150, s12, v76
    v_alignbit_b32 v151, 33, v76, 20
    v_lshl_add_u32 v150, v150, 1, v150
    ds_read_b96 v[52:54], v151
    v_and_b32 v150, -4, v150
    v_cndmask_b32 v150, v14, v150, s[16:17]
    buffer_load_dwordx2 v[38:39], v150, s[92:95], 0 offen
    v_bfe_i32 v59, v76, 1, 1
    v_and_or_b32 v59, v59, s63, v149
    s_nop 1
M_s2a:
    s_waitcnt vmcnt(0) lgkmcnt(0)
    v_add_u32 v151, s63, v56
    v_perm_b32 v148, v33, v32, v56
    v_add_u32 v152, s63, v151
    v_perm_b32 v149, v33, v32, v151
    v_perm_b32 v150, v33, v32, v152
    v_sub_f32 v148, v148, v40
    v_sub_f32 v149, v149, v41
    v_sub_f32 v150, v150, v42
    v_cvt_pk_bf16_f32 v65, v148, v149
    v_cvt_pk_bf16_f32 v150, 0, v150
    v_lshlrev_b32 v148, 16, v65
    v_and_b32 v149, s58, v65
    v_mul_f32 v153, v150, v150
    v_mul_f32 v148, v148, v148
    v_mul_f32 v149, v149, v149
    v_cvt_pk_bf16_f32 v153, 0, v153
    v_cvt_pk_bf16_f32 v148, 0, v148
    v_cvt_pk_bf16_f32 v149, 0, v149
    v_add_f32 v148, v148, v149
    v_add_f32 v148, v148, v153
    v_cvt_pk_bf16_f32 v148, 0, v148
    v_add_f32 v148, s64, v148
    v_cvt_pk_bf16_f32 v148, 0, v148
    v_sqrt_f32 v148, v148
    s_nop 0
    v_cvt_pk_bf16_f32 v66, v150, v148
    v_cmp_gt_u32 vcc, s62, v66
    s_and_b64 s[8:9], s[8:9], vcc
    v_lshrrev_b32 v96, 24, v64
    v_lshrrev_b32 v120, 21, v64
    v_and_b32 v120, 16, v120
    v_lshlrev_b32 v112, v120, v19
    v_and_or_b32 v96, v96, v18, s3
    s_mov_b64 exec, s[8:9]
    s_nop 0
    s_cbranch_execz M_sa1
    ds_add_rtn_u32 v112, v96, v112
M_sa1:
    s_mov_b64 exec, -1
    s_cmp_le_u32 s19, 64
    s_cbranch_scc1 M_s2b
    v_add_u32 v151, s63, v57
    v_perm_b32 v148, v35, v34, v57
    v_add_u32 v152, s63, v151
    v_perm_b32 v149, v35, v34, v151
    v_perm_b32 v150, v35, v34, v152
    v_sub_f32 v148, v148, v44
    v_sub_f32 v149, v149, v45
    v_sub_f32 v150, v150, v46
    v_cvt_pk_bf16_f32 v69, v148, v149
    v_cvt_pk_bf16_f32 v150, 0, v150
    v_lshlrev_b32 v148, 16, v69
    v_and_b32 v149, s58, v69
    v_mul_f32 v153, v150, v150
    v_mul_f32 v148, v148, v148
    v_mul_f32 v149, v149, v149
    v_cvt_pk_bf16_f32 v153, 0, v153
    v_cvt_pk_bf16_f32 v148, 0, v148
    v_cvt_pk_bf16_f32 v149, 0, v149
    v_add_f32 v148, v148, v149
    v_add_f32 v148, v148, v153
    v_cvt_pk_bf16_f32 v148, 0, v148
    v_add_f32 v148, s64, v148
    v_cvt_pk_bf16_f32 v148, 0, v148
    v_sqrt_f32 v148, v148
    s_nop 0
    v_cvt_pk_bf16_f32 v70, v150, v148
    v_cmp_gt_u32 vcc, s62, v70
    s_and_b64 s[10:11], s[10:11], vcc
    v_lshrrev_b32 v97, 24, v68
    v_lshrrev_b32 v121, 21, v68
    v_and_b32 v121, 16, v121
    v_lshlrev_b32 v113, v121, v19
    v_and_or_b32 v97, v97, v18, s3
    s_mov_b64 exec, s[10:11]
    s_nop 0
    s_cbranch_execz M_sa2
    ds_add_rtn_u32 v113, v97, v113
M_sa2:
    s_mov_b64 exec, -1
    s_cmp_le_u32 s19, 128
    s_cbranch_scc1 M_s2b
    v_add_u32 v151, s63, v58
    v_perm_b32 v148, v37, v36, v58
    v_add_u32 v152, s63, v151
    v_perm_b32 v149, v37, v36, v151
    v_perm_b32 v150, v37, v36, v152
    v_sub_f32 v148, v148, v48
    v_sub_f32 v149, v149, v49
    v_sub_f32 v150, v150, v50
    v_cvt_pk_bf16_f32 v73, v148, v149
    v_cvt_pk_bf16_f32 v150, 0, v150
    v_lshlrev_b32 v148, 16, v73
    v_and_b32 v149, s58, v73
    v_mul_f32 v153, v150, v150
    v_mul_f32 v148, v148, v148
    v_mul_f32 v149, v149, v149
    v_cvt_pk_bf16_f32 v153, 0, v153
    v_cvt_pk_bf16_f32 v148, 0, v148
    v_cvt_pk_bf16_f32 v149, 0, v149
    v_add_f32 v148, v148, v149
    v_add_f32 v148, v148, v153
    v_cvt_pk_bf16_f32 v148, 0, v148
    v_add_f32 v148, s64, v148
    v_cvt_pk_bf16_f32 v148, 0, v148
    v_sqrt_f32 v148, v148
    s_nop 0
    v_cvt_pk_bf16_f32 v74, v150, v148
    v_cmp_gt_u32 vcc, s62, v74
    s_and_b64 s[14:15], s[14:15], vcc
    v_lshrrev_b32 v98, 24, v72
    v_lshrrev_b32 v122, 21, v72
    v_and_b32 v122, 16, v122
    v_lshlrev_b32 v114, v122, v19
WUP_1607:
    s_cbranch_execz WUP_1795
    v_and_or_b32 v98, v98, v18, s3
    s_mov_b64 exec, s[14:15]
    s_nop 0
    s_cbranch_execz M_sa3
    ds_add_rtn_u32 v114, v98, v114
M_sa3:
    s_mov_b64 exec, -1
    s_cmp_le_u32 s19, 192
    s_cbranch_scc1 M_s2b
    v_add_u32 v151, s63, v59
    v_perm_b32 v148, v39, v38, v59
    v_add_u32 v152, s63, v151
    v_perm_b32 v149, v39, v38, v151
    v_perm_b32 v150, v39, v38, v152
    v_sub_f32 v148, v148, v52
    v_sub_f32 v149, v149, v53
    v_sub_f32 v150, v150, v54
    v_cvt_pk_bf16_f32 v77, v148, v149
    v_cvt_pk_bf16_f32 v150, 0, v150
    v_lshlrev_b32 v148, 16, v77
    v_and_b32 v149, s58, v77
    v_mul_f32 v153, v150, v150
    v_mul_f32 v148, v148, v148
    v_mul_f32 v149, v149, v149
    v_cvt_pk_bf16_f32 v153, 0, v153
    v_cvt_pk_bf16_f32 v148, 0, v148
    v_cvt_pk_bf16_f32 v149, 0, v149
    v_add_f32 v148, v148, v149
    v_add_f32 v148, v148, v153
    v_cvt_pk_bf16_f32 v148, 0, v148
    v_add_f32 v148, s64, v148
    v_cvt_pk_bf16_f32 v148, 0, v148
    v_sqrt_f32 v148, v148
    s_nop 0
    v_cvt_pk_bf16_f32 v78, v150, v148
    v_cmp_gt_u32 vcc, s62, v78
    s_and_b64 s[16:17], s[16:17], vcc
    v_lshrrev_b32 v99, 24, v76
    v_lshrrev_b32 v123, 21, v76
    v_and_b32 v123, 16, v123
    v_lshlrev_b32 v115, v123, v19
    v_and_or_b32 v99, v99, v18, s3
    s_mov_b64 exec, s[16:17]
    s_nop 0
    s_cbranch_execz M_sa4
    ds_add_rtn_u32 v115, v99, v115
M_sa4:
    s_mov_b64 exec, -1
M_s2b:
    s_mov_b32 s61, 0x3e22f983
    s_movk_i32 s63, 0x70
    s_movk_i32 s64, 128
    s_movk_i32 s65, 256
    s_movk_i32 s66, 384
    v_lshrrev_b32 v21, 4, v8
    v_lshlrev_b32 v21, 9, v21
    v_and_b32 v22, 15, v8
    v_lshl_or_b32 v21, v22, 4, v21
    s_lshl_b32 s45, s26, 10
    s_add_u32 s45, s45, 30720
    s_lshl_b32 s46, s26, 11
    s_add_u32 s46, s46, s44
    s_waitcnt lgkmcnt(0)
    s_barrier
    s_cmp_eq_u32 s26, 6
    s_cbranch_scc0 M_h1
    s_mov_b32 s53, 0x830800
    buffer_load_dwordx4 v[148:151], v1, s[36:39], s53 offen sc1
M_h1:
    s_add_u32 m0, s45, 0
    s_add_u32 s53, s46, 0
    buffer_load_dwordx4 v21, s[28:31], s53 offen  lds
    s_add_u32 m0, s45, 8192
    s_add_u32 s53, s46, 16384
    buffer_load_dwordx4 v21, s[28:31], s53 offen  lds
    s_add_u32 m0, s45, 16384
    s_add_u32 s53, s46, 32768
    buffer_load_dwordx4 v21, s[28:31], s53 offen  lds
    s_add_u32 m0, s45, 24576
    s_add_u32 s53, s46, 49152
    buffer_load_dwordx4 v21, s[28:31], s53 offen  lds
    s_add_u32 m0, s45, 32768
    s_add_u32 s53, s46, 65536
    buffer_load_dwordx4 v21, s[28:31], s53 offen  lds
    s_add_u32 m0, s45, 40960
    s_add_u32 s53, s46, 81920
    buffer_load_dwordx4 v21, s[28:31], s53 offen  lds
    s_cmp_ge_u32 s26, 2
    s_cbranch_scc1 M_rs11
    s_add_u32 m0, s45, 49152
    s_add_u32 s53, s46, 98304
    buffer_load_dwordx4 v21, s[28:31], s53 offen  lds
M_rs11:
    ds_read_b32 v28, v30
    ds_read_b32 v13, v9
    s_waitcnt lgkmcnt(1)
    v_and_b32 v31, 0xffff, v28
    v_lshrrev_b32 v28, 16, v28
    v_add_u32 v28, v28, v31
    v_mov_b32 v29, v28
    s_nop 1
    v_add_u32_dpp v29, v29, v29 row_shr:1 row_mask:0xf bank_mask:0xf bound_ctrl:0
    s_nop 1
    v_add_u32_dpp v29, v29, v29 row_shr:2 row_mask:0xf bank_mask:0xf bound_ctrl:0
    s_nop 1
    v_add_u32_dpp v29, v29, v29 row_shr:4 row_mask:0xf bank_mask:0xf bound_ctrl:0
    s_nop 1
    v_add_u32_dpp v29, v29, v29 row_shr:8 row_mask:0xf bank_mask:0xf bound_ctrl:0
    s_nop 1
    v_add_u32_dpp v29, v29, v29 row_bcast:15 row_mask:0xa bank_mask:0xf
    s_nop 1
    v_add_u32_dpp v29, v29, v29 row_bcast:31 row_mask:0xc bank_mask:0xf
    v_sub_u32 v28, v29, v28
    v_add_u32 v31, v28, v31
    v_lshl_or_b32 v28, v31, 16, v28
    ds_bpermute_b32 v104, v96, v28
    ds_bpermute_b32 v105, v97, v28
    ds_bpermute_b32 v106, v98, v28
    ds_bpermute_b32 v107, v99, v28
    v_readlane_b32 s62, v29, 63
    s_mov_b32 s54, 0
    s_mov_b32 s55, 0
    s_xor_b32 s12, s26, 4
    s_cmp_gt_u32 s62, 480
    s_cselect_b32 s27, 96, 64
    v_cmp_ge_u32 vcc, s27, v29
    v_cmp_ge_u32 s[70:71], s27, v31
    s_bcnt1_i32_b64 s56, vcc
    s_bcnt1_i32_b64 s57, s[70:71]
    s_add_u32 s56, s56, s57
    s_min_u32 s56, s56, 16
    s_lshr_b32 s27, s56, 1
    s_and_b32 s69, s56, 1
    v_readlane_b32 s57, v28, s27
    s_lshl4_add_u32 s69, s69, 0x100000
    s_bfe_u32 s57, s57, s69
    s_waitcnt lgkmcnt(0)
    v_readfirstlane_b32 s46, v13
    v_add_u32 v104, v104, v112
    v_bfe_u32 v104, v104, v120, 16
    v_cmp_gt_u32 vcc, 768, v104
    v_lshl_add_u32 v104, v104, 4, s67
    s_and_b64 exec, vcc, s[8:9]
    s_nop 2
    s_cbranch_execz M_sb12
    ds_write_b96 v104, v[64:66]
M_sb12:
    s_mov_b64 exec, -1
    s_cmp_le_u32 s19, 64
    s_cbranch_scc1 M_s2c
    v_add_u32 v105, v105, v113
    v_bfe_u32 v105, v105, v121, 16
    v_cmp_gt_u32 vcc, 768, v105
    v_lshl_add_u32 v105, v105, 4, s67
    s_and_b64 exec, vcc, s[10:11]
    s_nop 2
    s_cbranch_execz M_sb13
    ds_write_b96 v105, v[68:70]
M_sb13:
    s_mov_b64 exec, -1
    s_cmp_le_u32 s19, 128
    s_cbranch_scc1 M_s2c
    v_add_u32 v106, v106, v114
    v_bfe_u32 v106, v106, v122, 16
    v_cmp_gt_u32 vcc, 768, v106
    v_lshl_add_u32 v106, v106, 4, s67
    s_and_b64 exec, vcc, s[14:15]
    s_nop 2
    s_cbranch_execz M_sb14
    ds_write_b96 v106, v[72:74]
M_sb14:
    s_mov_b64 exec, -1
    s_cmp_le_u32 s19, 192
    s_cbranch_scc1 M_s2c
    v_add_u32 v107, v107, v115
    v_bfe_u32 v107, v107, v123, 16
    v_cmp_gt_u32 vcc, 768, v107
    v_lshl_add_u32 v107, v107, 4, s67
    s_and_b64 exec, vcc, s[16:17]
    s_nop 2
    s_cbranch_execz M_sb15
    ds_write_b96 v107, v[76:78]
M_sb15:
    s_mov_b64 exec, -1
M_s2c:
    s_cmp_eq_u32 s26, 6
    s_cbranch_scc0 M_h3
    s_mov_b32 s27, 0
    v_cmp_gt_u32 s[8:9], 63, v8
    v_cmp_eq_u32 s[10:11], 62, v8
    s_waitcnt vmcnt(6)
    s_nop 3
M_h2:
    v_cndmask_b32 v150, v150, v148, s[10:11]
    v_cndmask_b32 v151, v151, v148, s[10:11]
    v_xor_b32 v148, s18, v148
    v_xor_b32 v149, s18, v149
    v_xor_b32 v150, s18, v150
    v_xor_b32 v151, s18, v151
WUP_1795:
    s_cbranch_execz WUR_0
    v_or3_b32 v148, v148, v149, v150
    v_or_b32 v148, v148, v151
    v_cmp_ne_u32 vcc, 0, v148
    s_and_b64 vcc, vcc, s[8:9]
    s_cbranch_vccz M_h3
    s_add_u32 s27, s27, 1
    s_cmp_lt_u32 s27, 16384
    s_cbranch_scc0 M_h3
    s_sleep 2
    s_mov_b32 s53, 0x830800
    buffer_load_dwordx4 v[148:151], v1, s[36:39], s53 offen sc1
    s_waitcnt vmcnt(0)
    s_branch M_h2
M_h3:
    s_cmp_eq_u32 s2, 0
    s_cbranch_scc0 M_h4
    s_cmp_eq_u32 s26, 5
    s_cbranch_scc0 M_h4
    s_mov_b32 s27, 0x830000
    v_mov_b32 v148, s18
    v_mov_b32 v149, 0
    s_mov_b64 exec, 1
    buffer_store_dword v148, v149, s[36:39], s27 offen sc1
    s_mov_b64 exec, -1
M_h4:
    s_waitcnt lgkmcnt(0)
    s_barrier
    s_cmp_eq_u32 s12, 0
    s_cbranch_scc1 M_cut
    s_sub_u32 s27, s57, s55
    s_cmp_gt_u32 s27, 64
    s_cselect_b32 s40, 64, 96
    s_mov_b32 s54, s56
    s_mov_b32 s55, s57
    s_sub_u32 s27, s62, s55
    s_cmp_gt_u32 s27, 420
    s_cselect_b32 s27, 96, 64
    s_add_u32 s27, s27, s55
    v_cmp_ge_u32 vcc, s27, v29
    v_cmp_ge_u32 s[70:71], s27, v31
    s_bcnt1_i32_b64 s56, vcc
    s_bcnt1_i32_b64 s57, s[70:71]
    s_add_u32 s27, s54, 16
    s_add_u32 s56, s56, s57
    s_min_u32 s56, s56, s27
    s_min_u32 s56, s56, 100
    s_max_u32 s56, s56, 4
    s_lshr_b32 s27, s56, 1
    s_and_b32 s69, s56, 1
    v_readlane_b32 s57, v28, s27
    s_lshl4_add_u32 s69, s69, 0x100000
    s_bfe_u32 s57, s57, s69
    s_cmp_eq_u32 s12, 1
    s_cbranch_scc1 M_cut
    s_sub_u32 s27, s57, s55
    s_cmp_gt_u32 s27, 64
    s_cselect_b32 s41, 64, 96
    s_mov_b32 s54, s56
    s_mov_b32 s55, s57
    s_sub_u32 s27, s62, s55
    s_cmp_gt_u32 s27, 360
    s_cselect_b32 s27, 96, 64
    s_add_u32 s27, s27, s55
    v_cmp_ge_u32 vcc, s27, v29
    v_cmp_ge_u32 s[70:71], s27, v31
    s_bcnt1_i32_b64 s56, vcc
    s_bcnt1_i32_b64 s57, s[70:71]
    s_add_u32 s27, s54, 16
    s_add_u32 s56, s56, s57
    s_min_u32 s56, s56, s27
    s_min_u32 s56, s56, 100
    s_max_u32 s56, s56, 20
    s_lshr_b32 s27, s56, 1
    s_and_b32 s69, s56, 1
    v_readlane_b32 s57, v28, s27
    s_lshl4_add_u32 s69, s69, 0x100000
    s_bfe_u32 s57, s57, s69
    s_cmp_eq_u32 s12, 2
    s_cbranch_scc1 M_cut
    s_sub_u32 s27, s57, s55
    s_cmp_gt_u32 s27, 64
    s_cselect_b32 s42, 64, 96
    s_mov_b32 s54, s56
    s_mov_b32 s55, s57
    s_sub_u32 s27, s62, s55
    s_cmp_gt_u32 s27, 300
    s_cselect_b32 s27, 96, 64
    s_add_u32 s27, s27, s55
    v_cmp_ge_u32 vcc, s27, v29
    v_cmp_ge_u32 s[70:71], s27, v31
    s_bcnt1_i32_b64 s56, vcc
    s_bcnt1_i32_b64 s57, s[70:71]
    s_add_u32 s27, s54, 16
    s_add_u32 s56, s56, s57
    s_min_u32 s56, s56, s27
    s_min_u32 s56, s56, 100
    s_max_u32 s56, s56, 36
    s_lshr_b32 s27, s56, 1
    s_and_b32 s69, s56, 1
    v_readlane_b32 s57, v28, s27
    s_lshl4_add_u32 s69, s69, 0x100000
    s_bfe_u32 s57, s57, s69
    s_cmp_eq_u32 s12, 3
    s_cbranch_scc1 M_cut
    s_mov_b32 s54, s56
    s_mov_b32 s55, s57
    s_sub_u32 s27, s62, s55
    s_cmp_gt_u32 s27, 248
    s_cselect_b32 s27, s40, 64
    s_add_u32 s27, s27, s55
    v_cmp_ge_u32 vcc, s27, v29
    v_cmp_ge_u32 s[70:71], s27, v31
    s_bcnt1_i32_b64 s56, vcc
    s_bcnt1_i32_b64 s57, s[70:71]
    s_add_u32 s27, s54, 16
    s_add_u32 s56, s56, s57
    s_min_u32 s56, s56, s27
    s_min_u32 s56, s56, 100
    s_max_u32 s56, s56, 52
    s_lshr_b32 s27, s56, 1
    s_and_b32 s69, s56, 1
    v_readlane_b32 s57, v28, s27
    s_lshl4_add_u32 s69, s69, 0x100000
    s_bfe_u32 s57, s57, s69
    s_cmp_eq_u32 s12, 4
    s_cbranch_scc1 M_cut
    s_mov_b32 s54, s56
    s_mov_b32 s55, s57
    s_sub_u32 s27, s62, s55
    s_cmp_gt_u32 s27, 186
    s_cselect_b32 s27, s41, 64
    s_add_u32 s27, s27, s55
    v_cmp_ge_u32 vcc, s27, v29
    v_cmp_ge_u32 s[70:71], s27, v31
    s_bcnt1_i32_b64 s56, vcc
    s_bcnt1_i32_b64 s57, s[70:71]
    s_add_u32 s27, s54, 16
    s_add_u32 s56, s56, s57
    s_min_u32 s56, s56, s27
    s_min_u32 s56, s56, 100
    s_max_u32 s56, s56, 68
    s_lshr_b32 s27, s56, 1
    s_and_b32 s69, s56, 1
    v_readlane_b32 s57, v28, s27
    s_lshl4_add_u32 s69, s69, 0x100000
    s_bfe_u32 s57, s57, s69
    s_cmp_eq_u32 s12, 5
    s_cbranch_scc1 M_cut
    s_mov_b32 s54, s56
    s_mov_b32 s55, s57
    s_sub_u32 s27, s62, s55
    s_cmp_gt_u32 s27, 124
    s_cselect_b32 s27, s42, 64
    s_add_u32 s27, s27, s55
    v_cmp_ge_u32 vcc, s27, v29
    v_cmp_ge_u32 s[70:71], s27, v31
    s_bcnt1_i32_b64 s56, vcc
    s_bcnt1_i32_b64 s57, s[70:71]
    s_add_u32 s27, s54, 16
    s_add_u32 s56, s56, s57
    s_min_u32 s56, s56, s27
    s_min_u32 s56, s56, 100
    s_max_u32 s56, s56, 84
    s_lshr_b32 s27, s56, 1
    s_and_b32 s69, s56, 1
    v_readlane_b32 s57, v28, s27
    s_lshl4_add_u32 s69, s69, 0x100000
    s_bfe_u32 s57, s57, s69
    s_cmp_eq_u32 s12, 6
    s_cbranch_scc1 M_cut
    s_mov_b32 s54, s56
    s_mov_b32 s55, s57
    s_movk_i32 s56, 100
    s_mov_b32 s57, s62
M_cut:
    s_lshl_b32 s27, s55, 4
    s_add_u32 s27, s27, s67
    v_add_u32 v14, s27, v1
    v_lshlrev_b32 v15, 4, v11
    v_add_u32 v15, s27, v15
    ds_read_b32 v15, v15
    ds_read_b96 v[88:90], v14
WUP_1974:
    s_cbranch_execz WUP_2150
    ds_read_b96 v[92:94], v14 offset:1024
    s_lshl_b32 s59, s54, 1
    s_sub_u32 s45, s56, s54
    s_lshl_b32 s45, s45, 1
    s_lshl_b32 s40, s54, 10
    s_add_u32 s40, s40, s44
    s_add_u32 s41, s40, 4096
    s_add_u32 s42, s40, 8192
    s_add_u32 s43, s40, 12288
    s_lshl_b32 s6, s56, 10
    s_add_u32 s6, s6, s44
    s_mov_b32 s34, s6
    s_sub_u32 s47, s57, s55
    v_add_u32 v86, 64, v8
    s_mov_b32 s50, 1
    s_cmp_gt_u32 s47, 128
    s_cselect_b32 s27, 1, s46
    s_cmp_gt_u32 s57, 768
    s_cselect_b32 s27, 1, s27
    s_cmp_eq_u32 s27, 0
    s_cselect_b32 s47, s47, 0
    s_cselect_b32 s76, 1, 0
    s_mov_b32 s14, 0
    s_mov_b32 s15, 0
    s_mov_b32 s16, 0
    s_mov_b32 s17, 0
    v_cmp_gt_u32 s[8:9], s47, v8
    v_cmp_gt_u32 s[10:11], s47, v86
    s_add_u32 s48, s47, 31
    s_lshr_b32 s48, s48, 5
    v_bfrev_b32 v14, 2
    v_cmp_gt_u32 vcc, s47, v11
    s_mov_b32 s27, 0x1fffe
    s_waitcnt lgkmcnt(2)
    v_and_b32 v15, s27, v15
    v_lshlrev_b32 v15, 6, v15
    v_lshl_add_u32 v15, v10, 6, v15
    v_cndmask_b32 v15, v14, v15, vcc
    buffer_load_dwordx4 v[32:35], v15, s[72:75], 0 offen offset:0
    buffer_load_dwordx4 v[36:39], v15, s[72:75], 0 offen offset:16
    buffer_load_dwordx4 v[40:43], v15, s[72:75], 0 offen offset:32
    buffer_load_dwordx4 v[44:47], v15, s[72:75], 0 offen offset:48
    v_bfe_u32 v13, v1, 9, 1
    v_bfe_u32 v14, v1, 4, 5
    v_lshlrev_b32 v13, 11, v13
    v_lshl_add_u32 v13, v14, 2, v13
    buffer_load_dword v208, v13, s[4:7], s40 offen offset:256
    buffer_load_dword v209, v13, s[4:7], s40 offen offset:768
    buffer_load_dword v210, v13, s[4:7], s40 offen offset:1280
    buffer_load_dword v211, v13, s[4:7], s40 offen offset:1792
    buffer_load_dword v212, v13, s[4:7], s41 offen offset:256
    buffer_load_dword v213, v13, s[4:7], s41 offen offset:768
    buffer_load_dword v214, v13, s[4:7], s41 offen offset:1280
    buffer_load_dword v215, v13, s[4:7], s41 offen offset:1792
    buffer_load_dword v216, v13, s[4:7], s42 offen offset:256
    buffer_load_dword v217, v13, s[4:7], s42 offen offset:768
    buffer_load_dword v218, v13, s[4:7], s42 offen offset:1280
    buffer_load_dword v219, v13, s[4:7], s42 offen offset:1792
    buffer_load_dword v220, v13, s[4:7], s43 offen offset:256
    buffer_load_dword v221, v13, s[4:7], s43 offen offset:768
    buffer_load_dword v222, v13, s[4:7], s43 offen offset:1280
    buffer_load_dword v223, v13, s[4:7], s43 offen offset:1792
    buffer_load_dword v240, v13, s[4:7], s40 offen offset:384
    buffer_load_dword v241, v13, s[4:7], s40 offen offset:896
    buffer_load_dword v242, v13, s[4:7], s40 offen offset:1408
    buffer_load_dword v243, v13, s[4:7], s40 offen offset:1920
    buffer_load_dword v244, v13, s[4:7], s41 offen offset:384
    buffer_load_dword v245, v13, s[4:7], s41 offen offset:896
    buffer_load_dword v246, v13, s[4:7], s41 offen offset:1408
    buffer_load_dword v247, v13, s[4:7], s41 offen offset:1920
    buffer_load_dword v248, v13, s[4:7], s42 offen offset:384
    buffer_load_dword v249, v13, s[4:7], s42 offen offset:896
    buffer_load_dword v250, v13, s[4:7], s42 offen offset:1408
    buffer_load_dword v251, v13, s[4:7], s42 offen offset:1920
    buffer_load_dword v252, v13, s[4:7], s43 offen offset:384
    buffer_load_dword v253, v13, s[4:7], s43 offen offset:896
    buffer_load_dword v254, v13, s[4:7], s43 offen offset:1408
    buffer_load_dword v255, v13, s[4:7], s43 offen offset:1920
    s_waitcnt lgkmcnt(0)
M_win:
    v_lshrrev_b32 v8, 4, v1
    s_mov_b32 s53, 0x40490fdb
    s_mov_b32 s70, 0
    s_mov_b32 s54, 0x3e4ccccd
    s_mov_b32 s55, 0x1fffe
    v_mov_b32 v87, 1
    v_bfrev_b32 v14, 2
    v_and_b32 v96, s58, v90
    v_cndmask_b32 v96, 1.0, v96, s[8:9]
    v_rcp_f32 v98, v96
    v_mul_f32 v97, s53, v96
    v_cvt_pk_bf16_f32 v97, 0, v97
    v_mul_f32 v97, s54, v97
    v_cvt_pk_bf16_f32 v97, 0, v97
    v_mul_f32 v97, s61, v97
    v_cos_f32 v97, v97
    v_lshlrev_b32 v100, 16, v89
    v_and_b32 v101, s58, v89
    v_lshlrev_b32 v102, 16, v90
    v_cvt_pk_bf16_f32 v97, 0, v97
    v_add_f32 v97, 1.0, v97
    v_cvt_pk_bf16_f32 v97, 0, v97
    v_cndmask_b32 v97, 0, v97, s[8:9]
    v_mul_f32 v97, v97, v98
    v_add_f32 v103, v98, v98
    v_mul_f32 v97, 0x3e800000, v97
    v_mul_f32 v100, v100, v103
    v_mul_f32 v101, v101, v103
    v_mul_f32 v102, v102, v103
    v_and_b32 v99, s55, v88
    v_lshlrev_b32 v99, 8, v99
    v_cndmask_b32 v99, v14, v99, s[8:9]
    v_cvt_pk_bf16_f32 v100, v100, v101
    v_cvt_pk_bf16_f32 v102, 0, v102
    v_cndmask_b32 v104, 0, v87, s[8:9]
    v_mov_b32 v105, 0
    v_lshrrev_b32 v108, 24, v88
    v_subrev_u32 v108, s59, v108
    v_lshlrev_b32 v108, 1, v108
    v_lshlrev_b64 v[106:107], v108, v[104:105]
    ds_write_b128 v16, v[96:99] offset:0
    ds_write_b16 v17, v106 offset:2048
    ds_write_b16_d16_hi v17, v106 offset:2056
    ds_write_b16 v17, v107 offset:2064
    ds_write_b16_d16_hi v17, v107 offset:2072
    ds_write_b16 v17, v100 offset:2080
    ds_write_b16_d16_hi v17, v100 offset:2088
    ds_write_b16_d16_hi v17, v102 offset:2096
    s_cmp_eq_u64 s[10:11], 0
    s_cbranch_scc1 M_g1
    v_and_b32 v112, s58, v94
    v_cndmask_b32 v112, 1.0, v112, s[10:11]
    v_rcp_f32 v114, v112
    v_mul_f32 v113, s53, v112
    v_cvt_pk_bf16_f32 v113, 0, v113
    v_mul_f32 v113, s54, v113
    v_cvt_pk_bf16_f32 v113, 0, v113
    v_mul_f32 v113, s61, v113
    v_cos_f32 v113, v113
    v_lshlrev_b32 v116, 16, v93
    v_and_b32 v117, s58, v93
    v_lshlrev_b32 v118, 16, v94
    v_cvt_pk_bf16_f32 v113, 0, v113
    v_add_f32 v113, 1.0, v113
    v_cvt_pk_bf16_f32 v113, 0, v113
    v_cndmask_b32 v113, 0, v113, s[10:11]
    v_mul_f32 v113, v113, v114
    v_add_f32 v119, v114, v114
    v_mul_f32 v113, 0x3e800000, v113
    v_mul_f32 v116, v116, v119
    v_mul_f32 v117, v117, v119
    v_mul_f32 v118, v118, v119
    v_and_b32 v115, s55, v92
    v_lshlrev_b32 v115, 8, v115
    v_cndmask_b32 v115, v14, v115, s[10:11]
    v_cvt_pk_bf16_f32 v116, v116, v117
    v_cvt_pk_bf16_f32 v118, 0, v118
    v_cndmask_b32 v120, 0, v87, s[10:11]
    v_mov_b32 v121, 0
    v_lshrrev_b32 v124, 24, v92
    v_subrev_u32 v124, s59, v124
    v_lshlrev_b32 v124, 1, v124
    v_lshlrev_b64 v[122:123], v124, v[120:121]
    ds_write_b128 v16, v[112:115] offset:1024
    ds_write_b16 v17, v122 offset:2944
    ds_write_b16_d16_hi v17, v122 offset:2952
    ds_write_b16 v17, v123 offset:2960
    ds_write_b16_d16_hi v17, v123 offset:2968
    ds_write_b16 v17, v116 offset:2976
    ds_write_b16_d16_hi v17, v116 offset:2984
    ds_write_b16_d16_hi v17, v118 offset:2992
M_g1:
    s_waitcnt lgkmcnt(0)
    s_cmp_lg_u32 s50, 0
    s_cbranch_scc1 M_first
    s_cmp_eq_u32 s48, 0
    s_cselect_b32 s77, 0x40000000, 0
    ds_read_b32 v47, v3 offset:12
WUP_2150:
    s_cbranch_execz WUR_0
    v_bfe_u32 v46, v1, 9, 1
    s_waitcnt lgkmcnt(0)
    v_lshrrev_b32 v47, 2, v47
    v_lshl_add_u32 v47, v46, 6, v47
    buffer_load_dwordx4 v[32:35], v47, s[72:75], s77 offen offset:0
    buffer_load_dwordx4 v[36:39], v47, s[72:75], s77 offen offset:16
    buffer_load_dwordx4 v[40:43], v47, s[72:75], s77 offen offset:32
    buffer_load_dwordx4 v[44:47], v47, s[72:75], s77 offen offset:48
    s_branch M_noacc
M_first:
    s_mov_b32 s50, 2
    s_sub_u32 s27, s26, 4
    s_cmp_ge_u32 s27, 3
    s_cbranch_scc1 M_late
    s_cmp_eq_u32 s48, 0
    s_cbranch_scc1 M_late
    ds_read_b32 v64, v5 offset:12
    ds_read_b32 v65, v5 offset:140
    ds_read_b32 v66, v5 offset:268
    ds_read_b32 v67, v5 offset:396
    s_waitcnt lgkmcnt(3)
    v_and_or_b32 v64, v1, s63, v64
    s_waitcnt lgkmcnt(2)
    v_and_or_b32 v65, v1, s63, v65
    s_waitcnt lgkmcnt(1)
    v_and_or_b32 v66, v1, s63, v66
    s_waitcnt lgkmcnt(0)
    v_and_or_b32 v67, v1, s63, v67
    s_add_u32 m0, s51, 0
    s_nop 0
    buffer_load_dwordx4 v64, s[28:31], s64 offen lds
    s_add_u32 m0, s51, 1024
    s_nop 0
    buffer_load_dwordx4 v64, s[28:31], s65 offen lds
    s_add_u32 m0, s51, 2048
    s_nop 0
    buffer_load_dwordx4 v64, s[28:31], s66 offen lds
    s_add_u32 m0, s51, 3072
    s_nop 0
    buffer_load_dwordx4 v65, s[28:31], s64 offen lds
    s_add_u32 m0, s51, 4096
    s_nop 0
    buffer_load_dwordx4 v65, s[28:31], s65 offen lds
    s_add_u32 m0, s51, 5120
    s_nop 0
    buffer_load_dwordx4 v65, s[28:31], s66 offen lds
    s_add_u32 m0, s51, 6144
    s_nop 0
    buffer_load_dwordx4 v66, s[28:31], s64 offen lds
    s_add_u32 m0, s51, 7168
    s_nop 0
    buffer_load_dwordx4 v66, s[28:31], s65 offen lds
    s_add_u32 m0, s51, 8192
    s_nop 0
    buffer_load_dwordx4 v66, s[28:31], s66 offen lds
    s_add_u32 m0, s51, 9216
    s_nop 0
    buffer_load_dwordx4 v67, s[28:31], s64 offen lds
    s_add_u32 m0, s51, 10240
    s_nop 0
    buffer_load_dwordx4 v67, s[28:31], s65 offen lds
    s_add_u32 m0, s51, 11264
    s_nop 0
    buffer_load_dwordx4 v67, s[28:31], s66 offen lds
    s_mov_b32 s50, 3
    s_waitcnt vmcnt(48)
    s_branch M_late2
M_late:
    s_waitcnt vmcnt(36)
M_late2:
    s_mov_b32 s99, 1
    s_cmp_eq_u32 s48, 0
    s_cbranch_scc1 M_rd0
M_rd1:
    s_lshl_b32 s27, s59, 8
    s_add_u32 s27, s27, 30720
    v_lshlrev_b32 v12, 10, v10
    v_lshl_add_u32 v12, v11, 2, v12
    v_add_u32 v12, s27, v12
    s_barrier
    ds_read_u16_d16_hi v128, v12 offset:0
    ds_read_u16_d16_hi v144, v12 offset:2
    ds_read_u16_d16_hi v129, v12 offset:256
    ds_read_u16_d16_hi v145, v12 offset:258
    ds_read_u16_d16_hi v130, v12 offset:512
    ds_read_u16_d16_hi v146, v12 offset:514
    ds_read_u16_d16_hi v131, v12 offset:768
    ds_read_u16_d16_hi v147, v12 offset:770
    ds_read_u16_d16_hi v132, v12 offset:2048
    ds_read_u16_d16_hi v148, v12 offset:2050
    ds_read_u16_d16_hi v133, v12 offset:2304
    ds_read_u16_d16_hi v149, v12 offset:2306
    ds_read_u16_d16_hi v134, v12 offset:2560
    ds_read_u16_d16_hi v150, v12 offset:2562
    ds_read_u16_d16_hi v135, v12 offset:2816
    ds_read_u16_d16_hi v151, v12 offset:2818
    ds_read_u16_d16_hi v136, v12 offset:4096
    ds_read_u16_d16_hi v152, v12 offset:4098
    ds_read_u16_d16_hi v137, v12 offset:4352
    ds_read_u16_d16_hi v153, v12 offset:4354
    ds_read_u16_d16_hi v138, v12 offset:4608
    ds_read_u16_d16_hi v154, v12 offset:4610
    ds_read_u16_d16_hi v139, v12 offset:4864
    ds_read_u16_d16_hi v155, v12 offset:4866
    ds_read_u16_d16_hi v140, v12 offset:6144
    ds_read_u16_d16_hi v156, v12 offset:6146
    ds_read_u16_d16_hi v141, v12 offset:6400
    ds_read_u16_d16_hi v157, v12 offset:6402
    ds_read_u16_d16_hi v142, v12 offset:6656
    ds_read_u16_d16_hi v158, v12 offset:6658
    ds_read_u16_d16_hi v143, v12 offset:6912
    ds_read_u16_d16_hi v159, v12 offset:6914
    ds_read_u16_d16_hi v160, v12 offset:128
    ds_read_u16_d16_hi v176, v12 offset:130
    ds_read_u16_d16_hi v161, v12 offset:384
    ds_read_u16_d16_hi v177, v12 offset:386
    ds_read_u16_d16_hi v162, v12 offset:640
    ds_read_u16_d16_hi v178, v12 offset:642
    ds_read_u16_d16_hi v163, v12 offset:896
    ds_read_u16_d16_hi v179, v12 offset:898
    ds_read_u16_d16_hi v164, v12 offset:2176
    ds_read_u16_d16_hi v180, v12 offset:2178
    ds_read_u16_d16_hi v165, v12 offset:2432
    ds_read_u16_d16_hi v181, v12 offset:2434
    ds_read_u16_d16_hi v166, v12 offset:2688
    ds_read_u16_d16_hi v182, v12 offset:2690
    ds_read_u16_d16_hi v167, v12 offset:2944
    ds_read_u16_d16_hi v183, v12 offset:2946
    ds_read_u16_d16_hi v168, v12 offset:4224
    ds_read_u16_d16_hi v184, v12 offset:4226
    ds_read_u16_d16_hi v169, v12 offset:4480
    ds_read_u16_d16_hi v185, v12 offset:4482
    ds_read_u16_d16_hi v170, v12 offset:4736
    ds_read_u16_d16_hi v186, v12 offset:4738
    ds_read_u16_d16_hi v171, v12 offset:4992
    ds_read_u16_d16_hi v187, v12 offset:4994
    ds_read_u16_d16_hi v172, v12 offset:6272
    ds_read_u16_d16_hi v188, v12 offset:6274
    ds_read_u16_d16_hi v173, v12 offset:6528
    ds_read_u16_d16_hi v189, v12 offset:6530
    ds_read_u16_d16_hi v174, v12 offset:6784
    ds_read_u16_d16_hi v190, v12 offset:6786
    ds_read_u16_d16_hi v175, v12 offset:7040
    ds_read_u16_d16_hi v191, v12 offset:7042
    s_waitcnt lgkmcnt(0)
    s_cmp_eq_u32 s50, 3
    s_cbranch_scc1 M_noinit
    s_cmp_ge_u32 s26, 4
    s_cbranch_scc1 M_noacc
    s_barrier
    s_mov_b32 s50, 0
    s_cmp_eq_u32 s48, 0
    s_cbranch_scc1 M_noacc
    s_mov_b32 s70, 1
    s_waitcnt vmcnt(32)
    s_branch M_noinit
M_noacc:
    s_cmp_eq_u32 s48, 0
    s_cbranch_scc1 M_nob
WUP_2304:
    s_cbranch_execz WUP_3942
    ds_read_b32 v64, v5 offset:12
    ds_read_b32 v65, v5 offset:140
    ds_read_b32 v66, v5 offset:268
    ds_read_b32 v67, v5 offset:396
    s_waitcnt lgkmcnt(3)
    v_and_or_b32 v64, v1, s63, v64
    s_waitcnt lgkmcnt(2)
    v_and_or_b32 v65, v1, s63, v65
    s_waitcnt lgkmcnt(1)
    v_and_or_b32 v66, v1, s63, v66
    s_waitcnt lgkmcnt(0)
    v_and_or_b32 v67, v1, s63, v67
    s_add_u32 m0, s51, 0
    s_nop 0
    buffer_load_dwordx4 v64, s[28:31], s64 offen lds
    s_add_u32 m0, s51, 1024
    s_nop 0
    buffer_load_dwordx4 v64, s[28:31], s65 offen lds
    s_add_u32 m0, s51, 2048
    s_nop 0
    buffer_load_dwordx4 v64, s[28:31], s66 offen lds
    s_add_u32 m0, s51, 3072
    s_nop 0
    buffer_load_dwordx4 v65, s[28:31], s64 offen lds
    s_add_u32 m0, s51, 4096
    s_nop 0
    buffer_load_dwordx4 v65, s[28:31], s65 offen lds
    s_add_u32 m0, s51, 5120
    s_nop 0
    buffer_load_dwordx4 v65, s[28:31], s66 offen lds
    s_add_u32 m0, s51, 6144
    s_nop 0
    buffer_load_dwordx4 v66, s[28:31], s64 offen lds
    s_add_u32 m0, s51, 7168
    s_nop 0
    buffer_load_dwordx4 v66, s[28:31], s65 offen lds
    s_add_u32 m0, s51, 8192
    s_nop 0
    buffer_load_dwordx4 v66, s[28:31], s66 offen lds
    s_add_u32 m0, s51, 9216
    s_nop 0
    buffer_load_dwordx4 v67, s[28:31], s64 offen lds
    s_add_u32 m0, s51, 10240
    s_nop 0
    buffer_load_dwordx4 v67, s[28:31], s65 offen lds
    s_add_u32 m0, s51, 11264
    s_nop 0
    buffer_load_dwordx4 v67, s[28:31], s66 offen lds
    s_branch M_noinit
M_nob:
M_noinit:
    s_cmp_eq_u32 s50, 0
    s_cbranch_scc1 M_nod
    s_barrier
    s_mov_b32 s50, 0
M_nod:
    s_cmp_eq_u32 s48, 0
    s_cbranch_scc1 M_wend
    s_mov_b32 s49, 0
    s_cmp_lt_u32 s26, 4
    s_cbranch_scc1 M_yp
    s_setprio 1
M_yp:
    ds_read_b128 v[104:107], v3 offset:0
    ds_read_b128 v[72:75], v7
    ds_read_b128 v[76:79], v7 offset:16
    ds_read_b64 v[12:13], v4 offset:2048
    ds_read_b64 v[14:15], v4 offset:2160
    ds_read_b64 v[16:17], v4 offset:2272
    ds_read_b64 v[18:19], v4 offset:2384
    ds_read_b128 v[20:23], v1 offset:24576
    ds_read_b128 v[24:27], v1 offset:0
    ds_read_b128 v[28:31], v1 offset:1024
    s_waitcnt lgkmcnt(7)
    v_mul_f32 v72, v104, v72
    v_mul_f32 v73, v104, v73
    v_mul_f32 v74, v104, v74
    v_mul_f32 v75, v104, v75
    v_mul_f32 v76, v104, v76
    v_mul_f32 v77, v104, v77
    v_mul_f32 v78, v104, v78
    v_mul_f32 v79, v104, v79
    v_cvt_pk_bf16_f32 v72, 0, v72
    v_cvt_pk_bf16_f32 v73, 0, v73
    v_cvt_pk_bf16_f32 v74, 0, v74
    v_cvt_pk_bf16_f32 v75, 0, v75
    v_cvt_pk_bf16_f32 v76, 0, v76
    v_cvt_pk_bf16_f32 v77, 0, v77
    v_cvt_pk_bf16_f32 v78, 0, v78
    v_cvt_pk_bf16_f32 v79, 0, v79
    v_mul_f32 v72, s61, v72
    v_mul_f32 v73, s61, v73
    v_mul_f32 v74, s61, v74
    v_mul_f32 v75, s61, v75
    v_mul_f32 v76, s61, v76
    v_mul_f32 v77, s61, v77
    v_mul_f32 v78, s61, v78
    v_mul_f32 v79, s61, v79
    v_sin_f32 v72, v72
    v_sin_f32 v73, v73
    v_sin_f32 v74, v74
    v_sin_f32 v75, v75
    v_sin_f32 v76, v76
    v_sin_f32 v77, v77
    v_sin_f32 v78, v78
    v_sin_f32 v79, v79
    v_mul_f32 v72, v72, v105
    v_mul_f32 v73, v73, v105
    v_mul_f32 v74, v74, v105
    v_mul_f32 v75, v75, v105
    v_mul_f32 v76, v76, v105
    v_mul_f32 v77, v77, v105
    v_mul_f32 v78, v78, v105
    v_mul_f32 v79, v79, v105
    v_cvt_pk_bf16_f32 v8, v72, v73
    v_cvt_pk_bf16_f32 v9, v74, v75
    v_cvt_pk_bf16_f32 v10, v76, v77
    v_cvt_pk_bf16_f32 v11, v78, v79
    s_waitcnt lgkmcnt(3)
    v_pk_lshlrev_b16 v12, v6, v12
    v_pk_lshlrev_b16 v13, v6, v13
    v_pk_lshlrev_b16 v14, v6, v14
    v_pk_lshlrev_b16 v15, v6, v15
    v_pk_lshlrev_b16 v16, v6, v16
    v_pk_lshlrev_b16 v17, v6, v17
    v_pk_lshlrev_b16 v18, v6, v18
    v_pk_lshlrev_b16 v19, v6, v19
    s_waitcnt lgkmcnt(0)
    s_nop 0
M_batch:
    s_cmp_lg_u32 s99, 0
    s_waitcnt vmcnt(44)
    s_cbranch_scc1 M_hw16
    s_waitcnt vmcnt(12)
M_hw16:
    v_mfma_f32_32x32x16_bf16 v[80:95], v[8:11], v[20:23], 0
    ds_read_b128 v[20:23], v1 offset:2048
    s_add_u32 s77, s49, 1
    s_cmp_lt_u32 s77, s48
    s_cselect_b32 s77, 0, 0x40000000
    ds_read_b32 v63, v3 offset:524
    v_bfe_u32 v62, v1, 9, 1
    s_waitcnt lgkmcnt(0)
    v_lshrrev_b32 v63, 2, v63
    v_lshl_add_u32 v63, v62, 6, v63
    buffer_load_dwordx4 v[48:51], v63, s[72:75], s77 offen offset:0
    buffer_load_dwordx4 v[52:55], v63, s[72:75], s77 offen offset:16
    buffer_load_dwordx4 v[56:59], v63, s[72:75], s77 offen offset:32
    buffer_load_dwordx4 v[60:63], v63, s[72:75], s77 offen offset:48
    s_cmp_eq_u32 s70, 0
    s_cbranch_scc1 M_vb17
    ds_read_b32 v112, v5 offset:12
    ds_read_b32 v113, v5 offset:140
    s_waitcnt lgkmcnt(1)
    v_and_or_b32 v112, v1, s63, v112
    s_add_u32 m0, s51, 0
    s_nop 0
    buffer_load_dwordx4 v112, s[28:31], s64 offen lds
    s_add_u32 m0, s51, 1024
    s_nop 0
    buffer_load_dwordx4 v112, s[28:31], s65 offen lds
    s_add_u32 m0, s51, 2048
    s_nop 0
    buffer_load_dwordx4 v112, s[28:31], s66 offen lds
    s_waitcnt lgkmcnt(0)
    v_and_or_b32 v113, v1, s63, v113
    s_add_u32 m0, s51, 3072
    s_nop 0
    buffer_load_dwordx4 v113, s[28:31], s64 offen lds
    s_add_u32 m0, s51, 4096
    s_nop 0
    buffer_load_dwordx4 v113, s[28:31], s65 offen lds
    s_add_u32 m0, s51, 5120
    s_nop 0
    buffer_load_dwordx4 v113, s[28:31], s66 offen lds
M_vb17:
    v_mfma_f32_32x32x16_bf16 v[64:79], v[32:35], v[24:27], 0
    ds_read_b128 v[24:27], v1 offset:3072
    v_mfma_f32_32x32x16_bf16 v[64:79], v[36:39], v[28:31], v[64:79]
    ds_read_b128 v[28:31], v1 offset:25600
    v_mfma_f32_32x32x16_bf16 v[64:79], v[40:43], v[20:23], v[64:79]
    ds_read_b128 v[20:23], v1 offset:4096
    s_waitcnt lgkmcnt(2)
    v_mfma_f32_32x32x16_bf16 v[64:79], v[44:47], v[24:27], v[64:79]
    ds_read_b128 v[24:27], v1 offset:5120
WUP_2482:
    s_cbranch_execz WUP_3972
    s_cmp_eq_u32 s70, 0
    s_nop 9
    s_cbranch_scc1 M_vb18
    ds_read_b32 v114, v5 offset:268
    s_waitcnt lgkmcnt(0)
    v_and_or_b32 v114, v1, s63, v114
    s_add_u32 m0, s51, 6144
    s_nop 0
    buffer_load_dwordx4 v114, s[28:31], s64 offen lds
    s_add_u32 m0, s51, 7168
    s_nop 0
    buffer_load_dwordx4 v114, s[28:31], s65 offen lds
    s_add_u32 m0, s51, 8192
    s_nop 0
    buffer_load_dwordx4 v114, s[28:31], s66 offen lds
M_vb18:
    s_waitcnt lgkmcnt(2)
    v_mfma_f32_32x32x16_bf16 v[112:127], v[8:11], v[28:31], 0
    ds_read_b128 v[28:31], v1 offset:6144
    s_waitcnt lgkmcnt(2)
    v_mfma_f32_32x32x16_bf16 v[96:111], v[32:35], v[20:23], 0
    ds_read_b128 v[20:23], v1 offset:7168
    v_mul_f32 v64, v64, v80
    v_mul_f32 v65, v65, v81
    v_mul_f32 v66, v66, v82
    v_mul_f32 v67, v67, v83
    v_mul_f32 v68, v68, v84
    v_mul_f32 v69, v69, v85
    s_waitcnt lgkmcnt(2)
    v_mfma_f32_32x32x16_bf16 v[96:111], v[36:39], v[24:27], v[96:111]
    ds_read_b128 v[24:27], v1 offset:26624
    v_mul_f32 v70, v70, v86
    v_mul_f32 v71, v71, v87
    v_mul_f32 v72, v72, v88
    v_mul_f32 v73, v73, v89
    v_mul_f32 v74, v74, v90
    v_mul_f32 v75, v75, v91
    v_mul_f32 v76, v76, v92
    s_waitcnt lgkmcnt(2)
    v_mfma_f32_32x32x16_bf16 v[96:111], v[40:43], v[28:31], v[96:111]
    ds_read_b128 v[28:31], v1 offset:8192
    v_mul_f32 v77, v77, v93
    v_mul_f32 v78, v78, v94
    v_mul_f32 v79, v79, v95
    v_cvt_pk_bf16_f32 v64, v64, v65
    v_cvt_pk_bf16_f32 v65, v66, v67
    v_cvt_pk_bf16_f32 v66, v68, v69
    s_waitcnt lgkmcnt(2)
    v_mfma_f32_32x32x16_bf16 v[96:111], v[44:47], v[20:23], v[96:111]
    ds_read_b128 v[20:23], v1 offset:9216
    v_cvt_pk_bf16_f32 v67, v70, v71
    v_cvt_pk_bf16_f32 v68, v72, v73
    v_cvt_pk_bf16_f32 v69, v74, v75
    v_cvt_pk_bf16_f32 v70, v76, v77
    v_cvt_pk_bf16_f32 v71, v78, v79
    v_mfma_f32_32x32x16_bf16 v[128:143], v[12:15], v[64:67], v[128:143]
    s_nop 0
    v_mfma_f32_32x32x16_bf16 v[128:143], v[16:19], v[68:71], v[128:143]
    s_cmp_eq_u32 s70, 0
    s_nop 10
    s_cbranch_scc1 M_vb19
    ds_read_b32 v72, v5 offset:396
    s_waitcnt lgkmcnt(0)
    v_and_or_b32 v72, v1, s63, v72
    s_add_u32 m0, s51, 9216
    s_nop 0
    buffer_load_dwordx4 v72, s[28:31], s64 offen lds
    s_add_u32 m0, s51, 10240
    s_nop 0
    buffer_load_dwordx4 v72, s[28:31], s65 offen lds
    s_add_u32 m0, s51, 11264
    s_nop 0
    buffer_load_dwordx4 v72, s[28:31], s66 offen lds
M_vb19:
    s_waitcnt lgkmcnt(2)
    v_mfma_f32_32x32x16_bf16 v[80:95], v[8:11], v[24:27], 0
    ds_read_b128 v[24:27], v1 offset:10240
    s_waitcnt lgkmcnt(2)
    v_mfma_f32_32x32x16_bf16 v[64:79], v[32:35], v[28:31], 0
    ds_read_b128 v[28:31], v1 offset:11264
    v_mul_f32 v96, v96, v112
    v_mul_f32 v97, v97, v113
    v_mul_f32 v98, v98, v114
    v_mul_f32 v99, v99, v115
    v_mul_f32 v100, v100, v116
    v_mul_f32 v101, v101, v117
    s_waitcnt lgkmcnt(2)
    v_mfma_f32_32x32x16_bf16 v[64:79], v[36:39], v[20:23], v[64:79]
    ds_read_b128 v[20:23], v1 offset:27648
    v_mul_f32 v102, v102, v118
    v_mul_f32 v103, v103, v119
    v_mul_f32 v104, v104, v120
    v_mul_f32 v105, v105, v121
    v_mul_f32 v106, v106, v122
    v_mul_f32 v107, v107, v123
    v_mul_f32 v108, v108, v124
    s_waitcnt lgkmcnt(2)
    v_mfma_f32_32x32x16_bf16 v[64:79], v[40:43], v[24:27], v[64:79]
    ds_read_b128 v[24:27], v1 offset:12288
    v_mul_f32 v109, v109, v125
    v_mul_f32 v110, v110, v126
    v_mul_f32 v111, v111, v127
    v_cvt_pk_bf16_f32 v96, v96, v97
    v_cvt_pk_bf16_f32 v97, v98, v99
    v_cvt_pk_bf16_f32 v98, v100, v101
    s_waitcnt lgkmcnt(2)
    v_mfma_f32_32x32x16_bf16 v[64:79], v[44:47], v[28:31], v[64:79]
    ds_read_b128 v[28:31], v1 offset:13312
    v_cvt_pk_bf16_f32 v99, v102, v103
    v_cvt_pk_bf16_f32 v100, v104, v105
    v_cvt_pk_bf16_f32 v101, v106, v107
    v_cvt_pk_bf16_f32 v102, v108, v109
    v_cvt_pk_bf16_f32 v103, v110, v111
    v_mfma_f32_32x32x16_bf16 v[144:159], v[12:15], v[96:99], v[144:159]
    s_nop 0
    v_mfma_f32_32x32x16_bf16 v[144:159], v[16:19], v[100:103], v[144:159]
    s_waitcnt lgkmcnt(2)
    v_mfma_f32_32x32x16_bf16 v[112:127], v[8:11], v[20:23], 0
    ds_read_b128 v[20:23], v1 offset:14336
    s_waitcnt lgkmcnt(2)
    v_mfma_f32_32x32x16_bf16 v[96:111], v[32:35], v[24:27], 0
    ds_read_b128 v[24:27], v1 offset:15360
    v_mul_f32 v64, v64, v80
    v_mul_f32 v65, v65, v81
    v_mul_f32 v66, v66, v82
    v_mul_f32 v67, v67, v83
    v_mul_f32 v68, v68, v84
    v_mul_f32 v69, v69, v85
    v_mul_f32 v70, v70, v86
    v_mul_f32 v71, v71, v87
    v_mul_f32 v72, v72, v88
    v_mul_f32 v73, v73, v89
    v_mul_f32 v74, v74, v90
    v_mul_f32 v75, v75, v91
    v_mul_f32 v76, v76, v92
    v_mul_f32 v77, v77, v93
    v_mul_f32 v78, v78, v94
    v_mul_f32 v79, v79, v95
    s_cmp_eq_u32 s70, 0
    s_nop 0
    s_cbranch_scc1 M_vw20
    s_waitcnt vmcnt(0)
    s_mov_b32 s70, 0
M_vw20:
    s_waitcnt vmcnt(4)
    s_cmp_eq_u32 s99, 0
    s_cbranch_scc1 M_ru21
    v_lshlrev_b32 v192, 16, v208
    v_and_b32 v208, s58, v208
    v_lshlrev_b32 v193, 16, v209
    v_and_b32 v209, s58, v209
    v_lshlrev_b32 v194, 16, v210
    v_and_b32 v210, s58, v210
    v_lshlrev_b32 v195, 16, v211
    v_and_b32 v211, s58, v211
    v_lshlrev_b32 v196, 16, v212
    v_and_b32 v212, s58, v212
    v_lshlrev_b32 v197, 16, v213
    v_and_b32 v213, s58, v213
    v_lshlrev_b32 v198, 16, v214
    v_and_b32 v214, s58, v214
    v_lshlrev_b32 v199, 16, v215
    v_and_b32 v215, s58, v215
    v_lshlrev_b32 v200, 16, v216
    v_and_b32 v216, s58, v216
    v_lshlrev_b32 v201, 16, v217
WUP_2645:
    s_cbranch_execz WUR_1
    v_and_b32 v217, s58, v217
    v_lshlrev_b32 v202, 16, v218
    v_and_b32 v218, s58, v218
    v_lshlrev_b32 v203, 16, v219
    v_and_b32 v219, s58, v219
    v_lshlrev_b32 v204, 16, v220
    v_and_b32 v220, s58, v220
    v_lshlrev_b32 v205, 16, v221
    v_and_b32 v221, s58, v221
    v_lshlrev_b32 v206, 16, v222
    v_and_b32 v222, s58, v222
    v_lshlrev_b32 v207, 16, v223
    v_and_b32 v223, s58, v223
    v_lshlrev_b32 v224, 16, v240
    v_and_b32 v240, s58, v240
    v_lshlrev_b32 v225, 16, v241
    v_and_b32 v241, s58, v241
    v_lshlrev_b32 v226, 16, v242
    v_and_b32 v242, s58, v242
    v_lshlrev_b32 v227, 16, v243
    v_and_b32 v243, s58, v243
    v_lshlrev_b32 v228, 16, v244
    v_and_b32 v244, s58, v244
    v_lshlrev_b32 v229, 16, v245
    v_and_b32 v245, s58, v245
    v_lshlrev_b32 v230, 16, v246
    v_and_b32 v246, s58, v246
    v_lshlrev_b32 v231, 16, v247
    v_and_b32 v247, s58, v247
    v_lshlrev_b32 v232, 16, v248
    v_and_b32 v248, s58, v248
    v_lshlrev_b32 v233, 16, v249
    v_and_b32 v249, s58, v249
    v_lshlrev_b32 v234, 16, v250
    v_and_b32 v250, s58, v250
    v_lshlrev_b32 v235, 16, v251
    v_and_b32 v251, s58, v251
    v_lshlrev_b32 v236, 16, v252
    v_and_b32 v252, s58, v252
    v_lshlrev_b32 v237, 16, v253
    v_and_b32 v253, s58, v253
    v_lshlrev_b32 v238, 16, v254
    v_and_b32 v254, s58, v254
    v_lshlrev_b32 v239, 16, v255
    v_and_b32 v255, s58, v255
    s_mov_b32 s99, 0
    s_nop 0
M_ru21:
    ds_read_u16_d16_hi v80, v2 offset:0
    ds_read_u16_d16_hi v81, v2 offset:256
    ds_read_u16_d16_hi v82, v2 offset:512
    ds_read_u16_d16_hi v83, v2 offset:768
    ds_read_u16_d16_hi v84, v2 offset:3072
    ds_read_u16_d16_hi v85, v2 offset:3328
    ds_read_u16_d16_hi v86, v2 offset:3584
    ds_read_u16_d16_hi v87, v2 offset:3840
    ds_read_u16_d16_hi v88, v2 offset:6144
    ds_read_u16_d16_hi v89, v2 offset:6400
    ds_read_u16_d16_hi v90, v2 offset:6656
    ds_read_u16_d16_hi v91, v2 offset:6912
    ds_read_u16_d16_hi v92, v2 offset:9216
    ds_read_u16_d16_hi v93, v2 offset:9472
    ds_read_u16_d16_hi v94, v2 offset:9728
    ds_read_u16_d16_hi v95, v2 offset:9984
    s_waitcnt lgkmcnt(12)
    v_mul_f32 v80, v80, v64
    v_mul_f32 v81, v81, v65
    v_mul_f32 v82, v82, v66
    v_mul_f32 v83, v83, v67
    s_waitcnt lgkmcnt(8)
    v_mul_f32 v84, v84, v68
    v_mul_f32 v85, v85, v69
    v_mfma_f32_32x32x16_bf16 v[96:111], v[36:39], v[28:31], v[96:111]
    ds_read_b128 v[28:31], v1 offset:28672
    v_mul_f32 v86, v86, v70
    v_mul_f32 v87, v87, v71
    v_cvt_pk_bf16_f32 v80, v80, v81
    v_cvt_pk_bf16_f32 v81, v82, v83
    v_cvt_pk_bf16_f32 v82, v84, v85
    v_cvt_pk_bf16_f32 v83, v86, v87
    s_nop 1
    v_mfma_f32_32x32x16_bf16 v[160:175], v[12:15], v[80:83], v[160:175]
    ds_read_u16_d16_hi v80, v2 offset:1024
    ds_read_u16_d16_hi v81, v2 offset:1280
    ds_read_u16_d16_hi v82, v2 offset:1536
    ds_read_u16_d16_hi v83, v2 offset:1792
    ds_read_u16_d16_hi v84, v2 offset:4096
    ds_read_u16_d16_hi v85, v2 offset:4352
    ds_read_u16_d16_hi v86, v2 offset:4608
    ds_read_u16_d16_hi v87, v2 offset:4864
    s_waitcnt lgkmcnt(13)
    v_mul_f32 v88, v88, v72
    v_mul_f32 v89, v89, v73
    v_mul_f32 v90, v90, v74
    v_mul_f32 v91, v91, v75
    s_waitcnt lgkmcnt(9)
    v_mul_f32 v92, v92, v76
    v_mul_f32 v93, v93, v77
    v_mul_f32 v94, v94, v78
    v_mul_f32 v95, v95, v79
    v_cvt_pk_bf16_f32 v88, v88, v89
    v_cvt_pk_bf16_f32 v89, v90, v91
    v_cvt_pk_bf16_f32 v90, v92, v93
    v_cvt_pk_bf16_f32 v91, v94, v95
    s_nop 1
    v_mfma_f32_32x32x16_bf16 v[160:175], v[16:19], v[88:91], v[160:175]
    ds_read_u16_d16_hi v88, v2 offset:7168
    ds_read_u16_d16_hi v89, v2 offset:7424
    ds_read_u16_d16_hi v90, v2 offset:7680
    ds_read_u16_d16_hi v91, v2 offset:7936
    ds_read_u16_d16_hi v92, v2 offset:10240
    ds_read_u16_d16_hi v93, v2 offset:10496
    ds_read_u16_d16_hi v94, v2 offset:10752
    ds_read_u16_d16_hi v95, v2 offset:11008
    s_waitcnt lgkmcnt(12)
    v_mul_f32 v80, v80, v64
    v_mul_f32 v81, v81, v65
    v_mul_f32 v82, v82, v66
    v_mfma_f32_32x32x16_bf16 v[96:111], v[40:43], v[20:23], v[96:111]
    ds_read_b128 v[20:23], v1 offset:16384
    v_mul_f32 v83, v83, v67
    s_waitcnt lgkmcnt(9)
    v_mul_f32 v84, v84, v68
    v_mul_f32 v85, v85, v69
    v_mul_f32 v86, v86, v70
    v_mul_f32 v87, v87, v71
    v_cvt_pk_bf16_f32 v80, v80, v81
    v_cvt_pk_bf16_f32 v81, v82, v83
    v_cvt_pk_bf16_f32 v82, v84, v85
    v_cvt_pk_bf16_f32 v83, v86, v87
    s_nop 1
    v_mfma_f32_32x32x16_bf16 v[192:207], v[12:15], v[80:83], v[192:207]
    ds_read_u16_d16_hi v80, v2 offset:2048
    ds_read_u16_d16_hi v81, v2 offset:2304
    ds_read_u16_d16_hi v82, v2 offset:2560
    ds_read_u16_d16_hi v83, v2 offset:2816
    ds_read_u16_d16_hi v84, v2 offset:5120
    ds_read_u16_d16_hi v85, v2 offset:5376
    ds_read_u16_d16_hi v86, v2 offset:5632
    ds_read_u16_d16_hi v87, v2 offset:5888
    s_waitcnt lgkmcnt(13)
    v_mul_f32 v88, v88, v72
    v_mul_f32 v89, v89, v73
    v_mul_f32 v90, v90, v74
    v_mul_f32 v91, v91, v75
    s_waitcnt lgkmcnt(9)
    v_mul_f32 v92, v92, v76
    v_mul_f32 v93, v93, v77
    v_mul_f32 v94, v94, v78
    v_mul_f32 v95, v95, v79
    v_cvt_pk_bf16_f32 v88, v88, v89
    v_cvt_pk_bf16_f32 v89, v90, v91
    v_cvt_pk_bf16_f32 v90, v92, v93
    v_cvt_pk_bf16_f32 v91, v94, v95
    s_nop 1
    v_mfma_f32_32x32x16_bf16 v[192:207], v[16:19], v[88:91], v[192:207]
    ds_read_u16_d16_hi v88, v2 offset:8192
    ds_read_u16_d16_hi v89, v2 offset:8448
    ds_read_u16_d16_hi v90, v2 offset:8704
    ds_read_u16_d16_hi v91, v2 offset:8960
    ds_read_u16_d16_hi v92, v2 offset:11264
    ds_read_u16_d16_hi v93, v2 offset:11520
    ds_read_u16_d16_hi v94, v2 offset:11776
    ds_read_u16_d16_hi v95, v2 offset:12032
    v_mfma_f32_32x32x16_bf16 v[96:111], v[44:47], v[24:27], v[96:111]
    ds_read_b128 v[24:27], v1 offset:17408
    s_waitcnt lgkmcnt(13)
    v_mul_f32 v80, v80, v64
    v_mul_f32 v81, v81, v65
    v_mul_f32 v82, v82, v66
    v_mul_f32 v83, v83, v67
    s_waitcnt lgkmcnt(9)
    v_mul_f32 v84, v84, v68
    v_mul_f32 v85, v85, v69
    v_mul_f32 v86, v86, v70
    v_mul_f32 v87, v87, v71
    v_cvt_pk_bf16_f32 v80, v80, v81
    v_cvt_pk_bf16_f32 v81, v82, v83
    v_cvt_pk_bf16_f32 v82, v84, v85
    v_cvt_pk_bf16_f32 v83, v86, v87
    s_nop 1
    v_mfma_f32_32x32x16_bf16 v[224:239], v[12:15], v[80:83], v[224:239]
    s_waitcnt lgkmcnt(5)
    v_mul_f32 v88, v88, v72
    v_mul_f32 v89, v89, v73
    v_mul_f32 v90, v90, v74
    v_mul_f32 v91, v91, v75
    s_waitcnt lgkmcnt(1)
    v_mul_f32 v92, v92, v76
    v_mul_f32 v93, v93, v77
    v_mul_f32 v94, v94, v78
    v_mul_f32 v95, v95, v79
    v_cvt_pk_bf16_f32 v88, v88, v89
    v_cvt_pk_bf16_f32 v89, v90, v91
    v_cvt_pk_bf16_f32 v90, v92, v93
    v_cvt_pk_bf16_f32 v91, v94, v95
    s_nop 1
    v_mfma_f32_32x32x16_bf16 v[224:239], v[16:19], v[88:91], v[224:239]
    v_mfma_f32_32x32x16_bf16 v[80:95], v[8:11], v[28:31], 0
    ds_read_b128 v[28:31], v1 offset:18432
    v_mfma_f32_32x32x16_bf16 v[64:79], v[32:35], v[20:23], 0
    ds_read_b128 v[20:23], v1 offset:19456
    v_mul_f32 v96, v96, v112
    v_mul_f32 v97, v97, v113
    v_mul_f32 v98, v98, v114
    v_mul_f32 v99, v99, v115
    v_mul_f32 v100, v100, v116
    v_mul_f32 v101, v101, v117
    v_mul_f32 v102, v102, v118
    v_mul_f32 v103, v103, v119
    v_mul_f32 v104, v104, v120
    v_mul_f32 v105, v105, v121
    v_mul_f32 v106, v106, v122
    v_mul_f32 v107, v107, v123
    v_mul_f32 v108, v108, v124
    v_mul_f32 v109, v109, v125
    v_mul_f32 v110, v110, v126
    v_mul_f32 v111, v111, v127
    ds_read_u16_d16_hi v112, v2 offset:2
    ds_read_u16_d16_hi v113, v2 offset:258
    ds_read_u16_d16_hi v114, v2 offset:514
    ds_read_u16_d16_hi v115, v2 offset:770
    ds_read_u16_d16_hi v116, v2 offset:3074
    ds_read_u16_d16_hi v117, v2 offset:3330
    ds_read_u16_d16_hi v118, v2 offset:3586
    ds_read_u16_d16_hi v119, v2 offset:3842
    ds_read_u16_d16_hi v120, v2 offset:6146
    ds_read_u16_d16_hi v121, v2 offset:6402
    ds_read_u16_d16_hi v122, v2 offset:6658
    ds_read_u16_d16_hi v123, v2 offset:6914
    ds_read_u16_d16_hi v124, v2 offset:9218
    ds_read_u16_d16_hi v125, v2 offset:9474
    ds_read_u16_d16_hi v126, v2 offset:9730
    ds_read_u16_d16_hi v127, v2 offset:9986
    s_waitcnt lgkmcnt(12)
    v_mul_f32 v112, v112, v96
    v_mul_f32 v113, v113, v97
    v_mul_f32 v114, v114, v98
    v_mul_f32 v115, v115, v99
    s_waitcnt lgkmcnt(8)
    v_mul_f32 v116, v116, v100
    v_mul_f32 v117, v117, v101
    v_mul_f32 v118, v118, v102
    v_mfma_f32_32x32x16_bf16 v[64:79], v[36:39], v[24:27], v[64:79]
    ds_read_b128 v[24:27], v1 offset:29696
    v_mul_f32 v119, v119, v103
    v_cvt_pk_bf16_f32 v112, v112, v113
    v_cvt_pk_bf16_f32 v113, v114, v115
    v_cvt_pk_bf16_f32 v114, v116, v117
    v_cvt_pk_bf16_f32 v115, v118, v119
    s_nop 1
    v_mfma_f32_32x32x16_bf16 v[176:191], v[12:15], v[112:115], v[176:191]
    ds_read_u16_d16_hi v112, v2 offset:1026
    ds_read_u16_d16_hi v113, v2 offset:1282
    ds_read_u16_d16_hi v114, v2 offset:1538
    ds_read_u16_d16_hi v115, v2 offset:1794
    ds_read_u16_d16_hi v116, v2 offset:4098
    ds_read_u16_d16_hi v117, v2 offset:4354
    ds_read_u16_d16_hi v118, v2 offset:4610
    ds_read_u16_d16_hi v119, v2 offset:4866
    s_waitcnt lgkmcnt(13)
    v_mul_f32 v120, v120, v104
    v_mul_f32 v121, v121, v105
    v_mul_f32 v122, v122, v106
    v_mul_f32 v123, v123, v107
    s_waitcnt lgkmcnt(9)
    v_mul_f32 v124, v124, v108
    v_mul_f32 v125, v125, v109
    v_mul_f32 v126, v126, v110
    v_mul_f32 v127, v127, v111
    v_cvt_pk_bf16_f32 v120, v120, v121
    v_cvt_pk_bf16_f32 v121, v122, v123
    v_cvt_pk_bf16_f32 v122, v124, v125
    v_cvt_pk_bf16_f32 v123, v126, v127
    s_nop 1
    v_mfma_f32_32x32x16_bf16 v[176:191], v[16:19], v[120:123], v[176:191]
    ds_read_u16_d16_hi v120, v2 offset:7170
    ds_read_u16_d16_hi v121, v2 offset:7426
    ds_read_u16_d16_hi v122, v2 offset:7682
    ds_read_u16_d16_hi v123, v2 offset:7938
    ds_read_u16_d16_hi v124, v2 offset:10242
    ds_read_u16_d16_hi v125, v2 offset:10498
    ds_read_u16_d16_hi v126, v2 offset:10754
    ds_read_u16_d16_hi v127, v2 offset:11010
    s_waitcnt lgkmcnt(12)
    v_mul_f32 v112, v112, v96
    v_mul_f32 v113, v113, v97
    v_mul_f32 v114, v114, v98
    v_mul_f32 v115, v115, v99
    v_mfma_f32_32x32x16_bf16 v[64:79], v[40:43], v[28:31], v[64:79]
    ds_read_b128 v[28:31], v1 offset:20480
    s_waitcnt lgkmcnt(9)
    v_mul_f32 v116, v116, v100
    v_mul_f32 v117, v117, v101
    v_mul_f32 v118, v118, v102
    v_mul_f32 v119, v119, v103
    v_cvt_pk_bf16_f32 v112, v112, v113
    v_cvt_pk_bf16_f32 v113, v114, v115
    v_cvt_pk_bf16_f32 v114, v116, v117
    v_cvt_pk_bf16_f32 v115, v118, v119
    s_nop 1
    v_mfma_f32_32x32x16_bf16 v[208:223], v[12:15], v[112:115], v[208:223]
    ds_read_u16_d16_hi v112, v2 offset:2050
    ds_read_u16_d16_hi v113, v2 offset:2306
    ds_read_u16_d16_hi v114, v2 offset:2562
    ds_read_u16_d16_hi v115, v2 offset:2818
    ds_read_u16_d16_hi v116, v2 offset:5122
    ds_read_u16_d16_hi v117, v2 offset:5378
    ds_read_u16_d16_hi v118, v2 offset:5634
    ds_read_u16_d16_hi v119, v2 offset:5890
    s_waitcnt lgkmcnt(13)
    v_mul_f32 v120, v120, v104
    v_mul_f32 v121, v121, v105
    v_mul_f32 v122, v122, v106
    v_mul_f32 v123, v123, v107
    s_waitcnt lgkmcnt(9)
    v_mul_f32 v124, v124, v108
    v_mul_f32 v125, v125, v109
    v_mul_f32 v126, v126, v110
    v_mul_f32 v127, v127, v111
    v_cvt_pk_bf16_f32 v120, v120, v121
    v_cvt_pk_bf16_f32 v121, v122, v123
    v_cvt_pk_bf16_f32 v122, v124, v125
    v_cvt_pk_bf16_f32 v123, v126, v127
    s_nop 1
    v_mfma_f32_32x32x16_bf16 v[208:223], v[16:19], v[120:123], v[208:223]
    ds_read_u16_d16_hi v120, v2 offset:8194
    ds_read_u16_d16_hi v121, v2 offset:8450
    ds_read_u16_d16_hi v122, v2 offset:8706
    ds_read_u16_d16_hi v123, v2 offset:8962
    ds_read_u16_d16_hi v124, v2 offset:11266
    ds_read_u16_d16_hi v125, v2 offset:11522
    ds_read_u16_d16_hi v126, v2 offset:11778
    ds_read_u16_d16_hi v127, v2 offset:12034
    s_waitcnt lgkmcnt(12)
    v_mul_f32 v112, v112, v96
    v_mfma_f32_32x32x16_bf16 v[64:79], v[44:47], v[20:23], v[64:79]
    ds_read_b128 v[20:23], v1 offset:21504
    v_mul_f32 v113, v113, v97
    v_mul_f32 v114, v114, v98
    v_mul_f32 v115, v115, v99
    s_waitcnt lgkmcnt(9)
    v_mul_f32 v116, v116, v100
    v_mul_f32 v117, v117, v101
    v_mul_f32 v118, v118, v102
    v_mul_f32 v119, v119, v103
    v_cvt_pk_bf16_f32 v112, v112, v113
    v_cvt_pk_bf16_f32 v113, v114, v115
    v_cvt_pk_bf16_f32 v114, v116, v117
    v_cvt_pk_bf16_f32 v115, v118, v119
    s_nop 1
    v_mfma_f32_32x32x16_bf16 v[240:255], v[12:15], v[112:115], v[240:255]
    s_waitcnt lgkmcnt(5)
    v_mul_f32 v120, v120, v104
    v_mul_f32 v121, v121, v105
    v_mul_f32 v122, v122, v106
    v_mul_f32 v123, v123, v107
    s_waitcnt lgkmcnt(1)
    v_mul_f32 v124, v124, v108
    v_mul_f32 v125, v125, v109
    v_mul_f32 v126, v126, v110
    v_mul_f32 v127, v127, v111
    v_cvt_pk_bf16_f32 v120, v120, v121
    v_cvt_pk_bf16_f32 v121, v122, v123
    v_cvt_pk_bf16_f32 v122, v124, v125
    v_cvt_pk_bf16_f32 v123, v126, v127
    s_nop 1
    v_mfma_f32_32x32x16_bf16 v[240:255], v[16:19], v[120:123], v[240:255]
    s_cmp_lg_u32 s77, 0
    s_nop 10
    s_cbranch_scc1 M_nv22
    ds_read_b32 v112, v5 offset:524
    ds_read_b32 v113, v5 offset:652
    ds_read_b32 v114, v5 offset:780
    ds_read_b32 v115, v5 offset:908
    s_waitcnt lgkmcnt(3)
    v_and_or_b32 v112, v1, s63, v112
    s_waitcnt lgkmcnt(2)
    v_and_or_b32 v113, v1, s63, v113
    s_waitcnt lgkmcnt(1)
    v_and_or_b32 v114, v1, s63, v114
    s_waitcnt lgkmcnt(0)
    v_and_or_b32 v115, v1, s63, v115
    s_add_u32 m0, s51, 0
    s_nop 0
    buffer_load_dwordx4 v112, s[28:31], s64 offen lds
    s_add_u32 m0, s51, 1024
    s_nop 0
    buffer_load_dwordx4 v112, s[28:31], s65 offen lds
    s_add_u32 m0, s51, 2048
    s_nop 0
    buffer_load_dwordx4 v112, s[28:31], s66 offen lds
    s_add_u32 m0, s51, 3072
    s_nop 0
    buffer_load_dwordx4 v113, s[28:31], s64 offen lds
    s_add_u32 m0, s51, 4096
    s_nop 0
    buffer_load_dwordx4 v113, s[28:31], s65 offen lds
    s_add_u32 m0, s51, 5120
    s_nop 0
    buffer_load_dwordx4 v113, s[28:31], s66 offen lds
    s_add_u32 m0, s51, 6144
    s_nop 0
    buffer_load_dwordx4 v114, s[28:31], s64 offen lds
    s_add_u32 m0, s51, 7168
    s_nop 0
    buffer_load_dwordx4 v114, s[28:31], s65 offen lds
    s_add_u32 m0, s51, 8192
    s_nop 0
    buffer_load_dwordx4 v114, s[28:31], s66 offen lds
    s_add_u32 m0, s51, 9216
    s_nop 0
    buffer_load_dwordx4 v115, s[28:31], s64 offen lds
    s_add_u32 m0, s51, 10240
    s_nop 0
    buffer_load_dwordx4 v115, s[28:31], s65 offen lds
    s_add_u32 m0, s51, 11264
    s_nop 0
    buffer_load_dwordx4 v115, s[28:31], s66 offen lds
M_nv22:
    v_mfma_f32_32x32x16_bf16 v[112:127], v[8:11], v[24:27], 0
    ds_read_b128 v[24:27], v1 offset:22528
    v_mfma_f32_32x32x16_bf16 v[96:111], v[32:35], v[28:31], 0
    ds_read_b128 v[28:31], v1 offset:23552
    v_mul_f32 v64, v64, v80
    v_mul_f32 v65, v65, v81
    v_mul_f32 v66, v66, v82
    v_mul_f32 v67, v67, v83
    v_mul_f32 v68, v68, v84
    v_mul_f32 v69, v69, v85
    v_mul_f32 v70, v70, v86
    v_mul_f32 v71, v71, v87
    v_mul_f32 v72, v72, v88
    v_mul_f32 v73, v73, v89
    v_mul_f32 v74, v74, v90
    v_mul_f32 v75, v75, v91
    s_waitcnt lgkmcnt(2)
    v_mfma_f32_32x32x16_bf16 v[96:111], v[36:39], v[20:23], v[96:111]
    v_mul_f32 v76, v76, v92
    v_mul_f32 v77, v77, v93
    v_mul_f32 v78, v78, v94
    v_mul_f32 v79, v79, v95
    ds_read_b64 v[80:81], v0 offset:2080
    ds_read_b64 v[88:89], v0 offset:2088
    ds_read_b64 v[82:83], v0 offset:2192
    ds_read_b64 v[90:91], v0 offset:2200
    ds_read_b64 v[84:85], v0 offset:2304
    ds_read_b64 v[92:93], v0 offset:2312
    ds_read_b64 v[86:87], v0 offset:2416
    ds_read_b64 v[94:95], v0 offset:2424
    v_cvt_pk_bf16_f32 v64, v64, v65
    v_cvt_pk_bf16_f32 v65, v66, v67
    v_cvt_pk_bf16_f32 v66, v68, v69
    v_cvt_pk_bf16_f32 v67, v70, v71
    v_cvt_pk_bf16_f32 v68, v72, v73
    v_cvt_pk_bf16_f32 v69, v74, v75
    v_cvt_pk_bf16_f32 v70, v76, v77
    s_waitcnt lgkmcnt(9)
    v_mfma_f32_32x32x16_bf16 v[96:111], v[40:43], v[24:27], v[96:111]
    v_cvt_pk_bf16_f32 v71, v78, v79
    v_pk_lshrrev_b16 v72, 14, v12 op_sel_hi:[0,1]
    v_pk_lshrrev_b16 v73, 14, v13 op_sel_hi:[0,1]
    v_pk_lshrrev_b16 v74, 14, v14 op_sel_hi:[0,1]
    v_pk_lshrrev_b16 v75, 14, v15 op_sel_hi:[0,1]
    v_pk_lshrrev_b16 v76, 14, v16 op_sel_hi:[0,1]
    v_pk_lshrrev_b16 v77, 14, v17 op_sel_hi:[0,1]
    v_pk_lshrrev_b16 v78, 14, v18 op_sel_hi:[0,1]
    v_pk_lshrrev_b16 v79, 14, v19 op_sel_hi:[0,1]
    s_waitcnt lgkmcnt(0)
    v_pk_mul_lo_u16 v80, v72, v80
    v_pk_mul_lo_u16 v81, v73, v81
    v_pk_mul_lo_u16 v82, v74, v82
    v_mfma_f32_32x32x16_bf16 v[96:111], v[44:47], v[28:31], v[96:111]
    v_pk_mul_lo_u16 v83, v75, v83
    v_pk_mul_lo_u16 v84, v76, v84
    v_pk_mul_lo_u16 v85, v77, v85
    v_pk_mul_lo_u16 v86, v78, v86
    v_pk_mul_lo_u16 v87, v79, v87
    v_pk_mul_lo_u16 v88, v72, v88
    v_pk_mul_lo_u16 v89, v73, v89
    v_pk_mul_lo_u16 v90, v74, v90
    v_pk_mul_lo_u16 v91, v75, v91
    v_pk_mul_lo_u16 v92, v76, v92
    v_pk_mul_lo_u16 v93, v77, v93
    v_pk_mul_lo_u16 v94, v78, v94
    v_pk_mul_lo_u16 v95, v79, v95
    v_mfma_f32_32x32x16_bf16 v[160:175], v[80:83], v[64:67], v[160:175]
    v_mul_f32 v96, v96, v112
    v_mul_f32 v97, v97, v113
    v_mul_f32 v98, v98, v114
    v_mul_f32 v99, v99, v115
    v_mul_f32 v100, v100, v116
    v_mul_f32 v101, v101, v117
    v_mfma_f32_32x32x16_bf16 v[160:175], v[84:87], v[68:71], v[160:175]
    v_mul_f32 v102, v102, v118
    v_mul_f32 v103, v103, v119
    v_mul_f32 v104, v104, v120
    v_mul_f32 v105, v105, v121
    v_mul_f32 v106, v106, v122
    v_mul_f32 v107, v107, v123
    v_mfma_f32_32x32x16_bf16 v[192:207], v[88:91], v[64:67], v[192:207]
    v_mul_f32 v108, v108, v124
    v_mul_f32 v109, v109, v125
    v_mul_f32 v110, v110, v126
    v_mul_f32 v111, v111, v127
    ds_read_b64 v[112:113], v0 offset:2096
    ds_read_b64 v[114:115], v0 offset:2208
    ds_read_b64 v[116:117], v0 offset:2320
    ds_read_b64 v[118:119], v0 offset:2432
    v_cvt_pk_bf16_f32 v96, v96, v97
    v_mfma_f32_32x32x16_bf16 v[192:207], v[92:95], v[68:71], v[192:207]
    v_cvt_pk_bf16_f32 v97, v98, v99
    v_cvt_pk_bf16_f32 v98, v100, v101
    v_cvt_pk_bf16_f32 v99, v102, v103
    v_cvt_pk_bf16_f32 v100, v104, v105
    v_cvt_pk_bf16_f32 v101, v106, v107
    v_cvt_pk_bf16_f32 v102, v108, v109
    v_cvt_pk_bf16_f32 v103, v110, v111
    s_waitcnt lgkmcnt(0)
    v_pk_mul_lo_u16 v112, v72, v112
    v_pk_mul_lo_u16 v113, v73, v113
    v_pk_mul_lo_u16 v114, v74, v114
    v_pk_mul_lo_u16 v115, v75, v115
    v_pk_mul_lo_u16 v116, v76, v116
    v_pk_mul_lo_u16 v117, v77, v117
    v_pk_mul_lo_u16 v118, v78, v118
    v_pk_mul_lo_u16 v119, v79, v119
    v_mfma_f32_32x32x16_bf16 v[176:191], v[80:83], v[96:99], v[176:191]
    ds_read_b128 v[104:107], v3 offset:512
    ds_read_b128 v[72:75], v7
    ds_read_b128 v[76:79], v7 offset:16
    ds_read_b64 v[12:13], v4 offset:2496
    ds_read_b64 v[14:15], v4 offset:2608
    ds_read_b64 v[16:17], v4 offset:2720
    ds_read_b64 v[18:19], v4 offset:2832
    ds_read_b128 v[20:23], v1 offset:24576
    ds_read_b128 v[24:27], v1 offset:0
    ds_read_b128 v[28:31], v1 offset:1024
    s_waitcnt lgkmcnt(7)
    v_mul_f32 v72, v104, v72
    v_mul_f32 v73, v104, v73
    v_mul_f32 v74, v104, v74
    v_mul_f32 v75, v104, v75
    v_mul_f32 v76, v104, v76
    v_mfma_f32_32x32x16_bf16 v[176:191], v[84:87], v[100:103], v[176:191]
    v_mul_f32 v77, v104, v77
    v_mul_f32 v78, v104, v78
    v_mul_f32 v79, v104, v79
    v_cvt_pk_bf16_f32 v72, 0, v72
    v_cvt_pk_bf16_f32 v73, 0, v73
    v_cvt_pk_bf16_f32 v74, 0, v74
    v_cvt_pk_bf16_f32 v75, 0, v75
    v_mfma_f32_32x32x16_bf16 v[208:223], v[88:91], v[96:99], v[208:223]
    v_cvt_pk_bf16_f32 v76, 0, v76
    v_cvt_pk_bf16_f32 v77, 0, v77
    v_cvt_pk_bf16_f32 v78, 0, v78
    v_cvt_pk_bf16_f32 v79, 0, v79
    v_mul_f32 v72, s61, v72
    v_mul_f32 v73, s61, v73
    v_mfma_f32_32x32x16_bf16 v[208:223], v[92:95], v[100:103], v[208:223]
    v_mul_f32 v74, s61, v74
    v_mul_f32 v75, s61, v75
    v_mul_f32 v76, s61, v76
    v_mul_f32 v77, s61, v77
    v_mul_f32 v78, s61, v78
    v_mul_f32 v79, s61, v79
    v_sin_f32 v72, v72
    v_mfma_f32_32x32x16_bf16 v[224:239], v[112:115], v[64:67], v[224:239]
    v_sin_f32 v73, v73
    v_sin_f32 v74, v74
    v_sin_f32 v75, v75
    v_sin_f32 v76, v76
    v_sin_f32 v77, v77
    v_sin_f32 v78, v78
    v_sin_f32 v79, v79
    v_mfma_f32_32x32x16_bf16 v[240:255], v[112:115], v[96:99], v[240:255]
    v_mul_f32 v72, v72, v105
    v_mul_f32 v73, v73, v105
    v_mul_f32 v74, v74, v105
    v_mul_f32 v75, v75, v105
    v_mul_f32 v76, v76, v105
    v_mul_f32 v77, v77, v105
    v_mfma_f32_32x32x16_bf16 v[224:239], v[116:119], v[68:71], v[224:239]
    v_mul_f32 v78, v78, v105
    v_mul_f32 v79, v79, v105
    v_cvt_pk_bf16_f32 v8, v72, v73
    v_cvt_pk_bf16_f32 v9, v74, v75
    v_cvt_pk_bf16_f32 v10, v76, v77
    v_cvt_pk_bf16_f32 v11, v78, v79
    s_waitcnt lgkmcnt(3)
    v_pk_lshlrev_b16 v12, v6, v12
    v_mfma_f32_32x32x16_bf16 v[240:255], v[116:119], v[100:103], v[240:255]
    v_pk_lshlrev_b16 v13, v6, v13
    v_pk_lshlrev_b16 v14, v6, v14
    v_pk_lshlrev_b16 v15, v6, v15
    v_pk_lshlrev_b16 v16, v6, v16
    v_pk_lshlrev_b16 v17, v6, v17
    v_pk_lshlrev_b16 v18, v6, v18
    v_pk_lshlrev_b16 v19, v6, v19
    v_add_u32 v3, 512, v3
    v_add_u32 v4, 448, v4
    v_add_u32 v0, 448, v0
    v_add_u32 v5, 512, v5
    s_waitcnt lgkmcnt(0)
    s_add_u32 s49, s49, 1
    s_cmp_lt_u32 s49, s48
    s_cbranch_scc0 M_wend
    s_waitcnt vmcnt(12)
    v_mfma_f32_32x32x16_bf16 v[80:95], v[8:11], v[20:23], 0
    ds_read_b128 v[20:23], v1 offset:2048
    s_add_u32 s77, s49, 1
    s_cmp_lt_u32 s77, s48
    s_cselect_b32 s77, 0, 0x40000000
    ds_read_b32 v47, v3 offset:524
    v_bfe_u32 v46, v1, 9, 1
    s_waitcnt lgkmcnt(0)
    v_lshrrev_b32 v47, 2, v47
    v_lshl_add_u32 v47, v46, 6, v47
    buffer_load_dwordx4 v[32:35], v47, s[72:75], s77 offen offset:0
    buffer_load_dwordx4 v[36:39], v47, s[72:75], s77 offen offset:16
    buffer_load_dwordx4 v[40:43], v47, s[72:75], s77 offen offset:32
    buffer_load_dwordx4 v[44:47], v47, s[72:75], s77 offen offset:48
    v_mfma_f32_32x32x16_bf16 v[64:79], v[48:51], v[24:27], 0
    ds_read_b128 v[24:27], v1 offset:3072
    v_mfma_f32_32x32x16_bf16 v[64:79], v[52:55], v[28:31], v[64:79]
    ds_read_b128 v[28:31], v1 offset:25600
    v_mfma_f32_32x32x16_bf16 v[64:79], v[56:59], v[20:23], v[64:79]
    ds_read_b128 v[20:23], v1 offset:4096
    s_waitcnt lgkmcnt(2)
    v_mfma_f32_32x32x16_bf16 v[64:79], v[60:63], v[24:27], v[64:79]
    ds_read_b128 v[24:27], v1 offset:5120
    s_waitcnt lgkmcnt(2)
    v_mfma_f32_32x32x16_bf16 v[112:127], v[8:11], v[28:31], 0
    ds_read_b128 v[28:31], v1 offset:6144
    s_waitcnt lgkmcnt(2)
    v_mfma_f32_32x32x16_bf16 v[96:111], v[48:51], v[20:23], 0
    ds_read_b128 v[20:23], v1 offset:7168
    s_nop 4
    v_mul_f32 v64, v64, v80
    v_mul_f32 v65, v65, v81
    v_mul_f32 v66, v66, v82
    v_mul_f32 v67, v67, v83
    v_mul_f32 v68, v68, v84
    v_mul_f32 v69, v69, v85
    s_waitcnt lgkmcnt(2)
    v_mfma_f32_32x32x16_bf16 v[96:111], v[52:55], v[24:27], v[96:111]
    ds_read_b128 v[24:27], v1 offset:26624
    v_mul_f32 v70, v70, v86
    v_mul_f32 v71, v71, v87
    v_mul_f32 v72, v72, v88
    v_mul_f32 v73, v73, v89
    v_mul_f32 v74, v74, v90
    v_mul_f32 v75, v75, v91
    v_mul_f32 v76, v76, v92
    s_waitcnt lgkmcnt(2)
    v_mfma_f32_32x32x16_bf16 v[96:111], v[56:59], v[28:31], v[96:111]
    ds_read_b128 v[28:31], v1 offset:8192
    v_mul_f32 v77, v77, v93
    v_mul_f32 v78, v78, v94
    v_mul_f32 v79, v79, v95
    v_cvt_pk_bf16_f32 v64, v64, v65
    v_cvt_pk_bf16_f32 v65, v66, v67
    v_cvt_pk_bf16_f32 v66, v68, v69
    s_waitcnt lgkmcnt(2)
    v_mfma_f32_32x32x16_bf16 v[96:111], v[60:63], v[20:23], v[96:111]
    ds_read_b128 v[20:23], v1 offset:9216
    v_cvt_pk_bf16_f32 v67, v70, v71
    v_cvt_pk_bf16_f32 v68, v72, v73
    v_cvt_pk_bf16_f32 v69, v74, v75
    v_cvt_pk_bf16_f32 v70, v76, v77
    v_cvt_pk_bf16_f32 v71, v78, v79
    v_mfma_f32_32x32x16_bf16 v[128:143], v[12:15], v[64:67], v[128:143]
    s_nop 0
WUP_3316:
    s_cbranch_execz WUR_1
    v_mfma_f32_32x32x16_bf16 v[128:143], v[16:19], v[68:71], v[128:143]
    s_waitcnt lgkmcnt(2)
    v_mfma_f32_32x32x16_bf16 v[80:95], v[8:11], v[24:27], 0
    ds_read_b128 v[24:27], v1 offset:10240
    s_waitcnt lgkmcnt(2)
    v_mfma_f32_32x32x16_bf16 v[64:79], v[48:51], v[28:31], 0
    ds_read_b128 v[28:31], v1 offset:11264
    v_mul_f32 v96, v96, v112
    v_mul_f32 v97, v97, v113
    v_mul_f32 v98, v98, v114
    v_mul_f32 v99, v99, v115
    v_mul_f32 v100, v100, v116
    v_mul_f32 v101, v101, v117
    s_waitcnt lgkmcnt(2)
    v_mfma_f32_32x32x16_bf16 v[64:79], v[52:55], v[20:23], v[64:79]
    ds_read_b128 v[20:23], v1 offset:27648
    v_mul_f32 v102, v102, v118
    v_mul_f32 v103, v103, v119
    v_mul_f32 v104, v104, v120
    v_mul_f32 v105, v105, v121
    v_mul_f32 v106, v106, v122
    v_mul_f32 v107, v107, v123
    v_mul_f32 v108, v108, v124
    s_waitcnt lgkmcnt(2)
    v_mfma_f32_32x32x16_bf16 v[64:79], v[56:59], v[24:27], v[64:79]
    ds_read_b128 v[24:27], v1 offset:12288
    v_mul_f32 v109, v109, v125
    v_mul_f32 v110, v110, v126
    v_mul_f32 v111, v111, v127
    v_cvt_pk_bf16_f32 v96, v96, v97
    v_cvt_pk_bf16_f32 v97, v98, v99
    v_cvt_pk_bf16_f32 v98, v100, v101
    s_waitcnt lgkmcnt(2)
    v_mfma_f32_32x32x16_bf16 v[64:79], v[60:63], v[28:31], v[64:79]
    ds_read_b128 v[28:31], v1 offset:13312
    v_cvt_pk_bf16_f32 v99, v102, v103
    v_cvt_pk_bf16_f32 v100, v104, v105
    v_cvt_pk_bf16_f32 v101, v106, v107
    v_cvt_pk_bf16_f32 v102, v108, v109
    v_cvt_pk_bf16_f32 v103, v110, v111
    v_mfma_f32_32x32x16_bf16 v[144:159], v[12:15], v[96:99], v[144:159]
    s_nop 0
    v_mfma_f32_32x32x16_bf16 v[144:159], v[16:19], v[100:103], v[144:159]
    s_waitcnt lgkmcnt(2)
    v_mfma_f32_32x32x16_bf16 v[112:127], v[8:11], v[20:23], 0
    ds_read_b128 v[20:23], v1 offset:14336
    s_waitcnt lgkmcnt(2)
    v_mfma_f32_32x32x16_bf16 v[96:111], v[48:51], v[24:27], 0
    ds_read_b128 v[24:27], v1 offset:15360
    v_mul_f32 v64, v64, v80
    v_mul_f32 v65, v65, v81
    v_mul_f32 v66, v66, v82
    v_mul_f32 v67, v67, v83
    v_mul_f32 v68, v68, v84
    v_mul_f32 v69, v69, v85
    v_mul_f32 v70, v70, v86
    v_mul_f32 v71, v71, v87
    v_mul_f32 v72, v72, v88
    v_mul_f32 v73, v73, v89
    v_mul_f32 v74, v74, v90
    v_mul_f32 v75, v75, v91
    v_mul_f32 v76, v76, v92
    v_mul_f32 v77, v77, v93
    v_mul_f32 v78, v78, v94
    v_mul_f32 v79, v79, v95
    s_waitcnt vmcnt(4)
    ds_read_u16_d16_hi v80, v2 offset:0
    ds_read_u16_d16_hi v81, v2 offset:256
    ds_read_u16_d16_hi v82, v2 offset:512
    ds_read_u16_d16_hi v83, v2 offset:768
    ds_read_u16_d16_hi v84, v2 offset:3072
    ds_read_u16_d16_hi v85, v2 offset:3328
    ds_read_u16_d16_hi v86, v2 offset:3584
    ds_read_u16_d16_hi v87, v2 offset:3840
    ds_read_u16_d16_hi v88, v2 offset:6144
    ds_read_u16_d16_hi v89, v2 offset:6400
    ds_read_u16_d16_hi v90, v2 offset:6656
    ds_read_u16_d16_hi v91, v2 offset:6912
    ds_read_u16_d16_hi v92, v2 offset:9216
    ds_read_u16_d16_hi v93, v2 offset:9472
    ds_read_u16_d16_hi v94, v2 offset:9728
    ds_read_u16_d16_hi v95, v2 offset:9984
    s_waitcnt lgkmcnt(12)
    v_mul_f32 v80, v80, v64
    v_mul_f32 v81, v81, v65
    v_mul_f32 v82, v82, v66
    v_mul_f32 v83, v83, v67
    s_waitcnt lgkmcnt(8)
    v_mul_f32 v84, v84, v68
    v_mul_f32 v85, v85, v69
    v_mfma_f32_32x32x16_bf16 v[96:111], v[52:55], v[28:31], v[96:111]
    ds_read_b128 v[28:31], v1 offset:28672
    v_mul_f32 v86, v86, v70
    v_mul_f32 v87, v87, v71
    v_cvt_pk_bf16_f32 v80, v80, v81
    v_cvt_pk_bf16_f32 v81, v82, v83
    v_cvt_pk_bf16_f32 v82, v84, v85
    v_cvt_pk_bf16_f32 v83, v86, v87
    s_nop 1
    v_mfma_f32_32x32x16_bf16 v[160:175], v[12:15], v[80:83], v[160:175]
    ds_read_u16_d16_hi v80, v2 offset:1024
    ds_read_u16_d16_hi v81, v2 offset:1280
    ds_read_u16_d16_hi v82, v2 offset:1536
    ds_read_u16_d16_hi v83, v2 offset:1792
    ds_read_u16_d16_hi v84, v2 offset:4096
    ds_read_u16_d16_hi v85, v2 offset:4352
    ds_read_u16_d16_hi v86, v2 offset:4608
    ds_read_u16_d16_hi v87, v2 offset:4864
    s_waitcnt lgkmcnt(13)
    v_mul_f32 v88, v88, v72
    v_mul_f32 v89, v89, v73
    v_mul_f32 v90, v90, v74
    v_mul_f32 v91, v91, v75
    s_waitcnt lgkmcnt(9)
    v_mul_f32 v92, v92, v76
    v_mul_f32 v93, v93, v77
    v_mul_f32 v94, v94, v78
    v_mul_f32 v95, v95, v79
    v_cvt_pk_bf16_f32 v88, v88, v89
    v_cvt_pk_bf16_f32 v89, v90, v91
    v_cvt_pk_bf16_f32 v90, v92, v93
    v_cvt_pk_bf16_f32 v91, v94, v95
    s_nop 1
    v_mfma_f32_32x32x16_bf16 v[160:175], v[16:19], v[88:91], v[160:175]
    ds_read_u16_d16_hi v88, v2 offset:7168
    ds_read_u16_d16_hi v89, v2 offset:7424
    ds_read_u16_d16_hi v90, v2 offset:7680
    ds_read_u16_d16_hi v91, v2 offset:7936
    ds_read_u16_d16_hi v92, v2 offset:10240
    ds_read_u16_d16_hi v93, v2 offset:10496
    ds_read_u16_d16_hi v94, v2 offset:10752
    ds_read_u16_d16_hi v95, v2 offset:11008
    s_waitcnt lgkmcnt(12)
    v_mul_f32 v80, v80, v64
    v_mul_f32 v81, v81, v65
    v_mul_f32 v82, v82, v66
    v_mfma_f32_32x32x16_bf16 v[96:111], v[56:59], v[20:23], v[96:111]
    ds_read_b128 v[20:23], v1 offset:16384
    v_mul_f32 v83, v83, v67
    s_waitcnt lgkmcnt(9)
    v_mul_f32 v84, v84, v68
    v_mul_f32 v85, v85, v69
    v_mul_f32 v86, v86, v70
    v_mul_f32 v87, v87, v71
    v_cvt_pk_bf16_f32 v80, v80, v81
    v_cvt_pk_bf16_f32 v81, v82, v83
    v_cvt_pk_bf16_f32 v82, v84, v85
    v_cvt_pk_bf16_f32 v83, v86, v87
    s_nop 1
    v_mfma_f32_32x32x16_bf16 v[192:207], v[12:15], v[80:83], v[192:207]
    ds_read_u16_d16_hi v80, v2 offset:2048
    ds_read_u16_d16_hi v81, v2 offset:2304
    ds_read_u16_d16_hi v82, v2 offset:2560
    ds_read_u16_d16_hi v83, v2 offset:2816
    ds_read_u16_d16_hi v84, v2 offset:5120
    ds_read_u16_d16_hi v85, v2 offset:5376
    ds_read_u16_d16_hi v86, v2 offset:5632
    ds_read_u16_d16_hi v87, v2 offset:5888
    s_waitcnt lgkmcnt(13)
    v_mul_f32 v88, v88, v72
    v_mul_f32 v89, v89, v73
    v_mul_f32 v90, v90, v74
    v_mul_f32 v91, v91, v75
    s_waitcnt lgkmcnt(9)
    v_mul_f32 v92, v92, v76
    v_mul_f32 v93, v93, v77
    v_mul_f32 v94, v94, v78
    v_mul_f32 v95, v95, v79
    v_cvt_pk_bf16_f32 v88, v88, v89
    v_cvt_pk_bf16_f32 v89, v90, v91
    v_cvt_pk_bf16_f32 v90, v92, v93
    v_cvt_pk_bf16_f32 v91, v94, v95
    s_nop 1
    v_mfma_f32_32x32x16_bf16 v[192:207], v[16:19], v[88:91], v[192:207]
    ds_read_u16_d16_hi v88, v2 offset:8192
    ds_read_u16_d16_hi v89, v2 offset:8448
    ds_read_u16_d16_hi v90, v2 offset:8704
    ds_read_u16_d16_hi v91, v2 offset:8960
    ds_read_u16_d16_hi v92, v2 offset:11264
    ds_read_u16_d16_hi v93, v2 offset:11520
    ds_read_u16_d16_hi v94, v2 offset:11776
    ds_read_u16_d16_hi v95, v2 offset:12032
    v_mfma_f32_32x32x16_bf16 v[96:111], v[60:63], v[24:27], v[96:111]
    ds_read_b128 v[24:27], v1 offset:17408
    s_waitcnt lgkmcnt(13)
    v_mul_f32 v80, v80, v64
    v_mul_f32 v81, v81, v65
    v_mul_f32 v82, v82, v66
    v_mul_f32 v83, v83, v67
    s_waitcnt lgkmcnt(9)
    v_mul_f32 v84, v84, v68
    v_mul_f32 v85, v85, v69
    v_mul_f32 v86, v86, v70
    v_mul_f32 v87, v87, v71
    v_cvt_pk_bf16_f32 v80, v80, v81
    v_cvt_pk_bf16_f32 v81, v82, v83
    v_cvt_pk_bf16_f32 v82, v84, v85
    v_cvt_pk_bf16_f32 v83, v86, v87
    s_nop 1
    v_mfma_f32_32x32x16_bf16 v[224:239], v[12:15], v[80:83], v[224:239]
    s_waitcnt lgkmcnt(5)
    v_mul_f32 v88, v88, v72
    v_mul_f32 v89, v89, v73
    v_mul_f32 v90, v90, v74
    v_mul_f32 v91, v91, v75
    s_waitcnt lgkmcnt(1)
    v_mul_f32 v92, v92, v76
    v_mul_f32 v93, v93, v77
    v_mul_f32 v94, v94, v78
    v_mul_f32 v95, v95, v79
    v_cvt_pk_bf16_f32 v88, v88, v89
    v_cvt_pk_bf16_f32 v89, v90, v91
    v_cvt_pk_bf16_f32 v90, v92, v93
    v_cvt_pk_bf16_f32 v91, v94, v95
    s_nop 1
    v_mfma_f32_32x32x16_bf16 v[224:239], v[16:19], v[88:91], v[224:239]
    v_mfma_f32_32x32x16_bf16 v[80:95], v[8:11], v[28:31], 0
    ds_read_b128 v[28:31], v1 offset:18432
    v_mfma_f32_32x32x16_bf16 v[64:79], v[48:51], v[20:23], 0
    ds_read_b128 v[20:23], v1 offset:19456
    v_mul_f32 v96, v96, v112
    v_mul_f32 v97, v97, v113
    v_mul_f32 v98, v98, v114
    v_mul_f32 v99, v99, v115
    v_mul_f32 v100, v100, v116
    v_mul_f32 v101, v101, v117
    v_mul_f32 v102, v102, v118
    v_mul_f32 v103, v103, v119
    v_mul_f32 v104, v104, v120
    v_mul_f32 v105, v105, v121
    v_mul_f32 v106, v106, v122
    v_mul_f32 v107, v107, v123
    v_mul_f32 v108, v108, v124
    v_mul_f32 v109, v109, v125
    v_mul_f32 v110, v110, v126
    v_mul_f32 v111, v111, v127
    ds_read_u16_d16_hi v112, v2 offset:2
    ds_read_u16_d16_hi v113, v2 offset:258
    ds_read_u16_d16_hi v114, v2 offset:514
    ds_read_u16_d16_hi v115, v2 offset:770
    ds_read_u16_d16_hi v116, v2 offset:3074
    ds_read_u16_d16_hi v117, v2 offset:3330
    ds_read_u16_d16_hi v118, v2 offset:3586
    ds_read_u16_d16_hi v119, v2 offset:3842
    ds_read_u16_d16_hi v120, v2 offset:6146
    ds_read_u16_d16_hi v121, v2 offset:6402
    ds_read_u16_d16_hi v122, v2 offset:6658
    ds_read_u16_d16_hi v123, v2 offset:6914
    ds_read_u16_d16_hi v124, v2 offset:9218
    ds_read_u16_d16_hi v125, v2 offset:9474
    ds_read_u16_d16_hi v126, v2 offset:9730
    ds_read_u16_d16_hi v127, v2 offset:9986
    s_waitcnt lgkmcnt(12)
    v_mul_f32 v112, v112, v96
    v_mul_f32 v113, v113, v97
    v_mul_f32 v114, v114, v98
    v_mul_f32 v115, v115, v99
    s_waitcnt lgkmcnt(8)
    v_mul_f32 v116, v116, v100
    v_mul_f32 v117, v117, v101
    v_mul_f32 v118, v118, v102
    v_mfma_f32_32x32x16_bf16 v[64:79], v[52:55], v[24:27], v[64:79]
    ds_read_b128 v[24:27], v1 offset:29696
    v_mul_f32 v119, v119, v103
    v_cvt_pk_bf16_f32 v112, v112, v113
    v_cvt_pk_bf16_f32 v113, v114, v115
    v_cvt_pk_bf16_f32 v114, v116, v117
    v_cvt_pk_bf16_f32 v115, v118, v119
    s_nop 1
    v_mfma_f32_32x32x16_bf16 v[176:191], v[12:15], v[112:115], v[176:191]
    ds_read_u16_d16_hi v112, v2 offset:1026
    ds_read_u16_d16_hi v113, v2 offset:1282
    ds_read_u16_d16_hi v114, v2 offset:1538
    ds_read_u16_d16_hi v115, v2 offset:1794
    ds_read_u16_d16_hi v116, v2 offset:4098
    ds_read_u16_d16_hi v117, v2 offset:4354
    ds_read_u16_d16_hi v118, v2 offset:4610
    ds_read_u16_d16_hi v119, v2 offset:4866
    s_waitcnt lgkmcnt(13)
    v_mul_f32 v120, v120, v104
    v_mul_f32 v121, v121, v105
    v_mul_f32 v122, v122, v106
    v_mul_f32 v123, v123, v107
    s_waitcnt lgkmcnt(9)
    v_mul_f32 v124, v124, v108
    v_mul_f32 v125, v125, v109
    v_mul_f32 v126, v126, v110
    v_mul_f32 v127, v127, v111
    v_cvt_pk_bf16_f32 v120, v120, v121
    v_cvt_pk_bf16_f32 v121, v122, v123
    v_cvt_pk_bf16_f32 v122, v124, v125
    v_cvt_pk_bf16_f32 v123, v126, v127
    s_nop 1
    v_mfma_f32_32x32x16_bf16 v[176:191], v[16:19], v[120:123], v[176:191]
    ds_read_u16_d16_hi v120, v2 offset:7170
    ds_read_u16_d16_hi v121, v2 offset:7426
    ds_read_u16_d16_hi v122, v2 offset:7682
    ds_read_u16_d16_hi v123, v2 offset:7938
    ds_read_u16_d16_hi v124, v2 offset:10242
    ds_read_u16_d16_hi v125, v2 offset:10498
    ds_read_u16_d16_hi v126, v2 offset:10754
    ds_read_u16_d16_hi v127, v2 offset:11010
    s_waitcnt lgkmcnt(12)
    v_mul_f32 v112, v112, v96
    v_mul_f32 v113, v113, v97
    v_mul_f32 v114, v114, v98
    v_mul_f32 v115, v115, v99
    v_mfma_f32_32x32x16_bf16 v[64:79], v[56:59], v[28:31], v[64:79]
    ds_read_b128 v[28:31], v1 offset:20480
    s_waitcnt lgkmcnt(9)
    v_mul_f32 v116, v116, v100
    v_mul_f32 v117, v117, v101
    v_mul_f32 v118, v118, v102
    v_mul_f32 v119, v119, v103
    v_cvt_pk_bf16_f32 v112, v112, v113
    v_cvt_pk_bf16_f32 v113, v114, v115
    v_cvt_pk_bf16_f32 v114, v116, v117
    v_cvt_pk_bf16_f32 v115, v118, v119
    s_nop 1
    v_mfma_f32_32x32x16_bf16 v[208:223], v[12:15], v[112:115], v[208:223]
    ds_read_u16_d16_hi v112, v2 offset:2050
    ds_read_u16_d16_hi v113, v2 offset:2306
    ds_read_u16_d16_hi v114, v2 offset:2562
    ds_read_u16_d16_hi v115, v2 offset:2818
    ds_read_u16_d16_hi v116, v2 offset:5122
    ds_read_u16_d16_hi v117, v2 offset:5378
    ds_read_u16_d16_hi v118, v2 offset:5634
    ds_read_u16_d16_hi v119, v2 offset:5890
    s_waitcnt lgkmcnt(13)
    v_mul_f32 v120, v120, v104
    v_mul_f32 v121, v121, v105
    v_mul_f32 v122, v122, v106
    v_mul_f32 v123, v123, v107
    s_waitcnt lgkmcnt(9)
    v_mul_f32 v124, v124, v108
    v_mul_f32 v125, v125, v109
    v_mul_f32 v126, v126, v110
    v_mul_f32 v127, v127, v111
    v_cvt_pk_bf16_f32 v120, v120, v121
    v_cvt_pk_bf16_f32 v121, v122, v123
    v_cvt_pk_bf16_f32 v122, v124, v125
    v_cvt_pk_bf16_f32 v123, v126, v127
    s_nop 1
    v_mfma_f32_32x32x16_bf16 v[208:223], v[16:19], v[120:123], v[208:223]
    ds_read_u16_d16_hi v120, v2 offset:8194
    ds_read_u16_d16_hi v121, v2 offset:8450
    ds_read_u16_d16_hi v122, v2 offset:8706
    ds_read_u16_d16_hi v123, v2 offset:8962
    ds_read_u16_d16_hi v124, v2 offset:11266
    ds_read_u16_d16_hi v125, v2 offset:11522
    ds_read_u16_d16_hi v126, v2 offset:11778
    ds_read_u16_d16_hi v127, v2 offset:12034
    s_waitcnt lgkmcnt(12)
    v_mul_f32 v112, v112, v96
    v_mfma_f32_32x32x16_bf16 v[64:79], v[60:63], v[20:23], v[64:79]
    ds_read_b128 v[20:23], v1 offset:21504
    v_mul_f32 v113, v113, v97
    v_mul_f32 v114, v114, v98
    v_mul_f32 v115, v115, v99
    s_waitcnt lgkmcnt(9)
    v_mul_f32 v116, v116, v100
    v_mul_f32 v117, v117, v101
    v_mul_f32 v118, v118, v102
    v_mul_f32 v119, v119, v103
    v_cvt_pk_bf16_f32 v112, v112, v113
    v_cvt_pk_bf16_f32 v113, v114, v115
    v_cvt_pk_bf16_f32 v114, v116, v117
    v_cvt_pk_bf16_f32 v115, v118, v119
    s_nop 1
    v_mfma_f32_32x32x16_bf16 v[240:255], v[12:15], v[112:115], v[240:255]
    s_waitcnt lgkmcnt(5)
    v_mul_f32 v120, v120, v104
    v_mul_f32 v121, v121, v105
    v_mul_f32 v122, v122, v106
    v_mul_f32 v123, v123, v107
    s_waitcnt lgkmcnt(1)
    v_mul_f32 v124, v124, v108
    v_mul_f32 v125, v125, v109
    v_mul_f32 v126, v126, v110
    v_mul_f32 v127, v127, v111
    v_cvt_pk_bf16_f32 v120, v120, v121
    v_cvt_pk_bf16_f32 v121, v122, v123
    v_cvt_pk_bf16_f32 v122, v124, v125
    v_cvt_pk_bf16_f32 v123, v126, v127
    s_nop 1
    v_mfma_f32_32x32x16_bf16 v[240:255], v[16:19], v[120:123], v[240:255]
    s_cmp_lg_u32 s77, 0
    s_nop 10
    s_cbranch_scc1 M_nv23
    ds_read_b32 v112, v5 offset:524
    ds_read_b32 v113, v5 offset:652
    ds_read_b32 v114, v5 offset:780
    ds_read_b32 v115, v5 offset:908
    s_waitcnt lgkmcnt(3)
    v_and_or_b32 v112, v1, s63, v112
    s_waitcnt lgkmcnt(2)
    v_and_or_b32 v113, v1, s63, v113
    s_waitcnt lgkmcnt(1)
    v_and_or_b32 v114, v1, s63, v114
    s_waitcnt lgkmcnt(0)
    v_and_or_b32 v115, v1, s63, v115
    s_add_u32 m0, s51, 0
    s_nop 0
    buffer_load_dwordx4 v112, s[28:31], s64 offen lds
    s_add_u32 m0, s51, 1024
    s_nop 0
    buffer_load_dwordx4 v112, s[28:31], s65 offen lds
    s_add_u32 m0, s51, 2048
    s_nop 0
    buffer_load_dwordx4 v112, s[28:31], s66 offen lds
    s_add_u32 m0, s51, 3072
    s_nop 0
    buffer_load_dwordx4 v113, s[28:31], s64 offen lds
    s_add_u32 m0, s51, 4096
    s_nop 0
    buffer_load_dwordx4 v113, s[28:31], s65 offen lds
    s_add_u32 m0, s51, 5120
    s_nop 0
    buffer_load_dwordx4 v113, s[28:31], s66 offen lds
    s_add_u32 m0, s51, 6144
    s_nop 0
    buffer_load_dwordx4 v114, s[28:31], s64 offen lds
    s_add_u32 m0, s51, 7168
    s_nop 0
    buffer_load_dwordx4 v114, s[28:31], s65 offen lds
    s_add_u32 m0, s51, 8192
    s_nop 0
    buffer_load_dwordx4 v114, s[28:31], s66 offen lds
    s_add_u32 m0, s51, 9216
    s_nop 0
    buffer_load_dwordx4 v115, s[28:31], s64 offen lds
    s_add_u32 m0, s51, 10240
    s_nop 0
    buffer_load_dwordx4 v115, s[28:31], s65 offen lds
    s_add_u32 m0, s51, 11264
    s_nop 0
    buffer_load_dwordx4 v115, s[28:31], s66 offen lds
M_nv23:
    v_mfma_f32_32x32x16_bf16 v[112:127], v[8:11], v[24:27], 0
    ds_read_b128 v[24:27], v1 offset:22528
    v_mfma_f32_32x32x16_bf16 v[96:111], v[48:51], v[28:31], 0
    ds_read_b128 v[28:31], v1 offset:23552
    v_mul_f32 v64, v64, v80
    v_mul_f32 v65, v65, v81
    v_mul_f32 v66, v66, v82
    v_mul_f32 v67, v67, v83
    v_mul_f32 v68, v68, v84
    v_mul_f32 v69, v69, v85
    v_mul_f32 v70, v70, v86
    v_mul_f32 v71, v71, v87
    v_mul_f32 v72, v72, v88
    v_mul_f32 v73, v73, v89
    v_mul_f32 v74, v74, v90
    v_mul_f32 v75, v75, v91
    s_waitcnt lgkmcnt(2)
    v_mfma_f32_32x32x16_bf16 v[96:111], v[52:55], v[20:23], v[96:111]
    v_mul_f32 v76, v76, v92
    v_mul_f32 v77, v77, v93
    v_mul_f32 v78, v78, v94
    v_mul_f32 v79, v79, v95
    ds_read_b64 v[80:81], v0 offset:2080
    ds_read_b64 v[88:89], v0 offset:2088
    ds_read_b64 v[82:83], v0 offset:2192
    ds_read_b64 v[90:91], v0 offset:2200
    ds_read_b64 v[84:85], v0 offset:2304
    ds_read_b64 v[92:93], v0 offset:2312
    ds_read_b64 v[86:87], v0 offset:2416
    ds_read_b64 v[94:95], v0 offset:2424
    v_cvt_pk_bf16_f32 v64, v64, v65
    v_cvt_pk_bf16_f32 v65, v66, v67
    v_cvt_pk_bf16_f32 v66, v68, v69
    v_cvt_pk_bf16_f32 v67, v70, v71
    v_cvt_pk_bf16_f32 v68, v72, v73
    v_cvt_pk_bf16_f32 v69, v74, v75
    v_cvt_pk_bf16_f32 v70, v76, v77
    s_waitcnt lgkmcnt(9)
    v_mfma_f32_32x32x16_bf16 v[96:111], v[56:59], v[24:27], v[96:111]
    v_cvt_pk_bf16_f32 v71, v78, v79
    v_pk_lshrrev_b16 v72, 14, v12 op_sel_hi:[0,1]
    v_pk_lshrrev_b16 v73, 14, v13 op_sel_hi:[0,1]
    v_pk_lshrrev_b16 v74, 14, v14 op_sel_hi:[0,1]
    v_pk_lshrrev_b16 v75, 14, v15 op_sel_hi:[0,1]
    v_pk_lshrrev_b16 v76, 14, v16 op_sel_hi:[0,1]
    v_pk_lshrrev_b16 v77, 14, v17 op_sel_hi:[0,1]
    v_pk_lshrrev_b16 v78, 14, v18 op_sel_hi:[0,1]
    v_pk_lshrrev_b16 v79, 14, v19 op_sel_hi:[0,1]
    s_waitcnt lgkmcnt(0)
    v_pk_mul_lo_u16 v80, v72, v80
    v_pk_mul_lo_u16 v81, v73, v81
    v_pk_mul_lo_u16 v82, v74, v82
    v_mfma_f32_32x32x16_bf16 v[96:111], v[60:63], v[28:31], v[96:111]
    v_pk_mul_lo_u16 v83, v75, v83
    v_pk_mul_lo_u16 v84, v76, v84
    v_pk_mul_lo_u16 v85, v77, v85
    v_pk_mul_lo_u16 v86, v78, v86
    v_pk_mul_lo_u16 v87, v79, v87
    v_pk_mul_lo_u16 v88, v72, v88
    v_pk_mul_lo_u16 v89, v73, v89
    v_pk_mul_lo_u16 v90, v74, v90
    v_pk_mul_lo_u16 v91, v75, v91
    v_pk_mul_lo_u16 v92, v76, v92
    v_pk_mul_lo_u16 v93, v77, v93
    v_pk_mul_lo_u16 v94, v78, v94
    v_pk_mul_lo_u16 v95, v79, v95
    v_mfma_f32_32x32x16_bf16 v[160:175], v[80:83], v[64:67], v[160:175]
    v_mul_f32 v96, v96, v112
    v_mul_f32 v97, v97, v113
    v_mul_f32 v98, v98, v114
    v_mul_f32 v99, v99, v115
    v_mul_f32 v100, v100, v116
    v_mul_f32 v101, v101, v117
    v_mfma_f32_32x32x16_bf16 v[160:175], v[84:87], v[68:71], v[160:175]
    v_mul_f32 v102, v102, v118
    v_mul_f32 v103, v103, v119
    v_mul_f32 v104, v104, v120
    v_mul_f32 v105, v105, v121
    v_mul_f32 v106, v106, v122
    v_mul_f32 v107, v107, v123
    v_mfma_f32_32x32x16_bf16 v[192:207], v[88:91], v[64:67], v[192:207]
    v_mul_f32 v108, v108, v124
    v_mul_f32 v109, v109, v125
    v_mul_f32 v110, v110, v126
    v_mul_f32 v111, v111, v127
    ds_read_b64 v[112:113], v0 offset:2096
    ds_read_b64 v[114:115], v0 offset:2208
    ds_read_b64 v[116:117], v0 offset:2320
    ds_read_b64 v[118:119], v0 offset:2432
    v_cvt_pk_bf16_f32 v96, v96, v97
    v_mfma_f32_32x32x16_bf16 v[192:207], v[92:95], v[68:71], v[192:207]
    v_cvt_pk_bf16_f32 v97, v98, v99
    v_cvt_pk_bf16_f32 v98, v100, v101
    v_cvt_pk_bf16_f32 v99, v102, v103
    v_cvt_pk_bf16_f32 v100, v104, v105
    v_cvt_pk_bf16_f32 v101, v106, v107
    v_cvt_pk_bf16_f32 v102, v108, v109
    v_cvt_pk_bf16_f32 v103, v110, v111
    s_waitcnt lgkmcnt(0)
    v_pk_mul_lo_u16 v112, v72, v112
    v_pk_mul_lo_u16 v113, v73, v113
    v_pk_mul_lo_u16 v114, v74, v114
    v_pk_mul_lo_u16 v115, v75, v115
    v_pk_mul_lo_u16 v116, v76, v116
    v_pk_mul_lo_u16 v117, v77, v117
    v_pk_mul_lo_u16 v118, v78, v118
    v_pk_mul_lo_u16 v119, v79, v119
    v_mfma_f32_32x32x16_bf16 v[176:191], v[80:83], v[96:99], v[176:191]
    ds_read_b128 v[104:107], v3 offset:512
    ds_read_b128 v[72:75], v7
    ds_read_b128 v[76:79], v7 offset:16
    ds_read_b64 v[12:13], v4 offset:2496
    ds_read_b64 v[14:15], v4 offset:2608
    ds_read_b64 v[16:17], v4 offset:2720
    ds_read_b64 v[18:19], v4 offset:2832
    ds_read_b128 v[20:23], v1 offset:24576
    ds_read_b128 v[24:27], v1 offset:0
    ds_read_b128 v[28:31], v1 offset:1024
    s_waitcnt lgkmcnt(7)
    v_mul_f32 v72, v104, v72
    v_mul_f32 v73, v104, v73
    v_mul_f32 v74, v104, v74
    v_mul_f32 v75, v104, v75
    v_mul_f32 v76, v104, v76
    v_mfma_f32_32x32x16_bf16 v[176:191], v[84:87], v[100:103], v[176:191]
    v_mul_f32 v77, v104, v77
    v_mul_f32 v78, v104, v78
    v_mul_f32 v79, v104, v79
    v_cvt_pk_bf16_f32 v72, 0, v72
    v_cvt_pk_bf16_f32 v73, 0, v73
    v_cvt_pk_bf16_f32 v74, 0, v74
    v_cvt_pk_bf16_f32 v75, 0, v75
    v_mfma_f32_32x32x16_bf16 v[208:223], v[88:91], v[96:99], v[208:223]
    v_cvt_pk_bf16_f32 v76, 0, v76
    v_cvt_pk_bf16_f32 v77, 0, v77
    v_cvt_pk_bf16_f32 v78, 0, v78
    v_cvt_pk_bf16_f32 v79, 0, v79
    v_mul_f32 v72, s61, v72
    v_mul_f32 v73, s61, v73
    v_mfma_f32_32x32x16_bf16 v[208:223], v[92:95], v[100:103], v[208:223]
    v_mul_f32 v74, s61, v74
    v_mul_f32 v75, s61, v75
    v_mul_f32 v76, s61, v76
    v_mul_f32 v77, s61, v77
    v_mul_f32 v78, s61, v78
    v_mul_f32 v79, s61, v79
    v_sin_f32 v72, v72
    v_mfma_f32_32x32x16_bf16 v[224:239], v[112:115], v[64:67], v[224:239]
    v_sin_f32 v73, v73
    v_sin_f32 v74, v74
    v_sin_f32 v75, v75
    v_sin_f32 v76, v76
    v_sin_f32 v77, v77
    v_sin_f32 v78, v78
    v_sin_f32 v79, v79
    v_mfma_f32_32x32x16_bf16 v[240:255], v[112:115], v[96:99], v[240:255]
    v_mul_f32 v72, v72, v105
    v_mul_f32 v73, v73, v105
    v_mul_f32 v74, v74, v105
    v_mul_f32 v75, v75, v105
    v_mul_f32 v76, v76, v105
    v_mul_f32 v77, v77, v105
    v_mfma_f32_32x32x16_bf16 v[224:239], v[116:119], v[68:71], v[224:239]
    v_mul_f32 v78, v78, v105
    v_mul_f32 v79, v79, v105
    v_cvt_pk_bf16_f32 v8, v72, v73
    v_cvt_pk_bf16_f32 v9, v74, v75
    v_cvt_pk_bf16_f32 v10, v76, v77
    v_cvt_pk_bf16_f32 v11, v78, v79
    s_waitcnt lgkmcnt(3)
    v_pk_lshlrev_b16 v12, v6, v12
    v_mfma_f32_32x32x16_bf16 v[240:255], v[116:119], v[100:103], v[240:255]
    v_pk_lshlrev_b16 v13, v6, v13
    v_pk_lshlrev_b16 v14, v6, v14
    v_pk_lshlrev_b16 v15, v6, v15
    v_pk_lshlrev_b16 v16, v6, v16
    v_pk_lshlrev_b16 v17, v6, v17
    v_pk_lshlrev_b16 v18, v6, v18
    v_pk_lshlrev_b16 v19, v6, v19
    v_add_u32 v3, 512, v3
    v_add_u32 v4, 448, v4
    v_add_u32 v0, 448, v0
    v_add_u32 v5, 512, v5
    s_waitcnt lgkmcnt(0)
    s_add_u32 s49, s49, 1
    s_cmp_lt_u32 s49, s48
    s_cbranch_scc1 M_batch
M_wend:
    s_cmp_eq_u32 s76, 0
    s_cbranch_scc1 M_slow
M_epi:
WUP_3942:
    s_cbranch_execz WUR_1
    v_lshrrev_b32 v8, 4, v1
    v_lshrrev_b32 v10, 5, v8
    v_and_b32 v11, 31, v8
    v_lshlrev_b32 v12, 11, v10
    v_lshl_add_u32 v12, v11, 2, v12
    s_waitcnt vmcnt(0)
    v_cvt_pk_bf16_f32 v64, v128, v144
    v_cvt_pk_bf16_f32 v65, v129, v145
    v_cvt_pk_bf16_f32 v66, v130, v146
    v_cvt_pk_bf16_f32 v67, v131, v147
    v_cvt_pk_bf16_f32 v68, v132, v148
    v_cvt_pk_bf16_f32 v69, v133, v149
    v_cvt_pk_bf16_f32 v70, v134, v150
    v_cvt_pk_bf16_f32 v71, v135, v151
    v_cvt_pk_bf16_f32 v72, v136, v152
    v_cvt_pk_bf16_f32 v73, v137, v153
    v_cvt_pk_bf16_f32 v74, v138, v154
    v_cvt_pk_bf16_f32 v75, v139, v155
    buffer_store_dword v64, v12, s[32:35], s40 offen offset:0 sc1 nt
    buffer_store_dword v65, v12, s[32:35], s40 offen offset:512 sc1 nt
    buffer_store_dword v66, v12, s[32:35], s40 offen offset:1024 sc1 nt
    buffer_store_dword v67, v12, s[32:35], s40 offen offset:1536 sc1 nt
    buffer_store_dword v68, v12, s[32:35], s41 offen offset:0 sc1 nt
    buffer_store_dword v69, v12, s[32:35], s41 offen offset:512 sc1 nt
    buffer_store_dword v70, v12, s[32:35], s41 offen offset:1024 sc1 nt
    buffer_store_dword v71, v12, s[32:35], s41 offen offset:1536 sc1 nt
    buffer_store_dword v72, v12, s[32:35], s42 offen offset:0 sc1 nt
    buffer_store_dword v73, v12, s[32:35], s42 offen offset:512 sc1 nt
    buffer_store_dword v74, v12, s[32:35], s42 offen offset:1024 sc1 nt
    buffer_store_dword v75, v12, s[32:35], s42 offen offset:1536 sc1 nt
WUP_3972:
    s_cbranch_execz WUR_1
    v_cvt_pk_bf16_f32 v80, v160, v176
    v_cvt_pk_bf16_f32 v81, v161, v177
    v_cvt_pk_bf16_f32 v82, v162, v178
    v_cvt_pk_bf16_f32 v83, v163, v179
    v_cvt_pk_bf16_f32 v84, v164, v180
    v_cvt_pk_bf16_f32 v85, v165, v181
    v_cvt_pk_bf16_f32 v86, v166, v182
    v_cvt_pk_bf16_f32 v87, v167, v183
    v_cvt_pk_bf16_f32 v88, v168, v184
    v_cvt_pk_bf16_f32 v89, v169, v185
    v_cvt_pk_bf16_f32 v90, v170, v186
    v_cvt_pk_bf16_f32 v91, v171, v187
    buffer_store_dword v80, v12, s[32:35], s40 offen offset:128 sc1 nt
    buffer_store_dword v81, v12, s[32:35], s40 offen offset:640 sc1 nt
    buffer_store_dword v82, v12, s[32:35], s40 offen offset:1152 sc1 nt
    buffer_store_dword v83, v12, s[32:35], s40 offen offset:1664 sc1 nt
    buffer_store_dword v84, v12, s[32:35], s41 offen offset:128 sc1 nt
    buffer_store_dword v85, v12, s[32:35], s41 offen offset:640 sc1 nt
    buffer_store_dword v86, v12, s[32:35], s41 offen offset:1152 sc1 nt
    buffer_store_dword v87, v12, s[32:35], s41 offen offset:1664 sc1 nt
    buffer_store_dword v88, v12, s[32:35], s42 offen offset:128 sc1 nt
    buffer_store_dword v89, v12, s[32:35], s42 offen offset:640 sc1 nt
    buffer_store_dword v90, v12, s[32:35], s42 offen offset:1152 sc1 nt
    buffer_store_dword v91, v12, s[32:35], s42 offen offset:1664 sc1 nt
    v_cvt_pk_bf16_f32 v96, v192, v208
    v_cvt_pk_bf16_f32 v97, v193, v209
    v_cvt_pk_bf16_f32 v98, v194, v210
    v_cvt_pk_bf16_f32 v99, v195, v211
    v_cvt_pk_bf16_f32 v100, v196, v212
    v_cvt_pk_bf16_f32 v101, v197, v213
    v_cvt_pk_bf16_f32 v102, v198, v214
    v_cvt_pk_bf16_f32 v103, v199, v215
    v_cvt_pk_bf16_f32 v104, v200, v216
    v_cvt_pk_bf16_f32 v105, v201, v217
    v_cvt_pk_bf16_f32 v106, v202, v218
    v_cvt_pk_bf16_f32 v107, v203, v219
    buffer_store_dword v96, v12, s[32:35], s40 offen offset:256 sc1 nt
    buffer_store_dword v97, v12, s[32:35], s40 offen offset:768 sc1 nt
    buffer_store_dword v98, v12, s[32:35], s40 offen offset:1280 sc1 nt
    buffer_store_dword v99, v12, s[32:35], s40 offen offset:1792 sc1 nt
    buffer_store_dword v100, v12, s[32:35], s41 offen offset:256 sc1 nt
    buffer_store_dword v101, v12, s[32:35], s41 offen offset:768 sc1 nt
    buffer_store_dword v102, v12, s[32:35], s41 offen offset:1280 sc1 nt
    buffer_store_dword v103, v12, s[32:35], s41 offen offset:1792 sc1 nt
    buffer_store_dword v104, v12, s[32:35], s42 offen offset:256 sc1 nt
    buffer_store_dword v105, v12, s[32:35], s42 offen offset:768 sc1 nt
    buffer_store_dword v106, v12, s[32:35], s42 offen offset:1280 sc1 nt
    buffer_store_dword v107, v12, s[32:35], s42 offen offset:1792 sc1 nt
    v_cvt_pk_bf16_f32 v112, v224, v240
    v_cvt_pk_bf16_f32 v113, v225, v241
    v_cvt_pk_bf16_f32 v114, v226, v242
    v_cvt_pk_bf16_f32 v115, v227, v243
    v_cvt_pk_bf16_f32 v116, v228, v244
    v_cvt_pk_bf16_f32 v117, v229, v245
    v_cvt_pk_bf16_f32 v118, v230, v246
    v_cvt_pk_bf16_f32 v119, v231, v247
    v_cvt_pk_bf16_f32 v120, v232, v248
    v_cvt_pk_bf16_f32 v121, v233, v249
    v_cvt_pk_bf16_f32 v122, v234, v250
    v_cvt_pk_bf16_f32 v123, v235, v251
    buffer_store_dword v112, v12, s[32:35], s40 offen offset:384 sc1 nt
    buffer_store_dword v113, v12, s[32:35], s40 offen offset:896 sc1 nt
    buffer_store_dword v114, v12, s[32:35], s40 offen offset:1408 sc1 nt
    buffer_store_dword v115, v12, s[32:35], s40 offen offset:1920 sc1 nt
    buffer_store_dword v116, v12, s[32:35], s41 offen offset:384 sc1 nt
    buffer_store_dword v117, v12, s[32:35], s41 offen offset:896 sc1 nt
    buffer_store_dword v118, v12, s[32:35], s41 offen offset:1408 sc1 nt
    buffer_store_dword v119, v12, s[32:35], s41 offen offset:1920 sc1 nt
    buffer_store_dword v120, v12, s[32:35], s42 offen offset:384 sc1 nt
    buffer_store_dword v121, v12, s[32:35], s42 offen offset:896 sc1 nt
    buffer_store_dword v122, v12, s[32:35], s42 offen offset:1408 sc1 nt
    buffer_store_dword v123, v12, s[32:35], s42 offen offset:1920 sc1 nt
    s_cmp_le_u32 s45, 24
    s_cbranch_scc1 M_fin
    v_cvt_pk_bf16_f32 v76, v140, v156
    v_cvt_pk_bf16_f32 v77, v141, v157
    v_cvt_pk_bf16_f32 v78, v142, v158
    v_cvt_pk_bf16_f32 v79, v143, v159
    buffer_store_dword v76, v12, s[32:35], s43 offen offset:0 sc1 nt
    buffer_store_dword v77, v12, s[32:35], s43 offen offset:512 sc1 nt
    buffer_store_dword v78, v12, s[32:35], s43 offen offset:1024 sc1 nt
    buffer_store_dword v79, v12, s[32:35], s43 offen offset:1536 sc1 nt
    v_cvt_pk_bf16_f32 v92, v172, v188
    v_cvt_pk_bf16_f32 v93, v173, v189
    v_cvt_pk_bf16_f32 v94, v174, v190
    v_cvt_pk_bf16_f32 v95, v175, v191
    buffer_store_dword v92, v12, s[32:35], s43 offen offset:128 sc1 nt
    buffer_store_dword v93, v12, s[32:35], s43 offen offset:640 sc1 nt
    buffer_store_dword v94, v12, s[32:35], s43 offen offset:1152 sc1 nt
    buffer_store_dword v95, v12, s[32:35], s43 offen offset:1664 sc1 nt
    v_cvt_pk_bf16_f32 v108, v204, v220
    v_cvt_pk_bf16_f32 v109, v205, v221
    v_cvt_pk_bf16_f32 v110, v206, v222
    v_cvt_pk_bf16_f32 v111, v207, v223
    buffer_store_dword v108, v12, s[32:35], s43 offen offset:256 sc1 nt
    buffer_store_dword v109, v12, s[32:35], s43 offen offset:768 sc1 nt
    buffer_store_dword v110, v12, s[32:35], s43 offen offset:1280 sc1 nt
    buffer_store_dword v111, v12, s[32:35], s43 offen offset:1792 sc1 nt
    v_cvt_pk_bf16_f32 v124, v236, v252
    v_cvt_pk_bf16_f32 v125, v237, v253
    v_cvt_pk_bf16_f32 v126, v238, v254
    v_cvt_pk_bf16_f32 v127, v239, v255
    buffer_store_dword v124, v12, s[32:35], s43 offen offset:384 sc1 nt
    buffer_store_dword v125, v12, s[32:35], s43 offen offset:896 sc1 nt
    buffer_store_dword v126, v12, s[32:35], s43 offen offset:1408 sc1 nt
    buffer_store_dword v127, v12, s[32:35], s43 offen offset:1920 sc1 nt
M_fin:
K_end:
    s_endpgm
P_rare:
    v_mov_b32 v37, 131080
    v_mov_b32 v38, 131076
    s_mul_i32 s27, s2, 32768
    s_add_u32 s27, s27, 0x1100000
    s_lshl_b32 s59, s2, 15
    s_add_u32 s59, s59, 0x8fff84
    s_mov_b64 exec, s[56:57]
    v_cmp_gt_u32 vcc, 31, v76
    s_and_b64 exec, vcc, s[56:57]
    s_nop 3
    s_cbranch_execz P_r10
    ds_write_b32 v12, v92
P_r10:
    s_andn2_b64 exec, s[56:57], vcc
    s_cbranch_execz P_r30
    s_mov_b64 s[14:15], exec
    v_lshlrev_b32 v36, 1, v76
    v_add_u32 v36, 0xfeffffc4, v36
    ds_max_u32 v84, v36 offset:124
    v_cmp_gt_u32 vcc, 63, v76
    s_and_b64 exec, vcc, s[14:15]
    s_nop 3
    s_cbranch_execz P_r20
    v_lshlrev_b32 v124, 7, v68
    v_lshl_add_u32 v124, v76, 2, v124
    buffer_store_dword v92, v124, s[36:39], s59 offen sc1
    s_nop 0
P_r20:
    s_andn2_b64 exec, s[14:15], vcc
    s_cbranch_execz P_r30
    ds_write_b32 v38, v116
    ds_add_rtn_u32 v124, v37, v116
    v_mov_b32 v126, v92
    v_mov_b32 v127, v68
    s_waitcnt lgkmcnt(0)
    v_lshlrev_b32 v124, 3, v124
    buffer_store_dwordx2 v[126:127], v124, s[36:39], s27 offen sc1
    s_nop 0
P_r30:
    s_mov_b64 exec, s[56:57]
    v_cmp_gt_u32 vcc, 31, v77
    s_and_b64 exec, vcc, s[56:57]
    s_nop 3
    s_cbranch_execz P_r11
    ds_write_b32 v13, v93
P_r11:
    s_andn2_b64 exec, s[56:57], vcc
    s_cbranch_execz P_r31
    s_mov_b64 s[14:15], exec
    v_lshlrev_b32 v36, 1, v77
    v_add_u32 v36, 0xfeffffc4, v36
    ds_max_u32 v85, v36 offset:124
    v_cmp_gt_u32 vcc, 63, v77
    s_and_b64 exec, vcc, s[14:15]
    s_nop 3
    s_cbranch_execz P_r21
    v_lshlrev_b32 v124, 7, v69
    v_lshl_add_u32 v124, v77, 2, v124
    buffer_store_dword v93, v124, s[36:39], s59 offen sc1
    s_nop 0
P_r21:
    s_andn2_b64 exec, s[14:15], vcc
    s_cbranch_execz P_r31
    ds_write_b32 v38, v116
    ds_add_rtn_u32 v124, v37, v116
    v_mov_b32 v126, v93
    v_mov_b32 v127, v69
    s_waitcnt lgkmcnt(0)
    v_lshlrev_b32 v124, 3, v124
    buffer_store_dwordx2 v[126:127], v124, s[36:39], s27 offen sc1
    s_nop 0
P_r31:
    s_mov_b64 exec, s[56:57]
    v_cmp_gt_u32 vcc, 31, v78
    s_and_b64 exec, vcc, s[56:57]
    s_nop 3
    s_cbranch_execz P_r12
    ds_write_b32 v14, v94
P_r12:
    s_andn2_b64 exec, s[56:57], vcc
    s_cbranch_execz P_r32
    s_mov_b64 s[14:15], exec
    v_lshlrev_b32 v36, 1, v78
    v_add_u32 v36, 0xfeffffc4, v36
    ds_max_u32 v86, v36 offset:124
    v_cmp_gt_u32 vcc, 63, v78
    s_and_b64 exec, vcc, s[14:15]
    s_nop 3
    s_cbranch_execz P_r22
    v_lshlrev_b32 v124, 7, v70
    v_lshl_add_u32 v124, v78, 2, v124
    buffer_store_dword v94, v124, s[36:39], s59 offen sc1
    s_nop 0
P_r22:
    s_andn2_b64 exec, s[14:15], vcc
    s_cbranch_execz P_r32
    ds_write_b32 v38, v116
    ds_add_rtn_u32 v124, v37, v116
    v_mov_b32 v126, v94
    v_mov_b32 v127, v70
    s_waitcnt lgkmcnt(0)
    v_lshlrev_b32 v124, 3, v124
    buffer_store_dwordx2 v[126:127], v124, s[36:39], s27 offen sc1
    s_nop 0
P_r32:
    s_mov_b64 exec, s[56:57]
    v_cmp_gt_u32 vcc, 31, v79
    s_and_b64 exec, vcc, s[56:57]
    s_nop 3
    s_cbranch_execz P_r13
    ds_write_b32 v15, v95
P_r13:
    s_andn2_b64 exec, s[56:57], vcc
    s_cbranch_execz P_r33
    s_mov_b64 s[14:15], exec
    v_lshlrev_b32 v36, 1, v79
    v_add_u32 v36, 0xfeffffc4, v36
    ds_max_u32 v87, v36 offset:124
    v_cmp_gt_u32 vcc, 63, v79
    s_and_b64 exec, vcc, s[14:15]
    s_nop 3
    s_cbranch_execz P_r23
    v_lshlrev_b32 v124, 7, v71
    v_lshl_add_u32 v124, v79, 2, v124
    buffer_store_dword v95, v124, s[36:39], s59 offen sc1
    s_nop 0
P_r23:
    s_andn2_b64 exec, s[14:15], vcc
    s_cbranch_execz P_r33
    ds_write_b32 v38, v116
    ds_add_rtn_u32 v124, v37, v116
    v_mov_b32 v126, v95
    v_mov_b32 v127, v71
    s_waitcnt lgkmcnt(0)
    v_lshlrev_b32 v124, 3, v124
    buffer_store_dwordx2 v[126:127], v124, s[36:39], s27 offen sc1
    s_nop 0
P_r33:
    s_mov_b64 exec, s[56:57]
    v_cmp_gt_u32 vcc, 31, v80
    s_and_b64 exec, vcc, s[56:57]
    s_nop 3
    s_cbranch_execz P_r14
    ds_write_b32 v16, v96
P_r14:
    s_andn2_b64 exec, s[56:57], vcc
    s_cbranch_execz P_r34
    s_mov_b64 s[14:15], exec
    v_lshlrev_b32 v36, 1, v80
    v_add_u32 v36, 0xfeffffc4, v36
    ds_max_u32 v88, v36 offset:124
    v_cmp_gt_u32 vcc, 63, v80
    s_and_b64 exec, vcc, s[14:15]
    s_nop 3
    s_cbranch_execz P_r24
    v_lshlrev_b32 v124, 7, v72
    v_lshl_add_u32 v124, v80, 2, v124
    buffer_store_dword v96, v124, s[36:39], s59 offen sc1
    s_nop 0
P_r24:
    s_andn2_b64 exec, s[14:15], vcc
    s_cbranch_execz P_r34
    ds_write_b32 v38, v116
    ds_add_rtn_u32 v124, v37, v116
    v_mov_b32 v126, v96
    v_mov_b32 v127, v72
    s_waitcnt lgkmcnt(0)
    v_lshlrev_b32 v124, 3, v124
    buffer_store_dwordx2 v[126:127], v124, s[36:39], s27 offen sc1
    s_nop 0
P_r34:
    s_mov_b64 exec, s[56:57]
    v_cmp_gt_u32 vcc, 31, v81
    s_and_b64 exec, vcc, s[56:57]
    s_nop 3
    s_cbranch_execz P_r15
    ds_write_b32 v17, v97
P_r15:
    s_andn2_b64 exec, s[56:57], vcc
    s_cbranch_execz P_r35
    s_mov_b64 s[14:15], exec
    v_lshlrev_b32 v36, 1, v81
    v_add_u32 v36, 0xfeffffc4, v36
    ds_max_u32 v89, v36 offset:124
    v_cmp_gt_u32 vcc, 63, v81
    s_and_b64 exec, vcc, s[14:15]
    s_nop 3
    s_cbranch_execz P_r25
    v_lshlrev_b32 v124, 7, v73
    v_lshl_add_u32 v124, v81, 2, v124
    buffer_store_dword v97, v124, s[36:39], s59 offen sc1
    s_nop 0
P_r25:
    s_andn2_b64 exec, s[14:15], vcc
    s_cbranch_execz P_r35
    ds_write_b32 v38, v116
    ds_add_rtn_u32 v124, v37, v116
    v_mov_b32 v126, v97
    v_mov_b32 v127, v73
    s_waitcnt lgkmcnt(0)
    v_lshlrev_b32 v124, 3, v124
    buffer_store_dwordx2 v[126:127], v124, s[36:39], s27 offen sc1
    s_nop 0
P_r35:
    s_mov_b64 exec, s[56:57]
    v_cmp_gt_u32 vcc, 31, v82
    s_and_b64 exec, vcc, s[56:57]
    s_nop 3
    s_cbranch_execz P_r16
    ds_write_b32 v18, v98
P_r16:
    s_andn2_b64 exec, s[56:57], vcc
    s_cbranch_execz P_r36
    s_mov_b64 s[14:15], exec
    v_lshlrev_b32 v36, 1, v82
    v_add_u32 v36, 0xfeffffc4, v36
    ds_max_u32 v90, v36 offset:124
    v_cmp_gt_u32 vcc, 63, v82
    s_and_b64 exec, vcc, s[14:15]
    s_nop 3
    s_cbranch_execz P_r26
    v_lshlrev_b32 v124, 7, v74
    v_lshl_add_u32 v124, v82, 2, v124
    buffer_store_dword v98, v124, s[36:39], s59 offen sc1
    s_nop 0
P_r26:
    s_andn2_b64 exec, s[14:15], vcc
    s_cbranch_execz P_r36
    ds_write_b32 v38, v116
    ds_add_rtn_u32 v124, v37, v116
    v_mov_b32 v126, v98
    v_mov_b32 v127, v74
    s_waitcnt lgkmcnt(0)
    v_lshlrev_b32 v124, 3, v124
    buffer_store_dwordx2 v[126:127], v124, s[36:39], s27 offen sc1
    s_nop 0
P_r36:
    s_mov_b64 exec, s[56:57]
    v_cmp_gt_u32 vcc, 31, v83
    s_and_b64 exec, vcc, s[56:57]
    s_nop 3
    s_cbranch_execz P_r17
    ds_write_b32 v19, v99
P_r17:
    s_andn2_b64 exec, s[56:57], vcc
    s_cbranch_execz P_r37
    s_mov_b64 s[14:15], exec
    v_lshlrev_b32 v36, 1, v83
    v_add_u32 v36, 0xfeffffc4, v36
    ds_max_u32 v91, v36 offset:124
    v_cmp_gt_u32 vcc, 63, v83
    s_and_b64 exec, vcc, s[14:15]
    s_nop 3
    s_cbranch_execz P_r27
    v_lshlrev_b32 v124, 7, v75
    v_lshl_add_u32 v124, v83, 2, v124
    buffer_store_dword v99, v124, s[36:39], s59 offen sc1
    s_nop 0
P_r27:
    s_andn2_b64 exec, s[14:15], vcc
    s_cbranch_execz P_r37
    ds_write_b32 v38, v116
    ds_add_rtn_u32 v124, v37, v116
    v_mov_b32 v126, v99
    v_mov_b32 v127, v75
    s_waitcnt lgkmcnt(0)
    v_lshlrev_b32 v124, 3, v124
    buffer_store_dwordx2 v[126:127], v124, s[36:39], s27 offen sc1
    s_nop 0
P_r37:
    s_mov_b64 exec, -1
    s_waitcnt vmcnt(0)
    s_branch P_join
M_e4x:
WUP_4328:
    s_cbranch_execz WUP_4501
    s_mov_b32 s56, 0x05040100
    s_mov_b32 s57, 0x07060302
    s_waitcnt vmcnt(4)
    v_lshlrev_b32 v150, 4, v1
    v_cmp_gt_u32 vcc, 49, v1
    s_mov_b64 s[60:61], vcc
    s_mov_b32 s63, 0x830100
    s_mov_b32 s65, 0
    s_nop 1
    s_branch M_pb
M_pa:
    buffer_load_dwordx4 v[236:239], v150, s[36:39], s63 offen sc1
    s_waitcnt vmcnt(0)
M_pb:
    v_xor_b32 v236, s18, v236
    v_xor_b32 v237, s18, v237
    v_xor_b32 v238, s18, v238
    v_xor_b32 v239, s18, v239
    v_or3_b32 v236, v236, v237, v238
    v_or_b32 v236, v236, v239
    v_cmp_ne_u32 vcc, 0, v236
    s_and_b64 vcc, vcc, s[60:61]
    s_cbranch_vccz M_pad
    s_sleep 2
    s_add_u32 s65, s65, 1
    s_cmp_lt_u32 s65, 16384
    s_cbranch_scc1 M_pa
M_pad:
    s_sub_u32 s27, s26, 5
    s_lshl_b32 s27, s27, 10
    s_add_u32 s63, s27, 0x810000
    s_add_u32 s27, s27, 30720
    s_mov_b32 m0, s27
    s_nop 0
    buffer_load_dwordx4 v3, s[36:39], s63 offen sc1 lds
    s_add_u32 s27, s27, 3072
    s_add_u32 s63, s63, 3072
    s_mov_b32 m0, s27
    s_nop 0
    buffer_load_dwordx4 v3, s[36:39], s63 offen sc1 lds
    s_add_u32 s27, s27, 3072
    s_add_u32 s63, s63, 3072
    s_mov_b32 m0, s27
    s_nop 0
    buffer_load_dwordx4 v3, s[36:39], s63 offen sc1 lds
    s_add_u32 s27, s27, 3072
    s_add_u32 s63, s63, 3072
    s_mov_b32 m0, s27
    s_nop 0
    buffer_load_dwordx4 v3, s[36:39], s63 offen sc1 lds
    s_add_u32 s27, s27, 3072
    s_add_u32 s63, s63, 3072
    s_mov_b32 m0, s27
    s_nop 0
    buffer_load_dwordx4 v3, s[36:39], s63 offen sc1 lds
    s_add_u32 s27, s27, 3072
    s_add_u32 s63, s63, 3072
    s_mov_b32 m0, s27
    s_nop 0
    buffer_load_dwordx4 v3, s[36:39], s63 offen sc1 lds
    s_add_u32 s27, s27, 3072
    s_add_u32 s63, s63, 3072
    s_mov_b32 m0, s27
    s_nop 0
    buffer_load_dwordx4 v3, s[36:39], s63 offen sc1 lds
    s_add_u32 s27, s27, 3072
    s_add_u32 s63, s63, 3072
    s_mov_b32 m0, s27
    s_nop 0
    buffer_load_dwordx4 v3, s[36:39], s63 offen sc1 lds
    s_add_u32 s27, s27, 3072
    s_add_u32 s63, s63, 3072
    s_mov_b32 m0, s27
    s_nop 0
    buffer_load_dwordx4 v3, s[36:39], s63 offen sc1 lds
    s_add_u32 s27, s27, 3072
    s_add_u32 s63, s63, 3072
    s_mov_b32 m0, s27
    s_nop 0
    buffer_load_dwordx4 v3, s[36:39], s63 offen sc1 lds
    s_add_u32 s27, s27, 3072
    s_add_u32 s63, s63, 3072
    s_mov_b32 m0, s27
    s_nop 0
    buffer_load_dwordx4 v3, s[36:39], s63 offen sc1 lds
    s_add_u32 s27, s27, 3072
    s_add_u32 s63, s63, 3072
    s_mov_b32 m0, s27
    s_nop 0
    buffer_load_dwordx4 v3, s[36:39], s63 offen sc1 lds
    s_add_u32 s27, s27, 3072
    s_add_u32 s63, s63, 3072
    s_mov_b32 m0, s27
    s_nop 0
    buffer_load_dwordx4 v3, s[36:39], s63 offen sc1 lds
    s_add_u32 s27, s27, 3072
    s_add_u32 s63, s63, 3072
    s_mov_b32 m0, s27
    s_nop 0
    buffer_load_dwordx4 v3, s[36:39], s63 offen sc1 lds
    s_add_u32 s27, s27, 3072
    s_add_u32 s63, s63, 3072
    s_mov_b32 m0, s27
    s_nop 0
    buffer_load_dwordx4 v3, s[36:39], s63 offen sc1 lds
    s_add_u32 s27, s27, 3072
    s_add_u32 s63, s63, 3072
    s_mov_b32 m0, s27
    s_nop 0
    buffer_load_dwordx4 v3, s[36:39], s63 offen sc1 lds
    s_add_u32 s27, s27, 3072
    s_add_u32 s63, s63, 3072
    s_mov_b32 m0, s27
    s_nop 0
    buffer_load_dwordx4 v3, s[36:39], s63 offen sc1 lds
    s_add_u32 s27, s27, 3072
    s_add_u32 s63, s63, 3072
    s_mov_b32 m0, s27
    s_nop 0
    buffer_load_dwordx4 v3, s[36:39], s63 offen sc1 lds
    s_add_u32 s27, s27, 3072
    s_add_u32 s63, s63, 3072
    s_mov_b32 m0, s27
    s_nop 0
    buffer_load_dwordx4 v3, s[36:39], s63 offen sc1 lds
    s_add_u32 s27, s27, 3072
    s_add_u32 s63, s63, 3072
    s_mov_b32 m0, s27
    s_nop 0
    buffer_load_dwordx4 v3, s[36:39], s63 offen sc1 lds
    s_add_u32 s27, s27, 3072
    s_add_u32 s63, s63, 3072
    s_mov_b32 m0, s27
    s_nop 0
    buffer_load_dwordx4 v3, s[36:39], s63 offen sc1 lds
    s_add_u32 s27, s27, 3072
    s_add_u32 s63, s63, 3072
    s_mov_b32 m0, s27
    s_nop 0
    buffer_load_dwordx4 v3, s[36:39], s63 offen sc1 lds
    s_add_u32 s27, s27, 3072
    s_add_u32 s63, s63, 3072
    s_mov_b32 m0, s27
    s_nop 0
    buffer_load_dwordx4 v3, s[36:39], s63 offen sc1 lds
    s_add_u32 s27, s27, 3072
    s_add_u32 s63, s63, 3072
    s_mov_b32 m0, s27
    s_nop 0
    buffer_load_dwordx4 v3, s[36:39], s63 offen sc1 lds
    s_add_u32 s27, s27, 3072
    s_add_u32 s63, s63, 3072
    s_mov_b32 m0, s27
    s_nop 0
    buffer_load_dwordx4 v3, s[36:39], s63 offen sc1 lds
    s_add_u32 s27, s27, 3072
    s_add_u32 s63, s63, 3072
    s_mov_b32 m0, s27
    s_nop 0
    buffer_load_dwordx4 v3, s[36:39], s63 offen sc1 lds
    s_add_u32 s27, s27, 3072
    s_add_u32 s63, s63, 3072
    s_mov_b32 m0, s27
    s_nop 0
    buffer_load_dwordx4 v3, s[36:39], s63 offen sc1 lds
    s_add_u32 s27, s27, 3072
    s_add_u32 s63, s63, 3072
    s_mov_b32 m0, s27
    s_nop 0
    buffer_load_dwordx4 v3, s[36:39], s63 offen sc1 lds
    s_add_u32 s27, s27, 3072
    s_add_u32 s63, s63, 3072
    s_mov_b32 m0, s27
    s_nop 0
    buffer_load_dwordx4 v3, s[36:39], s63 offen sc1 lds
    s_add_u32 s27, s27, 3072
WUP_4501:
    s_cbranch_execz WUR_0
    s_add_u32 s63, s63, 3072
    s_mov_b32 m0, s27
    s_nop 0
    buffer_load_dwordx4 v3, s[36:39], s63 offen sc1 lds
    s_add_u32 s27, s27, 3072
    s_add_u32 s63, s63, 3072
    s_mov_b32 m0, s27
    s_nop 0
    buffer_load_dwordx4 v3, s[36:39], s63 offen sc1 lds
    s_add_u32 s27, s27, 3072
    s_add_u32 s63, s63, 3072
    s_mov_b32 m0, s27
    s_nop 0
    buffer_load_dwordx4 v3, s[36:39], s63 offen sc1 lds
    s_add_u32 s27, s27, 3072
    s_add_u32 s63, s63, 3072
    s_cmp_eq_u32 s26, 7
    s_cbranch_scc1 M_tfd
    s_mov_b32 m0, s27
    s_nop 0
    buffer_load_dwordx4 v3, s[36:39], s63 offen sc1 lds
M_tfd:
    s_setprio 0
    s_branch M_e5
M_mdx:
    s_mov_b32 s59, 0
M_md:
    s_cmp_eq_u64 s[68:69], 0
    s_cbranch_scc0 M_md1
    s_cmp_lg_u32 s59, 0
    s_cbranch_scc1 M_mdd
    s_mov_b32 s59, 1
    s_mov_b64 s[68:69], s[70:71]
    v_mov_b32 v187, v191
    s_nop 1
    s_branch M_md
M_md1:
    s_ff1_i32_b64 s27, s[68:69]
    s_bitset0_b64 s[68:69], s27
    v_readlane_b32 s60, v187, s27
    s_bfe_u32 s60, s60, 0x170001
    s_cmp_le_u32 s60, 32
    s_cbranch_scc1 M_md2
    ds_write_b32 v9, v19
    s_movk_i32 s60, 32
M_md2:
    s_lshr_b32 s27, s27, 2
    s_lshl_b32 s61, s59, 4
    s_add_u32 s27, s27, s61
    s_lshl_b32 s61, s26, 5
    s_add_u32 s27, s27, s61
    s_lshl_b32 s27, s27, 15
    s_lshl_b32 s61, s2, 7
    s_add_u32 s27, s27, s61
    s_add_u32 s27, s27, 0x900000
    v_mov_b32 v148, 0xff000000
    s_bfm_b64 exec, s60, 0
    buffer_load_dword v148, v20, s[36:39], s27 offen sc1
    s_mov_b64 exec, -1
    s_waitcnt vmcnt(0) lgkmcnt(0)
    v_and_b32 v64, s12, v148
    v_alignbit_b32 v65, s13, v148, 22
    ds_read_u16 v64, v64 offset:30720
    ds_read_b32 v65, v65
    s_waitcnt lgkmcnt(0)
    v_and_b32 v96, 0x0707, v64
    v_and_b32 v64, 0xf8f8, v64
    v_mul_u32_u24 v96, 0x200400, v96
    v_and_or_b32 v64, v96, s14, v64
    v_add_u32 v64, v64, v65
    v_dot4_i32_i8 v64, v64, v64, 0
    s_nop 2
    v_cmp_gt_i32 s[40:41], s15, v64
    s_nop 1
    v_mbcnt_lo_u32_b32 v96, s40, 0
    v_mbcnt_hi_u32_b32 v96, s41, v96
    v_lshl_add_u32 v96, v96, 2, s16
    s_bcnt1_i32_b64 s27, s[40:41]
    s_lshl2_add_u32 s16, s27, s16
    v_cndmask_b32 v96, v26, v96, s[40:41]
    ds_write_b32 v96, v148
    s_sub_u32 s27, s16, s17
    s_cmp_gt_u32 s27, 1024
    s_cbranch_scc0 M_md
    s_branch M_mdd
M_rd0:
    s_waitcnt vmcnt(0)
    v_lshlrev_b32 v192, 16, v208
    v_and_b32 v208, s58, v208
    v_lshlrev_b32 v193, 16, v209
    v_and_b32 v209, s58, v209
    v_lshlrev_b32 v194, 16, v210
    v_and_b32 v210, s58, v210
    v_lshlrev_b32 v195, 16, v211
    v_and_b32 v211, s58, v211
    v_lshlrev_b32 v196, 16, v212
    v_and_b32 v212, s58, v212
    v_lshlrev_b32 v197, 16, v213
    v_and_b32 v213, s58, v213
    v_lshlrev_b32 v198, 16, v214
    v_and_b32 v214, s58, v214
    v_lshlrev_b32 v199, 16, v215
    v_and_b32 v215, s58, v215
    v_lshlrev_b32 v200, 16, v216
    v_and_b32 v216, s58, v216
    v_lshlrev_b32 v201, 16, v217
    v_and_b32 v217, s58, v217
    v_lshlrev_b32 v202, 16, v218
    v_and_b32 v218, s58, v218
    v_lshlrev_b32 v203, 16, v219
    v_and_b32 v219, s58, v219
    v_lshlrev_b32 v204, 16, v220
    v_and_b32 v220, s58, v220
    v_lshlrev_b32 v205, 16, v221
    v_and_b32 v221, s58, v221
    v_lshlrev_b32 v206, 16, v222
    v_and_b32 v222, s58, v222
    v_lshlrev_b32 v207, 16, v223
    v_and_b32 v223, s58, v223
    v_lshlrev_b32 v224, 16, v240
    v_and_b32 v240, s58, v240
    v_lshlrev_b32 v225, 16, v241
    v_and_b32 v241, s58, v241
    v_lshlrev_b32 v226, 16, v242
    v_and_b32 v242, s58, v242
    v_lshlrev_b32 v227, 16, v243
    v_and_b32 v243, s58, v243
    v_lshlrev_b32 v228, 16, v244
    v_and_b32 v244, s58, v244
    v_lshlrev_b32 v229, 16, v245
    v_and_b32 v245, s58, v245
    v_lshlrev_b32 v230, 16, v246
    v_and_b32 v246, s58, v246
    v_lshlrev_b32 v231, 16, v247
    v_and_b32 v247, s58, v247
    v_lshlrev_b32 v232, 16, v248
    v_and_b32 v248, s58, v248
    v_lshlrev_b32 v233, 16, v249
    v_and_b32 v249, s58, v249
    v_lshlrev_b32 v234, 16, v250
    v_and_b32 v250, s58, v250
    v_lshlrev_b32 v235, 16, v251
    v_and_b32 v251, s58, v251
    v_lshlrev_b32 v236, 16, v252
    v_and_b32 v252, s58, v252
    v_lshlrev_b32 v237, 16, v253
    v_and_b32 v253, s58, v253
    v_lshlrev_b32 v238, 16, v254
    v_and_b32 v254, s58, v254
    v_lshlrev_b32 v239, 16, v255
    v_and_b32 v255, s58, v255
    s_mov_b32 s99, 0
    s_nop 0
    s_branch M_rd1
M_slow:
    v_lshrrev_b32 v8, 4, v1
    v_add_u32 v86, 64, v8
    v_bfrev_b32 v14, 2
    s_mov_b32 s63, 0x02020000
    s_mov_b32 s64, 0x322bcc77
    v_mov_b32 v103, 0x01000c0c
    v_and_b32 v12, 3, v8
    v_lshlrev_b32 v12, 3, v12
    v_lshrrev_b32_e64 v13, v12, s18
    v_bfe_u32 v15, v13, 1, 7
    v_lshlrev_b32 v15, 17, v15
    v_and_b32 v13, 1, v13
    v_or_b32 v95, v13, v15
    s_bfe_u32 s60, s18, 0x70019
    s_lshl_b32 s60, s60, 17
    s_bfe_u32 s27, s18, 0x10018
    s_or_b32 s60, s60, s27
    s_lshl_b32 s53, s2, 7
    s_cmp_eq_u32 s14, 2
    s_cbranch_scc1 M_sovf
    s_cmp_ge_u32 s15, 63
    s_cbranch_scc1 M_sph1
    s_lshl_b32 s62, s15, 2
    v_lshrrev_b32 v12, 5, v8
    v_and_b32 v13, 31, v8
    v_add_u32 v15, s62, v12
    v_cmp_gt_u32 vcc, 250, v15
    s_mov_b64 s[54:55], vcc
    v_lshlrev_b32 v15, 15, v15
    v_cndmask_b32 v15, v14, v15, s[54:55]
    s_cmp_lg_u32 s14, 0
    s_nop 0
    s_cbranch_scc1 M_s224
    v_lshl_add_u32 v16, v13, 2, v15
    buffer_load_dword v88, v16, s[36:39], s53 offen sc1
    s_waitcnt vmcnt(0)
    v_xor_b32 v88, v95, v88
    s_mov_b32 s27, 0xc8000000
    v_cmp_gt_u32 vcc, s27, v88
    s_and_b64 s[54:55], s[54:55], vcc
    s_nop 3
    s_branch M_s324
M_s224:
    buffer_load_dword v88, v15, s[36:39], s53 offen offset:124 sc1
    s_waitcnt vmcnt(0)
    v_xor_b32 v88, s60, v88
    v_bfe_u32 v88, v88, 1, 23
    v_cmp_gt_u32 vcc, v88, v13
    s_and_b64 s[54:55], s[54:55], vcc
    v_lshl_add_u32 v16, v13, 2, v15
    v_cndmask_b32 v16, v14, v16, s[54:55]
    s_add_u32 s27, s53, 0x900000
    buffer_load_dword v88, v16, s[36:39], s27 offen sc1
    s_waitcnt vmcnt(0)
M_s324:
    v_lshrrev_b32 v16, 24, v88
    v_subrev_u32 v17, s59, v16
    v_cmp_gt_u32 vcc, s45, v17
    s_and_b64 s[54:55], s[54:55], vcc
    v_and_b32 v96, 0x1fffe, v88
    v_lshl_add_u32 v96, v96, 1, v96
    v_and_b32 v96, -4, v96
    v_cndmask_b32 v96, v14, v96, s[54:55]
    buffer_load_dwordx2 v[98:99], v96, s[92:95], 0 offen
    v_mul_u32_u24 v97, 6, v16
    v_and_b32 v97, -4, v97
    v_cndmask_b32 v97, v14, v97, s[54:55]
    s_mul_i32 s27, s2, 1200
    buffer_load_dwordx2 v[100:101], v97, s[92:95], s27 offen
    v_bfe_i32 v102, v88, 1, 1
    v_and_or_b32 v102, v102, s63, v103
    v_bfe_i32 v104, v16, 0, 1
    v_and_or_b32 v104, v104, s63, v103
    v_add_u32 v105, s63, v104
    v_add_u32 v106, s63, v105
    s_waitcnt vmcnt(0)
    v_perm_b32 v107, v101, v100, v104
    v_perm_b32 v108, v101, v100, v105
    v_perm_b32 v109, v101, v100, v106
    v_add_u32 v113, s63, v102
    v_perm_b32 v110, v99, v98, v102
    v_add_u32 v114, s63, v113
    v_perm_b32 v111, v99, v98, v113
    v_perm_b32 v112, v99, v98, v114
    v_sub_f32 v110, v110, v107
    v_sub_f32 v111, v111, v108
    v_sub_f32 v112, v112, v109
    v_cvt_pk_bf16_f32 v89, v110, v111
    v_cvt_pk_bf16_f32 v112, 0, v112
    v_lshlrev_b32 v110, 16, v89
    v_and_b32 v111, s58, v89
    v_mul_f32 v115, v112, v112
    v_mul_f32 v110, v110, v110
    v_mul_f32 v111, v111, v111
    v_cvt_pk_bf16_f32 v115, 0, v115
    v_cvt_pk_bf16_f32 v110, 0, v110
    v_cvt_pk_bf16_f32 v111, 0, v111
    v_add_f32 v110, v110, v111
    v_add_f32 v110, v110, v115
    v_cvt_pk_bf16_f32 v110, 0, v110
    v_add_f32 v110, s64, v110
    v_cvt_pk_bf16_f32 v110, 0, v110
    v_sqrt_f32 v110, v110
    s_nop 0
    v_cvt_pk_bf16_f32 v90, v112, v110
    s_mov_b32 s27, 0x409d0000
    v_cmp_gt_u32 vcc, s27, v90
    s_and_b64 s[8:9], s[54:55], vcc
    v_lshrrev_b32 v12, 5, v86
    v_and_b32 v13, 31, v86
    v_add_u32 v15, s62, v12
    v_cmp_gt_u32 vcc, 250, v15
    s_mov_b64 s[54:55], vcc
    v_lshlrev_b32 v15, 15, v15
    v_cndmask_b32 v15, v14, v15, s[54:55]
    s_cmp_lg_u32 s14, 0
    s_nop 0
    s_cbranch_scc1 M_s225
    v_lshl_add_u32 v16, v13, 2, v15
    buffer_load_dword v92, v16, s[36:39], s53 offen sc1
    s_waitcnt vmcnt(0)
    v_xor_b32 v92, v95, v92
    s_mov_b32 s27, 0xc8000000
    v_cmp_gt_u32 vcc, s27, v92
    s_and_b64 s[54:55], s[54:55], vcc
    s_nop 3
    s_branch M_s325
M_s225:
    buffer_load_dword v92, v15, s[36:39], s53 offen offset:124 sc1
    s_waitcnt vmcnt(0)
    v_xor_b32 v92, s60, v92
    v_bfe_u32 v92, v92, 1, 23
    v_cmp_gt_u32 vcc, v92, v13
    s_and_b64 s[54:55], s[54:55], vcc
    v_lshl_add_u32 v16, v13, 2, v15
    v_cndmask_b32 v16, v14, v16, s[54:55]
    s_add_u32 s27, s53, 0x900000
    buffer_load_dword v92, v16, s[36:39], s27 offen sc1
    s_waitcnt vmcnt(0)
M_s325:
    v_lshrrev_b32 v16, 24, v92
    v_subrev_u32 v17, s59, v16
    v_cmp_gt_u32 vcc, s45, v17
    s_and_b64 s[54:55], s[54:55], vcc
    v_and_b32 v96, 0x1fffe, v92
    v_lshl_add_u32 v96, v96, 1, v96
    v_and_b32 v96, -4, v96
    v_cndmask_b32 v96, v14, v96, s[54:55]
    buffer_load_dwordx2 v[98:99], v96, s[92:95], 0 offen
    v_mul_u32_u24 v97, 6, v16
    v_and_b32 v97, -4, v97
    v_cndmask_b32 v97, v14, v97, s[54:55]
    s_mul_i32 s27, s2, 1200
    buffer_load_dwordx2 v[100:101], v97, s[92:95], s27 offen
    v_bfe_i32 v102, v92, 1, 1
    v_and_or_b32 v102, v102, s63, v103
    v_bfe_i32 v104, v16, 0, 1
    v_and_or_b32 v104, v104, s63, v103
    v_add_u32 v105, s63, v104
    v_add_u32 v106, s63, v105
    s_waitcnt vmcnt(0)
    v_perm_b32 v107, v101, v100, v104
    v_perm_b32 v108, v101, v100, v105
    v_perm_b32 v109, v101, v100, v106
    v_add_u32 v113, s63, v102
    v_perm_b32 v110, v99, v98, v102
    v_add_u32 v114, s63, v113
    v_perm_b32 v111, v99, v98, v113
    v_perm_b32 v112, v99, v98, v114
    v_sub_f32 v110, v110, v107
    v_sub_f32 v111, v111, v108
    v_sub_f32 v112, v112, v109
    v_cvt_pk_bf16_f32 v93, v110, v111
    v_cvt_pk_bf16_f32 v112, 0, v112
    v_lshlrev_b32 v110, 16, v93
    v_and_b32 v111, s58, v93
    v_mul_f32 v115, v112, v112
    v_mul_f32 v110, v110, v110
    v_mul_f32 v111, v111, v111
    v_cvt_pk_bf16_f32 v115, 0, v115
    v_cvt_pk_bf16_f32 v110, 0, v110
    v_cvt_pk_bf16_f32 v111, 0, v111
    v_add_f32 v110, v110, v111
    v_add_f32 v110, v110, v115
    v_cvt_pk_bf16_f32 v110, 0, v110
    v_add_f32 v110, s64, v110
    v_cvt_pk_bf16_f32 v110, 0, v110
    v_sqrt_f32 v110, v110
    s_nop 0
    v_cvt_pk_bf16_f32 v94, v112, v110
    s_mov_b32 s27, 0x409d0000
    v_cmp_gt_u32 vcc, s27, v94
    s_and_b64 s[10:11], s[54:55], vcc
    s_add_u32 s15, s15, 1
    s_nop 2
    s_branch M_sgo
M_sph1:
    s_add_u32 s14, s14, 1
    s_mov_b32 s15, 0
    s_mov_b32 s16, 0
    s_cmp_eq_u32 s14, 1
    s_cbranch_scc1 M_slow
M_sovf:
    s_cmp_ge_u32 s15, 250
    s_cbranch_scc1 M_send
    s_cmp_lg_u32 s16, 0
    s_cbranch_scc1 M_sblk
    s_lshl_b32 s27, s15, 15
    s_add_u32 s27, s27, s53
    v_mov_b32 v12, 0
    buffer_load_dword v13, v12, s[36:39], s27 offen offset:124 sc1
    s_waitcnt vmcnt(0)
    v_readfirstlane_b32 s17, v13
    s_xor_b32 s17, s17, s60
    s_bfe_u32 s17, s17, 0x170001
    s_cmp_gt_u32 s17, 32
    s_cselect_b32 s17, 1, 0
    s_cbranch_scc0 M_sblk0
    s_lshl_b32 s27, s15, 15
    s_add_u32 s27, s27, 32124
    buffer_load_dword v13, v12, s[36:39], s27 offen sc1
    s_waitcnt vmcnt(0)
    v_readfirstlane_b32 s17, v13
    s_min_u32 s17, s17, 3200
M_sblk0:
M_sblk:
    s_cmp_lt_u32 s16, s17
    s_cbranch_scc1 M_sld
    s_add_u32 s15, s15, 1
    s_mov_b32 s16, 0
    s_branch M_sovf
M_sld:
    s_mul_i32 s27, s15, 32768
    s_add_u32 s27, s27, 0x1100000
    v_add_u32 v12, s16, v8
    v_cmp_gt_u32 s[54:55], s17, v12
    v_lshlrev_b32 v12, 3, v12
    s_nop 0
    v_cndmask_b32 v12, v14, v12, s[54:55]
    buffer_load_dwordx2 v[88:89], v12, s[36:39], s27 offen sc1
    s_waitcnt vmcnt(0)
    v_cmp_eq_u32 vcc, s2, v89
    s_and_b64 s[54:55], s[54:55], vcc
    v_lshrrev_b32 v16, 24, v88
    v_subrev_u32 v17, s59, v16
    v_cmp_gt_u32 vcc, s45, v17
    s_and_b64 s[54:55], s[54:55], vcc
    v_and_b32 v96, 0x1fffe, v88
    v_lshl_add_u32 v96, v96, 1, v96
    v_and_b32 v96, -4, v96
    v_cndmask_b32 v96, v14, v96, s[54:55]
    buffer_load_dwordx2 v[98:99], v96, s[92:95], 0 offen
    v_mul_u32_u24 v97, 6, v16
    v_and_b32 v97, -4, v97
    v_cndmask_b32 v97, v14, v97, s[54:55]
    s_mul_i32 s27, s2, 1200
    buffer_load_dwordx2 v[100:101], v97, s[92:95], s27 offen
    v_bfe_i32 v102, v88, 1, 1
    v_and_or_b32 v102, v102, s63, v103
    v_bfe_i32 v104, v16, 0, 1
    v_and_or_b32 v104, v104, s63, v103
    v_add_u32 v105, s63, v104
    v_add_u32 v106, s63, v105
    s_waitcnt vmcnt(0)
    v_perm_b32 v107, v101, v100, v104
    v_perm_b32 v108, v101, v100, v105
    v_perm_b32 v109, v101, v100, v106
    v_add_u32 v113, s63, v102
    v_perm_b32 v110, v99, v98, v102
    v_add_u32 v114, s63, v113
    v_perm_b32 v111, v99, v98, v113
    v_perm_b32 v112, v99, v98, v114
    v_sub_f32 v110, v110, v107
    v_sub_f32 v111, v111, v108
    v_sub_f32 v112, v112, v109
    v_cvt_pk_bf16_f32 v89, v110, v111
    v_cvt_pk_bf16_f32 v112, 0, v112
    v_lshlrev_b32 v110, 16, v89
    v_and_b32 v111, s58, v89
    v_mul_f32 v115, v112, v112
    v_mul_f32 v110, v110, v110
    v_mul_f32 v111, v111, v111
    v_cvt_pk_bf16_f32 v115, 0, v115
    v_cvt_pk_bf16_f32 v110, 0, v110
    v_cvt_pk_bf16_f32 v111, 0, v111
    v_add_f32 v110, v110, v111
    v_add_f32 v110, v110, v115
    v_cvt_pk_bf16_f32 v110, 0, v110
    v_add_f32 v110, s64, v110
    v_cvt_pk_bf16_f32 v110, 0, v110
    v_sqrt_f32 v110, v110
    s_nop 0
    v_cvt_pk_bf16_f32 v90, v112, v110
    s_mov_b32 s27, 0x409d0000
    v_cmp_gt_u32 vcc, s27, v90
    s_and_b64 s[8:9], s[54:55], vcc
    s_mul_i32 s27, s15, 32768
    s_add_u32 s27, s27, 0x1100000
    v_add_u32 v12, s16, v86
    v_cmp_gt_u32 s[54:55], s17, v12
    v_lshlrev_b32 v12, 3, v12
    s_nop 0
    v_cndmask_b32 v12, v14, v12, s[54:55]
    buffer_load_dwordx2 v[92:93], v12, s[36:39], s27 offen sc1
    s_waitcnt vmcnt(0)
    v_cmp_eq_u32 vcc, s2, v93
    s_and_b64 s[54:55], s[54:55], vcc
    v_lshrrev_b32 v16, 24, v92
    v_subrev_u32 v17, s59, v16
    v_cmp_gt_u32 vcc, s45, v17
    s_and_b64 s[54:55], s[54:55], vcc
    v_and_b32 v96, 0x1fffe, v92
    v_lshl_add_u32 v96, v96, 1, v96
    v_and_b32 v96, -4, v96
    v_cndmask_b32 v96, v14, v96, s[54:55]
    buffer_load_dwordx2 v[98:99], v96, s[92:95], 0 offen
    v_mul_u32_u24 v97, 6, v16
    v_and_b32 v97, -4, v97
    v_cndmask_b32 v97, v14, v97, s[54:55]
    s_mul_i32 s27, s2, 1200
    buffer_load_dwordx2 v[100:101], v97, s[92:95], s27 offen
    v_bfe_i32 v102, v92, 1, 1
    v_and_or_b32 v102, v102, s63, v103
    v_bfe_i32 v104, v16, 0, 1
    v_and_or_b32 v104, v104, s63, v103
    v_add_u32 v105, s63, v104
    v_add_u32 v106, s63, v105
    s_waitcnt vmcnt(0)
    v_perm_b32 v107, v101, v100, v104
    v_perm_b32 v108, v101, v100, v105
    v_perm_b32 v109, v101, v100, v106
    v_add_u32 v113, s63, v102
    v_perm_b32 v110, v99, v98, v102
    v_add_u32 v114, s63, v113
    v_perm_b32 v111, v99, v98, v113
    v_perm_b32 v112, v99, v98, v114
    v_sub_f32 v110, v110, v107
    v_sub_f32 v111, v111, v108
    v_sub_f32 v112, v112, v109
    v_cvt_pk_bf16_f32 v93, v110, v111
    v_cvt_pk_bf16_f32 v112, 0, v112
    v_lshlrev_b32 v110, 16, v93
    v_and_b32 v111, s58, v93
    v_mul_f32 v115, v112, v112
    v_mul_f32 v110, v110, v110
    v_mul_f32 v111, v111, v111
    v_cvt_pk_bf16_f32 v115, 0, v115
    v_cvt_pk_bf16_f32 v110, 0, v110
    v_cvt_pk_bf16_f32 v111, 0, v111
    v_add_f32 v110, v110, v111
    v_add_f32 v110, v110, v115
    v_cvt_pk_bf16_f32 v110, 0, v110
    v_add_f32 v110, s64, v110
    v_cvt_pk_bf16_f32 v110, 0, v110
    v_sqrt_f32 v110, v110
    s_nop 0
    v_cvt_pk_bf16_f32 v94, v112, v110
    s_mov_b32 s27, 0x409d0000
    v_cmp_gt_u32 vcc, s27, v94
    s_and_b64 s[10:11], s[54:55], vcc
    s_add_u32 s16, s16, 128
    s_nop 2
M_sgo:
    s_or_b64 s[54:55], s[8:9], s[10:11]
    s_cmp_eq_u64 s[54:55], 0
    s_cbranch_scc1 M_slow
    s_mov_b32 s48, 4
    s_cmp_eq_u64 s[10:11], 0
    s_cselect_b32 s48, 2, 4
    s_movk_i32 s63, 0x70
    s_movk_i32 s64, 128
    v_lshrrev_b32 v8, 4, v1
    v_lshrrev_b32 v10, 5, v8
    v_and_b32 v11, 31, v8
    v_lshlrev_b32 v3, 4, v11
    v_add_u32 v3, s52, v3
    v_mul_u32_u24 v0, 56, v10
    v_add_u32 v0, s52, v0
    v_lshrrev_b32 v13, 3, v11
    v_lshl_add_u32 v4, v13, 3, v0
    v_lshrrev_b32 v13, 3, v8
    v_and_b32 v14, 1, v13
    v_lshrrev_b32 v13, 1, v13
    v_lshl_add_u32 v13, v14, 2, v13
    v_lshlrev_b32 v5, 4, v13
    v_add_u32 v5, s52, v5
    v_add_u32 v16, s52, v1
    v_lshrrev_b32 v17, 2, v8
    v_mul_u32_u24 v17, 56, v17
    v_and_b32 v13, 3, v8
    v_lshl_add_u32 v17, v13, 1, v17
    v_add_u32 v17, s52, v17
    s_nop 1
    s_branch M_win
M_send:
    s_mov_b64 s[8:9], 0
    s_mov_b64 s[10:11], 0
    s_mov_b32 s48, 0
    s_mov_b32 s76, 1
    s_movk_i32 s63, 0x70
    s_movk_i32 s64, 128
    v_lshrrev_b32 v8, 4, v1
    v_lshrrev_b32 v10, 5, v8
    v_and_b32 v11, 31, v8
    v_lshlrev_b32 v3, 4, v11
    v_add_u32 v3, s52, v3
    v_mul_u32_u24 v0, 56, v10
    v_add_u32 v0, s52, v0
    v_lshrrev_b32 v13, 3, v11
    v_lshl_add_u32 v4, v13, 3, v0
    v_lshrrev_b32 v13, 3, v8
    v_and_b32 v14, 1, v13
    v_lshrrev_b32 v13, 1, v13
    v_lshl_add_u32 v13, v14, 2, v13
    v_lshlrev_b32 v5, 4, v13
    v_add_u32 v5, s52, v5
    v_add_u32 v16, s52, v1
    v_lshrrev_b32 v17, 2, v8
    v_mul_u32_u24 v17, 56, v17
    v_and_b32 v13, 3, v8
    v_lshl_add_u32 v17, v13, 1, v17
    v_add_u32 v17, s52, v17
    s_nop 1
    s_branch M_win
.section .rodata,"a"
.p2align 6
.amdhsa_kernel standalone__molecular_angular_painn__graph_kernel
  .amdhsa_next_free_vgpr 256
  .amdhsa_next_free_sgpr 102
  .amdhsa_accum_offset 256
  .amdhsa_group_segment_fixed_size 0
  .amdhsa_kernarg_size 88
  .amdhsa_user_sgpr_count 2
  .amdhsa_user_sgpr_kernarg_segment_ptr 1
  .amdhsa_system_sgpr_workgroup_id_x 1
  .amdhsa_float_denorm_mode_32 3
.end_amdhsa_kernel
```

```asm
; @launch grid=(250,1,1) block=(512,1,1) lds=163840
.amdgcn_target "amdgcn-amd-amdhsa--gfx950"
.text
.globl standalone__molecular_angular_painn__graph_kernel
.p2align 12
.p2align 8
.type standalone__molecular_angular_painn__graph_kernel,@function
standalone__molecular_angular_painn__graph_kernel:
    s_cmp_ge_u32 s2, 250
    s_cbranch_scc1 K_end
    s_load_dwordx8 s[4:11], s[0:1], 0
    s_load_dwordx8 s[12:19], s[0:1], 32
    s_load_dwordx2 s[20:21], s[0:1], 64
    s_load_dwordx2 s[24:25], s[0:1], 80
    v_and_b32 v1, 63, v0
    v_lshrrev_b32 v119, 6, v0
    v_lshlrev_b32 v2, 4, v0
    v_readfirstlane_b32 s26, v119
    v_mov_b32 v20, 0xff000000
    v_mov_b32 v21, v20
    v_mov_b32 v22, v20
    v_mov_b32 v23, v20
    v_add_u32 v117, 131840, v2
    ds_write_b128 v117, v[20:23] offset:0
    ds_write_b128 v117, v[20:23] offset:8192
    ds_write_b128 v117, v[20:23] offset:16384
    v_cmp_gt_u32 vcc, 464, v0
    s_mov_b64 s[66:67], vcc
    s_mov_b64 exec, vcc
    ds_write_b128 v117, v[20:23] offset:24576
    s_mov_b64 exec, -1
    v_lshlrev_b32 v28, 2, v0
    v_mov_b32 v29, 0
    v_cmp_gt_u32 vcc, 256, v0
    s_and_saveexec_b64 s[60:61], vcc
    ds_write_b32 v28, v29 offset:8192
    s_mov_b64 exec, -1
    v_mov_b32 v30, 131076
    ds_write2_b32 v30, v29, v29 offset1:1
    ds_write_b32 v30, v29 offset:8
    s_mov_b32 s58, 0xffff0000
    v_lshlrev_b32 v3, 4, v1
    v_mov_b32 v116, 1
    v_lshrrev_b32 v119, 4, v1
    v_and_b32 v120, 15, v1
    v_lshlrev_b32 v121, 9, v120
    v_lshl_add_u32 v121, v119, 4, v121
    v_bfrev_b32 v118, 2
    s_cmp_eq_u32 s26, 4
    s_cselect_b32 s63, 8, 16
    s_cmp_gt_u32 s26, 4
    s_cselect_b32 s63, 0, s63
    v_cmp_gt_u32 vcc, s63, v120
    s_nop 1
    v_cndmask_b32 v36, v118, v121, vcc
    s_mul_i32 s62, s2, 200
    s_lshl_b32 s61, s26, 4
    s_add_u32 s62, s62, s61
    s_lshl_b32 s76, s62, 9
    s_add_u32 s77, s76, 65536
    s_mul_i32 s27, s2, 12800
    s_add_u32 s59, s27, 6400
    v_cmp_gt_u32 vcc, 400, v0
    s_mov_b64 s[56:57], vcc
    s_lshl_b32 s64, s26, 10
    s_add_u32 m0, s64, 0
    s_waitcnt lgkmcnt(0)
    s_barrier
    s_mov_b32 s48, s14
    s_mov_b32 s49, s15
    s_mov_b32 s50, 0x2000
    s_mov_b32 s51, 0x00020000
    s_cmp_eq_u32 s26, 7
    s_cbranch_scc1 P_w7
    s_mov_b32 s44, s10
    s_mov_b32 s45, s11
    s_mov_b32 s46, 0x30d400
    s_mov_b32 s47, 0x00020000
    s_mov_b32 s40, s8
    s_mov_b32 s41, s9
    s_mov_b32 s42, 0x30d400
    s_mov_b32 s43, 0x00020000
    s_mov_b32 s28, s4
    s_mov_b32 s29, s5
    s_mov_b32 s30, 0x186a000
    s_mov_b32 s31, 0x00020000
    buffer_load_dwordx4 v3, s[48:51], s64 offen lds
    s_mov_b64 exec, s[56:57]
    buffer_load_dwordx4 v[4:7], v2, s[44:47], s27 offen nt
    buffer_load_dwordx4 v[8:11], v2, s[44:47], s59 offen nt
    buffer_load_dwordx4 v[12:15], v2, s[40:43], s27 offen nt
    buffer_load_dwordx4 v[16:19], v2, s[40:43], s59 offen nt
    s_mov_b64 exec, -1
    s_mov_b32 s92, s6
    s_mov_b32 s93, s7
    s_mov_b32 s94, 0x493e0
    s_mov_b32 s95, 0x00020000
    s_mov_b32 s36, s24
    s_mov_b32 s37, s25
    s_mov_b32 s38, 0x241a800
    s_mov_b32 s39, 0x00020000
    s_add_u32 s72, s24, 0x1e00000
    s_addc_u32 s73, s25, 0
    s_mov_b32 s74, 0x61a800
    s_mov_b32 s75, 0x00020000
    s_mov_b32 s52, s16
    s_mov_b32 s53, s17
    s_mov_b32 s54, 0x6000
    s_mov_b32 s55, 0x00020000
    s_mov_b32 s96, s18
    s_mov_b32 s97, s19
    s_mov_b32 s98, 0x1800
    s_mov_b32 s99, 0x00020000
    s_mov_b32 s68, s12
    s_mov_b32 s69, s13
    s_mov_b32 s70, 0x20
    s_mov_b32 s71, 0x00020000
    s_mov_b32 s32, s20
    s_mov_b32 s33, s21
    s_mov_b32 s34, 0x186a000
    s_mov_b32 s35, 0x00020000
    v_bfe_u32 v122, v1, 2, 2
    v_lshl_add_u32 v122, v119, 3, v122
    v_lshlrev_b32 v122, 7, v122
    v_and_b32 v39, 3, v1
    v_lshl_add_u32 v122, v39, 3, v122
    s_mov_b64 exec, 0
    s_cmp_eq_u32 s26, 0
    s_cbranch_scc1 WUP_413
    s_cmp_eq_u32 s26, 1
    s_cbranch_scc1 WUP_548
    s_cmp_eq_u32 s26, 2
    s_cbranch_scc1 WUP_934
    s_cmp_eq_u32 s26, 3
    s_cbranch_scc1 WUP_4220
    s_cmp_eq_u32 s26, 4
    s_cbranch_scc1 WUP_1270
    s_cmp_eq_u32 s26, 5
    s_cbranch_scc1 WUP_1607
    s_cmp_eq_u32 s26, 6
    s_cbranch_scc1 WUP_1974
WUR_0:
    s_mov_b64 exec, -1
    s_nop 1
    s_branch P_bin
P_w7:
    s_lshr_b32 s3, s2, 3
    s_lshl_b32 s3, s3, 2
    s_and_b32 s65, s2, 3
    s_add_u32 s3, s3, s65
    s_and_b32 s65, s2, 4
    s_cselect_b32 s3, 0xffff, s3
    s_mul_i32 s65, s3, 3072
    v_mul_u32_u24 v38, 24, v1
    s_cmp_ge_u32 s3, 98
    s_cselect_b32 s65, 0x40000000, s65
    s_mov_b32 s92, s6
    s_mov_b32 s93, s7
    s_mov_b32 s94, 0x493e0
    s_mov_b32 s95, 0x00020000
    buffer_load_dwordx3 v[4:6], v38, s[92:95], s65 offen offset:0
    buffer_load_dwordx3 v[8:10], v38, s[92:95], s65 offen offset:12
    buffer_load_dwordx3 v[12:14], v38, s[92:95], s65 offen offset:1536
    buffer_load_dwordx3 v[16:18], v38, s[92:95], s65 offen offset:1548
    s_mov_b32 s27, 0x830000
    buffer_load_dwordx4 v3, s[48:51], s64 offen lds
    s_load_dword s22, s[24:25], s27
    s_mov_b32 s28, s4
    s_mov_b32 s29, s5
    s_mov_b32 s30, 0x186a000
    s_mov_b32 s31, 0x00020000
    s_mov_b32 s92, s6
    s_mov_b32 s93, s7
    s_mov_b32 s94, 0x493e0
    s_mov_b32 s95, 0x00020000
    s_mov_b32 s36, s24
    s_mov_b32 s37, s25
    s_mov_b32 s38, 0x241a800
    s_mov_b32 s39, 0x00020000
    s_add_u32 s72, s24, 0x1e00000
    s_addc_u32 s73, s25, 0
    s_mov_b32 s74, 0x61a800
    s_mov_b32 s75, 0x00020000
    s_mov_b32 s52, s16
    s_mov_b32 s53, s17
    s_mov_b32 s54, 0x6000
    s_mov_b32 s55, 0x00020000
    s_mov_b32 s96, s18
    s_mov_b32 s97, s19
    s_mov_b32 s98, 0x1800
    s_mov_b32 s99, 0x00020000
    s_mov_b32 s68, s12
    s_mov_b32 s69, s13
    s_mov_b32 s70, 0x20
    s_mov_b32 s71, 0x00020000
    s_mov_b32 s32, s20
    s_mov_b32 s33, s21
    s_mov_b32 s34, 0x186a000
    s_mov_b32 s35, 0x00020000
    v_bfe_u32 v122, v1, 2, 2
    v_lshl_add_u32 v122, v119, 3, v122
    v_lshlrev_b32 v122, 7, v122
    v_and_b32 v39, 3, v1
    v_lshl_add_u32 v122, v39, 3, v122
    s_cmp_ge_u32 s3, 98
    s_nop 0
    s_cbranch_scc1 P_w7n
    s_mov_b32 s60, 0x41800000
    s_movk_i32 s65, 0xf8
    v_lshlrev_b32 v38, 3, v1
    s_mul_i32 s27, s3, 1024
    s_add_u32 s27, s27, 0x810000
    s_waitcnt vmcnt(3)
    v_lshlrev_b32 v68, 16, v4
    v_and_b32 v69, s58, v4
    v_lshlrev_b32 v70, 16, v5
    v_and_b32 v71, s58, v5
    v_lshlrev_b32 v72, 16, v6
    v_and_b32 v73, s58, v6
    v_lshlrev_b32 v74, 16, v8
    v_and_b32 v75, s58, v8
    v_lshlrev_b32 v76, 16, v9
    v_and_b32 v77, s58, v9
    v_lshlrev_b32 v78, 16, v10
    v_and_b32 v79, s58, v10
    v_mul_f32 v68, s60, v68
    v_mul_f32 v69, s60, v69
    v_mul_f32 v70, s60, v70
    v_mul_f32 v71, s60, v71
    v_mul_f32 v72, s60, v72
    v_mul_f32 v73, s60, v73
    v_mul_f32 v74, s60, v74
    v_mul_f32 v75, s60, v75
    v_mul_f32 v76, s60, v76
    v_mul_f32 v77, s60, v77
    v_mul_f32 v78, s60, v78
    v_mul_f32 v79, s60, v79
    v_cvt_flr_i32_f32 v68, v68
    v_cvt_flr_i32_f32 v69, v69
    v_cvt_flr_i32_f32 v70, v70
    v_cvt_flr_i32_f32 v71, v71
    v_cvt_flr_i32_f32 v72, v72
    v_cvt_flr_i32_f32 v73, v73
    v_cvt_flr_i32_f32 v74, v74
    v_cvt_flr_i32_f32 v75, v75
    v_cvt_flr_i32_f32 v76, v76
    v_cvt_flr_i32_f32 v77, v77
    v_cvt_flr_i32_f32 v78, v78
    v_cvt_flr_i32_f32 v79, v79
    v_bfe_u32 v84, v70, 5, 3
    v_bfe_u32 v85, v70, 2, 3
    v_and_or_b32 v68, v68, s65, v84
    v_and_or_b32 v69, v69, s65, v85
    v_lshl_or_b32 v68, v69, 8, v68
    v_bfe_u32 v84, v73, 5, 3
    v_bfe_u32 v85, v73, 2, 3
    v_and_or_b32 v71, v71, s65, v84
    v_and_or_b32 v72, v72, s65, v85
    v_lshl_or_b32 v71, v72, 8, v71
    v_bfe_u32 v84, v76, 5, 3
    v_bfe_u32 v85, v76, 2, 3
    v_and_or_b32 v74, v74, s65, v84
    v_and_or_b32 v75, v75, s65, v85
    v_lshl_or_b32 v74, v75, 8, v74
    v_bfe_u32 v84, v79, 5, 3
    v_bfe_u32 v85, v79, 2, 3
    v_and_or_b32 v77, v77, s65, v84
    v_and_or_b32 v78, v78, s65, v85
    v_lshl_or_b32 v77, v78, 8, v77
    v_lshl_or_b32 v86, v71, 16, v68
    v_lshl_or_b32 v87, v77, 16, v74
    buffer_store_dwordx2 v[86:87], v38, s[36:39], s27 offen offset:0 sc1
    s_waitcnt vmcnt(2)
    v_lshlrev_b32 v68, 16, v12
    v_and_b32 v69, s58, v12
    v_lshlrev_b32 v70, 16, v13
    v_and_b32 v71, s58, v13
    v_lshlrev_b32 v72, 16, v14
    v_and_b32 v73, s58, v14
    v_lshlrev_b32 v74, 16, v16
    v_and_b32 v75, s58, v16
    v_lshlrev_b32 v76, 16, v17
    v_and_b32 v77, s58, v17
    v_lshlrev_b32 v78, 16, v18
    v_and_b32 v79, s58, v18
    v_mul_f32 v68, s60, v68
    v_mul_f32 v69, s60, v69
    v_mul_f32 v70, s60, v70
    v_mul_f32 v71, s60, v71
    v_mul_f32 v72, s60, v72
    v_mul_f32 v73, s60, v73
    v_mul_f32 v74, s60, v74
    v_mul_f32 v75, s60, v75
    v_mul_f32 v76, s60, v76
    v_mul_f32 v77, s60, v77
    v_mul_f32 v78, s60, v78
    v_mul_f32 v79, s60, v79
    v_cvt_flr_i32_f32 v68, v68
    v_cvt_flr_i32_f32 v69, v69
    v_cvt_flr_i32_f32 v70, v70
    v_cvt_flr_i32_f32 v71, v71
    v_cvt_flr_i32_f32 v72, v72
    v_cvt_flr_i32_f32 v73, v73
    v_cvt_flr_i32_f32 v74, v74
    v_cvt_flr_i32_f32 v75, v75
    v_cvt_flr_i32_f32 v76, v76
    v_cvt_flr_i32_f32 v77, v77
    v_cvt_flr_i32_f32 v78, v78
    v_cvt_flr_i32_f32 v79, v79
    v_bfe_u32 v84, v70, 5, 3
    v_bfe_u32 v85, v70, 2, 3
    v_and_or_b32 v68, v68, s65, v84
    v_and_or_b32 v69, v69, s65, v85
    v_lshl_or_b32 v68, v69, 8, v68
    v_bfe_u32 v84, v73, 5, 3
    v_bfe_u32 v85, v73, 2, 3
    v_and_or_b32 v71, v71, s65, v84
    v_and_or_b32 v72, v72, s65, v85
    v_lshl_or_b32 v71, v72, 8, v71
    v_bfe_u32 v84, v76, 5, 3
    v_bfe_u32 v85, v76, 2, 3
    v_and_or_b32 v74, v74, s65, v84
    v_and_or_b32 v75, v75, s65, v85
    v_lshl_or_b32 v74, v75, 8, v74
    v_bfe_u32 v84, v79, 5, 3
    v_bfe_u32 v85, v79, 2, 3
    v_and_or_b32 v77, v77, s65, v84
    v_and_or_b32 v78, v78, s65, v85
    v_lshl_or_b32 v77, v78, 8, v77
    v_lshl_or_b32 v88, v71, 16, v68
    v_lshl_or_b32 v89, v77, 16, v74
    buffer_store_dwordx2 v[88:89], v38, s[36:39], s27 offen offset:512 sc1
    s_nop 0
P_w7n:
    buffer_load_dwordx4 v[20:23], v121, s[28:31], s76 offen offset:0
    buffer_load_dwordx4 v[24:27], v121, s[28:31], s76 offen offset:64
    s_waitcnt lgkmcnt(0)
    v_lshrrev_b32 v124, 5, v1
    v_and_b32 v125, 31, v1
    v_mul_u32_u24 v124, 3072, v124
    v_lshl_add_u32 v124, v125, 2, v124
    s_lshr_b32 s60, s26, 2
    s_and_b32 s61, s26, 3
    s_mul_i32 s63, s61, 768
    s_lshl_b32 s65, s60, 7
    s_add_u32 s63, s63, s65
    s_add_u32 s65, s63, 0
    buffer_load_dword v128, v124, s[52:55], s65 offen
    s_add_u32 s65, s63, 6144
    buffer_load_dword v129, v124, s[52:55], s65 offen
    s_add_u32 s65, s63, 12288
    buffer_load_dword v130, v124, s[52:55], s65 offen
    s_add_u32 s65, s63, 18432
    buffer_load_dword v131, v124, s[52:55], s65 offen
    s_add_u32 s65, s63, 384
    buffer_load_dword v132, v124, s[52:55], s65 offen
    s_add_u32 s65, s63, 6528
    buffer_load_dword v133, v124, s[52:55], s65 offen
    s_add_u32 s65, s63, 12672
    buffer_load_dword v134, v124, s[52:55], s65 offen
    s_add_u32 s65, s63, 18816
    buffer_load_dword v135, v124, s[52:55], s65 offen
    s_cmp_ge_u32 s26, 4
    s_cbranch_scc1 P_e2c
    s_add_u32 s27, s26, 8
    s_lshr_b32 s60, s27, 2
    s_and_b32 s61, s27, 3
    s_mul_i32 s63, s61, 768
    s_lshl_b32 s65, s60, 7
    s_add_u32 s63, s63, s65
    s_add_u32 s65, s63, 0
    buffer_load_dword v136, v124, s[52:55], s65 offen
    s_add_u32 s65, s63, 6144
    buffer_load_dword v137, v124, s[52:55], s65 offen
    s_add_u32 s65, s63, 12288
    buffer_load_dword v138, v124, s[52:55], s65 offen
    s_add_u32 s65, s63, 18432
    buffer_load_dword v139, v124, s[52:55], s65 offen
    s_add_u32 s65, s63, 384
    buffer_load_dword v140, v124, s[52:55], s65 offen
    s_add_u32 s65, s63, 6528
    buffer_load_dword v141, v124, s[52:55], s65 offen
    s_add_u32 s65, s63, 12672
    buffer_load_dword v142, v124, s[52:55], s65 offen
    s_add_u32 s65, s63, 18816
    buffer_load_dword v143, v124, s[52:55], s65 offen
    s_branch P_e3c
P_e2c:
    s_sub_u32 s60, s26, 4
    s_lshl_b32 s63, s60, 7
    s_cmp_eq_u32 s26, 7
    s_cselect_b32 s63, 0x40000000, s63
    buffer_load_dword v136, v124, s[96:99], s63 offen offset:0
    buffer_load_dword v137, v124, s[96:99], s63 offen offset:384
    buffer_load_dword v138, v124, s[96:99], s63 offen offset:768
    buffer_load_dword v139, v124, s[96:99], s63 offen offset:1152
    buffer_load_dword v140, v124, s[96:99], s63 offen offset:1536
    buffer_load_dword v141, v124, s[96:99], s63 offen offset:1920
    buffer_load_dword v142, v124, s[96:99], s63 offen offset:2304
    buffer_load_dword v143, v124, s[96:99], s63 offen offset:2688
P_e3c:
    v_mul_u32_u24 v124, 6, v0
    v_and_b32 v124, -4, v124
    v_cmp_gt_u32 vcc, 200, v0
    s_nop 1
    v_cndmask_b32 v124, v118, v124, vcc
    s_mul_i32 s27, s2, 1200
    buffer_load_dwordx2 v[144:145], v124, s[92:95], s27 offen
    v_lshlrev_b32 v124, 1, v1
    buffer_load_ushort v146, v124, s[68:71], 0 offen
    s_waitcnt vmcnt(20) lgkmcnt(0)
    s_add_u32 s22, s22, 1
    v_mov_b32 v38, s22
    v_mov_b32 v39, 131072
    ds_write_b32 v39, v38
    s_cmp_ge_u32 s3, 98
    s_cbranch_scc1 P_join
    s_lshl_b32 s27, s3, 3
    s_add_u32 s27, s27, 0x830100
    v_mov_b32 v8, s22
    v_mov_b32 v9, s22
    v_mov_b32 v12, 0
    s_mov_b64 exec, 1
    buffer_store_dwordx2 v[8:9], v12, s[36:39], s27 offen sc1
    s_mov_b64 exec, -1
    s_branch P_join
P_bin:
WUP_413:
    s_cbranch_execz WUR_0
    s_mov_b32 s63, 0x147AE15
    s_movk_i32 s65, -200
    s_mov_b32 s60, 8192
    s_mov_b32 s61, 131840
    s_mov_b64 exec, s[56:57]
    s_waitcnt vmcnt(3)
    s_mov_b64 exec, -1
    buffer_load_dwordx4 v[20:23], v121, s[28:31], s76 offen offset:0
    buffer_load_dwordx4 v[24:27], v121, s[28:31], s76 offen offset:64
    buffer_load_dwordx4 v[28:31], v36, s[28:31], s77 offen offset:0
    buffer_load_dwordx4 v[32:35], v36, s[28:31], s77 offen offset:64
    v_lshrrev_b32 v124, 5, v1
    v_and_b32 v125, 31, v1
    v_mul_u32_u24 v124, 3072, v124
    v_lshl_add_u32 v124, v125, 2, v124
    s_lshr_b32 s60, s26, 2
    s_and_b32 s61, s26, 3
    s_mul_i32 s63, s61, 768
    s_lshl_b32 s65, s60, 7
    s_add_u32 s63, s63, s65
    s_add_u32 s65, s63, 0
    buffer_load_dword v128, v124, s[52:55], s65 offen
    s_add_u32 s65, s63, 6144
    buffer_load_dword v129, v124, s[52:55], s65 offen
    s_add_u32 s65, s63, 12288
    buffer_load_dword v130, v124, s[52:55], s65 offen
    s_add_u32 s65, s63, 18432
    buffer_load_dword v131, v124, s[52:55], s65 offen
    s_add_u32 s65, s63, 384
    buffer_load_dword v132, v124, s[52:55], s65 offen
    s_add_u32 s65, s63, 6528
    buffer_load_dword v133, v124, s[52:55], s65 offen
    s_add_u32 s65, s63, 12672
    buffer_load_dword v134, v124, s[52:55], s65 offen
    s_add_u32 s65, s63, 18816
    buffer_load_dword v135, v124, s[52:55], s65 offen
    s_cmp_ge_u32 s26, 4
    s_cbranch_scc1 P_e2a
    s_add_u32 s27, s26, 8
    s_lshr_b32 s60, s27, 2
    s_and_b32 s61, s27, 3
    s_mul_i32 s63, s61, 768
    s_lshl_b32 s65, s60, 7
    s_add_u32 s63, s63, s65
    s_add_u32 s65, s63, 0
    buffer_load_dword v136, v124, s[52:55], s65 offen
    s_add_u32 s65, s63, 6144
    buffer_load_dword v137, v124, s[52:55], s65 offen
    s_add_u32 s65, s63, 12288
    buffer_load_dword v138, v124, s[52:55], s65 offen
    s_add_u32 s65, s63, 18432
    buffer_load_dword v139, v124, s[52:55], s65 offen
    s_add_u32 s65, s63, 384
    buffer_load_dword v140, v124, s[52:55], s65 offen
    s_add_u32 s65, s63, 6528
    buffer_load_dword v141, v124, s[52:55], s65 offen
    s_add_u32 s65, s63, 12672
    buffer_load_dword v142, v124, s[52:55], s65 offen
    s_add_u32 s65, s63, 18816
    buffer_load_dword v143, v124, s[52:55], s65 offen
    s_branch P_e3a
P_e2a:
    s_sub_u32 s60, s26, 4
    s_lshl_b32 s63, s60, 7
    s_cmp_eq_u32 s26, 7
    s_cselect_b32 s63, 0x40000000, s63
    buffer_load_dword v136, v124, s[96:99], s63 offen offset:0
    buffer_load_dword v137, v124, s[96:99], s63 offen offset:384
    buffer_load_dword v138, v124, s[96:99], s63 offen offset:768
    buffer_load_dword v139, v124, s[96:99], s63 offen offset:1152
    buffer_load_dword v140, v124, s[96:99], s63 offen offset:1536
    buffer_load_dword v141, v124, s[96:99], s63 offen offset:1920
    buffer_load_dword v142, v124, s[96:99], s63 offen offset:2304
    buffer_load_dword v143, v124, s[96:99], s63 offen offset:2688
P_e3a:
    v_mul_u32_u24 v124, 6, v0
    v_and_b32 v124, -4, v124
    v_cmp_gt_u32 vcc, 200, v0
    s_nop 1
    v_cndmask_b32 v124, v118, v124, vcc
    s_mul_i32 s27, s2, 1200
    buffer_load_dwordx2 v[144:145], v124, s[92:95], s27 offen
    v_lshlrev_b32 v124, 1, v1
    buffer_load_ushort v146, v124, s[68:71], 0 offen
    s_mov_b32 s63, 0x147AE15
    s_movk_i32 s65, -200
    s_mov_b32 s60, 8192
    s_mov_b32 s61, 131840
    s_mov_b64 exec, s[56:57]
    v_mul_hi_u32 v68, v4, s63
    v_lshl_add_u32 v84, v68, 2, s60
    ds_add_rtn_u32 v76, v84, v116
    v_mul_hi_u32 v69, v5, s63
    v_lshl_add_u32 v85, v69, 2, s60
    ds_add_rtn_u32 v77, v85, v116
    v_mul_hi_u32 v70, v6, s63
    v_lshl_add_u32 v86, v70, 2, s60
    ds_add_rtn_u32 v78, v86, v116
    v_mul_hi_u32 v71, v7, s63
    v_lshl_add_u32 v87, v71, 2, s60
    ds_add_rtn_u32 v79, v87, v116
    s_waitcnt vmcnt(24)
    v_mul_hi_u32 v72, v8, s63
    v_lshl_add_u32 v88, v72, 2, s60
    ds_add_rtn_u32 v80, v88, v116
    v_mul_hi_u32 v73, v9, s63
    v_lshl_add_u32 v89, v73, 2, s60
    ds_add_rtn_u32 v81, v89, v116
    v_mul_hi_u32 v74, v10, s63
    v_lshl_add_u32 v90, v74, 2, s60
    ds_add_rtn_u32 v82, v90, v116
    v_mul_hi_u32 v75, v11, s63
    v_lshl_add_u32 v91, v75, 2, s60
    ds_add_rtn_u32 v83, v91, v116
    v_mad_i32_i24 v4, v68, s65, v4
    v_lshlrev_b32 v4, 24, v4
    v_lshl_add_u32 v84, v68, 7, s61
    v_mad_i32_i24 v5, v69, s65, v5
    v_lshlrev_b32 v5, 24, v5
    v_lshl_add_u32 v85, v69, 7, s61
    v_mad_i32_i24 v6, v70, s65, v6
    v_lshlrev_b32 v6, 24, v6
    v_lshl_add_u32 v86, v70, 7, s61
    v_mad_i32_i24 v7, v71, s65, v7
    v_lshlrev_b32 v7, 24, v7
    v_lshl_add_u32 v87, v71, 7, s61
    v_mad_i32_i24 v8, v72, s65, v8
    v_lshlrev_b32 v8, 24, v8
    v_lshl_add_u32 v88, v72, 7, s61
    v_mad_i32_i24 v9, v73, s65, v9
    v_lshlrev_b32 v9, 24, v9
    v_lshl_add_u32 v89, v73, 7, s61
    v_mad_i32_i24 v10, v74, s65, v10
    v_lshlrev_b32 v10, 24, v10
    v_lshl_add_u32 v90, v74, 7, s61
    v_mad_i32_i24 v11, v75, s65, v11
    v_lshlrev_b32 v11, 24, v11
WUP_548:
    s_cbranch_execz WUP_721
    v_lshl_add_u32 v91, v75, 7, s61
    s_waitcnt vmcnt(22)
    v_lshl_or_b32 v92, v12, 1, v4
    v_lshl_or_b32 v93, v13, 1, v5
    v_lshl_or_b32 v94, v14, 1, v6
    v_lshl_or_b32 v95, v15, 1, v7
    v_lshl_or_b32 v96, v16, 1, v8
    v_lshl_or_b32 v97, v17, 1, v9
    v_lshl_or_b32 v98, v18, 1, v10
    v_lshl_or_b32 v99, v19, 1, v11
    s_waitcnt lgkmcnt(0)
    v_max3_u32 v36, v76, v77, v78
    v_max3_u32 v37, v79, v80, v81
    v_max3_u32 v36, v36, v82, v83
    v_max_u32 v36, v36, v37
    v_lshl_add_u32 v12, v76, 2, v84
    v_lshl_add_u32 v13, v77, 2, v85
    v_lshl_add_u32 v14, v78, 2, v86
    v_lshl_add_u32 v15, v79, 2, v87
    v_lshl_add_u32 v16, v80, 2, v88
    v_lshl_add_u32 v17, v81, 2, v89
    v_lshl_add_u32 v18, v82, 2, v90
    v_lshl_add_u32 v19, v83, 2, v91
    v_cmp_lt_u32 vcc, 30, v36
    s_nop 4
    s_cbranch_vccnz P_rare
    ds_write_b32 v12, v92
    ds_write_b32 v13, v93
    ds_write_b32 v14, v94
    ds_write_b32 v15, v95
    ds_write_b32 v16, v96
    ds_write_b32 v17, v97
    ds_write_b32 v18, v98
    ds_write_b32 v19, v99
    s_mov_b64 exec, -1
P_join:
    s_lshl_b32 s23, s2, 15
    v_mov_b32 v4, 131072
    s_waitcnt lgkmcnt(0)
    s_mov_b64 exec, 0
    s_cmp_eq_u32 s26, 0
    s_cbranch_scc1 WUP_2300
    s_cmp_eq_u32 s26, 1
    s_cbranch_scc1 WUP_2486
    s_cmp_eq_u32 s26, 2
    s_cbranch_scc1 WUP_2657
    s_cmp_eq_u32 s26, 3
    s_cbranch_scc1 WUP_3314
WUR_1:
    s_mov_b64 exec, -1
    s_barrier
    ds_read_b64 v[4:5], v4
    ds_read_b128 v[100:103], v117 offset:0
    ds_read_b128 v[104:107], v117 offset:8192
    ds_read_b128 v[108:111], v117 offset:16384
    ds_read_b128 v[112:115], v117 offset:24576
    s_waitcnt lgkmcnt(4)
    v_readfirstlane_b32 s18, v4
    v_readfirstlane_b32 s19, v5
    s_bfe_u32 s8, s18, 0x70001
    s_lshl_b32 s8, s8, 17
    s_bfe_u32 s27, s18, 0x10000
    s_or_b32 s8, s8, s27
    s_bfe_u32 s9, s18, 0x70009
    s_lshl_b32 s9, s9, 17
    s_bfe_u32 s27, s18, 0x10008
    s_or_b32 s9, s9, s27
    s_bfe_u32 s10, s18, 0x70011
    s_lshl_b32 s10, s10, 17
    s_bfe_u32 s27, s18, 0x10010
    s_or_b32 s10, s10, s27
    s_bfe_u32 s11, s18, 0x70019
    s_lshl_b32 s11, s11, 17
    s_bfe_u32 s27, s18, 0x10018
    s_or_b32 s11, s11, s27
    s_cmp_eq_u32 s19, 0
    s_cbranch_scc1 P_noovf
    v_mov_b32 v4, 131080
    ds_read_b32 v4, v4
    v_mov_b32 v5, 0
    s_add_u32 s27, s23, 32124
    s_waitcnt lgkmcnt(0)
    buffer_store_dword v4, v5, s[36:39], s27 offen sc1
    s_waitcnt vmcnt(0)
    s_barrier
P_noovf:
    s_waitcnt lgkmcnt(3)
    v_xor_b32 v100, s8, v100
    v_xor_b32 v101, s9, v101
    v_xor_b32 v102, s10, v102
    v_xor_b32 v103, s11, v103
    buffer_store_dwordx4 v[100:103], v2, s[36:39], s23 offen sc1
    s_waitcnt lgkmcnt(2)
    v_xor_b32 v104, s8, v104
    v_xor_b32 v105, s9, v105
    v_xor_b32 v106, s10, v106
    v_xor_b32 v107, s11, v107
    s_add_u32 s59, s23, 8192
    buffer_store_dwordx4 v[104:107], v2, s[36:39], s59 offen sc1
    s_waitcnt lgkmcnt(1)
    v_xor_b32 v108, s8, v108
    v_xor_b32 v109, s9, v109
    v_xor_b32 v110, s10, v110
    v_xor_b32 v111, s11, v111
    s_add_u32 s59, s23, 16384
    buffer_store_dwordx4 v[108:111], v2, s[36:39], s59 offen sc1
    s_waitcnt lgkmcnt(0)
    v_xor_b32 v112, s8, v112
    v_xor_b32 v113, s9, v113
    v_xor_b32 v114, s10, v114
    v_xor_b32 v115, s11, v115
    s_mov_b64 exec, s[66:67]
    s_add_u32 s59, s23, 24576
    buffer_store_dwordx4 v[112:115], v2, s[36:39], s59 offen sc1
    s_mov_b64 exec, -1
    ds_read_b64_tr_b16 v[36:37], v122 offset:0
    ds_read_b64_tr_b16 v[38:39], v122 offset:512
    ds_read_b64_tr_b16 v[40:41], v122 offset:4096
    ds_read_b64_tr_b16 v[42:43], v122 offset:4608
    ds_read_b64_tr_b16 v[44:45], v122 offset:32
    ds_read_b64_tr_b16 v[46:47], v122 offset:544
    ds_read_b64_tr_b16 v[48:49], v122 offset:4128
    ds_read_b64_tr_b16 v[50:51], v122 offset:4640
    ds_read_b64_tr_b16 v[52:53], v122 offset:64
    ds_read_b64_tr_b16 v[54:55], v122 offset:576
    ds_read_b64_tr_b16 v[56:57], v122 offset:4160
    ds_read_b64_tr_b16 v[58:59], v122 offset:4672
    ds_read_b64_tr_b16 v[60:61], v122 offset:96
    ds_read_b64_tr_b16 v[62:63], v122 offset:608
    ds_read_b64_tr_b16 v[64:65], v122 offset:4192
    ds_read_b64_tr_b16 v[66:67], v122 offset:4704
    v_and_b32 v250, -2, v1
    v_add_lshl_u32 v250, v250, v1, 7
    v_cmp_gt_u32 vcc, 10, v1
    s_nop 1
    v_cndmask_b32 v250, v118, v250, vcc
    s_mul_i32 s65, s2, 102400
    s_mul_i32 s63, s26, 12800
    s_add_u32 s65, s65, s63
    buffer_load_dword v158, v250, s[28:31], s65 offen offset:256
    v_mov_b32 v5, 0xbfb8aa3b
    v_mov_b32 v6, 1.0
    v_lshlrev_b32 v123, 9, v119
    v_lshl_add_u32 v123, v120, 3, v123
    s_lshl_b32 s27, s62, 7
    s_waitcnt lgkmcnt(0)
    s_barrier
    s_mul_i32 s20, s2, 102400
    s_mul_i32 s21, s26, 12800
    s_add_u32 s20, s20, s21
    s_add_u32 s20, s4, s20
    s_addc_u32 s21, s5, 0
    s_waitcnt vmcnt(23)
    s_cmp_gt_u32 s26, 4
    s_cbranch_scc0 P_np
    s_setprio 2
P_np:
    v_mfma_f32_16x16x32_bf16 v[68:71], v[20:23], v[36:39], 0
    v_mfma_f32_16x16x32_bf16 v[72:75], v[20:23], v[44:47], 0
    v_mfma_f32_16x16x32_bf16 v[76:79], v[20:23], v[52:55], 0
    v_mfma_f32_16x16x32_bf16 v[80:83], v[20:23], v[60:63], 0
    v_mfma_f32_16x16x32_bf16 v[68:71], v[24:27], v[40:43], v[68:71]
    v_mfma_f32_16x16x32_bf16 v[72:75], v[24:27], v[48:51], v[72:75]
    v_mfma_f32_16x16x32_bf16 v[76:79], v[24:27], v[56:59], v[76:79]
    v_mfma_f32_16x16x32_bf16 v[80:83], v[24:27], v[64:67], v[80:83]
    s_nop 4
    v_cvt_pk_bf16_f32 v68, 0, v68
    v_cvt_pk_bf16_f32 v69, 0, v69
    v_cvt_pk_bf16_f32 v70, 0, v70
    v_cvt_pk_bf16_f32 v71, 0, v71
    v_cvt_pk_bf16_f32 v72, 0, v72
    v_cvt_pk_bf16_f32 v73, 0, v73
    v_cvt_pk_bf16_f32 v74, 0, v74
    v_cvt_pk_bf16_f32 v75, 0, v75
    v_cvt_pk_bf16_f32 v76, 0, v76
    v_cvt_pk_bf16_f32 v77, 0, v77
    v_cvt_pk_bf16_f32 v78, 0, v78
WUP_721:
    s_cbranch_execz WUR_0
    v_cvt_pk_bf16_f32 v79, 0, v79
    v_cvt_pk_bf16_f32 v80, 0, v80
    v_cvt_pk_bf16_f32 v81, 0, v81
    v_cvt_pk_bf16_f32 v82, 0, v82
    v_cvt_pk_bf16_f32 v83, 0, v83
    v_mul_f32 v84, v5, v68
    v_mul_f32 v85, v5, v69
    v_mul_f32 v86, v5, v70
    v_mul_f32 v87, v5, v71
    v_mul_f32 v88, v5, v72
    v_mul_f32 v89, v5, v73
    v_mul_f32 v90, v5, v74
    v_mul_f32 v91, v5, v75
    v_mul_f32 v92, v5, v76
    v_mul_f32 v93, v5, v77
    v_mul_f32 v94, v5, v78
    v_mul_f32 v95, v5, v79
    v_mul_f32 v96, v5, v80
    v_mul_f32 v97, v5, v81
    v_mul_f32 v98, v5, v82
    v_mul_f32 v99, v5, v83
    v_exp_f32 v84, v84
    v_exp_f32 v85, v85
    v_exp_f32 v86, v86
    v_exp_f32 v87, v87
    v_exp_f32 v88, v88
    v_exp_f32 v89, v89
    v_exp_f32 v90, v90
    v_exp_f32 v91, v91
    v_exp_f32 v92, v92
    v_exp_f32 v93, v93
    v_exp_f32 v94, v94
    v_exp_f32 v95, v95
    v_exp_f32 v96, v96
    v_exp_f32 v97, v97
    v_exp_f32 v98, v98
    v_exp_f32 v99, v99
    v_add_f32 v84, v6, v84
    v_add_f32 v85, v6, v85
    v_add_f32 v86, v6, v86
    v_add_f32 v87, v6, v87
    v_add_f32 v88, v6, v88
    v_add_f32 v89, v6, v89
    v_add_f32 v90, v6, v90
    v_add_f32 v91, v6, v91
    v_add_f32 v92, v6, v92
    v_add_f32 v93, v6, v93
    v_add_f32 v94, v6, v94
    v_add_f32 v95, v6, v95
    v_add_f32 v96, v6, v96
    v_add_f32 v97, v6, v97
    v_add_f32 v98, v6, v98
    v_add_f32 v99, v6, v99
    v_rcp_f32 v84, v84
    v_rcp_f32 v85, v85
    v_rcp_f32 v86, v86
    v_rcp_f32 v87, v87
    v_rcp_f32 v88, v88
    v_rcp_f32 v89, v89
    v_rcp_f32 v90, v90
    v_rcp_f32 v91, v91
    v_rcp_f32 v92, v92
    v_rcp_f32 v93, v93
    v_rcp_f32 v94, v94
    v_rcp_f32 v95, v95
    v_rcp_f32 v96, v96
    v_rcp_f32 v97, v97
    v_rcp_f32 v98, v98
    v_rcp_f32 v99, v99
    v_mul_f32 v84, v68, v84
    v_mul_f32 v85, v69, v85
    v_mul_f32 v86, v70, v86
    v_mul_f32 v87, v71, v87
    v_mul_f32 v88, v72, v88
    v_mul_f32 v89, v73, v89
    v_mul_f32 v90, v74, v90
    v_mul_f32 v91, v75, v91
    v_mul_f32 v92, v76, v92
    v_mul_f32 v93, v77, v93
    v_mul_f32 v94, v78, v94
    v_mul_f32 v95, v79, v95
    v_mul_f32 v96, v80, v96
    v_mul_f32 v97, v81, v97
    v_mul_f32 v98, v82, v98
    v_mul_f32 v99, v83, v99
    s_mov_b32 s63, 0x830100
    s_cmp_gt_u32 s26, 4
    s_cselect_b32 s63, s63, 0x40000000
    buffer_load_dwordx4 v[236:239], v3, s[36:39], s63 offen sc1
    v_cvt_pk_bf16_f32 v68, v84, v88
    v_cvt_pk_bf16_f32 v69, v92, v96
    buffer_store_dwordx2 v[68:69], v123, s[72:75], s27 offen offset:0 sc1
    v_cvt_pk_bf16_f32 v70, v85, v89
    v_cvt_pk_bf16_f32 v71, v93, v97
    buffer_store_dwordx2 v[70:71], v123, s[72:75], s27 offen offset:128 sc1
    v_cvt_pk_bf16_f32 v72, v86, v90
    v_cvt_pk_bf16_f32 v73, v94, v98
    buffer_store_dwordx2 v[72:73], v123, s[72:75], s27 offen offset:256 sc1
    v_cvt_pk_bf16_f32 v74, v87, v91
    v_cvt_pk_bf16_f32 v75, v95, v99
    buffer_store_dwordx2 v[74:75], v123, s[72:75], s27 offen offset:384 sc1
    s_cmp_gt_u32 s26, 4
    s_cbranch_scc1 M_e4x
    s_cmp_eq_u32 s26, 4
    s_cselect_b32 s63, 2, 4
    v_cmp_gt_u32 vcc, s63, v119
    s_nop 1
    v_cndmask_b32 v7, v118, v123, vcc
    s_add_u32 s27, s27, 16384
    v_mfma_f32_16x16x32_bf16 v[68:71], v[28:31], v[36:39], 0
    v_mfma_f32_16x16x32_bf16 v[72:75], v[28:31], v[44:47], 0
    v_mfma_f32_16x16x32_bf16 v[76:79], v[28:31], v[52:55], 0
    v_mfma_f32_16x16x32_bf16 v[80:83], v[28:31], v[60:63], 0
    v_mfma_f32_16x16x32_bf16 v[68:71], v[32:35], v[40:43], v[68:71]
    v_mfma_f32_16x16x32_bf16 v[72:75], v[32:35], v[48:51], v[72:75]
    v_mfma_f32_16x16x32_bf16 v[76:79], v[32:35], v[56:59], v[76:79]
    v_mfma_f32_16x16x32_bf16 v[80:83], v[32:35], v[64:67], v[80:83]
    s_nop 4
    v_cvt_pk_bf16_f32 v68, 0, v68
    v_cvt_pk_bf16_f32 v69, 0, v69
    v_cvt_pk_bf16_f32 v70, 0, v70
    v_cvt_pk_bf16_f32 v71, 0, v71
    v_cvt_pk_bf16_f32 v72, 0, v72
    v_cvt_pk_bf16_f32 v73, 0, v73
    v_cvt_pk_bf16_f32 v74, 0, v74
    v_cvt_pk_bf16_f32 v75, 0, v75
    v_cvt_pk_bf16_f32 v76, 0, v76
    v_cvt_pk_bf16_f32 v77, 0, v77
    v_cvt_pk_bf16_f32 v78, 0, v78
    v_cvt_pk_bf16_f32 v79, 0, v79
    v_cvt_pk_bf16_f32 v80, 0, v80
    v_cvt_pk_bf16_f32 v81, 0, v81
    v_cvt_pk_bf16_f32 v82, 0, v82
    v_cvt_pk_bf16_f32 v83, 0, v83
    v_mul_f32 v84, v5, v68
    v_mul_f32 v85, v5, v69
    v_mul_f32 v86, v5, v70
    v_mul_f32 v87, v5, v71
    v_mul_f32 v88, v5, v72
    v_mul_f32 v89, v5, v73
    v_mul_f32 v90, v5, v74
    v_mul_f32 v91, v5, v75
    v_mul_f32 v92, v5, v76
    v_mul_f32 v93, v5, v77
    v_mul_f32 v94, v5, v78
    v_mul_f32 v95, v5, v79
    v_mul_f32 v96, v5, v80
    v_mul_f32 v97, v5, v81
    v_mul_f32 v98, v5, v82
    v_mul_f32 v99, v5, v83
    v_exp_f32 v84, v84
    v_exp_f32 v85, v85
    v_exp_f32 v86, v86
    v_exp_f32 v87, v87
    v_exp_f32 v88, v88
    v_exp_f32 v89, v89
    v_exp_f32 v90, v90
    v_exp_f32 v91, v91
    v_exp_f32 v92, v92
    v_exp_f32 v93, v93
    v_exp_f32 v94, v94
    v_exp_f32 v95, v95
    v_exp_f32 v96, v96
    v_exp_f32 v97, v97
    v_exp_f32 v98, v98
    v_exp_f32 v99, v99
    v_add_f32 v84, v6, v84
    v_add_f32 v85, v6, v85
    v_add_f32 v86, v6, v86
    v_add_f32 v87, v6, v87
    v_add_f32 v88, v6, v88
    v_add_f32 v89, v6, v89
    v_add_f32 v90, v6, v90
    v_add_f32 v91, v6, v91
    v_add_f32 v92, v6, v92
    v_add_f32 v93, v6, v93
    v_add_f32 v94, v6, v94
    v_add_f32 v95, v6, v95
    v_add_f32 v96, v6, v96
    v_add_f32 v97, v6, v97
    v_add_f32 v98, v6, v98
    v_add_f32 v99, v6, v99
    v_rcp_f32 v84, v84
    v_rcp_f32 v85, v85
    v_rcp_f32 v86, v86
    v_rcp_f32 v87, v87
    v_rcp_f32 v88, v88
    v_rcp_f32 v89, v89
    v_rcp_f32 v90, v90
    v_rcp_f32 v91, v91
    v_rcp_f32 v92, v92
    v_rcp_f32 v93, v93
    v_rcp_f32 v94, v94
    v_rcp_f32 v95, v95
    v_rcp_f32 v96, v96
    v_rcp_f32 v97, v97
    v_rcp_f32 v98, v98
    v_rcp_f32 v99, v99
    v_mul_f32 v84, v68, v84
    v_mul_f32 v85, v69, v85
    v_mul_f32 v86, v70, v86
    v_mul_f32 v87, v71, v87
    v_mul_f32 v88, v72, v88
    v_mul_f32 v89, v73, v89
    v_mul_f32 v90, v74, v90
    v_mul_f32 v91, v75, v91
    v_mul_f32 v92, v76, v92
    v_mul_f32 v93, v77, v93
    v_mul_f32 v94, v78, v94
    v_mul_f32 v95, v79, v95
    v_mul_f32 v96, v80, v96
    v_mul_f32 v97, v81, v97
    v_mul_f32 v98, v82, v98
WUP_934:
    s_cbranch_execz WUP_1119
    v_mul_f32 v99, v83, v99
    v_cvt_pk_bf16_f32 v68, v84, v88
    v_cvt_pk_bf16_f32 v69, v92, v96
    buffer_store_dwordx2 v[68:69], v7, s[72:75], s27 offen offset:0 sc1
    v_cvt_pk_bf16_f32 v70, v85, v89
    v_cvt_pk_bf16_f32 v71, v93, v97
    buffer_store_dwordx2 v[70:71], v7, s[72:75], s27 offen offset:128 sc1
    v_cvt_pk_bf16_f32 v72, v86, v90
    v_cvt_pk_bf16_f32 v73, v94, v98
    buffer_store_dwordx2 v[72:73], v7, s[72:75], s27 offen offset:256 sc1
    v_cvt_pk_bf16_f32 v74, v87, v91
    v_cvt_pk_bf16_f32 v75, v95, v99
    buffer_store_dwordx2 v[74:75], v7, s[72:75], s27 offen offset:384 sc1
    s_nop 0
P_h2:
    s_mov_b32 s56, 0x05040100
    s_mov_b32 s57, 0x07060302
    s_waitcnt vmcnt(14)
M_e5:
    s_lshr_b32 s60, s26, 2
    s_and_b32 s61, s26, 3
    s_lshl_b32 s60, s60, 3
    s_add_u32 s60, s60, s61
    s_lshl_b32 s60, s60, 10
    s_movk_i32 s61, 4096
    v_perm_b32 v148, v129, v128, s56
    v_perm_b32 v152, v129, v128, s57
    v_perm_b32 v149, v131, v130, s56
    v_perm_b32 v153, v131, v130, s57
    v_perm_b32 v150, v133, v132, s56
    v_perm_b32 v154, v133, v132, s57
    v_perm_b32 v151, v135, v134, s56
    v_perm_b32 v155, v135, v134, s57
    v_add_u32 v156, s60, v3
    v_add_u32 v157, s61, v156
    ds_write_b128 v156, v[148:151]
    ds_write_b128 v157, v[152:155]
    s_cmp_eq_u32 s26, 7
    s_cbranch_scc1 M_w2
    s_add_u32 s27, s26, 8
    s_lshr_b32 s60, s27, 2
    s_and_b32 s61, s27, 3
    s_lshl_b32 s60, s60, 3
    s_add_u32 s60, s60, s61
    s_lshl_b32 s60, s60, 10
    s_movk_i32 s61, 4096
    s_cmp_lt_u32 s26, 4
    s_cbranch_scc1 M_w1
    s_sub_u32 s60, s26, 4
    s_lshl_b32 s60, s60, 11
    s_add_u32 s60, s60, 24576
    s_movk_i32 s61, 1024
M_w1:
    v_perm_b32 v148, v137, v136, s56
    v_perm_b32 v152, v137, v136, s57
    v_perm_b32 v149, v139, v138, s56
    v_perm_b32 v153, v139, v138, s57
    v_perm_b32 v150, v141, v140, s56
    v_perm_b32 v154, v141, v140, s57
    v_perm_b32 v151, v143, v142, s56
    v_perm_b32 v155, v143, v142, s57
    v_add_u32 v156, s60, v3
    v_add_u32 v157, s61, v156
    ds_write_b128 v156, v[148:151]
    ds_write_b128 v157, v[152:155]
M_w2:
    s_cmp_ge_u32 s26, 4
    s_cbranch_scc1 M_t4
    v_bfe_i32 v148, v0, 0, 1
    v_mov_b32 v149, 0x01000c0c
    s_mov_b32 s63, 0x02020000
    v_and_or_b32 v148, v148, s63, v149
    v_add_u32 v149, s63, v148
    v_add_u32 v150, s63, v149
    v_perm_b32 v152, v145, v144, v148
    v_perm_b32 v153, v145, v144, v149
    v_perm_b32 v154, v145, v144, v150
    s_mov_b32 s60, 0x41800000
    v_mul_f32 v148, s60, v152
    v_mul_f32 v149, s60, v153
    v_mul_f32 v150, s60, v154
    v_cvt_flr_i32_f32 v148, v148
    v_cvt_flr_i32_f32 v149, v149
    v_cvt_flr_i32_f32 v150, v150
    v_sub_u32 v148, 4, v148
    v_sub_u32 v149, 4, v149
    v_sub_u32 v150, 2, v150
    v_and_b32 v148, 0xff, v148
    v_and_b32 v149, 0xff, v149
    v_and_b32 v150, 0xff, v150
    v_lshl_or_b32 v148, v149, 8, v148
    v_lshl_or_b32 v148, v150, 16, v148
    v_mov_b32 v149, 0x7f000000
    v_cmp_gt_u32 vcc, 200, v0
    s_nop 1
    v_cndmask_b32 v148, v149, v148, vcc
    v_lshlrev_b32 v150, 2, v0
    v_add_u32 v150, 133120, v150
    ds_write_b32 v150, v148
    v_lshlrev_b32 v150, 4, v0
    v_add_u32 v150, 135168, v150
    s_mov_b64 exec, vcc
    ds_write_b96 v150, v[152:154]
    s_mov_b64 exec, -1
    s_branch M_t8
M_t4:
    s_cmp_eq_u32 s26, 4
    s_cbranch_scc0 M_t5
    v_lshlrev_b32 v150, 2, v1
    v_add_u32 v151, 132864, v150
    v_mov_b32 v148, 0
    ds_write_b32 v151, v148
    v_mov_b32 v151, 132672
    ds_write_b32 v151, v148
    v_add_u32 v151, 132608, v150
    v_lshlrev_b32 v148, 16, v146
    s_mov_b64 exec, 0xffff
    ds_write_b32 v151, v148
    s_mov_b64 exec, -1
    s_branch M_t8
M_t5:
M_t8:
    v_lshrrev_b32 v24, 2, v1
    v_lshlrev_b32 v24, 15, v24
    v_and_b32 v25, 3, v1
    v_lshl_add_u32 v24, v25, 4, v24
    s_lshl_b32 s27, s26, 20
    s_lshl_b32 s53, s2, 7
    s_add_u32 s27, s27, s53
    s_add_u32 s53, s27, 524288
    s_mov_b64 s[60:61], -1
    s_cmp_eq_u32 s26, 7
    s_cselect_b32 s61, 0xff, s61
    s_xor_b32 s63, s8, 0xff000000
    v_mov_b32 v164, s63
    v_mov_b32 v172, s63
    s_xor_b32 s63, s9, 0xff000000
    v_mov_b32 v165, s63
    v_mov_b32 v173, s63
    s_xor_b32 s63, s10, 0xff000000
    v_mov_b32 v166, s63
    v_mov_b32 v174, s63
    s_xor_b32 s63, s11, 0xff000000
    v_mov_b32 v167, s63
    v_mov_b32 v175, s63
    buffer_load_dwordx4 v[160:163], v24, s[36:39], s27 offen sc1
    s_mov_b64 exec, s[60:61]
    buffer_load_dwordx4 v[164:167], v24, s[36:39], s53 offen sc1
    s_mov_b64 exec, -1
    buffer_load_dwordx4 v[168:171], v24, s[36:39], s27 offen offset:64 sc1
    s_mov_b64 exec, s[60:61]
    buffer_load_dwordx4 v[172:175], v24, s[36:39], s53 offen offset:64 sc1
    s_mov_b64 exec, -1
    v_lshlrev_b32 v1, 4, v1
    v_lshrrev_b32 v8, 4, v1
    v_lshrrev_b32 v10, 5, v8
    v_and_b32 v11, 31, v8
    s_mov_b32 s6, 0x186a000
    s_mov_b32 s7, 0x00020000
    s_mul_i32 s44, s2, 102400
    s_mul_i32 s51, s26, 12800
    s_add_u32 s51, s51, 30720
    s_mul_i32 s52, s26, 3840
    s_add_u32 s52, s52, 133120
    s_mov_b32 s67, 120320
    s_mov_b32 s3, 132864
    v_lshrrev_b32 v8, 4, v1
    v_lshrrev_b32 v10, 5, v8
    v_and_b32 v11, 31, v8
    v_lshlrev_b32 v3, 4, v11
    v_add_u32 v3, s52, v3
    v_mul_u32_u24 v0, 56, v10
    v_add_u32 v0, s52, v0
    v_lshrrev_b32 v13, 3, v11
    v_lshl_add_u32 v4, v13, 3, v0
    v_lshrrev_b32 v13, 3, v8
    v_and_b32 v14, 1, v13
    v_lshrrev_b32 v13, 1, v13
    v_lshl_add_u32 v13, v14, 2, v13
    v_lshlrev_b32 v5, 4, v13
    v_add_u32 v5, s52, v5
    v_add_u32 v16, s52, v1
    v_lshrrev_b32 v17, 2, v8
    v_mul_u32_u24 v17, 56, v17
    v_and_b32 v13, 3, v8
    v_lshl_add_u32 v17, v13, 1, v17
    v_add_u32 v17, s52, v17
    v_lshlrev_b32 v2, 7, v10
    v_lshl_add_u32 v2, v11, 2, v2
    v_add_u32 v2, s51, v2
    v_and_b32 v13, 7, v11
    v_lshlrev_b32 v13, 1, v13
WUP_1119:
    s_cbranch_execz WUR_0
    v_sub_u32 v13, 14, v13
    v_lshl_or_b32 v6, v13, 16, v13
    v_lshlrev_b32 v7, 5, v10
    v_add_u32 v7, 132608, v7
    v_lshlrev_b32 v20, 2, v8
    v_add_u32 v30, 132864, v20
    v_mov_b32 v9, 132672
    v_mov_b32 v18, 0xfc
    v_mov_b32 v19, 1
    s_mov_b32 s12, 0x1fffe
    s_movk_i32 s13, 130
    s_mov_b32 s14, 0xfc0000
    s_movk_i32 s15, 7800
    s_lshl_b32 s17, s26, 10
    s_add_u32 s17, s17, 138368
    s_mov_b32 s16, s17
    v_add_u32 v26, 134144, v20
    v_add_u32 v27, 134144, v1
    s_mov_b32 s62, 0xfe0001
    s_mov_b32 s65, 0
    s_waitcnt vmcnt(4)
    v_mov_b32 v148, 131084
    s_mov_b64 exec, 1
    ds_add_rtn_u32 v149, v148, v19
    s_lshl_b32 s63, s2, 2
    s_add_u32 s63, s63, 0x830800
    v_mov_b32 v150, s18
    v_mov_b32 v151, 0
    s_waitcnt lgkmcnt(0)
    v_readfirstlane_b32 s19, v149
    s_cmp_eq_u32 s19, 7
    s_cselect_b32 s63, s63, 0x40000000
    buffer_store_dword v150, v151, s[36:39], s63 offen sc1
    s_mov_b64 exec, -1
    s_waitcnt vmcnt(1)
    s_branch M_cw2
M_cw:
    s_waitcnt vmcnt(0)
M_cw2:
    v_xor_b32 v176, s8, v160
    v_xor_b32 v177, s9, v161
    v_xor_b32 v178, s10, v162
    v_xor_b32 v179, s11, v163
    v_xor_b32 v180, s8, v164
    v_xor_b32 v181, s9, v165
    v_xor_b32 v182, s10, v166
    v_xor_b32 v183, s11, v167
    v_xor_b32 v184, s8, v168
    v_xor_b32 v185, s9, v169
    v_xor_b32 v186, s10, v170
    v_xor_b32 v187, s11, v171
    v_xor_b32 v188, s8, v172
    v_xor_b32 v189, s9, v173
    v_xor_b32 v190, s10, v174
    v_xor_b32 v191, s11, v175
    v_or3_b32 v148, v176, v177, v178
    v_or3_b32 v148, v148, v179, v180
    v_or3_b32 v148, v148, v181, v182
    v_or3_b32 v148, v148, v183, v184
    v_or3_b32 v148, v148, v185, v186
    v_or3_b32 v148, v148, v187, v188
    v_or3_b32 v148, v148, v189, v190
    v_or_b32 v148, v148, v191
    v_and_b32 v148, s62, v148
    v_cmp_ne_u32 vcc, 0, v148
    s_nop 4
    s_cbranch_vccz M_cok
    s_add_u32 s65, s65, 1
    s_cmp_lt_u32 s65, 16384
    s_cbranch_scc0 M_cok
    s_sleep 4
    buffer_load_dwordx4 v[160:163], v24, s[36:39], s27 offen sc1
    s_mov_b64 exec, s[60:61]
    buffer_load_dwordx4 v[164:167], v24, s[36:39], s53 offen sc1
    s_mov_b64 exec, -1
    buffer_load_dwordx4 v[168:171], v24, s[36:39], s27 offen offset:64 sc1
    s_mov_b64 exec, s[60:61]
    buffer_load_dwordx4 v[172:175], v24, s[36:39], s53 offen offset:64 sc1
    s_mov_b64 exec, -1
    s_branch M_cw
M_cok:
    s_waitcnt lgkmcnt(0)
    s_barrier
M_f1:
    v_add_u32 v159, 10, v8
    v_and_b32 v157, -2, v159
    v_add_lshl_u32 v159, v157, v159, 7
    v_cmp_gt_u32 vcc, 20, v8
    v_bfrev_b32 v157, 2
    s_nop 0
    v_cndmask_b32 v159, v157, v159, vcc
    s_mul_i32 s27, s26, 12800
    s_add_u32 s27, s27, s44
    buffer_load_dword v63, v159, s[28:31], s27 offen offset:256
    v_and_b32 v64, s12, v176
    v_alignbit_b32 v65, s13, v176, 22
    ds_read_u16 v64, v64 offset:30720
    ds_read_b32 v65, v65
    v_and_b32 v66, s12, v177
    v_alignbit_b32 v67, s13, v177, 22
    ds_read_u16 v66, v66 offset:30720
    ds_read_b32 v67, v67
    v_and_b32 v68, s12, v178
    v_alignbit_b32 v69, s13, v178, 22
    ds_read_u16 v68, v68 offset:30720
    ds_read_b32 v69, v69
    v_and_b32 v70, s12, v179
    v_alignbit_b32 v71, s13, v179, 22
    ds_read_u16 v70, v70 offset:30720
    ds_read_b32 v71, v71
    v_and_b32 v72, s12, v180
    v_alignbit_b32 v73, s13, v180, 22
    ds_read_u16 v72, v72 offset:30720
    ds_read_b32 v73, v73
    v_and_b32 v74, s12, v181
    v_alignbit_b32 v75, s13, v181, 22
    ds_read_u16 v74, v74 offset:30720
    ds_read_b32 v75, v75
    v_and_b32 v76, s12, v182
    v_alignbit_b32 v77, s13, v182, 22
    ds_read_u16 v76, v76 offset:30720
    ds_read_b32 v77, v77
    v_and_b32 v78, s12, v183
    v_alignbit_b32 v79, s13, v183, 22
    ds_read_u16 v78, v78 offset:30720
    ds_read_b32 v79, v79
    s_mov_b32 s63, 0xc8000000
    s_lshl_b32 s59, s26, 11
    s_add_u32 s59, s59, 146560
    s_mov_b32 s60, s59
    v_cmp_gt_u32 s[54:55], s63, v184
    s_nop 1
    v_mbcnt_lo_u32_b32 v148, s54, 0
    v_mbcnt_hi_u32_b32 v148, s55, v148
    v_lshl_add_u32 v148, v148, 4, s60
    s_bcnt1_i32_b64 s27, s[54:55]
    s_lshl4_add_u32 s60, s27, s60
    v_cndmask_b32 v148, v27, v148, s[54:55]
    ds_write_b128 v148, v[184:187]
    v_cmp_gt_u32 s[54:55], s63, v188
    s_nop 1
    v_mbcnt_lo_u32_b32 v148, s54, 0
    v_mbcnt_hi_u32_b32 v148, s55, v148
    v_lshl_add_u32 v148, v148, 4, s60
    s_bcnt1_i32_b64 s27, s[54:55]
    s_lshl4_add_u32 s60, s27, s60
    v_cndmask_b32 v148, v27, v148, s[54:55]
    ds_write_b128 v148, v[188:191]
    s_mov_b32 s63, 0xff000000
    v_cmp_lt_u32 s[68:69], s63, v187
    v_cmp_lt_u32 s[70:71], s63, v191
    s_waitcnt lgkmcnt(10)
    v_and_b32 v96, 0x0707, v64
    v_and_b32 v97, 0x0707, v66
    v_and_b32 v98, 0x0707, v68
WUP_1270:
    s_cbranch_execz WUP_1431
    v_and_b32 v99, 0x0707, v70
    v_and_b32 v64, 0xf8f8, v64
    v_and_b32 v66, 0xf8f8, v66
    v_and_b32 v68, 0xf8f8, v68
    v_and_b32 v70, 0xf8f8, v70
    v_mul_u32_u24 v96, 0x200400, v96
    v_mul_u32_u24 v97, 0x200400, v97
    v_mul_u32_u24 v98, 0x200400, v98
    v_mul_u32_u24 v99, 0x200400, v99
    v_and_or_b32 v64, v96, s14, v64
    v_and_or_b32 v66, v97, s14, v66
    v_and_or_b32 v68, v98, s14, v68
    v_and_or_b32 v70, v99, s14, v70
    v_add_u32 v64, v64, v65
    v_add_u32 v66, v66, v67
    v_add_u32 v68, v68, v69
    v_add_u32 v70, v70, v71
    v_dot4_i32_i8 v64, v64, v64, 0
    v_dot4_i32_i8 v66, v66, v66, 0
    v_dot4_i32_i8 v68, v68, v68, 0
    v_dot4_i32_i8 v70, v70, v70, 0
    v_cmp_gt_i32 s[40:41], s15, v64
    v_cmp_gt_i32 s[42:43], s15, v66
    v_cmp_gt_i32 s[46:47], s15, v68
    v_cmp_gt_i32 s[54:55], s15, v70
    v_mbcnt_lo_u32_b32 v96, s40, 0
    v_mbcnt_lo_u32_b32 v97, s42, 0
    v_mbcnt_lo_u32_b32 v98, s46, 0
    v_mbcnt_lo_u32_b32 v99, s54, 0
    v_mbcnt_hi_u32_b32 v96, s41, v96
    v_mbcnt_hi_u32_b32 v97, s43, v97
    v_mbcnt_hi_u32_b32 v98, s47, v98
    v_mbcnt_hi_u32_b32 v99, s55, v99
    v_lshl_add_u32 v96, v96, 2, s16
    s_bcnt1_i32_b64 s27, s[40:41]
    s_lshl2_add_u32 s16, s27, s16
    v_lshl_add_u32 v97, v97, 2, s16
    s_bcnt1_i32_b64 s27, s[42:43]
    s_lshl2_add_u32 s16, s27, s16
    v_lshl_add_u32 v98, v98, 2, s16
    s_bcnt1_i32_b64 s27, s[46:47]
    s_lshl2_add_u32 s16, s27, s16
    v_lshl_add_u32 v99, v99, 2, s16
    s_bcnt1_i32_b64 s27, s[54:55]
    s_lshl2_add_u32 s16, s27, s16
    v_cndmask_b32 v96, v26, v96, s[40:41]
    ds_write_b32 v96, v176
    v_cndmask_b32 v97, v26, v97, s[42:43]
    ds_write_b32 v97, v177
    v_cndmask_b32 v98, v26, v98, s[46:47]
    ds_write_b32 v98, v178
    v_cndmask_b32 v99, v26, v99, s[54:55]
    ds_write_b32 v99, v179
    s_waitcnt lgkmcnt(6)
    v_and_b32 v100, 0x0707, v72
    v_and_b32 v101, 0x0707, v74
    v_and_b32 v102, 0x0707, v76
    v_and_b32 v103, 0x0707, v78
    v_and_b32 v72, 0xf8f8, v72
    v_and_b32 v74, 0xf8f8, v74
    v_and_b32 v76, 0xf8f8, v76
    v_and_b32 v78, 0xf8f8, v78
    v_mul_u32_u24 v100, 0x200400, v100
    v_mul_u32_u24 v101, 0x200400, v101
    v_mul_u32_u24 v102, 0x200400, v102
    v_mul_u32_u24 v103, 0x200400, v103
    v_and_or_b32 v72, v100, s14, v72
    v_and_or_b32 v74, v101, s14, v74
    v_and_or_b32 v76, v102, s14, v76
    v_and_or_b32 v78, v103, s14, v78
    v_add_u32 v72, v72, v73
    v_add_u32 v74, v74, v75
    v_add_u32 v76, v76, v77
    v_add_u32 v78, v78, v79
    v_dot4_i32_i8 v72, v72, v72, 0
    v_dot4_i32_i8 v74, v74, v74, 0
    v_dot4_i32_i8 v76, v76, v76, 0
    v_dot4_i32_i8 v78, v78, v78, 0
    v_cmp_gt_i32 s[40:41], s15, v72
    v_cmp_gt_i32 s[42:43], s15, v74
    v_cmp_gt_i32 s[46:47], s15, v76
    v_cmp_gt_i32 s[54:55], s15, v78
    v_mbcnt_lo_u32_b32 v100, s40, 0
    v_mbcnt_lo_u32_b32 v101, s42, 0
    v_mbcnt_lo_u32_b32 v102, s46, 0
    v_mbcnt_lo_u32_b32 v103, s54, 0
    v_mbcnt_hi_u32_b32 v100, s41, v100
    v_mbcnt_hi_u32_b32 v101, s43, v101
    v_mbcnt_hi_u32_b32 v102, s47, v102
    v_mbcnt_hi_u32_b32 v103, s55, v103
    v_lshl_add_u32 v100, v100, 2, s16
    s_bcnt1_i32_b64 s27, s[40:41]
    s_lshl2_add_u32 s16, s27, s16
    v_lshl_add_u32 v101, v101, 2, s16
    s_bcnt1_i32_b64 s27, s[42:43]
    s_lshl2_add_u32 s16, s27, s16
    v_lshl_add_u32 v102, v102, 2, s16
    s_bcnt1_i32_b64 s27, s[46:47]
    s_lshl2_add_u32 s16, s27, s16
    v_lshl_add_u32 v103, v103, 2, s16
    s_bcnt1_i32_b64 s27, s[54:55]
    s_lshl2_add_u32 s16, s27, s16
    v_cndmask_b32 v100, v26, v100, s[40:41]
    ds_write_b32 v100, v180
    v_cndmask_b32 v101, v26, v101, s[42:43]
    ds_write_b32 v101, v181
    v_cndmask_b32 v102, v26, v102, s[46:47]
    ds_write_b32 v102, v182
    v_cndmask_b32 v103, v26, v103, s[54:55]
    ds_write_b32 v103, v183
    s_sub_u32 s60, s60, s59
    v_add_u32 v149, s59, v20
    v_mov_b32 v150, 0xff000000
    s_nop 1
M_pc:
    s_cmp_eq_u32 s60, 0
    s_cbranch_scc1 M_pcd
    s_waitcnt lgkmcnt(0)
    ds_read_b32 v148, v149
    v_cmp_gt_u32 vcc, s60, v20
    s_waitcnt lgkmcnt(0)
    s_nop 0
    v_cndmask_b32 v148, v150, v148, vcc
    v_and_b32 v64, s12, v148
    v_alignbit_b32 v65, s13, v148, 22
    ds_read_u16 v64, v64 offset:30720
    ds_read_b32 v65, v65
    s_waitcnt lgkmcnt(0)
    v_and_b32 v96, 0x0707, v64
    v_and_b32 v64, 0xf8f8, v64
    v_mul_u32_u24 v96, 0x200400, v96
    v_and_or_b32 v64, v96, s14, v64
    v_add_u32 v64, v64, v65
    v_dot4_i32_i8 v64, v64, v64, 0
    s_nop 2
    v_cmp_gt_i32 s[40:41], s15, v64
    s_nop 1
    v_mbcnt_lo_u32_b32 v96, s40, 0
    v_mbcnt_hi_u32_b32 v96, s41, v96
    v_lshl_add_u32 v96, v96, 2, s16
    s_bcnt1_i32_b64 s27, s[40:41]
    s_lshl2_add_u32 s16, s27, s16
    v_cndmask_b32 v96, v26, v96, s[40:41]
    ds_write_b32 v96, v148
    v_add_u32 v149, 256, v149
    s_min_u32 s27, s60, 256
    s_sub_u32 s60, s60, s27
    s_sub_u32 s27, s16, s17
    s_cmp_gt_u32 s27, 1024
    s_cbranch_scc0 M_pc
M_pcd:
    s_or_b64 s[54:55], s[68:69], s[70:71]
    s_cmp_eq_u64 s[54:55], 0
    s_cbranch_scc0 M_mdx
M_mdd:
    s_sub_u32 s19, s16, s17
    s_lshr_b32 s19, s19, 2
    s_cmp_le_u32 s19, 256
    s_cbranch_scc1 M_c1
    ds_write_b32 v9, v19
    s_movk_i32 s19, 256
M_c1:
    v_add_u32 v148, s17, v20
    s_waitcnt lgkmcnt(0)
    ds_read_b32 v64, v148 offset:0
WUP_1431:
    s_cbranch_execz WUR_0
    ds_read_b32 v68, v148 offset:256
    ds_read_b32 v72, v148 offset:512
    ds_read_b32 v76, v148 offset:768
    s_mov_b32 s27, s19
    v_cmp_gt_i32 s[8:9], s27, v8
    s_sub_u32 s27, s19, 64
    v_cmp_gt_i32 s[10:11], s27, v8
    s_sub_u32 s27, s19, 128
    v_cmp_gt_i32 s[14:15], s27, v8
    s_sub_u32 s27, s19, 192
    v_cmp_gt_i32 s[16:17], s27, v8
    s_mov_b32 s63, 0x02020000
    s_mov_b32 s64, 0x322bcc77
    s_mov_b32 s62, 0x409d0000
    v_mov_b32 v149, 0x01000c0c
    v_bfrev_b32 v14, 2
    s_waitcnt lgkmcnt(0)
    v_and_b32 v150, s12, v64
    v_alignbit_b32 v151, 33, v64, 20
    v_lshl_add_u32 v150, v150, 1, v150
    ds_read_b96 v[40:42], v151
    v_and_b32 v150, -4, v150
    v_cndmask_b32 v150, v14, v150, s[8:9]
    buffer_load_dwordx2 v[32:33], v150, s[92:95], 0 offen
    v_bfe_i32 v56, v64, 1, 1
    v_and_or_b32 v56, v56, s63, v149
    s_cmp_le_u32 s19, 64
    s_nop 0
    s_cbranch_scc1 M_s2a
    v_and_b32 v150, s12, v68
    v_alignbit_b32 v151, 33, v68, 20
    v_lshl_add_u32 v150, v150, 1, v150
    ds_read_b96 v[44:46], v151
    v_and_b32 v150, -4, v150
    v_cndmask_b32 v150, v14, v150, s[10:11]
    buffer_load_dwordx2 v[34:35], v150, s[92:95], 0 offen
    v_bfe_i32 v57, v68, 1, 1
    v_and_or_b32 v57, v57, s63, v149
    s_cmp_le_u32 s19, 128
    s_nop 0
    s_cbranch_scc1 M_s2a
    v_and_b32 v150, s12, v72
    v_alignbit_b32 v151, 33, v72, 20
    v_lshl_add_u32 v150, v150, 1, v150
    ds_read_b96 v[48:50], v151
    v_and_b32 v150, -4, v150
    v_cndmask_b32 v150, v14, v150, s[14:15]
    buffer_load_dwordx2 v[36:37], v150, s[92:95], 0 offen
    v_bfe_i32 v58, v72, 1, 1
    v_and_or_b32 v58, v58, s63, v149
    s_cmp_le_u32 s19, 192
    s_nop 0
    s_cbranch_scc1 M_s2a
    v_and_b32 v150, s12, v76
    v_alignbit_b32 v151, 33, v76, 20
    v_lshl_add_u32 v150, v150, 1, v150
    ds_read_b96 v[52:54], v151
    v_and_b32 v150, -4, v150
    v_cndmask_b32 v150, v14, v150, s[16:17]
    buffer_load_dwordx2 v[38:39], v150, s[92:95], 0 offen
    v_bfe_i32 v59, v76, 1, 1
    v_and_or_b32 v59, v59, s63, v149
    s_nop 1
M_s2a:
    s_waitcnt vmcnt(0) lgkmcnt(0)
    v_add_u32 v151, s63, v56
    v_perm_b32 v148, v33, v32, v56
    v_add_u32 v152, s63, v151
    v_perm_b32 v149, v33, v32, v151
    v_perm_b32 v150, v33, v32, v152
    v_sub_f32 v148, v148, v40
    v_sub_f32 v149, v149, v41
    v_sub_f32 v150, v150, v42
    v_cvt_pk_bf16_f32 v65, v148, v149
    v_cvt_pk_bf16_f32 v150, 0, v150
    v_lshlrev_b32 v148, 16, v65
    v_and_b32 v149, s58, v65
    v_mul_f32 v153, v150, v150
    v_mul_f32 v148, v148, v148
    v_mul_f32 v149, v149, v149
    v_cvt_pk_bf16_f32 v153, 0, v153
    v_cvt_pk_bf16_f32 v148, 0, v148
    v_cvt_pk_bf16_f32 v149, 0, v149
    v_add_f32 v148, v148, v149
    v_add_f32 v148, v148, v153
    v_cvt_pk_bf16_f32 v148, 0, v148
    v_add_f32 v148, s64, v148
    v_cvt_pk_bf16_f32 v148, 0, v148
    v_sqrt_f32 v148, v148
    s_nop 0
    v_cvt_pk_bf16_f32 v66, v150, v148
    v_cmp_gt_u32 vcc, s62, v66
    s_and_b64 s[8:9], s[8:9], vcc
    v_lshrrev_b32 v96, 24, v64
    v_lshrrev_b32 v120, 21, v64
    v_and_b32 v120, 16, v120
    v_lshlrev_b32 v112, v120, v19
    v_and_or_b32 v96, v96, v18, s3
    s_mov_b64 exec, s[8:9]
    s_nop 0
    s_cbranch_execz M_sa1
    ds_add_rtn_u32 v112, v96, v112
M_sa1:
    s_mov_b64 exec, -1
    s_cmp_le_u32 s19, 64
    s_cbranch_scc1 M_s2b
    v_add_u32 v151, s63, v57
    v_perm_b32 v148, v35, v34, v57
    v_add_u32 v152, s63, v151
    v_perm_b32 v149, v35, v34, v151
    v_perm_b32 v150, v35, v34, v152
    v_sub_f32 v148, v148, v44
    v_sub_f32 v149, v149, v45
    v_sub_f32 v150, v150, v46
    v_cvt_pk_bf16_f32 v69, v148, v149
    v_cvt_pk_bf16_f32 v150, 0, v150
    v_lshlrev_b32 v148, 16, v69
    v_and_b32 v149, s58, v69
    v_mul_f32 v153, v150, v150
    v_mul_f32 v148, v148, v148
    v_mul_f32 v149, v149, v149
    v_cvt_pk_bf16_f32 v153, 0, v153
    v_cvt_pk_bf16_f32 v148, 0, v148
    v_cvt_pk_bf16_f32 v149, 0, v149
    v_add_f32 v148, v148, v149
    v_add_f32 v148, v148, v153
    v_cvt_pk_bf16_f32 v148, 0, v148
    v_add_f32 v148, s64, v148
    v_cvt_pk_bf16_f32 v148, 0, v148
    v_sqrt_f32 v148, v148
    s_nop 0
    v_cvt_pk_bf16_f32 v70, v150, v148
    v_cmp_gt_u32 vcc, s62, v70
    s_and_b64 s[10:11], s[10:11], vcc
    v_lshrrev_b32 v97, 24, v68
    v_lshrrev_b32 v121, 21, v68
    v_and_b32 v121, 16, v121
    v_lshlrev_b32 v113, v121, v19
    v_and_or_b32 v97, v97, v18, s3
    s_mov_b64 exec, s[10:11]
    s_nop 0
    s_cbranch_execz M_sa2
    ds_add_rtn_u32 v113, v97, v113
M_sa2:
    s_mov_b64 exec, -1
    s_cmp_le_u32 s19, 128
    s_cbranch_scc1 M_s2b
    v_add_u32 v151, s63, v58
    v_perm_b32 v148, v37, v36, v58
    v_add_u32 v152, s63, v151
    v_perm_b32 v149, v37, v36, v151
    v_perm_b32 v150, v37, v36, v152
    v_sub_f32 v148, v148, v48
    v_sub_f32 v149, v149, v49
    v_sub_f32 v150, v150, v50
    v_cvt_pk_bf16_f32 v73, v148, v149
    v_cvt_pk_bf16_f32 v150, 0, v150
    v_lshlrev_b32 v148, 16, v73
    v_and_b32 v149, s58, v73
    v_mul_f32 v153, v150, v150
    v_mul_f32 v148, v148, v148
    v_mul_f32 v149, v149, v149
    v_cvt_pk_bf16_f32 v153, 0, v153
    v_cvt_pk_bf16_f32 v148, 0, v148
    v_cvt_pk_bf16_f32 v149, 0, v149
    v_add_f32 v148, v148, v149
    v_add_f32 v148, v148, v153
    v_cvt_pk_bf16_f32 v148, 0, v148
    v_add_f32 v148, s64, v148
    v_cvt_pk_bf16_f32 v148, 0, v148
    v_sqrt_f32 v148, v148
    s_nop 0
    v_cvt_pk_bf16_f32 v74, v150, v148
    v_cmp_gt_u32 vcc, s62, v74
    s_and_b64 s[14:15], s[14:15], vcc
    v_lshrrev_b32 v98, 24, v72
    v_lshrrev_b32 v122, 21, v72
    v_and_b32 v122, 16, v122
    v_lshlrev_b32 v114, v122, v19
WUP_1607:
    s_cbranch_execz WUP_1794
    v_and_or_b32 v98, v98, v18, s3
    s_mov_b64 exec, s[14:15]
    s_nop 0
    s_cbranch_execz M_sa3
    ds_add_rtn_u32 v114, v98, v114
M_sa3:
    s_mov_b64 exec, -1
    s_cmp_le_u32 s19, 192
    s_cbranch_scc1 M_s2b
    v_add_u32 v151, s63, v59
    v_perm_b32 v148, v39, v38, v59
    v_add_u32 v152, s63, v151
    v_perm_b32 v149, v39, v38, v151
    v_perm_b32 v150, v39, v38, v152
    v_sub_f32 v148, v148, v52
    v_sub_f32 v149, v149, v53
    v_sub_f32 v150, v150, v54
    v_cvt_pk_bf16_f32 v77, v148, v149
    v_cvt_pk_bf16_f32 v150, 0, v150
    v_lshlrev_b32 v148, 16, v77
    v_and_b32 v149, s58, v77
    v_mul_f32 v153, v150, v150
    v_mul_f32 v148, v148, v148
    v_mul_f32 v149, v149, v149
    v_cvt_pk_bf16_f32 v153, 0, v153
    v_cvt_pk_bf16_f32 v148, 0, v148
    v_cvt_pk_bf16_f32 v149, 0, v149
    v_add_f32 v148, v148, v149
    v_add_f32 v148, v148, v153
    v_cvt_pk_bf16_f32 v148, 0, v148
    v_add_f32 v148, s64, v148
    v_cvt_pk_bf16_f32 v148, 0, v148
    v_sqrt_f32 v148, v148
    s_nop 0
    v_cvt_pk_bf16_f32 v78, v150, v148
    v_cmp_gt_u32 vcc, s62, v78
    s_and_b64 s[16:17], s[16:17], vcc
    v_lshrrev_b32 v99, 24, v76
    v_lshrrev_b32 v123, 21, v76
    v_and_b32 v123, 16, v123
    v_lshlrev_b32 v115, v123, v19
    v_and_or_b32 v99, v99, v18, s3
    s_mov_b64 exec, s[16:17]
    s_nop 0
    s_cbranch_execz M_sa4
    ds_add_rtn_u32 v115, v99, v115
M_sa4:
    s_mov_b64 exec, -1
M_s2b:
    s_mov_b32 s61, 0x3e22f983
    s_movk_i32 s63, 0x70
    s_movk_i32 s64, 2176
    s_movk_i32 s65, 1280
    s_movk_i32 s66, 384
    v_lshrrev_b32 v21, 4, v8
    v_lshlrev_b32 v21, 9, v21
    v_and_b32 v22, 15, v8
    v_lshl_or_b32 v21, v22, 4, v21
    s_lshl_b32 s45, s26, 10
    s_add_u32 s45, s45, 30720
    s_lshl_b32 s46, s26, 11
    s_add_u32 s46, s46, s44
    s_waitcnt lgkmcnt(0)
    s_barrier
    s_cmp_eq_u32 s26, 6
    s_cbranch_scc0 M_h1
    s_mov_b32 s53, 0x830800
    buffer_load_dwordx4 v[148:151], v1, s[36:39], s53 offen sc1
M_h1:
    s_add_u32 m0, s45, 0
    s_add_u32 s53, s46, 0
    buffer_load_dwordx4 v21, s[28:31], s53 offen  lds
    s_add_u32 m0, s45, 8192
    s_add_u32 s53, s46, 16384
    buffer_load_dwordx4 v21, s[28:31], s53 offen  lds
    s_add_u32 m0, s45, 16384
    s_add_u32 s53, s46, 32768
    buffer_load_dwordx4 v21, s[28:31], s53 offen  lds
    s_add_u32 m0, s45, 24576
    s_add_u32 s53, s46, 49152
    buffer_load_dwordx4 v21, s[28:31], s53 offen  lds
    s_add_u32 m0, s45, 32768
    s_add_u32 s53, s46, 65536
    buffer_load_dwordx4 v21, s[28:31], s53 offen  lds
    s_add_u32 m0, s45, 40960
    s_add_u32 s53, s46, 81920
    buffer_load_dwordx4 v21, s[28:31], s53 offen  lds
    s_cmp_ge_u32 s26, 2
    s_cbranch_scc1 M_rs11
    s_add_u32 m0, s45, 49152
    s_add_u32 s53, s46, 98304
    buffer_load_dwordx4 v21, s[28:31], s53 offen  lds
M_rs11:
    s_sub_u32 s28, s28, 2048
    s_subb_u32 s29, s29, 0
    s_add_u32 s30, s30, 2048
    ds_read_b32 v28, v30
    ds_read_b32 v13, v9
    s_waitcnt lgkmcnt(1)
    v_and_b32 v31, 0xffff, v28
    v_lshrrev_b32 v28, 16, v28
    v_add_u32 v28, v28, v31
    v_mov_b32 v29, v28
    s_nop 1
    v_add_u32_dpp v29, v29, v29 row_shr:1 row_mask:0xf bank_mask:0xf bound_ctrl:0
    s_nop 1
    v_add_u32_dpp v29, v29, v29 row_shr:2 row_mask:0xf bank_mask:0xf bound_ctrl:0
    s_nop 1
    v_add_u32_dpp v29, v29, v29 row_shr:4 row_mask:0xf bank_mask:0xf bound_ctrl:0
    s_nop 1
    v_add_u32_dpp v29, v29, v29 row_shr:8 row_mask:0xf bank_mask:0xf bound_ctrl:0
    s_nop 1
    v_add_u32_dpp v29, v29, v29 row_bcast:15 row_mask:0xa bank_mask:0xf
    s_nop 1
    v_add_u32_dpp v29, v29, v29 row_bcast:31 row_mask:0xc bank_mask:0xf
    v_sub_u32 v28, v29, v28
    v_add_u32 v31, v28, v31
    v_lshl_or_b32 v28, v31, 16, v28
    ds_bpermute_b32 v104, v96, v28
    ds_bpermute_b32 v105, v97, v28
    ds_bpermute_b32 v106, v98, v28
    ds_bpermute_b32 v107, v99, v28
    v_readlane_b32 s62, v29, 63
    s_mov_b32 s54, 0
    s_mov_b32 s55, 0
    s_xor_b32 s12, s26, 4
    s_cmp_gt_u32 s62, 480
    s_cselect_b32 s27, 96, 64
    v_cmp_ge_u32 vcc, s27, v29
    v_cmp_ge_u32 s[70:71], s27, v31
    s_bcnt1_i32_b64 s56, vcc
    s_bcnt1_i32_b64 s57, s[70:71]
    s_add_u32 s56, s56, s57
    s_min_u32 s56, s56, 16
    s_lshr_b32 s27, s56, 1
    s_and_b32 s69, s56, 1
    v_readlane_b32 s57, v28, s27
    s_lshl4_add_u32 s69, s69, 0x100000
    s_bfe_u32 s57, s57, s69
    s_waitcnt lgkmcnt(0)
    v_readfirstlane_b32 s46, v13
    v_add_u32 v104, v104, v112
    v_bfe_u32 v104, v104, v120, 16
    v_cmp_gt_u32 vcc, 768, v104
    v_lshl_add_u32 v104, v104, 4, s67
    s_and_b64 exec, vcc, s[8:9]
    s_nop 2
    s_cbranch_execz M_sb12
    ds_write_b96 v104, v[64:66]
M_sb12:
    s_mov_b64 exec, -1
    s_cmp_le_u32 s19, 64
    s_cbranch_scc1 M_s2c
    v_add_u32 v105, v105, v113
    v_bfe_u32 v105, v105, v121, 16
    v_cmp_gt_u32 vcc, 768, v105
    v_lshl_add_u32 v105, v105, 4, s67
    s_and_b64 exec, vcc, s[10:11]
    s_nop 2
    s_cbranch_execz M_sb13
    ds_write_b96 v105, v[68:70]
M_sb13:
    s_mov_b64 exec, -1
    s_cmp_le_u32 s19, 128
    s_cbranch_scc1 M_s2c
    v_add_u32 v106, v106, v114
    v_bfe_u32 v106, v106, v122, 16
    v_cmp_gt_u32 vcc, 768, v106
    v_lshl_add_u32 v106, v106, 4, s67
    s_and_b64 exec, vcc, s[14:15]
    s_nop 2
    s_cbranch_execz M_sb14
    ds_write_b96 v106, v[72:74]
M_sb14:
    s_mov_b64 exec, -1
    s_cmp_le_u32 s19, 192
    s_cbranch_scc1 M_s2c
    v_add_u32 v107, v107, v115
    v_bfe_u32 v107, v107, v123, 16
    v_cmp_gt_u32 vcc, 768, v107
    v_lshl_add_u32 v107, v107, 4, s67
    s_and_b64 exec, vcc, s[16:17]
    s_nop 2
    s_cbranch_execz M_sb15
    ds_write_b96 v107, v[76:78]
M_sb15:
    s_mov_b64 exec, -1
M_s2c:
    s_cmp_eq_u32 s26, 6
    s_cbranch_scc0 M_h3
    s_mov_b32 s27, 0
    v_cmp_gt_u32 s[8:9], 63, v8
    v_cmp_eq_u32 s[10:11], 62, v8
    s_waitcnt vmcnt(6)
    s_nop 3
M_h2:
    v_cndmask_b32 v150, v150, v148, s[10:11]
    v_cndmask_b32 v151, v151, v148, s[10:11]
WUP_1794:
    s_cbranch_execz WUR_0
    v_xor_b32 v148, s18, v148
    v_xor_b32 v149, s18, v149
    v_xor_b32 v150, s18, v150
    v_xor_b32 v151, s18, v151
    v_or3_b32 v148, v148, v149, v150
    v_or_b32 v148, v148, v151
    v_cmp_ne_u32 vcc, 0, v148
    s_and_b64 vcc, vcc, s[8:9]
    s_cbranch_vccz M_h3
    s_add_u32 s27, s27, 1
    s_cmp_lt_u32 s27, 16384
    s_cbranch_scc0 M_h3
    s_sleep 2
    s_mov_b32 s53, 0x830800
    buffer_load_dwordx4 v[148:151], v1, s[36:39], s53 offen sc1
    s_waitcnt vmcnt(0)
    s_branch M_h2
M_h3:
    s_cmp_eq_u32 s2, 0
    s_cbranch_scc0 M_h4
    s_cmp_eq_u32 s26, 5
    s_cbranch_scc0 M_h4
    s_mov_b32 s27, 0x830000
    v_mov_b32 v148, s18
    v_mov_b32 v149, 0
    s_mov_b64 exec, 1
    buffer_store_dword v148, v149, s[36:39], s27 offen sc1
    s_mov_b64 exec, -1
M_h4:
    s_waitcnt lgkmcnt(0)
    s_barrier
    s_cmp_eq_u32 s12, 0
    s_cbranch_scc1 M_cut
    s_sub_u32 s27, s57, s55
    s_cmp_gt_u32 s27, 64
    s_cselect_b32 s40, 64, 96
    s_mov_b32 s54, s56
    s_mov_b32 s55, s57
    s_sub_u32 s27, s62, s55
    s_cmp_gt_u32 s27, 420
    s_cselect_b32 s27, 96, 64
    s_add_u32 s27, s27, s55
    v_cmp_ge_u32 vcc, s27, v29
    v_cmp_ge_u32 s[70:71], s27, v31
    s_bcnt1_i32_b64 s56, vcc
    s_bcnt1_i32_b64 s57, s[70:71]
    s_add_u32 s27, s54, 16
    s_add_u32 s56, s56, s57
    s_min_u32 s56, s56, s27
    s_min_u32 s56, s56, 100
    s_max_u32 s56, s56, 4
    s_lshr_b32 s27, s56, 1
    s_and_b32 s69, s56, 1
    v_readlane_b32 s57, v28, s27
    s_lshl4_add_u32 s69, s69, 0x100000
    s_bfe_u32 s57, s57, s69
    s_cmp_eq_u32 s12, 1
    s_cbranch_scc1 M_cut
    s_sub_u32 s27, s57, s55
    s_cmp_gt_u32 s27, 64
    s_cselect_b32 s41, 64, 96
    s_mov_b32 s54, s56
    s_mov_b32 s55, s57
    s_sub_u32 s27, s62, s55
    s_cmp_gt_u32 s27, 360
    s_cselect_b32 s27, 96, 64
    s_add_u32 s27, s27, s55
    v_cmp_ge_u32 vcc, s27, v29
    v_cmp_ge_u32 s[70:71], s27, v31
    s_bcnt1_i32_b64 s56, vcc
    s_bcnt1_i32_b64 s57, s[70:71]
    s_add_u32 s27, s54, 16
    s_add_u32 s56, s56, s57
    s_min_u32 s56, s56, s27
    s_min_u32 s56, s56, 100
    s_max_u32 s56, s56, 20
    s_lshr_b32 s27, s56, 1
    s_and_b32 s69, s56, 1
    v_readlane_b32 s57, v28, s27
    s_lshl4_add_u32 s69, s69, 0x100000
    s_bfe_u32 s57, s57, s69
    s_cmp_eq_u32 s12, 2
    s_cbranch_scc1 M_cut
    s_sub_u32 s27, s57, s55
    s_cmp_gt_u32 s27, 64
    s_cselect_b32 s42, 64, 96
    s_mov_b32 s54, s56
    s_mov_b32 s55, s57
    s_sub_u32 s27, s62, s55
    s_cmp_gt_u32 s27, 300
    s_cselect_b32 s27, 96, 64
    s_add_u32 s27, s27, s55
    v_cmp_ge_u32 vcc, s27, v29
    v_cmp_ge_u32 s[70:71], s27, v31
    s_bcnt1_i32_b64 s56, vcc
    s_bcnt1_i32_b64 s57, s[70:71]
    s_add_u32 s27, s54, 16
    s_add_u32 s56, s56, s57
    s_min_u32 s56, s56, s27
    s_min_u32 s56, s56, 100
    s_max_u32 s56, s56, 36
    s_lshr_b32 s27, s56, 1
    s_and_b32 s69, s56, 1
    v_readlane_b32 s57, v28, s27
    s_lshl4_add_u32 s69, s69, 0x100000
    s_bfe_u32 s57, s57, s69
    s_cmp_eq_u32 s12, 3
    s_cbranch_scc1 M_cut
    s_mov_b32 s54, s56
    s_mov_b32 s55, s57
    s_sub_u32 s27, s62, s55
    s_cmp_gt_u32 s27, 248
    s_cselect_b32 s27, s40, 64
    s_add_u32 s27, s27, s55
    v_cmp_ge_u32 vcc, s27, v29
    v_cmp_ge_u32 s[70:71], s27, v31
    s_bcnt1_i32_b64 s56, vcc
    s_bcnt1_i32_b64 s57, s[70:71]
    s_add_u32 s27, s54, 16
    s_add_u32 s56, s56, s57
    s_min_u32 s56, s56, s27
    s_min_u32 s56, s56, 100
    s_max_u32 s56, s56, 52
    s_lshr_b32 s27, s56, 1
    s_and_b32 s69, s56, 1
    v_readlane_b32 s57, v28, s27
    s_lshl4_add_u32 s69, s69, 0x100000
    s_bfe_u32 s57, s57, s69
    s_cmp_eq_u32 s12, 4
    s_cbranch_scc1 M_cut
    s_mov_b32 s54, s56
    s_mov_b32 s55, s57
    s_sub_u32 s27, s62, s55
    s_cmp_gt_u32 s27, 186
    s_cselect_b32 s27, s41, 64
    s_add_u32 s27, s27, s55
    v_cmp_ge_u32 vcc, s27, v29
    v_cmp_ge_u32 s[70:71], s27, v31
    s_bcnt1_i32_b64 s56, vcc
    s_bcnt1_i32_b64 s57, s[70:71]
    s_add_u32 s27, s54, 16
    s_add_u32 s56, s56, s57
    s_min_u32 s56, s56, s27
    s_min_u32 s56, s56, 100
    s_max_u32 s56, s56, 68
    s_lshr_b32 s27, s56, 1
    s_and_b32 s69, s56, 1
    v_readlane_b32 s57, v28, s27
    s_lshl4_add_u32 s69, s69, 0x100000
    s_bfe_u32 s57, s57, s69
    s_cmp_eq_u32 s12, 5
    s_cbranch_scc1 M_cut
    s_mov_b32 s54, s56
    s_mov_b32 s55, s57
    s_sub_u32 s27, s62, s55
    s_cmp_gt_u32 s27, 124
    s_cselect_b32 s27, s42, 64
    s_add_u32 s27, s27, s55
    v_cmp_ge_u32 vcc, s27, v29
    v_cmp_ge_u32 s[70:71], s27, v31
    s_bcnt1_i32_b64 s56, vcc
    s_bcnt1_i32_b64 s57, s[70:71]
    s_add_u32 s27, s54, 16
    s_add_u32 s56, s56, s57
    s_min_u32 s56, s56, s27
    s_min_u32 s56, s56, 100
    s_max_u32 s56, s56, 84
    s_lshr_b32 s27, s56, 1
    s_and_b32 s69, s56, 1
    v_readlane_b32 s57, v28, s27
    s_lshl4_add_u32 s69, s69, 0x100000
    s_bfe_u32 s57, s57, s69
    s_cmp_eq_u32 s12, 6
    s_cbranch_scc1 M_cut
    s_mov_b32 s54, s56
    s_mov_b32 s55, s57
    s_movk_i32 s56, 100
    s_mov_b32 s57, s62
M_cut:
    s_lshl_b32 s27, s55, 4
    s_add_u32 s27, s27, s67
    v_add_u32 v14, s27, v1
    v_lshlrev_b32 v15, 4, v11
WUP_1974:
    s_cbranch_execz WUP_2150
    v_add_u32 v15, s27, v15
    ds_read_b32 v15, v15
    ds_read_b96 v[88:90], v14
    ds_read_b96 v[92:94], v14 offset:1024
    s_lshl_b32 s59, s54, 1
    s_sub_u32 s45, s56, s54
    s_lshl_b32 s45, s45, 1
    s_lshl_b32 s40, s54, 10
    s_add_u32 s40, s40, s44
    s_add_u32 s41, s40, 4096
    s_add_u32 s42, s40, 8192
    s_add_u32 s43, s40, 12288
    s_lshl_b32 s6, s56, 10
    s_add_u32 s6, s6, s44
    s_mov_b32 s34, s6
    s_sub_u32 s47, s57, s55
    v_add_u32 v86, 64, v8
    s_mov_b32 s50, 1
    s_cmp_gt_u32 s47, 128
    s_cselect_b32 s27, 1, s46
    s_cmp_gt_u32 s57, 768
    s_cselect_b32 s27, 1, s27
    s_cmp_eq_u32 s27, 0
    s_cselect_b32 s47, s47, 0
    s_cselect_b32 s76, 1, 0
    s_mov_b32 s14, 0
    s_mov_b32 s15, 0
    s_mov_b32 s16, 0
    s_mov_b32 s17, 0
    v_cmp_gt_u32 s[8:9], s47, v8
    v_cmp_gt_u32 s[10:11], s47, v86
    s_add_u32 s48, s47, 31
    s_lshr_b32 s48, s48, 5
    v_bfrev_b32 v14, 2
    v_cmp_gt_u32 vcc, s47, v11
    s_mov_b32 s27, 0x1fffe
    s_waitcnt lgkmcnt(2)
    v_and_b32 v15, s27, v15
    v_lshlrev_b32 v15, 6, v15
    v_lshl_add_u32 v15, v10, 6, v15
    v_cndmask_b32 v15, v14, v15, vcc
    buffer_load_dwordx4 v[32:35], v15, s[72:75], 0 offen offset:0
    buffer_load_dwordx4 v[36:39], v15, s[72:75], 0 offen offset:16
    buffer_load_dwordx4 v[40:43], v15, s[72:75], 0 offen offset:32
    buffer_load_dwordx4 v[44:47], v15, s[72:75], 0 offen offset:48
    v_bfe_u32 v13, v1, 9, 1
    v_bfe_u32 v14, v1, 4, 5
    v_lshlrev_b32 v13, 11, v13
    v_lshl_add_u32 v13, v14, 2, v13
    buffer_load_dword v208, v13, s[4:7], s40 offen offset:256
    buffer_load_dword v209, v13, s[4:7], s40 offen offset:768
    buffer_load_dword v210, v13, s[4:7], s40 offen offset:1280
    buffer_load_dword v211, v13, s[4:7], s40 offen offset:1792
    buffer_load_dword v212, v13, s[4:7], s41 offen offset:256
    buffer_load_dword v213, v13, s[4:7], s41 offen offset:768
    buffer_load_dword v214, v13, s[4:7], s41 offen offset:1280
    buffer_load_dword v215, v13, s[4:7], s41 offen offset:1792
    buffer_load_dword v216, v13, s[4:7], s42 offen offset:256
    buffer_load_dword v217, v13, s[4:7], s42 offen offset:768
    buffer_load_dword v218, v13, s[4:7], s42 offen offset:1280
    buffer_load_dword v219, v13, s[4:7], s42 offen offset:1792
    buffer_load_dword v220, v13, s[4:7], s43 offen offset:256
    buffer_load_dword v221, v13, s[4:7], s43 offen offset:768
    buffer_load_dword v222, v13, s[4:7], s43 offen offset:1280
    buffer_load_dword v223, v13, s[4:7], s43 offen offset:1792
    buffer_load_dword v240, v13, s[4:7], s40 offen offset:384
    buffer_load_dword v241, v13, s[4:7], s40 offen offset:896
    buffer_load_dword v242, v13, s[4:7], s40 offen offset:1408
    buffer_load_dword v243, v13, s[4:7], s40 offen offset:1920
    buffer_load_dword v244, v13, s[4:7], s41 offen offset:384
    buffer_load_dword v245, v13, s[4:7], s41 offen offset:896
    buffer_load_dword v246, v13, s[4:7], s41 offen offset:1408
    buffer_load_dword v247, v13, s[4:7], s41 offen offset:1920
    buffer_load_dword v248, v13, s[4:7], s42 offen offset:384
    buffer_load_dword v249, v13, s[4:7], s42 offen offset:896
    buffer_load_dword v250, v13, s[4:7], s42 offen offset:1408
    buffer_load_dword v251, v13, s[4:7], s42 offen offset:1920
    buffer_load_dword v252, v13, s[4:7], s43 offen offset:384
    buffer_load_dword v253, v13, s[4:7], s43 offen offset:896
    buffer_load_dword v254, v13, s[4:7], s43 offen offset:1408
    buffer_load_dword v255, v13, s[4:7], s43 offen offset:1920
    s_waitcnt lgkmcnt(0)
M_win:
    v_lshrrev_b32 v8, 4, v1
    s_mov_b32 s53, 0x40490fdb
    s_mov_b32 s70, 0
    s_mov_b32 s54, 0x3e4ccccd
    s_mov_b32 s55, 0x1fffe
    v_mov_b32 v87, 1
    v_bfrev_b32 v14, 2
    v_and_b32 v96, s58, v90
    v_cndmask_b32 v96, 1.0, v96, s[8:9]
    v_rcp_f32 v98, v96
    v_mul_f32 v97, s53, v96
    v_cvt_pk_bf16_f32 v97, 0, v97
    v_mul_f32 v97, s54, v97
    v_cvt_pk_bf16_f32 v97, 0, v97
    v_mul_f32 v97, s61, v97
    v_cos_f32 v97, v97
    v_lshlrev_b32 v100, 16, v89
    v_and_b32 v101, s58, v89
    v_lshlrev_b32 v102, 16, v90
    v_cvt_pk_bf16_f32 v97, 0, v97
    v_add_f32 v97, 1.0, v97
    v_cvt_pk_bf16_f32 v97, 0, v97
    v_cndmask_b32 v97, 0, v97, s[8:9]
    v_mul_f32 v97, v97, v98
    v_add_f32 v103, v98, v98
    v_mul_f32 v97, 0x3e800000, v97
    v_mul_f32 v100, v100, v103
    v_mul_f32 v101, v101, v103
    v_mul_f32 v102, v102, v103
    v_and_b32 v99, s55, v88
    v_lshlrev_b32 v99, 8, v99
    v_cndmask_b32 v99, v14, v99, s[8:9]
    v_cvt_pk_bf16_f32 v100, v100, v101
    v_cvt_pk_bf16_f32 v102, 0, v102
    v_cndmask_b32 v104, 0, v87, s[8:9]
    v_mov_b32 v105, 0
    v_lshrrev_b32 v108, 24, v88
    v_subrev_u32 v108, s59, v108
    v_lshlrev_b32 v108, 1, v108
    v_lshlrev_b64 v[106:107], v108, v[104:105]
    ds_write_b128 v16, v[96:99] offset:0
    ds_write_b16 v17, v106 offset:2048
    ds_write_b16_d16_hi v17, v106 offset:2056
    ds_write_b16 v17, v107 offset:2064
    ds_write_b16_d16_hi v17, v107 offset:2072
    ds_write_b16 v17, v100 offset:2080
    ds_write_b16_d16_hi v17, v100 offset:2088
    ds_write_b16_d16_hi v17, v102 offset:2096
    s_cmp_eq_u64 s[10:11], 0
    s_cbranch_scc1 M_g1
    v_and_b32 v112, s58, v94
    v_cndmask_b32 v112, 1.0, v112, s[10:11]
    v_rcp_f32 v114, v112
    v_mul_f32 v113, s53, v112
    v_cvt_pk_bf16_f32 v113, 0, v113
    v_mul_f32 v113, s54, v113
    v_cvt_pk_bf16_f32 v113, 0, v113
    v_mul_f32 v113, s61, v113
    v_cos_f32 v113, v113
    v_lshlrev_b32 v116, 16, v93
    v_and_b32 v117, s58, v93
    v_lshlrev_b32 v118, 16, v94
    v_cvt_pk_bf16_f32 v113, 0, v113
    v_add_f32 v113, 1.0, v113
    v_cvt_pk_bf16_f32 v113, 0, v113
    v_cndmask_b32 v113, 0, v113, s[10:11]
    v_mul_f32 v113, v113, v114
    v_add_f32 v119, v114, v114
    v_mul_f32 v113, 0x3e800000, v113
    v_mul_f32 v116, v116, v119
    v_mul_f32 v117, v117, v119
    v_mul_f32 v118, v118, v119
    v_and_b32 v115, s55, v92
    v_lshlrev_b32 v115, 8, v115
    v_cndmask_b32 v115, v14, v115, s[10:11]
    v_cvt_pk_bf16_f32 v116, v116, v117
    v_cvt_pk_bf16_f32 v118, 0, v118
    v_cndmask_b32 v120, 0, v87, s[10:11]
    v_mov_b32 v121, 0
    v_lshrrev_b32 v124, 24, v92
    v_subrev_u32 v124, s59, v124
    v_lshlrev_b32 v124, 1, v124
    v_lshlrev_b64 v[122:123], v124, v[120:121]
    ds_write_b128 v16, v[112:115] offset:1024
    ds_write_b16 v17, v122 offset:2944
    ds_write_b16_d16_hi v17, v122 offset:2952
    ds_write_b16 v17, v123 offset:2960
    ds_write_b16_d16_hi v17, v123 offset:2968
    ds_write_b16 v17, v116 offset:2976
    ds_write_b16_d16_hi v17, v116 offset:2984
    ds_write_b16_d16_hi v17, v118 offset:2992
M_g1:
    s_waitcnt lgkmcnt(0)
    s_cmp_lg_u32 s50, 0
    s_cbranch_scc1 M_first
WUP_2150:
    s_cbranch_execz WUR_0
    s_cmp_eq_u32 s48, 0
    s_cselect_b32 s77, 0x40000000, 0
    ds_read_b32 v47, v3 offset:12
    v_bfe_u32 v46, v1, 9, 1
    s_waitcnt lgkmcnt(0)
    v_lshrrev_b32 v47, 2, v47
    v_lshl_add_u32 v47, v46, 6, v47
    buffer_load_dwordx4 v[32:35], v47, s[72:75], s77 offen offset:0
    buffer_load_dwordx4 v[36:39], v47, s[72:75], s77 offen offset:16
    buffer_load_dwordx4 v[40:43], v47, s[72:75], s77 offen offset:32
    buffer_load_dwordx4 v[44:47], v47, s[72:75], s77 offen offset:48
    s_branch M_noacc
M_first:
    s_mov_b32 s50, 2
    s_sub_u32 s27, s26, 4
    s_cmp_ge_u32 s27, 3
    s_cbranch_scc1 M_late
    s_cmp_eq_u32 s48, 0
    s_cbranch_scc1 M_late
    ds_read_b32 v64, v5 offset:12
    ds_read_b32 v65, v5 offset:140
    ds_read_b32 v66, v5 offset:268
    ds_read_b32 v67, v5 offset:396
    s_add_u32 m0, s51, 0
    s_waitcnt lgkmcnt(3)
    v_and_or_b32 v64, v1, s63, v64
    buffer_load_dwordx4 v64, s[28:31], s64 offen offset:0 lds
    buffer_load_dwordx4 v64, s[28:31], s65 offen offset:1024 lds
    buffer_load_dwordx4 v64, s[28:31], s66 offen offset:2048 lds
    s_add_u32 m0, s51, 3072
    s_waitcnt lgkmcnt(2)
    v_and_or_b32 v65, v1, s63, v65
    buffer_load_dwordx4 v65, s[28:31], s64 offen offset:0 lds
    buffer_load_dwordx4 v65, s[28:31], s65 offen offset:1024 lds
    buffer_load_dwordx4 v65, s[28:31], s66 offen offset:2048 lds
    s_add_u32 m0, s51, 6144
    s_waitcnt lgkmcnt(1)
    v_and_or_b32 v66, v1, s63, v66
    buffer_load_dwordx4 v66, s[28:31], s64 offen offset:0 lds
    buffer_load_dwordx4 v66, s[28:31], s65 offen offset:1024 lds
    buffer_load_dwordx4 v66, s[28:31], s66 offen offset:2048 lds
    s_add_u32 m0, s51, 9216
    s_waitcnt lgkmcnt(0)
    v_and_or_b32 v67, v1, s63, v67
    buffer_load_dwordx4 v67, s[28:31], s64 offen offset:0 lds
    buffer_load_dwordx4 v67, s[28:31], s65 offen offset:1024 lds
    buffer_load_dwordx4 v67, s[28:31], s66 offen offset:2048 lds
    s_mov_b32 s50, 3
    s_waitcnt vmcnt(48)
    s_branch M_late2
M_late:
    s_waitcnt vmcnt(36)
M_late2:
    s_mov_b32 s99, 1
    s_cmp_eq_u32 s48, 0
    s_cbranch_scc1 M_rd0
M_rd1:
    s_lshl_b32 s27, s59, 8
    s_add_u32 s27, s27, 30720
    v_lshlrev_b32 v12, 10, v10
    v_lshl_add_u32 v12, v11, 2, v12
    v_add_u32 v12, s27, v12
    s_barrier
    ds_read_u16_d16_hi v128, v12 offset:0
    ds_read_u16_d16_hi v144, v12 offset:2
    ds_read_u16_d16_hi v129, v12 offset:256
    ds_read_u16_d16_hi v145, v12 offset:258
    ds_read_u16_d16_hi v130, v12 offset:512
    ds_read_u16_d16_hi v146, v12 offset:514
    ds_read_u16_d16_hi v131, v12 offset:768
    ds_read_u16_d16_hi v147, v12 offset:770
    ds_read_u16_d16_hi v132, v12 offset:2048
    ds_read_u16_d16_hi v148, v12 offset:2050
    ds_read_u16_d16_hi v133, v12 offset:2304
    ds_read_u16_d16_hi v149, v12 offset:2306
    ds_read_u16_d16_hi v134, v12 offset:2560
    ds_read_u16_d16_hi v150, v12 offset:2562
    ds_read_u16_d16_hi v135, v12 offset:2816
    ds_read_u16_d16_hi v151, v12 offset:2818
    ds_read_u16_d16_hi v136, v12 offset:4096
    ds_read_u16_d16_hi v152, v12 offset:4098
    ds_read_u16_d16_hi v137, v12 offset:4352
    ds_read_u16_d16_hi v153, v12 offset:4354
    ds_read_u16_d16_hi v138, v12 offset:4608
    ds_read_u16_d16_hi v154, v12 offset:4610
    ds_read_u16_d16_hi v139, v12 offset:4864
    ds_read_u16_d16_hi v155, v12 offset:4866
    ds_read_u16_d16_hi v140, v12 offset:6144
    ds_read_u16_d16_hi v156, v12 offset:6146
    ds_read_u16_d16_hi v141, v12 offset:6400
    ds_read_u16_d16_hi v157, v12 offset:6402
    ds_read_u16_d16_hi v142, v12 offset:6656
    ds_read_u16_d16_hi v158, v12 offset:6658
    ds_read_u16_d16_hi v143, v12 offset:6912
    ds_read_u16_d16_hi v159, v12 offset:6914
    ds_read_u16_d16_hi v160, v12 offset:128
    ds_read_u16_d16_hi v176, v12 offset:130
    ds_read_u16_d16_hi v161, v12 offset:384
    ds_read_u16_d16_hi v177, v12 offset:386
    ds_read_u16_d16_hi v162, v12 offset:640
    ds_read_u16_d16_hi v178, v12 offset:642
    ds_read_u16_d16_hi v163, v12 offset:896
    ds_read_u16_d16_hi v179, v12 offset:898
    ds_read_u16_d16_hi v164, v12 offset:2176
    ds_read_u16_d16_hi v180, v12 offset:2178
    ds_read_u16_d16_hi v165, v12 offset:2432
    ds_read_u16_d16_hi v181, v12 offset:2434
    ds_read_u16_d16_hi v166, v12 offset:2688
    ds_read_u16_d16_hi v182, v12 offset:2690
    ds_read_u16_d16_hi v167, v12 offset:2944
    ds_read_u16_d16_hi v183, v12 offset:2946
    ds_read_u16_d16_hi v168, v12 offset:4224
    ds_read_u16_d16_hi v184, v12 offset:4226
    ds_read_u16_d16_hi v169, v12 offset:4480
    ds_read_u16_d16_hi v185, v12 offset:4482
    ds_read_u16_d16_hi v170, v12 offset:4736
    ds_read_u16_d16_hi v186, v12 offset:4738
    ds_read_u16_d16_hi v171, v12 offset:4992
    ds_read_u16_d16_hi v187, v12 offset:4994
    ds_read_u16_d16_hi v172, v12 offset:6272
    ds_read_u16_d16_hi v188, v12 offset:6274
    ds_read_u16_d16_hi v173, v12 offset:6528
    ds_read_u16_d16_hi v189, v12 offset:6530
    ds_read_u16_d16_hi v174, v12 offset:6784
    ds_read_u16_d16_hi v190, v12 offset:6786
    ds_read_u16_d16_hi v175, v12 offset:7040
    ds_read_u16_d16_hi v191, v12 offset:7042
    s_waitcnt lgkmcnt(0)
    s_cmp_eq_u32 s50, 3
    s_cbranch_scc1 M_noinit
    s_cmp_ge_u32 s26, 4
    s_cbranch_scc1 M_noacc
    s_barrier
    s_mov_b32 s50, 0
    s_cmp_eq_u32 s48, 0
    s_cbranch_scc1 M_noacc
    s_mov_b32 s70, 1
    s_waitcnt vmcnt(32)
    s_branch M_noinit
M_noacc:
    s_cmp_eq_u32 s48, 0
    s_cbranch_scc1 M_nob
    ds_read_b32 v64, v5 offset:12
    ds_read_b32 v65, v5 offset:140
    ds_read_b32 v66, v5 offset:268
    ds_read_b32 v67, v5 offset:396
    s_add_u32 m0, s51, 0
    s_waitcnt lgkmcnt(3)
    v_and_or_b32 v64, v1, s63, v64
    buffer_load_dwordx4 v64, s[28:31], s64 offen offset:0 lds
    buffer_load_dwordx4 v64, s[28:31], s65 offen offset:1024 lds
    buffer_load_dwordx4 v64, s[28:31], s66 offen offset:2048 lds
    s_add_u32 m0, s51, 3072
    s_waitcnt lgkmcnt(2)
    v_and_or_b32 v65, v1, s63, v65
WUP_2300:
    s_cbranch_execz WUP_3834
    buffer_load_dwordx4 v65, s[28:31], s64 offen offset:0 lds
    buffer_load_dwordx4 v65, s[28:31], s65 offen offset:1024 lds
    buffer_load_dwordx4 v65, s[28:31], s66 offen offset:2048 lds
    s_add_u32 m0, s51, 6144
    s_waitcnt lgkmcnt(1)
    v_and_or_b32 v66, v1, s63, v66
    buffer_load_dwordx4 v66, s[28:31], s64 offen offset:0 lds
    buffer_load_dwordx4 v66, s[28:31], s65 offen offset:1024 lds
    buffer_load_dwordx4 v66, s[28:31], s66 offen offset:2048 lds
    s_add_u32 m0, s51, 9216
    s_waitcnt lgkmcnt(0)
    v_and_or_b32 v67, v1, s63, v67
    buffer_load_dwordx4 v67, s[28:31], s64 offen offset:0 lds
    buffer_load_dwordx4 v67, s[28:31], s65 offen offset:1024 lds
    buffer_load_dwordx4 v67, s[28:31], s66 offen offset:2048 lds
    s_branch M_noinit
M_nob:
M_noinit:
    s_cmp_eq_u32 s50, 0
    s_cbranch_scc1 M_nod
    s_barrier
    s_mov_b32 s50, 0
M_nod:
    s_cmp_eq_u32 s48, 0
    s_cbranch_scc1 M_wend
    s_mov_b32 s49, 0
    s_sub_u32 s27, s48, s49
    s_cmp_ge_u32 s26, 4
    s_addc_u32 s27, s27, 0
    s_setprio 0
    s_cmp_le_u32 s27, 1
    s_cbranch_scc1 M_rp16
    s_setprio 1
    s_cmp_le_u32 s27, 2
    s_cbranch_scc1 M_rp16
    s_setprio 2
    s_cmp_le_u32 s27, 3
    s_cbranch_scc1 M_rp16
    s_setprio 3
M_rp16:
    ds_read_b128 v[48:51], v3 offset:0
    ds_read_b128 v[52:55], v7
    ds_read_b128 v[56:59], v7 offset:16
    ds_read_b64 v[12:13], v4 offset:2048
    ds_read_b64 v[14:15], v4 offset:2160
    ds_read_b64 v[16:17], v4 offset:2272
    ds_read_b64 v[18:19], v4 offset:2384
    ds_read_b128 v[20:23], v1 offset:24576
    ds_read_b128 v[24:27], v1 offset:0
    ds_read_b128 v[28:31], v1 offset:1024
    s_waitcnt lgkmcnt(7)
    v_mul_f32 v52, v48, v52
    v_mul_f32 v53, v48, v53
    v_mul_f32 v54, v48, v54
    v_mul_f32 v55, v48, v55
    v_mul_f32 v56, v48, v56
    v_mul_f32 v57, v48, v57
    v_mul_f32 v58, v48, v58
    v_mul_f32 v59, v48, v59
    v_cvt_pk_bf16_f32 v52, 0, v52
    v_cvt_pk_bf16_f32 v53, 0, v53
    v_cvt_pk_bf16_f32 v54, 0, v54
    v_cvt_pk_bf16_f32 v55, 0, v55
    v_cvt_pk_bf16_f32 v56, 0, v56
    v_cvt_pk_bf16_f32 v57, 0, v57
    v_cvt_pk_bf16_f32 v58, 0, v58
    v_cvt_pk_bf16_f32 v59, 0, v59
    v_mul_f32 v52, s61, v52
    v_mul_f32 v53, s61, v53
    v_mul_f32 v54, s61, v54
    v_mul_f32 v55, s61, v55
    v_mul_f32 v56, s61, v56
    v_mul_f32 v57, s61, v57
    v_mul_f32 v58, s61, v58
    v_mul_f32 v59, s61, v59
    v_sin_f32 v52, v52
    v_sin_f32 v53, v53
    v_sin_f32 v54, v54
    v_sin_f32 v55, v55
    v_sin_f32 v56, v56
    v_sin_f32 v57, v57
    v_sin_f32 v58, v58
    v_sin_f32 v59, v59
    v_mul_f32 v52, v52, v49
    v_mul_f32 v53, v53, v49
    v_mul_f32 v54, v54, v49
    v_mul_f32 v55, v55, v49
    v_mul_f32 v56, v56, v49
    v_mul_f32 v57, v57, v49
    v_mul_f32 v58, v58, v49
    v_mul_f32 v59, v59, v49
    v_cvt_pk_bf16_f32 v8, v52, v53
    v_cvt_pk_bf16_f32 v9, v54, v55
    v_cvt_pk_bf16_f32 v10, v56, v57
    v_cvt_pk_bf16_f32 v11, v58, v59
    s_waitcnt lgkmcnt(3)
    v_pk_lshlrev_b16 v12, v6, v12
    v_pk_lshlrev_b16 v13, v6, v13
    v_pk_lshlrev_b16 v14, v6, v14
    v_pk_lshlrev_b16 v15, v6, v15
    v_pk_lshlrev_b16 v16, v6, v16
    v_pk_lshlrev_b16 v17, v6, v17
    v_pk_lshlrev_b16 v18, v6, v18
    v_pk_lshlrev_b16 v19, v6, v19
    s_waitcnt lgkmcnt(0)
    s_nop 0
M_batch:
    s_cmp_lg_u32 s99, 0
    s_waitcnt vmcnt(44)
    s_cbranch_scc1 M_hw17
    s_waitcnt vmcnt(12)
M_hw17:
    ds_read_b32 v63, v3 offset:524
    v_mfma_f32_32x32x16_bf16 v[80:95], v[8:11], v[20:23], 0
    ds_read_b128 v[20:23], v1 offset:2048
    s_add_u32 s77, s49, 1
    s_cmp_lt_u32 s77, s48
    s_cselect_b32 s77, 0, 0x40000000
    v_mfma_f32_32x32x16_bf16 v[64:79], v[32:35], v[24:27], 0
    ds_read_b128 v[24:27], v1 offset:3072
    v_mfma_f32_32x32x16_bf16 v[64:79], v[36:39], v[28:31], v[64:79]
    ds_read_b128 v[28:31], v1 offset:25600
    v_bfe_u32 v62, v1, 9, 1
    s_waitcnt lgkmcnt(3)
    v_lshrrev_b32 v63, 2, v63
    v_lshl_add_u32 v63, v62, 6, v63
    buffer_load_dwordx4 v[48:51], v63, s[72:75], s77 offen offset:0
    buffer_load_dwordx4 v[52:55], v63, s[72:75], s77 offen offset:16
    buffer_load_dwordx4 v[56:59], v63, s[72:75], s77 offen offset:32
    buffer_load_dwordx4 v[60:63], v63, s[72:75], s77 offen offset:48
    s_cmp_eq_u32 s70, 0
    s_nop 1
    s_cbranch_scc1 M_vb18
    ds_read_b32 v112, v5 offset:12
    ds_read_b32 v113, v5 offset:140
    s_add_u32 m0, s51, 0
    s_waitcnt lgkmcnt(1)
    v_and_or_b32 v112, v1, s63, v112
    buffer_load_dwordx4 v112, s[28:31], s64 offen offset:0 lds
    buffer_load_dwordx4 v112, s[28:31], s65 offen offset:1024 lds
    buffer_load_dwordx4 v112, s[28:31], s66 offen offset:2048 lds
    s_add_u32 m0, s51, 3072
    s_waitcnt lgkmcnt(0)
    v_and_or_b32 v113, v1, s63, v113
    buffer_load_dwordx4 v113, s[28:31], s64 offen offset:0 lds
    buffer_load_dwordx4 v113, s[28:31], s65 offen offset:1024 lds
    buffer_load_dwordx4 v113, s[28:31], s66 offen offset:2048 lds
M_vb18:
    s_waitcnt lgkmcnt(2)
    v_mfma_f32_32x32x16_bf16 v[64:79], v[40:43], v[20:23], v[64:79]
    ds_read_b128 v[20:23], v1 offset:4096
    s_waitcnt lgkmcnt(2)
    v_mfma_f32_32x32x16_bf16 v[64:79], v[44:47], v[24:27], v[64:79]
    ds_read_b128 v[24:27], v1 offset:5120
    s_cmp_eq_u32 s70, 0
    s_nop 9
    s_cbranch_scc1 M_vb19
    ds_read_b32 v114, v5 offset:268
    s_add_u32 m0, s51, 6144
    s_waitcnt lgkmcnt(0)
    v_and_or_b32 v114, v1, s63, v114
    buffer_load_dwordx4 v114, s[28:31], s64 offen offset:0 lds
    buffer_load_dwordx4 v114, s[28:31], s65 offen offset:1024 lds
    buffer_load_dwordx4 v114, s[28:31], s66 offen offset:2048 lds
M_vb19:
    s_waitcnt lgkmcnt(2)
    v_mfma_f32_32x32x16_bf16 v[112:127], v[8:11], v[28:31], 0
    ds_read_b128 v[28:31], v1 offset:6144
    s_waitcnt lgkmcnt(2)
    v_mfma_f32_32x32x16_bf16 v[96:111], v[32:35], v[20:23], 0
    ds_read_b128 v[20:23], v1 offset:7168
    v_mul_f32 v64, v64, v80
    v_mul_f32 v65, v65, v81
    v_mul_f32 v66, v66, v82
    v_mul_f32 v67, v67, v83
    v_mul_f32 v68, v68, v84
    v_mul_f32 v69, v69, v85
    s_waitcnt lgkmcnt(2)
    v_mfma_f32_32x32x16_bf16 v[96:111], v[36:39], v[24:27], v[96:111]
    ds_read_b128 v[24:27], v1 offset:26624
    v_mul_f32 v70, v70, v86
    v_mul_f32 v71, v71, v87
    v_mul_f32 v72, v72, v88
    v_mul_f32 v73, v73, v89
    v_mul_f32 v74, v74, v90
    v_mul_f32 v75, v75, v91
    v_mul_f32 v76, v76, v92
    s_waitcnt lgkmcnt(2)
    v_mfma_f32_32x32x16_bf16 v[96:111], v[40:43], v[28:31], v[96:111]
    ds_read_b128 v[28:31], v1 offset:8192
    v_mul_f32 v77, v77, v93
    v_mul_f32 v78, v78, v94
    v_mul_f32 v79, v79, v95
    v_cvt_pk_bf16_f32 v64, v64, v65
WUP_2486:
    s_cbranch_execz WUP_3938
    v_cvt_pk_bf16_f32 v65, v66, v67
    v_cvt_pk_bf16_f32 v66, v68, v69
    s_waitcnt lgkmcnt(2)
    v_mfma_f32_32x32x16_bf16 v[96:111], v[44:47], v[20:23], v[96:111]
    ds_read_b128 v[20:23], v1 offset:9216
    v_cvt_pk_bf16_f32 v67, v70, v71
    v_cvt_pk_bf16_f32 v68, v72, v73
    v_cvt_pk_bf16_f32 v69, v74, v75
    v_cvt_pk_bf16_f32 v70, v76, v77
    v_cvt_pk_bf16_f32 v71, v78, v79
    v_mfma_f32_32x32x16_bf16 v[128:143], v[12:15], v[64:67], v[128:143]
    s_nop 0
    v_mfma_f32_32x32x16_bf16 v[128:143], v[16:19], v[68:71], v[128:143]
    s_cmp_eq_u32 s70, 0
    s_nop 10
    s_cbranch_scc1 M_vb20
    ds_read_b32 v72, v5 offset:396
    s_add_u32 m0, s51, 9216
    s_waitcnt lgkmcnt(0)
    v_and_or_b32 v72, v1, s63, v72
    buffer_load_dwordx4 v72, s[28:31], s64 offen offset:0 lds
    buffer_load_dwordx4 v72, s[28:31], s65 offen offset:1024 lds
    buffer_load_dwordx4 v72, s[28:31], s66 offen offset:2048 lds
M_vb20:
    s_waitcnt lgkmcnt(2)
    v_mfma_f32_32x32x16_bf16 v[80:95], v[8:11], v[24:27], 0
    ds_read_b128 v[24:27], v1 offset:10240
    s_waitcnt lgkmcnt(2)
    v_mfma_f32_32x32x16_bf16 v[64:79], v[32:35], v[28:31], 0
    ds_read_b128 v[28:31], v1 offset:11264
    v_mul_f32 v96, v96, v112
    v_mul_f32 v97, v97, v113
    v_mul_f32 v98, v98, v114
    v_mul_f32 v99, v99, v115
    v_mul_f32 v100, v100, v116
    v_mul_f32 v101, v101, v117
    s_waitcnt lgkmcnt(2)
    v_mfma_f32_32x32x16_bf16 v[64:79], v[36:39], v[20:23], v[64:79]
    ds_read_b128 v[20:23], v1 offset:27648
    v_mul_f32 v102, v102, v118
    v_mul_f32 v103, v103, v119
    v_mul_f32 v104, v104, v120
    v_mul_f32 v105, v105, v121
    v_mul_f32 v106, v106, v122
    v_mul_f32 v107, v107, v123
    v_mul_f32 v108, v108, v124
    s_waitcnt lgkmcnt(2)
    v_mfma_f32_32x32x16_bf16 v[64:79], v[40:43], v[24:27], v[64:79]
    ds_read_b128 v[24:27], v1 offset:12288
    v_mul_f32 v109, v109, v125
    v_mul_f32 v110, v110, v126
    v_mul_f32 v111, v111, v127
    v_cvt_pk_bf16_f32 v96, v96, v97
    v_cvt_pk_bf16_f32 v97, v98, v99
    v_cvt_pk_bf16_f32 v98, v100, v101
    s_waitcnt lgkmcnt(2)
    v_mfma_f32_32x32x16_bf16 v[64:79], v[44:47], v[28:31], v[64:79]
    ds_read_b128 v[28:31], v1 offset:13312
    v_cvt_pk_bf16_f32 v99, v102, v103
    v_cvt_pk_bf16_f32 v100, v104, v105
    v_cvt_pk_bf16_f32 v101, v106, v107
    v_cvt_pk_bf16_f32 v102, v108, v109
    v_cvt_pk_bf16_f32 v103, v110, v111
    v_mfma_f32_32x32x16_bf16 v[144:159], v[12:15], v[96:99], v[144:159]
    s_nop 0
    v_mfma_f32_32x32x16_bf16 v[144:159], v[16:19], v[100:103], v[144:159]
    s_waitcnt lgkmcnt(2)
    v_mfma_f32_32x32x16_bf16 v[112:127], v[8:11], v[20:23], 0
    ds_read_b128 v[20:23], v1 offset:14336
    s_waitcnt lgkmcnt(2)
    v_mfma_f32_32x32x16_bf16 v[96:111], v[32:35], v[24:27], 0
    ds_read_b128 v[24:27], v1 offset:15360
    v_mul_f32 v64, v64, v80
    v_mul_f32 v65, v65, v81
    v_mul_f32 v66, v66, v82
    v_mul_f32 v67, v67, v83
    v_mul_f32 v68, v68, v84
    v_mul_f32 v69, v69, v85
    v_mul_f32 v70, v70, v86
    v_mul_f32 v71, v71, v87
    v_mul_f32 v72, v72, v88
    v_mul_f32 v73, v73, v89
    v_mul_f32 v74, v74, v90
    v_mul_f32 v75, v75, v91
    v_mul_f32 v76, v76, v92
    v_mul_f32 v77, v77, v93
    v_mul_f32 v78, v78, v94
    v_mul_f32 v79, v79, v95
    s_cmp_eq_u32 s70, 0
    s_nop 0
    s_cbranch_scc1 M_vw21
    s_waitcnt vmcnt(0)
    s_mov_b32 s70, 0
M_vw21:
    s_waitcnt vmcnt(4)
    s_cmp_eq_u32 s99, 0
    s_cbranch_scc1 M_ru22
    v_lshlrev_b32 v192, 16, v208
    v_and_b32 v208, s58, v208
    v_lshlrev_b32 v193, 16, v209
    v_and_b32 v209, s58, v209
    v_lshlrev_b32 v194, 16, v210
    v_and_b32 v210, s58, v210
    v_lshlrev_b32 v195, 16, v211
    v_and_b32 v211, s58, v211
    v_lshlrev_b32 v196, 16, v212
    v_and_b32 v212, s58, v212
    v_lshlrev_b32 v197, 16, v213
    v_and_b32 v213, s58, v213
    v_lshlrev_b32 v198, 16, v214
    v_and_b32 v214, s58, v214
    v_lshlrev_b32 v199, 16, v215
    v_and_b32 v215, s58, v215
    v_lshlrev_b32 v200, 16, v216
    v_and_b32 v216, s58, v216
    v_lshlrev_b32 v201, 16, v217
    v_and_b32 v217, s58, v217
    v_lshlrev_b32 v202, 16, v218
    v_and_b32 v218, s58, v218
    v_lshlrev_b32 v203, 16, v219
    v_and_b32 v219, s58, v219
    v_lshlrev_b32 v204, 16, v220
    v_and_b32 v220, s58, v220
    v_lshlrev_b32 v205, 16, v221
    v_and_b32 v221, s58, v221
    v_lshlrev_b32 v206, 16, v222
    v_and_b32 v222, s58, v222
    v_lshlrev_b32 v207, 16, v223
    v_and_b32 v223, s58, v223
    v_lshlrev_b32 v224, 16, v240
    v_and_b32 v240, s58, v240
    v_lshlrev_b32 v225, 16, v241
    v_and_b32 v241, s58, v241
    v_lshlrev_b32 v226, 16, v242
    v_and_b32 v242, s58, v242
    v_lshlrev_b32 v227, 16, v243
    v_and_b32 v243, s58, v243
    v_lshlrev_b32 v228, 16, v244
    v_and_b32 v244, s58, v244
    v_lshlrev_b32 v229, 16, v245
    v_and_b32 v245, s58, v245
    v_lshlrev_b32 v230, 16, v246
    v_and_b32 v246, s58, v246
    v_lshlrev_b32 v231, 16, v247
    v_and_b32 v247, s58, v247
    v_lshlrev_b32 v232, 16, v248
    v_and_b32 v248, s58, v248
    v_lshlrev_b32 v233, 16, v249
    v_and_b32 v249, s58, v249
    v_lshlrev_b32 v234, 16, v250
    v_and_b32 v250, s58, v250
    v_lshlrev_b32 v235, 16, v251
    v_and_b32 v251, s58, v251
    v_lshlrev_b32 v236, 16, v252
    v_and_b32 v252, s58, v252
    v_lshlrev_b32 v237, 16, v253
    v_and_b32 v253, s58, v253
    v_lshlrev_b32 v238, 16, v254
    v_and_b32 v254, s58, v254
    v_lshlrev_b32 v239, 16, v255
    v_and_b32 v255, s58, v255
    s_mov_b32 s99, 0
    s_nop 0
M_ru22:
    ds_read_u16_d16_hi v80, v2 offset:0
    ds_read_u16_d16_hi v81, v2 offset:256
    ds_read_u16_d16_hi v82, v2 offset:512
    ds_read_u16_d16_hi v83, v2 offset:768
    ds_read_u16_d16_hi v84, v2 offset:3072
    ds_read_u16_d16_hi v85, v2 offset:3328
    ds_read_u16_d16_hi v86, v2 offset:3584
    ds_read_u16_d16_hi v87, v2 offset:3840
    ds_read_u16_d16_hi v88, v2 offset:6144
    ds_read_u16_d16_hi v89, v2 offset:6400
WUP_2657:
    s_cbranch_execz WUR_1
    ds_read_u16_d16_hi v90, v2 offset:6656
    ds_read_u16_d16_hi v91, v2 offset:6912
    ds_read_u16_d16_hi v92, v2 offset:9216
    ds_read_u16_d16_hi v93, v2 offset:9472
    ds_read_u16_d16_hi v94, v2 offset:9728
    ds_read_u16_d16_hi v95, v2 offset:9984
    s_waitcnt lgkmcnt(8)
    v_mul_f32 v80, v80, v64
    v_mul_f32 v81, v81, v65
    v_mul_f32 v82, v82, v66
    v_mul_f32 v83, v83, v67
    v_mul_f32 v84, v84, v68
    v_mul_f32 v85, v85, v69
    v_mfma_f32_32x32x16_bf16 v[96:111], v[36:39], v[28:31], v[96:111]
    ds_read_b128 v[28:31], v1 offset:28672
    v_mul_f32 v86, v86, v70
    v_mul_f32 v87, v87, v71
    v_cvt_pk_bf16_f32 v80, v80, v81
    v_cvt_pk_bf16_f32 v81, v82, v83
    v_cvt_pk_bf16_f32 v82, v84, v85
    v_cvt_pk_bf16_f32 v83, v86, v87
    s_waitcnt lgkmcnt(1)
    v_mul_f32 v88, v88, v72
    v_mul_f32 v89, v89, v73
    v_mfma_f32_32x32x16_bf16 v[160:175], v[12:15], v[80:83], v[160:175]
    ds_read_u16_d16_hi v80, v2 offset:1024
    ds_read_u16_d16_hi v81, v2 offset:1280
    ds_read_u16_d16_hi v82, v2 offset:1536
    ds_read_u16_d16_hi v83, v2 offset:1792
    ds_read_u16_d16_hi v84, v2 offset:4096
    ds_read_u16_d16_hi v85, v2 offset:4352
    ds_read_u16_d16_hi v86, v2 offset:4608
    ds_read_u16_d16_hi v87, v2 offset:4864
    v_mul_f32 v90, v90, v74
    v_mul_f32 v91, v91, v75
    v_mul_f32 v92, v92, v76
    v_mul_f32 v93, v93, v77
    v_mul_f32 v94, v94, v78
    v_mul_f32 v95, v95, v79
    v_cvt_pk_bf16_f32 v88, v88, v89
    v_cvt_pk_bf16_f32 v89, v90, v91
    v_cvt_pk_bf16_f32 v90, v92, v93
    v_cvt_pk_bf16_f32 v91, v94, v95
    s_waitcnt lgkmcnt(0)
    v_mul_f32 v80, v80, v64
    v_mul_f32 v81, v81, v65
    v_mfma_f32_32x32x16_bf16 v[160:175], v[16:19], v[88:91], v[160:175]
    ds_read_u16_d16_hi v88, v2 offset:7168
    ds_read_u16_d16_hi v89, v2 offset:7424
    ds_read_u16_d16_hi v90, v2 offset:7680
    ds_read_u16_d16_hi v91, v2 offset:7936
    ds_read_u16_d16_hi v92, v2 offset:10240
    ds_read_u16_d16_hi v93, v2 offset:10496
    ds_read_u16_d16_hi v94, v2 offset:10752
    ds_read_u16_d16_hi v95, v2 offset:11008
    v_mul_f32 v82, v82, v66
    v_mfma_f32_32x32x16_bf16 v[96:111], v[40:43], v[20:23], v[96:111]
    ds_read_b128 v[20:23], v1 offset:16384
    v_mul_f32 v83, v83, v67
    v_mul_f32 v84, v84, v68
    v_mul_f32 v85, v85, v69
    v_mul_f32 v86, v86, v70
    v_mul_f32 v87, v87, v71
    v_cvt_pk_bf16_f32 v80, v80, v81
    v_cvt_pk_bf16_f32 v81, v82, v83
    v_cvt_pk_bf16_f32 v82, v84, v85
    v_cvt_pk_bf16_f32 v83, v86, v87
    s_waitcnt lgkmcnt(1)
    v_mul_f32 v88, v88, v72
    v_mul_f32 v89, v89, v73
    v_mfma_f32_32x32x16_bf16 v[192:207], v[12:15], v[80:83], v[192:207]
    ds_read_u16_d16_hi v80, v2 offset:2048
    ds_read_u16_d16_hi v81, v2 offset:2304
    ds_read_u16_d16_hi v82, v2 offset:2560
    ds_read_u16_d16_hi v83, v2 offset:2816
    ds_read_u16_d16_hi v84, v2 offset:5120
    ds_read_u16_d16_hi v85, v2 offset:5376
    ds_read_u16_d16_hi v86, v2 offset:5632
    ds_read_u16_d16_hi v87, v2 offset:5888
    v_mul_f32 v90, v90, v74
    v_mul_f32 v91, v91, v75
    v_mul_f32 v92, v92, v76
    v_mul_f32 v93, v93, v77
    v_mul_f32 v94, v94, v78
    v_mul_f32 v95, v95, v79
    v_cvt_pk_bf16_f32 v88, v88, v89
    v_cvt_pk_bf16_f32 v89, v90, v91
    v_cvt_pk_bf16_f32 v90, v92, v93
    v_cvt_pk_bf16_f32 v91, v94, v95
    s_waitcnt lgkmcnt(0)
    v_mul_f32 v80, v80, v64
    v_mul_f32 v81, v81, v65
    v_mfma_f32_32x32x16_bf16 v[96:111], v[44:47], v[24:27], v[96:111]
    ds_read_b128 v[24:27], v1 offset:17408
    v_mfma_f32_32x32x16_bf16 v[192:207], v[16:19], v[88:91], v[192:207]
    ds_read_u16_d16_hi v88, v2 offset:8192
    ds_read_u16_d16_hi v89, v2 offset:8448
    ds_read_u16_d16_hi v90, v2 offset:8704
    ds_read_u16_d16_hi v91, v2 offset:8960
    ds_read_u16_d16_hi v92, v2 offset:11264
    ds_read_u16_d16_hi v93, v2 offset:11520
    ds_read_u16_d16_hi v94, v2 offset:11776
    ds_read_u16_d16_hi v95, v2 offset:12032
    v_mul_f32 v82, v82, v66
    v_mul_f32 v83, v83, v67
    v_mul_f32 v84, v84, v68
    v_mul_f32 v85, v85, v69
    v_mul_f32 v86, v86, v70
    v_mul_f32 v87, v87, v71
    v_cvt_pk_bf16_f32 v80, v80, v81
    v_cvt_pk_bf16_f32 v81, v82, v83
    v_cvt_pk_bf16_f32 v82, v84, v85
    v_cvt_pk_bf16_f32 v83, v86, v87
    s_waitcnt lgkmcnt(0)
    v_mul_f32 v88, v88, v72
    v_mul_f32 v89, v89, v73
    v_mfma_f32_32x32x16_bf16 v[224:239], v[12:15], v[80:83], v[224:239]
    v_mul_f32 v90, v90, v74
    v_mul_f32 v91, v91, v75
    v_mul_f32 v92, v92, v76
    v_mul_f32 v93, v93, v77
    v_mul_f32 v94, v94, v78
    v_mul_f32 v95, v95, v79
    v_cvt_pk_bf16_f32 v88, v88, v89
    v_cvt_pk_bf16_f32 v89, v90, v91
    v_cvt_pk_bf16_f32 v90, v92, v93
    v_cvt_pk_bf16_f32 v91, v94, v95
    s_nop 1
    v_mfma_f32_32x32x16_bf16 v[224:239], v[16:19], v[88:91], v[224:239]
    v_mfma_f32_32x32x16_bf16 v[80:95], v[8:11], v[28:31], 0
    ds_read_b128 v[28:31], v1 offset:18432
    v_mfma_f32_32x32x16_bf16 v[64:79], v[32:35], v[20:23], 0
    ds_read_b128 v[20:23], v1 offset:19456
    v_mul_f32 v96, v96, v112
    v_mul_f32 v97, v97, v113
    v_mul_f32 v98, v98, v114
    v_mul_f32 v99, v99, v115
    v_mul_f32 v100, v100, v116
    v_mul_f32 v101, v101, v117
    v_mul_f32 v102, v102, v118
    v_mul_f32 v103, v103, v119
    v_mul_f32 v104, v104, v120
    v_mul_f32 v105, v105, v121
    v_mul_f32 v106, v106, v122
    v_mul_f32 v107, v107, v123
    v_mul_f32 v108, v108, v124
    v_mul_f32 v109, v109, v125
    v_mul_f32 v110, v110, v126
    v_mul_f32 v111, v111, v127
    ds_read_u16_d16_hi v112, v2 offset:2
    ds_read_u16_d16_hi v113, v2 offset:258
    ds_read_u16_d16_hi v114, v2 offset:514
    ds_read_u16_d16_hi v115, v2 offset:770
    ds_read_u16_d16_hi v116, v2 offset:3074
    ds_read_u16_d16_hi v117, v2 offset:3330
    ds_read_u16_d16_hi v118, v2 offset:3586
    ds_read_u16_d16_hi v119, v2 offset:3842
    ds_read_u16_d16_hi v120, v2 offset:6146
    ds_read_u16_d16_hi v121, v2 offset:6402
    ds_read_u16_d16_hi v122, v2 offset:6658
    ds_read_u16_d16_hi v123, v2 offset:6914
    ds_read_u16_d16_hi v124, v2 offset:9218
    ds_read_u16_d16_hi v125, v2 offset:9474
    ds_read_u16_d16_hi v126, v2 offset:9730
    ds_read_u16_d16_hi v127, v2 offset:9986
    s_waitcnt lgkmcnt(8)
    v_mul_f32 v112, v112, v96
    v_mul_f32 v113, v113, v97
    v_mul_f32 v114, v114, v98
    v_mul_f32 v115, v115, v99
    v_mul_f32 v116, v116, v100
    v_mul_f32 v117, v117, v101
    v_mul_f32 v118, v118, v102
    v_mfma_f32_32x32x16_bf16 v[64:79], v[36:39], v[24:27], v[64:79]
    ds_read_b128 v[24:27], v1 offset:29696
    v_mul_f32 v119, v119, v103
    v_cvt_pk_bf16_f32 v112, v112, v113
    v_cvt_pk_bf16_f32 v113, v114, v115
    v_cvt_pk_bf16_f32 v114, v116, v117
    v_cvt_pk_bf16_f32 v115, v118, v119
    s_waitcnt lgkmcnt(1)
    v_mul_f32 v120, v120, v104
    v_mul_f32 v121, v121, v105
    v_mfma_f32_32x32x16_bf16 v[176:191], v[12:15], v[112:115], v[176:191]
    ds_read_u16_d16_hi v112, v2 offset:1026
    ds_read_u16_d16_hi v113, v2 offset:1282
    ds_read_u16_d16_hi v114, v2 offset:1538
    ds_read_u16_d16_hi v115, v2 offset:1794
    ds_read_u16_d16_hi v116, v2 offset:4098
    ds_read_u16_d16_hi v117, v2 offset:4354
    ds_read_u16_d16_hi v118, v2 offset:4610
    ds_read_u16_d16_hi v119, v2 offset:4866
    v_mul_f32 v122, v122, v106
    v_mul_f32 v123, v123, v107
    v_mul_f32 v124, v124, v108
    v_mul_f32 v125, v125, v109
    v_mul_f32 v126, v126, v110
    v_mul_f32 v127, v127, v111
    v_cvt_pk_bf16_f32 v120, v120, v121
    v_cvt_pk_bf16_f32 v121, v122, v123
    v_cvt_pk_bf16_f32 v122, v124, v125
    v_cvt_pk_bf16_f32 v123, v126, v127
    s_waitcnt lgkmcnt(0)
    v_mul_f32 v112, v112, v96
    v_mul_f32 v113, v113, v97
    v_mfma_f32_32x32x16_bf16 v[176:191], v[16:19], v[120:123], v[176:191]
    ds_read_u16_d16_hi v120, v2 offset:7170
    ds_read_u16_d16_hi v121, v2 offset:7426
    ds_read_u16_d16_hi v122, v2 offset:7682
    ds_read_u16_d16_hi v123, v2 offset:7938
    ds_read_u16_d16_hi v124, v2 offset:10242
    ds_read_u16_d16_hi v125, v2 offset:10498
    ds_read_u16_d16_hi v126, v2 offset:10754
    ds_read_u16_d16_hi v127, v2 offset:11010
    v_mul_f32 v114, v114, v98
    v_mul_f32 v115, v115, v99
    v_mfma_f32_32x32x16_bf16 v[64:79], v[40:43], v[28:31], v[64:79]
    ds_read_b128 v[28:31], v1 offset:20480
    v_mul_f32 v116, v116, v100
    v_mul_f32 v117, v117, v101
    v_mul_f32 v118, v118, v102
    v_mul_f32 v119, v119, v103
    v_cvt_pk_bf16_f32 v112, v112, v113
    v_cvt_pk_bf16_f32 v113, v114, v115
    v_cvt_pk_bf16_f32 v114, v116, v117
    v_cvt_pk_bf16_f32 v115, v118, v119
    s_waitcnt lgkmcnt(1)
    v_mul_f32 v120, v120, v104
    v_mul_f32 v121, v121, v105
    v_mfma_f32_32x32x16_bf16 v[208:223], v[12:15], v[112:115], v[208:223]
    ds_read_u16_d16_hi v112, v2 offset:2050
    ds_read_u16_d16_hi v113, v2 offset:2306
    ds_read_u16_d16_hi v114, v2 offset:2562
    ds_read_u16_d16_hi v115, v2 offset:2818
    ds_read_u16_d16_hi v116, v2 offset:5122
    ds_read_u16_d16_hi v117, v2 offset:5378
    ds_read_u16_d16_hi v118, v2 offset:5634
    ds_read_u16_d16_hi v119, v2 offset:5890
    v_mul_f32 v122, v122, v106
    v_mul_f32 v123, v123, v107
    v_mul_f32 v124, v124, v108
    v_mul_f32 v125, v125, v109
    v_mul_f32 v126, v126, v110
    v_mul_f32 v127, v127, v111
    v_cvt_pk_bf16_f32 v120, v120, v121
    v_cvt_pk_bf16_f32 v121, v122, v123
    v_cvt_pk_bf16_f32 v122, v124, v125
    v_cvt_pk_bf16_f32 v123, v126, v127
    s_waitcnt lgkmcnt(0)
    v_mul_f32 v112, v112, v96
    v_mul_f32 v113, v113, v97
    v_mfma_f32_32x32x16_bf16 v[208:223], v[16:19], v[120:123], v[208:223]
    v_mfma_f32_32x32x16_bf16 v[64:79], v[44:47], v[20:23], v[64:79]
    ds_read_b128 v[20:23], v1 offset:21504
    ds_read_u16_d16_hi v120, v2 offset:8194
    ds_read_u16_d16_hi v121, v2 offset:8450
    ds_read_u16_d16_hi v122, v2 offset:8706
    ds_read_u16_d16_hi v123, v2 offset:8962
    ds_read_u16_d16_hi v124, v2 offset:11266
    ds_read_u16_d16_hi v125, v2 offset:11522
    ds_read_u16_d16_hi v126, v2 offset:11778
    ds_read_u16_d16_hi v127, v2 offset:12034
    v_mul_f32 v114, v114, v98
    v_mul_f32 v115, v115, v99
    v_mul_f32 v116, v116, v100
    v_mul_f32 v117, v117, v101
    v_mul_f32 v118, v118, v102
    v_mul_f32 v119, v119, v103
    v_cvt_pk_bf16_f32 v112, v112, v113
    v_cvt_pk_bf16_f32 v113, v114, v115
    v_cvt_pk_bf16_f32 v114, v116, v117
    v_cvt_pk_bf16_f32 v115, v118, v119
    s_waitcnt lgkmcnt(0)
    v_mul_f32 v120, v120, v104
    v_mul_f32 v121, v121, v105
    v_mfma_f32_32x32x16_bf16 v[240:255], v[12:15], v[112:115], v[240:255]
    ds_read_b32 v112, v5 offset:524
    ds_read_b32 v113, v5 offset:652
    ds_read_b32 v114, v5 offset:780
    ds_read_b32 v115, v5 offset:908
    v_mul_f32 v122, v122, v106
    v_mul_f32 v123, v123, v107
    v_mul_f32 v124, v124, v108
    v_mul_f32 v125, v125, v109
    v_mul_f32 v126, v126, v110
    v_mul_f32 v127, v127, v111
    v_cvt_pk_bf16_f32 v120, v120, v121
    v_cvt_pk_bf16_f32 v121, v122, v123
    v_cvt_pk_bf16_f32 v122, v124, v125
    v_cvt_pk_bf16_f32 v123, v126, v127
    s_nop 1
    v_mfma_f32_32x32x16_bf16 v[240:255], v[16:19], v[120:123], v[240:255]
    s_cmp_lg_u32 s77, 0
    s_cbranch_scc1 M_nv23
    s_add_u32 m0, s51, 0
    s_waitcnt lgkmcnt(3)
    v_and_or_b32 v112, v1, s63, v112
    buffer_load_dwordx4 v112, s[28:31], s64 offen offset:0 lds
    buffer_load_dwordx4 v112, s[28:31], s65 offen offset:1024 lds
    buffer_load_dwordx4 v112, s[28:31], s66 offen offset:2048 lds
    s_add_u32 m0, s51, 3072
    s_waitcnt lgkmcnt(2)
    v_and_or_b32 v113, v1, s63, v113
    buffer_load_dwordx4 v113, s[28:31], s64 offen offset:0 lds
    buffer_load_dwordx4 v113, s[28:31], s65 offen offset:1024 lds
    buffer_load_dwordx4 v113, s[28:31], s66 offen offset:2048 lds
    s_add_u32 m0, s51, 6144
    s_waitcnt lgkmcnt(1)
    v_and_or_b32 v114, v1, s63, v114
    buffer_load_dwordx4 v114, s[28:31], s64 offen offset:0 lds
    buffer_load_dwordx4 v114, s[28:31], s65 offen offset:1024 lds
    buffer_load_dwordx4 v114, s[28:31], s66 offen offset:2048 lds
    s_add_u32 m0, s51, 9216
    s_waitcnt lgkmcnt(0)
    v_and_or_b32 v115, v1, s63, v115
    buffer_load_dwordx4 v115, s[28:31], s64 offen offset:0 lds
    buffer_load_dwordx4 v115, s[28:31], s65 offen offset:1024 lds
    buffer_load_dwordx4 v115, s[28:31], s66 offen offset:2048 lds
M_nv23:
    s_waitcnt lgkmcnt(0)
    v_mfma_f32_32x32x16_bf16 v[112:127], v[8:11], v[24:27], 0
    ds_read_b128 v[24:27], v1 offset:22528
    v_mfma_f32_32x32x16_bf16 v[96:111], v[32:35], v[28:31], 0
    ds_read_b128 v[28:31], v1 offset:23552
    v_mul_f32 v64, v64, v80
    v_mul_f32 v65, v65, v81
    v_mul_f32 v66, v66, v82
    v_mul_f32 v67, v67, v83
    v_mul_f32 v68, v68, v84
    v_mul_f32 v69, v69, v85
    v_mul_f32 v70, v70, v86
    v_mul_f32 v71, v71, v87
    v_mul_f32 v72, v72, v88
    v_mul_f32 v73, v73, v89
    v_mul_f32 v74, v74, v90
    v_mul_f32 v75, v75, v91
    v_mfma_f32_32x32x16_bf16 v[96:111], v[36:39], v[20:23], v[96:111]
    v_mul_f32 v76, v76, v92
    v_mul_f32 v77, v77, v93
    v_mul_f32 v78, v78, v94
    v_mul_f32 v79, v79, v95
    ds_read_b64 v[80:81], v0 offset:2080
    ds_read_b64 v[88:89], v0 offset:2088
    ds_read_b64 v[82:83], v0 offset:2192
    ds_read_b64 v[90:91], v0 offset:2200
    ds_read_b64 v[84:85], v0 offset:2304
    ds_read_b64 v[92:93], v0 offset:2312
    ds_read_b64 v[86:87], v0 offset:2416
    ds_read_b64 v[94:95], v0 offset:2424
    v_cvt_pk_bf16_f32 v64, v64, v65
    v_cvt_pk_bf16_f32 v65, v66, v67
    v_cvt_pk_bf16_f32 v66, v68, v69
    v_cvt_pk_bf16_f32 v67, v70, v71
    v_cvt_pk_bf16_f32 v68, v72, v73
    v_cvt_pk_bf16_f32 v69, v74, v75
    v_cvt_pk_bf16_f32 v70, v76, v77
    s_waitcnt lgkmcnt(9)
    v_mfma_f32_32x32x16_bf16 v[96:111], v[40:43], v[24:27], v[96:111]
    v_cvt_pk_bf16_f32 v71, v78, v79
    v_pk_lshrrev_b16 v72, 14, v12 op_sel_hi:[0,1]
    v_pk_lshrrev_b16 v73, 14, v13 op_sel_hi:[0,1]
    v_pk_lshrrev_b16 v74, 14, v14 op_sel_hi:[0,1]
    v_pk_lshrrev_b16 v75, 14, v15 op_sel_hi:[0,1]
    v_pk_lshrrev_b16 v76, 14, v16 op_sel_hi:[0,1]
    v_pk_lshrrev_b16 v77, 14, v17 op_sel_hi:[0,1]
    v_pk_lshrrev_b16 v78, 14, v18 op_sel_hi:[0,1]
    v_pk_lshrrev_b16 v79, 14, v19 op_sel_hi:[0,1]
    s_waitcnt lgkmcnt(0)
    v_pk_mul_lo_u16 v80, v72, v80
    v_pk_mul_lo_u16 v81, v73, v81
    v_pk_mul_lo_u16 v82, v74, v82
    v_mfma_f32_32x32x16_bf16 v[96:111], v[44:47], v[28:31], v[96:111]
    v_pk_mul_lo_u16 v83, v75, v83
    v_pk_mul_lo_u16 v84, v76, v84
    v_pk_mul_lo_u16 v85, v77, v85
    v_pk_mul_lo_u16 v86, v78, v86
    v_pk_mul_lo_u16 v87, v79, v87
    v_pk_mul_lo_u16 v88, v72, v88
    v_pk_mul_lo_u16 v89, v73, v89
    v_pk_mul_lo_u16 v90, v74, v90
    v_pk_mul_lo_u16 v91, v75, v91
    v_pk_mul_lo_u16 v92, v76, v92
    v_pk_mul_lo_u16 v93, v77, v93
    v_pk_mul_lo_u16 v94, v78, v94
    v_pk_mul_lo_u16 v95, v79, v95
    v_mfma_f32_32x32x16_bf16 v[160:175], v[80:83], v[64:67], v[160:175]
    ds_read_b128 v[32:35], v3 offset:512
    ds_read_b128 v[36:39], v7
    ds_read_b128 v[40:43], v7 offset:16
    ds_read_b64 v[12:13], v4 offset:2496
    ds_read_b64 v[14:15], v4 offset:2608
    ds_read_b64 v[16:17], v4 offset:2720
    ds_read_b64 v[18:19], v4 offset:2832
    ds_read_b128 v[20:23], v1 offset:24576
    ds_read_b128 v[24:27], v1 offset:0
    ds_read_b128 v[28:31], v1 offset:1024
    v_mul_f32 v96, v96, v112
    v_mul_f32 v97, v97, v113
    v_mul_f32 v98, v98, v114
    v_mul_f32 v99, v99, v115
    v_mul_f32 v100, v100, v116
    v_mfma_f32_32x32x16_bf16 v[160:175], v[84:87], v[68:71], v[160:175]
    v_mul_f32 v101, v101, v117
    v_mul_f32 v102, v102, v118
    v_mul_f32 v103, v103, v119
    v_mul_f32 v104, v104, v120
    v_mul_f32 v105, v105, v121
    v_mul_f32 v106, v106, v122
    v_mul_f32 v107, v107, v123
    v_mfma_f32_32x32x16_bf16 v[192:207], v[88:91], v[64:67], v[192:207]
    v_mul_f32 v108, v108, v124
    v_mul_f32 v109, v109, v125
    v_mul_f32 v110, v110, v126
    v_mul_f32 v111, v111, v127
    ds_read_b64 v[112:113], v0 offset:2096
    ds_read_b64 v[114:115], v0 offset:2208
    ds_read_b64 v[116:117], v0 offset:2320
    ds_read_b64 v[118:119], v0 offset:2432
    v_cvt_pk_bf16_f32 v96, v96, v97
    v_mfma_f32_32x32x16_bf16 v[192:207], v[92:95], v[68:71], v[192:207]
    v_cvt_pk_bf16_f32 v97, v98, v99
    v_cvt_pk_bf16_f32 v98, v100, v101
    v_cvt_pk_bf16_f32 v99, v102, v103
    v_cvt_pk_bf16_f32 v100, v104, v105
    v_cvt_pk_bf16_f32 v101, v106, v107
    v_cvt_pk_bf16_f32 v102, v108, v109
    v_cvt_pk_bf16_f32 v103, v110, v111
    s_waitcnt lgkmcnt(0)
    v_pk_mul_lo_u16 v112, v72, v112
    v_pk_mul_lo_u16 v113, v73, v113
    v_pk_mul_lo_u16 v114, v74, v114
    v_pk_mul_lo_u16 v115, v75, v115
    v_pk_mul_lo_u16 v116, v76, v116
    v_pk_mul_lo_u16 v117, v77, v117
    v_pk_mul_lo_u16 v118, v78, v118
    v_pk_mul_lo_u16 v119, v79, v119
    v_mfma_f32_32x32x16_bf16 v[176:191], v[80:83], v[96:99], v[176:191]
    v_mul_f32 v36, v32, v36
    v_mul_f32 v37, v32, v37
    v_mul_f32 v38, v32, v38
    v_mul_f32 v39, v32, v39
    v_mul_f32 v40, v32, v40
    v_mul_f32 v41, v32, v41
    v_mfma_f32_32x32x16_bf16 v[176:191], v[84:87], v[100:103], v[176:191]
    v_mul_f32 v42, v32, v42
    v_mul_f32 v43, v32, v43
    v_cvt_pk_bf16_f32 v36, 0, v36
    v_cvt_pk_bf16_f32 v37, 0, v37
    v_cvt_pk_bf16_f32 v38, 0, v38
    v_cvt_pk_bf16_f32 v39, 0, v39
    v_cvt_pk_bf16_f32 v40, 0, v40
    v_mfma_f32_32x32x16_bf16 v[208:223], v[88:91], v[96:99], v[208:223]
    v_cvt_pk_bf16_f32 v41, 0, v41
    v_cvt_pk_bf16_f32 v42, 0, v42
    v_cvt_pk_bf16_f32 v43, 0, v43
    v_mul_f32 v36, s61, v36
    v_mul_f32 v37, s61, v37
    v_mul_f32 v38, s61, v38
    v_mfma_f32_32x32x16_bf16 v[208:223], v[92:95], v[100:103], v[208:223]
    v_mul_f32 v39, s61, v39
    v_mul_f32 v40, s61, v40
    v_mul_f32 v41, s61, v41
    v_mul_f32 v42, s61, v42
    v_mul_f32 v43, s61, v43
    v_sin_f32 v36, v36
    v_sin_f32 v37, v37
    v_mfma_f32_32x32x16_bf16 v[224:239], v[112:115], v[64:67], v[224:239]
    v_sin_f32 v38, v38
    v_sin_f32 v39, v39
    v_sin_f32 v40, v40
    v_sin_f32 v41, v41
    v_sin_f32 v42, v42
    v_sin_f32 v43, v43
    v_mfma_f32_32x32x16_bf16 v[240:255], v[112:115], v[96:99], v[240:255]
    v_mul_f32 v36, v36, v33
    v_mul_f32 v37, v37, v33
    v_mul_f32 v38, v38, v33
    v_mul_f32 v39, v39, v33
    v_mul_f32 v40, v40, v33
    v_mul_f32 v41, v41, v33
    v_mul_f32 v42, v42, v33
    v_mfma_f32_32x32x16_bf16 v[224:239], v[116:119], v[68:71], v[224:239]
    v_mul_f32 v43, v43, v33
    v_cvt_pk_bf16_f32 v8, v36, v37
    v_cvt_pk_bf16_f32 v9, v38, v39
    v_cvt_pk_bf16_f32 v10, v40, v41
    v_cvt_pk_bf16_f32 v11, v42, v43
    v_pk_lshlrev_b16 v12, v6, v12
    v_mfma_f32_32x32x16_bf16 v[240:255], v[116:119], v[100:103], v[240:255]
    v_pk_lshlrev_b16 v13, v6, v13
    v_pk_lshlrev_b16 v14, v6, v14
    v_pk_lshlrev_b16 v15, v6, v15
    v_pk_lshlrev_b16 v16, v6, v16
    v_pk_lshlrev_b16 v17, v6, v17
    v_pk_lshlrev_b16 v18, v6, v18
    v_pk_lshlrev_b16 v19, v6, v19
    v_add_u32 v3, 512, v3
    v_add_u32 v4, 448, v4
    v_add_u32 v0, 448, v0
    v_add_u32 v5, 512, v5
    s_waitcnt lgkmcnt(0)
    s_add_u32 s49, s49, 1
    s_sub_u32 s27, s48, s49
    s_cmp_ge_u32 s26, 4
    s_addc_u32 s27, s27, 0
    s_setprio 0
    s_cmp_le_u32 s27, 1
    s_cbranch_scc1 M_rp24
    s_setprio 1
    s_cmp_le_u32 s27, 2
    s_cbranch_scc1 M_rp24
    s_setprio 2
    s_cmp_le_u32 s27, 3
    s_cbranch_scc1 M_rp24
    s_setprio 3
M_rp24:
    s_cmp_lt_u32 s49, s48
    s_cbranch_scc0 M_wend
    s_waitcnt vmcnt(12)
    ds_read_b32 v47, v3 offset:524
    v_mfma_f32_32x32x16_bf16 v[80:95], v[8:11], v[20:23], 0
    ds_read_b128 v[20:23], v1 offset:2048
    s_add_u32 s77, s49, 1
    s_cmp_lt_u32 s77, s48
    s_cselect_b32 s77, 0, 0x40000000
    v_mfma_f32_32x32x16_bf16 v[64:79], v[48:51], v[24:27], 0
    ds_read_b128 v[24:27], v1 offset:3072
    v_mfma_f32_32x32x16_bf16 v[64:79], v[52:55], v[28:31], v[64:79]
    ds_read_b128 v[28:31], v1 offset:25600
    v_bfe_u32 v46, v1, 9, 1
    s_waitcnt lgkmcnt(3)
    v_lshrrev_b32 v47, 2, v47
    v_lshl_add_u32 v47, v46, 6, v47
    buffer_load_dwordx4 v[32:35], v47, s[72:75], s77 offen offset:0
    buffer_load_dwordx4 v[36:39], v47, s[72:75], s77 offen offset:16
    buffer_load_dwordx4 v[40:43], v47, s[72:75], s77 offen offset:32
    buffer_load_dwordx4 v[44:47], v47, s[72:75], s77 offen offset:48
    s_waitcnt lgkmcnt(2)
    v_mfma_f32_32x32x16_bf16 v[64:79], v[56:59], v[20:23], v[64:79]
    ds_read_b128 v[20:23], v1 offset:4096
    s_waitcnt lgkmcnt(2)
    v_mfma_f32_32x32x16_bf16 v[64:79], v[60:63], v[24:27], v[64:79]
    ds_read_b128 v[24:27], v1 offset:5120
    s_waitcnt lgkmcnt(2)
    v_mfma_f32_32x32x16_bf16 v[112:127], v[8:11], v[28:31], 0
    ds_read_b128 v[28:31], v1 offset:6144
    s_waitcnt lgkmcnt(2)
    v_mfma_f32_32x32x16_bf16 v[96:111], v[48:51], v[20:23], 0
    ds_read_b128 v[20:23], v1 offset:7168
    s_nop 4
    v_mul_f32 v64, v64, v80
    v_mul_f32 v65, v65, v81
    v_mul_f32 v66, v66, v82
    v_mul_f32 v67, v67, v83
    v_mul_f32 v68, v68, v84
    v_mul_f32 v69, v69, v85
    s_waitcnt lgkmcnt(2)
    v_mfma_f32_32x32x16_bf16 v[96:111], v[52:55], v[24:27], v[96:111]
    ds_read_b128 v[24:27], v1 offset:26624
    v_mul_f32 v70, v70, v86
    v_mul_f32 v71, v71, v87
    v_mul_f32 v72, v72, v88
    v_mul_f32 v73, v73, v89
    v_mul_f32 v74, v74, v90
    v_mul_f32 v75, v75, v91
    v_mul_f32 v76, v76, v92
    s_waitcnt lgkmcnt(2)
    v_mfma_f32_32x32x16_bf16 v[96:111], v[56:59], v[28:31], v[96:111]
    ds_read_b128 v[28:31], v1 offset:8192
    v_mul_f32 v77, v77, v93
    v_mul_f32 v78, v78, v94
    v_mul_f32 v79, v79, v95
    v_cvt_pk_bf16_f32 v64, v64, v65
    v_cvt_pk_bf16_f32 v65, v66, v67
    v_cvt_pk_bf16_f32 v66, v68, v69
    s_waitcnt lgkmcnt(2)
    v_mfma_f32_32x32x16_bf16 v[96:111], v[60:63], v[20:23], v[96:111]
    ds_read_b128 v[20:23], v1 offset:9216
    v_cvt_pk_bf16_f32 v67, v70, v71
    v_cvt_pk_bf16_f32 v68, v72, v73
    v_cvt_pk_bf16_f32 v69, v74, v75
    v_cvt_pk_bf16_f32 v70, v76, v77
    v_cvt_pk_bf16_f32 v71, v78, v79
    v_mfma_f32_32x32x16_bf16 v[128:143], v[12:15], v[64:67], v[128:143]
    s_nop 0
    v_mfma_f32_32x32x16_bf16 v[128:143], v[16:19], v[68:71], v[128:143]
    s_waitcnt lgkmcnt(2)
    v_mfma_f32_32x32x16_bf16 v[80:95], v[8:11], v[24:27], 0
    ds_read_b128 v[24:27], v1 offset:10240
    s_waitcnt lgkmcnt(2)
    v_mfma_f32_32x32x16_bf16 v[64:79], v[48:51], v[28:31], 0
    ds_read_b128 v[28:31], v1 offset:11264
    v_mul_f32 v96, v96, v112
    v_mul_f32 v97, v97, v113
    v_mul_f32 v98, v98, v114
    v_mul_f32 v99, v99, v115
    v_mul_f32 v100, v100, v116
    v_mul_f32 v101, v101, v117
    s_waitcnt lgkmcnt(2)
    v_mfma_f32_32x32x16_bf16 v[64:79], v[52:55], v[20:23], v[64:79]
    ds_read_b128 v[20:23], v1 offset:27648
    v_mul_f32 v102, v102, v118
    v_mul_f32 v103, v103, v119
    v_mul_f32 v104, v104, v120
    v_mul_f32 v105, v105, v121
    v_mul_f32 v106, v106, v122
    v_mul_f32 v107, v107, v123
    v_mul_f32 v108, v108, v124
    s_waitcnt lgkmcnt(2)
    v_mfma_f32_32x32x16_bf16 v[64:79], v[56:59], v[24:27], v[64:79]
    ds_read_b128 v[24:27], v1 offset:12288
    v_mul_f32 v109, v109, v125
    v_mul_f32 v110, v110, v126
    v_mul_f32 v111, v111, v127
    v_cvt_pk_bf16_f32 v96, v96, v97
    v_cvt_pk_bf16_f32 v97, v98, v99
    v_cvt_pk_bf16_f32 v98, v100, v101
    s_waitcnt lgkmcnt(2)
    v_mfma_f32_32x32x16_bf16 v[64:79], v[60:63], v[28:31], v[64:79]
    ds_read_b128 v[28:31], v1 offset:13312
    v_cvt_pk_bf16_f32 v99, v102, v103
    v_cvt_pk_bf16_f32 v100, v104, v105
    v_cvt_pk_bf16_f32 v101, v106, v107
    v_cvt_pk_bf16_f32 v102, v108, v109
    v_cvt_pk_bf16_f32 v103, v110, v111
    v_mfma_f32_32x32x16_bf16 v[144:159], v[12:15], v[96:99], v[144:159]
    s_nop 0
    v_mfma_f32_32x32x16_bf16 v[144:159], v[16:19], v[100:103], v[144:159]
    s_waitcnt lgkmcnt(2)
    v_mfma_f32_32x32x16_bf16 v[112:127], v[8:11], v[20:23], 0
    ds_read_b128 v[20:23], v1 offset:14336
    s_waitcnt lgkmcnt(2)
    v_mfma_f32_32x32x16_bf16 v[96:111], v[48:51], v[24:27], 0
    ds_read_b128 v[24:27], v1 offset:15360
    v_mul_f32 v64, v64, v80
    v_mul_f32 v65, v65, v81
    v_mul_f32 v66, v66, v82
    v_mul_f32 v67, v67, v83
    v_mul_f32 v68, v68, v84
    v_mul_f32 v69, v69, v85
    v_mul_f32 v70, v70, v86
    v_mul_f32 v71, v71, v87
    v_mul_f32 v72, v72, v88
    v_mul_f32 v73, v73, v89
    v_mul_f32 v74, v74, v90
    v_mul_f32 v75, v75, v91
    v_mul_f32 v76, v76, v92
    v_mul_f32 v77, v77, v93
    v_mul_f32 v78, v78, v94
    v_mul_f32 v79, v79, v95
    s_waitcnt vmcnt(4)
    ds_read_u16_d16_hi v80, v2 offset:0
    ds_read_u16_d16_hi v81, v2 offset:256
    ds_read_u16_d16_hi v82, v2 offset:512
    ds_read_u16_d16_hi v83, v2 offset:768
    ds_read_u16_d16_hi v84, v2 offset:3072
    ds_read_u16_d16_hi v85, v2 offset:3328
    ds_read_u16_d16_hi v86, v2 offset:3584
    ds_read_u16_d16_hi v87, v2 offset:3840
WUP_3314:
    s_cbranch_execz WUR_1
    ds_read_u16_d16_hi v88, v2 offset:6144
    ds_read_u16_d16_hi v89, v2 offset:6400
    ds_read_u16_d16_hi v90, v2 offset:6656
    ds_read_u16_d16_hi v91, v2 offset:6912
    ds_read_u16_d16_hi v92, v2 offset:9216
    ds_read_u16_d16_hi v93, v2 offset:9472
    ds_read_u16_d16_hi v94, v2 offset:9728
    ds_read_u16_d16_hi v95, v2 offset:9984
    s_waitcnt lgkmcnt(8)
    v_mul_f32 v80, v80, v64
    v_mul_f32 v81, v81, v65
    v_mul_f32 v82, v82, v66
    v_mul_f32 v83, v83, v67
    v_mul_f32 v84, v84, v68
    v_mul_f32 v85, v85, v69
    v_mfma_f32_32x32x16_bf16 v[96:111], v[52:55], v[28:31], v[96:111]
    ds_read_b128 v[28:31], v1 offset:28672
    v_mul_f32 v86, v86, v70
    v_mul_f32 v87, v87, v71
    v_cvt_pk_bf16_f32 v80, v80, v81
    v_cvt_pk_bf16_f32 v81, v82, v83
    v_cvt_pk_bf16_f32 v82, v84, v85
    v_cvt_pk_bf16_f32 v83, v86, v87
    s_waitcnt lgkmcnt(1)
    v_mul_f32 v88, v88, v72
    v_mul_f32 v89, v89, v73
    v_mfma_f32_32x32x16_bf16 v[160:175], v[12:15], v[80:83], v[160:175]
    ds_read_u16_d16_hi v80, v2 offset:1024
    ds_read_u16_d16_hi v81, v2 offset:1280
    ds_read_u16_d16_hi v82, v2 offset:1536
    ds_read_u16_d16_hi v83, v2 offset:1792
    ds_read_u16_d16_hi v84, v2 offset:4096
    ds_read_u16_d16_hi v85, v2 offset:4352
    ds_read_u16_d16_hi v86, v2 offset:4608
    ds_read_u16_d16_hi v87, v2 offset:4864
    v_mul_f32 v90, v90, v74
    v_mul_f32 v91, v91, v75
    v_mul_f32 v92, v92, v76
    v_mul_f32 v93, v93, v77
    v_mul_f32 v94, v94, v78
    v_mul_f32 v95, v95, v79
    v_cvt_pk_bf16_f32 v88, v88, v89
    v_cvt_pk_bf16_f32 v89, v90, v91
    v_cvt_pk_bf16_f32 v90, v92, v93
    v_cvt_pk_bf16_f32 v91, v94, v95
    s_waitcnt lgkmcnt(0)
    v_mul_f32 v80, v80, v64
    v_mul_f32 v81, v81, v65
    v_mfma_f32_32x32x16_bf16 v[160:175], v[16:19], v[88:91], v[160:175]
    ds_read_u16_d16_hi v88, v2 offset:7168
    ds_read_u16_d16_hi v89, v2 offset:7424
    ds_read_u16_d16_hi v90, v2 offset:7680
    ds_read_u16_d16_hi v91, v2 offset:7936
    ds_read_u16_d16_hi v92, v2 offset:10240
    ds_read_u16_d16_hi v93, v2 offset:10496
    ds_read_u16_d16_hi v94, v2 offset:10752
    ds_read_u16_d16_hi v95, v2 offset:11008
    v_mul_f32 v82, v82, v66
    v_mfma_f32_32x32x16_bf16 v[96:111], v[56:59], v[20:23], v[96:111]
    ds_read_b128 v[20:23], v1 offset:16384
    v_mul_f32 v83, v83, v67
    v_mul_f32 v84, v84, v68
    v_mul_f32 v85, v85, v69
    v_mul_f32 v86, v86, v70
    v_mul_f32 v87, v87, v71
    v_cvt_pk_bf16_f32 v80, v80, v81
    v_cvt_pk_bf16_f32 v81, v82, v83
    v_cvt_pk_bf16_f32 v82, v84, v85
    v_cvt_pk_bf16_f32 v83, v86, v87
    s_waitcnt lgkmcnt(1)
    v_mul_f32 v88, v88, v72
    v_mul_f32 v89, v89, v73
    v_mfma_f32_32x32x16_bf16 v[192:207], v[12:15], v[80:83], v[192:207]
    ds_read_u16_d16_hi v80, v2 offset:2048
    ds_read_u16_d16_hi v81, v2 offset:2304
    ds_read_u16_d16_hi v82, v2 offset:2560
    ds_read_u16_d16_hi v83, v2 offset:2816
    ds_read_u16_d16_hi v84, v2 offset:5120
    ds_read_u16_d16_hi v85, v2 offset:5376
    ds_read_u16_d16_hi v86, v2 offset:5632
    ds_read_u16_d16_hi v87, v2 offset:5888
    v_mul_f32 v90, v90, v74
    v_mul_f32 v91, v91, v75
    v_mul_f32 v92, v92, v76
    v_mul_f32 v93, v93, v77
    v_mul_f32 v94, v94, v78
    v_mul_f32 v95, v95, v79
    v_cvt_pk_bf16_f32 v88, v88, v89
    v_cvt_pk_bf16_f32 v89, v90, v91
    v_cvt_pk_bf16_f32 v90, v92, v93
    v_cvt_pk_bf16_f32 v91, v94, v95
    s_waitcnt lgkmcnt(0)
    v_mul_f32 v80, v80, v64
    v_mul_f32 v81, v81, v65
    v_mfma_f32_32x32x16_bf16 v[96:111], v[60:63], v[24:27], v[96:111]
    ds_read_b128 v[24:27], v1 offset:17408
    v_mfma_f32_32x32x16_bf16 v[192:207], v[16:19], v[88:91], v[192:207]
    ds_read_u16_d16_hi v88, v2 offset:8192
    ds_read_u16_d16_hi v89, v2 offset:8448
    ds_read_u16_d16_hi v90, v2 offset:8704
    ds_read_u16_d16_hi v91, v2 offset:8960
    ds_read_u16_d16_hi v92, v2 offset:11264
    ds_read_u16_d16_hi v93, v2 offset:11520
    ds_read_u16_d16_hi v94, v2 offset:11776
    ds_read_u16_d16_hi v95, v2 offset:12032
    v_mul_f32 v82, v82, v66
    v_mul_f32 v83, v83, v67
    v_mul_f32 v84, v84, v68
    v_mul_f32 v85, v85, v69
    v_mul_f32 v86, v86, v70
    v_mul_f32 v87, v87, v71
    v_cvt_pk_bf16_f32 v80, v80, v81
    v_cvt_pk_bf16_f32 v81, v82, v83
    v_cvt_pk_bf16_f32 v82, v84, v85
    v_cvt_pk_bf16_f32 v83, v86, v87
    s_waitcnt lgkmcnt(0)
    v_mul_f32 v88, v88, v72
    v_mul_f32 v89, v89, v73
    v_mfma_f32_32x32x16_bf16 v[224:239], v[12:15], v[80:83], v[224:239]
    v_mul_f32 v90, v90, v74
    v_mul_f32 v91, v91, v75
    v_mul_f32 v92, v92, v76
    v_mul_f32 v93, v93, v77
    v_mul_f32 v94, v94, v78
    v_mul_f32 v95, v95, v79
    v_cvt_pk_bf16_f32 v88, v88, v89
    v_cvt_pk_bf16_f32 v89, v90, v91
    v_cvt_pk_bf16_f32 v90, v92, v93
    v_cvt_pk_bf16_f32 v91, v94, v95
    s_nop 1
    v_mfma_f32_32x32x16_bf16 v[224:239], v[16:19], v[88:91], v[224:239]
    v_mfma_f32_32x32x16_bf16 v[80:95], v[8:11], v[28:31], 0
    ds_read_b128 v[28:31], v1 offset:18432
    v_mfma_f32_32x32x16_bf16 v[64:79], v[48:51], v[20:23], 0
    ds_read_b128 v[20:23], v1 offset:19456
    v_mul_f32 v96, v96, v112
    v_mul_f32 v97, v97, v113
    v_mul_f32 v98, v98, v114
    v_mul_f32 v99, v99, v115
    v_mul_f32 v100, v100, v116
    v_mul_f32 v101, v101, v117
    v_mul_f32 v102, v102, v118
    v_mul_f32 v103, v103, v119
    v_mul_f32 v104, v104, v120
    v_mul_f32 v105, v105, v121
    v_mul_f32 v106, v106, v122
    v_mul_f32 v107, v107, v123
    v_mul_f32 v108, v108, v124
    v_mul_f32 v109, v109, v125
    v_mul_f32 v110, v110, v126
    v_mul_f32 v111, v111, v127
    ds_read_u16_d16_hi v112, v2 offset:2
    ds_read_u16_d16_hi v113, v2 offset:258
    ds_read_u16_d16_hi v114, v2 offset:514
    ds_read_u16_d16_hi v115, v2 offset:770
    ds_read_u16_d16_hi v116, v2 offset:3074
    ds_read_u16_d16_hi v117, v2 offset:3330
    ds_read_u16_d16_hi v118, v2 offset:3586
    ds_read_u16_d16_hi v119, v2 offset:3842
    ds_read_u16_d16_hi v120, v2 offset:6146
    ds_read_u16_d16_hi v121, v2 offset:6402
    ds_read_u16_d16_hi v122, v2 offset:6658
    ds_read_u16_d16_hi v123, v2 offset:6914
    ds_read_u16_d16_hi v124, v2 offset:9218
    ds_read_u16_d16_hi v125, v2 offset:9474
    ds_read_u16_d16_hi v126, v2 offset:9730
    ds_read_u16_d16_hi v127, v2 offset:9986
    s_waitcnt lgkmcnt(8)
    v_mul_f32 v112, v112, v96
    v_mul_f32 v113, v113, v97
    v_mul_f32 v114, v114, v98
    v_mul_f32 v115, v115, v99
    v_mul_f32 v116, v116, v100
    v_mul_f32 v117, v117, v101
    v_mul_f32 v118, v118, v102
    v_mfma_f32_32x32x16_bf16 v[64:79], v[52:55], v[24:27], v[64:79]
    ds_read_b128 v[24:27], v1 offset:29696
    v_mul_f32 v119, v119, v103
    v_cvt_pk_bf16_f32 v112, v112, v113
    v_cvt_pk_bf16_f32 v113, v114, v115
    v_cvt_pk_bf16_f32 v114, v116, v117
    v_cvt_pk_bf16_f32 v115, v118, v119
    s_waitcnt lgkmcnt(1)
    v_mul_f32 v120, v120, v104
    v_mul_f32 v121, v121, v105
    v_mfma_f32_32x32x16_bf16 v[176:191], v[12:15], v[112:115], v[176:191]
    ds_read_u16_d16_hi v112, v2 offset:1026
    ds_read_u16_d16_hi v113, v2 offset:1282
    ds_read_u16_d16_hi v114, v2 offset:1538
    ds_read_u16_d16_hi v115, v2 offset:1794
    ds_read_u16_d16_hi v116, v2 offset:4098
    ds_read_u16_d16_hi v117, v2 offset:4354
    ds_read_u16_d16_hi v118, v2 offset:4610
    ds_read_u16_d16_hi v119, v2 offset:4866
    v_mul_f32 v122, v122, v106
    v_mul_f32 v123, v123, v107
    v_mul_f32 v124, v124, v108
    v_mul_f32 v125, v125, v109
    v_mul_f32 v126, v126, v110
    v_mul_f32 v127, v127, v111
    v_cvt_pk_bf16_f32 v120, v120, v121
    v_cvt_pk_bf16_f32 v121, v122, v123
    v_cvt_pk_bf16_f32 v122, v124, v125
    v_cvt_pk_bf16_f32 v123, v126, v127
    s_waitcnt lgkmcnt(0)
    v_mul_f32 v112, v112, v96
    v_mul_f32 v113, v113, v97
    v_mfma_f32_32x32x16_bf16 v[176:191], v[16:19], v[120:123], v[176:191]
    ds_read_u16_d16_hi v120, v2 offset:7170
    ds_read_u16_d16_hi v121, v2 offset:7426
    ds_read_u16_d16_hi v122, v2 offset:7682
    ds_read_u16_d16_hi v123, v2 offset:7938
    ds_read_u16_d16_hi v124, v2 offset:10242
    ds_read_u16_d16_hi v125, v2 offset:10498
    ds_read_u16_d16_hi v126, v2 offset:10754
    ds_read_u16_d16_hi v127, v2 offset:11010
    v_mul_f32 v114, v114, v98
    v_mul_f32 v115, v115, v99
    v_mfma_f32_32x32x16_bf16 v[64:79], v[56:59], v[28:31], v[64:79]
    ds_read_b128 v[28:31], v1 offset:20480
    v_mul_f32 v116, v116, v100
    v_mul_f32 v117, v117, v101
    v_mul_f32 v118, v118, v102
    v_mul_f32 v119, v119, v103
    v_cvt_pk_bf16_f32 v112, v112, v113
    v_cvt_pk_bf16_f32 v113, v114, v115
    v_cvt_pk_bf16_f32 v114, v116, v117
    v_cvt_pk_bf16_f32 v115, v118, v119
    s_waitcnt lgkmcnt(1)
    v_mul_f32 v120, v120, v104
    v_mul_f32 v121, v121, v105
    v_mfma_f32_32x32x16_bf16 v[208:223], v[12:15], v[112:115], v[208:223]
    ds_read_u16_d16_hi v112, v2 offset:2050
    ds_read_u16_d16_hi v113, v2 offset:2306
    ds_read_u16_d16_hi v114, v2 offset:2562
    ds_read_u16_d16_hi v115, v2 offset:2818
    ds_read_u16_d16_hi v116, v2 offset:5122
    ds_read_u16_d16_hi v117, v2 offset:5378
    ds_read_u16_d16_hi v118, v2 offset:5634
    ds_read_u16_d16_hi v119, v2 offset:5890
    v_mul_f32 v122, v122, v106
    v_mul_f32 v123, v123, v107
    v_mul_f32 v124, v124, v108
    v_mul_f32 v125, v125, v109
    v_mul_f32 v126, v126, v110
    v_mul_f32 v127, v127, v111
    v_cvt_pk_bf16_f32 v120, v120, v121
    v_cvt_pk_bf16_f32 v121, v122, v123
    v_cvt_pk_bf16_f32 v122, v124, v125
    v_cvt_pk_bf16_f32 v123, v126, v127
    s_waitcnt lgkmcnt(0)
    v_mul_f32 v112, v112, v96
    v_mul_f32 v113, v113, v97
    v_mfma_f32_32x32x16_bf16 v[208:223], v[16:19], v[120:123], v[208:223]
    v_mfma_f32_32x32x16_bf16 v[64:79], v[60:63], v[20:23], v[64:79]
    ds_read_b128 v[20:23], v1 offset:21504
    ds_read_u16_d16_hi v120, v2 offset:8194
    ds_read_u16_d16_hi v121, v2 offset:8450
    ds_read_u16_d16_hi v122, v2 offset:8706
    ds_read_u16_d16_hi v123, v2 offset:8962
    ds_read_u16_d16_hi v124, v2 offset:11266
    ds_read_u16_d16_hi v125, v2 offset:11522
    ds_read_u16_d16_hi v126, v2 offset:11778
    ds_read_u16_d16_hi v127, v2 offset:12034
    v_mul_f32 v114, v114, v98
    v_mul_f32 v115, v115, v99
    v_mul_f32 v116, v116, v100
    v_mul_f32 v117, v117, v101
    v_mul_f32 v118, v118, v102
    v_mul_f32 v119, v119, v103
    v_cvt_pk_bf16_f32 v112, v112, v113
    v_cvt_pk_bf16_f32 v113, v114, v115
    v_cvt_pk_bf16_f32 v114, v116, v117
    v_cvt_pk_bf16_f32 v115, v118, v119
    s_waitcnt lgkmcnt(0)
    v_mul_f32 v120, v120, v104
    v_mul_f32 v121, v121, v105
    v_mfma_f32_32x32x16_bf16 v[240:255], v[12:15], v[112:115], v[240:255]
    ds_read_b32 v112, v5 offset:524
    ds_read_b32 v113, v5 offset:652
    ds_read_b32 v114, v5 offset:780
    ds_read_b32 v115, v5 offset:908
    v_mul_f32 v122, v122, v106
    v_mul_f32 v123, v123, v107
    v_mul_f32 v124, v124, v108
    v_mul_f32 v125, v125, v109
    v_mul_f32 v126, v126, v110
    v_mul_f32 v127, v127, v111
    v_cvt_pk_bf16_f32 v120, v120, v121
    v_cvt_pk_bf16_f32 v121, v122, v123
    v_cvt_pk_bf16_f32 v122, v124, v125
    v_cvt_pk_bf16_f32 v123, v126, v127
    s_nop 1
    v_mfma_f32_32x32x16_bf16 v[240:255], v[16:19], v[120:123], v[240:255]
    s_cmp_lg_u32 s77, 0
    s_cbranch_scc1 M_nv25
    s_add_u32 m0, s51, 0
    s_waitcnt lgkmcnt(3)
    v_and_or_b32 v112, v1, s63, v112
    buffer_load_dwordx4 v112, s[28:31], s64 offen offset:0 lds
    buffer_load_dwordx4 v112, s[28:31], s65 offen offset:1024 lds
    buffer_load_dwordx4 v112, s[28:31], s66 offen offset:2048 lds
    s_add_u32 m0, s51, 3072
    s_waitcnt lgkmcnt(2)
    v_and_or_b32 v113, v1, s63, v113
    buffer_load_dwordx4 v113, s[28:31], s64 offen offset:0 lds
    buffer_load_dwordx4 v113, s[28:31], s65 offen offset:1024 lds
    buffer_load_dwordx4 v113, s[28:31], s66 offen offset:2048 lds
    s_add_u32 m0, s51, 6144
    s_waitcnt lgkmcnt(1)
    v_and_or_b32 v114, v1, s63, v114
    buffer_load_dwordx4 v114, s[28:31], s64 offen offset:0 lds
    buffer_load_dwordx4 v114, s[28:31], s65 offen offset:1024 lds
    buffer_load_dwordx4 v114, s[28:31], s66 offen offset:2048 lds
    s_add_u32 m0, s51, 9216
    s_waitcnt lgkmcnt(0)
    v_and_or_b32 v115, v1, s63, v115
    buffer_load_dwordx4 v115, s[28:31], s64 offen offset:0 lds
    buffer_load_dwordx4 v115, s[28:31], s65 offen offset:1024 lds
    buffer_load_dwordx4 v115, s[28:31], s66 offen offset:2048 lds
M_nv25:
    s_waitcnt lgkmcnt(0)
    v_mfma_f32_32x32x16_bf16 v[112:127], v[8:11], v[24:27], 0
    ds_read_b128 v[24:27], v1 offset:22528
    v_mfma_f32_32x32x16_bf16 v[96:111], v[48:51], v[28:31], 0
    ds_read_b128 v[28:31], v1 offset:23552
    v_mul_f32 v64, v64, v80
    v_mul_f32 v65, v65, v81
    v_mul_f32 v66, v66, v82
    v_mul_f32 v67, v67, v83
    v_mul_f32 v68, v68, v84
    v_mul_f32 v69, v69, v85
    v_mul_f32 v70, v70, v86
    v_mul_f32 v71, v71, v87
    v_mul_f32 v72, v72, v88
    v_mul_f32 v73, v73, v89
    v_mul_f32 v74, v74, v90
    v_mul_f32 v75, v75, v91
    v_mfma_f32_32x32x16_bf16 v[96:111], v[52:55], v[20:23], v[96:111]
    v_mul_f32 v76, v76, v92
    v_mul_f32 v77, v77, v93
    v_mul_f32 v78, v78, v94
    v_mul_f32 v79, v79, v95
    ds_read_b64 v[80:81], v0 offset:2080
    ds_read_b64 v[88:89], v0 offset:2088
    ds_read_b64 v[82:83], v0 offset:2192
    ds_read_b64 v[90:91], v0 offset:2200
    ds_read_b64 v[84:85], v0 offset:2304
    ds_read_b64 v[92:93], v0 offset:2312
    ds_read_b64 v[86:87], v0 offset:2416
    ds_read_b64 v[94:95], v0 offset:2424
    v_cvt_pk_bf16_f32 v64, v64, v65
    v_cvt_pk_bf16_f32 v65, v66, v67
    v_cvt_pk_bf16_f32 v66, v68, v69
    v_cvt_pk_bf16_f32 v67, v70, v71
    v_cvt_pk_bf16_f32 v68, v72, v73
    v_cvt_pk_bf16_f32 v69, v74, v75
    v_cvt_pk_bf16_f32 v70, v76, v77
    s_waitcnt lgkmcnt(9)
    v_mfma_f32_32x32x16_bf16 v[96:111], v[56:59], v[24:27], v[96:111]
    v_cvt_pk_bf16_f32 v71, v78, v79
    v_pk_lshrrev_b16 v72, 14, v12 op_sel_hi:[0,1]
    v_pk_lshrrev_b16 v73, 14, v13 op_sel_hi:[0,1]
    v_pk_lshrrev_b16 v74, 14, v14 op_sel_hi:[0,1]
    v_pk_lshrrev_b16 v75, 14, v15 op_sel_hi:[0,1]
    v_pk_lshrrev_b16 v76, 14, v16 op_sel_hi:[0,1]
    v_pk_lshrrev_b16 v77, 14, v17 op_sel_hi:[0,1]
    v_pk_lshrrev_b16 v78, 14, v18 op_sel_hi:[0,1]
    v_pk_lshrrev_b16 v79, 14, v19 op_sel_hi:[0,1]
    s_waitcnt lgkmcnt(0)
    v_pk_mul_lo_u16 v80, v72, v80
    v_pk_mul_lo_u16 v81, v73, v81
    v_pk_mul_lo_u16 v82, v74, v82
    v_mfma_f32_32x32x16_bf16 v[96:111], v[60:63], v[28:31], v[96:111]
    v_pk_mul_lo_u16 v83, v75, v83
    v_pk_mul_lo_u16 v84, v76, v84
    v_pk_mul_lo_u16 v85, v77, v85
    v_pk_mul_lo_u16 v86, v78, v86
    v_pk_mul_lo_u16 v87, v79, v87
    v_pk_mul_lo_u16 v88, v72, v88
    v_pk_mul_lo_u16 v89, v73, v89
    v_pk_mul_lo_u16 v90, v74, v90
    v_pk_mul_lo_u16 v91, v75, v91
    v_pk_mul_lo_u16 v92, v76, v92
    v_pk_mul_lo_u16 v93, v77, v93
    v_pk_mul_lo_u16 v94, v78, v94
    v_pk_mul_lo_u16 v95, v79, v95
    v_mfma_f32_32x32x16_bf16 v[160:175], v[80:83], v[64:67], v[160:175]
    ds_read_b128 v[48:51], v3 offset:512
    ds_read_b128 v[52:55], v7
    ds_read_b128 v[56:59], v7 offset:16
    ds_read_b64 v[12:13], v4 offset:2496
    ds_read_b64 v[14:15], v4 offset:2608
    ds_read_b64 v[16:17], v4 offset:2720
    ds_read_b64 v[18:19], v4 offset:2832
    ds_read_b128 v[20:23], v1 offset:24576
    ds_read_b128 v[24:27], v1 offset:0
    ds_read_b128 v[28:31], v1 offset:1024
    v_mul_f32 v96, v96, v112
    v_mul_f32 v97, v97, v113
    v_mul_f32 v98, v98, v114
    v_mul_f32 v99, v99, v115
    v_mul_f32 v100, v100, v116
    v_mfma_f32_32x32x16_bf16 v[160:175], v[84:87], v[68:71], v[160:175]
    v_mul_f32 v101, v101, v117
    v_mul_f32 v102, v102, v118
    v_mul_f32 v103, v103, v119
    v_mul_f32 v104, v104, v120
    v_mul_f32 v105, v105, v121
    v_mul_f32 v106, v106, v122
    v_mul_f32 v107, v107, v123
    v_mfma_f32_32x32x16_bf16 v[192:207], v[88:91], v[64:67], v[192:207]
    v_mul_f32 v108, v108, v124
    v_mul_f32 v109, v109, v125
    v_mul_f32 v110, v110, v126
    v_mul_f32 v111, v111, v127
    ds_read_b64 v[112:113], v0 offset:2096
    ds_read_b64 v[114:115], v0 offset:2208
    ds_read_b64 v[116:117], v0 offset:2320
    ds_read_b64 v[118:119], v0 offset:2432
    v_cvt_pk_bf16_f32 v96, v96, v97
    v_mfma_f32_32x32x16_bf16 v[192:207], v[92:95], v[68:71], v[192:207]
    v_cvt_pk_bf16_f32 v97, v98, v99
    v_cvt_pk_bf16_f32 v98, v100, v101
    v_cvt_pk_bf16_f32 v99, v102, v103
    v_cvt_pk_bf16_f32 v100, v104, v105
    v_cvt_pk_bf16_f32 v101, v106, v107
    v_cvt_pk_bf16_f32 v102, v108, v109
    v_cvt_pk_bf16_f32 v103, v110, v111
    s_waitcnt lgkmcnt(0)
    v_pk_mul_lo_u16 v112, v72, v112
    v_pk_mul_lo_u16 v113, v73, v113
    v_pk_mul_lo_u16 v114, v74, v114
    v_pk_mul_lo_u16 v115, v75, v115
    v_pk_mul_lo_u16 v116, v76, v116
    v_pk_mul_lo_u16 v117, v77, v117
    v_pk_mul_lo_u16 v118, v78, v118
    v_pk_mul_lo_u16 v119, v79, v119
    v_mfma_f32_32x32x16_bf16 v[176:191], v[80:83], v[96:99], v[176:191]
    v_mul_f32 v52, v48, v52
    v_mul_f32 v53, v48, v53
    v_mul_f32 v54, v48, v54
    v_mul_f32 v55, v48, v55
    v_mul_f32 v56, v48, v56
    v_mul_f32 v57, v48, v57
    v_mfma_f32_32x32x16_bf16 v[176:191], v[84:87], v[100:103], v[176:191]
    v_mul_f32 v58, v48, v58
    v_mul_f32 v59, v48, v59
    v_cvt_pk_bf16_f32 v52, 0, v52
    v_cvt_pk_bf16_f32 v53, 0, v53
    v_cvt_pk_bf16_f32 v54, 0, v54
    v_cvt_pk_bf16_f32 v55, 0, v55
    v_cvt_pk_bf16_f32 v56, 0, v56
    v_mfma_f32_32x32x16_bf16 v[208:223], v[88:91], v[96:99], v[208:223]
    v_cvt_pk_bf16_f32 v57, 0, v57
    v_cvt_pk_bf16_f32 v58, 0, v58
    v_cvt_pk_bf16_f32 v59, 0, v59
    v_mul_f32 v52, s61, v52
    v_mul_f32 v53, s61, v53
    v_mul_f32 v54, s61, v54
    v_mfma_f32_32x32x16_bf16 v[208:223], v[92:95], v[100:103], v[208:223]
    v_mul_f32 v55, s61, v55
    v_mul_f32 v56, s61, v56
    v_mul_f32 v57, s61, v57
    v_mul_f32 v58, s61, v58
    v_mul_f32 v59, s61, v59
    v_sin_f32 v52, v52
    v_sin_f32 v53, v53
    v_mfma_f32_32x32x16_bf16 v[224:239], v[112:115], v[64:67], v[224:239]
    v_sin_f32 v54, v54
    v_sin_f32 v55, v55
    v_sin_f32 v56, v56
    v_sin_f32 v57, v57
    v_sin_f32 v58, v58
    v_sin_f32 v59, v59
    v_mfma_f32_32x32x16_bf16 v[240:255], v[112:115], v[96:99], v[240:255]
    v_mul_f32 v52, v52, v49
    v_mul_f32 v53, v53, v49
    v_mul_f32 v54, v54, v49
    v_mul_f32 v55, v55, v49
    v_mul_f32 v56, v56, v49
    v_mul_f32 v57, v57, v49
    v_mul_f32 v58, v58, v49
    v_mfma_f32_32x32x16_bf16 v[224:239], v[116:119], v[68:71], v[224:239]
    v_mul_f32 v59, v59, v49
    v_cvt_pk_bf16_f32 v8, v52, v53
    v_cvt_pk_bf16_f32 v9, v54, v55
    v_cvt_pk_bf16_f32 v10, v56, v57
    v_cvt_pk_bf16_f32 v11, v58, v59
    v_pk_lshlrev_b16 v12, v6, v12
    v_mfma_f32_32x32x16_bf16 v[240:255], v[116:119], v[100:103], v[240:255]
    v_pk_lshlrev_b16 v13, v6, v13
    v_pk_lshlrev_b16 v14, v6, v14
    v_pk_lshlrev_b16 v15, v6, v15
    v_pk_lshlrev_b16 v16, v6, v16
    v_pk_lshlrev_b16 v17, v6, v17
    v_pk_lshlrev_b16 v18, v6, v18
    v_pk_lshlrev_b16 v19, v6, v19
    v_add_u32 v3, 512, v3
    v_add_u32 v4, 448, v4
    v_add_u32 v0, 448, v0
    v_add_u32 v5, 512, v5
    s_waitcnt lgkmcnt(0)
    s_add_u32 s49, s49, 1
    s_sub_u32 s27, s48, s49
    s_cmp_ge_u32 s26, 4
    s_addc_u32 s27, s27, 0
    s_setprio 0
    s_cmp_le_u32 s27, 1
    s_cbranch_scc1 M_rp26
    s_setprio 1
    s_cmp_le_u32 s27, 2
    s_cbranch_scc1 M_rp26
    s_setprio 2
    s_cmp_le_u32 s27, 3
    s_cbranch_scc1 M_rp26
    s_setprio 3
M_rp26:
    s_cmp_lt_u32 s49, s48
    s_cbranch_scc1 M_batch
M_wend:
    s_cmp_eq_u32 s76, 0
    s_cbranch_scc1 M_slow
M_epi:
WUP_3834:
    s_cbranch_execz WUR_1
    v_lshrrev_b32 v8, 4, v1
    v_lshrrev_b32 v10, 5, v8
    v_and_b32 v11, 31, v8
    v_lshlrev_b32 v12, 11, v10
    v_lshl_add_u32 v12, v11, 2, v12
    s_waitcnt vmcnt(0)
    v_cvt_pk_bf16_f32 v64, v128, v144
    v_cvt_pk_bf16_f32 v65, v129, v145
    v_cvt_pk_bf16_f32 v66, v130, v146
    v_cvt_pk_bf16_f32 v67, v131, v147
    v_cvt_pk_bf16_f32 v68, v132, v148
    v_cvt_pk_bf16_f32 v69, v133, v149
    v_cvt_pk_bf16_f32 v70, v134, v150
    v_cvt_pk_bf16_f32 v71, v135, v151
    v_cvt_pk_bf16_f32 v72, v136, v152
    v_cvt_pk_bf16_f32 v73, v137, v153
    v_cvt_pk_bf16_f32 v74, v138, v154
    v_cvt_pk_bf16_f32 v75, v139, v155
    buffer_store_dword v64, v12, s[32:35], s40 offen offset:0 sc1 nt
    buffer_store_dword v65, v12, s[32:35], s40 offen offset:512 sc1 nt
    buffer_store_dword v66, v12, s[32:35], s40 offen offset:1024 sc1 nt
    buffer_store_dword v67, v12, s[32:35], s40 offen offset:1536 sc1 nt
    buffer_store_dword v68, v12, s[32:35], s41 offen offset:0 sc1 nt
    buffer_store_dword v69, v12, s[32:35], s41 offen offset:512 sc1 nt
    buffer_store_dword v70, v12, s[32:35], s41 offen offset:1024 sc1 nt
    buffer_store_dword v71, v12, s[32:35], s41 offen offset:1536 sc1 nt
    buffer_store_dword v72, v12, s[32:35], s42 offen offset:0 sc1 nt
    buffer_store_dword v73, v12, s[32:35], s42 offen offset:512 sc1 nt
    buffer_store_dword v74, v12, s[32:35], s42 offen offset:1024 sc1 nt
    buffer_store_dword v75, v12, s[32:35], s42 offen offset:1536 sc1 nt
    v_cvt_pk_bf16_f32 v80, v160, v176
    v_cvt_pk_bf16_f32 v81, v161, v177
    v_cvt_pk_bf16_f32 v82, v162, v178
    v_cvt_pk_bf16_f32 v83, v163, v179
    v_cvt_pk_bf16_f32 v84, v164, v180
    v_cvt_pk_bf16_f32 v85, v165, v181
    v_cvt_pk_bf16_f32 v86, v166, v182
    v_cvt_pk_bf16_f32 v87, v167, v183
    v_cvt_pk_bf16_f32 v88, v168, v184
    v_cvt_pk_bf16_f32 v89, v169, v185
    v_cvt_pk_bf16_f32 v90, v170, v186
    v_cvt_pk_bf16_f32 v91, v171, v187
    buffer_store_dword v80, v12, s[32:35], s40 offen offset:128 sc1 nt
    buffer_store_dword v81, v12, s[32:35], s40 offen offset:640 sc1 nt
    buffer_store_dword v82, v12, s[32:35], s40 offen offset:1152 sc1 nt
    buffer_store_dword v83, v12, s[32:35], s40 offen offset:1664 sc1 nt
    buffer_store_dword v84, v12, s[32:35], s41 offen offset:128 sc1 nt
    buffer_store_dword v85, v12, s[32:35], s41 offen offset:640 sc1 nt
    buffer_store_dword v86, v12, s[32:35], s41 offen offset:1152 sc1 nt
    buffer_store_dword v87, v12, s[32:35], s41 offen offset:1664 sc1 nt
    buffer_store_dword v88, v12, s[32:35], s42 offen offset:128 sc1 nt
    buffer_store_dword v89, v12, s[32:35], s42 offen offset:640 sc1 nt
    buffer_store_dword v90, v12, s[32:35], s42 offen offset:1152 sc1 nt
    buffer_store_dword v91, v12, s[32:35], s42 offen offset:1664 sc1 nt
    v_cvt_pk_bf16_f32 v96, v192, v208
    v_cvt_pk_bf16_f32 v97, v193, v209
    v_cvt_pk_bf16_f32 v98, v194, v210
    v_cvt_pk_bf16_f32 v99, v195, v211
    v_cvt_pk_bf16_f32 v100, v196, v212
    v_cvt_pk_bf16_f32 v101, v197, v213
    v_cvt_pk_bf16_f32 v102, v198, v214
    v_cvt_pk_bf16_f32 v103, v199, v215
    v_cvt_pk_bf16_f32 v104, v200, v216
    v_cvt_pk_bf16_f32 v105, v201, v217
    v_cvt_pk_bf16_f32 v106, v202, v218
    v_cvt_pk_bf16_f32 v107, v203, v219
    buffer_store_dword v96, v12, s[32:35], s40 offen offset:256 sc1 nt
    buffer_store_dword v97, v12, s[32:35], s40 offen offset:768 sc1 nt
    buffer_store_dword v98, v12, s[32:35], s40 offen offset:1280 sc1 nt
    buffer_store_dword v99, v12, s[32:35], s40 offen offset:1792 sc1 nt
    buffer_store_dword v100, v12, s[32:35], s41 offen offset:256 sc1 nt
    buffer_store_dword v101, v12, s[32:35], s41 offen offset:768 sc1 nt
    buffer_store_dword v102, v12, s[32:35], s41 offen offset:1280 sc1 nt
    buffer_store_dword v103, v12, s[32:35], s41 offen offset:1792 sc1 nt
    buffer_store_dword v104, v12, s[32:35], s42 offen offset:256 sc1 nt
    buffer_store_dword v105, v12, s[32:35], s42 offen offset:768 sc1 nt
    buffer_store_dword v106, v12, s[32:35], s42 offen offset:1280 sc1 nt
    buffer_store_dword v107, v12, s[32:35], s42 offen offset:1792 sc1 nt
    v_cvt_pk_bf16_f32 v112, v224, v240
    v_cvt_pk_bf16_f32 v113, v225, v241
    v_cvt_pk_bf16_f32 v114, v226, v242
    v_cvt_pk_bf16_f32 v115, v227, v243
    v_cvt_pk_bf16_f32 v116, v228, v244
    v_cvt_pk_bf16_f32 v117, v229, v245
    v_cvt_pk_bf16_f32 v118, v230, v246
    v_cvt_pk_bf16_f32 v119, v231, v247
    v_cvt_pk_bf16_f32 v120, v232, v248
    v_cvt_pk_bf16_f32 v121, v233, v249
    v_cvt_pk_bf16_f32 v122, v234, v250
    v_cvt_pk_bf16_f32 v123, v235, v251
    buffer_store_dword v112, v12, s[32:35], s40 offen offset:384 sc1 nt
    buffer_store_dword v113, v12, s[32:35], s40 offen offset:896 sc1 nt
    buffer_store_dword v114, v12, s[32:35], s40 offen offset:1408 sc1 nt
    buffer_store_dword v115, v12, s[32:35], s40 offen offset:1920 sc1 nt
    buffer_store_dword v116, v12, s[32:35], s41 offen offset:384 sc1 nt
    buffer_store_dword v117, v12, s[32:35], s41 offen offset:896 sc1 nt
    buffer_store_dword v118, v12, s[32:35], s41 offen offset:1408 sc1 nt
    buffer_store_dword v119, v12, s[32:35], s41 offen offset:1920 sc1 nt
    buffer_store_dword v120, v12, s[32:35], s42 offen offset:384 sc1 nt
    buffer_store_dword v121, v12, s[32:35], s42 offen offset:896 sc1 nt
    buffer_store_dword v122, v12, s[32:35], s42 offen offset:1408 sc1 nt
    buffer_store_dword v123, v12, s[32:35], s42 offen offset:1920 sc1 nt
    s_cmp_le_u32 s45, 24
    s_cbranch_scc1 M_fin
WUP_3938:
    s_cbranch_execz WUR_1
    v_cvt_pk_bf16_f32 v76, v140, v156
    v_cvt_pk_bf16_f32 v77, v141, v157
    v_cvt_pk_bf16_f32 v78, v142, v158
    v_cvt_pk_bf16_f32 v79, v143, v159
    buffer_store_dword v76, v12, s[32:35], s43 offen offset:0 sc1 nt
    buffer_store_dword v77, v12, s[32:35], s43 offen offset:512 sc1 nt
    buffer_store_dword v78, v12, s[32:35], s43 offen offset:1024 sc1 nt
    buffer_store_dword v79, v12, s[32:35], s43 offen offset:1536 sc1 nt
    v_cvt_pk_bf16_f32 v92, v172, v188
    v_cvt_pk_bf16_f32 v93, v173, v189
    v_cvt_pk_bf16_f32 v94, v174, v190
    v_cvt_pk_bf16_f32 v95, v175, v191
    buffer_store_dword v92, v12, s[32:35], s43 offen offset:128 sc1 nt
    buffer_store_dword v93, v12, s[32:35], s43 offen offset:640 sc1 nt
    buffer_store_dword v94, v12, s[32:35], s43 offen offset:1152 sc1 nt
    buffer_store_dword v95, v12, s[32:35], s43 offen offset:1664 sc1 nt
    v_cvt_pk_bf16_f32 v108, v204, v220
    v_cvt_pk_bf16_f32 v109, v205, v221
    v_cvt_pk_bf16_f32 v110, v206, v222
    v_cvt_pk_bf16_f32 v111, v207, v223
    buffer_store_dword v108, v12, s[32:35], s43 offen offset:256 sc1 nt
    buffer_store_dword v109, v12, s[32:35], s43 offen offset:768 sc1 nt
    buffer_store_dword v110, v12, s[32:35], s43 offen offset:1280 sc1 nt
    buffer_store_dword v111, v12, s[32:35], s43 offen offset:1792 sc1 nt
    v_cvt_pk_bf16_f32 v124, v236, v252
    v_cvt_pk_bf16_f32 v125, v237, v253
    v_cvt_pk_bf16_f32 v126, v238, v254
    v_cvt_pk_bf16_f32 v127, v239, v255
    buffer_store_dword v124, v12, s[32:35], s43 offen offset:384 sc1 nt
    buffer_store_dword v125, v12, s[32:35], s43 offen offset:896 sc1 nt
    buffer_store_dword v126, v12, s[32:35], s43 offen offset:1408 sc1 nt
    buffer_store_dword v127, v12, s[32:35], s43 offen offset:1920 sc1 nt
M_fin:
K_end:
    s_endpgm
P_rare:
    v_mov_b32 v37, 131080
    v_mov_b32 v38, 131076
    s_mul_i32 s27, s2, 32768
    s_add_u32 s27, s27, 0x1100000
    s_lshl_b32 s59, s2, 15
    s_add_u32 s59, s59, 0x8fff84
    s_mov_b64 exec, s[56:57]
    v_cmp_gt_u32 vcc, 31, v76
    s_and_b64 exec, vcc, s[56:57]
    s_nop 3
    s_cbranch_execz P_r10
    ds_write_b32 v12, v92
P_r10:
    s_andn2_b64 exec, s[56:57], vcc
    s_cbranch_execz P_r30
    s_mov_b64 s[14:15], exec
    v_lshlrev_b32 v36, 1, v76
    v_add_u32 v36, 0xfeffffc4, v36
    ds_max_u32 v84, v36 offset:124
    v_cmp_gt_u32 vcc, 63, v76
    s_and_b64 exec, vcc, s[14:15]
    s_nop 3
    s_cbranch_execz P_r20
    v_lshlrev_b32 v124, 7, v68
    v_lshl_add_u32 v124, v76, 2, v124
    buffer_store_dword v92, v124, s[36:39], s59 offen sc1
    s_nop 0
P_r20:
    s_andn2_b64 exec, s[14:15], vcc
    s_cbranch_execz P_r30
    ds_write_b32 v38, v116
    ds_add_rtn_u32 v124, v37, v116
    v_mov_b32 v126, v92
    v_mov_b32 v127, v68
    s_waitcnt lgkmcnt(0)
    v_lshlrev_b32 v124, 3, v124
    buffer_store_dwordx2 v[126:127], v124, s[36:39], s27 offen sc1
    s_nop 0
P_r30:
    s_mov_b64 exec, s[56:57]
    v_cmp_gt_u32 vcc, 31, v77
    s_and_b64 exec, vcc, s[56:57]
    s_nop 3
    s_cbranch_execz P_r11
    ds_write_b32 v13, v93
P_r11:
    s_andn2_b64 exec, s[56:57], vcc
    s_cbranch_execz P_r31
    s_mov_b64 s[14:15], exec
    v_lshlrev_b32 v36, 1, v77
    v_add_u32 v36, 0xfeffffc4, v36
    ds_max_u32 v85, v36 offset:124
    v_cmp_gt_u32 vcc, 63, v77
    s_and_b64 exec, vcc, s[14:15]
    s_nop 3
    s_cbranch_execz P_r21
    v_lshlrev_b32 v124, 7, v69
    v_lshl_add_u32 v124, v77, 2, v124
    buffer_store_dword v93, v124, s[36:39], s59 offen sc1
    s_nop 0
P_r21:
    s_andn2_b64 exec, s[14:15], vcc
    s_cbranch_execz P_r31
    ds_write_b32 v38, v116
    ds_add_rtn_u32 v124, v37, v116
    v_mov_b32 v126, v93
    v_mov_b32 v127, v69
    s_waitcnt lgkmcnt(0)
    v_lshlrev_b32 v124, 3, v124
    buffer_store_dwordx2 v[126:127], v124, s[36:39], s27 offen sc1
    s_nop 0
P_r31:
    s_mov_b64 exec, s[56:57]
    v_cmp_gt_u32 vcc, 31, v78
    s_and_b64 exec, vcc, s[56:57]
    s_nop 3
    s_cbranch_execz P_r12
    ds_write_b32 v14, v94
P_r12:
    s_andn2_b64 exec, s[56:57], vcc
    s_cbranch_execz P_r32
    s_mov_b64 s[14:15], exec
    v_lshlrev_b32 v36, 1, v78
    v_add_u32 v36, 0xfeffffc4, v36
    ds_max_u32 v86, v36 offset:124
    v_cmp_gt_u32 vcc, 63, v78
    s_and_b64 exec, vcc, s[14:15]
    s_nop 3
    s_cbranch_execz P_r22
    v_lshlrev_b32 v124, 7, v70
    v_lshl_add_u32 v124, v78, 2, v124
    buffer_store_dword v94, v124, s[36:39], s59 offen sc1
    s_nop 0
P_r22:
    s_andn2_b64 exec, s[14:15], vcc
    s_cbranch_execz P_r32
    ds_write_b32 v38, v116
    ds_add_rtn_u32 v124, v37, v116
    v_mov_b32 v126, v94
    v_mov_b32 v127, v70
    s_waitcnt lgkmcnt(0)
    v_lshlrev_b32 v124, 3, v124
    buffer_store_dwordx2 v[126:127], v124, s[36:39], s27 offen sc1
    s_nop 0
P_r32:
    s_mov_b64 exec, s[56:57]
    v_cmp_gt_u32 vcc, 31, v79
    s_and_b64 exec, vcc, s[56:57]
    s_nop 3
    s_cbranch_execz P_r13
    ds_write_b32 v15, v95
P_r13:
    s_andn2_b64 exec, s[56:57], vcc
    s_cbranch_execz P_r33
    s_mov_b64 s[14:15], exec
    v_lshlrev_b32 v36, 1, v79
    v_add_u32 v36, 0xfeffffc4, v36
    ds_max_u32 v87, v36 offset:124
    v_cmp_gt_u32 vcc, 63, v79
    s_and_b64 exec, vcc, s[14:15]
    s_nop 3
    s_cbranch_execz P_r23
    v_lshlrev_b32 v124, 7, v71
    v_lshl_add_u32 v124, v79, 2, v124
    buffer_store_dword v95, v124, s[36:39], s59 offen sc1
    s_nop 0
P_r23:
    s_andn2_b64 exec, s[14:15], vcc
    s_cbranch_execz P_r33
    ds_write_b32 v38, v116
    ds_add_rtn_u32 v124, v37, v116
    v_mov_b32 v126, v95
    v_mov_b32 v127, v71
    s_waitcnt lgkmcnt(0)
    v_lshlrev_b32 v124, 3, v124
    buffer_store_dwordx2 v[126:127], v124, s[36:39], s27 offen sc1
    s_nop 0
P_r33:
    s_mov_b64 exec, s[56:57]
    v_cmp_gt_u32 vcc, 31, v80
    s_and_b64 exec, vcc, s[56:57]
    s_nop 3
    s_cbranch_execz P_r14
    ds_write_b32 v16, v96
P_r14:
    s_andn2_b64 exec, s[56:57], vcc
    s_cbranch_execz P_r34
    s_mov_b64 s[14:15], exec
    v_lshlrev_b32 v36, 1, v80
    v_add_u32 v36, 0xfeffffc4, v36
    ds_max_u32 v88, v36 offset:124
    v_cmp_gt_u32 vcc, 63, v80
    s_and_b64 exec, vcc, s[14:15]
    s_nop 3
    s_cbranch_execz P_r24
    v_lshlrev_b32 v124, 7, v72
    v_lshl_add_u32 v124, v80, 2, v124
    buffer_store_dword v96, v124, s[36:39], s59 offen sc1
    s_nop 0
P_r24:
    s_andn2_b64 exec, s[14:15], vcc
    s_cbranch_execz P_r34
    ds_write_b32 v38, v116
    ds_add_rtn_u32 v124, v37, v116
    v_mov_b32 v126, v96
    v_mov_b32 v127, v72
    s_waitcnt lgkmcnt(0)
    v_lshlrev_b32 v124, 3, v124
    buffer_store_dwordx2 v[126:127], v124, s[36:39], s27 offen sc1
    s_nop 0
P_r34:
    s_mov_b64 exec, s[56:57]
    v_cmp_gt_u32 vcc, 31, v81
    s_and_b64 exec, vcc, s[56:57]
    s_nop 3
    s_cbranch_execz P_r15
    ds_write_b32 v17, v97
P_r15:
    s_andn2_b64 exec, s[56:57], vcc
    s_cbranch_execz P_r35
    s_mov_b64 s[14:15], exec
    v_lshlrev_b32 v36, 1, v81
    v_add_u32 v36, 0xfeffffc4, v36
    ds_max_u32 v89, v36 offset:124
    v_cmp_gt_u32 vcc, 63, v81
    s_and_b64 exec, vcc, s[14:15]
    s_nop 3
    s_cbranch_execz P_r25
    v_lshlrev_b32 v124, 7, v73
    v_lshl_add_u32 v124, v81, 2, v124
    buffer_store_dword v97, v124, s[36:39], s59 offen sc1
    s_nop 0
P_r25:
    s_andn2_b64 exec, s[14:15], vcc
    s_cbranch_execz P_r35
    ds_write_b32 v38, v116
    ds_add_rtn_u32 v124, v37, v116
    v_mov_b32 v126, v97
    v_mov_b32 v127, v73
    s_waitcnt lgkmcnt(0)
    v_lshlrev_b32 v124, 3, v124
    buffer_store_dwordx2 v[126:127], v124, s[36:39], s27 offen sc1
    s_nop 0
P_r35:
    s_mov_b64 exec, s[56:57]
    v_cmp_gt_u32 vcc, 31, v82
    s_and_b64 exec, vcc, s[56:57]
    s_nop 3
    s_cbranch_execz P_r16
    ds_write_b32 v18, v98
P_r16:
    s_andn2_b64 exec, s[56:57], vcc
    s_cbranch_execz P_r36
    s_mov_b64 s[14:15], exec
    v_lshlrev_b32 v36, 1, v82
    v_add_u32 v36, 0xfeffffc4, v36
    ds_max_u32 v90, v36 offset:124
    v_cmp_gt_u32 vcc, 63, v82
    s_and_b64 exec, vcc, s[14:15]
    s_nop 3
    s_cbranch_execz P_r26
    v_lshlrev_b32 v124, 7, v74
    v_lshl_add_u32 v124, v82, 2, v124
    buffer_store_dword v98, v124, s[36:39], s59 offen sc1
    s_nop 0
P_r26:
    s_andn2_b64 exec, s[14:15], vcc
    s_cbranch_execz P_r36
    ds_write_b32 v38, v116
    ds_add_rtn_u32 v124, v37, v116
    v_mov_b32 v126, v98
    v_mov_b32 v127, v74
    s_waitcnt lgkmcnt(0)
    v_lshlrev_b32 v124, 3, v124
    buffer_store_dwordx2 v[126:127], v124, s[36:39], s27 offen sc1
    s_nop 0
P_r36:
    s_mov_b64 exec, s[56:57]
    v_cmp_gt_u32 vcc, 31, v83
    s_and_b64 exec, vcc, s[56:57]
    s_nop 3
    s_cbranch_execz P_r17
    ds_write_b32 v19, v99
P_r17:
    s_andn2_b64 exec, s[56:57], vcc
    s_cbranch_execz P_r37
    s_mov_b64 s[14:15], exec
    v_lshlrev_b32 v36, 1, v83
    v_add_u32 v36, 0xfeffffc4, v36
    ds_max_u32 v91, v36 offset:124
    v_cmp_gt_u32 vcc, 63, v83
    s_and_b64 exec, vcc, s[14:15]
    s_nop 3
    s_cbranch_execz P_r27
    v_lshlrev_b32 v124, 7, v75
    v_lshl_add_u32 v124, v83, 2, v124
    buffer_store_dword v99, v124, s[36:39], s59 offen sc1
    s_nop 0
P_r27:
    s_andn2_b64 exec, s[14:15], vcc
    s_cbranch_execz P_r37
    ds_write_b32 v38, v116
    ds_add_rtn_u32 v124, v37, v116
    v_mov_b32 v126, v99
    v_mov_b32 v127, v75
    s_waitcnt lgkmcnt(0)
    v_lshlrev_b32 v124, 3, v124
    buffer_store_dwordx2 v[126:127], v124, s[36:39], s27 offen sc1
    s_nop 0
P_r37:
    s_mov_b64 exec, -1
    s_waitcnt vmcnt(0)
    s_branch P_join
M_e4x:
WUP_4220:
    s_cbranch_execz WUP_4395
    s_mov_b32 s56, 0x05040100
    s_mov_b32 s57, 0x07060302
    s_waitcnt vmcnt(4)
    v_lshlrev_b32 v150, 4, v1
    v_cmp_gt_u32 vcc, 49, v1
    s_mov_b64 s[60:61], vcc
    s_mov_b32 s63, 0x830100
    s_mov_b32 s65, 0
    s_nop 1
    s_branch M_pb
M_pa:
    buffer_load_dwordx4 v[236:239], v150, s[36:39], s63 offen sc1
    s_waitcnt vmcnt(0)
M_pb:
    v_xor_b32 v236, s18, v236
    v_xor_b32 v237, s18, v237
    v_xor_b32 v238, s18, v238
    v_xor_b32 v239, s18, v239
    v_or3_b32 v236, v236, v237, v238
    v_or_b32 v236, v236, v239
    v_cmp_ne_u32 vcc, 0, v236
    s_and_b64 vcc, vcc, s[60:61]
    s_cbranch_vccz M_pad
    s_sleep 2
    s_add_u32 s65, s65, 1
    s_cmp_lt_u32 s65, 16384
    s_cbranch_scc1 M_pa
M_pad:
    s_sub_u32 s27, s26, 5
    s_lshl_b32 s27, s27, 10
    s_add_u32 s63, s27, 0x810000
    s_add_u32 s27, s27, 30720
    s_mov_b32 m0, s27
    s_nop 0
    buffer_load_dwordx4 v3, s[36:39], s63 offen sc1 lds
    s_add_u32 s27, s27, 3072
    s_add_u32 s63, s63, 3072
    s_mov_b32 m0, s27
    s_nop 0
    buffer_load_dwordx4 v3, s[36:39], s63 offen sc1 lds
    s_add_u32 s27, s27, 3072
    s_add_u32 s63, s63, 3072
    s_mov_b32 m0, s27
    s_nop 0
    buffer_load_dwordx4 v3, s[36:39], s63 offen sc1 lds
    s_add_u32 s27, s27, 3072
    s_add_u32 s63, s63, 3072
    s_mov_b32 m0, s27
    s_nop 0
    buffer_load_dwordx4 v3, s[36:39], s63 offen sc1 lds
    s_add_u32 s27, s27, 3072
    s_add_u32 s63, s63, 3072
    s_mov_b32 m0, s27
    s_nop 0
    buffer_load_dwordx4 v3, s[36:39], s63 offen sc1 lds
    s_add_u32 s27, s27, 3072
    s_add_u32 s63, s63, 3072
    s_mov_b32 m0, s27
    s_nop 0
    buffer_load_dwordx4 v3, s[36:39], s63 offen sc1 lds
    s_add_u32 s27, s27, 3072
    s_add_u32 s63, s63, 3072
    s_mov_b32 m0, s27
    s_nop 0
    buffer_load_dwordx4 v3, s[36:39], s63 offen sc1 lds
    s_add_u32 s27, s27, 3072
    s_add_u32 s63, s63, 3072
    s_mov_b32 m0, s27
    s_nop 0
    buffer_load_dwordx4 v3, s[36:39], s63 offen sc1 lds
    s_add_u32 s27, s27, 3072
    s_add_u32 s63, s63, 3072
    s_mov_b32 m0, s27
    s_nop 0
    buffer_load_dwordx4 v3, s[36:39], s63 offen sc1 lds
    s_add_u32 s27, s27, 3072
    s_add_u32 s63, s63, 3072
    s_mov_b32 m0, s27
    s_nop 0
    buffer_load_dwordx4 v3, s[36:39], s63 offen sc1 lds
    s_add_u32 s27, s27, 3072
    s_add_u32 s63, s63, 3072
    s_mov_b32 m0, s27
    s_nop 0
    buffer_load_dwordx4 v3, s[36:39], s63 offen sc1 lds
    s_add_u32 s27, s27, 3072
    s_add_u32 s63, s63, 3072
    s_mov_b32 m0, s27
    s_nop 0
    buffer_load_dwordx4 v3, s[36:39], s63 offen sc1 lds
    s_add_u32 s27, s27, 3072
    s_add_u32 s63, s63, 3072
    s_mov_b32 m0, s27
    s_nop 0
    buffer_load_dwordx4 v3, s[36:39], s63 offen sc1 lds
    s_add_u32 s27, s27, 3072
    s_add_u32 s63, s63, 3072
    s_mov_b32 m0, s27
    s_nop 0
    buffer_load_dwordx4 v3, s[36:39], s63 offen sc1 lds
    s_add_u32 s27, s27, 3072
    s_add_u32 s63, s63, 3072
    s_mov_b32 m0, s27
    s_nop 0
    buffer_load_dwordx4 v3, s[36:39], s63 offen sc1 lds
    s_add_u32 s27, s27, 3072
    s_add_u32 s63, s63, 3072
    s_mov_b32 m0, s27
    s_nop 0
    buffer_load_dwordx4 v3, s[36:39], s63 offen sc1 lds
    s_add_u32 s27, s27, 3072
    s_add_u32 s63, s63, 3072
    s_mov_b32 m0, s27
    s_nop 0
    buffer_load_dwordx4 v3, s[36:39], s63 offen sc1 lds
    s_add_u32 s27, s27, 3072
    s_add_u32 s63, s63, 3072
    s_mov_b32 m0, s27
    s_nop 0
    buffer_load_dwordx4 v3, s[36:39], s63 offen sc1 lds
    s_add_u32 s27, s27, 3072
    s_add_u32 s63, s63, 3072
    s_mov_b32 m0, s27
    s_nop 0
    buffer_load_dwordx4 v3, s[36:39], s63 offen sc1 lds
    s_add_u32 s27, s27, 3072
    s_add_u32 s63, s63, 3072
    s_mov_b32 m0, s27
    s_nop 0
    buffer_load_dwordx4 v3, s[36:39], s63 offen sc1 lds
    s_add_u32 s27, s27, 3072
    s_add_u32 s63, s63, 3072
    s_mov_b32 m0, s27
    s_nop 0
    buffer_load_dwordx4 v3, s[36:39], s63 offen sc1 lds
    s_add_u32 s27, s27, 3072
    s_add_u32 s63, s63, 3072
    s_mov_b32 m0, s27
    s_nop 0
    buffer_load_dwordx4 v3, s[36:39], s63 offen sc1 lds
    s_add_u32 s27, s27, 3072
    s_add_u32 s63, s63, 3072
    s_mov_b32 m0, s27
    s_nop 0
    buffer_load_dwordx4 v3, s[36:39], s63 offen sc1 lds
    s_add_u32 s27, s27, 3072
    s_add_u32 s63, s63, 3072
    s_mov_b32 m0, s27
    s_nop 0
    buffer_load_dwordx4 v3, s[36:39], s63 offen sc1 lds
    s_add_u32 s27, s27, 3072
    s_add_u32 s63, s63, 3072
    s_mov_b32 m0, s27
    s_nop 0
    buffer_load_dwordx4 v3, s[36:39], s63 offen sc1 lds
    s_add_u32 s27, s27, 3072
    s_add_u32 s63, s63, 3072
    s_mov_b32 m0, s27
    s_nop 0
    buffer_load_dwordx4 v3, s[36:39], s63 offen sc1 lds
    s_add_u32 s27, s27, 3072
    s_add_u32 s63, s63, 3072
    s_mov_b32 m0, s27
    s_nop 0
    buffer_load_dwordx4 v3, s[36:39], s63 offen sc1 lds
    s_add_u32 s27, s27, 3072
    s_add_u32 s63, s63, 3072
    s_mov_b32 m0, s27
    s_nop 0
    buffer_load_dwordx4 v3, s[36:39], s63 offen sc1 lds
    s_add_u32 s27, s27, 3072
    s_add_u32 s63, s63, 3072
    s_mov_b32 m0, s27
    s_nop 0
    buffer_load_dwordx4 v3, s[36:39], s63 offen sc1 lds
    s_add_u32 s27, s27, 3072
    s_add_u32 s63, s63, 3072
    s_mov_b32 m0, s27
WUP_4395:
    s_cbranch_execz WUR_0
    s_nop 0
    buffer_load_dwordx4 v3, s[36:39], s63 offen sc1 lds
    s_add_u32 s27, s27, 3072
    s_add_u32 s63, s63, 3072
    s_mov_b32 m0, s27
    s_nop 0
    buffer_load_dwordx4 v3, s[36:39], s63 offen sc1 lds
    s_add_u32 s27, s27, 3072
    s_add_u32 s63, s63, 3072
    s_mov_b32 m0, s27
    s_nop 0
    buffer_load_dwordx4 v3, s[36:39], s63 offen sc1 lds
    s_add_u32 s27, s27, 3072
    s_add_u32 s63, s63, 3072
    s_cmp_eq_u32 s26, 7
    s_cbranch_scc1 M_tfd
    s_mov_b32 m0, s27
    s_nop 0
    buffer_load_dwordx4 v3, s[36:39], s63 offen sc1 lds
M_tfd:
    s_setprio 0
    s_branch M_e5
M_mdx:
    s_mov_b32 s59, 0
M_md:
    s_cmp_eq_u64 s[68:69], 0
    s_cbranch_scc0 M_md1
    s_cmp_lg_u32 s59, 0
    s_cbranch_scc1 M_mdd
    s_mov_b32 s59, 1
    s_mov_b64 s[68:69], s[70:71]
    v_mov_b32 v187, v191
    s_nop 1
    s_branch M_md
M_md1:
    s_ff1_i32_b64 s27, s[68:69]
    s_bitset0_b64 s[68:69], s27
    v_readlane_b32 s60, v187, s27
    s_bfe_u32 s60, s60, 0x170001
    s_cmp_le_u32 s60, 32
    s_cbranch_scc1 M_md2
    ds_write_b32 v9, v19
    s_movk_i32 s60, 32
M_md2:
    s_lshr_b32 s27, s27, 2
    s_lshl_b32 s61, s59, 4
    s_add_u32 s27, s27, s61
    s_lshl_b32 s61, s26, 5
    s_add_u32 s27, s27, s61
    s_lshl_b32 s27, s27, 15
    s_lshl_b32 s61, s2, 7
    s_add_u32 s27, s27, s61
    s_add_u32 s27, s27, 0x900000
    v_mov_b32 v148, 0xff000000
    s_bfm_b64 exec, s60, 0
    buffer_load_dword v148, v20, s[36:39], s27 offen sc1
    s_mov_b64 exec, -1
    s_waitcnt vmcnt(0) lgkmcnt(0)
    v_and_b32 v64, s12, v148
    v_alignbit_b32 v65, s13, v148, 22
    ds_read_u16 v64, v64 offset:30720
    ds_read_b32 v65, v65
    s_waitcnt lgkmcnt(0)
    v_and_b32 v96, 0x0707, v64
    v_and_b32 v64, 0xf8f8, v64
    v_mul_u32_u24 v96, 0x200400, v96
    v_and_or_b32 v64, v96, s14, v64
    v_add_u32 v64, v64, v65
    v_dot4_i32_i8 v64, v64, v64, 0
    s_nop 2
    v_cmp_gt_i32 s[40:41], s15, v64
    s_nop 1
    v_mbcnt_lo_u32_b32 v96, s40, 0
    v_mbcnt_hi_u32_b32 v96, s41, v96
    v_lshl_add_u32 v96, v96, 2, s16
    s_bcnt1_i32_b64 s27, s[40:41]
    s_lshl2_add_u32 s16, s27, s16
    v_cndmask_b32 v96, v26, v96, s[40:41]
    ds_write_b32 v96, v148
    s_sub_u32 s27, s16, s17
    s_cmp_gt_u32 s27, 1024
    s_cbranch_scc0 M_md
    s_branch M_mdd
M_rd0:
    s_waitcnt vmcnt(0)
    v_lshlrev_b32 v192, 16, v208
    v_and_b32 v208, s58, v208
    v_lshlrev_b32 v193, 16, v209
    v_and_b32 v209, s58, v209
    v_lshlrev_b32 v194, 16, v210
    v_and_b32 v210, s58, v210
    v_lshlrev_b32 v195, 16, v211
    v_and_b32 v211, s58, v211
    v_lshlrev_b32 v196, 16, v212
    v_and_b32 v212, s58, v212
    v_lshlrev_b32 v197, 16, v213
    v_and_b32 v213, s58, v213
    v_lshlrev_b32 v198, 16, v214
    v_and_b32 v214, s58, v214
    v_lshlrev_b32 v199, 16, v215
    v_and_b32 v215, s58, v215
    v_lshlrev_b32 v200, 16, v216
    v_and_b32 v216, s58, v216
    v_lshlrev_b32 v201, 16, v217
    v_and_b32 v217, s58, v217
    v_lshlrev_b32 v202, 16, v218
    v_and_b32 v218, s58, v218
    v_lshlrev_b32 v203, 16, v219
    v_and_b32 v219, s58, v219
    v_lshlrev_b32 v204, 16, v220
    v_and_b32 v220, s58, v220
    v_lshlrev_b32 v205, 16, v221
    v_and_b32 v221, s58, v221
    v_lshlrev_b32 v206, 16, v222
    v_and_b32 v222, s58, v222
    v_lshlrev_b32 v207, 16, v223
    v_and_b32 v223, s58, v223
    v_lshlrev_b32 v224, 16, v240
    v_and_b32 v240, s58, v240
    v_lshlrev_b32 v225, 16, v241
    v_and_b32 v241, s58, v241
    v_lshlrev_b32 v226, 16, v242
    v_and_b32 v242, s58, v242
    v_lshlrev_b32 v227, 16, v243
    v_and_b32 v243, s58, v243
    v_lshlrev_b32 v228, 16, v244
    v_and_b32 v244, s58, v244
    v_lshlrev_b32 v229, 16, v245
    v_and_b32 v245, s58, v245
    v_lshlrev_b32 v230, 16, v246
    v_and_b32 v246, s58, v246
    v_lshlrev_b32 v231, 16, v247
    v_and_b32 v247, s58, v247
    v_lshlrev_b32 v232, 16, v248
    v_and_b32 v248, s58, v248
    v_lshlrev_b32 v233, 16, v249
    v_and_b32 v249, s58, v249
    v_lshlrev_b32 v234, 16, v250
    v_and_b32 v250, s58, v250
    v_lshlrev_b32 v235, 16, v251
    v_and_b32 v251, s58, v251
    v_lshlrev_b32 v236, 16, v252
    v_and_b32 v252, s58, v252
    v_lshlrev_b32 v237, 16, v253
    v_and_b32 v253, s58, v253
    v_lshlrev_b32 v238, 16, v254
    v_and_b32 v254, s58, v254
    v_lshlrev_b32 v239, 16, v255
    v_and_b32 v255, s58, v255
    s_mov_b32 s99, 0
    s_nop 0
    s_branch M_rd1
M_slow:
    v_lshrrev_b32 v8, 4, v1
    v_add_u32 v86, 64, v8
    v_bfrev_b32 v14, 2
    s_mov_b32 s63, 0x02020000
    s_mov_b32 s64, 0x322bcc77
    v_mov_b32 v103, 0x01000c0c
    v_and_b32 v12, 3, v8
    v_lshlrev_b32 v12, 3, v12
    v_lshrrev_b32_e64 v13, v12, s18
    v_bfe_u32 v15, v13, 1, 7
    v_lshlrev_b32 v15, 17, v15
    v_and_b32 v13, 1, v13
    v_or_b32 v95, v13, v15
    s_bfe_u32 s60, s18, 0x70019
    s_lshl_b32 s60, s60, 17
    s_bfe_u32 s27, s18, 0x10018
    s_or_b32 s60, s60, s27
    s_lshl_b32 s53, s2, 7
    s_cmp_eq_u32 s14, 2
    s_cbranch_scc1 M_sovf
    s_cmp_ge_u32 s15, 63
    s_cbranch_scc1 M_sph1
    s_lshl_b32 s62, s15, 2
    v_lshrrev_b32 v12, 5, v8
    v_and_b32 v13, 31, v8
    v_add_u32 v15, s62, v12
    v_cmp_gt_u32 vcc, 250, v15
    s_mov_b64 s[54:55], vcc
    v_lshlrev_b32 v15, 15, v15
    v_cndmask_b32 v15, v14, v15, s[54:55]
    s_cmp_lg_u32 s14, 0
    s_nop 0
    s_cbranch_scc1 M_s227
    v_lshl_add_u32 v16, v13, 2, v15
    buffer_load_dword v88, v16, s[36:39], s53 offen sc1
    s_waitcnt vmcnt(0)
    v_xor_b32 v88, v95, v88
    s_mov_b32 s27, 0xc8000000
    v_cmp_gt_u32 vcc, s27, v88
    s_and_b64 s[54:55], s[54:55], vcc
    s_nop 3
    s_branch M_s327
M_s227:
    buffer_load_dword v88, v15, s[36:39], s53 offen offset:124 sc1
    s_waitcnt vmcnt(0)
    v_xor_b32 v88, s60, v88
    v_bfe_u32 v88, v88, 1, 23
    v_cmp_gt_u32 vcc, v88, v13
    s_and_b64 s[54:55], s[54:55], vcc
    v_lshl_add_u32 v16, v13, 2, v15
    v_cndmask_b32 v16, v14, v16, s[54:55]
    s_add_u32 s27, s53, 0x900000
    buffer_load_dword v88, v16, s[36:39], s27 offen sc1
    s_waitcnt vmcnt(0)
M_s327:
    v_lshrrev_b32 v16, 24, v88
    v_subrev_u32 v17, s59, v16
    v_cmp_gt_u32 vcc, s45, v17
    s_and_b64 s[54:55], s[54:55], vcc
    v_and_b32 v96, 0x1fffe, v88
    v_lshl_add_u32 v96, v96, 1, v96
    v_and_b32 v96, -4, v96
    v_cndmask_b32 v96, v14, v96, s[54:55]
    buffer_load_dwordx2 v[98:99], v96, s[92:95], 0 offen
    v_mul_u32_u24 v97, 6, v16
    v_and_b32 v97, -4, v97
    v_cndmask_b32 v97, v14, v97, s[54:55]
    s_mul_i32 s27, s2, 1200
    buffer_load_dwordx2 v[100:101], v97, s[92:95], s27 offen
    v_bfe_i32 v102, v88, 1, 1
    v_and_or_b32 v102, v102, s63, v103
    v_bfe_i32 v104, v16, 0, 1
    v_and_or_b32 v104, v104, s63, v103
    v_add_u32 v105, s63, v104
    v_add_u32 v106, s63, v105
    s_waitcnt vmcnt(0)
    v_perm_b32 v107, v101, v100, v104
    v_perm_b32 v108, v101, v100, v105
    v_perm_b32 v109, v101, v100, v106
    v_add_u32 v113, s63, v102
    v_perm_b32 v110, v99, v98, v102
    v_add_u32 v114, s63, v113
    v_perm_b32 v111, v99, v98, v113
    v_perm_b32 v112, v99, v98, v114
    v_sub_f32 v110, v110, v107
    v_sub_f32 v111, v111, v108
    v_sub_f32 v112, v112, v109
    v_cvt_pk_bf16_f32 v89, v110, v111
    v_cvt_pk_bf16_f32 v112, 0, v112
    v_lshlrev_b32 v110, 16, v89
    v_and_b32 v111, s58, v89
    v_mul_f32 v115, v112, v112
    v_mul_f32 v110, v110, v110
    v_mul_f32 v111, v111, v111
    v_cvt_pk_bf16_f32 v115, 0, v115
    v_cvt_pk_bf16_f32 v110, 0, v110
    v_cvt_pk_bf16_f32 v111, 0, v111
    v_add_f32 v110, v110, v111
    v_add_f32 v110, v110, v115
    v_cvt_pk_bf16_f32 v110, 0, v110
    v_add_f32 v110, s64, v110
    v_cvt_pk_bf16_f32 v110, 0, v110
    v_sqrt_f32 v110, v110
    s_nop 0
    v_cvt_pk_bf16_f32 v90, v112, v110
    s_mov_b32 s27, 0x409d0000
    v_cmp_gt_u32 vcc, s27, v90
    s_and_b64 s[8:9], s[54:55], vcc
    v_lshrrev_b32 v12, 5, v86
    v_and_b32 v13, 31, v86
    v_add_u32 v15, s62, v12
    v_cmp_gt_u32 vcc, 250, v15
    s_mov_b64 s[54:55], vcc
    v_lshlrev_b32 v15, 15, v15
    v_cndmask_b32 v15, v14, v15, s[54:55]
    s_cmp_lg_u32 s14, 0
    s_nop 0
    s_cbranch_scc1 M_s228
    v_lshl_add_u32 v16, v13, 2, v15
    buffer_load_dword v92, v16, s[36:39], s53 offen sc1
    s_waitcnt vmcnt(0)
    v_xor_b32 v92, v95, v92
    s_mov_b32 s27, 0xc8000000
    v_cmp_gt_u32 vcc, s27, v92
    s_and_b64 s[54:55], s[54:55], vcc
    s_nop 3
    s_branch M_s328
M_s228:
    buffer_load_dword v92, v15, s[36:39], s53 offen offset:124 sc1
    s_waitcnt vmcnt(0)
    v_xor_b32 v92, s60, v92
    v_bfe_u32 v92, v92, 1, 23
    v_cmp_gt_u32 vcc, v92, v13
    s_and_b64 s[54:55], s[54:55], vcc
    v_lshl_add_u32 v16, v13, 2, v15
    v_cndmask_b32 v16, v14, v16, s[54:55]
    s_add_u32 s27, s53, 0x900000
    buffer_load_dword v92, v16, s[36:39], s27 offen sc1
    s_waitcnt vmcnt(0)
M_s328:
    v_lshrrev_b32 v16, 24, v92
    v_subrev_u32 v17, s59, v16
    v_cmp_gt_u32 vcc, s45, v17
    s_and_b64 s[54:55], s[54:55], vcc
    v_and_b32 v96, 0x1fffe, v92
    v_lshl_add_u32 v96, v96, 1, v96
    v_and_b32 v96, -4, v96
    v_cndmask_b32 v96, v14, v96, s[54:55]
    buffer_load_dwordx2 v[98:99], v96, s[92:95], 0 offen
    v_mul_u32_u24 v97, 6, v16
    v_and_b32 v97, -4, v97
    v_cndmask_b32 v97, v14, v97, s[54:55]
    s_mul_i32 s27, s2, 1200
    buffer_load_dwordx2 v[100:101], v97, s[92:95], s27 offen
    v_bfe_i32 v102, v92, 1, 1
    v_and_or_b32 v102, v102, s63, v103
    v_bfe_i32 v104, v16, 0, 1
    v_and_or_b32 v104, v104, s63, v103
    v_add_u32 v105, s63, v104
    v_add_u32 v106, s63, v105
    s_waitcnt vmcnt(0)
    v_perm_b32 v107, v101, v100, v104
    v_perm_b32 v108, v101, v100, v105
    v_perm_b32 v109, v101, v100, v106
    v_add_u32 v113, s63, v102
    v_perm_b32 v110, v99, v98, v102
    v_add_u32 v114, s63, v113
    v_perm_b32 v111, v99, v98, v113
    v_perm_b32 v112, v99, v98, v114
    v_sub_f32 v110, v110, v107
    v_sub_f32 v111, v111, v108
    v_sub_f32 v112, v112, v109
    v_cvt_pk_bf16_f32 v93, v110, v111
    v_cvt_pk_bf16_f32 v112, 0, v112
    v_lshlrev_b32 v110, 16, v93
    v_and_b32 v111, s58, v93
    v_mul_f32 v115, v112, v112
    v_mul_f32 v110, v110, v110
    v_mul_f32 v111, v111, v111
    v_cvt_pk_bf16_f32 v115, 0, v115
    v_cvt_pk_bf16_f32 v110, 0, v110
    v_cvt_pk_bf16_f32 v111, 0, v111
    v_add_f32 v110, v110, v111
    v_add_f32 v110, v110, v115
    v_cvt_pk_bf16_f32 v110, 0, v110
    v_add_f32 v110, s64, v110
    v_cvt_pk_bf16_f32 v110, 0, v110
    v_sqrt_f32 v110, v110
    s_nop 0
    v_cvt_pk_bf16_f32 v94, v112, v110
    s_mov_b32 s27, 0x409d0000
    v_cmp_gt_u32 vcc, s27, v94
    s_and_b64 s[10:11], s[54:55], vcc
    s_add_u32 s15, s15, 1
    s_nop 2
    s_branch M_sgo
M_sph1:
    s_add_u32 s14, s14, 1
    s_mov_b32 s15, 0
    s_mov_b32 s16, 0
    s_cmp_eq_u32 s14, 1
    s_cbranch_scc1 M_slow
M_sovf:
    s_cmp_ge_u32 s15, 250
    s_cbranch_scc1 M_send
    s_cmp_lg_u32 s16, 0
    s_cbranch_scc1 M_sblk
    s_lshl_b32 s27, s15, 15
    s_add_u32 s27, s27, s53
    v_mov_b32 v12, 0
    buffer_load_dword v13, v12, s[36:39], s27 offen offset:124 sc1
    s_waitcnt vmcnt(0)
    v_readfirstlane_b32 s17, v13
    s_xor_b32 s17, s17, s60
    s_bfe_u32 s17, s17, 0x170001
    s_cmp_gt_u32 s17, 32
    s_cselect_b32 s17, 1, 0
    s_cbranch_scc0 M_sblk0
    s_lshl_b32 s27, s15, 15
    s_add_u32 s27, s27, 32124
    buffer_load_dword v13, v12, s[36:39], s27 offen sc1
    s_waitcnt vmcnt(0)
    v_readfirstlane_b32 s17, v13
    s_min_u32 s17, s17, 3200
M_sblk0:
M_sblk:
    s_cmp_lt_u32 s16, s17
    s_cbranch_scc1 M_sld
    s_add_u32 s15, s15, 1
    s_mov_b32 s16, 0
    s_branch M_sovf
M_sld:
    s_mul_i32 s27, s15, 32768
    s_add_u32 s27, s27, 0x1100000
    v_add_u32 v12, s16, v8
    v_cmp_gt_u32 s[54:55], s17, v12
    v_lshlrev_b32 v12, 3, v12
    s_nop 0
    v_cndmask_b32 v12, v14, v12, s[54:55]
    buffer_load_dwordx2 v[88:89], v12, s[36:39], s27 offen sc1
    s_waitcnt vmcnt(0)
    v_cmp_eq_u32 vcc, s2, v89
    s_and_b64 s[54:55], s[54:55], vcc
    v_lshrrev_b32 v16, 24, v88
    v_subrev_u32 v17, s59, v16
    v_cmp_gt_u32 vcc, s45, v17
    s_and_b64 s[54:55], s[54:55], vcc
    v_and_b32 v96, 0x1fffe, v88
    v_lshl_add_u32 v96, v96, 1, v96
    v_and_b32 v96, -4, v96
    v_cndmask_b32 v96, v14, v96, s[54:55]
    buffer_load_dwordx2 v[98:99], v96, s[92:95], 0 offen
    v_mul_u32_u24 v97, 6, v16
    v_and_b32 v97, -4, v97
    v_cndmask_b32 v97, v14, v97, s[54:55]
    s_mul_i32 s27, s2, 1200
    buffer_load_dwordx2 v[100:101], v97, s[92:95], s27 offen
    v_bfe_i32 v102, v88, 1, 1
    v_and_or_b32 v102, v102, s63, v103
    v_bfe_i32 v104, v16, 0, 1
    v_and_or_b32 v104, v104, s63, v103
    v_add_u32 v105, s63, v104
    v_add_u32 v106, s63, v105
    s_waitcnt vmcnt(0)
    v_perm_b32 v107, v101, v100, v104
    v_perm_b32 v108, v101, v100, v105
    v_perm_b32 v109, v101, v100, v106
    v_add_u32 v113, s63, v102
    v_perm_b32 v110, v99, v98, v102
    v_add_u32 v114, s63, v113
    v_perm_b32 v111, v99, v98, v113
    v_perm_b32 v112, v99, v98, v114
    v_sub_f32 v110, v110, v107
    v_sub_f32 v111, v111, v108
    v_sub_f32 v112, v112, v109
    v_cvt_pk_bf16_f32 v89, v110, v111
    v_cvt_pk_bf16_f32 v112, 0, v112
    v_lshlrev_b32 v110, 16, v89
    v_and_b32 v111, s58, v89
    v_mul_f32 v115, v112, v112
    v_mul_f32 v110, v110, v110
    v_mul_f32 v111, v111, v111
    v_cvt_pk_bf16_f32 v115, 0, v115
    v_cvt_pk_bf16_f32 v110, 0, v110
    v_cvt_pk_bf16_f32 v111, 0, v111
    v_add_f32 v110, v110, v111
    v_add_f32 v110, v110, v115
    v_cvt_pk_bf16_f32 v110, 0, v110
    v_add_f32 v110, s64, v110
    v_cvt_pk_bf16_f32 v110, 0, v110
    v_sqrt_f32 v110, v110
    s_nop 0
    v_cvt_pk_bf16_f32 v90, v112, v110
    s_mov_b32 s27, 0x409d0000
    v_cmp_gt_u32 vcc, s27, v90
    s_and_b64 s[8:9], s[54:55], vcc
    s_mul_i32 s27, s15, 32768
    s_add_u32 s27, s27, 0x1100000
    v_add_u32 v12, s16, v86
    v_cmp_gt_u32 s[54:55], s17, v12
    v_lshlrev_b32 v12, 3, v12
    s_nop 0
    v_cndmask_b32 v12, v14, v12, s[54:55]
    buffer_load_dwordx2 v[92:93], v12, s[36:39], s27 offen sc1
    s_waitcnt vmcnt(0)
    v_cmp_eq_u32 vcc, s2, v93
    s_and_b64 s[54:55], s[54:55], vcc
    v_lshrrev_b32 v16, 24, v92
    v_subrev_u32 v17, s59, v16
    v_cmp_gt_u32 vcc, s45, v17
    s_and_b64 s[54:55], s[54:55], vcc
    v_and_b32 v96, 0x1fffe, v92
    v_lshl_add_u32 v96, v96, 1, v96
    v_and_b32 v96, -4, v96
    v_cndmask_b32 v96, v14, v96, s[54:55]
    buffer_load_dwordx2 v[98:99], v96, s[92:95], 0 offen
    v_mul_u32_u24 v97, 6, v16
    v_and_b32 v97, -4, v97
    v_cndmask_b32 v97, v14, v97, s[54:55]
    s_mul_i32 s27, s2, 1200
    buffer_load_dwordx2 v[100:101], v97, s[92:95], s27 offen
    v_bfe_i32 v102, v92, 1, 1
    v_and_or_b32 v102, v102, s63, v103
    v_bfe_i32 v104, v16, 0, 1
    v_and_or_b32 v104, v104, s63, v103
    v_add_u32 v105, s63, v104
    v_add_u32 v106, s63, v105
    s_waitcnt vmcnt(0)
    v_perm_b32 v107, v101, v100, v104
    v_perm_b32 v108, v101, v100, v105
    v_perm_b32 v109, v101, v100, v106
    v_add_u32 v113, s63, v102
    v_perm_b32 v110, v99, v98, v102
    v_add_u32 v114, s63, v113
    v_perm_b32 v111, v99, v98, v113
    v_perm_b32 v112, v99, v98, v114
    v_sub_f32 v110, v110, v107
    v_sub_f32 v111, v111, v108
    v_sub_f32 v112, v112, v109
    v_cvt_pk_bf16_f32 v93, v110, v111
    v_cvt_pk_bf16_f32 v112, 0, v112
    v_lshlrev_b32 v110, 16, v93
    v_and_b32 v111, s58, v93
    v_mul_f32 v115, v112, v112
    v_mul_f32 v110, v110, v110
    v_mul_f32 v111, v111, v111
    v_cvt_pk_bf16_f32 v115, 0, v115
    v_cvt_pk_bf16_f32 v110, 0, v110
    v_cvt_pk_bf16_f32 v111, 0, v111
    v_add_f32 v110, v110, v111
    v_add_f32 v110, v110, v115
    v_cvt_pk_bf16_f32 v110, 0, v110
    v_add_f32 v110, s64, v110
    v_cvt_pk_bf16_f32 v110, 0, v110
    v_sqrt_f32 v110, v110
    s_nop 0
    v_cvt_pk_bf16_f32 v94, v112, v110
    s_mov_b32 s27, 0x409d0000
    v_cmp_gt_u32 vcc, s27, v94
    s_and_b64 s[10:11], s[54:55], vcc
    s_add_u32 s16, s16, 128
    s_nop 2
M_sgo:
    s_or_b64 s[54:55], s[8:9], s[10:11]
    s_cmp_eq_u64 s[54:55], 0
    s_cbranch_scc1 M_slow
    s_mov_b32 s48, 4
    s_cmp_eq_u64 s[10:11], 0
    s_cselect_b32 s48, 2, 4
    s_movk_i32 s63, 0x70
    s_movk_i32 s64, 2176
    v_lshrrev_b32 v8, 4, v1
    v_lshrrev_b32 v10, 5, v8
    v_and_b32 v11, 31, v8
    v_lshlrev_b32 v3, 4, v11
    v_add_u32 v3, s52, v3
    v_mul_u32_u24 v0, 56, v10
    v_add_u32 v0, s52, v0
    v_lshrrev_b32 v13, 3, v11
    v_lshl_add_u32 v4, v13, 3, v0
    v_lshrrev_b32 v13, 3, v8
    v_and_b32 v14, 1, v13
    v_lshrrev_b32 v13, 1, v13
    v_lshl_add_u32 v13, v14, 2, v13
    v_lshlrev_b32 v5, 4, v13
    v_add_u32 v5, s52, v5
    v_add_u32 v16, s52, v1
    v_lshrrev_b32 v17, 2, v8
    v_mul_u32_u24 v17, 56, v17
    v_and_b32 v13, 3, v8
    v_lshl_add_u32 v17, v13, 1, v17
    v_add_u32 v17, s52, v17
    s_nop 1
    s_branch M_win
M_send:
    s_mov_b64 s[8:9], 0
    s_mov_b64 s[10:11], 0
    s_mov_b32 s48, 0
    s_mov_b32 s76, 1
    s_movk_i32 s63, 0x70
    s_movk_i32 s64, 2176
    v_lshrrev_b32 v8, 4, v1
    v_lshrrev_b32 v10, 5, v8
    v_and_b32 v11, 31, v8
    v_lshlrev_b32 v3, 4, v11
    v_add_u32 v3, s52, v3
    v_mul_u32_u24 v0, 56, v10
    v_add_u32 v0, s52, v0
    v_lshrrev_b32 v13, 3, v11
    v_lshl_add_u32 v4, v13, 3, v0
    v_lshrrev_b32 v13, 3, v8
    v_and_b32 v14, 1, v13
    v_lshrrev_b32 v13, 1, v13
    v_lshl_add_u32 v13, v14, 2, v13
    v_lshlrev_b32 v5, 4, v13
    v_add_u32 v5, s52, v5
    v_add_u32 v16, s52, v1
    v_lshrrev_b32 v17, 2, v8
    v_mul_u32_u24 v17, 56, v17
    v_and_b32 v13, 3, v8
    v_lshl_add_u32 v17, v13, 1, v17
    v_add_u32 v17, s52, v17
    s_nop 1
    s_branch M_win
.section .rodata,"a"
.p2align 6
.amdhsa_kernel standalone__molecular_angular_painn__graph_kernel
  .amdhsa_next_free_vgpr 256
  .amdhsa_next_free_sgpr 102
  .amdhsa_accum_offset 256
  .amdhsa_group_segment_fixed_size 0
  .amdhsa_kernarg_size 88
  .amdhsa_user_sgpr_count 2
  .amdhsa_user_sgpr_kernarg_segment_ptr 1
  .amdhsa_system_sgpr_workgroup_id_x 1
  .amdhsa_float_denorm_mode_32 3
.end_amdhsa_kernel
```

```asm
; @launch grid=(250,1,1) block=(512,1,1) lds=163840
.amdgcn_target "amdgcn-amd-amdhsa--gfx950"
.text
.globl standalone__molecular_angular_painn__graph_kernel
.p2align 12
.p2align 8
.type standalone__molecular_angular_painn__graph_kernel,@function
standalone__molecular_angular_painn__graph_kernel:
    s_cmp_ge_u32 s2, 250
    s_cbranch_scc1 K_end
    s_load_dwordx8 s[4:11], s[0:1], 0
    s_load_dwordx8 s[12:19], s[0:1], 32
    s_load_dwordx2 s[20:21], s[0:1], 64
    s_load_dwordx2 s[24:25], s[0:1], 80
    v_and_b32 v1, 63, v0
    v_lshrrev_b32 v119, 6, v0
    v_lshlrev_b32 v2, 4, v0
    v_readfirstlane_b32 s26, v119
    v_mov_b32 v20, 0xff000000
    v_mov_b32 v21, v20
    v_mov_b32 v22, v20
    v_mov_b32 v23, v20
    v_add_u32 v117, 131840, v2
    ds_write_b128 v117, v[20:23] offset:0
    ds_write_b128 v117, v[20:23] offset:8192
    ds_write_b128 v117, v[20:23] offset:16384
    v_cmp_gt_u32 vcc, 464, v0
    s_mov_b64 s[66:67], vcc
    s_mov_b64 exec, vcc
    ds_write_b128 v117, v[20:23] offset:24576
    s_mov_b64 exec, -1
    v_lshlrev_b32 v28, 2, v0
    v_mov_b32 v29, 0
    v_cmp_gt_u32 vcc, 256, v0
    s_and_saveexec_b64 s[60:61], vcc
    ds_write_b32 v28, v29 offset:8192
    s_mov_b64 exec, -1
    v_mov_b32 v30, 131076
    ds_write2_b32 v30, v29, v29 offset1:1
    ds_write_b32 v30, v29 offset:8
    s_mov_b32 s58, 0xffff0000
    v_lshlrev_b32 v3, 4, v1
    v_mov_b32 v116, 1
    v_lshrrev_b32 v119, 4, v1
    v_and_b32 v120, 15, v1
    v_lshlrev_b32 v121, 9, v120
    v_lshl_add_u32 v121, v119, 4, v121
    v_bfrev_b32 v118, 2
    s_cmp_eq_u32 s26, 4
    s_cselect_b32 s63, 8, 16
    s_cmp_gt_u32 s26, 4
    s_cselect_b32 s63, 0, s63
    v_cmp_gt_u32 vcc, s63, v120
    s_nop 1
    v_cndmask_b32 v36, v118, v121, vcc
    s_mul_i32 s62, s2, 200
    s_lshl_b32 s61, s26, 4
    s_add_u32 s62, s62, s61
    s_lshl_b32 s76, s62, 9
    s_add_u32 s77, s76, 65536
    s_mul_i32 s27, s2, 12800
    s_add_u32 s59, s27, 6400
    v_cmp_gt_u32 vcc, 400, v0
    s_mov_b64 s[56:57], vcc
    s_lshl_b32 s64, s26, 10
    s_add_u32 m0, s64, 0
    s_waitcnt lgkmcnt(0)
    s_barrier
    s_mov_b32 s48, s14
    s_mov_b32 s49, s15
    s_mov_b32 s50, 0x2000
    s_mov_b32 s51, 0x00020000
    s_cmp_eq_u32 s26, 7
    s_cbranch_scc1 P_w7
    s_mov_b32 s44, s10
    s_mov_b32 s45, s11
    s_mov_b32 s46, 0x30d400
    s_mov_b32 s47, 0x00020000
    s_mov_b32 s40, s8
    s_mov_b32 s41, s9
    s_mov_b32 s42, 0x30d400
    s_mov_b32 s43, 0x00020000
    s_mov_b32 s28, s4
    s_mov_b32 s29, s5
    s_mov_b32 s30, 0x186a000
    s_mov_b32 s31, 0x00020000
    buffer_load_dwordx4 v3, s[48:51], s64 offen lds
    s_mov_b64 exec, s[56:57]
    buffer_load_dwordx4 v[4:7], v2, s[44:47], s27 offen nt
    buffer_load_dwordx4 v[8:11], v2, s[44:47], s59 offen nt
    buffer_load_dwordx4 v[12:15], v2, s[40:43], s27 offen nt
    buffer_load_dwordx4 v[16:19], v2, s[40:43], s59 offen nt
    s_mov_b64 exec, -1
    s_mov_b32 s92, s6
    s_mov_b32 s93, s7
    s_mov_b32 s94, 0x493e0
    s_mov_b32 s95, 0x00020000
    s_mov_b32 s36, s24
    s_mov_b32 s37, s25
    s_mov_b32 s38, 0x241a800
    s_mov_b32 s39, 0x00020000
    s_add_u32 s72, s24, 0x1e00000
    s_addc_u32 s73, s25, 0
    s_mov_b32 s74, 0x61a800
    s_mov_b32 s75, 0x00020000
    s_mov_b32 s52, s16
    s_mov_b32 s53, s17
    s_mov_b32 s54, 0x6000
    s_mov_b32 s55, 0x00020000
    s_mov_b32 s96, s18
    s_mov_b32 s97, s19
    s_mov_b32 s98, 0x1800
    s_mov_b32 s99, 0x00020000
    s_mov_b32 s68, s12
    s_mov_b32 s69, s13
    s_mov_b32 s70, 0x20
    s_mov_b32 s71, 0x00020000
    s_mov_b32 s32, s20
    s_mov_b32 s33, s21
    s_mov_b32 s34, 0x186a000
    s_mov_b32 s35, 0x00020000
    v_bfe_u32 v122, v1, 2, 2
    v_lshl_add_u32 v122, v119, 3, v122
    v_lshlrev_b32 v122, 7, v122
    v_and_b32 v39, 3, v1
    v_lshl_add_u32 v122, v39, 3, v122
    s_mov_b64 exec, 0
    s_cmp_eq_u32 s26, 0
    s_cbranch_scc1 WUP_413
    s_cmp_eq_u32 s26, 1
    s_cbranch_scc1 WUP_548
    s_cmp_eq_u32 s26, 2
    s_cbranch_scc1 WUP_934
    s_cmp_eq_u32 s26, 3
    s_cbranch_scc1 WUP_4205
    s_cmp_eq_u32 s26, 4
    s_cbranch_scc1 WUP_1270
    s_cmp_eq_u32 s26, 5
    s_cbranch_scc1 WUP_1607
    s_cmp_eq_u32 s26, 6
    s_cbranch_scc1 WUP_1970
WUR_0:
    s_mov_b64 exec, -1
    s_nop 1
    s_branch P_bin
P_w7:
    s_lshr_b32 s3, s2, 3
    s_lshl_b32 s3, s3, 2
    s_and_b32 s65, s2, 3
    s_add_u32 s3, s3, s65
    s_and_b32 s65, s2, 4
    s_cselect_b32 s3, 0xffff, s3
    s_mul_i32 s65, s3, 3072
    v_mul_u32_u24 v38, 24, v1
    s_cmp_ge_u32 s3, 98
    s_cselect_b32 s65, 0x40000000, s65
    s_mov_b32 s92, s6
    s_mov_b32 s93, s7
    s_mov_b32 s94, 0x493e0
    s_mov_b32 s95, 0x00020000
    buffer_load_dwordx3 v[4:6], v38, s[92:95], s65 offen offset:0
    buffer_load_dwordx3 v[8:10], v38, s[92:95], s65 offen offset:12
    buffer_load_dwordx3 v[12:14], v38, s[92:95], s65 offen offset:1536
    buffer_load_dwordx3 v[16:18], v38, s[92:95], s65 offen offset:1548
    s_mov_b32 s27, 0x830000
    buffer_load_dwordx4 v3, s[48:51], s64 offen lds
    s_load_dword s22, s[24:25], s27
    s_mov_b32 s28, s4
    s_mov_b32 s29, s5
    s_mov_b32 s30, 0x186a000
    s_mov_b32 s31, 0x00020000
    s_mov_b32 s92, s6
    s_mov_b32 s93, s7
    s_mov_b32 s94, 0x493e0
    s_mov_b32 s95, 0x00020000
    s_mov_b32 s36, s24
    s_mov_b32 s37, s25
    s_mov_b32 s38, 0x241a800
    s_mov_b32 s39, 0x00020000
    s_add_u32 s72, s24, 0x1e00000
    s_addc_u32 s73, s25, 0
    s_mov_b32 s74, 0x61a800
    s_mov_b32 s75, 0x00020000
    s_mov_b32 s52, s16
    s_mov_b32 s53, s17
    s_mov_b32 s54, 0x6000
    s_mov_b32 s55, 0x00020000
    s_mov_b32 s96, s18
    s_mov_b32 s97, s19
    s_mov_b32 s98, 0x1800
    s_mov_b32 s99, 0x00020000
    s_mov_b32 s68, s12
    s_mov_b32 s69, s13
    s_mov_b32 s70, 0x20
    s_mov_b32 s71, 0x00020000
    s_mov_b32 s32, s20
    s_mov_b32 s33, s21
    s_mov_b32 s34, 0x186a000
    s_mov_b32 s35, 0x00020000
    v_bfe_u32 v122, v1, 2, 2
    v_lshl_add_u32 v122, v119, 3, v122
    v_lshlrev_b32 v122, 7, v122
    v_and_b32 v39, 3, v1
    v_lshl_add_u32 v122, v39, 3, v122
    s_cmp_ge_u32 s3, 98
    s_nop 0
    s_cbranch_scc1 P_w7n
    s_mov_b32 s60, 0x41800000
    s_movk_i32 s65, 0xf8
    v_lshlrev_b32 v38, 3, v1
    s_mul_i32 s27, s3, 1024
    s_add_u32 s27, s27, 0x810000
    s_waitcnt vmcnt(3)
    v_lshlrev_b32 v68, 16, v4
    v_and_b32 v69, s58, v4
    v_lshlrev_b32 v70, 16, v5
    v_and_b32 v71, s58, v5
    v_lshlrev_b32 v72, 16, v6
    v_and_b32 v73, s58, v6
    v_lshlrev_b32 v74, 16, v8
    v_and_b32 v75, s58, v8
    v_lshlrev_b32 v76, 16, v9
    v_and_b32 v77, s58, v9
    v_lshlrev_b32 v78, 16, v10
    v_and_b32 v79, s58, v10
    v_mul_f32 v68, s60, v68
    v_mul_f32 v69, s60, v69
    v_mul_f32 v70, s60, v70
    v_mul_f32 v71, s60, v71
    v_mul_f32 v72, s60, v72
    v_mul_f32 v73, s60, v73
    v_mul_f32 v74, s60, v74
    v_mul_f32 v75, s60, v75
    v_mul_f32 v76, s60, v76
    v_mul_f32 v77, s60, v77
    v_mul_f32 v78, s60, v78
    v_mul_f32 v79, s60, v79
    v_cvt_flr_i32_f32 v68, v68
    v_cvt_flr_i32_f32 v69, v69
    v_cvt_flr_i32_f32 v70, v70
    v_cvt_flr_i32_f32 v71, v71
    v_cvt_flr_i32_f32 v72, v72
    v_cvt_flr_i32_f32 v73, v73
    v_cvt_flr_i32_f32 v74, v74
    v_cvt_flr_i32_f32 v75, v75
    v_cvt_flr_i32_f32 v76, v76
    v_cvt_flr_i32_f32 v77, v77
    v_cvt_flr_i32_f32 v78, v78
    v_cvt_flr_i32_f32 v79, v79
    v_bfe_u32 v84, v70, 5, 3
    v_bfe_u32 v85, v70, 2, 3
    v_and_or_b32 v68, v68, s65, v84
    v_and_or_b32 v69, v69, s65, v85
    v_lshl_or_b32 v68, v69, 8, v68
    v_bfe_u32 v84, v73, 5, 3
    v_bfe_u32 v85, v73, 2, 3
    v_and_or_b32 v71, v71, s65, v84
    v_and_or_b32 v72, v72, s65, v85
    v_lshl_or_b32 v71, v72, 8, v71
    v_bfe_u32 v84, v76, 5, 3
    v_bfe_u32 v85, v76, 2, 3
    v_and_or_b32 v74, v74, s65, v84
    v_and_or_b32 v75, v75, s65, v85
    v_lshl_or_b32 v74, v75, 8, v74
    v_bfe_u32 v84, v79, 5, 3
    v_bfe_u32 v85, v79, 2, 3
    v_and_or_b32 v77, v77, s65, v84
    v_and_or_b32 v78, v78, s65, v85
    v_lshl_or_b32 v77, v78, 8, v77
    v_lshl_or_b32 v86, v71, 16, v68
    v_lshl_or_b32 v87, v77, 16, v74
    buffer_store_dwordx2 v[86:87], v38, s[36:39], s27 offen offset:0 sc1
    s_waitcnt vmcnt(2)
    v_lshlrev_b32 v68, 16, v12
    v_and_b32 v69, s58, v12
    v_lshlrev_b32 v70, 16, v13
    v_and_b32 v71, s58, v13
    v_lshlrev_b32 v72, 16, v14
    v_and_b32 v73, s58, v14
    v_lshlrev_b32 v74, 16, v16
    v_and_b32 v75, s58, v16
    v_lshlrev_b32 v76, 16, v17
    v_and_b32 v77, s58, v17
    v_lshlrev_b32 v78, 16, v18
    v_and_b32 v79, s58, v18
    v_mul_f32 v68, s60, v68
    v_mul_f32 v69, s60, v69
    v_mul_f32 v70, s60, v70
    v_mul_f32 v71, s60, v71
    v_mul_f32 v72, s60, v72
    v_mul_f32 v73, s60, v73
    v_mul_f32 v74, s60, v74
    v_mul_f32 v75, s60, v75
    v_mul_f32 v76, s60, v76
    v_mul_f32 v77, s60, v77
    v_mul_f32 v78, s60, v78
    v_mul_f32 v79, s60, v79
    v_cvt_flr_i32_f32 v68, v68
    v_cvt_flr_i32_f32 v69, v69
    v_cvt_flr_i32_f32 v70, v70
    v_cvt_flr_i32_f32 v71, v71
    v_cvt_flr_i32_f32 v72, v72
    v_cvt_flr_i32_f32 v73, v73
    v_cvt_flr_i32_f32 v74, v74
    v_cvt_flr_i32_f32 v75, v75
    v_cvt_flr_i32_f32 v76, v76
    v_cvt_flr_i32_f32 v77, v77
    v_cvt_flr_i32_f32 v78, v78
    v_cvt_flr_i32_f32 v79, v79
    v_bfe_u32 v84, v70, 5, 3
    v_bfe_u32 v85, v70, 2, 3
    v_and_or_b32 v68, v68, s65, v84
    v_and_or_b32 v69, v69, s65, v85
    v_lshl_or_b32 v68, v69, 8, v68
    v_bfe_u32 v84, v73, 5, 3
    v_bfe_u32 v85, v73, 2, 3
    v_and_or_b32 v71, v71, s65, v84
    v_and_or_b32 v72, v72, s65, v85
    v_lshl_or_b32 v71, v72, 8, v71
    v_bfe_u32 v84, v76, 5, 3
    v_bfe_u32 v85, v76, 2, 3
    v_and_or_b32 v74, v74, s65, v84
    v_and_or_b32 v75, v75, s65, v85
    v_lshl_or_b32 v74, v75, 8, v74
    v_bfe_u32 v84, v79, 5, 3
    v_bfe_u32 v85, v79, 2, 3
    v_and_or_b32 v77, v77, s65, v84
    v_and_or_b32 v78, v78, s65, v85
    v_lshl_or_b32 v77, v78, 8, v77
    v_lshl_or_b32 v88, v71, 16, v68
    v_lshl_or_b32 v89, v77, 16, v74
    buffer_store_dwordx2 v[88:89], v38, s[36:39], s27 offen offset:512 sc1
    s_nop 0
P_w7n:
    buffer_load_dwordx4 v[20:23], v121, s[28:31], s76 offen offset:0
    buffer_load_dwordx4 v[24:27], v121, s[28:31], s76 offen offset:64
    s_waitcnt lgkmcnt(0)
    v_lshrrev_b32 v124, 5, v1
    v_and_b32 v125, 31, v1
    v_mul_u32_u24 v124, 3072, v124
    v_lshl_add_u32 v124, v125, 2, v124
    s_lshr_b32 s60, s26, 2
    s_and_b32 s61, s26, 3
    s_mul_i32 s63, s61, 768
    s_lshl_b32 s65, s60, 7
    s_add_u32 s63, s63, s65
    s_add_u32 s65, s63, 0
    buffer_load_dword v128, v124, s[52:55], s65 offen
    s_add_u32 s65, s63, 6144
    buffer_load_dword v129, v124, s[52:55], s65 offen
    s_add_u32 s65, s63, 12288
    buffer_load_dword v130, v124, s[52:55], s65 offen
    s_add_u32 s65, s63, 18432
    buffer_load_dword v131, v124, s[52:55], s65 offen
    s_add_u32 s65, s63, 384
    buffer_load_dword v132, v124, s[52:55], s65 offen
    s_add_u32 s65, s63, 6528
    buffer_load_dword v133, v124, s[52:55], s65 offen
    s_add_u32 s65, s63, 12672
    buffer_load_dword v134, v124, s[52:55], s65 offen
    s_add_u32 s65, s63, 18816
    buffer_load_dword v135, v124, s[52:55], s65 offen
    s_cmp_ge_u32 s26, 4
    s_cbranch_scc1 P_e2c
    s_add_u32 s27, s26, 8
    s_lshr_b32 s60, s27, 2
    s_and_b32 s61, s27, 3
    s_mul_i32 s63, s61, 768
    s_lshl_b32 s65, s60, 7
    s_add_u32 s63, s63, s65
    s_add_u32 s65, s63, 0
    buffer_load_dword v136, v124, s[52:55], s65 offen
    s_add_u32 s65, s63, 6144
    buffer_load_dword v137, v124, s[52:55], s65 offen
    s_add_u32 s65, s63, 12288
    buffer_load_dword v138, v124, s[52:55], s65 offen
    s_add_u32 s65, s63, 18432
    buffer_load_dword v139, v124, s[52:55], s65 offen
    s_add_u32 s65, s63, 384
    buffer_load_dword v140, v124, s[52:55], s65 offen
    s_add_u32 s65, s63, 6528
    buffer_load_dword v141, v124, s[52:55], s65 offen
    s_add_u32 s65, s63, 12672
    buffer_load_dword v142, v124, s[52:55], s65 offen
    s_add_u32 s65, s63, 18816
    buffer_load_dword v143, v124, s[52:55], s65 offen
    s_branch P_e3c
P_e2c:
    s_sub_u32 s60, s26, 4
    s_lshl_b32 s63, s60, 7
    s_cmp_eq_u32 s26, 7
    s_cselect_b32 s63, 0x40000000, s63
    buffer_load_dword v136, v124, s[96:99], s63 offen offset:0
    buffer_load_dword v137, v124, s[96:99], s63 offen offset:384
    buffer_load_dword v138, v124, s[96:99], s63 offen offset:768
    buffer_load_dword v139, v124, s[96:99], s63 offen offset:1152
    buffer_load_dword v140, v124, s[96:99], s63 offen offset:1536
    buffer_load_dword v141, v124, s[96:99], s63 offen offset:1920
    buffer_load_dword v142, v124, s[96:99], s63 offen offset:2304
    buffer_load_dword v143, v124, s[96:99], s63 offen offset:2688
P_e3c:
    v_mul_u32_u24 v124, 6, v0
    v_and_b32 v124, -4, v124
    v_cmp_gt_u32 vcc, 200, v0
    s_nop 1
    v_cndmask_b32 v124, v118, v124, vcc
    s_mul_i32 s27, s2, 1200
    buffer_load_dwordx2 v[144:145], v124, s[92:95], s27 offen
    v_lshlrev_b32 v124, 1, v1
    buffer_load_ushort v146, v124, s[68:71], 0 offen
    s_waitcnt vmcnt(20) lgkmcnt(0)
    s_add_u32 s22, s22, 1
    v_mov_b32 v38, s22
    v_mov_b32 v39, 131072
    ds_write_b32 v39, v38
    s_cmp_ge_u32 s3, 98
    s_cbranch_scc1 P_join
    s_lshl_b32 s27, s3, 3
    s_add_u32 s27, s27, 0x830100
    v_mov_b32 v8, s22
    v_mov_b32 v9, s22
    v_mov_b32 v12, 0
    s_mov_b64 exec, 1
    buffer_store_dwordx2 v[8:9], v12, s[36:39], s27 offen sc1
    s_mov_b64 exec, -1
    s_branch P_join
P_bin:
WUP_413:
    s_cbranch_execz WUR_0
    s_mov_b32 s63, 0x147AE15
    s_movk_i32 s65, -200
    s_mov_b32 s60, 8192
    s_mov_b32 s61, 131840
    s_mov_b64 exec, s[56:57]
    s_waitcnt vmcnt(3)
    s_mov_b64 exec, -1
    buffer_load_dwordx4 v[20:23], v121, s[28:31], s76 offen offset:0
    buffer_load_dwordx4 v[24:27], v121, s[28:31], s76 offen offset:64
    buffer_load_dwordx4 v[28:31], v36, s[28:31], s77 offen offset:0
    buffer_load_dwordx4 v[32:35], v36, s[28:31], s77 offen offset:64
    v_lshrrev_b32 v124, 5, v1
    v_and_b32 v125, 31, v1
    v_mul_u32_u24 v124, 3072, v124
    v_lshl_add_u32 v124, v125, 2, v124
    s_lshr_b32 s60, s26, 2
    s_and_b32 s61, s26, 3
    s_mul_i32 s63, s61, 768
    s_lshl_b32 s65, s60, 7
    s_add_u32 s63, s63, s65
    s_add_u32 s65, s63, 0
    buffer_load_dword v128, v124, s[52:55], s65 offen
    s_add_u32 s65, s63, 6144
    buffer_load_dword v129, v124, s[52:55], s65 offen
    s_add_u32 s65, s63, 12288
    buffer_load_dword v130, v124, s[52:55], s65 offen
    s_add_u32 s65, s63, 18432
    buffer_load_dword v131, v124, s[52:55], s65 offen
    s_add_u32 s65, s63, 384
    buffer_load_dword v132, v124, s[52:55], s65 offen
    s_add_u32 s65, s63, 6528
    buffer_load_dword v133, v124, s[52:55], s65 offen
    s_add_u32 s65, s63, 12672
    buffer_load_dword v134, v124, s[52:55], s65 offen
    s_add_u32 s65, s63, 18816
    buffer_load_dword v135, v124, s[52:55], s65 offen
    s_cmp_ge_u32 s26, 4
    s_cbranch_scc1 P_e2a
    s_add_u32 s27, s26, 8
    s_lshr_b32 s60, s27, 2
    s_and_b32 s61, s27, 3
    s_mul_i32 s63, s61, 768
    s_lshl_b32 s65, s60, 7
    s_add_u32 s63, s63, s65
    s_add_u32 s65, s63, 0
    buffer_load_dword v136, v124, s[52:55], s65 offen
    s_add_u32 s65, s63, 6144
    buffer_load_dword v137, v124, s[52:55], s65 offen
    s_add_u32 s65, s63, 12288
    buffer_load_dword v138, v124, s[52:55], s65 offen
    s_add_u32 s65, s63, 18432
    buffer_load_dword v139, v124, s[52:55], s65 offen
    s_add_u32 s65, s63, 384
    buffer_load_dword v140, v124, s[52:55], s65 offen
    s_add_u32 s65, s63, 6528
    buffer_load_dword v141, v124, s[52:55], s65 offen
    s_add_u32 s65, s63, 12672
    buffer_load_dword v142, v124, s[52:55], s65 offen
    s_add_u32 s65, s63, 18816
    buffer_load_dword v143, v124, s[52:55], s65 offen
    s_branch P_e3a
P_e2a:
    s_sub_u32 s60, s26, 4
    s_lshl_b32 s63, s60, 7
    s_cmp_eq_u32 s26, 7
    s_cselect_b32 s63, 0x40000000, s63
    buffer_load_dword v136, v124, s[96:99], s63 offen offset:0
    buffer_load_dword v137, v124, s[96:99], s63 offen offset:384
    buffer_load_dword v138, v124, s[96:99], s63 offen offset:768
    buffer_load_dword v139, v124, s[96:99], s63 offen offset:1152
    buffer_load_dword v140, v124, s[96:99], s63 offen offset:1536
    buffer_load_dword v141, v124, s[96:99], s63 offen offset:1920
    buffer_load_dword v142, v124, s[96:99], s63 offen offset:2304
    buffer_load_dword v143, v124, s[96:99], s63 offen offset:2688
P_e3a:
    v_mul_u32_u24 v124, 6, v0
    v_and_b32 v124, -4, v124
    v_cmp_gt_u32 vcc, 200, v0
    s_nop 1
    v_cndmask_b32 v124, v118, v124, vcc
    s_mul_i32 s27, s2, 1200
    buffer_load_dwordx2 v[144:145], v124, s[92:95], s27 offen
    v_lshlrev_b32 v124, 1, v1
    buffer_load_ushort v146, v124, s[68:71], 0 offen
    s_mov_b32 s63, 0x147AE15
    s_movk_i32 s65, -200
    s_mov_b32 s60, 8192
    s_mov_b32 s61, 131840
    s_mov_b64 exec, s[56:57]
    v_mul_hi_u32 v68, v4, s63
    v_lshl_add_u32 v84, v68, 2, s60
    ds_add_rtn_u32 v76, v84, v116
    v_mul_hi_u32 v69, v5, s63
    v_lshl_add_u32 v85, v69, 2, s60
    ds_add_rtn_u32 v77, v85, v116
    v_mul_hi_u32 v70, v6, s63
    v_lshl_add_u32 v86, v70, 2, s60
    ds_add_rtn_u32 v78, v86, v116
    v_mul_hi_u32 v71, v7, s63
    v_lshl_add_u32 v87, v71, 2, s60
    ds_add_rtn_u32 v79, v87, v116
    s_waitcnt vmcnt(24)
    v_mul_hi_u32 v72, v8, s63
    v_lshl_add_u32 v88, v72, 2, s60
    ds_add_rtn_u32 v80, v88, v116
    v_mul_hi_u32 v73, v9, s63
    v_lshl_add_u32 v89, v73, 2, s60
    ds_add_rtn_u32 v81, v89, v116
    v_mul_hi_u32 v74, v10, s63
    v_lshl_add_u32 v90, v74, 2, s60
    ds_add_rtn_u32 v82, v90, v116
    v_mul_hi_u32 v75, v11, s63
    v_lshl_add_u32 v91, v75, 2, s60
    ds_add_rtn_u32 v83, v91, v116
    v_mad_i32_i24 v4, v68, s65, v4
    v_lshlrev_b32 v4, 24, v4
    v_lshl_add_u32 v84, v68, 7, s61
    v_mad_i32_i24 v5, v69, s65, v5
    v_lshlrev_b32 v5, 24, v5
    v_lshl_add_u32 v85, v69, 7, s61
    v_mad_i32_i24 v6, v70, s65, v6
    v_lshlrev_b32 v6, 24, v6
    v_lshl_add_u32 v86, v70, 7, s61
    v_mad_i32_i24 v7, v71, s65, v7
    v_lshlrev_b32 v7, 24, v7
    v_lshl_add_u32 v87, v71, 7, s61
    v_mad_i32_i24 v8, v72, s65, v8
    v_lshlrev_b32 v8, 24, v8
    v_lshl_add_u32 v88, v72, 7, s61
    v_mad_i32_i24 v9, v73, s65, v9
    v_lshlrev_b32 v9, 24, v9
    v_lshl_add_u32 v89, v73, 7, s61
    v_mad_i32_i24 v10, v74, s65, v10
    v_lshlrev_b32 v10, 24, v10
    v_lshl_add_u32 v90, v74, 7, s61
    v_mad_i32_i24 v11, v75, s65, v11
    v_lshlrev_b32 v11, 24, v11
WUP_548:
    s_cbranch_execz WUP_721
    v_lshl_add_u32 v91, v75, 7, s61
    s_waitcnt vmcnt(22)
    v_lshl_or_b32 v92, v12, 1, v4
    v_lshl_or_b32 v93, v13, 1, v5
    v_lshl_or_b32 v94, v14, 1, v6
    v_lshl_or_b32 v95, v15, 1, v7
    v_lshl_or_b32 v96, v16, 1, v8
    v_lshl_or_b32 v97, v17, 1, v9
    v_lshl_or_b32 v98, v18, 1, v10
    v_lshl_or_b32 v99, v19, 1, v11
    s_waitcnt lgkmcnt(0)
    v_max3_u32 v36, v76, v77, v78
    v_max3_u32 v37, v79, v80, v81
    v_max3_u32 v36, v36, v82, v83
    v_max_u32 v36, v36, v37
    v_lshl_add_u32 v12, v76, 2, v84
    v_lshl_add_u32 v13, v77, 2, v85
    v_lshl_add_u32 v14, v78, 2, v86
    v_lshl_add_u32 v15, v79, 2, v87
    v_lshl_add_u32 v16, v80, 2, v88
    v_lshl_add_u32 v17, v81, 2, v89
    v_lshl_add_u32 v18, v82, 2, v90
    v_lshl_add_u32 v19, v83, 2, v91
    v_cmp_lt_u32 vcc, 30, v36
    s_nop 4
    s_cbranch_vccnz P_rare
    ds_write_b32 v12, v92
    ds_write_b32 v13, v93
    ds_write_b32 v14, v94
    ds_write_b32 v15, v95
    ds_write_b32 v16, v96
    ds_write_b32 v17, v97
    ds_write_b32 v18, v98
    ds_write_b32 v19, v99
    s_mov_b64 exec, -1
P_join:
    s_lshl_b32 s23, s2, 15
    v_mov_b32 v4, 131072
    s_waitcnt lgkmcnt(0)
    s_mov_b64 exec, 0
    s_cmp_eq_u32 s26, 0
    s_cbranch_scc1 WUP_2301
    s_cmp_eq_u32 s26, 1
    s_cbranch_scc1 WUP_2488
    s_cmp_eq_u32 s26, 2
    s_cbranch_scc1 WUP_2660
    s_cmp_eq_u32 s26, 3
    s_cbranch_scc1 WUP_3315
WUR_1:
    s_mov_b64 exec, -1
    s_barrier
    ds_read_b64 v[4:5], v4
    ds_read_b128 v[100:103], v117 offset:0
    ds_read_b128 v[104:107], v117 offset:8192
    ds_read_b128 v[108:111], v117 offset:16384
    ds_read_b128 v[112:115], v117 offset:24576
    s_waitcnt lgkmcnt(4)
    v_readfirstlane_b32 s18, v4
    v_readfirstlane_b32 s19, v5
    s_bfe_u32 s8, s18, 0x70001
    s_lshl_b32 s8, s8, 17
    s_bfe_u32 s27, s18, 0x10000
    s_or_b32 s8, s8, s27
    s_bfe_u32 s9, s18, 0x70009
    s_lshl_b32 s9, s9, 17
    s_bfe_u32 s27, s18, 0x10008
    s_or_b32 s9, s9, s27
    s_bfe_u32 s10, s18, 0x70011
    s_lshl_b32 s10, s10, 17
    s_bfe_u32 s27, s18, 0x10010
    s_or_b32 s10, s10, s27
    s_bfe_u32 s11, s18, 0x70019
    s_lshl_b32 s11, s11, 17
    s_bfe_u32 s27, s18, 0x10018
    s_or_b32 s11, s11, s27
    s_cmp_eq_u32 s19, 0
    s_cbranch_scc1 P_noovf
    v_mov_b32 v4, 131080
    ds_read_b32 v4, v4
    v_mov_b32 v5, 0
    s_add_u32 s27, s23, 32124
    s_waitcnt lgkmcnt(0)
    buffer_store_dword v4, v5, s[36:39], s27 offen sc1
    s_waitcnt vmcnt(0)
    s_barrier
P_noovf:
    s_waitcnt lgkmcnt(3)
    v_xor_b32 v100, s8, v100
    v_xor_b32 v101, s9, v101
    v_xor_b32 v102, s10, v102
    v_xor_b32 v103, s11, v103
    buffer_store_dwordx4 v[100:103], v2, s[36:39], s23 offen sc1
    s_waitcnt lgkmcnt(2)
    v_xor_b32 v104, s8, v104
    v_xor_b32 v105, s9, v105
    v_xor_b32 v106, s10, v106
    v_xor_b32 v107, s11, v107
    s_add_u32 s59, s23, 8192
    buffer_store_dwordx4 v[104:107], v2, s[36:39], s59 offen sc1
    s_waitcnt lgkmcnt(1)
    v_xor_b32 v108, s8, v108
    v_xor_b32 v109, s9, v109
    v_xor_b32 v110, s10, v110
    v_xor_b32 v111, s11, v111
    s_add_u32 s59, s23, 16384
    buffer_store_dwordx4 v[108:111], v2, s[36:39], s59 offen sc1
    s_waitcnt lgkmcnt(0)
    v_xor_b32 v112, s8, v112
    v_xor_b32 v113, s9, v113
    v_xor_b32 v114, s10, v114
    v_xor_b32 v115, s11, v115
    s_mov_b64 exec, s[66:67]
    s_add_u32 s59, s23, 24576
    buffer_store_dwordx4 v[112:115], v2, s[36:39], s59 offen sc1
    s_mov_b64 exec, -1
    ds_read_b64_tr_b16 v[36:37], v122 offset:0
    ds_read_b64_tr_b16 v[38:39], v122 offset:512
    ds_read_b64_tr_b16 v[40:41], v122 offset:4096
    ds_read_b64_tr_b16 v[42:43], v122 offset:4608
    ds_read_b64_tr_b16 v[44:45], v122 offset:32
    ds_read_b64_tr_b16 v[46:47], v122 offset:544
    ds_read_b64_tr_b16 v[48:49], v122 offset:4128
    ds_read_b64_tr_b16 v[50:51], v122 offset:4640
    ds_read_b64_tr_b16 v[52:53], v122 offset:64
    ds_read_b64_tr_b16 v[54:55], v122 offset:576
    ds_read_b64_tr_b16 v[56:57], v122 offset:4160
    ds_read_b64_tr_b16 v[58:59], v122 offset:4672
    ds_read_b64_tr_b16 v[60:61], v122 offset:96
    ds_read_b64_tr_b16 v[62:63], v122 offset:608
    ds_read_b64_tr_b16 v[64:65], v122 offset:4192
    ds_read_b64_tr_b16 v[66:67], v122 offset:4704
    v_and_b32 v250, -2, v1
    v_add_lshl_u32 v250, v250, v1, 7
    v_cmp_gt_u32 vcc, 10, v1
    s_nop 1
    v_cndmask_b32 v250, v118, v250, vcc
    s_mul_i32 s65, s2, 102400
    s_mul_i32 s63, s26, 12800
    s_add_u32 s65, s65, s63
    buffer_load_dword v158, v250, s[28:31], s65 offen offset:256
    v_mov_b32 v5, 0xbfb8aa3b
    v_mov_b32 v6, 1.0
    v_lshlrev_b32 v123, 9, v119
    v_lshl_add_u32 v123, v120, 3, v123
    s_lshl_b32 s27, s62, 7
    s_waitcnt lgkmcnt(0)
    s_barrier
    s_mul_i32 s20, s2, 102400
    s_mul_i32 s21, s26, 12800
    s_add_u32 s20, s20, s21
    s_add_u32 s20, s4, s20
    s_addc_u32 s21, s5, 0
    s_waitcnt vmcnt(23)
    s_cmp_gt_u32 s26, 4
    s_cbranch_scc0 P_np
    s_setprio 2
P_np:
    v_mfma_f32_16x16x32_bf16 v[68:71], v[20:23], v[36:39], 0
    v_mfma_f32_16x16x32_bf16 v[72:75], v[20:23], v[44:47], 0
    v_mfma_f32_16x16x32_bf16 v[76:79], v[20:23], v[52:55], 0
    v_mfma_f32_16x16x32_bf16 v[80:83], v[20:23], v[60:63], 0
    v_mfma_f32_16x16x32_bf16 v[68:71], v[24:27], v[40:43], v[68:71]
    v_mfma_f32_16x16x32_bf16 v[72:75], v[24:27], v[48:51], v[72:75]
    v_mfma_f32_16x16x32_bf16 v[76:79], v[24:27], v[56:59], v[76:79]
    v_mfma_f32_16x16x32_bf16 v[80:83], v[24:27], v[64:67], v[80:83]
    s_nop 4
    v_cvt_pk_bf16_f32 v68, 0, v68
    v_cvt_pk_bf16_f32 v69, 0, v69
    v_cvt_pk_bf16_f32 v70, 0, v70
    v_cvt_pk_bf16_f32 v71, 0, v71
    v_cvt_pk_bf16_f32 v72, 0, v72
    v_cvt_pk_bf16_f32 v73, 0, v73
    v_cvt_pk_bf16_f32 v74, 0, v74
    v_cvt_pk_bf16_f32 v75, 0, v75
    v_cvt_pk_bf16_f32 v76, 0, v76
    v_cvt_pk_bf16_f32 v77, 0, v77
    v_cvt_pk_bf16_f32 v78, 0, v78
WUP_721:
    s_cbranch_execz WUR_0
    v_cvt_pk_bf16_f32 v79, 0, v79
    v_cvt_pk_bf16_f32 v80, 0, v80
    v_cvt_pk_bf16_f32 v81, 0, v81
    v_cvt_pk_bf16_f32 v82, 0, v82
    v_cvt_pk_bf16_f32 v83, 0, v83
    v_mul_f32 v84, v5, v68
    v_mul_f32 v85, v5, v69
    v_mul_f32 v86, v5, v70
    v_mul_f32 v87, v5, v71
    v_mul_f32 v88, v5, v72
    v_mul_f32 v89, v5, v73
    v_mul_f32 v90, v5, v74
    v_mul_f32 v91, v5, v75
    v_mul_f32 v92, v5, v76
    v_mul_f32 v93, v5, v77
    v_mul_f32 v94, v5, v78
    v_mul_f32 v95, v5, v79
    v_mul_f32 v96, v5, v80
    v_mul_f32 v97, v5, v81
    v_mul_f32 v98, v5, v82
    v_mul_f32 v99, v5, v83
    v_exp_f32 v84, v84
    v_exp_f32 v85, v85
    v_exp_f32 v86, v86
    v_exp_f32 v87, v87
    v_exp_f32 v88, v88
    v_exp_f32 v89, v89
    v_exp_f32 v90, v90
    v_exp_f32 v91, v91
    v_exp_f32 v92, v92
    v_exp_f32 v93, v93
    v_exp_f32 v94, v94
    v_exp_f32 v95, v95
    v_exp_f32 v96, v96
    v_exp_f32 v97, v97
    v_exp_f32 v98, v98
    v_exp_f32 v99, v99
    v_add_f32 v84, v6, v84
    v_add_f32 v85, v6, v85
    v_add_f32 v86, v6, v86
    v_add_f32 v87, v6, v87
    v_add_f32 v88, v6, v88
    v_add_f32 v89, v6, v89
    v_add_f32 v90, v6, v90
    v_add_f32 v91, v6, v91
    v_add_f32 v92, v6, v92
    v_add_f32 v93, v6, v93
    v_add_f32 v94, v6, v94
    v_add_f32 v95, v6, v95
    v_add_f32 v96, v6, v96
    v_add_f32 v97, v6, v97
    v_add_f32 v98, v6, v98
    v_add_f32 v99, v6, v99
    v_rcp_f32 v84, v84
    v_rcp_f32 v85, v85
    v_rcp_f32 v86, v86
    v_rcp_f32 v87, v87
    v_rcp_f32 v88, v88
    v_rcp_f32 v89, v89
    v_rcp_f32 v90, v90
    v_rcp_f32 v91, v91
    v_rcp_f32 v92, v92
    v_rcp_f32 v93, v93
    v_rcp_f32 v94, v94
    v_rcp_f32 v95, v95
    v_rcp_f32 v96, v96
    v_rcp_f32 v97, v97
    v_rcp_f32 v98, v98
    v_rcp_f32 v99, v99
    v_mul_f32 v84, v68, v84
    v_mul_f32 v85, v69, v85
    v_mul_f32 v86, v70, v86
    v_mul_f32 v87, v71, v87
    v_mul_f32 v88, v72, v88
    v_mul_f32 v89, v73, v89
    v_mul_f32 v90, v74, v90
    v_mul_f32 v91, v75, v91
    v_mul_f32 v92, v76, v92
    v_mul_f32 v93, v77, v93
    v_mul_f32 v94, v78, v94
    v_mul_f32 v95, v79, v95
    v_mul_f32 v96, v80, v96
    v_mul_f32 v97, v81, v97
    v_mul_f32 v98, v82, v98
    v_mul_f32 v99, v83, v99
    s_mov_b32 s63, 0x830100
    s_cmp_gt_u32 s26, 4
    s_cselect_b32 s63, s63, 0x40000000
    buffer_load_dwordx4 v[236:239], v3, s[36:39], s63 offen sc1
    v_cvt_pk_bf16_f32 v68, v84, v88
    v_cvt_pk_bf16_f32 v69, v92, v96
    buffer_store_dwordx2 v[68:69], v123, s[72:75], s27 offen offset:0 sc1
    v_cvt_pk_bf16_f32 v70, v85, v89
    v_cvt_pk_bf16_f32 v71, v93, v97
    buffer_store_dwordx2 v[70:71], v123, s[72:75], s27 offen offset:128 sc1
    v_cvt_pk_bf16_f32 v72, v86, v90
    v_cvt_pk_bf16_f32 v73, v94, v98
    buffer_store_dwordx2 v[72:73], v123, s[72:75], s27 offen offset:256 sc1
    v_cvt_pk_bf16_f32 v74, v87, v91
    v_cvt_pk_bf16_f32 v75, v95, v99
    buffer_store_dwordx2 v[74:75], v123, s[72:75], s27 offen offset:384 sc1
    s_cmp_gt_u32 s26, 4
    s_cbranch_scc1 M_e4x
    s_cmp_eq_u32 s26, 4
    s_cselect_b32 s63, 2, 4
    v_cmp_gt_u32 vcc, s63, v119
    s_nop 1
    v_cndmask_b32 v7, v118, v123, vcc
    s_add_u32 s27, s27, 16384
    v_mfma_f32_16x16x32_bf16 v[68:71], v[28:31], v[36:39], 0
    v_mfma_f32_16x16x32_bf16 v[72:75], v[28:31], v[44:47], 0
    v_mfma_f32_16x16x32_bf16 v[76:79], v[28:31], v[52:55], 0
    v_mfma_f32_16x16x32_bf16 v[80:83], v[28:31], v[60:63], 0
    v_mfma_f32_16x16x32_bf16 v[68:71], v[32:35], v[40:43], v[68:71]
    v_mfma_f32_16x16x32_bf16 v[72:75], v[32:35], v[48:51], v[72:75]
    v_mfma_f32_16x16x32_bf16 v[76:79], v[32:35], v[56:59], v[76:79]
    v_mfma_f32_16x16x32_bf16 v[80:83], v[32:35], v[64:67], v[80:83]
    s_nop 4
    v_cvt_pk_bf16_f32 v68, 0, v68
    v_cvt_pk_bf16_f32 v69, 0, v69
    v_cvt_pk_bf16_f32 v70, 0, v70
    v_cvt_pk_bf16_f32 v71, 0, v71
    v_cvt_pk_bf16_f32 v72, 0, v72
    v_cvt_pk_bf16_f32 v73, 0, v73
    v_cvt_pk_bf16_f32 v74, 0, v74
    v_cvt_pk_bf16_f32 v75, 0, v75
    v_cvt_pk_bf16_f32 v76, 0, v76
    v_cvt_pk_bf16_f32 v77, 0, v77
    v_cvt_pk_bf16_f32 v78, 0, v78
    v_cvt_pk_bf16_f32 v79, 0, v79
    v_cvt_pk_bf16_f32 v80, 0, v80
    v_cvt_pk_bf16_f32 v81, 0, v81
    v_cvt_pk_bf16_f32 v82, 0, v82
    v_cvt_pk_bf16_f32 v83, 0, v83
    v_mul_f32 v84, v5, v68
    v_mul_f32 v85, v5, v69
    v_mul_f32 v86, v5, v70
    v_mul_f32 v87, v5, v71
    v_mul_f32 v88, v5, v72
    v_mul_f32 v89, v5, v73
    v_mul_f32 v90, v5, v74
    v_mul_f32 v91, v5, v75
    v_mul_f32 v92, v5, v76
    v_mul_f32 v93, v5, v77
    v_mul_f32 v94, v5, v78
    v_mul_f32 v95, v5, v79
    v_mul_f32 v96, v5, v80
    v_mul_f32 v97, v5, v81
    v_mul_f32 v98, v5, v82
    v_mul_f32 v99, v5, v83
    v_exp_f32 v84, v84
    v_exp_f32 v85, v85
    v_exp_f32 v86, v86
    v_exp_f32 v87, v87
    v_exp_f32 v88, v88
    v_exp_f32 v89, v89
    v_exp_f32 v90, v90
    v_exp_f32 v91, v91
    v_exp_f32 v92, v92
    v_exp_f32 v93, v93
    v_exp_f32 v94, v94
    v_exp_f32 v95, v95
    v_exp_f32 v96, v96
    v_exp_f32 v97, v97
    v_exp_f32 v98, v98
    v_exp_f32 v99, v99
    v_add_f32 v84, v6, v84
    v_add_f32 v85, v6, v85
    v_add_f32 v86, v6, v86
    v_add_f32 v87, v6, v87
    v_add_f32 v88, v6, v88
    v_add_f32 v89, v6, v89
    v_add_f32 v90, v6, v90
    v_add_f32 v91, v6, v91
    v_add_f32 v92, v6, v92
    v_add_f32 v93, v6, v93
    v_add_f32 v94, v6, v94
    v_add_f32 v95, v6, v95
    v_add_f32 v96, v6, v96
    v_add_f32 v97, v6, v97
    v_add_f32 v98, v6, v98
    v_add_f32 v99, v6, v99
    v_rcp_f32 v84, v84
    v_rcp_f32 v85, v85
    v_rcp_f32 v86, v86
    v_rcp_f32 v87, v87
    v_rcp_f32 v88, v88
    v_rcp_f32 v89, v89
    v_rcp_f32 v90, v90
    v_rcp_f32 v91, v91
    v_rcp_f32 v92, v92
    v_rcp_f32 v93, v93
    v_rcp_f32 v94, v94
    v_rcp_f32 v95, v95
    v_rcp_f32 v96, v96
    v_rcp_f32 v97, v97
    v_rcp_f32 v98, v98
    v_rcp_f32 v99, v99
    v_mul_f32 v84, v68, v84
    v_mul_f32 v85, v69, v85
    v_mul_f32 v86, v70, v86
    v_mul_f32 v87, v71, v87
    v_mul_f32 v88, v72, v88
    v_mul_f32 v89, v73, v89
    v_mul_f32 v90, v74, v90
    v_mul_f32 v91, v75, v91
    v_mul_f32 v92, v76, v92
    v_mul_f32 v93, v77, v93
    v_mul_f32 v94, v78, v94
    v_mul_f32 v95, v79, v95
    v_mul_f32 v96, v80, v96
    v_mul_f32 v97, v81, v97
    v_mul_f32 v98, v82, v98
WUP_934:
    s_cbranch_execz WUP_1119
    v_mul_f32 v99, v83, v99
    v_cvt_pk_bf16_f32 v68, v84, v88
    v_cvt_pk_bf16_f32 v69, v92, v96
    buffer_store_dwordx2 v[68:69], v7, s[72:75], s27 offen offset:0 sc1
    v_cvt_pk_bf16_f32 v70, v85, v89
    v_cvt_pk_bf16_f32 v71, v93, v97
    buffer_store_dwordx2 v[70:71], v7, s[72:75], s27 offen offset:128 sc1
    v_cvt_pk_bf16_f32 v72, v86, v90
    v_cvt_pk_bf16_f32 v73, v94, v98
    buffer_store_dwordx2 v[72:73], v7, s[72:75], s27 offen offset:256 sc1
    v_cvt_pk_bf16_f32 v74, v87, v91
    v_cvt_pk_bf16_f32 v75, v95, v99
    buffer_store_dwordx2 v[74:75], v7, s[72:75], s27 offen offset:384 sc1
    s_nop 0
P_h2:
    s_mov_b32 s56, 0x05040100
    s_mov_b32 s57, 0x07060302
    s_waitcnt vmcnt(14)
M_e5:
    s_lshr_b32 s60, s26, 2
    s_and_b32 s61, s26, 3
    s_lshl_b32 s60, s60, 3
    s_add_u32 s60, s60, s61
    s_lshl_b32 s60, s60, 10
    s_movk_i32 s61, 4096
    v_perm_b32 v148, v129, v128, s56
    v_perm_b32 v152, v129, v128, s57
    v_perm_b32 v149, v131, v130, s56
    v_perm_b32 v153, v131, v130, s57
    v_perm_b32 v150, v133, v132, s56
    v_perm_b32 v154, v133, v132, s57
    v_perm_b32 v151, v135, v134, s56
    v_perm_b32 v155, v135, v134, s57
    v_add_u32 v156, s60, v3
    v_add_u32 v157, s61, v156
    ds_write_b128 v156, v[148:151]
    ds_write_b128 v157, v[152:155]
    s_cmp_eq_u32 s26, 7
    s_cbranch_scc1 M_w2
    s_add_u32 s27, s26, 8
    s_lshr_b32 s60, s27, 2
    s_and_b32 s61, s27, 3
    s_lshl_b32 s60, s60, 3
    s_add_u32 s60, s60, s61
    s_lshl_b32 s60, s60, 10
    s_movk_i32 s61, 4096
    s_cmp_lt_u32 s26, 4
    s_cbranch_scc1 M_w1
    s_sub_u32 s60, s26, 4
    s_lshl_b32 s60, s60, 11
    s_add_u32 s60, s60, 24576
    s_movk_i32 s61, 1024
M_w1:
    v_perm_b32 v148, v137, v136, s56
    v_perm_b32 v152, v137, v136, s57
    v_perm_b32 v149, v139, v138, s56
    v_perm_b32 v153, v139, v138, s57
    v_perm_b32 v150, v141, v140, s56
    v_perm_b32 v154, v141, v140, s57
    v_perm_b32 v151, v143, v142, s56
    v_perm_b32 v155, v143, v142, s57
    v_add_u32 v156, s60, v3
    v_add_u32 v157, s61, v156
    ds_write_b128 v156, v[148:151]
    ds_write_b128 v157, v[152:155]
M_w2:
    s_cmp_ge_u32 s26, 4
    s_cbranch_scc1 M_t4
    v_bfe_i32 v148, v0, 0, 1
    v_mov_b32 v149, 0x01000c0c
    s_mov_b32 s63, 0x02020000
    v_and_or_b32 v148, v148, s63, v149
    v_add_u32 v149, s63, v148
    v_add_u32 v150, s63, v149
    v_perm_b32 v152, v145, v144, v148
    v_perm_b32 v153, v145, v144, v149
    v_perm_b32 v154, v145, v144, v150
    s_mov_b32 s60, 0x41800000
    v_mul_f32 v148, s60, v152
    v_mul_f32 v149, s60, v153
    v_mul_f32 v150, s60, v154
    v_cvt_flr_i32_f32 v148, v148
    v_cvt_flr_i32_f32 v149, v149
    v_cvt_flr_i32_f32 v150, v150
    v_sub_u32 v148, 4, v148
    v_sub_u32 v149, 4, v149
    v_sub_u32 v150, 2, v150
    v_and_b32 v148, 0xff, v148
    v_and_b32 v149, 0xff, v149
    v_and_b32 v150, 0xff, v150
    v_lshl_or_b32 v148, v149, 8, v148
    v_lshl_or_b32 v148, v150, 16, v148
    v_mov_b32 v149, 0x7f000000
    v_cmp_gt_u32 vcc, 200, v0
    s_nop 1
    v_cndmask_b32 v148, v149, v148, vcc
    v_lshlrev_b32 v150, 2, v0
    v_add_u32 v150, 133120, v150
    ds_write_b32 v150, v148
    v_lshlrev_b32 v150, 4, v0
    v_add_u32 v150, 135168, v150
    s_mov_b64 exec, vcc
    ds_write_b96 v150, v[152:154]
    s_mov_b64 exec, -1
    s_branch M_t8
M_t4:
    s_cmp_eq_u32 s26, 4
    s_cbranch_scc0 M_t5
    v_lshlrev_b32 v150, 2, v1
    v_add_u32 v151, 132864, v150
    v_mov_b32 v148, 0
    ds_write_b32 v151, v148
    v_mov_b32 v151, 132672
    ds_write_b32 v151, v148
    v_add_u32 v151, 132608, v150
    v_lshlrev_b32 v148, 16, v146
    s_mov_b64 exec, 0xffff
    ds_write_b32 v151, v148
    s_mov_b64 exec, -1
    s_branch M_t8
M_t5:
M_t8:
    v_lshrrev_b32 v24, 2, v1
    v_lshlrev_b32 v24, 15, v24
    v_and_b32 v25, 3, v1
    v_lshl_add_u32 v24, v25, 4, v24
    s_lshl_b32 s27, s26, 20
    s_lshl_b32 s53, s2, 7
    s_add_u32 s27, s27, s53
    s_add_u32 s53, s27, 524288
    s_mov_b64 s[60:61], -1
    s_cmp_eq_u32 s26, 7
    s_cselect_b32 s61, 0xff, s61
    s_xor_b32 s63, s8, 0xff000000
    v_mov_b32 v164, s63
    v_mov_b32 v172, s63
    s_xor_b32 s63, s9, 0xff000000
    v_mov_b32 v165, s63
    v_mov_b32 v173, s63
    s_xor_b32 s63, s10, 0xff000000
    v_mov_b32 v166, s63
    v_mov_b32 v174, s63
    s_xor_b32 s63, s11, 0xff000000
    v_mov_b32 v167, s63
    v_mov_b32 v175, s63
    buffer_load_dwordx4 v[160:163], v24, s[36:39], s27 offen sc1
    s_mov_b64 exec, s[60:61]
    buffer_load_dwordx4 v[164:167], v24, s[36:39], s53 offen sc1
    s_mov_b64 exec, -1
    buffer_load_dwordx4 v[168:171], v24, s[36:39], s27 offen offset:64 sc1
    s_mov_b64 exec, s[60:61]
    buffer_load_dwordx4 v[172:175], v24, s[36:39], s53 offen offset:64 sc1
    s_mov_b64 exec, -1
    v_lshlrev_b32 v1, 4, v1
    v_lshrrev_b32 v8, 4, v1
    v_lshrrev_b32 v10, 5, v8
    v_and_b32 v11, 31, v8
    s_mov_b32 s6, 0x186a000
    s_mov_b32 s7, 0x00020000
    s_mul_i32 s44, s2, 102400
    s_mul_i32 s51, s26, 12800
    s_add_u32 s51, s51, 30720
    s_mul_i32 s52, s26, 3840
    s_add_u32 s52, s52, 133120
    s_mov_b32 s67, 120320
    s_mov_b32 s3, 132864
    v_lshrrev_b32 v8, 4, v1
    v_lshrrev_b32 v10, 5, v8
    v_and_b32 v11, 31, v8
    v_lshlrev_b32 v3, 4, v11
    v_add_u32 v3, s52, v3
    v_mul_u32_u24 v0, 56, v10
    v_add_u32 v0, s52, v0
    v_lshrrev_b32 v13, 3, v11
    v_lshl_add_u32 v4, v13, 3, v0
    v_lshrrev_b32 v13, 3, v8
    v_and_b32 v14, 1, v13
    v_lshrrev_b32 v13, 1, v13
    v_lshl_add_u32 v13, v14, 2, v13
    v_lshlrev_b32 v5, 4, v13
    v_add_u32 v5, s52, v5
    v_add_u32 v16, s52, v1
    v_lshrrev_b32 v17, 2, v8
    v_mul_u32_u24 v17, 56, v17
    v_and_b32 v13, 3, v8
    v_lshl_add_u32 v17, v13, 1, v17
    v_add_u32 v17, s52, v17
    v_lshlrev_b32 v2, 7, v10
    v_lshl_add_u32 v2, v11, 2, v2
    v_add_u32 v2, s51, v2
    v_and_b32 v13, 7, v11
    v_lshlrev_b32 v13, 1, v13
WUP_1119:
    s_cbranch_execz WUR_0
    v_sub_u32 v13, 14, v13
    v_lshl_or_b32 v6, v13, 16, v13
    v_lshlrev_b32 v7, 5, v10
    v_add_u32 v7, 132608, v7
    v_lshlrev_b32 v20, 2, v8
    v_add_u32 v30, 132864, v20
    v_mov_b32 v9, 132672
    v_mov_b32 v18, 0xfc
    v_mov_b32 v19, 1
    s_mov_b32 s12, 0x1fffe
    s_movk_i32 s13, 130
    s_mov_b32 s14, 0xfc0000
    s_movk_i32 s15, 7800
    s_lshl_b32 s17, s26, 10
    s_add_u32 s17, s17, 138368
    s_mov_b32 s16, s17
    v_add_u32 v26, 134144, v20
    v_add_u32 v27, 134144, v1
    s_mov_b32 s62, 0xfe0001
    s_mov_b32 s65, 0
    s_waitcnt vmcnt(4)
    v_mov_b32 v148, 131084
    s_mov_b64 exec, 1
    ds_add_rtn_u32 v149, v148, v19
    s_lshl_b32 s63, s2, 2
    s_add_u32 s63, s63, 0x830800
    v_mov_b32 v150, s18
    v_mov_b32 v151, 0
    s_waitcnt lgkmcnt(0)
    v_readfirstlane_b32 s19, v149
    s_cmp_eq_u32 s19, 7
    s_cselect_b32 s63, s63, 0x40000000
    buffer_store_dword v150, v151, s[36:39], s63 offen sc1
    s_mov_b64 exec, -1
    s_waitcnt vmcnt(1)
    s_branch M_cw2
M_cw:
    s_waitcnt vmcnt(0)
M_cw2:
    v_xor_b32 v176, s8, v160
    v_xor_b32 v177, s9, v161
    v_xor_b32 v178, s10, v162
    v_xor_b32 v179, s11, v163
    v_xor_b32 v180, s8, v164
    v_xor_b32 v181, s9, v165
    v_xor_b32 v182, s10, v166
    v_xor_b32 v183, s11, v167
    v_xor_b32 v184, s8, v168
    v_xor_b32 v185, s9, v169
    v_xor_b32 v186, s10, v170
    v_xor_b32 v187, s11, v171
    v_xor_b32 v188, s8, v172
    v_xor_b32 v189, s9, v173
    v_xor_b32 v190, s10, v174
    v_xor_b32 v191, s11, v175
    v_or3_b32 v148, v176, v177, v178
    v_or3_b32 v148, v148, v179, v180
    v_or3_b32 v148, v148, v181, v182
    v_or3_b32 v148, v148, v183, v184
    v_or3_b32 v148, v148, v185, v186
    v_or3_b32 v148, v148, v187, v188
    v_or3_b32 v148, v148, v189, v190
    v_or_b32 v148, v148, v191
    v_and_b32 v148, s62, v148
    v_cmp_ne_u32 vcc, 0, v148
    s_nop 4
    s_cbranch_vccz M_cok
    s_add_u32 s65, s65, 1
    s_cmp_lt_u32 s65, 16384
    s_cbranch_scc0 M_cok
    s_sleep 4
    buffer_load_dwordx4 v[160:163], v24, s[36:39], s27 offen sc1
    s_mov_b64 exec, s[60:61]
    buffer_load_dwordx4 v[164:167], v24, s[36:39], s53 offen sc1
    s_mov_b64 exec, -1
    buffer_load_dwordx4 v[168:171], v24, s[36:39], s27 offen offset:64 sc1
    s_mov_b64 exec, s[60:61]
    buffer_load_dwordx4 v[172:175], v24, s[36:39], s53 offen offset:64 sc1
    s_mov_b64 exec, -1
    s_branch M_cw
M_cok:
    s_waitcnt lgkmcnt(0)
    s_barrier
M_f1:
    v_add_u32 v159, 10, v8
    v_and_b32 v157, -2, v159
    v_add_lshl_u32 v159, v157, v159, 7
    v_cmp_gt_u32 vcc, 20, v8
    v_bfrev_b32 v157, 2
    s_nop 0
    v_cndmask_b32 v159, v157, v159, vcc
    s_mul_i32 s27, s26, 12800
    s_add_u32 s27, s27, s44
    buffer_load_dword v63, v159, s[28:31], s27 offen offset:256
    v_and_b32 v64, s12, v176
    v_alignbit_b32 v65, s13, v176, 22
    ds_read_u16 v64, v64 offset:30720
    ds_read_b32 v65, v65
    v_and_b32 v66, s12, v177
    v_alignbit_b32 v67, s13, v177, 22
    ds_read_u16 v66, v66 offset:30720
    ds_read_b32 v67, v67
    v_and_b32 v68, s12, v178
    v_alignbit_b32 v69, s13, v178, 22
    ds_read_u16 v68, v68 offset:30720
    ds_read_b32 v69, v69
    v_and_b32 v70, s12, v179
    v_alignbit_b32 v71, s13, v179, 22
    ds_read_u16 v70, v70 offset:30720
    ds_read_b32 v71, v71
    v_and_b32 v72, s12, v180
    v_alignbit_b32 v73, s13, v180, 22
    ds_read_u16 v72, v72 offset:30720
    ds_read_b32 v73, v73
    v_and_b32 v74, s12, v181
    v_alignbit_b32 v75, s13, v181, 22
    ds_read_u16 v74, v74 offset:30720
    ds_read_b32 v75, v75
    v_and_b32 v76, s12, v182
    v_alignbit_b32 v77, s13, v182, 22
    ds_read_u16 v76, v76 offset:30720
    ds_read_b32 v77, v77
    v_and_b32 v78, s12, v183
    v_alignbit_b32 v79, s13, v183, 22
    ds_read_u16 v78, v78 offset:30720
    ds_read_b32 v79, v79
    s_mov_b32 s63, 0xc8000000
    s_lshl_b32 s59, s26, 11
    s_add_u32 s59, s59, 146560
    s_mov_b32 s60, s59
    v_cmp_gt_u32 s[54:55], s63, v184
    s_nop 1
    v_mbcnt_lo_u32_b32 v148, s54, 0
    v_mbcnt_hi_u32_b32 v148, s55, v148
    v_lshl_add_u32 v148, v148, 4, s60
    s_bcnt1_i32_b64 s27, s[54:55]
    s_lshl4_add_u32 s60, s27, s60
    v_cndmask_b32 v148, v27, v148, s[54:55]
    ds_write_b128 v148, v[184:187]
    v_cmp_gt_u32 s[54:55], s63, v188
    s_nop 1
    v_mbcnt_lo_u32_b32 v148, s54, 0
    v_mbcnt_hi_u32_b32 v148, s55, v148
    v_lshl_add_u32 v148, v148, 4, s60
    s_bcnt1_i32_b64 s27, s[54:55]
    s_lshl4_add_u32 s60, s27, s60
    v_cndmask_b32 v148, v27, v148, s[54:55]
    ds_write_b128 v148, v[188:191]
    s_mov_b32 s63, 0xff000000
    v_cmp_lt_u32 s[68:69], s63, v187
    v_cmp_lt_u32 s[70:71], s63, v191
    s_waitcnt lgkmcnt(10)
    v_and_b32 v96, 0x0707, v64
    v_and_b32 v97, 0x0707, v66
    v_and_b32 v98, 0x0707, v68
WUP_1270:
    s_cbranch_execz WUP_1431
    v_and_b32 v99, 0x0707, v70
    v_and_b32 v64, 0xf8f8, v64
    v_and_b32 v66, 0xf8f8, v66
    v_and_b32 v68, 0xf8f8, v68
    v_and_b32 v70, 0xf8f8, v70
    v_mul_u32_u24 v96, 0x200400, v96
    v_mul_u32_u24 v97, 0x200400, v97
    v_mul_u32_u24 v98, 0x200400, v98
    v_mul_u32_u24 v99, 0x200400, v99
    v_and_or_b32 v64, v96, s14, v64
    v_and_or_b32 v66, v97, s14, v66
    v_and_or_b32 v68, v98, s14, v68
    v_and_or_b32 v70, v99, s14, v70
    v_add_u32 v64, v64, v65
    v_add_u32 v66, v66, v67
    v_add_u32 v68, v68, v69
    v_add_u32 v70, v70, v71
    v_dot4_i32_i8 v64, v64, v64, 0
    v_dot4_i32_i8 v66, v66, v66, 0
    v_dot4_i32_i8 v68, v68, v68, 0
    v_dot4_i32_i8 v70, v70, v70, 0
    v_cmp_gt_i32 s[40:41], s15, v64
    v_cmp_gt_i32 s[42:43], s15, v66
    v_cmp_gt_i32 s[46:47], s15, v68
    v_cmp_gt_i32 s[54:55], s15, v70
    v_mbcnt_lo_u32_b32 v96, s40, 0
    v_mbcnt_lo_u32_b32 v97, s42, 0
    v_mbcnt_lo_u32_b32 v98, s46, 0
    v_mbcnt_lo_u32_b32 v99, s54, 0
    v_mbcnt_hi_u32_b32 v96, s41, v96
    v_mbcnt_hi_u32_b32 v97, s43, v97
    v_mbcnt_hi_u32_b32 v98, s47, v98
    v_mbcnt_hi_u32_b32 v99, s55, v99
    v_lshl_add_u32 v96, v96, 2, s16
    s_bcnt1_i32_b64 s27, s[40:41]
    s_lshl2_add_u32 s16, s27, s16
    v_lshl_add_u32 v97, v97, 2, s16
    s_bcnt1_i32_b64 s27, s[42:43]
    s_lshl2_add_u32 s16, s27, s16
    v_lshl_add_u32 v98, v98, 2, s16
    s_bcnt1_i32_b64 s27, s[46:47]
    s_lshl2_add_u32 s16, s27, s16
    v_lshl_add_u32 v99, v99, 2, s16
    s_bcnt1_i32_b64 s27, s[54:55]
    s_lshl2_add_u32 s16, s27, s16
    v_cndmask_b32 v96, v26, v96, s[40:41]
    ds_write_b32 v96, v176
    v_cndmask_b32 v97, v26, v97, s[42:43]
    ds_write_b32 v97, v177
    v_cndmask_b32 v98, v26, v98, s[46:47]
    ds_write_b32 v98, v178
    v_cndmask_b32 v99, v26, v99, s[54:55]
    ds_write_b32 v99, v179
    s_waitcnt lgkmcnt(6)
    v_and_b32 v100, 0x0707, v72
    v_and_b32 v101, 0x0707, v74
    v_and_b32 v102, 0x0707, v76
    v_and_b32 v103, 0x0707, v78
    v_and_b32 v72, 0xf8f8, v72
    v_and_b32 v74, 0xf8f8, v74
    v_and_b32 v76, 0xf8f8, v76
    v_and_b32 v78, 0xf8f8, v78
    v_mul_u32_u24 v100, 0x200400, v100
    v_mul_u32_u24 v101, 0x200400, v101
    v_mul_u32_u24 v102, 0x200400, v102
    v_mul_u32_u24 v103, 0x200400, v103
    v_and_or_b32 v72, v100, s14, v72
    v_and_or_b32 v74, v101, s14, v74
    v_and_or_b32 v76, v102, s14, v76
    v_and_or_b32 v78, v103, s14, v78
    v_add_u32 v72, v72, v73
    v_add_u32 v74, v74, v75
    v_add_u32 v76, v76, v77
    v_add_u32 v78, v78, v79
    v_dot4_i32_i8 v72, v72, v72, 0
    v_dot4_i32_i8 v74, v74, v74, 0
    v_dot4_i32_i8 v76, v76, v76, 0
    v_dot4_i32_i8 v78, v78, v78, 0
    v_cmp_gt_i32 s[40:41], s15, v72
    v_cmp_gt_i32 s[42:43], s15, v74
    v_cmp_gt_i32 s[46:47], s15, v76
    v_cmp_gt_i32 s[54:55], s15, v78
    v_mbcnt_lo_u32_b32 v100, s40, 0
    v_mbcnt_lo_u32_b32 v101, s42, 0
    v_mbcnt_lo_u32_b32 v102, s46, 0
    v_mbcnt_lo_u32_b32 v103, s54, 0
    v_mbcnt_hi_u32_b32 v100, s41, v100
    v_mbcnt_hi_u32_b32 v101, s43, v101
    v_mbcnt_hi_u32_b32 v102, s47, v102
    v_mbcnt_hi_u32_b32 v103, s55, v103
    v_lshl_add_u32 v100, v100, 2, s16
    s_bcnt1_i32_b64 s27, s[40:41]
    s_lshl2_add_u32 s16, s27, s16
    v_lshl_add_u32 v101, v101, 2, s16
    s_bcnt1_i32_b64 s27, s[42:43]
    s_lshl2_add_u32 s16, s27, s16
    v_lshl_add_u32 v102, v102, 2, s16
    s_bcnt1_i32_b64 s27, s[46:47]
    s_lshl2_add_u32 s16, s27, s16
    v_lshl_add_u32 v103, v103, 2, s16
    s_bcnt1_i32_b64 s27, s[54:55]
    s_lshl2_add_u32 s16, s27, s16
    v_cndmask_b32 v100, v26, v100, s[40:41]
    ds_write_b32 v100, v180
    v_cndmask_b32 v101, v26, v101, s[42:43]
    ds_write_b32 v101, v181
    v_cndmask_b32 v102, v26, v102, s[46:47]
    ds_write_b32 v102, v182
    v_cndmask_b32 v103, v26, v103, s[54:55]
    ds_write_b32 v103, v183
    s_sub_u32 s60, s60, s59
    v_add_u32 v149, s59, v20
    v_mov_b32 v150, 0xff000000
    s_nop 1
M_pc:
    s_cmp_eq_u32 s60, 0
    s_cbranch_scc1 M_pcd
    s_waitcnt lgkmcnt(0)
    ds_read_b32 v148, v149
    v_cmp_gt_u32 vcc, s60, v20
    s_waitcnt lgkmcnt(0)
    s_nop 0
    v_cndmask_b32 v148, v150, v148, vcc
    v_and_b32 v64, s12, v148
    v_alignbit_b32 v65, s13, v148, 22
    ds_read_u16 v64, v64 offset:30720
    ds_read_b32 v65, v65
    s_waitcnt lgkmcnt(0)
    v_and_b32 v96, 0x0707, v64
    v_and_b32 v64, 0xf8f8, v64
    v_mul_u32_u24 v96, 0x200400, v96
    v_and_or_b32 v64, v96, s14, v64
    v_add_u32 v64, v64, v65
    v_dot4_i32_i8 v64, v64, v64, 0
    s_nop 2
    v_cmp_gt_i32 s[40:41], s15, v64
    s_nop 1
    v_mbcnt_lo_u32_b32 v96, s40, 0
    v_mbcnt_hi_u32_b32 v96, s41, v96
    v_lshl_add_u32 v96, v96, 2, s16
    s_bcnt1_i32_b64 s27, s[40:41]
    s_lshl2_add_u32 s16, s27, s16
    v_cndmask_b32 v96, v26, v96, s[40:41]
    ds_write_b32 v96, v148
    v_add_u32 v149, 256, v149
    s_min_u32 s27, s60, 256
    s_sub_u32 s60, s60, s27
    s_sub_u32 s27, s16, s17
    s_cmp_gt_u32 s27, 1024
    s_cbranch_scc0 M_pc
M_pcd:
    s_or_b64 s[54:55], s[68:69], s[70:71]
    s_cmp_eq_u64 s[54:55], 0
    s_cbranch_scc0 M_mdx
M_mdd:
    s_sub_u32 s19, s16, s17
    s_lshr_b32 s19, s19, 2
    s_cmp_le_u32 s19, 256
    s_cbranch_scc1 M_c1
    ds_write_b32 v9, v19
    s_movk_i32 s19, 256
M_c1:
    v_add_u32 v148, s17, v20
    s_waitcnt lgkmcnt(0)
    ds_read_b32 v64, v148 offset:0
WUP_1431:
    s_cbranch_execz WUR_0
    ds_read_b32 v68, v148 offset:256
    ds_read_b32 v72, v148 offset:512
    ds_read_b32 v76, v148 offset:768
    s_mov_b32 s27, s19
    v_cmp_gt_i32 s[8:9], s27, v8
    s_sub_u32 s27, s19, 64
    v_cmp_gt_i32 s[10:11], s27, v8
    s_sub_u32 s27, s19, 128
    v_cmp_gt_i32 s[14:15], s27, v8
    s_sub_u32 s27, s19, 192
    v_cmp_gt_i32 s[16:17], s27, v8
    s_mov_b32 s63, 0x02020000
    s_mov_b32 s64, 0x322bcc77
    s_mov_b32 s62, 0x409d0000
    v_mov_b32 v149, 0x01000c0c
    v_bfrev_b32 v14, 2
    s_waitcnt lgkmcnt(0)
    v_and_b32 v150, s12, v64
    v_alignbit_b32 v151, 33, v64, 20
    v_lshl_add_u32 v150, v150, 1, v150
    ds_read_b96 v[40:42], v151
    v_and_b32 v150, -4, v150
    v_cndmask_b32 v150, v14, v150, s[8:9]
    buffer_load_dwordx2 v[32:33], v150, s[92:95], 0 offen
    v_bfe_i32 v56, v64, 1, 1
    v_and_or_b32 v56, v56, s63, v149
    s_cmp_le_u32 s19, 64
    s_nop 0
    s_cbranch_scc1 M_s2a
    v_and_b32 v150, s12, v68
    v_alignbit_b32 v151, 33, v68, 20
    v_lshl_add_u32 v150, v150, 1, v150
    ds_read_b96 v[44:46], v151
    v_and_b32 v150, -4, v150
    v_cndmask_b32 v150, v14, v150, s[10:11]
    buffer_load_dwordx2 v[34:35], v150, s[92:95], 0 offen
    v_bfe_i32 v57, v68, 1, 1
    v_and_or_b32 v57, v57, s63, v149
    s_cmp_le_u32 s19, 128
    s_nop 0
    s_cbranch_scc1 M_s2a
    v_and_b32 v150, s12, v72
    v_alignbit_b32 v151, 33, v72, 20
    v_lshl_add_u32 v150, v150, 1, v150
    ds_read_b96 v[48:50], v151
    v_and_b32 v150, -4, v150
    v_cndmask_b32 v150, v14, v150, s[14:15]
    buffer_load_dwordx2 v[36:37], v150, s[92:95], 0 offen
    v_bfe_i32 v58, v72, 1, 1
    v_and_or_b32 v58, v58, s63, v149
    s_cmp_le_u32 s19, 192
    s_nop 0
    s_cbranch_scc1 M_s2a
    v_and_b32 v150, s12, v76
    v_alignbit_b32 v151, 33, v76, 20
    v_lshl_add_u32 v150, v150, 1, v150
    ds_read_b96 v[52:54], v151
    v_and_b32 v150, -4, v150
    v_cndmask_b32 v150, v14, v150, s[16:17]
    buffer_load_dwordx2 v[38:39], v150, s[92:95], 0 offen
    v_bfe_i32 v59, v76, 1, 1
    v_and_or_b32 v59, v59, s63, v149
    s_nop 1
M_s2a:
    s_waitcnt vmcnt(0) lgkmcnt(0)
    v_add_u32 v151, s63, v56
    v_perm_b32 v148, v33, v32, v56
    v_add_u32 v152, s63, v151
    v_perm_b32 v149, v33, v32, v151
    v_perm_b32 v150, v33, v32, v152
    v_sub_f32 v148, v148, v40
    v_sub_f32 v149, v149, v41
    v_sub_f32 v150, v150, v42
    v_cvt_pk_bf16_f32 v65, v148, v149
    v_cvt_pk_bf16_f32 v150, 0, v150
    v_lshlrev_b32 v148, 16, v65
    v_and_b32 v149, s58, v65
    v_mul_f32 v153, v150, v150
    v_mul_f32 v148, v148, v148
    v_mul_f32 v149, v149, v149
    v_cvt_pk_bf16_f32 v153, 0, v153
    v_cvt_pk_bf16_f32 v148, 0, v148
    v_cvt_pk_bf16_f32 v149, 0, v149
    v_add_f32 v148, v148, v149
    v_add_f32 v148, v148, v153
    v_cvt_pk_bf16_f32 v148, 0, v148
    v_add_f32 v148, s64, v148
    v_cvt_pk_bf16_f32 v148, 0, v148
    v_sqrt_f32 v148, v148
    s_nop 0
    v_cvt_pk_bf16_f32 v66, v150, v148
    v_cmp_gt_u32 vcc, s62, v66
    s_and_b64 s[8:9], s[8:9], vcc
    v_lshrrev_b32 v96, 24, v64
    v_lshrrev_b32 v120, 21, v64
    v_and_b32 v120, 16, v120
    v_lshlrev_b32 v112, v120, v19
    v_and_or_b32 v96, v96, v18, s3
    s_mov_b64 exec, s[8:9]
    s_nop 0
    s_cbranch_execz M_sa1
    ds_add_rtn_u32 v112, v96, v112
M_sa1:
    s_mov_b64 exec, -1
    s_cmp_le_u32 s19, 64
    s_cbranch_scc1 M_s2b
    v_add_u32 v151, s63, v57
    v_perm_b32 v148, v35, v34, v57
    v_add_u32 v152, s63, v151
    v_perm_b32 v149, v35, v34, v151
    v_perm_b32 v150, v35, v34, v152
    v_sub_f32 v148, v148, v44
    v_sub_f32 v149, v149, v45
    v_sub_f32 v150, v150, v46
    v_cvt_pk_bf16_f32 v69, v148, v149
    v_cvt_pk_bf16_f32 v150, 0, v150
    v_lshlrev_b32 v148, 16, v69
    v_and_b32 v149, s58, v69
    v_mul_f32 v153, v150, v150
    v_mul_f32 v148, v148, v148
    v_mul_f32 v149, v149, v149
    v_cvt_pk_bf16_f32 v153, 0, v153
    v_cvt_pk_bf16_f32 v148, 0, v148
    v_cvt_pk_bf16_f32 v149, 0, v149
    v_add_f32 v148, v148, v149
    v_add_f32 v148, v148, v153
    v_cvt_pk_bf16_f32 v148, 0, v148
    v_add_f32 v148, s64, v148
    v_cvt_pk_bf16_f32 v148, 0, v148
    v_sqrt_f32 v148, v148
    s_nop 0
    v_cvt_pk_bf16_f32 v70, v150, v148
    v_cmp_gt_u32 vcc, s62, v70
    s_and_b64 s[10:11], s[10:11], vcc
    v_lshrrev_b32 v97, 24, v68
    v_lshrrev_b32 v121, 21, v68
    v_and_b32 v121, 16, v121
    v_lshlrev_b32 v113, v121, v19
    v_and_or_b32 v97, v97, v18, s3
    s_mov_b64 exec, s[10:11]
    s_nop 0
    s_cbranch_execz M_sa2
    ds_add_rtn_u32 v113, v97, v113
M_sa2:
    s_mov_b64 exec, -1
    s_cmp_le_u32 s19, 128
    s_cbranch_scc1 M_s2b
    v_add_u32 v151, s63, v58
    v_perm_b32 v148, v37, v36, v58
    v_add_u32 v152, s63, v151
    v_perm_b32 v149, v37, v36, v151
    v_perm_b32 v150, v37, v36, v152
    v_sub_f32 v148, v148, v48
    v_sub_f32 v149, v149, v49
    v_sub_f32 v150, v150, v50
    v_cvt_pk_bf16_f32 v73, v148, v149
    v_cvt_pk_bf16_f32 v150, 0, v150
    v_lshlrev_b32 v148, 16, v73
    v_and_b32 v149, s58, v73
    v_mul_f32 v153, v150, v150
    v_mul_f32 v148, v148, v148
    v_mul_f32 v149, v149, v149
    v_cvt_pk_bf16_f32 v153, 0, v153
    v_cvt_pk_bf16_f32 v148, 0, v148
    v_cvt_pk_bf16_f32 v149, 0, v149
    v_add_f32 v148, v148, v149
    v_add_f32 v148, v148, v153
    v_cvt_pk_bf16_f32 v148, 0, v148
    v_add_f32 v148, s64, v148
    v_cvt_pk_bf16_f32 v148, 0, v148
    v_sqrt_f32 v148, v148
    s_nop 0
    v_cvt_pk_bf16_f32 v74, v150, v148
    v_cmp_gt_u32 vcc, s62, v74
    s_and_b64 s[14:15], s[14:15], vcc
    v_lshrrev_b32 v98, 24, v72
    v_lshrrev_b32 v122, 21, v72
    v_and_b32 v122, 16, v122
    v_lshlrev_b32 v114, v122, v19
WUP_1607:
    s_cbranch_execz WUP_1793
    v_and_or_b32 v98, v98, v18, s3
    s_mov_b64 exec, s[14:15]
    s_nop 0
    s_cbranch_execz M_sa3
    ds_add_rtn_u32 v114, v98, v114
M_sa3:
    s_mov_b64 exec, -1
    s_cmp_le_u32 s19, 192
    s_cbranch_scc1 M_s2b
    v_add_u32 v151, s63, v59
    v_perm_b32 v148, v39, v38, v59
    v_add_u32 v152, s63, v151
    v_perm_b32 v149, v39, v38, v151
    v_perm_b32 v150, v39, v38, v152
    v_sub_f32 v148, v148, v52
    v_sub_f32 v149, v149, v53
    v_sub_f32 v150, v150, v54
    v_cvt_pk_bf16_f32 v77, v148, v149
    v_cvt_pk_bf16_f32 v150, 0, v150
    v_lshlrev_b32 v148, 16, v77
    v_and_b32 v149, s58, v77
    v_mul_f32 v153, v150, v150
    v_mul_f32 v148, v148, v148
    v_mul_f32 v149, v149, v149
    v_cvt_pk_bf16_f32 v153, 0, v153
    v_cvt_pk_bf16_f32 v148, 0, v148
    v_cvt_pk_bf16_f32 v149, 0, v149
    v_add_f32 v148, v148, v149
    v_add_f32 v148, v148, v153
    v_cvt_pk_bf16_f32 v148, 0, v148
    v_add_f32 v148, s64, v148
    v_cvt_pk_bf16_f32 v148, 0, v148
    v_sqrt_f32 v148, v148
    s_nop 0
    v_cvt_pk_bf16_f32 v78, v150, v148
    v_cmp_gt_u32 vcc, s62, v78
    s_and_b64 s[16:17], s[16:17], vcc
    v_lshrrev_b32 v99, 24, v76
    v_lshrrev_b32 v123, 21, v76
    v_and_b32 v123, 16, v123
    v_lshlrev_b32 v115, v123, v19
    v_and_or_b32 v99, v99, v18, s3
    s_mov_b64 exec, s[16:17]
    s_nop 0
    s_cbranch_execz M_sa4
    ds_add_rtn_u32 v115, v99, v115
M_sa4:
    s_mov_b64 exec, -1
M_s2b:
    s_mov_b32 s61, 0x3e22f983
    s_movk_i32 s63, 0x70
    s_movk_i32 s64, 2176
    s_movk_i32 s65, 1280
    s_movk_i32 s66, 384
    v_lshrrev_b32 v21, 4, v8
    v_lshlrev_b32 v21, 9, v21
    v_and_b32 v22, 15, v8
    v_lshl_or_b32 v21, v22, 4, v21
    s_lshl_b32 s45, s26, 10
    s_add_u32 s45, s45, 30720
    s_lshl_b32 s46, s26, 11
    s_add_u32 s46, s46, s44
    s_waitcnt lgkmcnt(0)
    s_barrier
    s_cmp_eq_u32 s26, 6
    s_cbranch_scc0 M_h1
    s_mov_b32 s53, 0x830800
    buffer_load_dwordx4 v[148:151], v1, s[36:39], s53 offen sc1
M_h1:
    s_add_u32 m0, s45, 0
    s_add_u32 s53, s46, 0
    buffer_load_dwordx4 v21, s[28:31], s53 offen  lds
    s_add_u32 m0, s45, 8192
    s_add_u32 s53, s46, 16384
    buffer_load_dwordx4 v21, s[28:31], s53 offen  lds
    s_add_u32 m0, s45, 16384
    s_add_u32 s53, s46, 32768
    buffer_load_dwordx4 v21, s[28:31], s53 offen  lds
    s_add_u32 m0, s45, 24576
    s_add_u32 s53, s46, 49152
    buffer_load_dwordx4 v21, s[28:31], s53 offen  lds
    s_add_u32 m0, s45, 32768
    s_add_u32 s53, s46, 65536
    buffer_load_dwordx4 v21, s[28:31], s53 offen  lds
    s_add_u32 m0, s45, 40960
    s_add_u32 s53, s46, 81920
    buffer_load_dwordx4 v21, s[28:31], s53 offen  lds
    s_cmp_ge_u32 s26, 2
    s_cbranch_scc1 M_rs11
    s_add_u32 m0, s45, 49152
    s_add_u32 s53, s46, 98304
    buffer_load_dwordx4 v21, s[28:31], s53 offen  lds
M_rs11:
    s_sub_u32 s28, s28, 2048
    s_subb_u32 s29, s29, 0
    s_add_u32 s30, s30, 2048
    ds_read_b32 v28, v30
    ds_read_b32 v13, v9
    s_waitcnt lgkmcnt(1)
    v_and_b32 v31, 0xffff, v28
    v_lshrrev_b32 v28, 16, v28
    v_add_u32 v28, v28, v31
    v_mov_b32 v29, v28
    s_nop 1
    v_add_u32_dpp v29, v29, v29 row_shr:1 row_mask:0xf bank_mask:0xf bound_ctrl:0
    s_nop 1
    v_add_u32_dpp v29, v29, v29 row_shr:2 row_mask:0xf bank_mask:0xf bound_ctrl:0
    s_nop 1
    v_add_u32_dpp v29, v29, v29 row_shr:4 row_mask:0xf bank_mask:0xf bound_ctrl:0
    s_nop 1
    v_add_u32_dpp v29, v29, v29 row_shr:8 row_mask:0xf bank_mask:0xf bound_ctrl:0
    s_nop 1
    v_add_u32_dpp v29, v29, v29 row_bcast:15 row_mask:0xa bank_mask:0xf
    s_nop 1
    v_add_u32_dpp v29, v29, v29 row_bcast:31 row_mask:0xc bank_mask:0xf
    v_sub_u32 v28, v29, v28
    v_add_u32 v31, v28, v31
    v_lshl_or_b32 v28, v31, 16, v28
    ds_bpermute_b32 v104, v96, v28
    ds_bpermute_b32 v105, v97, v28
    ds_bpermute_b32 v106, v98, v28
    ds_bpermute_b32 v107, v99, v28
    v_readlane_b32 s62, v29, 63
    s_mov_b32 s54, 0
    s_mov_b32 s55, 0
    s_xor_b32 s12, s26, 4
    s_cmp_gt_u32 s62, 480
    s_cselect_b32 s27, 96, 64
    v_readlane_b32 s70, v28, 8
    s_and_b32 s70, s70, 0xffff
    s_cmp_ge_u32 s70, 88
    s_cselect_b32 s27, s27, 64
    v_cmp_ge_u32 vcc, s27, v29
    v_cmp_ge_u32 s[70:71], s27, v31
    s_bcnt1_i32_b64 s56, vcc
    s_bcnt1_i32_b64 s57, s[70:71]
    s_add_u32 s56, s56, s57
    s_min_u32 s56, s56, 16
    s_lshr_b32 s27, s56, 1
    s_and_b32 s69, s56, 1
    v_readlane_b32 s57, v28, s27
    s_lshl4_add_u32 s69, s69, 0x100000
    s_bfe_u32 s57, s57, s69
    s_waitcnt lgkmcnt(0)
    v_readfirstlane_b32 s46, v13
    v_add_u32 v104, v104, v112
    v_bfe_u32 v104, v104, v120, 16
    v_cmp_gt_u32 vcc, 768, v104
    v_lshl_add_u32 v104, v104, 4, s67
    s_and_b64 exec, vcc, s[8:9]
    s_nop 2
    s_cbranch_execz M_sb12
    ds_write_b96 v104, v[64:66]
M_sb12:
    s_mov_b64 exec, -1
    s_cmp_le_u32 s19, 64
    s_cbranch_scc1 M_s2c
    v_add_u32 v105, v105, v113
    v_bfe_u32 v105, v105, v121, 16
    v_cmp_gt_u32 vcc, 768, v105
    v_lshl_add_u32 v105, v105, 4, s67
    s_and_b64 exec, vcc, s[10:11]
    s_nop 2
    s_cbranch_execz M_sb13
    ds_write_b96 v105, v[68:70]
M_sb13:
    s_mov_b64 exec, -1
    s_cmp_le_u32 s19, 128
    s_cbranch_scc1 M_s2c
    v_add_u32 v106, v106, v114
    v_bfe_u32 v106, v106, v122, 16
    v_cmp_gt_u32 vcc, 768, v106
    v_lshl_add_u32 v106, v106, 4, s67
    s_and_b64 exec, vcc, s[14:15]
    s_nop 2
    s_cbranch_execz M_sb14
    ds_write_b96 v106, v[72:74]
M_sb14:
    s_mov_b64 exec, -1
    s_cmp_le_u32 s19, 192
    s_cbranch_scc1 M_s2c
    v_add_u32 v107, v107, v115
    v_bfe_u32 v107, v107, v123, 16
    v_cmp_gt_u32 vcc, 768, v107
    v_lshl_add_u32 v107, v107, 4, s67
    s_and_b64 exec, vcc, s[16:17]
    s_nop 2
    s_cbranch_execz M_sb15
    ds_write_b96 v107, v[76:78]
M_sb15:
    s_mov_b64 exec, -1
M_s2c:
    s_cmp_eq_u32 s26, 6
    s_cbranch_scc0 M_h3
    s_mov_b32 s27, 0
    v_cmp_gt_u32 s[8:9], 63, v8
WUP_1793:
    s_cbranch_execz WUR_0
    v_cmp_eq_u32 s[10:11], 62, v8
    s_waitcnt vmcnt(6)
    s_nop 3
M_h2:
    v_cndmask_b32 v150, v150, v148, s[10:11]
    v_cndmask_b32 v151, v151, v148, s[10:11]
    v_xor_b32 v148, s18, v148
    v_xor_b32 v149, s18, v149
    v_xor_b32 v150, s18, v150
    v_xor_b32 v151, s18, v151
    v_or3_b32 v148, v148, v149, v150
    v_or_b32 v148, v148, v151
    v_cmp_ne_u32 vcc, 0, v148
    s_and_b64 vcc, vcc, s[8:9]
    s_cbranch_vccz M_h3
    s_add_u32 s27, s27, 1
    s_cmp_lt_u32 s27, 16384
    s_cbranch_scc0 M_h3
    s_sleep 2
    s_mov_b32 s53, 0x830800
    buffer_load_dwordx4 v[148:151], v1, s[36:39], s53 offen sc1
    s_waitcnt vmcnt(0)
    s_branch M_h2
M_h3:
    s_cmp_eq_u32 s2, 0
    s_cbranch_scc0 M_h4
    s_cmp_eq_u32 s26, 5
    s_cbranch_scc0 M_h4
    s_mov_b32 s27, 0x830000
    v_mov_b32 v148, s18
    v_mov_b32 v149, 0
    s_mov_b64 exec, 1
    buffer_store_dword v148, v149, s[36:39], s27 offen sc1
    s_mov_b64 exec, -1
M_h4:
    s_waitcnt lgkmcnt(0)
    s_barrier
    s_cmp_eq_u32 s12, 0
    s_cbranch_scc1 M_cut
    s_sub_u32 s27, s57, s55
    s_cmp_gt_u32 s27, 64
    s_cselect_b32 s40, 64, 96
    s_mov_b32 s54, s56
    s_mov_b32 s55, s57
    s_sub_u32 s27, s62, s55
    s_cmp_gt_u32 s27, 420
    s_cselect_b32 s27, 96, 64
    s_lshr_b32 s70, s54, 1
    s_add_u32 s70, s70, 8
    s_and_b32 s69, s54, 1
    v_readlane_b32 s70, v28, s70
    s_lshl4_add_u32 s69, s69, 0x100000
    s_bfe_u32 s70, s70, s69
    s_sub_u32 s70, s70, s55
    s_cmp_ge_u32 s70, 88
    s_cselect_b32 s27, s27, 64
    s_add_u32 s27, s27, s55
    v_cmp_ge_u32 vcc, s27, v29
    v_cmp_ge_u32 s[70:71], s27, v31
    s_bcnt1_i32_b64 s56, vcc
    s_bcnt1_i32_b64 s57, s[70:71]
    s_add_u32 s27, s54, 16
    s_add_u32 s56, s56, s57
    s_min_u32 s56, s56, s27
    s_min_u32 s56, s56, 100
    s_max_u32 s56, s56, 4
    s_lshr_b32 s27, s56, 1
    s_and_b32 s69, s56, 1
    v_readlane_b32 s57, v28, s27
    s_lshl4_add_u32 s69, s69, 0x100000
    s_bfe_u32 s57, s57, s69
    s_cmp_eq_u32 s12, 1
    s_cbranch_scc1 M_cut
    s_sub_u32 s27, s57, s55
    s_cmp_gt_u32 s27, 64
    s_cselect_b32 s41, 64, 96
    s_mov_b32 s54, s56
    s_mov_b32 s55, s57
    s_sub_u32 s27, s62, s55
    s_cmp_gt_u32 s27, 360
    s_cselect_b32 s27, 96, 64
    s_lshr_b32 s70, s54, 1
    s_add_u32 s70, s70, 8
    s_and_b32 s69, s54, 1
    v_readlane_b32 s70, v28, s70
    s_lshl4_add_u32 s69, s69, 0x100000
    s_bfe_u32 s70, s70, s69
    s_sub_u32 s70, s70, s55
    s_cmp_ge_u32 s70, 88
    s_cselect_b32 s27, s27, 64
    s_add_u32 s27, s27, s55
    v_cmp_ge_u32 vcc, s27, v29
    v_cmp_ge_u32 s[70:71], s27, v31
    s_bcnt1_i32_b64 s56, vcc
    s_bcnt1_i32_b64 s57, s[70:71]
    s_add_u32 s27, s54, 16
    s_add_u32 s56, s56, s57
    s_min_u32 s56, s56, s27
    s_min_u32 s56, s56, 100
    s_max_u32 s56, s56, 20
    s_lshr_b32 s27, s56, 1
    s_and_b32 s69, s56, 1
    v_readlane_b32 s57, v28, s27
    s_lshl4_add_u32 s69, s69, 0x100000
    s_bfe_u32 s57, s57, s69
    s_cmp_eq_u32 s12, 2
    s_cbranch_scc1 M_cut
    s_sub_u32 s27, s57, s55
    s_cmp_gt_u32 s27, 64
    s_cselect_b32 s42, 64, 96
    s_mov_b32 s54, s56
    s_mov_b32 s55, s57
    s_sub_u32 s27, s62, s55
    s_cmp_gt_u32 s27, 300
    s_cselect_b32 s27, 96, 64
    s_lshr_b32 s70, s54, 1
    s_add_u32 s70, s70, 8
    s_and_b32 s69, s54, 1
    v_readlane_b32 s70, v28, s70
    s_lshl4_add_u32 s69, s69, 0x100000
    s_bfe_u32 s70, s70, s69
    s_sub_u32 s70, s70, s55
    s_cmp_ge_u32 s70, 88
    s_cselect_b32 s27, s27, 64
    s_add_u32 s27, s27, s55
    v_cmp_ge_u32 vcc, s27, v29
    v_cmp_ge_u32 s[70:71], s27, v31
    s_bcnt1_i32_b64 s56, vcc
    s_bcnt1_i32_b64 s57, s[70:71]
    s_add_u32 s27, s54, 16
    s_add_u32 s56, s56, s57
    s_min_u32 s56, s56, s27
    s_min_u32 s56, s56, 100
    s_max_u32 s56, s56, 36
    s_lshr_b32 s27, s56, 1
    s_and_b32 s69, s56, 1
    v_readlane_b32 s57, v28, s27
    s_lshl4_add_u32 s69, s69, 0x100000
    s_bfe_u32 s57, s57, s69
    s_cmp_eq_u32 s12, 3
    s_cbranch_scc1 M_cut
    s_mov_b32 s54, s56
    s_mov_b32 s55, s57
    s_sub_u32 s27, s62, s55
    s_cmp_gt_u32 s27, 240
    s_cselect_b32 s27, s40, 64
    s_add_u32 s27, s27, s55
    v_cmp_ge_u32 vcc, s27, v29
    v_cmp_ge_u32 s[70:71], s27, v31
    s_bcnt1_i32_b64 s56, vcc
    s_bcnt1_i32_b64 s57, s[70:71]
    s_add_u32 s27, s54, 16
    s_add_u32 s56, s56, s57
    s_min_u32 s56, s56, s27
    s_min_u32 s56, s56, 100
    s_max_u32 s56, s56, 52
    s_lshr_b32 s27, s56, 1
    s_and_b32 s69, s56, 1
    v_readlane_b32 s57, v28, s27
    s_lshl4_add_u32 s69, s69, 0x100000
    s_bfe_u32 s57, s57, s69
    s_cmp_eq_u32 s12, 4
    s_cbranch_scc1 M_cut
    s_mov_b32 s54, s56
    s_mov_b32 s55, s57
    s_sub_u32 s27, s62, s55
    s_cmp_gt_u32 s27, 180
    s_cselect_b32 s27, s41, 64
    s_add_u32 s27, s27, s55
    v_cmp_ge_u32 vcc, s27, v29
    v_cmp_ge_u32 s[70:71], s27, v31
    s_bcnt1_i32_b64 s56, vcc
    s_bcnt1_i32_b64 s57, s[70:71]
    s_add_u32 s27, s54, 16
    s_add_u32 s56, s56, s57
    s_min_u32 s56, s56, s27
    s_min_u32 s56, s56, 100
    s_max_u32 s56, s56, 68
    s_lshr_b32 s27, s56, 1
    s_and_b32 s69, s56, 1
WUP_1970:
    s_cbranch_execz WUP_2152
    v_readlane_b32 s57, v28, s27
    s_lshl4_add_u32 s69, s69, 0x100000
    s_bfe_u32 s57, s57, s69
    s_cmp_eq_u32 s12, 5
    s_cbranch_scc1 M_cut
    s_mov_b32 s54, s56
    s_mov_b32 s55, s57
    s_sub_u32 s27, s62, s55
    s_cmp_gt_u32 s27, 120
    s_cselect_b32 s27, s42, 64
    s_add_u32 s27, s27, s55
    v_cmp_ge_u32 vcc, s27, v29
    v_cmp_ge_u32 s[70:71], s27, v31
    s_bcnt1_i32_b64 s56, vcc
    s_bcnt1_i32_b64 s57, s[70:71]
    s_add_u32 s27, s54, 16
    s_add_u32 s56, s56, s57
    s_min_u32 s56, s56, s27
    s_min_u32 s56, s56, 100
    s_max_u32 s56, s56, 84
    s_lshr_b32 s27, s56, 1
    s_and_b32 s69, s56, 1
    v_readlane_b32 s57, v28, s27
    s_lshl4_add_u32 s69, s69, 0x100000
    s_bfe_u32 s57, s57, s69
    s_cmp_eq_u32 s12, 6
    s_cbranch_scc1 M_cut
    s_mov_b32 s54, s56
    s_mov_b32 s55, s57
    s_movk_i32 s56, 100
    s_mov_b32 s57, s62
M_cut:
    s_lshl_b32 s27, s55, 4
    s_add_u32 s27, s27, s67
    v_add_u32 v14, s27, v1
    v_lshlrev_b32 v15, 4, v11
    v_add_u32 v15, s27, v15
    ds_read_b32 v15, v15
    ds_read_b96 v[88:90], v14
    ds_read_b96 v[92:94], v14 offset:1024
    s_lshl_b32 s59, s54, 1
    s_sub_u32 s45, s56, s54
    s_lshl_b32 s45, s45, 1
    s_lshl_b32 s40, s54, 10
    s_add_u32 s40, s40, s44
    s_add_u32 s41, s40, 4096
    s_add_u32 s42, s40, 8192
    s_add_u32 s43, s40, 12288
    s_lshl_b32 s6, s56, 10
    s_add_u32 s6, s6, s44
    s_mov_b32 s34, s6
    s_sub_u32 s47, s57, s55
    v_add_u32 v86, 64, v8
    s_mov_b32 s50, 1
    s_cmp_gt_u32 s47, 128
    s_cselect_b32 s27, 1, s46
    s_cmp_gt_u32 s57, 768
    s_cselect_b32 s27, 1, s27
    s_cmp_eq_u32 s27, 0
    s_cselect_b32 s47, s47, 0
    s_cselect_b32 s76, 1, 0
    s_mov_b32 s14, 0
    s_mov_b32 s15, 0
    s_mov_b32 s16, 0
    s_mov_b32 s17, 0
    v_cmp_gt_u32 s[8:9], s47, v8
    v_cmp_gt_u32 s[10:11], s47, v86
    s_add_u32 s48, s47, 31
    s_lshr_b32 s48, s48, 5
    v_bfrev_b32 v14, 2
    v_cmp_gt_u32 vcc, s47, v11
    s_mov_b32 s27, 0x1fffe
    s_waitcnt lgkmcnt(2)
    v_and_b32 v15, s27, v15
    v_lshlrev_b32 v15, 6, v15
    v_lshl_add_u32 v15, v10, 6, v15
    v_cndmask_b32 v15, v14, v15, vcc
    buffer_load_dwordx4 v[32:35], v15, s[72:75], 0 offen offset:0
    buffer_load_dwordx4 v[36:39], v15, s[72:75], 0 offen offset:16
    buffer_load_dwordx4 v[40:43], v15, s[72:75], 0 offen offset:32
    buffer_load_dwordx4 v[44:47], v15, s[72:75], 0 offen offset:48
    v_bfe_u32 v13, v1, 9, 1
    v_bfe_u32 v14, v1, 4, 5
    v_lshlrev_b32 v13, 11, v13
    v_lshl_add_u32 v13, v14, 2, v13
    buffer_load_dword v208, v13, s[4:7], s40 offen offset:256
    buffer_load_dword v209, v13, s[4:7], s40 offen offset:768
    buffer_load_dword v210, v13, s[4:7], s40 offen offset:1280
    buffer_load_dword v211, v13, s[4:7], s40 offen offset:1792
    buffer_load_dword v212, v13, s[4:7], s41 offen offset:256
    buffer_load_dword v213, v13, s[4:7], s41 offen offset:768
    buffer_load_dword v214, v13, s[4:7], s41 offen offset:1280
    buffer_load_dword v215, v13, s[4:7], s41 offen offset:1792
    buffer_load_dword v216, v13, s[4:7], s42 offen offset:256
    buffer_load_dword v217, v13, s[4:7], s42 offen offset:768
    buffer_load_dword v218, v13, s[4:7], s42 offen offset:1280
    buffer_load_dword v219, v13, s[4:7], s42 offen offset:1792
    buffer_load_dword v220, v13, s[4:7], s43 offen offset:256
    buffer_load_dword v221, v13, s[4:7], s43 offen offset:768
    buffer_load_dword v222, v13, s[4:7], s43 offen offset:1280
    buffer_load_dword v223, v13, s[4:7], s43 offen offset:1792
    buffer_load_dword v240, v13, s[4:7], s40 offen offset:384
    buffer_load_dword v241, v13, s[4:7], s40 offen offset:896
    buffer_load_dword v242, v13, s[4:7], s40 offen offset:1408
    buffer_load_dword v243, v13, s[4:7], s40 offen offset:1920
    buffer_load_dword v244, v13, s[4:7], s41 offen offset:384
    buffer_load_dword v245, v13, s[4:7], s41 offen offset:896
    buffer_load_dword v246, v13, s[4:7], s41 offen offset:1408
    buffer_load_dword v247, v13, s[4:7], s41 offen offset:1920
    buffer_load_dword v248, v13, s[4:7], s42 offen offset:384
    buffer_load_dword v249, v13, s[4:7], s42 offen offset:896
    buffer_load_dword v250, v13, s[4:7], s42 offen offset:1408
    buffer_load_dword v251, v13, s[4:7], s42 offen offset:1920
    buffer_load_dword v252, v13, s[4:7], s43 offen offset:384
    buffer_load_dword v253, v13, s[4:7], s43 offen offset:896
    buffer_load_dword v254, v13, s[4:7], s43 offen offset:1408
    buffer_load_dword v255, v13, s[4:7], s43 offen offset:1920
    s_waitcnt lgkmcnt(0)
M_win:
    v_lshrrev_b32 v8, 4, v1
    s_mov_b32 s53, 0x40490fdb
    s_mov_b32 s70, 0
    s_mov_b32 s54, 0x3e4ccccd
    s_mov_b32 s55, 0x1fffe
    v_mov_b32 v87, 1
    v_bfrev_b32 v14, 2
    v_and_b32 v96, s58, v90
    v_cndmask_b32 v96, 1.0, v96, s[8:9]
    v_rcp_f32 v98, v96
    v_mul_f32 v97, s53, v96
    v_cvt_pk_bf16_f32 v97, 0, v97
    v_mul_f32 v97, s54, v97
    v_cvt_pk_bf16_f32 v97, 0, v97
    v_mul_f32 v97, s61, v97
    v_cos_f32 v97, v97
    v_lshlrev_b32 v100, 16, v89
    v_and_b32 v101, s58, v89
    v_lshlrev_b32 v102, 16, v90
    v_cvt_pk_bf16_f32 v97, 0, v97
    v_add_f32 v97, 1.0, v97
    v_cvt_pk_bf16_f32 v97, 0, v97
    v_cndmask_b32 v97, 0, v97, s[8:9]
    v_mul_f32 v97, v97, v98
    v_add_f32 v103, v98, v98
    v_mul_f32 v97, 0x3e800000, v97
    v_mul_f32 v100, v100, v103
    v_mul_f32 v101, v101, v103
    v_mul_f32 v102, v102, v103
    v_and_b32 v99, s55, v88
    v_lshlrev_b32 v99, 8, v99
    v_cndmask_b32 v99, v14, v99, s[8:9]
    v_cvt_pk_bf16_f32 v100, v100, v101
    v_cvt_pk_bf16_f32 v102, 0, v102
    v_cndmask_b32 v104, 0, v87, s[8:9]
    v_mov_b32 v105, 0
    v_lshrrev_b32 v108, 24, v88
    v_subrev_u32 v108, s59, v108
    v_lshlrev_b32 v108, 1, v108
    v_lshlrev_b64 v[106:107], v108, v[104:105]
    ds_write_b128 v16, v[96:99] offset:0
    ds_write_b16 v17, v106 offset:2048
    ds_write_b16_d16_hi v17, v106 offset:2056
    ds_write_b16 v17, v107 offset:2064
    ds_write_b16_d16_hi v17, v107 offset:2072
    ds_write_b16 v17, v100 offset:2080
    ds_write_b16_d16_hi v17, v100 offset:2088
    ds_write_b16_d16_hi v17, v102 offset:2096
    s_cmp_eq_u64 s[10:11], 0
    s_cbranch_scc1 M_g1
    v_and_b32 v112, s58, v94
    v_cndmask_b32 v112, 1.0, v112, s[10:11]
    v_rcp_f32 v114, v112
    v_mul_f32 v113, s53, v112
    v_cvt_pk_bf16_f32 v113, 0, v113
    v_mul_f32 v113, s54, v113
    v_cvt_pk_bf16_f32 v113, 0, v113
    v_mul_f32 v113, s61, v113
    v_cos_f32 v113, v113
    v_lshlrev_b32 v116, 16, v93
    v_and_b32 v117, s58, v93
    v_lshlrev_b32 v118, 16, v94
    v_cvt_pk_bf16_f32 v113, 0, v113
    v_add_f32 v113, 1.0, v113
    v_cvt_pk_bf16_f32 v113, 0, v113
WUP_2152:
    s_cbranch_execz WUR_0
    v_cndmask_b32 v113, 0, v113, s[10:11]
    v_mul_f32 v113, v113, v114
    v_add_f32 v119, v114, v114
    v_mul_f32 v113, 0x3e800000, v113
    v_mul_f32 v116, v116, v119
    v_mul_f32 v117, v117, v119
    v_mul_f32 v118, v118, v119
    v_and_b32 v115, s55, v92
    v_lshlrev_b32 v115, 8, v115
    v_cndmask_b32 v115, v14, v115, s[10:11]
    v_cvt_pk_bf16_f32 v116, v116, v117
    v_cvt_pk_bf16_f32 v118, 0, v118
    v_cndmask_b32 v120, 0, v87, s[10:11]
    v_mov_b32 v121, 0
    v_lshrrev_b32 v124, 24, v92
    v_subrev_u32 v124, s59, v124
    v_lshlrev_b32 v124, 1, v124
    v_lshlrev_b64 v[122:123], v124, v[120:121]
    ds_write_b128 v16, v[112:115] offset:1024
    ds_write_b16 v17, v122 offset:2944
    ds_write_b16_d16_hi v17, v122 offset:2952
    ds_write_b16 v17, v123 offset:2960
    ds_write_b16_d16_hi v17, v123 offset:2968
    ds_write_b16 v17, v116 offset:2976
    ds_write_b16_d16_hi v17, v116 offset:2984
    ds_write_b16_d16_hi v17, v118 offset:2992
M_g1:
    s_waitcnt lgkmcnt(0)
    s_cmp_lg_u32 s50, 0
    s_cbranch_scc1 M_first
    s_cmp_eq_u32 s48, 0
    s_cselect_b32 s77, 0x40000000, 0
    ds_read_b32 v47, v3 offset:12
    v_bfe_u32 v46, v1, 9, 1
    s_waitcnt lgkmcnt(0)
    v_lshrrev_b32 v47, 2, v47
    v_lshl_add_u32 v47, v46, 6, v47
    buffer_load_dwordx4 v[32:35], v47, s[72:75], s77 offen offset:0
    buffer_load_dwordx4 v[36:39], v47, s[72:75], s77 offen offset:16
    buffer_load_dwordx4 v[40:43], v47, s[72:75], s77 offen offset:32
    buffer_load_dwordx4 v[44:47], v47, s[72:75], s77 offen offset:48
    s_branch M_noacc
M_first:
    s_mov_b32 s50, 2
    s_sub_u32 s27, s26, 4
    s_cmp_ge_u32 s27, 3
    s_cbranch_scc1 M_late
    s_cmp_eq_u32 s48, 0
    s_cbranch_scc1 M_late
    ds_read_b32 v64, v5 offset:12
    ds_read_b32 v65, v5 offset:140
    ds_read_b32 v66, v5 offset:268
    ds_read_b32 v67, v5 offset:396
    s_add_u32 m0, s51, 0
    s_waitcnt lgkmcnt(3)
    v_and_or_b32 v64, v1, s63, v64
    buffer_load_dwordx4 v64, s[28:31], s64 offen offset:0 lds
    buffer_load_dwordx4 v64, s[28:31], s65 offen offset:1024 lds
    buffer_load_dwordx4 v64, s[28:31], s66 offen offset:2048 lds
    s_add_u32 m0, s51, 3072
    s_waitcnt lgkmcnt(2)
    v_and_or_b32 v65, v1, s63, v65
    buffer_load_dwordx4 v65, s[28:31], s64 offen offset:0 lds
    buffer_load_dwordx4 v65, s[28:31], s65 offen offset:1024 lds
    buffer_load_dwordx4 v65, s[28:31], s66 offen offset:2048 lds
    s_add_u32 m0, s51, 6144
    s_waitcnt lgkmcnt(1)
    v_and_or_b32 v66, v1, s63, v66
    buffer_load_dwordx4 v66, s[28:31], s64 offen offset:0 lds
    buffer_load_dwordx4 v66, s[28:31], s65 offen offset:1024 lds
    buffer_load_dwordx4 v66, s[28:31], s66 offen offset:2048 lds
    s_add_u32 m0, s51, 9216
    s_waitcnt lgkmcnt(0)
    v_and_or_b32 v67, v1, s63, v67
    buffer_load_dwordx4 v67, s[28:31], s64 offen offset:0 lds
    buffer_load_dwordx4 v67, s[28:31], s65 offen offset:1024 lds
    buffer_load_dwordx4 v67, s[28:31], s66 offen offset:2048 lds
    s_mov_b32 s50, 3
    s_waitcnt vmcnt(48)
    s_branch M_late2
M_late:
    s_waitcnt vmcnt(36)
M_late2:
    s_mov_b32 s99, 1
    s_cmp_eq_u32 s48, 0
    s_cbranch_scc1 M_rd0
M_rd1:
    s_lshl_b32 s27, s59, 8
    s_add_u32 s27, s27, 30720
    v_lshlrev_b32 v12, 10, v10
    v_lshl_add_u32 v12, v11, 2, v12
    v_add_u32 v12, s27, v12
    s_barrier
    ds_read_u16_d16_hi v128, v12 offset:0
    ds_read_u16_d16_hi v144, v12 offset:2
    ds_read_u16_d16_hi v129, v12 offset:256
    ds_read_u16_d16_hi v145, v12 offset:258
    ds_read_u16_d16_hi v130, v12 offset:512
    ds_read_u16_d16_hi v146, v12 offset:514
    ds_read_u16_d16_hi v131, v12 offset:768
    ds_read_u16_d16_hi v147, v12 offset:770
    ds_read_u16_d16_hi v132, v12 offset:2048
    ds_read_u16_d16_hi v148, v12 offset:2050
    ds_read_u16_d16_hi v133, v12 offset:2304
    ds_read_u16_d16_hi v149, v12 offset:2306
    ds_read_u16_d16_hi v134, v12 offset:2560
    ds_read_u16_d16_hi v150, v12 offset:2562
    ds_read_u16_d16_hi v135, v12 offset:2816
    ds_read_u16_d16_hi v151, v12 offset:2818
    ds_read_u16_d16_hi v136, v12 offset:4096
    ds_read_u16_d16_hi v152, v12 offset:4098
    ds_read_u16_d16_hi v137, v12 offset:4352
    ds_read_u16_d16_hi v153, v12 offset:4354
    ds_read_u16_d16_hi v138, v12 offset:4608
    ds_read_u16_d16_hi v154, v12 offset:4610
    ds_read_u16_d16_hi v139, v12 offset:4864
    ds_read_u16_d16_hi v155, v12 offset:4866
    ds_read_u16_d16_hi v140, v12 offset:6144
    ds_read_u16_d16_hi v156, v12 offset:6146
    ds_read_u16_d16_hi v141, v12 offset:6400
    ds_read_u16_d16_hi v157, v12 offset:6402
    ds_read_u16_d16_hi v142, v12 offset:6656
    ds_read_u16_d16_hi v158, v12 offset:6658
    ds_read_u16_d16_hi v143, v12 offset:6912
    ds_read_u16_d16_hi v159, v12 offset:6914
    ds_read_u16_d16_hi v160, v12 offset:128
    ds_read_u16_d16_hi v176, v12 offset:130
    ds_read_u16_d16_hi v161, v12 offset:384
    ds_read_u16_d16_hi v177, v12 offset:386
    ds_read_u16_d16_hi v162, v12 offset:640
    ds_read_u16_d16_hi v178, v12 offset:642
    ds_read_u16_d16_hi v163, v12 offset:896
    ds_read_u16_d16_hi v179, v12 offset:898
    ds_read_u16_d16_hi v164, v12 offset:2176
    ds_read_u16_d16_hi v180, v12 offset:2178
    ds_read_u16_d16_hi v165, v12 offset:2432
    ds_read_u16_d16_hi v181, v12 offset:2434
    ds_read_u16_d16_hi v166, v12 offset:2688
    ds_read_u16_d16_hi v182, v12 offset:2690
    ds_read_u16_d16_hi v167, v12 offset:2944
    ds_read_u16_d16_hi v183, v12 offset:2946
    ds_read_u16_d16_hi v168, v12 offset:4224
    ds_read_u16_d16_hi v184, v12 offset:4226
    ds_read_u16_d16_hi v169, v12 offset:4480
    ds_read_u16_d16_hi v185, v12 offset:4482
    ds_read_u16_d16_hi v170, v12 offset:4736
    ds_read_u16_d16_hi v186, v12 offset:4738
    ds_read_u16_d16_hi v171, v12 offset:4992
    ds_read_u16_d16_hi v187, v12 offset:4994
    ds_read_u16_d16_hi v172, v12 offset:6272
    ds_read_u16_d16_hi v188, v12 offset:6274
    ds_read_u16_d16_hi v173, v12 offset:6528
    ds_read_u16_d16_hi v189, v12 offset:6530
    ds_read_u16_d16_hi v174, v12 offset:6784
WUP_2301:
    s_cbranch_execz WUP_3819
    ds_read_u16_d16_hi v190, v12 offset:6786
    ds_read_u16_d16_hi v175, v12 offset:7040
    ds_read_u16_d16_hi v191, v12 offset:7042
    s_waitcnt lgkmcnt(0)
    s_cmp_eq_u32 s50, 3
    s_cbranch_scc1 M_noinit
    s_cmp_ge_u32 s26, 4
    s_cbranch_scc1 M_noacc
    s_barrier
    s_mov_b32 s50, 0
M_noacc:
    s_cmp_eq_u32 s48, 0
    s_cbranch_scc1 M_nob
    ds_read_b32 v64, v5 offset:12
    ds_read_b32 v65, v5 offset:140
    ds_read_b32 v66, v5 offset:268
    ds_read_b32 v67, v5 offset:396
    s_add_u32 m0, s51, 0
    s_waitcnt lgkmcnt(3)
    v_and_or_b32 v64, v1, s63, v64
    buffer_load_dwordx4 v64, s[28:31], s64 offen offset:0 lds
    buffer_load_dwordx4 v64, s[28:31], s65 offen offset:1024 lds
    buffer_load_dwordx4 v64, s[28:31], s66 offen offset:2048 lds
    s_add_u32 m0, s51, 3072
    s_waitcnt lgkmcnt(2)
    v_and_or_b32 v65, v1, s63, v65
    buffer_load_dwordx4 v65, s[28:31], s64 offen offset:0 lds
    buffer_load_dwordx4 v65, s[28:31], s65 offen offset:1024 lds
    buffer_load_dwordx4 v65, s[28:31], s66 offen offset:2048 lds
    s_add_u32 m0, s51, 6144
    s_waitcnt lgkmcnt(1)
    v_and_or_b32 v66, v1, s63, v66
    buffer_load_dwordx4 v66, s[28:31], s64 offen offset:0 lds
    buffer_load_dwordx4 v66, s[28:31], s65 offen offset:1024 lds
    buffer_load_dwordx4 v66, s[28:31], s66 offen offset:2048 lds
    s_add_u32 m0, s51, 9216
    s_waitcnt lgkmcnt(0)
    v_and_or_b32 v67, v1, s63, v67
    buffer_load_dwordx4 v67, s[28:31], s64 offen offset:0 lds
    buffer_load_dwordx4 v67, s[28:31], s65 offen offset:1024 lds
    buffer_load_dwordx4 v67, s[28:31], s66 offen offset:2048 lds
    s_branch M_noinit
M_nob:
M_noinit:
    s_cmp_eq_u32 s50, 0
    s_cbranch_scc1 M_nod
    s_barrier
    s_mov_b32 s50, 0
M_nod:
    s_cmp_eq_u32 s48, 0
    s_cbranch_scc1 M_wend
    s_mov_b32 s49, 0
    s_sub_u32 s27, s48, s49
    s_cmp_ge_u32 s26, 4
    s_addc_u32 s27, s27, 0
    s_setprio 0
    s_cmp_le_u32 s27, 1
    s_cbranch_scc1 M_rp16
    s_setprio 1
    s_cmp_le_u32 s27, 2
    s_cbranch_scc1 M_rp16
    s_setprio 2
    s_cmp_le_u32 s27, 3
    s_cbranch_scc1 M_rp16
    s_setprio 3
M_rp16:
    ds_read_b128 v[48:51], v3 offset:0
    ds_read_b128 v[52:55], v7
    ds_read_b128 v[56:59], v7 offset:16
    ds_read_b64 v[12:13], v4 offset:2048
    ds_read_b64 v[14:15], v4 offset:2160
    ds_read_b64 v[16:17], v4 offset:2272
    ds_read_b64 v[18:19], v4 offset:2384
    ds_read_b128 v[20:23], v1 offset:24576
    ds_read_b128 v[24:27], v1 offset:0
    ds_read_b128 v[28:31], v1 offset:1024
    s_waitcnt lgkmcnt(7)
    v_mul_f32 v52, v48, v52
    v_mul_f32 v53, v48, v53
    v_mul_f32 v54, v48, v54
    v_mul_f32 v55, v48, v55
    v_mul_f32 v56, v48, v56
    v_mul_f32 v57, v48, v57
    v_mul_f32 v58, v48, v58
    v_mul_f32 v59, v48, v59
    v_cvt_pk_bf16_f32 v52, 0, v52
    v_cvt_pk_bf16_f32 v53, 0, v53
    v_cvt_pk_bf16_f32 v54, 0, v54
    v_cvt_pk_bf16_f32 v55, 0, v55
    v_cvt_pk_bf16_f32 v56, 0, v56
    v_cvt_pk_bf16_f32 v57, 0, v57
    v_cvt_pk_bf16_f32 v58, 0, v58
    v_cvt_pk_bf16_f32 v59, 0, v59
    v_mul_f32 v52, s61, v52
    v_mul_f32 v53, s61, v53
    v_mul_f32 v54, s61, v54
    v_mul_f32 v55, s61, v55
    v_mul_f32 v56, s61, v56
    v_mul_f32 v57, s61, v57
    v_mul_f32 v58, s61, v58
    v_mul_f32 v59, s61, v59
    v_sin_f32 v52, v52
    v_sin_f32 v53, v53
    v_sin_f32 v54, v54
    v_sin_f32 v55, v55
    v_sin_f32 v56, v56
    v_sin_f32 v57, v57
    v_sin_f32 v58, v58
    v_sin_f32 v59, v59
    v_mul_f32 v52, v52, v49
    v_mul_f32 v53, v53, v49
    v_mul_f32 v54, v54, v49
    v_mul_f32 v55, v55, v49
    v_mul_f32 v56, v56, v49
    v_mul_f32 v57, v57, v49
    v_mul_f32 v58, v58, v49
    v_mul_f32 v59, v59, v49
    v_cvt_pk_bf16_f32 v8, v52, v53
    v_cvt_pk_bf16_f32 v9, v54, v55
    v_cvt_pk_bf16_f32 v10, v56, v57
    v_cvt_pk_bf16_f32 v11, v58, v59
    s_waitcnt lgkmcnt(3)
    v_pk_lshlrev_b16 v12, v6, v12
    v_pk_lshlrev_b16 v13, v6, v13
    v_pk_lshlrev_b16 v14, v6, v14
    v_pk_lshlrev_b16 v15, v6, v15
    v_pk_lshlrev_b16 v16, v6, v16
    v_pk_lshlrev_b16 v17, v6, v17
    v_pk_lshlrev_b16 v18, v6, v18
    v_pk_lshlrev_b16 v19, v6, v19
    s_waitcnt lgkmcnt(0)
    s_nop 0
M_batch:
    s_cmp_lg_u32 s99, 0
    s_waitcnt vmcnt(44)
    s_cbranch_scc1 M_hw17
    s_waitcnt vmcnt(12)
M_hw17:
    ds_read_b32 v63, v3 offset:524
    v_mfma_f32_32x32x16_bf16 v[80:95], v[8:11], v[20:23], 0
    ds_read_b128 v[20:23], v1 offset:2048
    s_add_u32 s77, s49, 1
    s_cmp_lt_u32 s77, s48
    s_cselect_b32 s77, 0, 0x40000000
    v_mfma_f32_32x32x16_bf16 v[64:79], v[32:35], v[24:27], 0
    ds_read_b128 v[24:27], v1 offset:3072
    v_mfma_f32_32x32x16_bf16 v[64:79], v[36:39], v[28:31], v[64:79]
    ds_read_b128 v[28:31], v1 offset:25600
    v_bfe_u32 v62, v1, 9, 1
    s_waitcnt lgkmcnt(3)
    v_lshrrev_b32 v63, 2, v63
    v_lshl_add_u32 v63, v62, 6, v63
    buffer_load_dwordx4 v[48:51], v63, s[72:75], s77 offen offset:0
    buffer_load_dwordx4 v[52:55], v63, s[72:75], s77 offen offset:16
    buffer_load_dwordx4 v[56:59], v63, s[72:75], s77 offen offset:32
    buffer_load_dwordx4 v[60:63], v63, s[72:75], s77 offen offset:48
    s_waitcnt lgkmcnt(2)
    v_mfma_f32_32x32x16_bf16 v[64:79], v[40:43], v[20:23], v[64:79]
    ds_read_b128 v[20:23], v1 offset:4096
    s_waitcnt lgkmcnt(2)
    v_mfma_f32_32x32x16_bf16 v[64:79], v[44:47], v[24:27], v[64:79]
    ds_read_b128 v[24:27], v1 offset:5120
    s_waitcnt lgkmcnt(2)
    v_mfma_f32_32x32x16_bf16 v[112:127], v[8:11], v[28:31], 0
    ds_read_b128 v[28:31], v1 offset:6144
    s_waitcnt lgkmcnt(2)
    v_mfma_f32_32x32x16_bf16 v[96:111], v[32:35], v[20:23], 0
    ds_read_b128 v[20:23], v1 offset:7168
    s_nop 4
    v_mul_f32 v64, v64, v80
    v_mul_f32 v65, v65, v81
    v_mul_f32 v66, v66, v82
    v_mul_f32 v67, v67, v83
    v_mul_f32 v68, v68, v84
    v_mul_f32 v69, v69, v85
    s_waitcnt lgkmcnt(2)
    v_mfma_f32_32x32x16_bf16 v[96:111], v[36:39], v[24:27], v[96:111]
    ds_read_b128 v[24:27], v1 offset:26624
    v_mul_f32 v70, v70, v86
    v_mul_f32 v71, v71, v87
    v_mul_f32 v72, v72, v88
    v_mul_f32 v73, v73, v89
    v_mul_f32 v74, v74, v90
    v_mul_f32 v75, v75, v91
    v_mul_f32 v76, v76, v92
    s_waitcnt lgkmcnt(2)
    v_mfma_f32_32x32x16_bf16 v[96:111], v[40:43], v[28:31], v[96:111]
    ds_read_b128 v[28:31], v1 offset:8192
    v_mul_f32 v77, v77, v93
    v_mul_f32 v78, v78, v94
    v_mul_f32 v79, v79, v95
    v_cvt_pk_bf16_f32 v64, v64, v65
    v_cvt_pk_bf16_f32 v65, v66, v67
    v_cvt_pk_bf16_f32 v66, v68, v69
WUP_2488:
    s_cbranch_execz WUP_3936
    s_waitcnt lgkmcnt(2)
    v_mfma_f32_32x32x16_bf16 v[96:111], v[44:47], v[20:23], v[96:111]
    ds_read_b128 v[20:23], v1 offset:9216
    v_cvt_pk_bf16_f32 v67, v70, v71
    v_cvt_pk_bf16_f32 v68, v72, v73
    v_cvt_pk_bf16_f32 v69, v74, v75
    v_cvt_pk_bf16_f32 v70, v76, v77
    v_cvt_pk_bf16_f32 v71, v78, v79
    v_mfma_f32_32x32x16_bf16 v[128:143], v[12:15], v[64:67], v[128:143]
    s_nop 0
    v_mfma_f32_32x32x16_bf16 v[128:143], v[16:19], v[68:71], v[128:143]
    s_waitcnt lgkmcnt(2)
    v_mfma_f32_32x32x16_bf16 v[80:95], v[8:11], v[24:27], 0
    ds_read_b128 v[24:27], v1 offset:10240
    s_waitcnt lgkmcnt(2)
    v_mfma_f32_32x32x16_bf16 v[64:79], v[32:35], v[28:31], 0
    ds_read_b128 v[28:31], v1 offset:11264
    v_mul_f32 v96, v96, v112
    v_mul_f32 v97, v97, v113
    v_mul_f32 v98, v98, v114
    v_mul_f32 v99, v99, v115
    v_mul_f32 v100, v100, v116
    v_mul_f32 v101, v101, v117
    s_waitcnt lgkmcnt(2)
    v_mfma_f32_32x32x16_bf16 v[64:79], v[36:39], v[20:23], v[64:79]
    ds_read_b128 v[20:23], v1 offset:27648
    v_mul_f32 v102, v102, v118
    v_mul_f32 v103, v103, v119
    v_mul_f32 v104, v104, v120
    v_mul_f32 v105, v105, v121
    v_mul_f32 v106, v106, v122
    v_mul_f32 v107, v107, v123
    v_mul_f32 v108, v108, v124
    s_waitcnt lgkmcnt(2)
    v_mfma_f32_32x32x16_bf16 v[64:79], v[40:43], v[24:27], v[64:79]
    ds_read_b128 v[24:27], v1 offset:12288
    v_mul_f32 v109, v109, v125
    v_mul_f32 v110, v110, v126
    v_mul_f32 v111, v111, v127
    v_cvt_pk_bf16_f32 v96, v96, v97
    v_cvt_pk_bf16_f32 v97, v98, v99
    v_cvt_pk_bf16_f32 v98, v100, v101
    s_waitcnt lgkmcnt(2)
    v_mfma_f32_32x32x16_bf16 v[64:79], v[44:47], v[28:31], v[64:79]
    ds_read_b128 v[28:31], v1 offset:13312
    v_cvt_pk_bf16_f32 v99, v102, v103
    v_cvt_pk_bf16_f32 v100, v104, v105
    v_cvt_pk_bf16_f32 v101, v106, v107
    v_cvt_pk_bf16_f32 v102, v108, v109
    v_cvt_pk_bf16_f32 v103, v110, v111
    v_mfma_f32_32x32x16_bf16 v[144:159], v[12:15], v[96:99], v[144:159]
    s_nop 0
    v_mfma_f32_32x32x16_bf16 v[144:159], v[16:19], v[100:103], v[144:159]
    s_waitcnt lgkmcnt(2)
    v_mfma_f32_32x32x16_bf16 v[112:127], v[8:11], v[20:23], 0
    ds_read_b128 v[20:23], v1 offset:14336
    s_waitcnt lgkmcnt(2)
    v_mfma_f32_32x32x16_bf16 v[96:111], v[32:35], v[24:27], 0
    ds_read_b128 v[24:27], v1 offset:15360
    v_mul_f32 v64, v64, v80
    v_mul_f32 v65, v65, v81
    v_mul_f32 v66, v66, v82
    v_mul_f32 v67, v67, v83
    v_mul_f32 v68, v68, v84
    v_mul_f32 v69, v69, v85
    v_mul_f32 v70, v70, v86
    v_mul_f32 v71, v71, v87
    v_mul_f32 v72, v72, v88
    v_mul_f32 v73, v73, v89
    v_mul_f32 v74, v74, v90
    v_mul_f32 v75, v75, v91
    v_mul_f32 v76, v76, v92
    v_mul_f32 v77, v77, v93
    v_mul_f32 v78, v78, v94
    v_mul_f32 v79, v79, v95
    s_waitcnt vmcnt(4)
    s_cmp_eq_u32 s99, 0
    s_cbranch_scc1 M_ru18
    v_lshlrev_b32 v192, 16, v208
    v_and_b32 v208, s58, v208
    v_lshlrev_b32 v193, 16, v209
    v_and_b32 v209, s58, v209
    v_lshlrev_b32 v194, 16, v210
    v_and_b32 v210, s58, v210
    v_lshlrev_b32 v195, 16, v211
    v_and_b32 v211, s58, v211
    v_lshlrev_b32 v196, 16, v212
    v_and_b32 v212, s58, v212
    v_lshlrev_b32 v197, 16, v213
    v_and_b32 v213, s58, v213
    v_lshlrev_b32 v198, 16, v214
    v_and_b32 v214, s58, v214
    v_lshlrev_b32 v199, 16, v215
    v_and_b32 v215, s58, v215
    v_lshlrev_b32 v200, 16, v216
    v_and_b32 v216, s58, v216
    v_lshlrev_b32 v201, 16, v217
    v_and_b32 v217, s58, v217
    v_lshlrev_b32 v202, 16, v218
    v_and_b32 v218, s58, v218
    v_lshlrev_b32 v203, 16, v219
    v_and_b32 v219, s58, v219
    v_lshlrev_b32 v204, 16, v220
    v_and_b32 v220, s58, v220
    v_lshlrev_b32 v205, 16, v221
    v_and_b32 v221, s58, v221
    v_lshlrev_b32 v206, 16, v222
    v_and_b32 v222, s58, v222
    v_lshlrev_b32 v207, 16, v223
    v_and_b32 v223, s58, v223
    v_lshlrev_b32 v224, 16, v240
    v_and_b32 v240, s58, v240
    v_lshlrev_b32 v225, 16, v241
    v_and_b32 v241, s58, v241
    v_lshlrev_b32 v226, 16, v242
    v_and_b32 v242, s58, v242
    v_lshlrev_b32 v227, 16, v243
    v_and_b32 v243, s58, v243
    v_lshlrev_b32 v228, 16, v244
    v_and_b32 v244, s58, v244
    v_lshlrev_b32 v229, 16, v245
    v_and_b32 v245, s58, v245
    v_lshlrev_b32 v230, 16, v246
    v_and_b32 v246, s58, v246
    v_lshlrev_b32 v231, 16, v247
    v_and_b32 v247, s58, v247
    v_lshlrev_b32 v232, 16, v248
    v_and_b32 v248, s58, v248
    v_lshlrev_b32 v233, 16, v249
    v_and_b32 v249, s58, v249
    v_lshlrev_b32 v234, 16, v250
    v_and_b32 v250, s58, v250
    v_lshlrev_b32 v235, 16, v251
    v_and_b32 v251, s58, v251
    v_lshlrev_b32 v236, 16, v252
    v_and_b32 v252, s58, v252
    v_lshlrev_b32 v237, 16, v253
    v_and_b32 v253, s58, v253
    v_lshlrev_b32 v238, 16, v254
    v_and_b32 v254, s58, v254
    v_lshlrev_b32 v239, 16, v255
    v_and_b32 v255, s58, v255
    s_mov_b32 s99, 0
    s_nop 0
M_ru18:
    ds_read_u16_d16_hi v80, v2 offset:0
    ds_read_u16_d16_hi v81, v2 offset:256
    ds_read_u16_d16_hi v82, v2 offset:512
    ds_read_u16_d16_hi v83, v2 offset:768
    ds_read_u16_d16_hi v84, v2 offset:3072
    ds_read_u16_d16_hi v85, v2 offset:3328
    ds_read_u16_d16_hi v86, v2 offset:3584
    ds_read_u16_d16_hi v87, v2 offset:3840
    ds_read_u16_d16_hi v88, v2 offset:6144
    ds_read_u16_d16_hi v89, v2 offset:6400
    ds_read_u16_d16_hi v90, v2 offset:6656
    ds_read_u16_d16_hi v91, v2 offset:6912
    ds_read_u16_d16_hi v92, v2 offset:9216
    ds_read_u16_d16_hi v93, v2 offset:9472
    ds_read_u16_d16_hi v94, v2 offset:9728
    ds_read_u16_d16_hi v95, v2 offset:9984
    s_waitcnt lgkmcnt(8)
    v_mul_f32 v80, v80, v64
    v_mul_f32 v81, v81, v65
    v_mul_f32 v82, v82, v66
    v_mul_f32 v83, v83, v67
    v_mul_f32 v84, v84, v68
    v_mul_f32 v85, v85, v69
    v_mfma_f32_32x32x16_bf16 v[96:111], v[36:39], v[28:31], v[96:111]
    ds_read_b128 v[28:31], v1 offset:28672
    v_mul_f32 v86, v86, v70
    v_mul_f32 v87, v87, v71
    v_cvt_pk_bf16_f32 v80, v80, v81
WUP_2660:
    s_cbranch_execz WUR_1
    v_cvt_pk_bf16_f32 v81, v82, v83
    v_cvt_pk_bf16_f32 v82, v84, v85
    v_cvt_pk_bf16_f32 v83, v86, v87
    s_waitcnt lgkmcnt(1)
    v_mul_f32 v88, v88, v72
    v_mul_f32 v89, v89, v73
    v_mfma_f32_32x32x16_bf16 v[160:175], v[12:15], v[80:83], v[160:175]
    ds_read_u16_d16_hi v80, v2 offset:1024
    ds_read_u16_d16_hi v81, v2 offset:1280
    ds_read_u16_d16_hi v82, v2 offset:1536
    ds_read_u16_d16_hi v83, v2 offset:1792
    ds_read_u16_d16_hi v84, v2 offset:4096
    ds_read_u16_d16_hi v85, v2 offset:4352
    ds_read_u16_d16_hi v86, v2 offset:4608
    ds_read_u16_d16_hi v87, v2 offset:4864
    v_mul_f32 v90, v90, v74
    v_mul_f32 v91, v91, v75
    v_mul_f32 v92, v92, v76
    v_mul_f32 v93, v93, v77
    v_mul_f32 v94, v94, v78
    v_mul_f32 v95, v95, v79
    v_cvt_pk_bf16_f32 v88, v88, v89
    v_cvt_pk_bf16_f32 v89, v90, v91
    v_cvt_pk_bf16_f32 v90, v92, v93
    v_cvt_pk_bf16_f32 v91, v94, v95
    s_waitcnt lgkmcnt(0)
    v_mul_f32 v80, v80, v64
    v_mul_f32 v81, v81, v65
    v_mfma_f32_32x32x16_bf16 v[160:175], v[16:19], v[88:91], v[160:175]
    ds_read_u16_d16_hi v88, v2 offset:7168
    ds_read_u16_d16_hi v89, v2 offset:7424
    ds_read_u16_d16_hi v90, v2 offset:7680
    ds_read_u16_d16_hi v91, v2 offset:7936
    ds_read_u16_d16_hi v92, v2 offset:10240
    ds_read_u16_d16_hi v93, v2 offset:10496
    ds_read_u16_d16_hi v94, v2 offset:10752
    ds_read_u16_d16_hi v95, v2 offset:11008
    v_mul_f32 v82, v82, v66
    v_mfma_f32_32x32x16_bf16 v[96:111], v[40:43], v[20:23], v[96:111]
    ds_read_b128 v[20:23], v1 offset:16384
    v_mul_f32 v83, v83, v67
    v_mul_f32 v84, v84, v68
    v_mul_f32 v85, v85, v69
    v_mul_f32 v86, v86, v70
    v_mul_f32 v87, v87, v71
    v_cvt_pk_bf16_f32 v80, v80, v81
    v_cvt_pk_bf16_f32 v81, v82, v83
    v_cvt_pk_bf16_f32 v82, v84, v85
    v_cvt_pk_bf16_f32 v83, v86, v87
    s_waitcnt lgkmcnt(1)
    v_mul_f32 v88, v88, v72
    v_mul_f32 v89, v89, v73
    v_mfma_f32_32x32x16_bf16 v[192:207], v[12:15], v[80:83], v[192:207]
    ds_read_u16_d16_hi v80, v2 offset:2048
    ds_read_u16_d16_hi v81, v2 offset:2304
    ds_read_u16_d16_hi v82, v2 offset:2560
    ds_read_u16_d16_hi v83, v2 offset:2816
    ds_read_u16_d16_hi v84, v2 offset:5120
    ds_read_u16_d16_hi v85, v2 offset:5376
    ds_read_u16_d16_hi v86, v2 offset:5632
    ds_read_u16_d16_hi v87, v2 offset:5888
    v_mul_f32 v90, v90, v74
    v_mul_f32 v91, v91, v75
    v_mul_f32 v92, v92, v76
    v_mul_f32 v93, v93, v77
    v_mul_f32 v94, v94, v78
    v_mul_f32 v95, v95, v79
    v_cvt_pk_bf16_f32 v88, v88, v89
    v_cvt_pk_bf16_f32 v89, v90, v91
    v_cvt_pk_bf16_f32 v90, v92, v93
    v_cvt_pk_bf16_f32 v91, v94, v95
    s_waitcnt lgkmcnt(0)
    v_mul_f32 v80, v80, v64
    v_mul_f32 v81, v81, v65
    v_mfma_f32_32x32x16_bf16 v[96:111], v[44:47], v[24:27], v[96:111]
    ds_read_b128 v[24:27], v1 offset:17408
    v_mfma_f32_32x32x16_bf16 v[192:207], v[16:19], v[88:91], v[192:207]
    ds_read_u16_d16_hi v88, v2 offset:8192
    ds_read_u16_d16_hi v89, v2 offset:8448
    ds_read_u16_d16_hi v90, v2 offset:8704
    ds_read_u16_d16_hi v91, v2 offset:8960
    ds_read_u16_d16_hi v92, v2 offset:11264
    ds_read_u16_d16_hi v93, v2 offset:11520
    ds_read_u16_d16_hi v94, v2 offset:11776
    ds_read_u16_d16_hi v95, v2 offset:12032
    v_mul_f32 v82, v82, v66
    v_mul_f32 v83, v83, v67
    v_mul_f32 v84, v84, v68
    v_mul_f32 v85, v85, v69
    v_mul_f32 v86, v86, v70
    v_mul_f32 v87, v87, v71
    v_cvt_pk_bf16_f32 v80, v80, v81
    v_cvt_pk_bf16_f32 v81, v82, v83
    v_cvt_pk_bf16_f32 v82, v84, v85
    v_cvt_pk_bf16_f32 v83, v86, v87
    s_waitcnt lgkmcnt(0)
    v_mul_f32 v88, v88, v72
    v_mul_f32 v89, v89, v73
    v_mfma_f32_32x32x16_bf16 v[224:239], v[12:15], v[80:83], v[224:239]
    v_mul_f32 v90, v90, v74
    v_mul_f32 v91, v91, v75
    v_mul_f32 v92, v92, v76
    v_mul_f32 v93, v93, v77
    v_mul_f32 v94, v94, v78
    v_mul_f32 v95, v95, v79
    v_cvt_pk_bf16_f32 v88, v88, v89
    v_cvt_pk_bf16_f32 v89, v90, v91
    v_cvt_pk_bf16_f32 v90, v92, v93
    v_cvt_pk_bf16_f32 v91, v94, v95
    s_nop 1
    v_mfma_f32_32x32x16_bf16 v[224:239], v[16:19], v[88:91], v[224:239]
    v_mfma_f32_32x32x16_bf16 v[80:95], v[8:11], v[28:31], 0
    ds_read_b128 v[28:31], v1 offset:18432
    v_mfma_f32_32x32x16_bf16 v[64:79], v[32:35], v[20:23], 0
    ds_read_b128 v[20:23], v1 offset:19456
    v_mul_f32 v96, v96, v112
    v_mul_f32 v97, v97, v113
    v_mul_f32 v98, v98, v114
    v_mul_f32 v99, v99, v115
    v_mul_f32 v100, v100, v116
    v_mul_f32 v101, v101, v117
    v_mul_f32 v102, v102, v118
    v_mul_f32 v103, v103, v119
    v_mul_f32 v104, v104, v120
    v_mul_f32 v105, v105, v121
    v_mul_f32 v106, v106, v122
    v_mul_f32 v107, v107, v123
    v_mul_f32 v108, v108, v124
    v_mul_f32 v109, v109, v125
    v_mul_f32 v110, v110, v126
    v_mul_f32 v111, v111, v127
    ds_read_u16_d16_hi v112, v2 offset:2
    ds_read_u16_d16_hi v113, v2 offset:258
    ds_read_u16_d16_hi v114, v2 offset:514
    ds_read_u16_d16_hi v115, v2 offset:770
    ds_read_u16_d16_hi v116, v2 offset:3074
    ds_read_u16_d16_hi v117, v2 offset:3330
    ds_read_u16_d16_hi v118, v2 offset:3586
    ds_read_u16_d16_hi v119, v2 offset:3842
    ds_read_u16_d16_hi v120, v2 offset:6146
    ds_read_u16_d16_hi v121, v2 offset:6402
    ds_read_u16_d16_hi v122, v2 offset:6658
    ds_read_u16_d16_hi v123, v2 offset:6914
    ds_read_u16_d16_hi v124, v2 offset:9218
    ds_read_u16_d16_hi v125, v2 offset:9474
    ds_read_u16_d16_hi v126, v2 offset:9730
    ds_read_u16_d16_hi v127, v2 offset:9986
    s_waitcnt lgkmcnt(8)
    v_mul_f32 v112, v112, v96
    v_mul_f32 v113, v113, v97
    v_mul_f32 v114, v114, v98
    v_mul_f32 v115, v115, v99
    v_mul_f32 v116, v116, v100
    v_mul_f32 v117, v117, v101
    v_mul_f32 v118, v118, v102
    v_mfma_f32_32x32x16_bf16 v[64:79], v[36:39], v[24:27], v[64:79]
    ds_read_b128 v[24:27], v1 offset:29696
    v_mul_f32 v119, v119, v103
    v_cvt_pk_bf16_f32 v112, v112, v113
    v_cvt_pk_bf16_f32 v113, v114, v115
    v_cvt_pk_bf16_f32 v114, v116, v117
    v_cvt_pk_bf16_f32 v115, v118, v119
    s_waitcnt lgkmcnt(1)
    v_mul_f32 v120, v120, v104
    v_mul_f32 v121, v121, v105
    v_mfma_f32_32x32x16_bf16 v[176:191], v[12:15], v[112:115], v[176:191]
    ds_read_u16_d16_hi v112, v2 offset:1026
    ds_read_u16_d16_hi v113, v2 offset:1282
    ds_read_u16_d16_hi v114, v2 offset:1538
    ds_read_u16_d16_hi v115, v2 offset:1794
    ds_read_u16_d16_hi v116, v2 offset:4098
    ds_read_u16_d16_hi v117, v2 offset:4354
    ds_read_u16_d16_hi v118, v2 offset:4610
    ds_read_u16_d16_hi v119, v2 offset:4866
    v_mul_f32 v122, v122, v106
    v_mul_f32 v123, v123, v107
    v_mul_f32 v124, v124, v108
    v_mul_f32 v125, v125, v109
    v_mul_f32 v126, v126, v110
    v_mul_f32 v127, v127, v111
    v_cvt_pk_bf16_f32 v120, v120, v121
    v_cvt_pk_bf16_f32 v121, v122, v123
    v_cvt_pk_bf16_f32 v122, v124, v125
    v_cvt_pk_bf16_f32 v123, v126, v127
    s_waitcnt lgkmcnt(0)
    v_mul_f32 v112, v112, v96
    v_mul_f32 v113, v113, v97
    v_mfma_f32_32x32x16_bf16 v[176:191], v[16:19], v[120:123], v[176:191]
    ds_read_u16_d16_hi v120, v2 offset:7170
    ds_read_u16_d16_hi v121, v2 offset:7426
    ds_read_u16_d16_hi v122, v2 offset:7682
    ds_read_u16_d16_hi v123, v2 offset:7938
    ds_read_u16_d16_hi v124, v2 offset:10242
    ds_read_u16_d16_hi v125, v2 offset:10498
    ds_read_u16_d16_hi v126, v2 offset:10754
    ds_read_u16_d16_hi v127, v2 offset:11010
    v_mul_f32 v114, v114, v98
    v_mul_f32 v115, v115, v99
    v_mfma_f32_32x32x16_bf16 v[64:79], v[40:43], v[28:31], v[64:79]
    ds_read_b128 v[28:31], v1 offset:20480
    v_mul_f32 v116, v116, v100
    v_mul_f32 v117, v117, v101
    v_mul_f32 v118, v118, v102
    v_mul_f32 v119, v119, v103
    v_cvt_pk_bf16_f32 v112, v112, v113
    v_cvt_pk_bf16_f32 v113, v114, v115
    v_cvt_pk_bf16_f32 v114, v116, v117
    v_cvt_pk_bf16_f32 v115, v118, v119
    s_waitcnt lgkmcnt(1)
    v_mul_f32 v120, v120, v104
    v_mul_f32 v121, v121, v105
    v_mfma_f32_32x32x16_bf16 v[208:223], v[12:15], v[112:115], v[208:223]
    ds_read_u16_d16_hi v112, v2 offset:2050
    ds_read_u16_d16_hi v113, v2 offset:2306
    ds_read_u16_d16_hi v114, v2 offset:2562
    ds_read_u16_d16_hi v115, v2 offset:2818
    ds_read_u16_d16_hi v116, v2 offset:5122
    ds_read_u16_d16_hi v117, v2 offset:5378
    ds_read_u16_d16_hi v118, v2 offset:5634
    ds_read_u16_d16_hi v119, v2 offset:5890
    v_mul_f32 v122, v122, v106
    v_mul_f32 v123, v123, v107
    v_mul_f32 v124, v124, v108
    v_mul_f32 v125, v125, v109
    v_mul_f32 v126, v126, v110
    v_mul_f32 v127, v127, v111
    v_cvt_pk_bf16_f32 v120, v120, v121
    v_cvt_pk_bf16_f32 v121, v122, v123
    v_cvt_pk_bf16_f32 v122, v124, v125
    v_cvt_pk_bf16_f32 v123, v126, v127
    s_waitcnt lgkmcnt(0)
    v_mul_f32 v112, v112, v96
    v_mul_f32 v113, v113, v97
    v_mfma_f32_32x32x16_bf16 v[208:223], v[16:19], v[120:123], v[208:223]
    v_mfma_f32_32x32x16_bf16 v[64:79], v[44:47], v[20:23], v[64:79]
    ds_read_b128 v[20:23], v1 offset:21504
    ds_read_u16_d16_hi v120, v2 offset:8194
    ds_read_u16_d16_hi v121, v2 offset:8450
    ds_read_u16_d16_hi v122, v2 offset:8706
    ds_read_u16_d16_hi v123, v2 offset:8962
    ds_read_u16_d16_hi v124, v2 offset:11266
    ds_read_u16_d16_hi v125, v2 offset:11522
    ds_read_u16_d16_hi v126, v2 offset:11778
    ds_read_u16_d16_hi v127, v2 offset:12034
    v_mul_f32 v114, v114, v98
    v_mul_f32 v115, v115, v99
    v_mul_f32 v116, v116, v100
    v_mul_f32 v117, v117, v101
    v_mul_f32 v118, v118, v102
    v_mul_f32 v119, v119, v103
    v_cvt_pk_bf16_f32 v112, v112, v113
    v_cvt_pk_bf16_f32 v113, v114, v115
    v_cvt_pk_bf16_f32 v114, v116, v117
    v_cvt_pk_bf16_f32 v115, v118, v119
    s_waitcnt lgkmcnt(0)
    v_mul_f32 v120, v120, v104
    v_mul_f32 v121, v121, v105
    v_mfma_f32_32x32x16_bf16 v[240:255], v[12:15], v[112:115], v[240:255]
    ds_read_b32 v112, v5 offset:524
    ds_read_b32 v113, v5 offset:652
    ds_read_b32 v114, v5 offset:780
    ds_read_b32 v115, v5 offset:908
    v_mul_f32 v122, v122, v106
    v_mul_f32 v123, v123, v107
    v_mul_f32 v124, v124, v108
    v_mul_f32 v125, v125, v109
    v_mul_f32 v126, v126, v110
    v_mul_f32 v127, v127, v111
    v_cvt_pk_bf16_f32 v120, v120, v121
    v_cvt_pk_bf16_f32 v121, v122, v123
    v_cvt_pk_bf16_f32 v122, v124, v125
    v_cvt_pk_bf16_f32 v123, v126, v127
    s_nop 1
    v_mfma_f32_32x32x16_bf16 v[240:255], v[16:19], v[120:123], v[240:255]
    s_cmp_lg_u32 s77, 0
    s_cbranch_scc1 M_nv19
    s_add_u32 m0, s51, 0
    s_waitcnt lgkmcnt(3)
    v_and_or_b32 v112, v1, s63, v112
    buffer_load_dwordx4 v112, s[28:31], s64 offen offset:0 lds
    buffer_load_dwordx4 v112, s[28:31], s65 offen offset:1024 lds
    buffer_load_dwordx4 v112, s[28:31], s66 offen offset:2048 lds
    s_add_u32 m0, s51, 3072
    s_waitcnt lgkmcnt(2)
    v_and_or_b32 v113, v1, s63, v113
    buffer_load_dwordx4 v113, s[28:31], s64 offen offset:0 lds
    buffer_load_dwordx4 v113, s[28:31], s65 offen offset:1024 lds
    buffer_load_dwordx4 v113, s[28:31], s66 offen offset:2048 lds
    s_add_u32 m0, s51, 6144
    s_waitcnt lgkmcnt(1)
    v_and_or_b32 v114, v1, s63, v114
    buffer_load_dwordx4 v114, s[28:31], s64 offen offset:0 lds
    buffer_load_dwordx4 v114, s[28:31], s65 offen offset:1024 lds
    buffer_load_dwordx4 v114, s[28:31], s66 offen offset:2048 lds
    s_add_u32 m0, s51, 9216
    s_waitcnt lgkmcnt(0)
    v_and_or_b32 v115, v1, s63, v115
    buffer_load_dwordx4 v115, s[28:31], s64 offen offset:0 lds
    buffer_load_dwordx4 v115, s[28:31], s65 offen offset:1024 lds
    buffer_load_dwordx4 v115, s[28:31], s66 offen offset:2048 lds
M_nv19:
    s_waitcnt lgkmcnt(0)
    v_mfma_f32_32x32x16_bf16 v[112:127], v[8:11], v[24:27], 0
    ds_read_b128 v[24:27], v1 offset:22528
    v_mfma_f32_32x32x16_bf16 v[96:111], v[32:35], v[28:31], 0
    ds_read_b128 v[28:31], v1 offset:23552
    v_mul_f32 v64, v64, v80
    v_mul_f32 v65, v65, v81
    v_mul_f32 v66, v66, v82
    v_mul_f32 v67, v67, v83
    v_mul_f32 v68, v68, v84
    v_mul_f32 v69, v69, v85
    v_mul_f32 v70, v70, v86
    v_mul_f32 v71, v71, v87
    v_mul_f32 v72, v72, v88
    v_mul_f32 v73, v73, v89
    v_mul_f32 v74, v74, v90
    v_mul_f32 v75, v75, v91
    v_mfma_f32_32x32x16_bf16 v[96:111], v[36:39], v[20:23], v[96:111]
    v_mul_f32 v76, v76, v92
    v_mul_f32 v77, v77, v93
    v_mul_f32 v78, v78, v94
    v_mul_f32 v79, v79, v95
    ds_read_b64 v[80:81], v0 offset:2080
    ds_read_b64 v[88:89], v0 offset:2088
    ds_read_b64 v[82:83], v0 offset:2192
    ds_read_b64 v[90:91], v0 offset:2200
    ds_read_b64 v[84:85], v0 offset:2304
    ds_read_b64 v[92:93], v0 offset:2312
    ds_read_b64 v[86:87], v0 offset:2416
    ds_read_b64 v[94:95], v0 offset:2424
    v_cvt_pk_bf16_f32 v64, v64, v65
    v_cvt_pk_bf16_f32 v65, v66, v67
    v_cvt_pk_bf16_f32 v66, v68, v69
    v_cvt_pk_bf16_f32 v67, v70, v71
    v_cvt_pk_bf16_f32 v68, v72, v73
    v_cvt_pk_bf16_f32 v69, v74, v75
    v_cvt_pk_bf16_f32 v70, v76, v77
    s_waitcnt lgkmcnt(9)
    v_mfma_f32_32x32x16_bf16 v[96:111], v[40:43], v[24:27], v[96:111]
    v_cvt_pk_bf16_f32 v71, v78, v79
    v_pk_lshrrev_b16 v72, 14, v12 op_sel_hi:[0,1]
    v_pk_lshrrev_b16 v73, 14, v13 op_sel_hi:[0,1]
    v_pk_lshrrev_b16 v74, 14, v14 op_sel_hi:[0,1]
    v_pk_lshrrev_b16 v75, 14, v15 op_sel_hi:[0,1]
    v_pk_lshrrev_b16 v76, 14, v16 op_sel_hi:[0,1]
    v_pk_lshrrev_b16 v77, 14, v17 op_sel_hi:[0,1]
    v_pk_lshrrev_b16 v78, 14, v18 op_sel_hi:[0,1]
    v_pk_lshrrev_b16 v79, 14, v19 op_sel_hi:[0,1]
    s_waitcnt lgkmcnt(0)
    v_pk_mul_lo_u16 v80, v72, v80
    v_pk_mul_lo_u16 v81, v73, v81
    v_pk_mul_lo_u16 v82, v74, v82
    v_mfma_f32_32x32x16_bf16 v[96:111], v[44:47], v[28:31], v[96:111]
    v_pk_mul_lo_u16 v83, v75, v83
    v_pk_mul_lo_u16 v84, v76, v84
    v_pk_mul_lo_u16 v85, v77, v85
    v_pk_mul_lo_u16 v86, v78, v86
    v_pk_mul_lo_u16 v87, v79, v87
    v_pk_mul_lo_u16 v88, v72, v88
    v_pk_mul_lo_u16 v89, v73, v89
    v_pk_mul_lo_u16 v90, v74, v90
    v_pk_mul_lo_u16 v91, v75, v91
    v_pk_mul_lo_u16 v92, v76, v92
    v_pk_mul_lo_u16 v93, v77, v93
    v_pk_mul_lo_u16 v94, v78, v94
    v_pk_mul_lo_u16 v95, v79, v95
    v_mfma_f32_32x32x16_bf16 v[160:175], v[80:83], v[64:67], v[160:175]
    ds_read_b128 v[32:35], v3 offset:512
    ds_read_b128 v[36:39], v7
    ds_read_b128 v[40:43], v7 offset:16
    ds_read_b64 v[12:13], v4 offset:2496
    ds_read_b64 v[14:15], v4 offset:2608
    ds_read_b64 v[16:17], v4 offset:2720
    ds_read_b64 v[18:19], v4 offset:2832
    ds_read_b128 v[20:23], v1 offset:24576
    ds_read_b128 v[24:27], v1 offset:0
    ds_read_b128 v[28:31], v1 offset:1024
    v_mul_f32 v96, v96, v112
    v_mul_f32 v97, v97, v113
    v_mul_f32 v98, v98, v114
    v_mul_f32 v99, v99, v115
    v_mul_f32 v100, v100, v116
    v_mfma_f32_32x32x16_bf16 v[160:175], v[84:87], v[68:71], v[160:175]
    v_mul_f32 v101, v101, v117
    v_mul_f32 v102, v102, v118
    v_mul_f32 v103, v103, v119
    v_mul_f32 v104, v104, v120
    v_mul_f32 v105, v105, v121
    v_mul_f32 v106, v106, v122
    v_mul_f32 v107, v107, v123
    v_mfma_f32_32x32x16_bf16 v[192:207], v[88:91], v[64:67], v[192:207]
    v_mul_f32 v108, v108, v124
    v_mul_f32 v109, v109, v125
    v_mul_f32 v110, v110, v126
    v_mul_f32 v111, v111, v127
    ds_read_b64 v[112:113], v0 offset:2096
    ds_read_b64 v[114:115], v0 offset:2208
    ds_read_b64 v[116:117], v0 offset:2320
    ds_read_b64 v[118:119], v0 offset:2432
    v_cvt_pk_bf16_f32 v96, v96, v97
    v_mfma_f32_32x32x16_bf16 v[192:207], v[92:95], v[68:71], v[192:207]
    v_cvt_pk_bf16_f32 v97, v98, v99
    v_cvt_pk_bf16_f32 v98, v100, v101
    v_cvt_pk_bf16_f32 v99, v102, v103
    v_cvt_pk_bf16_f32 v100, v104, v105
    v_cvt_pk_bf16_f32 v101, v106, v107
    v_cvt_pk_bf16_f32 v102, v108, v109
    v_cvt_pk_bf16_f32 v103, v110, v111
    s_waitcnt lgkmcnt(0)
    v_pk_mul_lo_u16 v112, v72, v112
    v_pk_mul_lo_u16 v113, v73, v113
    v_pk_mul_lo_u16 v114, v74, v114
    v_pk_mul_lo_u16 v115, v75, v115
    v_pk_mul_lo_u16 v116, v76, v116
    v_pk_mul_lo_u16 v117, v77, v117
    v_pk_mul_lo_u16 v118, v78, v118
    v_pk_mul_lo_u16 v119, v79, v119
    v_mfma_f32_32x32x16_bf16 v[176:191], v[80:83], v[96:99], v[176:191]
    v_mul_f32 v36, v32, v36
    v_mul_f32 v37, v32, v37
    v_mul_f32 v38, v32, v38
    v_mul_f32 v39, v32, v39
    v_mul_f32 v40, v32, v40
    v_mul_f32 v41, v32, v41
    v_mfma_f32_32x32x16_bf16 v[176:191], v[84:87], v[100:103], v[176:191]
    v_mul_f32 v42, v32, v42
    v_mul_f32 v43, v32, v43
    v_cvt_pk_bf16_f32 v36, 0, v36
    v_cvt_pk_bf16_f32 v37, 0, v37
    v_cvt_pk_bf16_f32 v38, 0, v38
    v_cvt_pk_bf16_f32 v39, 0, v39
    v_cvt_pk_bf16_f32 v40, 0, v40
    v_mfma_f32_32x32x16_bf16 v[208:223], v[88:91], v[96:99], v[208:223]
    v_cvt_pk_bf16_f32 v41, 0, v41
    v_cvt_pk_bf16_f32 v42, 0, v42
    v_cvt_pk_bf16_f32 v43, 0, v43
    v_mul_f32 v36, s61, v36
    v_mul_f32 v37, s61, v37
    v_mul_f32 v38, s61, v38
    v_mfma_f32_32x32x16_bf16 v[208:223], v[92:95], v[100:103], v[208:223]
    v_mul_f32 v39, s61, v39
    v_mul_f32 v40, s61, v40
    v_mul_f32 v41, s61, v41
    v_mul_f32 v42, s61, v42
    v_mul_f32 v43, s61, v43
    v_sin_f32 v36, v36
    v_sin_f32 v37, v37
    v_mfma_f32_32x32x16_bf16 v[224:239], v[112:115], v[64:67], v[224:239]
    v_sin_f32 v38, v38
    v_sin_f32 v39, v39
    v_sin_f32 v40, v40
    v_sin_f32 v41, v41
    v_sin_f32 v42, v42
    v_sin_f32 v43, v43
    v_mfma_f32_32x32x16_bf16 v[240:255], v[112:115], v[96:99], v[240:255]
    v_mul_f32 v36, v36, v33
    v_mul_f32 v37, v37, v33
    v_mul_f32 v38, v38, v33
    v_mul_f32 v39, v39, v33
    v_mul_f32 v40, v40, v33
    v_mul_f32 v41, v41, v33
    v_mul_f32 v42, v42, v33
    v_mfma_f32_32x32x16_bf16 v[224:239], v[116:119], v[68:71], v[224:239]
    v_mul_f32 v43, v43, v33
    v_cvt_pk_bf16_f32 v8, v36, v37
    v_cvt_pk_bf16_f32 v9, v38, v39
    v_cvt_pk_bf16_f32 v10, v40, v41
    v_cvt_pk_bf16_f32 v11, v42, v43
    v_pk_lshlrev_b16 v12, v6, v12
    v_mfma_f32_32x32x16_bf16 v[240:255], v[116:119], v[100:103], v[240:255]
    v_pk_lshlrev_b16 v13, v6, v13
    v_pk_lshlrev_b16 v14, v6, v14
    v_pk_lshlrev_b16 v15, v6, v15
    v_pk_lshlrev_b16 v16, v6, v16
    v_pk_lshlrev_b16 v17, v6, v17
    v_pk_lshlrev_b16 v18, v6, v18
    v_pk_lshlrev_b16 v19, v6, v19
    v_add_u32 v3, 512, v3
    v_add_u32 v4, 448, v4
    v_add_u32 v0, 448, v0
    v_add_u32 v5, 512, v5
    s_waitcnt lgkmcnt(0)
    s_add_u32 s49, s49, 1
    s_sub_u32 s27, s48, s49
    s_cmp_ge_u32 s26, 4
    s_addc_u32 s27, s27, 0
    s_setprio 0
    s_cmp_le_u32 s27, 1
    s_cbranch_scc1 M_rp20
    s_setprio 1
    s_cmp_le_u32 s27, 2
    s_cbranch_scc1 M_rp20
    s_setprio 2
    s_cmp_le_u32 s27, 3
    s_cbranch_scc1 M_rp20
    s_setprio 3
M_rp20:
    s_cmp_lt_u32 s49, s48
    s_cbranch_scc0 M_wend
    s_waitcnt vmcnt(12)
    ds_read_b32 v47, v3 offset:524
    v_mfma_f32_32x32x16_bf16 v[80:95], v[8:11], v[20:23], 0
    ds_read_b128 v[20:23], v1 offset:2048
    s_add_u32 s77, s49, 1
    s_cmp_lt_u32 s77, s48
    s_cselect_b32 s77, 0, 0x40000000
    v_mfma_f32_32x32x16_bf16 v[64:79], v[48:51], v[24:27], 0
    ds_read_b128 v[24:27], v1 offset:3072
    v_mfma_f32_32x32x16_bf16 v[64:79], v[52:55], v[28:31], v[64:79]
    ds_read_b128 v[28:31], v1 offset:25600
    v_bfe_u32 v46, v1, 9, 1
    s_waitcnt lgkmcnt(3)
    v_lshrrev_b32 v47, 2, v47
    v_lshl_add_u32 v47, v46, 6, v47
    buffer_load_dwordx4 v[32:35], v47, s[72:75], s77 offen offset:0
    buffer_load_dwordx4 v[36:39], v47, s[72:75], s77 offen offset:16
    buffer_load_dwordx4 v[40:43], v47, s[72:75], s77 offen offset:32
    buffer_load_dwordx4 v[44:47], v47, s[72:75], s77 offen offset:48
    s_waitcnt lgkmcnt(2)
    v_mfma_f32_32x32x16_bf16 v[64:79], v[56:59], v[20:23], v[64:79]
    ds_read_b128 v[20:23], v1 offset:4096
    s_waitcnt lgkmcnt(2)
    v_mfma_f32_32x32x16_bf16 v[64:79], v[60:63], v[24:27], v[64:79]
    ds_read_b128 v[24:27], v1 offset:5120
    s_waitcnt lgkmcnt(2)
    v_mfma_f32_32x32x16_bf16 v[112:127], v[8:11], v[28:31], 0
    ds_read_b128 v[28:31], v1 offset:6144
    s_waitcnt lgkmcnt(2)
    v_mfma_f32_32x32x16_bf16 v[96:111], v[48:51], v[20:23], 0
    ds_read_b128 v[20:23], v1 offset:7168
    s_nop 4
    v_mul_f32 v64, v64, v80
    v_mul_f32 v65, v65, v81
    v_mul_f32 v66, v66, v82
    v_mul_f32 v67, v67, v83
    v_mul_f32 v68, v68, v84
    v_mul_f32 v69, v69, v85
    s_waitcnt lgkmcnt(2)
    v_mfma_f32_32x32x16_bf16 v[96:111], v[52:55], v[24:27], v[96:111]
    ds_read_b128 v[24:27], v1 offset:26624
    v_mul_f32 v70, v70, v86
    v_mul_f32 v71, v71, v87
    v_mul_f32 v72, v72, v88
    v_mul_f32 v73, v73, v89
    v_mul_f32 v74, v74, v90
    v_mul_f32 v75, v75, v91
    v_mul_f32 v76, v76, v92
    s_waitcnt lgkmcnt(2)
    v_mfma_f32_32x32x16_bf16 v[96:111], v[56:59], v[28:31], v[96:111]
    ds_read_b128 v[28:31], v1 offset:8192
    v_mul_f32 v77, v77, v93
    v_mul_f32 v78, v78, v94
    v_mul_f32 v79, v79, v95
    v_cvt_pk_bf16_f32 v64, v64, v65
    v_cvt_pk_bf16_f32 v65, v66, v67
    v_cvt_pk_bf16_f32 v66, v68, v69
    s_waitcnt lgkmcnt(2)
    v_mfma_f32_32x32x16_bf16 v[96:111], v[60:63], v[20:23], v[96:111]
    ds_read_b128 v[20:23], v1 offset:9216
    v_cvt_pk_bf16_f32 v67, v70, v71
    v_cvt_pk_bf16_f32 v68, v72, v73
    v_cvt_pk_bf16_f32 v69, v74, v75
    v_cvt_pk_bf16_f32 v70, v76, v77
    v_cvt_pk_bf16_f32 v71, v78, v79
    v_mfma_f32_32x32x16_bf16 v[128:143], v[12:15], v[64:67], v[128:143]
    s_nop 0
    v_mfma_f32_32x32x16_bf16 v[128:143], v[16:19], v[68:71], v[128:143]
    s_waitcnt lgkmcnt(2)
    v_mfma_f32_32x32x16_bf16 v[80:95], v[8:11], v[24:27], 0
    ds_read_b128 v[24:27], v1 offset:10240
    s_waitcnt lgkmcnt(2)
    v_mfma_f32_32x32x16_bf16 v[64:79], v[48:51], v[28:31], 0
    ds_read_b128 v[28:31], v1 offset:11264
    v_mul_f32 v96, v96, v112
    v_mul_f32 v97, v97, v113
    v_mul_f32 v98, v98, v114
    v_mul_f32 v99, v99, v115
    v_mul_f32 v100, v100, v116
    v_mul_f32 v101, v101, v117
    s_waitcnt lgkmcnt(2)
    v_mfma_f32_32x32x16_bf16 v[64:79], v[52:55], v[20:23], v[64:79]
    ds_read_b128 v[20:23], v1 offset:27648
    v_mul_f32 v102, v102, v118
    v_mul_f32 v103, v103, v119
    v_mul_f32 v104, v104, v120
    v_mul_f32 v105, v105, v121
    v_mul_f32 v106, v106, v122
    v_mul_f32 v107, v107, v123
    v_mul_f32 v108, v108, v124
    s_waitcnt lgkmcnt(2)
    v_mfma_f32_32x32x16_bf16 v[64:79], v[56:59], v[24:27], v[64:79]
    ds_read_b128 v[24:27], v1 offset:12288
    v_mul_f32 v109, v109, v125
    v_mul_f32 v110, v110, v126
    v_mul_f32 v111, v111, v127
    v_cvt_pk_bf16_f32 v96, v96, v97
    v_cvt_pk_bf16_f32 v97, v98, v99
    v_cvt_pk_bf16_f32 v98, v100, v101
    s_waitcnt lgkmcnt(2)
    v_mfma_f32_32x32x16_bf16 v[64:79], v[60:63], v[28:31], v[64:79]
    ds_read_b128 v[28:31], v1 offset:13312
    v_cvt_pk_bf16_f32 v99, v102, v103
    v_cvt_pk_bf16_f32 v100, v104, v105
    v_cvt_pk_bf16_f32 v101, v106, v107
    v_cvt_pk_bf16_f32 v102, v108, v109
    v_cvt_pk_bf16_f32 v103, v110, v111
    v_mfma_f32_32x32x16_bf16 v[144:159], v[12:15], v[96:99], v[144:159]
    s_nop 0
    v_mfma_f32_32x32x16_bf16 v[144:159], v[16:19], v[100:103], v[144:159]
    s_waitcnt lgkmcnt(2)
    v_mfma_f32_32x32x16_bf16 v[112:127], v[8:11], v[20:23], 0
    ds_read_b128 v[20:23], v1 offset:14336
    s_waitcnt lgkmcnt(2)
    v_mfma_f32_32x32x16_bf16 v[96:111], v[48:51], v[24:27], 0
    ds_read_b128 v[24:27], v1 offset:15360
    v_mul_f32 v64, v64, v80
    v_mul_f32 v65, v65, v81
    v_mul_f32 v66, v66, v82
    v_mul_f32 v67, v67, v83
    v_mul_f32 v68, v68, v84
    v_mul_f32 v69, v69, v85
    v_mul_f32 v70, v70, v86
    v_mul_f32 v71, v71, v87
    v_mul_f32 v72, v72, v88
    v_mul_f32 v73, v73, v89
    v_mul_f32 v74, v74, v90
    v_mul_f32 v75, v75, v91
    v_mul_f32 v76, v76, v92
    v_mul_f32 v77, v77, v93
    v_mul_f32 v78, v78, v94
    v_mul_f32 v79, v79, v95
    s_waitcnt vmcnt(4)
    ds_read_u16_d16_hi v80, v2 offset:0
    ds_read_u16_d16_hi v81, v2 offset:256
    ds_read_u16_d16_hi v82, v2 offset:512
    ds_read_u16_d16_hi v83, v2 offset:768
    ds_read_u16_d16_hi v84, v2 offset:3072
    ds_read_u16_d16_hi v85, v2 offset:3328
    ds_read_u16_d16_hi v86, v2 offset:3584
    ds_read_u16_d16_hi v87, v2 offset:3840
    ds_read_u16_d16_hi v88, v2 offset:6144
    ds_read_u16_d16_hi v89, v2 offset:6400
    ds_read_u16_d16_hi v90, v2 offset:6656
    ds_read_u16_d16_hi v91, v2 offset:6912
    ds_read_u16_d16_hi v92, v2 offset:9216
    ds_read_u16_d16_hi v93, v2 offset:9472
    ds_read_u16_d16_hi v94, v2 offset:9728
    ds_read_u16_d16_hi v95, v2 offset:9984
    s_waitcnt lgkmcnt(8)
    v_mul_f32 v80, v80, v64
    v_mul_f32 v81, v81, v65
    v_mul_f32 v82, v82, v66
    v_mul_f32 v83, v83, v67
    v_mul_f32 v84, v84, v68
    v_mul_f32 v85, v85, v69
    v_mfma_f32_32x32x16_bf16 v[96:111], v[52:55], v[28:31], v[96:111]
WUP_3315:
    s_cbranch_execz WUR_1
    ds_read_b128 v[28:31], v1 offset:28672
    v_mul_f32 v86, v86, v70
    v_mul_f32 v87, v87, v71
    v_cvt_pk_bf16_f32 v80, v80, v81
    v_cvt_pk_bf16_f32 v81, v82, v83
    v_cvt_pk_bf16_f32 v82, v84, v85
    v_cvt_pk_bf16_f32 v83, v86, v87
    s_waitcnt lgkmcnt(1)
    v_mul_f32 v88, v88, v72
    v_mul_f32 v89, v89, v73
    v_mfma_f32_32x32x16_bf16 v[160:175], v[12:15], v[80:83], v[160:175]
    ds_read_u16_d16_hi v80, v2 offset:1024
    ds_read_u16_d16_hi v81, v2 offset:1280
    ds_read_u16_d16_hi v82, v2 offset:1536
    ds_read_u16_d16_hi v83, v2 offset:1792
    ds_read_u16_d16_hi v84, v2 offset:4096
    ds_read_u16_d16_hi v85, v2 offset:4352
    ds_read_u16_d16_hi v86, v2 offset:4608
    ds_read_u16_d16_hi v87, v2 offset:4864
    v_mul_f32 v90, v90, v74
    v_mul_f32 v91, v91, v75
    v_mul_f32 v92, v92, v76
    v_mul_f32 v93, v93, v77
    v_mul_f32 v94, v94, v78
    v_mul_f32 v95, v95, v79
    v_cvt_pk_bf16_f32 v88, v88, v89
    v_cvt_pk_bf16_f32 v89, v90, v91
    v_cvt_pk_bf16_f32 v90, v92, v93
    v_cvt_pk_bf16_f32 v91, v94, v95
    s_waitcnt lgkmcnt(0)
    v_mul_f32 v80, v80, v64
    v_mul_f32 v81, v81, v65
    v_mfma_f32_32x32x16_bf16 v[160:175], v[16:19], v[88:91], v[160:175]
    ds_read_u16_d16_hi v88, v2 offset:7168
    ds_read_u16_d16_hi v89, v2 offset:7424
    ds_read_u16_d16_hi v90, v2 offset:7680
    ds_read_u16_d16_hi v91, v2 offset:7936
    ds_read_u16_d16_hi v92, v2 offset:10240
    ds_read_u16_d16_hi v93, v2 offset:10496
    ds_read_u16_d16_hi v94, v2 offset:10752
    ds_read_u16_d16_hi v95, v2 offset:11008
    v_mul_f32 v82, v82, v66
    v_mfma_f32_32x32x16_bf16 v[96:111], v[56:59], v[20:23], v[96:111]
    ds_read_b128 v[20:23], v1 offset:16384
    v_mul_f32 v83, v83, v67
    v_mul_f32 v84, v84, v68
    v_mul_f32 v85, v85, v69
    v_mul_f32 v86, v86, v70
    v_mul_f32 v87, v87, v71
    v_cvt_pk_bf16_f32 v80, v80, v81
    v_cvt_pk_bf16_f32 v81, v82, v83
    v_cvt_pk_bf16_f32 v82, v84, v85
    v_cvt_pk_bf16_f32 v83, v86, v87
    s_waitcnt lgkmcnt(1)
    v_mul_f32 v88, v88, v72
    v_mul_f32 v89, v89, v73
    v_mfma_f32_32x32x16_bf16 v[192:207], v[12:15], v[80:83], v[192:207]
    ds_read_u16_d16_hi v80, v2 offset:2048
    ds_read_u16_d16_hi v81, v2 offset:2304
    ds_read_u16_d16_hi v82, v2 offset:2560
    ds_read_u16_d16_hi v83, v2 offset:2816
    ds_read_u16_d16_hi v84, v2 offset:5120
    ds_read_u16_d16_hi v85, v2 offset:5376
    ds_read_u16_d16_hi v86, v2 offset:5632
    ds_read_u16_d16_hi v87, v2 offset:5888
    v_mul_f32 v90, v90, v74
    v_mul_f32 v91, v91, v75
    v_mul_f32 v92, v92, v76
    v_mul_f32 v93, v93, v77
    v_mul_f32 v94, v94, v78
    v_mul_f32 v95, v95, v79
    v_cvt_pk_bf16_f32 v88, v88, v89
    v_cvt_pk_bf16_f32 v89, v90, v91
    v_cvt_pk_bf16_f32 v90, v92, v93
    v_cvt_pk_bf16_f32 v91, v94, v95
    s_waitcnt lgkmcnt(0)
    v_mul_f32 v80, v80, v64
    v_mul_f32 v81, v81, v65
    v_mfma_f32_32x32x16_bf16 v[96:111], v[60:63], v[24:27], v[96:111]
    ds_read_b128 v[24:27], v1 offset:17408
    v_mfma_f32_32x32x16_bf16 v[192:207], v[16:19], v[88:91], v[192:207]
    ds_read_u16_d16_hi v88, v2 offset:8192
    ds_read_u16_d16_hi v89, v2 offset:8448
    ds_read_u16_d16_hi v90, v2 offset:8704
    ds_read_u16_d16_hi v91, v2 offset:8960
    ds_read_u16_d16_hi v92, v2 offset:11264
    ds_read_u16_d16_hi v93, v2 offset:11520
    ds_read_u16_d16_hi v94, v2 offset:11776
    ds_read_u16_d16_hi v95, v2 offset:12032
    v_mul_f32 v82, v82, v66
    v_mul_f32 v83, v83, v67
    v_mul_f32 v84, v84, v68
    v_mul_f32 v85, v85, v69
    v_mul_f32 v86, v86, v70
    v_mul_f32 v87, v87, v71
    v_cvt_pk_bf16_f32 v80, v80, v81
    v_cvt_pk_bf16_f32 v81, v82, v83
    v_cvt_pk_bf16_f32 v82, v84, v85
    v_cvt_pk_bf16_f32 v83, v86, v87
    s_waitcnt lgkmcnt(0)
    v_mul_f32 v88, v88, v72
    v_mul_f32 v89, v89, v73
    v_mfma_f32_32x32x16_bf16 v[224:239], v[12:15], v[80:83], v[224:239]
    v_mul_f32 v90, v90, v74
    v_mul_f32 v91, v91, v75
    v_mul_f32 v92, v92, v76
    v_mul_f32 v93, v93, v77
    v_mul_f32 v94, v94, v78
    v_mul_f32 v95, v95, v79
    v_cvt_pk_bf16_f32 v88, v88, v89
    v_cvt_pk_bf16_f32 v89, v90, v91
    v_cvt_pk_bf16_f32 v90, v92, v93
    v_cvt_pk_bf16_f32 v91, v94, v95
    s_nop 1
    v_mfma_f32_32x32x16_bf16 v[224:239], v[16:19], v[88:91], v[224:239]
    v_mfma_f32_32x32x16_bf16 v[80:95], v[8:11], v[28:31], 0
    ds_read_b128 v[28:31], v1 offset:18432
    v_mfma_f32_32x32x16_bf16 v[64:79], v[48:51], v[20:23], 0
    ds_read_b128 v[20:23], v1 offset:19456
    v_mul_f32 v96, v96, v112
    v_mul_f32 v97, v97, v113
    v_mul_f32 v98, v98, v114
    v_mul_f32 v99, v99, v115
    v_mul_f32 v100, v100, v116
    v_mul_f32 v101, v101, v117
    v_mul_f32 v102, v102, v118
    v_mul_f32 v103, v103, v119
    v_mul_f32 v104, v104, v120
    v_mul_f32 v105, v105, v121
    v_mul_f32 v106, v106, v122
    v_mul_f32 v107, v107, v123
    v_mul_f32 v108, v108, v124
    v_mul_f32 v109, v109, v125
    v_mul_f32 v110, v110, v126
    v_mul_f32 v111, v111, v127
    ds_read_u16_d16_hi v112, v2 offset:2
    ds_read_u16_d16_hi v113, v2 offset:258
    ds_read_u16_d16_hi v114, v2 offset:514
    ds_read_u16_d16_hi v115, v2 offset:770
    ds_read_u16_d16_hi v116, v2 offset:3074
    ds_read_u16_d16_hi v117, v2 offset:3330
    ds_read_u16_d16_hi v118, v2 offset:3586
    ds_read_u16_d16_hi v119, v2 offset:3842
    ds_read_u16_d16_hi v120, v2 offset:6146
    ds_read_u16_d16_hi v121, v2 offset:6402
    ds_read_u16_d16_hi v122, v2 offset:6658
    ds_read_u16_d16_hi v123, v2 offset:6914
    ds_read_u16_d16_hi v124, v2 offset:9218
    ds_read_u16_d16_hi v125, v2 offset:9474
    ds_read_u16_d16_hi v126, v2 offset:9730
    ds_read_u16_d16_hi v127, v2 offset:9986
    s_waitcnt lgkmcnt(8)
    v_mul_f32 v112, v112, v96
    v_mul_f32 v113, v113, v97
    v_mul_f32 v114, v114, v98
    v_mul_f32 v115, v115, v99
    v_mul_f32 v116, v116, v100
    v_mul_f32 v117, v117, v101
    v_mul_f32 v118, v118, v102
    v_mfma_f32_32x32x16_bf16 v[64:79], v[52:55], v[24:27], v[64:79]
    ds_read_b128 v[24:27], v1 offset:29696
    v_mul_f32 v119, v119, v103
    v_cvt_pk_bf16_f32 v112, v112, v113
    v_cvt_pk_bf16_f32 v113, v114, v115
    v_cvt_pk_bf16_f32 v114, v116, v117
    v_cvt_pk_bf16_f32 v115, v118, v119
    s_waitcnt lgkmcnt(1)
    v_mul_f32 v120, v120, v104
    v_mul_f32 v121, v121, v105
    v_mfma_f32_32x32x16_bf16 v[176:191], v[12:15], v[112:115], v[176:191]
    ds_read_u16_d16_hi v112, v2 offset:1026
    ds_read_u16_d16_hi v113, v2 offset:1282
    ds_read_u16_d16_hi v114, v2 offset:1538
    ds_read_u16_d16_hi v115, v2 offset:1794
    ds_read_u16_d16_hi v116, v2 offset:4098
    ds_read_u16_d16_hi v117, v2 offset:4354
    ds_read_u16_d16_hi v118, v2 offset:4610
    ds_read_u16_d16_hi v119, v2 offset:4866
    v_mul_f32 v122, v122, v106
    v_mul_f32 v123, v123, v107
    v_mul_f32 v124, v124, v108
    v_mul_f32 v125, v125, v109
    v_mul_f32 v126, v126, v110
    v_mul_f32 v127, v127, v111
    v_cvt_pk_bf16_f32 v120, v120, v121
    v_cvt_pk_bf16_f32 v121, v122, v123
    v_cvt_pk_bf16_f32 v122, v124, v125
    v_cvt_pk_bf16_f32 v123, v126, v127
    s_waitcnt lgkmcnt(0)
    v_mul_f32 v112, v112, v96
    v_mul_f32 v113, v113, v97
    v_mfma_f32_32x32x16_bf16 v[176:191], v[16:19], v[120:123], v[176:191]
    ds_read_u16_d16_hi v120, v2 offset:7170
    ds_read_u16_d16_hi v121, v2 offset:7426
    ds_read_u16_d16_hi v122, v2 offset:7682
    ds_read_u16_d16_hi v123, v2 offset:7938
    ds_read_u16_d16_hi v124, v2 offset:10242
    ds_read_u16_d16_hi v125, v2 offset:10498
    ds_read_u16_d16_hi v126, v2 offset:10754
    ds_read_u16_d16_hi v127, v2 offset:11010
    v_mul_f32 v114, v114, v98
    v_mul_f32 v115, v115, v99
    v_mfma_f32_32x32x16_bf16 v[64:79], v[56:59], v[28:31], v[64:79]
    ds_read_b128 v[28:31], v1 offset:20480
    v_mul_f32 v116, v116, v100
    v_mul_f32 v117, v117, v101
    v_mul_f32 v118, v118, v102
    v_mul_f32 v119, v119, v103
    v_cvt_pk_bf16_f32 v112, v112, v113
    v_cvt_pk_bf16_f32 v113, v114, v115
    v_cvt_pk_bf16_f32 v114, v116, v117
    v_cvt_pk_bf16_f32 v115, v118, v119
    s_waitcnt lgkmcnt(1)
    v_mul_f32 v120, v120, v104
    v_mul_f32 v121, v121, v105
    v_mfma_f32_32x32x16_bf16 v[208:223], v[12:15], v[112:115], v[208:223]
    ds_read_u16_d16_hi v112, v2 offset:2050
    ds_read_u16_d16_hi v113, v2 offset:2306
    ds_read_u16_d16_hi v114, v2 offset:2562
    ds_read_u16_d16_hi v115, v2 offset:2818
    ds_read_u16_d16_hi v116, v2 offset:5122
    ds_read_u16_d16_hi v117, v2 offset:5378
    ds_read_u16_d16_hi v118, v2 offset:5634
    ds_read_u16_d16_hi v119, v2 offset:5890
    v_mul_f32 v122, v122, v106
    v_mul_f32 v123, v123, v107
    v_mul_f32 v124, v124, v108
    v_mul_f32 v125, v125, v109
    v_mul_f32 v126, v126, v110
    v_mul_f32 v127, v127, v111
    v_cvt_pk_bf16_f32 v120, v120, v121
    v_cvt_pk_bf16_f32 v121, v122, v123
    v_cvt_pk_bf16_f32 v122, v124, v125
    v_cvt_pk_bf16_f32 v123, v126, v127
    s_waitcnt lgkmcnt(0)
    v_mul_f32 v112, v112, v96
    v_mul_f32 v113, v113, v97
    v_mfma_f32_32x32x16_bf16 v[208:223], v[16:19], v[120:123], v[208:223]
    v_mfma_f32_32x32x16_bf16 v[64:79], v[60:63], v[20:23], v[64:79]
    ds_read_b128 v[20:23], v1 offset:21504
    ds_read_u16_d16_hi v120, v2 offset:8194
    ds_read_u16_d16_hi v121, v2 offset:8450
    ds_read_u16_d16_hi v122, v2 offset:8706
    ds_read_u16_d16_hi v123, v2 offset:8962
    ds_read_u16_d16_hi v124, v2 offset:11266
    ds_read_u16_d16_hi v125, v2 offset:11522
    ds_read_u16_d16_hi v126, v2 offset:11778
    ds_read_u16_d16_hi v127, v2 offset:12034
    v_mul_f32 v114, v114, v98
    v_mul_f32 v115, v115, v99
    v_mul_f32 v116, v116, v100
    v_mul_f32 v117, v117, v101
    v_mul_f32 v118, v118, v102
    v_mul_f32 v119, v119, v103
    v_cvt_pk_bf16_f32 v112, v112, v113
    v_cvt_pk_bf16_f32 v113, v114, v115
    v_cvt_pk_bf16_f32 v114, v116, v117
    v_cvt_pk_bf16_f32 v115, v118, v119
    s_waitcnt lgkmcnt(0)
    v_mul_f32 v120, v120, v104
    v_mul_f32 v121, v121, v105
    v_mfma_f32_32x32x16_bf16 v[240:255], v[12:15], v[112:115], v[240:255]
    ds_read_b32 v112, v5 offset:524
    ds_read_b32 v113, v5 offset:652
    ds_read_b32 v114, v5 offset:780
    ds_read_b32 v115, v5 offset:908
    v_mul_f32 v122, v122, v106
    v_mul_f32 v123, v123, v107
    v_mul_f32 v124, v124, v108
    v_mul_f32 v125, v125, v109
    v_mul_f32 v126, v126, v110
    v_mul_f32 v127, v127, v111
    v_cvt_pk_bf16_f32 v120, v120, v121
    v_cvt_pk_bf16_f32 v121, v122, v123
    v_cvt_pk_bf16_f32 v122, v124, v125
    v_cvt_pk_bf16_f32 v123, v126, v127
    s_nop 1
    v_mfma_f32_32x32x16_bf16 v[240:255], v[16:19], v[120:123], v[240:255]
    s_cmp_lg_u32 s77, 0
    s_cbranch_scc1 M_nv21
    s_add_u32 m0, s51, 0
    s_waitcnt lgkmcnt(3)
    v_and_or_b32 v112, v1, s63, v112
    buffer_load_dwordx4 v112, s[28:31], s64 offen offset:0 lds
    buffer_load_dwordx4 v112, s[28:31], s65 offen offset:1024 lds
    buffer_load_dwordx4 v112, s[28:31], s66 offen offset:2048 lds
    s_add_u32 m0, s51, 3072
    s_waitcnt lgkmcnt(2)
    v_and_or_b32 v113, v1, s63, v113
    buffer_load_dwordx4 v113, s[28:31], s64 offen offset:0 lds
    buffer_load_dwordx4 v113, s[28:31], s65 offen offset:1024 lds
    buffer_load_dwordx4 v113, s[28:31], s66 offen offset:2048 lds
    s_add_u32 m0, s51, 6144
    s_waitcnt lgkmcnt(1)
    v_and_or_b32 v114, v1, s63, v114
    buffer_load_dwordx4 v114, s[28:31], s64 offen offset:0 lds
    buffer_load_dwordx4 v114, s[28:31], s65 offen offset:1024 lds
    buffer_load_dwordx4 v114, s[28:31], s66 offen offset:2048 lds
    s_add_u32 m0, s51, 9216
    s_waitcnt lgkmcnt(0)
    v_and_or_b32 v115, v1, s63, v115
    buffer_load_dwordx4 v115, s[28:31], s64 offen offset:0 lds
    buffer_load_dwordx4 v115, s[28:31], s65 offen offset:1024 lds
    buffer_load_dwordx4 v115, s[28:31], s66 offen offset:2048 lds
M_nv21:
    s_waitcnt lgkmcnt(0)
    v_mfma_f32_32x32x16_bf16 v[112:127], v[8:11], v[24:27], 0
    ds_read_b128 v[24:27], v1 offset:22528
    v_mfma_f32_32x32x16_bf16 v[96:111], v[48:51], v[28:31], 0
    ds_read_b128 v[28:31], v1 offset:23552
    v_mul_f32 v64, v64, v80
    v_mul_f32 v65, v65, v81
    v_mul_f32 v66, v66, v82
    v_mul_f32 v67, v67, v83
    v_mul_f32 v68, v68, v84
    v_mul_f32 v69, v69, v85
    v_mul_f32 v70, v70, v86
    v_mul_f32 v71, v71, v87
    v_mul_f32 v72, v72, v88
    v_mul_f32 v73, v73, v89
    v_mul_f32 v74, v74, v90
    v_mul_f32 v75, v75, v91
    v_mfma_f32_32x32x16_bf16 v[96:111], v[52:55], v[20:23], v[96:111]
    v_mul_f32 v76, v76, v92
    v_mul_f32 v77, v77, v93
    v_mul_f32 v78, v78, v94
    v_mul_f32 v79, v79, v95
    ds_read_b64 v[80:81], v0 offset:2080
    ds_read_b64 v[88:89], v0 offset:2088
    ds_read_b64 v[82:83], v0 offset:2192
    ds_read_b64 v[90:91], v0 offset:2200
    ds_read_b64 v[84:85], v0 offset:2304
    ds_read_b64 v[92:93], v0 offset:2312
    ds_read_b64 v[86:87], v0 offset:2416
    ds_read_b64 v[94:95], v0 offset:2424
    v_cvt_pk_bf16_f32 v64, v64, v65
    v_cvt_pk_bf16_f32 v65, v66, v67
    v_cvt_pk_bf16_f32 v66, v68, v69
    v_cvt_pk_bf16_f32 v67, v70, v71
    v_cvt_pk_bf16_f32 v68, v72, v73
    v_cvt_pk_bf16_f32 v69, v74, v75
    v_cvt_pk_bf16_f32 v70, v76, v77
    s_waitcnt lgkmcnt(9)
    v_mfma_f32_32x32x16_bf16 v[96:111], v[56:59], v[24:27], v[96:111]
    v_cvt_pk_bf16_f32 v71, v78, v79
    v_pk_lshrrev_b16 v72, 14, v12 op_sel_hi:[0,1]
    v_pk_lshrrev_b16 v73, 14, v13 op_sel_hi:[0,1]
    v_pk_lshrrev_b16 v74, 14, v14 op_sel_hi:[0,1]
    v_pk_lshrrev_b16 v75, 14, v15 op_sel_hi:[0,1]
    v_pk_lshrrev_b16 v76, 14, v16 op_sel_hi:[0,1]
    v_pk_lshrrev_b16 v77, 14, v17 op_sel_hi:[0,1]
    v_pk_lshrrev_b16 v78, 14, v18 op_sel_hi:[0,1]
    v_pk_lshrrev_b16 v79, 14, v19 op_sel_hi:[0,1]
    s_waitcnt lgkmcnt(0)
    v_pk_mul_lo_u16 v80, v72, v80
    v_pk_mul_lo_u16 v81, v73, v81
    v_pk_mul_lo_u16 v82, v74, v82
    v_mfma_f32_32x32x16_bf16 v[96:111], v[60:63], v[28:31], v[96:111]
    v_pk_mul_lo_u16 v83, v75, v83
    v_pk_mul_lo_u16 v84, v76, v84
    v_pk_mul_lo_u16 v85, v77, v85
    v_pk_mul_lo_u16 v86, v78, v86
    v_pk_mul_lo_u16 v87, v79, v87
    v_pk_mul_lo_u16 v88, v72, v88
    v_pk_mul_lo_u16 v89, v73, v89
    v_pk_mul_lo_u16 v90, v74, v90
    v_pk_mul_lo_u16 v91, v75, v91
    v_pk_mul_lo_u16 v92, v76, v92
    v_pk_mul_lo_u16 v93, v77, v93
    v_pk_mul_lo_u16 v94, v78, v94
    v_pk_mul_lo_u16 v95, v79, v95
    v_mfma_f32_32x32x16_bf16 v[160:175], v[80:83], v[64:67], v[160:175]
    ds_read_b128 v[48:51], v3 offset:512
    ds_read_b128 v[52:55], v7
    ds_read_b128 v[56:59], v7 offset:16
    ds_read_b64 v[12:13], v4 offset:2496
    ds_read_b64 v[14:15], v4 offset:2608
    ds_read_b64 v[16:17], v4 offset:2720
    ds_read_b64 v[18:19], v4 offset:2832
    ds_read_b128 v[20:23], v1 offset:24576
    ds_read_b128 v[24:27], v1 offset:0
    ds_read_b128 v[28:31], v1 offset:1024
    v_mul_f32 v96, v96, v112
    v_mul_f32 v97, v97, v113
    v_mul_f32 v98, v98, v114
    v_mul_f32 v99, v99, v115
    v_mul_f32 v100, v100, v116
    v_mfma_f32_32x32x16_bf16 v[160:175], v[84:87], v[68:71], v[160:175]
    v_mul_f32 v101, v101, v117
    v_mul_f32 v102, v102, v118
    v_mul_f32 v103, v103, v119
    v_mul_f32 v104, v104, v120
    v_mul_f32 v105, v105, v121
    v_mul_f32 v106, v106, v122
    v_mul_f32 v107, v107, v123
    v_mfma_f32_32x32x16_bf16 v[192:207], v[88:91], v[64:67], v[192:207]
    v_mul_f32 v108, v108, v124
    v_mul_f32 v109, v109, v125
    v_mul_f32 v110, v110, v126
    v_mul_f32 v111, v111, v127
    ds_read_b64 v[112:113], v0 offset:2096
    ds_read_b64 v[114:115], v0 offset:2208
    ds_read_b64 v[116:117], v0 offset:2320
    ds_read_b64 v[118:119], v0 offset:2432
    v_cvt_pk_bf16_f32 v96, v96, v97
    v_mfma_f32_32x32x16_bf16 v[192:207], v[92:95], v[68:71], v[192:207]
    v_cvt_pk_bf16_f32 v97, v98, v99
    v_cvt_pk_bf16_f32 v98, v100, v101
    v_cvt_pk_bf16_f32 v99, v102, v103
    v_cvt_pk_bf16_f32 v100, v104, v105
    v_cvt_pk_bf16_f32 v101, v106, v107
    v_cvt_pk_bf16_f32 v102, v108, v109
    v_cvt_pk_bf16_f32 v103, v110, v111
    s_waitcnt lgkmcnt(0)
    v_pk_mul_lo_u16 v112, v72, v112
    v_pk_mul_lo_u16 v113, v73, v113
    v_pk_mul_lo_u16 v114, v74, v114
    v_pk_mul_lo_u16 v115, v75, v115
    v_pk_mul_lo_u16 v116, v76, v116
    v_pk_mul_lo_u16 v117, v77, v117
    v_pk_mul_lo_u16 v118, v78, v118
    v_pk_mul_lo_u16 v119, v79, v119
    v_mfma_f32_32x32x16_bf16 v[176:191], v[80:83], v[96:99], v[176:191]
    v_mul_f32 v52, v48, v52
    v_mul_f32 v53, v48, v53
    v_mul_f32 v54, v48, v54
    v_mul_f32 v55, v48, v55
    v_mul_f32 v56, v48, v56
    v_mul_f32 v57, v48, v57
    v_mfma_f32_32x32x16_bf16 v[176:191], v[84:87], v[100:103], v[176:191]
    v_mul_f32 v58, v48, v58
    v_mul_f32 v59, v48, v59
    v_cvt_pk_bf16_f32 v52, 0, v52
    v_cvt_pk_bf16_f32 v53, 0, v53
    v_cvt_pk_bf16_f32 v54, 0, v54
    v_cvt_pk_bf16_f32 v55, 0, v55
    v_cvt_pk_bf16_f32 v56, 0, v56
    v_mfma_f32_32x32x16_bf16 v[208:223], v[88:91], v[96:99], v[208:223]
    v_cvt_pk_bf16_f32 v57, 0, v57
    v_cvt_pk_bf16_f32 v58, 0, v58
    v_cvt_pk_bf16_f32 v59, 0, v59
    v_mul_f32 v52, s61, v52
    v_mul_f32 v53, s61, v53
    v_mul_f32 v54, s61, v54
    v_mfma_f32_32x32x16_bf16 v[208:223], v[92:95], v[100:103], v[208:223]
    v_mul_f32 v55, s61, v55
    v_mul_f32 v56, s61, v56
    v_mul_f32 v57, s61, v57
    v_mul_f32 v58, s61, v58
    v_mul_f32 v59, s61, v59
    v_sin_f32 v52, v52
    v_sin_f32 v53, v53
    v_mfma_f32_32x32x16_bf16 v[224:239], v[112:115], v[64:67], v[224:239]
    v_sin_f32 v54, v54
    v_sin_f32 v55, v55
    v_sin_f32 v56, v56
    v_sin_f32 v57, v57
    v_sin_f32 v58, v58
    v_sin_f32 v59, v59
    v_mfma_f32_32x32x16_bf16 v[240:255], v[112:115], v[96:99], v[240:255]
    v_mul_f32 v52, v52, v49
    v_mul_f32 v53, v53, v49
    v_mul_f32 v54, v54, v49
    v_mul_f32 v55, v55, v49
    v_mul_f32 v56, v56, v49
    v_mul_f32 v57, v57, v49
    v_mul_f32 v58, v58, v49
    v_mfma_f32_32x32x16_bf16 v[224:239], v[116:119], v[68:71], v[224:239]
    v_mul_f32 v59, v59, v49
    v_cvt_pk_bf16_f32 v8, v52, v53
    v_cvt_pk_bf16_f32 v9, v54, v55
    v_cvt_pk_bf16_f32 v10, v56, v57
    v_cvt_pk_bf16_f32 v11, v58, v59
    v_pk_lshlrev_b16 v12, v6, v12
    v_mfma_f32_32x32x16_bf16 v[240:255], v[116:119], v[100:103], v[240:255]
    v_pk_lshlrev_b16 v13, v6, v13
    v_pk_lshlrev_b16 v14, v6, v14
    v_pk_lshlrev_b16 v15, v6, v15
    v_pk_lshlrev_b16 v16, v6, v16
    v_pk_lshlrev_b16 v17, v6, v17
    v_pk_lshlrev_b16 v18, v6, v18
    v_pk_lshlrev_b16 v19, v6, v19
    v_add_u32 v3, 512, v3
    v_add_u32 v4, 448, v4
    v_add_u32 v0, 448, v0
    v_add_u32 v5, 512, v5
    s_waitcnt lgkmcnt(0)
    s_add_u32 s49, s49, 1
    s_sub_u32 s27, s48, s49
    s_cmp_ge_u32 s26, 4
    s_addc_u32 s27, s27, 0
    s_setprio 0
    s_cmp_le_u32 s27, 1
    s_cbranch_scc1 M_rp22
    s_setprio 1
    s_cmp_le_u32 s27, 2
    s_cbranch_scc1 M_rp22
    s_setprio 2
    s_cmp_le_u32 s27, 3
    s_cbranch_scc1 M_rp22
    s_setprio 3
M_rp22:
    s_cmp_lt_u32 s49, s48
    s_cbranch_scc1 M_batch
M_wend:
    s_cmp_eq_u32 s76, 0
    s_cbranch_scc1 M_slow
M_epi:
WUP_3819:
    s_cbranch_execz WUR_1
    v_lshrrev_b32 v8, 4, v1
    v_lshrrev_b32 v10, 5, v8
    v_and_b32 v11, 31, v8
    v_lshlrev_b32 v12, 11, v10
    v_lshl_add_u32 v12, v11, 2, v12
    s_waitcnt vmcnt(0)
    v_cvt_pk_bf16_f32 v64, v128, v144
    v_cvt_pk_bf16_f32 v65, v129, v145
    v_cvt_pk_bf16_f32 v66, v130, v146
    v_cvt_pk_bf16_f32 v67, v131, v147
    v_cvt_pk_bf16_f32 v68, v132, v148
    v_cvt_pk_bf16_f32 v69, v133, v149
    v_cvt_pk_bf16_f32 v70, v134, v150
    v_cvt_pk_bf16_f32 v71, v135, v151
    v_cvt_pk_bf16_f32 v72, v136, v152
    v_cvt_pk_bf16_f32 v73, v137, v153
    v_cvt_pk_bf16_f32 v74, v138, v154
    v_cvt_pk_bf16_f32 v75, v139, v155
    buffer_store_dword v64, v12, s[32:35], s40 offen offset:0 sc1 nt
    buffer_store_dword v65, v12, s[32:35], s40 offen offset:512 sc1 nt
    buffer_store_dword v66, v12, s[32:35], s40 offen offset:1024 sc1 nt
    buffer_store_dword v67, v12, s[32:35], s40 offen offset:1536 sc1 nt
    buffer_store_dword v68, v12, s[32:35], s41 offen offset:0 sc1 nt
    buffer_store_dword v69, v12, s[32:35], s41 offen offset:512 sc1 nt
    buffer_store_dword v70, v12, s[32:35], s41 offen offset:1024 sc1 nt
    buffer_store_dword v71, v12, s[32:35], s41 offen offset:1536 sc1 nt
    buffer_store_dword v72, v12, s[32:35], s42 offen offset:0 sc1 nt
    buffer_store_dword v73, v12, s[32:35], s42 offen offset:512 sc1 nt
    buffer_store_dword v74, v12, s[32:35], s42 offen offset:1024 sc1 nt
    buffer_store_dword v75, v12, s[32:35], s42 offen offset:1536 sc1 nt
    v_cvt_pk_bf16_f32 v80, v160, v176
    v_cvt_pk_bf16_f32 v81, v161, v177
    v_cvt_pk_bf16_f32 v82, v162, v178
    v_cvt_pk_bf16_f32 v83, v163, v179
    v_cvt_pk_bf16_f32 v84, v164, v180
    v_cvt_pk_bf16_f32 v85, v165, v181
    v_cvt_pk_bf16_f32 v86, v166, v182
    v_cvt_pk_bf16_f32 v87, v167, v183
    v_cvt_pk_bf16_f32 v88, v168, v184
    v_cvt_pk_bf16_f32 v89, v169, v185
    v_cvt_pk_bf16_f32 v90, v170, v186
    v_cvt_pk_bf16_f32 v91, v171, v187
    buffer_store_dword v80, v12, s[32:35], s40 offen offset:128 sc1 nt
    buffer_store_dword v81, v12, s[32:35], s40 offen offset:640 sc1 nt
    buffer_store_dword v82, v12, s[32:35], s40 offen offset:1152 sc1 nt
    buffer_store_dword v83, v12, s[32:35], s40 offen offset:1664 sc1 nt
    buffer_store_dword v84, v12, s[32:35], s41 offen offset:128 sc1 nt
    buffer_store_dword v85, v12, s[32:35], s41 offen offset:640 sc1 nt
    buffer_store_dword v86, v12, s[32:35], s41 offen offset:1152 sc1 nt
    buffer_store_dword v87, v12, s[32:35], s41 offen offset:1664 sc1 nt
    buffer_store_dword v88, v12, s[32:35], s42 offen offset:128 sc1 nt
    buffer_store_dword v89, v12, s[32:35], s42 offen offset:640 sc1 nt
    buffer_store_dword v90, v12, s[32:35], s42 offen offset:1152 sc1 nt
    buffer_store_dword v91, v12, s[32:35], s42 offen offset:1664 sc1 nt
    v_cvt_pk_bf16_f32 v96, v192, v208
    v_cvt_pk_bf16_f32 v97, v193, v209
    v_cvt_pk_bf16_f32 v98, v194, v210
    v_cvt_pk_bf16_f32 v99, v195, v211
    v_cvt_pk_bf16_f32 v100, v196, v212
    v_cvt_pk_bf16_f32 v101, v197, v213
    v_cvt_pk_bf16_f32 v102, v198, v214
    v_cvt_pk_bf16_f32 v103, v199, v215
    v_cvt_pk_bf16_f32 v104, v200, v216
    v_cvt_pk_bf16_f32 v105, v201, v217
    v_cvt_pk_bf16_f32 v106, v202, v218
    v_cvt_pk_bf16_f32 v107, v203, v219
    buffer_store_dword v96, v12, s[32:35], s40 offen offset:256 sc1 nt
    buffer_store_dword v97, v12, s[32:35], s40 offen offset:768 sc1 nt
    buffer_store_dword v98, v12, s[32:35], s40 offen offset:1280 sc1 nt
    buffer_store_dword v99, v12, s[32:35], s40 offen offset:1792 sc1 nt
    buffer_store_dword v100, v12, s[32:35], s41 offen offset:256 sc1 nt
    buffer_store_dword v101, v12, s[32:35], s41 offen offset:768 sc1 nt
    buffer_store_dword v102, v12, s[32:35], s41 offen offset:1280 sc1 nt
    buffer_store_dword v103, v12, s[32:35], s41 offen offset:1792 sc1 nt
    buffer_store_dword v104, v12, s[32:35], s42 offen offset:256 sc1 nt
    buffer_store_dword v105, v12, s[32:35], s42 offen offset:768 sc1 nt
    buffer_store_dword v106, v12, s[32:35], s42 offen offset:1280 sc1 nt
    buffer_store_dword v107, v12, s[32:35], s42 offen offset:1792 sc1 nt
    v_cvt_pk_bf16_f32 v112, v224, v240
    v_cvt_pk_bf16_f32 v113, v225, v241
    v_cvt_pk_bf16_f32 v114, v226, v242
    v_cvt_pk_bf16_f32 v115, v227, v243
    v_cvt_pk_bf16_f32 v116, v228, v244
    v_cvt_pk_bf16_f32 v117, v229, v245
    v_cvt_pk_bf16_f32 v118, v230, v246
    v_cvt_pk_bf16_f32 v119, v231, v247
    v_cvt_pk_bf16_f32 v120, v232, v248
    v_cvt_pk_bf16_f32 v121, v233, v249
    v_cvt_pk_bf16_f32 v122, v234, v250
    v_cvt_pk_bf16_f32 v123, v235, v251
    buffer_store_dword v112, v12, s[32:35], s40 offen offset:384 sc1 nt
    buffer_store_dword v113, v12, s[32:35], s40 offen offset:896 sc1 nt
    buffer_store_dword v114, v12, s[32:35], s40 offen offset:1408 sc1 nt
    buffer_store_dword v115, v12, s[32:35], s40 offen offset:1920 sc1 nt
    buffer_store_dword v116, v12, s[32:35], s41 offen offset:384 sc1 nt
    buffer_store_dword v117, v12, s[32:35], s41 offen offset:896 sc1 nt
    buffer_store_dword v118, v12, s[32:35], s41 offen offset:1408 sc1 nt
    buffer_store_dword v119, v12, s[32:35], s41 offen offset:1920 sc1 nt
    buffer_store_dword v120, v12, s[32:35], s42 offen offset:384 sc1 nt
    buffer_store_dword v121, v12, s[32:35], s42 offen offset:896 sc1 nt
    buffer_store_dword v122, v12, s[32:35], s42 offen offset:1408 sc1 nt
    buffer_store_dword v123, v12, s[32:35], s42 offen offset:1920 sc1 nt
    s_cmp_le_u32 s45, 24
    s_cbranch_scc1 M_fin
    v_cvt_pk_bf16_f32 v76, v140, v156
    v_cvt_pk_bf16_f32 v77, v141, v157
    v_cvt_pk_bf16_f32 v78, v142, v158
    v_cvt_pk_bf16_f32 v79, v143, v159
    buffer_store_dword v76, v12, s[32:35], s43 offen offset:0 sc1 nt
    buffer_store_dword v77, v12, s[32:35], s43 offen offset:512 sc1 nt
    buffer_store_dword v78, v12, s[32:35], s43 offen offset:1024 sc1 nt
    buffer_store_dword v79, v12, s[32:35], s43 offen offset:1536 sc1 nt
    v_cvt_pk_bf16_f32 v92, v172, v188
    v_cvt_pk_bf16_f32 v93, v173, v189
    v_cvt_pk_bf16_f32 v94, v174, v190
    v_cvt_pk_bf16_f32 v95, v175, v191
    buffer_store_dword v92, v12, s[32:35], s43 offen offset:128 sc1 nt
WUP_3936:
    s_cbranch_execz WUR_1
    buffer_store_dword v93, v12, s[32:35], s43 offen offset:640 sc1 nt
    buffer_store_dword v94, v12, s[32:35], s43 offen offset:1152 sc1 nt
    buffer_store_dword v95, v12, s[32:35], s43 offen offset:1664 sc1 nt
    v_cvt_pk_bf16_f32 v108, v204, v220
    v_cvt_pk_bf16_f32 v109, v205, v221
    v_cvt_pk_bf16_f32 v110, v206, v222
    v_cvt_pk_bf16_f32 v111, v207, v223
    buffer_store_dword v108, v12, s[32:35], s43 offen offset:256 sc1 nt
    buffer_store_dword v109, v12, s[32:35], s43 offen offset:768 sc1 nt
    buffer_store_dword v110, v12, s[32:35], s43 offen offset:1280 sc1 nt
    buffer_store_dword v111, v12, s[32:35], s43 offen offset:1792 sc1 nt
    v_cvt_pk_bf16_f32 v124, v236, v252
    v_cvt_pk_bf16_f32 v125, v237, v253
    v_cvt_pk_bf16_f32 v126, v238, v254
    v_cvt_pk_bf16_f32 v127, v239, v255
    buffer_store_dword v124, v12, s[32:35], s43 offen offset:384 sc1 nt
    buffer_store_dword v125, v12, s[32:35], s43 offen offset:896 sc1 nt
    buffer_store_dword v126, v12, s[32:35], s43 offen offset:1408 sc1 nt
    buffer_store_dword v127, v12, s[32:35], s43 offen offset:1920 sc1 nt
M_fin:
K_end:
    s_endpgm
P_rare:
    v_mov_b32 v37, 131080
    v_mov_b32 v38, 131076
    s_mul_i32 s27, s2, 32768
    s_add_u32 s27, s27, 0x1100000
    s_lshl_b32 s59, s2, 15
    s_add_u32 s59, s59, 0x8fff84
    s_mov_b64 exec, s[56:57]
    v_cmp_gt_u32 vcc, 31, v76
    s_and_b64 exec, vcc, s[56:57]
    s_nop 3
    s_cbranch_execz P_r10
    ds_write_b32 v12, v92
P_r10:
    s_andn2_b64 exec, s[56:57], vcc
    s_cbranch_execz P_r30
    s_mov_b64 s[14:15], exec
    v_lshlrev_b32 v36, 1, v76
    v_add_u32 v36, 0xfeffffc4, v36
    ds_max_u32 v84, v36 offset:124
    v_cmp_gt_u32 vcc, 63, v76
    s_and_b64 exec, vcc, s[14:15]
    s_nop 3
    s_cbranch_execz P_r20
    v_lshlrev_b32 v124, 7, v68
    v_lshl_add_u32 v124, v76, 2, v124
    buffer_store_dword v92, v124, s[36:39], s59 offen sc1
    s_nop 0
P_r20:
    s_andn2_b64 exec, s[14:15], vcc
    s_cbranch_execz P_r30
    ds_write_b32 v38, v116
    ds_add_rtn_u32 v124, v37, v116
    v_mov_b32 v126, v92
    v_mov_b32 v127, v68
    s_waitcnt lgkmcnt(0)
    v_lshlrev_b32 v124, 3, v124
    buffer_store_dwordx2 v[126:127], v124, s[36:39], s27 offen sc1
    s_nop 0
P_r30:
    s_mov_b64 exec, s[56:57]
    v_cmp_gt_u32 vcc, 31, v77
    s_and_b64 exec, vcc, s[56:57]
    s_nop 3
    s_cbranch_execz P_r11
    ds_write_b32 v13, v93
P_r11:
    s_andn2_b64 exec, s[56:57], vcc
    s_cbranch_execz P_r31
    s_mov_b64 s[14:15], exec
    v_lshlrev_b32 v36, 1, v77
    v_add_u32 v36, 0xfeffffc4, v36
    ds_max_u32 v85, v36 offset:124
    v_cmp_gt_u32 vcc, 63, v77
    s_and_b64 exec, vcc, s[14:15]
    s_nop 3
    s_cbranch_execz P_r21
    v_lshlrev_b32 v124, 7, v69
    v_lshl_add_u32 v124, v77, 2, v124
    buffer_store_dword v93, v124, s[36:39], s59 offen sc1
    s_nop 0
P_r21:
    s_andn2_b64 exec, s[14:15], vcc
    s_cbranch_execz P_r31
    ds_write_b32 v38, v116
    ds_add_rtn_u32 v124, v37, v116
    v_mov_b32 v126, v93
    v_mov_b32 v127, v69
    s_waitcnt lgkmcnt(0)
    v_lshlrev_b32 v124, 3, v124
    buffer_store_dwordx2 v[126:127], v124, s[36:39], s27 offen sc1
    s_nop 0
P_r31:
    s_mov_b64 exec, s[56:57]
    v_cmp_gt_u32 vcc, 31, v78
    s_and_b64 exec, vcc, s[56:57]
    s_nop 3
    s_cbranch_execz P_r12
    ds_write_b32 v14, v94
P_r12:
    s_andn2_b64 exec, s[56:57], vcc
    s_cbranch_execz P_r32
    s_mov_b64 s[14:15], exec
    v_lshlrev_b32 v36, 1, v78
    v_add_u32 v36, 0xfeffffc4, v36
    ds_max_u32 v86, v36 offset:124
    v_cmp_gt_u32 vcc, 63, v78
    s_and_b64 exec, vcc, s[14:15]
    s_nop 3
    s_cbranch_execz P_r22
    v_lshlrev_b32 v124, 7, v70
    v_lshl_add_u32 v124, v78, 2, v124
    buffer_store_dword v94, v124, s[36:39], s59 offen sc1
    s_nop 0
P_r22:
    s_andn2_b64 exec, s[14:15], vcc
    s_cbranch_execz P_r32
    ds_write_b32 v38, v116
    ds_add_rtn_u32 v124, v37, v116
    v_mov_b32 v126, v94
    v_mov_b32 v127, v70
    s_waitcnt lgkmcnt(0)
    v_lshlrev_b32 v124, 3, v124
    buffer_store_dwordx2 v[126:127], v124, s[36:39], s27 offen sc1
    s_nop 0
P_r32:
    s_mov_b64 exec, s[56:57]
    v_cmp_gt_u32 vcc, 31, v79
    s_and_b64 exec, vcc, s[56:57]
    s_nop 3
    s_cbranch_execz P_r13
    ds_write_b32 v15, v95
P_r13:
    s_andn2_b64 exec, s[56:57], vcc
    s_cbranch_execz P_r33
    s_mov_b64 s[14:15], exec
    v_lshlrev_b32 v36, 1, v79
    v_add_u32 v36, 0xfeffffc4, v36
    ds_max_u32 v87, v36 offset:124
    v_cmp_gt_u32 vcc, 63, v79
    s_and_b64 exec, vcc, s[14:15]
    s_nop 3
    s_cbranch_execz P_r23
    v_lshlrev_b32 v124, 7, v71
    v_lshl_add_u32 v124, v79, 2, v124
    buffer_store_dword v95, v124, s[36:39], s59 offen sc1
    s_nop 0
P_r23:
    s_andn2_b64 exec, s[14:15], vcc
    s_cbranch_execz P_r33
    ds_write_b32 v38, v116
    ds_add_rtn_u32 v124, v37, v116
    v_mov_b32 v126, v95
    v_mov_b32 v127, v71
    s_waitcnt lgkmcnt(0)
    v_lshlrev_b32 v124, 3, v124
    buffer_store_dwordx2 v[126:127], v124, s[36:39], s27 offen sc1
    s_nop 0
P_r33:
    s_mov_b64 exec, s[56:57]
    v_cmp_gt_u32 vcc, 31, v80
    s_and_b64 exec, vcc, s[56:57]
    s_nop 3
    s_cbranch_execz P_r14
    ds_write_b32 v16, v96
P_r14:
    s_andn2_b64 exec, s[56:57], vcc
    s_cbranch_execz P_r34
    s_mov_b64 s[14:15], exec
    v_lshlrev_b32 v36, 1, v80
    v_add_u32 v36, 0xfeffffc4, v36
    ds_max_u32 v88, v36 offset:124
    v_cmp_gt_u32 vcc, 63, v80
    s_and_b64 exec, vcc, s[14:15]
    s_nop 3
    s_cbranch_execz P_r24
    v_lshlrev_b32 v124, 7, v72
    v_lshl_add_u32 v124, v80, 2, v124
    buffer_store_dword v96, v124, s[36:39], s59 offen sc1
    s_nop 0
P_r24:
    s_andn2_b64 exec, s[14:15], vcc
    s_cbranch_execz P_r34
    ds_write_b32 v38, v116
    ds_add_rtn_u32 v124, v37, v116
    v_mov_b32 v126, v96
    v_mov_b32 v127, v72
    s_waitcnt lgkmcnt(0)
    v_lshlrev_b32 v124, 3, v124
    buffer_store_dwordx2 v[126:127], v124, s[36:39], s27 offen sc1
    s_nop 0
P_r34:
    s_mov_b64 exec, s[56:57]
    v_cmp_gt_u32 vcc, 31, v81
    s_and_b64 exec, vcc, s[56:57]
    s_nop 3
    s_cbranch_execz P_r15
    ds_write_b32 v17, v97
P_r15:
    s_andn2_b64 exec, s[56:57], vcc
    s_cbranch_execz P_r35
    s_mov_b64 s[14:15], exec
    v_lshlrev_b32 v36, 1, v81
    v_add_u32 v36, 0xfeffffc4, v36
    ds_max_u32 v89, v36 offset:124
    v_cmp_gt_u32 vcc, 63, v81
    s_and_b64 exec, vcc, s[14:15]
    s_nop 3
    s_cbranch_execz P_r25
    v_lshlrev_b32 v124, 7, v73
    v_lshl_add_u32 v124, v81, 2, v124
    buffer_store_dword v97, v124, s[36:39], s59 offen sc1
    s_nop 0
P_r25:
    s_andn2_b64 exec, s[14:15], vcc
    s_cbranch_execz P_r35
    ds_write_b32 v38, v116
    ds_add_rtn_u32 v124, v37, v116
    v_mov_b32 v126, v97
    v_mov_b32 v127, v73
    s_waitcnt lgkmcnt(0)
    v_lshlrev_b32 v124, 3, v124
    buffer_store_dwordx2 v[126:127], v124, s[36:39], s27 offen sc1
    s_nop 0
P_r35:
    s_mov_b64 exec, s[56:57]
    v_cmp_gt_u32 vcc, 31, v82
    s_and_b64 exec, vcc, s[56:57]
    s_nop 3
    s_cbranch_execz P_r16
    ds_write_b32 v18, v98
P_r16:
    s_andn2_b64 exec, s[56:57], vcc
    s_cbranch_execz P_r36
    s_mov_b64 s[14:15], exec
    v_lshlrev_b32 v36, 1, v82
    v_add_u32 v36, 0xfeffffc4, v36
    ds_max_u32 v90, v36 offset:124
    v_cmp_gt_u32 vcc, 63, v82
    s_and_b64 exec, vcc, s[14:15]
    s_nop 3
    s_cbranch_execz P_r26
    v_lshlrev_b32 v124, 7, v74
    v_lshl_add_u32 v124, v82, 2, v124
    buffer_store_dword v98, v124, s[36:39], s59 offen sc1
    s_nop 0
P_r26:
    s_andn2_b64 exec, s[14:15], vcc
    s_cbranch_execz P_r36
    ds_write_b32 v38, v116
    ds_add_rtn_u32 v124, v37, v116
    v_mov_b32 v126, v98
    v_mov_b32 v127, v74
    s_waitcnt lgkmcnt(0)
    v_lshlrev_b32 v124, 3, v124
    buffer_store_dwordx2 v[126:127], v124, s[36:39], s27 offen sc1
    s_nop 0
P_r36:
    s_mov_b64 exec, s[56:57]
    v_cmp_gt_u32 vcc, 31, v83
    s_and_b64 exec, vcc, s[56:57]
    s_nop 3
    s_cbranch_execz P_r17
    ds_write_b32 v19, v99
P_r17:
    s_andn2_b64 exec, s[56:57], vcc
    s_cbranch_execz P_r37
    s_mov_b64 s[14:15], exec
    v_lshlrev_b32 v36, 1, v83
    v_add_u32 v36, 0xfeffffc4, v36
    ds_max_u32 v91, v36 offset:124
    v_cmp_gt_u32 vcc, 63, v83
    s_and_b64 exec, vcc, s[14:15]
    s_nop 3
    s_cbranch_execz P_r27
    v_lshlrev_b32 v124, 7, v75
    v_lshl_add_u32 v124, v83, 2, v124
    buffer_store_dword v99, v124, s[36:39], s59 offen sc1
    s_nop 0
P_r27:
    s_andn2_b64 exec, s[14:15], vcc
    s_cbranch_execz P_r37
    ds_write_b32 v38, v116
    ds_add_rtn_u32 v124, v37, v116
    v_mov_b32 v126, v99
    v_mov_b32 v127, v75
    s_waitcnt lgkmcnt(0)
    v_lshlrev_b32 v124, 3, v124
    buffer_store_dwordx2 v[126:127], v124, s[36:39], s27 offen sc1
    s_nop 0
P_r37:
    s_mov_b64 exec, -1
    s_waitcnt vmcnt(0)
    s_branch P_join
M_e4x:
WUP_4205:
    s_cbranch_execz WUP_4376
    s_mov_b32 s56, 0x05040100
    s_mov_b32 s57, 0x07060302
    s_waitcnt vmcnt(4)
    v_lshlrev_b32 v150, 4, v1
    v_cmp_gt_u32 vcc, 49, v1
    s_mov_b64 s[60:61], vcc
    s_mov_b32 s63, 0x830100
    s_mov_b32 s65, 0
    s_nop 1
    s_branch M_pb
M_pa:
    buffer_load_dwordx4 v[236:239], v150, s[36:39], s63 offen sc1
    s_waitcnt vmcnt(0)
M_pb:
    v_xor_b32 v236, s18, v236
    v_xor_b32 v237, s18, v237
    v_xor_b32 v238, s18, v238
    v_xor_b32 v239, s18, v239
    v_or3_b32 v236, v236, v237, v238
    v_or_b32 v236, v236, v239
    v_cmp_ne_u32 vcc, 0, v236
    s_and_b64 vcc, vcc, s[60:61]
    s_cbranch_vccz M_pad
    s_sleep 2
    s_add_u32 s65, s65, 1
    s_cmp_lt_u32 s65, 16384
    s_cbranch_scc1 M_pa
M_pad:
    s_sub_u32 s27, s26, 5
    s_lshl_b32 s27, s27, 10
    s_add_u32 s63, s27, 0x810000
    s_add_u32 s27, s27, 30720
    s_mov_b32 m0, s27
    s_nop 0
    buffer_load_dwordx4 v3, s[36:39], s63 offen sc1 lds
    s_add_u32 s27, s27, 3072
    s_add_u32 s63, s63, 3072
    s_mov_b32 m0, s27
    s_nop 0
    buffer_load_dwordx4 v3, s[36:39], s63 offen sc1 lds
    s_add_u32 s27, s27, 3072
    s_add_u32 s63, s63, 3072
    s_mov_b32 m0, s27
    s_nop 0
    buffer_load_dwordx4 v3, s[36:39], s63 offen sc1 lds
    s_add_u32 s27, s27, 3072
    s_add_u32 s63, s63, 3072
    s_mov_b32 m0, s27
    s_nop 0
    buffer_load_dwordx4 v3, s[36:39], s63 offen sc1 lds
    s_add_u32 s27, s27, 3072
    s_add_u32 s63, s63, 3072
    s_mov_b32 m0, s27
    s_nop 0
    buffer_load_dwordx4 v3, s[36:39], s63 offen sc1 lds
    s_add_u32 s27, s27, 3072
    s_add_u32 s63, s63, 3072
    s_mov_b32 m0, s27
    s_nop 0
    buffer_load_dwordx4 v3, s[36:39], s63 offen sc1 lds
    s_add_u32 s27, s27, 3072
    s_add_u32 s63, s63, 3072
    s_mov_b32 m0, s27
    s_nop 0
    buffer_load_dwordx4 v3, s[36:39], s63 offen sc1 lds
    s_add_u32 s27, s27, 3072
    s_add_u32 s63, s63, 3072
    s_mov_b32 m0, s27
    s_nop 0
    buffer_load_dwordx4 v3, s[36:39], s63 offen sc1 lds
    s_add_u32 s27, s27, 3072
    s_add_u32 s63, s63, 3072
    s_mov_b32 m0, s27
    s_nop 0
    buffer_load_dwordx4 v3, s[36:39], s63 offen sc1 lds
    s_add_u32 s27, s27, 3072
    s_add_u32 s63, s63, 3072
    s_mov_b32 m0, s27
    s_nop 0
    buffer_load_dwordx4 v3, s[36:39], s63 offen sc1 lds
    s_add_u32 s27, s27, 3072
    s_add_u32 s63, s63, 3072
    s_mov_b32 m0, s27
    s_nop 0
    buffer_load_dwordx4 v3, s[36:39], s63 offen sc1 lds
    s_add_u32 s27, s27, 3072
    s_add_u32 s63, s63, 3072
    s_mov_b32 m0, s27
    s_nop 0
    buffer_load_dwordx4 v3, s[36:39], s63 offen sc1 lds
    s_add_u32 s27, s27, 3072
    s_add_u32 s63, s63, 3072
    s_mov_b32 m0, s27
    s_nop 0
    buffer_load_dwordx4 v3, s[36:39], s63 offen sc1 lds
    s_add_u32 s27, s27, 3072
    s_add_u32 s63, s63, 3072
    s_mov_b32 m0, s27
    s_nop 0
    buffer_load_dwordx4 v3, s[36:39], s63 offen sc1 lds
    s_add_u32 s27, s27, 3072
    s_add_u32 s63, s63, 3072
    s_mov_b32 m0, s27
    s_nop 0
    buffer_load_dwordx4 v3, s[36:39], s63 offen sc1 lds
    s_add_u32 s27, s27, 3072
    s_add_u32 s63, s63, 3072
    s_mov_b32 m0, s27
    s_nop 0
    buffer_load_dwordx4 v3, s[36:39], s63 offen sc1 lds
    s_add_u32 s27, s27, 3072
    s_add_u32 s63, s63, 3072
    s_mov_b32 m0, s27
    s_nop 0
    buffer_load_dwordx4 v3, s[36:39], s63 offen sc1 lds
    s_add_u32 s27, s27, 3072
    s_add_u32 s63, s63, 3072
    s_mov_b32 m0, s27
    s_nop 0
    buffer_load_dwordx4 v3, s[36:39], s63 offen sc1 lds
    s_add_u32 s27, s27, 3072
    s_add_u32 s63, s63, 3072
    s_mov_b32 m0, s27
    s_nop 0
    buffer_load_dwordx4 v3, s[36:39], s63 offen sc1 lds
    s_add_u32 s27, s27, 3072
    s_add_u32 s63, s63, 3072
    s_mov_b32 m0, s27
    s_nop 0
    buffer_load_dwordx4 v3, s[36:39], s63 offen sc1 lds
    s_add_u32 s27, s27, 3072
    s_add_u32 s63, s63, 3072
    s_mov_b32 m0, s27
    s_nop 0
    buffer_load_dwordx4 v3, s[36:39], s63 offen sc1 lds
    s_add_u32 s27, s27, 3072
    s_add_u32 s63, s63, 3072
    s_mov_b32 m0, s27
    s_nop 0
    buffer_load_dwordx4 v3, s[36:39], s63 offen sc1 lds
    s_add_u32 s27, s27, 3072
    s_add_u32 s63, s63, 3072
    s_mov_b32 m0, s27
    s_nop 0
    buffer_load_dwordx4 v3, s[36:39], s63 offen sc1 lds
    s_add_u32 s27, s27, 3072
    s_add_u32 s63, s63, 3072
    s_mov_b32 m0, s27
    s_nop 0
    buffer_load_dwordx4 v3, s[36:39], s63 offen sc1 lds
    s_add_u32 s27, s27, 3072
    s_add_u32 s63, s63, 3072
    s_mov_b32 m0, s27
    s_nop 0
    buffer_load_dwordx4 v3, s[36:39], s63 offen sc1 lds
    s_add_u32 s27, s27, 3072
    s_add_u32 s63, s63, 3072
    s_mov_b32 m0, s27
    s_nop 0
    buffer_load_dwordx4 v3, s[36:39], s63 offen sc1 lds
    s_add_u32 s27, s27, 3072
    s_add_u32 s63, s63, 3072
    s_mov_b32 m0, s27
    s_nop 0
    buffer_load_dwordx4 v3, s[36:39], s63 offen sc1 lds
    s_add_u32 s27, s27, 3072
    s_add_u32 s63, s63, 3072
    s_mov_b32 m0, s27
    s_nop 0
    buffer_load_dwordx4 v3, s[36:39], s63 offen sc1 lds
    s_add_u32 s27, s27, 3072
    s_add_u32 s63, s63, 3072
    s_mov_b32 m0, s27
    s_nop 0
WUP_4376:
    s_cbranch_execz WUR_0
    buffer_load_dwordx4 v3, s[36:39], s63 offen sc1 lds
    s_add_u32 s27, s27, 3072
    s_add_u32 s63, s63, 3072
    s_mov_b32 m0, s27
    s_nop 0
    buffer_load_dwordx4 v3, s[36:39], s63 offen sc1 lds
    s_add_u32 s27, s27, 3072
    s_add_u32 s63, s63, 3072
    s_mov_b32 m0, s27
    s_nop 0
    buffer_load_dwordx4 v3, s[36:39], s63 offen sc1 lds
    s_add_u32 s27, s27, 3072
    s_add_u32 s63, s63, 3072
    s_mov_b32 m0, s27
    s_nop 0
    buffer_load_dwordx4 v3, s[36:39], s63 offen sc1 lds
    s_add_u32 s27, s27, 3072
    s_add_u32 s63, s63, 3072
    s_cmp_eq_u32 s26, 7
    s_cbranch_scc1 M_tfd
    s_mov_b32 m0, s27
    s_nop 0
    buffer_load_dwordx4 v3, s[36:39], s63 offen sc1 lds
M_tfd:
    s_setprio 0
    s_branch M_e5
M_mdx:
    s_mov_b32 s59, 0
M_md:
    s_cmp_eq_u64 s[68:69], 0
    s_cbranch_scc0 M_md1
    s_cmp_lg_u32 s59, 0
    s_cbranch_scc1 M_mdd
    s_mov_b32 s59, 1
    s_mov_b64 s[68:69], s[70:71]
    v_mov_b32 v187, v191
    s_nop 1
    s_branch M_md
M_md1:
    s_ff1_i32_b64 s27, s[68:69]
    s_bitset0_b64 s[68:69], s27
    v_readlane_b32 s60, v187, s27
    s_bfe_u32 s60, s60, 0x170001
    s_cmp_le_u32 s60, 32
    s_cbranch_scc1 M_md2
    ds_write_b32 v9, v19
    s_movk_i32 s60, 32
M_md2:
    s_lshr_b32 s27, s27, 2
    s_lshl_b32 s61, s59, 4
    s_add_u32 s27, s27, s61
    s_lshl_b32 s61, s26, 5
    s_add_u32 s27, s27, s61
    s_lshl_b32 s27, s27, 15
    s_lshl_b32 s61, s2, 7
    s_add_u32 s27, s27, s61
    s_add_u32 s27, s27, 0x900000
    v_mov_b32 v148, 0xff000000
    s_bfm_b64 exec, s60, 0
    buffer_load_dword v148, v20, s[36:39], s27 offen sc1
    s_mov_b64 exec, -1
    s_waitcnt vmcnt(0) lgkmcnt(0)
    v_and_b32 v64, s12, v148
    v_alignbit_b32 v65, s13, v148, 22
    ds_read_u16 v64, v64 offset:30720
    ds_read_b32 v65, v65
    s_waitcnt lgkmcnt(0)
    v_and_b32 v96, 0x0707, v64
    v_and_b32 v64, 0xf8f8, v64
    v_mul_u32_u24 v96, 0x200400, v96
    v_and_or_b32 v64, v96, s14, v64
    v_add_u32 v64, v64, v65
    v_dot4_i32_i8 v64, v64, v64, 0
    s_nop 2
    v_cmp_gt_i32 s[40:41], s15, v64
    s_nop 1
    v_mbcnt_lo_u32_b32 v96, s40, 0
    v_mbcnt_hi_u32_b32 v96, s41, v96
    v_lshl_add_u32 v96, v96, 2, s16
    s_bcnt1_i32_b64 s27, s[40:41]
    s_lshl2_add_u32 s16, s27, s16
    v_cndmask_b32 v96, v26, v96, s[40:41]
    ds_write_b32 v96, v148
    s_sub_u32 s27, s16, s17
    s_cmp_gt_u32 s27, 1024
    s_cbranch_scc0 M_md
    s_branch M_mdd
M_rd0:
    s_waitcnt vmcnt(0)
    v_lshlrev_b32 v192, 16, v208
    v_and_b32 v208, s58, v208
    v_lshlrev_b32 v193, 16, v209
    v_and_b32 v209, s58, v209
    v_lshlrev_b32 v194, 16, v210
    v_and_b32 v210, s58, v210
    v_lshlrev_b32 v195, 16, v211
    v_and_b32 v211, s58, v211
    v_lshlrev_b32 v196, 16, v212
    v_and_b32 v212, s58, v212
    v_lshlrev_b32 v197, 16, v213
    v_and_b32 v213, s58, v213
    v_lshlrev_b32 v198, 16, v214
    v_and_b32 v214, s58, v214
    v_lshlrev_b32 v199, 16, v215
    v_and_b32 v215, s58, v215
    v_lshlrev_b32 v200, 16, v216
    v_and_b32 v216, s58, v216
    v_lshlrev_b32 v201, 16, v217
    v_and_b32 v217, s58, v217
    v_lshlrev_b32 v202, 16, v218
    v_and_b32 v218, s58, v218
    v_lshlrev_b32 v203, 16, v219
    v_and_b32 v219, s58, v219
    v_lshlrev_b32 v204, 16, v220
    v_and_b32 v220, s58, v220
    v_lshlrev_b32 v205, 16, v221
    v_and_b32 v221, s58, v221
    v_lshlrev_b32 v206, 16, v222
    v_and_b32 v222, s58, v222
    v_lshlrev_b32 v207, 16, v223
    v_and_b32 v223, s58, v223
    v_lshlrev_b32 v224, 16, v240
    v_and_b32 v240, s58, v240
    v_lshlrev_b32 v225, 16, v241
    v_and_b32 v241, s58, v241
    v_lshlrev_b32 v226, 16, v242
    v_and_b32 v242, s58, v242
    v_lshlrev_b32 v227, 16, v243
    v_and_b32 v243, s58, v243
    v_lshlrev_b32 v228, 16, v244
    v_and_b32 v244, s58, v244
    v_lshlrev_b32 v229, 16, v245
    v_and_b32 v245, s58, v245
    v_lshlrev_b32 v230, 16, v246
    v_and_b32 v246, s58, v246
    v_lshlrev_b32 v231, 16, v247
    v_and_b32 v247, s58, v247
    v_lshlrev_b32 v232, 16, v248
    v_and_b32 v248, s58, v248
    v_lshlrev_b32 v233, 16, v249
    v_and_b32 v249, s58, v249
    v_lshlrev_b32 v234, 16, v250
    v_and_b32 v250, s58, v250
    v_lshlrev_b32 v235, 16, v251
    v_and_b32 v251, s58, v251
    v_lshlrev_b32 v236, 16, v252
    v_and_b32 v252, s58, v252
    v_lshlrev_b32 v237, 16, v253
    v_and_b32 v253, s58, v253
    v_lshlrev_b32 v238, 16, v254
    v_and_b32 v254, s58, v254
    v_lshlrev_b32 v239, 16, v255
    v_and_b32 v255, s58, v255
    s_mov_b32 s99, 0
    s_nop 0
    s_branch M_rd1
M_slow:
    v_lshrrev_b32 v8, 4, v1
    v_add_u32 v86, 64, v8
    v_bfrev_b32 v14, 2
    s_mov_b32 s63, 0x02020000
    s_mov_b32 s64, 0x322bcc77
    v_mov_b32 v103, 0x01000c0c
    v_and_b32 v12, 3, v8
    v_lshlrev_b32 v12, 3, v12
    v_lshrrev_b32_e64 v13, v12, s18
    v_bfe_u32 v15, v13, 1, 7
    v_lshlrev_b32 v15, 17, v15
    v_and_b32 v13, 1, v13
    v_or_b32 v95, v13, v15
    s_bfe_u32 s60, s18, 0x70019
    s_lshl_b32 s60, s60, 17
    s_bfe_u32 s27, s18, 0x10018
    s_or_b32 s60, s60, s27
    s_lshl_b32 s53, s2, 7
    s_cmp_eq_u32 s14, 2
    s_cbranch_scc1 M_sovf
    s_cmp_ge_u32 s15, 63
    s_cbranch_scc1 M_sph1
    s_lshl_b32 s62, s15, 2
    v_lshrrev_b32 v12, 5, v8
    v_and_b32 v13, 31, v8
    v_add_u32 v15, s62, v12
    v_cmp_gt_u32 vcc, 250, v15
    s_mov_b64 s[54:55], vcc
    v_lshlrev_b32 v15, 15, v15
    v_cndmask_b32 v15, v14, v15, s[54:55]
    s_cmp_lg_u32 s14, 0
    s_nop 0
    s_cbranch_scc1 M_s223
    v_lshl_add_u32 v16, v13, 2, v15
    buffer_load_dword v88, v16, s[36:39], s53 offen sc1
    s_waitcnt vmcnt(0)
    v_xor_b32 v88, v95, v88
    s_mov_b32 s27, 0xc8000000
    v_cmp_gt_u32 vcc, s27, v88
    s_and_b64 s[54:55], s[54:55], vcc
    s_nop 3
    s_branch M_s323
M_s223:
    buffer_load_dword v88, v15, s[36:39], s53 offen offset:124 sc1
    s_waitcnt vmcnt(0)
    v_xor_b32 v88, s60, v88
    v_bfe_u32 v88, v88, 1, 23
    v_cmp_gt_u32 vcc, v88, v13
    s_and_b64 s[54:55], s[54:55], vcc
    v_lshl_add_u32 v16, v13, 2, v15
    v_cndmask_b32 v16, v14, v16, s[54:55]
    s_add_u32 s27, s53, 0x900000
    buffer_load_dword v88, v16, s[36:39], s27 offen sc1
    s_waitcnt vmcnt(0)
M_s323:
    v_lshrrev_b32 v16, 24, v88
    v_subrev_u32 v17, s59, v16
    v_cmp_gt_u32 vcc, s45, v17
    s_and_b64 s[54:55], s[54:55], vcc
    v_and_b32 v96, 0x1fffe, v88
    v_lshl_add_u32 v96, v96, 1, v96
    v_and_b32 v96, -4, v96
    v_cndmask_b32 v96, v14, v96, s[54:55]
    buffer_load_dwordx2 v[98:99], v96, s[92:95], 0 offen
    v_mul_u32_u24 v97, 6, v16
    v_and_b32 v97, -4, v97
    v_cndmask_b32 v97, v14, v97, s[54:55]
    s_mul_i32 s27, s2, 1200
    buffer_load_dwordx2 v[100:101], v97, s[92:95], s27 offen
    v_bfe_i32 v102, v88, 1, 1
    v_and_or_b32 v102, v102, s63, v103
    v_bfe_i32 v104, v16, 0, 1
    v_and_or_b32 v104, v104, s63, v103
    v_add_u32 v105, s63, v104
    v_add_u32 v106, s63, v105
    s_waitcnt vmcnt(0)
    v_perm_b32 v107, v101, v100, v104
    v_perm_b32 v108, v101, v100, v105
    v_perm_b32 v109, v101, v100, v106
    v_add_u32 v113, s63, v102
    v_perm_b32 v110, v99, v98, v102
    v_add_u32 v114, s63, v113
    v_perm_b32 v111, v99, v98, v113
    v_perm_b32 v112, v99, v98, v114
    v_sub_f32 v110, v110, v107
    v_sub_f32 v111, v111, v108
    v_sub_f32 v112, v112, v109
    v_cvt_pk_bf16_f32 v89, v110, v111
    v_cvt_pk_bf16_f32 v112, 0, v112
    v_lshlrev_b32 v110, 16, v89
    v_and_b32 v111, s58, v89
    v_mul_f32 v115, v112, v112
    v_mul_f32 v110, v110, v110
    v_mul_f32 v111, v111, v111
    v_cvt_pk_bf16_f32 v115, 0, v115
    v_cvt_pk_bf16_f32 v110, 0, v110
    v_cvt_pk_bf16_f32 v111, 0, v111
    v_add_f32 v110, v110, v111
    v_add_f32 v110, v110, v115
    v_cvt_pk_bf16_f32 v110, 0, v110
    v_add_f32 v110, s64, v110
    v_cvt_pk_bf16_f32 v110, 0, v110
    v_sqrt_f32 v110, v110
    s_nop 0
    v_cvt_pk_bf16_f32 v90, v112, v110
    s_mov_b32 s27, 0x409d0000
    v_cmp_gt_u32 vcc, s27, v90
    s_and_b64 s[8:9], s[54:55], vcc
    v_lshrrev_b32 v12, 5, v86
    v_and_b32 v13, 31, v86
    v_add_u32 v15, s62, v12
    v_cmp_gt_u32 vcc, 250, v15
    s_mov_b64 s[54:55], vcc
    v_lshlrev_b32 v15, 15, v15
    v_cndmask_b32 v15, v14, v15, s[54:55]
    s_cmp_lg_u32 s14, 0
    s_nop 0
    s_cbranch_scc1 M_s224
    v_lshl_add_u32 v16, v13, 2, v15
    buffer_load_dword v92, v16, s[36:39], s53 offen sc1
    s_waitcnt vmcnt(0)
    v_xor_b32 v92, v95, v92
    s_mov_b32 s27, 0xc8000000
    v_cmp_gt_u32 vcc, s27, v92
    s_and_b64 s[54:55], s[54:55], vcc
    s_nop 3
    s_branch M_s324
M_s224:
    buffer_load_dword v92, v15, s[36:39], s53 offen offset:124 sc1
    s_waitcnt vmcnt(0)
    v_xor_b32 v92, s60, v92
    v_bfe_u32 v92, v92, 1, 23
    v_cmp_gt_u32 vcc, v92, v13
    s_and_b64 s[54:55], s[54:55], vcc
    v_lshl_add_u32 v16, v13, 2, v15
    v_cndmask_b32 v16, v14, v16, s[54:55]
    s_add_u32 s27, s53, 0x900000
    buffer_load_dword v92, v16, s[36:39], s27 offen sc1
    s_waitcnt vmcnt(0)
M_s324:
    v_lshrrev_b32 v16, 24, v92
    v_subrev_u32 v17, s59, v16
    v_cmp_gt_u32 vcc, s45, v17
    s_and_b64 s[54:55], s[54:55], vcc
    v_and_b32 v96, 0x1fffe, v92
    v_lshl_add_u32 v96, v96, 1, v96
    v_and_b32 v96, -4, v96
    v_cndmask_b32 v96, v14, v96, s[54:55]
    buffer_load_dwordx2 v[98:99], v96, s[92:95], 0 offen
    v_mul_u32_u24 v97, 6, v16
    v_and_b32 v97, -4, v97
    v_cndmask_b32 v97, v14, v97, s[54:55]
    s_mul_i32 s27, s2, 1200
    buffer_load_dwordx2 v[100:101], v97, s[92:95], s27 offen
    v_bfe_i32 v102, v92, 1, 1
    v_and_or_b32 v102, v102, s63, v103
    v_bfe_i32 v104, v16, 0, 1
    v_and_or_b32 v104, v104, s63, v103
    v_add_u32 v105, s63, v104
    v_add_u32 v106, s63, v105
    s_waitcnt vmcnt(0)
    v_perm_b32 v107, v101, v100, v104
    v_perm_b32 v108, v101, v100, v105
    v_perm_b32 v109, v101, v100, v106
    v_add_u32 v113, s63, v102
    v_perm_b32 v110, v99, v98, v102
    v_add_u32 v114, s63, v113
    v_perm_b32 v111, v99, v98, v113
    v_perm_b32 v112, v99, v98, v114
    v_sub_f32 v110, v110, v107
    v_sub_f32 v111, v111, v108
    v_sub_f32 v112, v112, v109
    v_cvt_pk_bf16_f32 v93, v110, v111
    v_cvt_pk_bf16_f32 v112, 0, v112
    v_lshlrev_b32 v110, 16, v93
    v_and_b32 v111, s58, v93
    v_mul_f32 v115, v112, v112
    v_mul_f32 v110, v110, v110
    v_mul_f32 v111, v111, v111
    v_cvt_pk_bf16_f32 v115, 0, v115
    v_cvt_pk_bf16_f32 v110, 0, v110
    v_cvt_pk_bf16_f32 v111, 0, v111
    v_add_f32 v110, v110, v111
    v_add_f32 v110, v110, v115
    v_cvt_pk_bf16_f32 v110, 0, v110
    v_add_f32 v110, s64, v110
    v_cvt_pk_bf16_f32 v110, 0, v110
    v_sqrt_f32 v110, v110
    s_nop 0
    v_cvt_pk_bf16_f32 v94, v112, v110
    s_mov_b32 s27, 0x409d0000
    v_cmp_gt_u32 vcc, s27, v94
    s_and_b64 s[10:11], s[54:55], vcc
    s_add_u32 s15, s15, 1
    s_nop 2
    s_branch M_sgo
M_sph1:
    s_add_u32 s14, s14, 1
    s_mov_b32 s15, 0
    s_mov_b32 s16, 0
    s_cmp_eq_u32 s14, 1
    s_cbranch_scc1 M_slow
M_sovf:
    s_cmp_ge_u32 s15, 250
    s_cbranch_scc1 M_send
    s_cmp_lg_u32 s16, 0
    s_cbranch_scc1 M_sblk
    s_lshl_b32 s27, s15, 15
    s_add_u32 s27, s27, s53
    v_mov_b32 v12, 0
    buffer_load_dword v13, v12, s[36:39], s27 offen offset:124 sc1
    s_waitcnt vmcnt(0)
    v_readfirstlane_b32 s17, v13
    s_xor_b32 s17, s17, s60
    s_bfe_u32 s17, s17, 0x170001
    s_cmp_gt_u32 s17, 32
    s_cselect_b32 s17, 1, 0
    s_cbranch_scc0 M_sblk0
    s_lshl_b32 s27, s15, 15
    s_add_u32 s27, s27, 32124
    buffer_load_dword v13, v12, s[36:39], s27 offen sc1
    s_waitcnt vmcnt(0)
    v_readfirstlane_b32 s17, v13
    s_min_u32 s17, s17, 3200
M_sblk0:
M_sblk:
    s_cmp_lt_u32 s16, s17
    s_cbranch_scc1 M_sld
    s_add_u32 s15, s15, 1
    s_mov_b32 s16, 0
    s_branch M_sovf
M_sld:
    s_mul_i32 s27, s15, 32768
    s_add_u32 s27, s27, 0x1100000
    v_add_u32 v12, s16, v8
    v_cmp_gt_u32 s[54:55], s17, v12
    v_lshlrev_b32 v12, 3, v12
    s_nop 0
    v_cndmask_b32 v12, v14, v12, s[54:55]
    buffer_load_dwordx2 v[88:89], v12, s[36:39], s27 offen sc1
    s_waitcnt vmcnt(0)
    v_cmp_eq_u32 vcc, s2, v89
    s_and_b64 s[54:55], s[54:55], vcc
    v_lshrrev_b32 v16, 24, v88
    v_subrev_u32 v17, s59, v16
    v_cmp_gt_u32 vcc, s45, v17
    s_and_b64 s[54:55], s[54:55], vcc
    v_and_b32 v96, 0x1fffe, v88
    v_lshl_add_u32 v96, v96, 1, v96
    v_and_b32 v96, -4, v96
    v_cndmask_b32 v96, v14, v96, s[54:55]
    buffer_load_dwordx2 v[98:99], v96, s[92:95], 0 offen
    v_mul_u32_u24 v97, 6, v16
    v_and_b32 v97, -4, v97
    v_cndmask_b32 v97, v14, v97, s[54:55]
    s_mul_i32 s27, s2, 1200
    buffer_load_dwordx2 v[100:101], v97, s[92:95], s27 offen
    v_bfe_i32 v102, v88, 1, 1
    v_and_or_b32 v102, v102, s63, v103
    v_bfe_i32 v104, v16, 0, 1
    v_and_or_b32 v104, v104, s63, v103
    v_add_u32 v105, s63, v104
    v_add_u32 v106, s63, v105
    s_waitcnt vmcnt(0)
    v_perm_b32 v107, v101, v100, v104
    v_perm_b32 v108, v101, v100, v105
    v_perm_b32 v109, v101, v100, v106
    v_add_u32 v113, s63, v102
    v_perm_b32 v110, v99, v98, v102
    v_add_u32 v114, s63, v113
    v_perm_b32 v111, v99, v98, v113
    v_perm_b32 v112, v99, v98, v114
    v_sub_f32 v110, v110, v107
    v_sub_f32 v111, v111, v108
    v_sub_f32 v112, v112, v109
    v_cvt_pk_bf16_f32 v89, v110, v111
    v_cvt_pk_bf16_f32 v112, 0, v112
    v_lshlrev_b32 v110, 16, v89
    v_and_b32 v111, s58, v89
    v_mul_f32 v115, v112, v112
    v_mul_f32 v110, v110, v110
    v_mul_f32 v111, v111, v111
    v_cvt_pk_bf16_f32 v115, 0, v115
    v_cvt_pk_bf16_f32 v110, 0, v110
    v_cvt_pk_bf16_f32 v111, 0, v111
    v_add_f32 v110, v110, v111
    v_add_f32 v110, v110, v115
    v_cvt_pk_bf16_f32 v110, 0, v110
    v_add_f32 v110, s64, v110
    v_cvt_pk_bf16_f32 v110, 0, v110
    v_sqrt_f32 v110, v110
    s_nop 0
    v_cvt_pk_bf16_f32 v90, v112, v110
    s_mov_b32 s27, 0x409d0000
    v_cmp_gt_u32 vcc, s27, v90
    s_and_b64 s[8:9], s[54:55], vcc
    s_mul_i32 s27, s15, 32768
    s_add_u32 s27, s27, 0x1100000
    v_add_u32 v12, s16, v86
    v_cmp_gt_u32 s[54:55], s17, v12
    v_lshlrev_b32 v12, 3, v12
    s_nop 0
    v_cndmask_b32 v12, v14, v12, s[54:55]
    buffer_load_dwordx2 v[92:93], v12, s[36:39], s27 offen sc1
    s_waitcnt vmcnt(0)
    v_cmp_eq_u32 vcc, s2, v93
    s_and_b64 s[54:55], s[54:55], vcc
    v_lshrrev_b32 v16, 24, v92
    v_subrev_u32 v17, s59, v16
    v_cmp_gt_u32 vcc, s45, v17
    s_and_b64 s[54:55], s[54:55], vcc
    v_and_b32 v96, 0x1fffe, v92
    v_lshl_add_u32 v96, v96, 1, v96
    v_and_b32 v96, -4, v96
    v_cndmask_b32 v96, v14, v96, s[54:55]
    buffer_load_dwordx2 v[98:99], v96, s[92:95], 0 offen
    v_mul_u32_u24 v97, 6, v16
    v_and_b32 v97, -4, v97
    v_cndmask_b32 v97, v14, v97, s[54:55]
    s_mul_i32 s27, s2, 1200
    buffer_load_dwordx2 v[100:101], v97, s[92:95], s27 offen
    v_bfe_i32 v102, v92, 1, 1
    v_and_or_b32 v102, v102, s63, v103
    v_bfe_i32 v104, v16, 0, 1
    v_and_or_b32 v104, v104, s63, v103
    v_add_u32 v105, s63, v104
    v_add_u32 v106, s63, v105
    s_waitcnt vmcnt(0)
    v_perm_b32 v107, v101, v100, v104
    v_perm_b32 v108, v101, v100, v105
    v_perm_b32 v109, v101, v100, v106
    v_add_u32 v113, s63, v102
    v_perm_b32 v110, v99, v98, v102
    v_add_u32 v114, s63, v113
    v_perm_b32 v111, v99, v98, v113
    v_perm_b32 v112, v99, v98, v114
    v_sub_f32 v110, v110, v107
    v_sub_f32 v111, v111, v108
    v_sub_f32 v112, v112, v109
    v_cvt_pk_bf16_f32 v93, v110, v111
    v_cvt_pk_bf16_f32 v112, 0, v112
    v_lshlrev_b32 v110, 16, v93
    v_and_b32 v111, s58, v93
    v_mul_f32 v115, v112, v112
    v_mul_f32 v110, v110, v110
    v_mul_f32 v111, v111, v111
    v_cvt_pk_bf16_f32 v115, 0, v115
    v_cvt_pk_bf16_f32 v110, 0, v110
    v_cvt_pk_bf16_f32 v111, 0, v111
    v_add_f32 v110, v110, v111
    v_add_f32 v110, v110, v115
    v_cvt_pk_bf16_f32 v110, 0, v110
    v_add_f32 v110, s64, v110
    v_cvt_pk_bf16_f32 v110, 0, v110
    v_sqrt_f32 v110, v110
    s_nop 0
    v_cvt_pk_bf16_f32 v94, v112, v110
    s_mov_b32 s27, 0x409d0000
    v_cmp_gt_u32 vcc, s27, v94
    s_and_b64 s[10:11], s[54:55], vcc
    s_add_u32 s16, s16, 128
    s_nop 2
M_sgo:
    s_or_b64 s[54:55], s[8:9], s[10:11]
    s_cmp_eq_u64 s[54:55], 0
    s_cbranch_scc1 M_slow
    s_mov_b32 s48, 4
    s_cmp_eq_u64 s[10:11], 0
    s_cselect_b32 s48, 2, 4
    s_movk_i32 s63, 0x70
    s_movk_i32 s64, 2176
    v_lshrrev_b32 v8, 4, v1
    v_lshrrev_b32 v10, 5, v8
    v_and_b32 v11, 31, v8
    v_lshlrev_b32 v3, 4, v11
    v_add_u32 v3, s52, v3
    v_mul_u32_u24 v0, 56, v10
    v_add_u32 v0, s52, v0
    v_lshrrev_b32 v13, 3, v11
    v_lshl_add_u32 v4, v13, 3, v0
    v_lshrrev_b32 v13, 3, v8
    v_and_b32 v14, 1, v13
    v_lshrrev_b32 v13, 1, v13
    v_lshl_add_u32 v13, v14, 2, v13
    v_lshlrev_b32 v5, 4, v13
    v_add_u32 v5, s52, v5
    v_add_u32 v16, s52, v1
    v_lshrrev_b32 v17, 2, v8
    v_mul_u32_u24 v17, 56, v17
    v_and_b32 v13, 3, v8
    v_lshl_add_u32 v17, v13, 1, v17
    v_add_u32 v17, s52, v17
    s_nop 1
    s_branch M_win
M_send:
    s_mov_b64 s[8:9], 0
    s_mov_b64 s[10:11], 0
    s_mov_b32 s48, 0
    s_mov_b32 s76, 1
    s_movk_i32 s63, 0x70
    s_movk_i32 s64, 2176
    v_lshrrev_b32 v8, 4, v1
    v_lshrrev_b32 v10, 5, v8
    v_and_b32 v11, 31, v8
    v_lshlrev_b32 v3, 4, v11
    v_add_u32 v3, s52, v3
    v_mul_u32_u24 v0, 56, v10
    v_add_u32 v0, s52, v0
    v_lshrrev_b32 v13, 3, v11
    v_lshl_add_u32 v4, v13, 3, v0
    v_lshrrev_b32 v13, 3, v8
    v_and_b32 v14, 1, v13
    v_lshrrev_b32 v13, 1, v13
    v_lshl_add_u32 v13, v14, 2, v13
    v_lshlrev_b32 v5, 4, v13
    v_add_u32 v5, s52, v5
    v_add_u32 v16, s52, v1
    v_lshrrev_b32 v17, 2, v8
    v_mul_u32_u24 v17, 56, v17
    v_and_b32 v13, 3, v8
    v_lshl_add_u32 v17, v13, 1, v17
    v_add_u32 v17, s52, v17
    s_nop 1
    s_branch M_win
.section .rodata,"a"
.p2align 6
.amdhsa_kernel standalone__molecular_angular_painn__graph_kernel
  .amdhsa_next_free_vgpr 256
  .amdhsa_next_free_sgpr 102
  .amdhsa_accum_offset 256
  .amdhsa_group_segment_fixed_size 0
  .amdhsa_kernarg_size 88
  .amdhsa_user_sgpr_count 2
  .amdhsa_user_sgpr_kernarg_segment_ptr 1
  .amdhsa_system_sgpr_workgroup_id_x 1
  .amdhsa_float_denorm_mode_32 3
.end_amdhsa_kernel
```
